```python
import torch

def _softmax(x, axis=-1):
    return torch.softmax(x, dim=axis)
def _gelu(x):
    return torch.nn.functional.gelu(x, approximate="tanh")
def _silu(x):
    return torch.nn.functional.silu(x)
def _sigmoid(x):
    return torch.sigmoid(x)
def _layernorm(x, axis=-1, eps=1e-5):
    m = x.mean(dim=axis, keepdim=True)
    v = x.var(dim=axis, keepdim=True, unbiased=False)
    return (x - m) / torch.sqrt(v + eps)
def _scatter_add(tgt, idx, src, axis=0):
    return tgt.clone().index_add_(axis, idx, src)
def _segment_sum(src, seg, n):
    out = torch.zeros((n,) + src.shape[1:], dtype=src.dtype)
    return out.index_add_(0, seg, src)
def _pad(x, pw):
    flat = tuple(v for pair in reversed(pw) for v in pair)
    return torch.nn.functional.pad(x, flat)

kernel_name = 'interleave_layers__sliding_local_dilated__glu_gated_swiglu__prompt'

def setup_inputs():

    _w = (lambda a: (lambda t: t.to(torch.bfloat16) if t.is_floating_point() else t)(torch.as_tensor(a)))
    def _A_setup():
        B, S, D = 1, 2048, 1024
        return {
            "x": _w((lambda *s: torch.randn(*s, dtype=torch.bfloat16) * 0.05)(B, S, D)),
            "wqkv": _w((lambda *s: torch.randn(*s, dtype=torch.bfloat16) * 0.05)(D, 3 * D)),
            "wo": _w((lambda *s: torch.randn(*s, dtype=torch.bfloat16) * 0.05)(D, D)),
        }
    _A_in = _A_setup()

    def _B_setup():
        B, S, D, F = 1, 2048, 1024, 3584
        return {
            "x": _w((lambda *s: torch.randn(*s, dtype=torch.bfloat16) * 0.05)(B, S, D)),
            "w1": _w((lambda *s: torch.randn(*s, dtype=torch.bfloat16) * 0.8)(D, F) * (2.0 / D) ** 0.5),
            "w3": _w((lambda *s: torch.randn(*s, dtype=torch.bfloat16) * 0.8)(D, F) * (2.0 / D) ** 0.5),
            "w2": _w((lambda *s: torch.randn(*s, dtype=torch.bfloat16) * 0.8)(F, D) * (2.0 / F) ** 0.5),
        }
    _B_in = _B_setup()

    return {
        "A_x": _A_in["x"],
        "A_wqkv": _A_in["wqkv"],
        "A_wo": _A_in["wo"],
        "B_x": _B_in["x"],
        "B_w1": _B_in["w1"],
        "B_w3": _B_in["w3"],
        "B_w2": _B_in["w2"],
    }

def reference(A_x, A_wqkv, A_wo, B_x, B_w1, B_w3, B_w2):
    def _A_ref(x, wqkv, wo):
        B, S, D = x.shape
        H = 32; Dh = D // H
        W, dil = 8, 2
        qkv = (lambda x, *d: x.permute(*d))((x @ wqkv).reshape(B, S, 3, H, Dh), 2, 0, 3, 1, 4)
        q, k, v = qkv[0], qkv[1], qkv[2]
        scale = Dh ** -0.5
        pos = torch.arange(S)
        off = torch.arange(W) * dil
        idx = pos[:, None] - off[None, :]
        mask = idx >= 0
        idx_c = torch.where(mask, idx, 0).reshape(-1)
        kg = k[:, :, idx_c, :].reshape(B, H, S, W, Dh)
        vg = v[:, :, idx_c, :].reshape(B, H, S, W, Dh)
        logits = torch.einsum("bhsd,bhswd->bhsw", q, kg) * scale
        logits = torch.where(mask[None, None, :, :], logits, -1e9)
        attn = _softmax(logits, axis=-1)
        o = torch.einsum("bhsw,bhswd->bhsd", attn, vg)
        return (lambda x, *d: x.permute(*d))(o, 0, 2, 1, 3).reshape(B, S, D) @ wo

    def _B_ref(x, w1, w3, w2):
        gate = torch.einsum("bsd,df->bsf", x, w1)
        up = torch.einsum("bsd,df->bsf", x, w3)
        h = _silu(gate) * up
        out = torch.einsum("bsf,fd->bsd", h, w2)
        return out

    x = A_x
    x = x + _A_ref(_layernorm(x, axis=-1), A_wqkv, A_wo)
    x = x + _B_ref(_layernorm(x, axis=-1), B_w1, B_w3, B_w2)
    x = x + _A_ref(_layernorm(x, axis=-1), A_wqkv, A_wo)
    x = x + _B_ref(_layernorm(x, axis=-1), B_w1, B_w3, B_w2)
    return x
```

```asm
; @launch grid=(256,1,1) block=(512,1,1) lds=163840
.amdgcn_target "amdgcn-amd-amdhsa--gfx950"
.text
.globl interleave_layers__sliding_local_dilated__glu_gated_swiglu__prompt_kernel
.p2align 8
.type interleave_layers__sliding_local_dilated__glu_gated_swiglu__prompt_kernel,@function
interleave_layers__sliding_local_dilated__glu_gated_swiglu__prompt_kernel:
    s_cmp_ge_u32 s2, 256
    s_cbranch_scc1 L_end
    s_load_dwordx4 s[84:87], s[0:1], 0
    s_load_dwordx2 s[4:5], s[0:1], 72
    s_load_dwordx2 s[88:89], s[0:1], 16
    s_load_dwordx4 s[92:95], s[0:1], 32
    s_load_dwordx4 s[96:99], s[0:1], 48
    s_load_dwordx2 s[90:91], s[0:1], 64
    v_lshrrev_b32 v1, 6, v0
    v_and_b32 v250, 63, v0
    v_readfirstlane_b32 s3, v1
    v_lshrrev_b32 v251, 4, v250
    v_and_b32 v252, 15, v250
    v_lshlrev_b32 v249, 4, v250
    s_and_b32 s70, s2, 7
    s_lshr_b32 s72, s2, 4
    s_lshr_b32 s71, s2, 3
    s_and_b32 s71, s71, 1
    s_lshl_b32 s73, s70, 1
    s_sub_u32 s74, s72, s73
    s_and_b32 s74, s74, 15
    s_add_u32 s73, s73, s71
    s_add_u32 s61, s74, s70
    s_and_b32 s61, s61, 7
    s_lshl_b32 s68, s61, 1
    s_lshr_b32 s64, s74, 3
    s_add_u32 s68, s68, s64
    s_lshl_b32 s67, s70, 1
    s_add_u32 s67, s67, s72
    s_and_b32 s67, s67, 15
    s_mov_b32 s60, 0
    s_mov_b32 s59, 1
    s_lshl_b32 s57, s70, 1
    s_mov_b32 s58, s70
    s_and_b32 s69, s3, 3
    s_mov_b32 s75, 0
    s_mov_b32 s78, 1
    s_mov_b32 s79, 4194304
    s_waitcnt lgkmcnt(0)
    s_mov_b32 s80, s4
    s_mov_b32 s81, s5
    s_mov_b32 s82, 79691776
    s_mov_b32 s83, 0x00020000
    s_cmp_ge_u32 s3, 4
    s_cbranch_scc1 L_load
    s_mul_i32 s64, s3, 18432
    v_add_u32 v8, s64, v249
    v_mov_b32 v4, 0x3f803f80
    v_mov_b32 v5, 0x3f803f80
    v_mov_b32 v6, 0x3f803f80
    v_mov_b32 v7, 0x3f803f80
    s_mov_b64 exec, 0xff
    ds_write_b128 v8, v[4:7]
    s_mov_b64 exec, -1
    s_lshl_b32 s64, s3, 2
    s_add_u32 s64, s64, 163472
    v_mov_b32 v8, s64
    v_mov_b32 v0, 0
    ds_write_b32 v8, v0
    s_cmp_lg_u32 s3, 3
    s_cbranch_scc1 L_noinit
    v_mov_b32 v1, 0
    v_mov_b32 v2, 0
    v_mov_b32 v3, 0
    v_lshrrev_b32 v8, 1, v250
    v_lshlrev_b32 v8, 13, v8
    v_and_b32 v9, 1, v250
    v_lshl_add_u32 v8, v9, 4, v8
    s_lshl_b32 s64, s73, 4
    s_add_u32 s64, s64, s72
    s_lshl_b32 s64, s64, 5
    s_add_u32 s65, s64, 75497472
    s_mov_b64 exec, 0xffff
    buffer_store_dwordx4 v[0:3], v8, s[80:83], s65 offen sc0 sc1
    s_mov_b64 exec, 3
    s_add_u32 s65, s64, 75571200
    buffer_store_dwordx4 v[0:3], v249, s[80:83], s65 offen sc0 sc1
    s_lshl_b32 s64, s74, 4
    s_add_u32 s64, s64, s73
    s_lshl_b32 s64, s64, 5
    s_add_u32 s65, s64, 75579392
    buffer_store_dwordx4 v[0:3], v249, s[80:83], s65 offen sc0 sc1
    s_lshl_b32 s64, s73, 4
    s_add_u32 s64, s64, s74
    s_lshl_b32 s64, s64, 4
    s_add_u32 s65, s64, 75563008
    v_lshlrev_b32 v8, 12, v250
    buffer_store_dwordx4 v[0:3], v8, s[80:83], s65 offen sc0 sc1
    s_mov_b64 exec, -1
L_noinit:
    s_mov_b32 s8, s84
    s_mov_b32 s9, s85
    s_mov_b32 s10, 4194304
    s_mov_b32 s11, 0x00020000
    s_lshl_b32 s16, s72, 2
    s_add_u32 s16, s16, s3
    s_lshl_b32 s16, s16, 1
    s_lshl_b32 s17, s73, 7
    s_add_u32 s18, s17, s16
    s_lshl_b32 s18, s18, 11
    s_add_u32 s19, s17, s72
    s_sub_u32 s19, s19, 16
    s_lshl_b32 s19, s19, 11
    s_cmp_eq_u32 s73, 0
    s_cselect_b32 s19, 0x7f000000, s19
    s_cmp_lg_u32 s3, 0
    s_cselect_b32 s19, 0x7f000000, s19
    buffer_load_dwordx4 v[16:19], v249, s[8:11], s18 offen offset:0
    buffer_load_dwordx4 v[20:23], v249, s[8:11], s18 offen offset:1024
    buffer_load_dwordx4 v[24:27], v249, s[8:11], s18 offen offset:2048
    buffer_load_dwordx4 v[28:31], v249, s[8:11], s18 offen offset:3072
    v_mov_b32 v32, 0
    v_mov_b32 v33, 0
    v_mov_b32 v34, 0
    v_mov_b32 v35, 0
    v_mov_b32 v36, 0
    v_mov_b32 v37, 0
    v_mov_b32 v38, 0
    v_mov_b32 v39, 0
    s_cbranch_scc1 xs_1
    buffer_load_dwordx4 v[32:35], v249, s[8:11], s19 offen offset:0
    buffer_load_dwordx4 v[36:39], v249, s[8:11], s19 offen offset:1024
xs_1:
    v_mov_b32 v56, 0x3f803f80
    s_waitcnt vmcnt(0)
    v_dot2_f32_bf16 v48, v16, v56, 0
    v_dot2_f32_bf16 v49, v16, v16, 0
    v_dot2_f32_bf16 v48, v17, v56, v48
    v_dot2_f32_bf16 v49, v17, v17, v49
    v_dot2_f32_bf16 v48, v18, v56, v48
    v_dot2_f32_bf16 v49, v18, v18, v49
    v_dot2_f32_bf16 v48, v19, v56, v48
    v_dot2_f32_bf16 v49, v19, v19, v49
    v_dot2_f32_bf16 v48, v20, v56, v48
    v_dot2_f32_bf16 v49, v20, v20, v49
    v_dot2_f32_bf16 v48, v21, v56, v48
    v_dot2_f32_bf16 v49, v21, v21, v49
    v_dot2_f32_bf16 v48, v22, v56, v48
    v_dot2_f32_bf16 v49, v22, v22, v49
    v_dot2_f32_bf16 v48, v23, v56, v48
    v_dot2_f32_bf16 v49, v23, v23, v49
    v_dot2_f32_bf16 v50, v24, v56, 0
    v_dot2_f32_bf16 v51, v24, v24, 0
    v_dot2_f32_bf16 v50, v25, v56, v50
    v_dot2_f32_bf16 v51, v25, v25, v51
    v_dot2_f32_bf16 v50, v26, v56, v50
    v_dot2_f32_bf16 v51, v26, v26, v51
    v_dot2_f32_bf16 v50, v27, v56, v50
    v_dot2_f32_bf16 v51, v27, v27, v51
    v_dot2_f32_bf16 v50, v28, v56, v50
    v_dot2_f32_bf16 v51, v28, v28, v51
    v_dot2_f32_bf16 v50, v29, v56, v50
    v_dot2_f32_bf16 v51, v29, v29, v51
    v_dot2_f32_bf16 v50, v30, v56, v50
    v_dot2_f32_bf16 v51, v30, v30, v51
    v_dot2_f32_bf16 v50, v31, v56, v50
    v_dot2_f32_bf16 v51, v31, v31, v51
    v_dot2_f32_bf16 v52, v32, v56, 0
    v_dot2_f32_bf16 v53, v32, v32, 0
    v_dot2_f32_bf16 v52, v33, v56, v52
    v_dot2_f32_bf16 v53, v33, v33, v53
    v_dot2_f32_bf16 v52, v34, v56, v52
    v_dot2_f32_bf16 v53, v34, v34, v53
    v_dot2_f32_bf16 v52, v35, v56, v52
    v_dot2_f32_bf16 v53, v35, v35, v53
    v_dot2_f32_bf16 v52, v36, v56, v52
    v_dot2_f32_bf16 v53, v36, v36, v53
    v_dot2_f32_bf16 v52, v37, v56, v52
    v_dot2_f32_bf16 v53, v37, v37, v53
    v_dot2_f32_bf16 v52, v38, v56, v52
    v_dot2_f32_bf16 v53, v38, v38, v53
    v_dot2_f32_bf16 v52, v39, v56, v52
    v_dot2_f32_bf16 v53, v39, v39, v53
    s_nop 2
    v_add_f32_dpp v48, v48, v48 quad_perm:[1,0,3,2] row_mask:0xf bank_mask:0xf
    v_add_f32_dpp v49, v49, v49 quad_perm:[1,0,3,2] row_mask:0xf bank_mask:0xf
    v_add_f32_dpp v50, v50, v50 quad_perm:[1,0,3,2] row_mask:0xf bank_mask:0xf
    v_add_f32_dpp v51, v51, v51 quad_perm:[1,0,3,2] row_mask:0xf bank_mask:0xf
    v_add_f32_dpp v52, v52, v52 quad_perm:[1,0,3,2] row_mask:0xf bank_mask:0xf
    v_add_f32_dpp v53, v53, v53 quad_perm:[1,0,3,2] row_mask:0xf bank_mask:0xf
    v_add_f32_dpp v48, v48, v48 quad_perm:[2,3,0,1] row_mask:0xf bank_mask:0xf
    v_add_f32_dpp v49, v49, v49 quad_perm:[2,3,0,1] row_mask:0xf bank_mask:0xf
    v_add_f32_dpp v50, v50, v50 quad_perm:[2,3,0,1] row_mask:0xf bank_mask:0xf
    v_add_f32_dpp v51, v51, v51 quad_perm:[2,3,0,1] row_mask:0xf bank_mask:0xf
    v_add_f32_dpp v52, v52, v52 quad_perm:[2,3,0,1] row_mask:0xf bank_mask:0xf
    v_add_f32_dpp v53, v53, v53 quad_perm:[2,3,0,1] row_mask:0xf bank_mask:0xf
    v_add_f32_dpp v48, v48, v48 row_half_mirror row_mask:0xf bank_mask:0xf
    v_add_f32_dpp v49, v49, v49 row_half_mirror row_mask:0xf bank_mask:0xf
    v_add_f32_dpp v50, v50, v50 row_half_mirror row_mask:0xf bank_mask:0xf
    v_add_f32_dpp v51, v51, v51 row_half_mirror row_mask:0xf bank_mask:0xf
    v_add_f32_dpp v52, v52, v52 row_half_mirror row_mask:0xf bank_mask:0xf
    v_add_f32_dpp v53, v53, v53 row_half_mirror row_mask:0xf bank_mask:0xf
    v_add_f32_dpp v48, v48, v48 row_mirror row_mask:0xf bank_mask:0xf
    v_add_f32_dpp v49, v49, v49 row_mirror row_mask:0xf bank_mask:0xf
    v_add_f32_dpp v50, v50, v50 row_mirror row_mask:0xf bank_mask:0xf
    v_add_f32_dpp v51, v51, v51 row_mirror row_mask:0xf bank_mask:0xf
    v_add_f32_dpp v52, v52, v52 row_mirror row_mask:0xf bank_mask:0xf
    v_add_f32_dpp v53, v53, v53 row_mirror row_mask:0xf bank_mask:0xf
    v_mov_b32 v16, v48
    v_mov_b32 v17, v49
    v_mov_b32 v18, v50
    v_mov_b32 v19, v51
    v_mov_b32 v20, v52
    v_mov_b32 v21, v53
    s_nop 1
    v_permlane16_swap_b32 v48, v16
    v_permlane16_swap_b32 v49, v17
    v_permlane16_swap_b32 v50, v18
    v_permlane16_swap_b32 v51, v19
    v_permlane16_swap_b32 v52, v20
    v_permlane16_swap_b32 v53, v21
    v_add_f32 v48, v48, v16
    v_add_f32 v49, v49, v17
    v_add_f32 v50, v50, v18
    v_add_f32 v51, v51, v19
    v_add_f32 v52, v52, v20
    v_add_f32 v53, v53, v21
    v_mov_b32 v16, v48
    v_mov_b32 v17, v49
    v_mov_b32 v18, v50
    v_mov_b32 v19, v51
    v_mov_b32 v20, v52
    v_mov_b32 v21, v53
    s_nop 1
    v_permlane32_swap_b32 v48, v16
    v_permlane32_swap_b32 v49, v17
    v_permlane32_swap_b32 v50, v18
    v_permlane32_swap_b32 v51, v19
    v_permlane32_swap_b32 v52, v20
    v_permlane32_swap_b32 v53, v21
    v_add_f32 v48, v48, v16
    v_add_f32 v49, v49, v17
    v_add_f32 v50, v50, v18
    v_add_f32 v51, v51, v19
    v_add_f32 v52, v52, v20
    v_add_f32 v53, v53, v21
    v_cmp_eq_u32 vcc, 1, v250
    s_nop 1
    v_cndmask_b32 v48, v48, v50, vcc
    v_cndmask_b32 v49, v49, v51, vcc
    v_cmp_eq_u32 vcc, 2, v250
    s_nop 1
    v_cndmask_b32 v48, v48, v52, vcc
    v_cndmask_b32 v49, v49, v53, vcc
    v_mul_f32 v48, 0x3a800000, v48
    v_mul_f32 v49, 0x3a800000, v49
    v_fma_f32 v49, -v48, v48, v49
    v_max_f32 v49, 0, v49
    v_cvt_pk_bf16_f32 v48, v48, v48
    v_lshlrev_b32 v48, 16, v48
    v_cvt_pk_bf16_f32 v49, v49, v49
    v_lshlrev_b32 v49, 16, v49
    v_add_f32 v49, 0x3727c5ac, v49
    v_cvt_pk_bf16_f32 v49, v49, v49
    v_lshlrev_b32 v49, 16, v49
    v_sqrt_f32 v49, v49
    s_nop 0
    v_cvt_pk_bf16_f32 v49, v49, v49
    v_lshlrev_b32 v49, 16, v49
    v_rcp_f32 v49, v49
    s_nop 0
    s_add_u32 s16, s16, 16
    v_add_u32 v16, s16, v250
    v_mov_b32 v17, s72
    v_cndmask_b32 v16, v16, v17, vcc
    v_lshlrev_b32 v16, 3, v16
    s_lshl_b32 s17, s73, 11
    s_add_u32 s17, s17, 74186752
    s_cmp_eq_u32 s3, 0
    s_cselect_b64 exec, 7, 3
    buffer_store_dwordx2 v[48:49], v16, s[80:83], s17 offen sc0 sc1
    s_mov_b64 exec, -1
    s_waitcnt lgkmcnt(0)
C_layer:
    s_and_b32 s19, s3, 1
    s_lshr_b32 s20, s3, 1
    s_cmp_lg_u32 s75, 0
    s_cbranch_scc1 ad_2_f
    v_lshlrev_b32 v253, 7, v252
    v_and_b32 v254, 6, v250
    v_xor_b32 v254, v254, v251
    v_lshl_add_u32 v204, v254, 4, v253
    v_xor_b32 v205, 64, v204
    s_branch ad_2_d
ad_2_f:
    v_mov_b32 v204, v249
    v_add_u32 v205, 1024, v249
ad_2_d:
    v_lshrrev_b32 v253, 2, v252
    v_mul_u32_u24 v253, 3104, v253
    v_lshl_add_u32 v253, v251, 7, v253
    v_and_b32 v254, 3, v252
    v_lshl_add_u32 v253, v254, 3, v253
    s_lshl_b32 s64, s19, 6
    s_add_u32 s64, s64, 73984
    v_add_u32 v208, s64, v253
    v_mov_b32 v209, v208
    s_mov_b32 s16, 0
    s_mov_b32 s17, 18432
    v_add_u32 v206, s17, v204
    v_add_u32 v207, s17, v205
    s_lshl_b32 s21, s73, 4
    s_add_u32 s21, s21, s67
    s_lshl_b32 s21, s21, 1
    s_add_u32 s21, s21, s19
    s_lshl_b32 s21, s21, 1
    s_add_u32 s21, s21, s20
    s_lshl_b32 s21, s21, 12
    s_lshl_b32 s64, s60, 22
    s_add_u32 s21, s21, s64
    s_add_u32 s21, s21, 12582912
    v_lshlrev_b32 v253, 2, v251
    v_sub_u32 v253, v252, v253
    v_subrev_u32 v254, 0, v253
    v_and_b32 v210, 1, v254
    v_cmp_eq_u32 s[26:27], 0, v210
    v_cmp_le_i32 vcc, 0, v254
    s_and_b64 s[28:29], s[26:27], vcc
    v_cmp_ge_i32 vcc, -2, v254
    s_and_b64 s[36:37], s[26:27], vcc
    v_subrev_u32 v254, 1, v253
    v_and_b32 v210, 1, v254
    v_cmp_eq_u32 s[26:27], 0, v210
    v_cmp_le_i32 vcc, 0, v254
    s_and_b64 s[30:31], s[26:27], vcc
    v_cmp_ge_i32 vcc, -2, v254
    s_and_b64 s[38:39], s[26:27], vcc
    v_subrev_u32 v254, 2, v253
    v_and_b32 v210, 1, v254
    v_cmp_eq_u32 s[26:27], 0, v210
    v_cmp_le_i32 vcc, 0, v254
    s_and_b64 s[32:33], s[26:27], vcc
    v_cmp_ge_i32 vcc, -2, v254
    s_and_b64 s[40:41], s[26:27], vcc
    v_subrev_u32 v254, 3, v253
    v_and_b32 v210, 1, v254
    v_cmp_eq_u32 s[26:27], 0, v210
    v_cmp_le_i32 vcc, 0, v254
    s_and_b64 s[34:35], s[26:27], vcc
    v_cmp_ge_i32 vcc, -2, v254
    s_and_b64 s[42:43], s[26:27], vcc
    s_or_b32 s22, s73, s20
    s_cmp_eq_u32 s22, 0
    s_cselect_b64 s[44:45], 0, s[36:37]
    s_cselect_b64 s[46:47], 0, s[38:39]
    s_cselect_b64 s[48:49], 0, s[40:41]
    s_cselect_b64 s[50:51], 0, s[42:43]
    s_mov_b32 s23, 0x3e8293ee
    s_mov_b32 s24, 0xf149f2ca
    v_mov_b32 v212, 0
    v_mov_b32 v213, 0
    v_mov_b32 v214, 0
    v_mov_b32 v215, 0
    s_mov_b32 s18, 16
    s_nop 0
    v_mfma_f32_32x32x16_bf16 v[0:15], v[212:215], v[212:215], 0
    v_mfma_f32_32x32x16_bf16 v[16:31], v[212:215], v[212:215], 0
    v_mfma_f32_32x32x16_bf16 v[32:47], v[212:215], v[212:215], 0
    v_mfma_f32_32x32x16_bf16 v[48:63], v[212:215], v[212:215], 0
    v_mfma_f32_32x32x16_bf16 v[64:79], v[212:215], v[212:215], 0
    v_mfma_f32_32x32x16_bf16 v[80:95], v[212:215], v[212:215], 0
    v_mfma_f32_32x32x16_bf16 v[96:111], v[212:215], v[212:215], 0
    v_mfma_f32_32x32x16_bf16 v[112:127], v[212:215], v[212:215], 0
    s_nop 7
    s_nop 3
    s_cmp_eq_u32 s20, 1
    s_cbranch_scc1 g1c_r1
    s_barrier
    ds_read_b128 v[116:119], v206 offset:0
    ds_read_b64_tr_b16 v[164:165], v209 offset:13440
    ds_read_b64_tr_b16 v[166:167], v209 offset:13952
    ds_read_b128 v[120:123], v206 offset:2048
    ds_read_b64_tr_b16 v[168:169], v209 offset:13472
    ds_read_b64_tr_b16 v[170:171], v209 offset:13984
    ds_read_b128 v[124:127], v206 offset:4096
    ds_read_b64_tr_b16 v[172:173], v209 offset:14464
    ds_read_b64_tr_b16 v[174:175], v209 offset:14976
    ds_read_b128 v[128:131], v206 offset:6144
    ds_read_b64_tr_b16 v[176:177], v209 offset:14496
    ds_read_b64_tr_b16 v[178:179], v209 offset:15008
    ds_read_b128 v[132:135], v206 offset:8192
    ds_read_b64_tr_b16 v[156:157], v209 offset:12416
    ds_read_b64_tr_b16 v[158:159], v209 offset:12928
    ds_read_b64_tr_b16 v[160:161], v209 offset:12448
    ds_read_b64_tr_b16 v[162:163], v209 offset:12960
    s_add_u32 s16, s16, 24832
    s_cmp_eq_u32 s16, 74496
    s_cselect_b32 s16, 0, s16
    v_add_u32 v209, s16, v208
    s_waitcnt lgkmcnt(0)
g1c_loop0:
    s_barrier
    v_mfma_f32_16x16x32_bf16 v[112:115], v[156:159], v[116:119], v[112:115]
    ds_read_b128 v[136:139], v207 offset:0
    v_mfma_f32_16x16x32_bf16 v[32:35], v[164:167], v[116:119], v[32:35]
    ds_read_b64_tr_b16 v[188:189], v209 offset:1024
    v_mfma_f32_16x16x32_bf16 v[36:39], v[168:171], v[116:119], v[36:39]
    ds_read_b64_tr_b16 v[190:191], v209 offset:1536
    v_mfma_f32_16x16x32_bf16 v[40:43], v[164:167], v[120:123], v[40:43]
    ds_read_b128 v[140:143], v207 offset:2048
    v_mfma_f32_16x16x32_bf16 v[48:51], v[164:167], v[124:127], v[48:51]
    ds_read_b64_tr_b16 v[192:193], v209 offset:1056
    v_mfma_f32_16x16x32_bf16 v[56:59], v[164:167], v[128:131], v[56:59]
    ds_read_b64_tr_b16 v[194:195], v209 offset:1568
    v_mfma_f32_16x16x32_bf16 v[64:67], v[164:167], v[132:135], v[64:67]
    ds_read_b128 v[144:147], v207 offset:4096
    v_mfma_f32_16x16x32_bf16 v[44:47], v[168:171], v[120:123], v[44:47]
    ds_read_b64_tr_b16 v[196:197], v209 offset:2048
    v_mfma_f32_16x16x32_bf16 v[52:55], v[168:171], v[124:127], v[52:55]
    ds_read_b64_tr_b16 v[198:199], v209 offset:2560
    v_mfma_f32_16x16x32_bf16 v[60:63], v[168:171], v[128:131], v[60:63]
    ds_read_b128 v[148:151], v207 offset:6144
    v_mfma_f32_16x16x32_bf16 v[68:71], v[168:171], v[132:135], v[68:71]
    ds_read_b64_tr_b16 v[200:201], v209 offset:2080
    v_mfma_f32_16x16x32_bf16 v[80:83], v[120:123], v[172:175], v[80:83]
    ds_read_b64_tr_b16 v[202:203], v209 offset:2592
    v_mfma_f32_16x16x32_bf16 v[88:91], v[124:127], v[172:175], v[88:91]
    ds_read_b128 v[152:155], v207 offset:8192
    v_mfma_f32_16x16x32_bf16 v[96:99], v[128:131], v[172:175], v[96:99]
    ds_read_b64_tr_b16 v[180:181], v209 offset:0
    v_mfma_f32_16x16x32_bf16 v[104:107], v[132:135], v[172:175], v[104:107]
    ds_read_b64_tr_b16 v[182:183], v209 offset:512
    v_mfma_f32_16x16x32_bf16 v[84:87], v[120:123], v[176:179], v[84:87]
    ds_read_b64_tr_b16 v[184:185], v209 offset:32
    v_mfma_f32_16x16x32_bf16 v[92:95], v[124:127], v[176:179], v[92:95]
    ds_read_b64_tr_b16 v[186:187], v209 offset:544
    v_mfma_f32_16x16x32_bf16 v[100:103], v[128:131], v[176:179], v[100:103]
    v_mfma_f32_16x16x32_bf16 v[108:111], v[132:135], v[176:179], v[108:111]
    s_add_u32 s17, s17, 18432
    s_cmp_eq_u32 s17, 73728
    v_mfma_f32_16x16x32_bf16 v[0:3], v[156:159], v[120:123], v[0:3]
    v_mfma_f32_16x16x32_bf16 v[8:11], v[156:159], v[124:127], v[8:11]
    s_cselect_b32 s17, 0, s17
    v_mfma_f32_16x16x32_bf16 v[16:19], v[156:159], v[128:131], v[16:19]
    v_mfma_f32_16x16x32_bf16 v[24:27], v[156:159], v[132:135], v[24:27]
    v_add_u32 v206, s17, v204
    v_mfma_f32_16x16x32_bf16 v[4:7], v[160:163], v[120:123], v[4:7]
    v_mfma_f32_16x16x32_bf16 v[12:15], v[160:163], v[124:127], v[12:15]
    v_add_u32 v207, s17, v205
    v_mfma_f32_16x16x32_bf16 v[20:23], v[160:163], v[128:131], v[20:23]
    v_mfma_f32_16x16x32_bf16 v[28:31], v[160:163], v[132:135], v[28:31]
    s_waitcnt lgkmcnt(0)
    v_mfma_f32_16x16x32_bf16 v[112:115], v[180:183], v[136:139], v[112:115]
    ds_read_b128 v[116:119], v206 offset:0
    v_mfma_f32_16x16x32_bf16 v[32:35], v[188:191], v[136:139], v[32:35]
    ds_read_b64_tr_b16 v[164:165], v209 offset:13440
    v_mfma_f32_16x16x32_bf16 v[36:39], v[192:195], v[136:139], v[36:39]
    ds_read_b64_tr_b16 v[166:167], v209 offset:13952
    v_mfma_f32_16x16x32_bf16 v[40:43], v[188:191], v[140:143], v[40:43]
    ds_read_b128 v[120:123], v206 offset:2048
    v_mfma_f32_16x16x32_bf16 v[48:51], v[188:191], v[144:147], v[48:51]
    ds_read_b64_tr_b16 v[168:169], v209 offset:13472
    v_mfma_f32_16x16x32_bf16 v[56:59], v[188:191], v[148:151], v[56:59]
    ds_read_b64_tr_b16 v[170:171], v209 offset:13984
    v_mfma_f32_16x16x32_bf16 v[64:67], v[188:191], v[152:155], v[64:67]
    ds_read_b128 v[124:127], v206 offset:4096
    v_mfma_f32_16x16x32_bf16 v[44:47], v[192:195], v[140:143], v[44:47]
    ds_read_b64_tr_b16 v[172:173], v209 offset:14464
    v_mfma_f32_16x16x32_bf16 v[52:55], v[192:195], v[144:147], v[52:55]
    ds_read_b64_tr_b16 v[174:175], v209 offset:14976
    v_mfma_f32_16x16x32_bf16 v[60:63], v[192:195], v[148:151], v[60:63]
    ds_read_b128 v[128:131], v206 offset:6144
    v_mfma_f32_16x16x32_bf16 v[68:71], v[192:195], v[152:155], v[68:71]
    ds_read_b64_tr_b16 v[176:177], v209 offset:14496
    v_mfma_f32_16x16x32_bf16 v[80:83], v[140:143], v[196:199], v[80:83]
    ds_read_b64_tr_b16 v[178:179], v209 offset:15008
    v_mfma_f32_16x16x32_bf16 v[88:91], v[144:147], v[196:199], v[88:91]
    ds_read_b128 v[132:135], v206 offset:8192
    v_mfma_f32_16x16x32_bf16 v[96:99], v[148:151], v[196:199], v[96:99]
    ds_read_b64_tr_b16 v[156:157], v209 offset:12416
    v_mfma_f32_16x16x32_bf16 v[104:107], v[152:155], v[196:199], v[104:107]
    ds_read_b64_tr_b16 v[158:159], v209 offset:12928
    v_mfma_f32_16x16x32_bf16 v[84:87], v[140:143], v[200:203], v[84:87]
    ds_read_b64_tr_b16 v[160:161], v209 offset:12448
    v_mfma_f32_16x16x32_bf16 v[92:95], v[144:147], v[200:203], v[92:95]
    ds_read_b64_tr_b16 v[162:163], v209 offset:12960
    v_mfma_f32_16x16x32_bf16 v[100:103], v[148:151], v[200:203], v[100:103]
    v_mfma_f32_16x16x32_bf16 v[108:111], v[152:155], v[200:203], v[108:111]
    s_add_u32 s16, s16, 24832
    s_cmp_eq_u32 s16, 74496
    v_mfma_f32_16x16x32_bf16 v[0:3], v[180:183], v[140:143], v[0:3]
    v_mfma_f32_16x16x32_bf16 v[8:11], v[180:183], v[144:147], v[8:11]
    s_cselect_b32 s16, 0, s16
    v_mfma_f32_16x16x32_bf16 v[16:19], v[180:183], v[148:151], v[16:19]
    v_mfma_f32_16x16x32_bf16 v[24:27], v[180:183], v[152:155], v[24:27]
    v_add_u32 v209, s16, v208
    v_mfma_f32_16x16x32_bf16 v[4:7], v[184:187], v[140:143], v[4:7]
    v_mfma_f32_16x16x32_bf16 v[12:15], v[184:187], v[144:147], v[12:15]
    s_sub_u32 s18, s18, 1
    s_cmp_lg_u32 s18, 0
    v_mfma_f32_16x16x32_bf16 v[20:23], v[184:187], v[148:151], v[20:23]
    v_mfma_f32_16x16x32_bf16 v[28:31], v[184:187], v[152:155], v[28:31]
    s_waitcnt vmcnt(0) lgkmcnt(0)
    s_cbranch_scc1 g1c_loop0
    s_barrier
    s_mul_i32 s64, s19, 6144
    s_add_u32 s64, s64, 18432
    v_add_u32 v116, s64, v249
    s_mul_i32 s64, s19, 384
    s_add_u32 s64, s64, 162688
    v_lshlrev_b32 v117, 4, v251
    v_add_u32 v117, s64, v117
    v_lshlrev_b32 v119, 2, v252
    v_add_u32 v119, s64, v119
    ds_write_b128 v116, v[64:67] offset:0
    ds_write_b128 v116, v[68:71] offset:1024
    ds_write_b128 v116, v[104:107] offset:2048
    ds_write_b128 v116, v[108:111] offset:3072
    s_mov_b32 exec_lo, 0x00010001
    s_mov_b32 exec_hi, 0x00010001
    ds_write_b128 v117, v[112:115]
    ds_write_b128 v117, v[32:35] offset:128
    ds_write_b128 v117, v[36:39] offset:192
    s_mov_b64 exec, -1
    s_lshl_b32 s64, s3, 2
    s_add_u32 s64, s64, 163472
    s_add_u32 s65, s75, 1
    v_mov_b32 v118, s64
    v_mov_b32 v120, s65
    ds_write_b32 v118, v120
    v_xor_b32 v118, 8, v118
    v_mov_b32 v121, 163456
    ds_read_b32 v121, v121
xs_3:
    ds_read_b32 v122, v118
    s_sub_u32 s79, s79, 1
    s_cbranch_scc1 L_abort
    s_waitcnt lgkmcnt(0)
    v_cmp_ne_u32 vcc, v120, v122
    s_cbranch_vccnz xs_3
    v_readfirstlane_b32 s78, v121
    s_mov_b32 s59, s78
    s_mul_i32 s60, s59, s75
    ds_read_b128 v[72:75], v116 offset:4096
    ds_read_b128 v[76:79], v116 offset:5120
    s_branch g1c_epi
g1c_r1:
    s_barrier
    ds_read_b128 v[116:119], v206 offset:0
    ds_read_b64_tr_b16 v[164:165], v209 offset:13440
    ds_read_b64_tr_b16 v[166:167], v209 offset:13952
    ds_read_b128 v[120:123], v206 offset:10240
    ds_read_b64_tr_b16 v[168:169], v209 offset:13472
    ds_read_b64_tr_b16 v[170:171], v209 offset:13984
    ds_read_b128 v[124:127], v206 offset:12288
    ds_read_b64_tr_b16 v[172:173], v209 offset:14464
    ds_read_b64_tr_b16 v[174:175], v209 offset:14976
    ds_read_b128 v[128:131], v206 offset:14336
    ds_read_b64_tr_b16 v[176:177], v209 offset:14496
    ds_read_b64_tr_b16 v[178:179], v209 offset:15008
    ds_read_b128 v[132:135], v206 offset:16384
    ds_read_b64_tr_b16 v[156:157], v209 offset:12416
    ds_read_b64_tr_b16 v[158:159], v209 offset:12928
    ds_read_b64_tr_b16 v[160:161], v209 offset:12448
    ds_read_b64_tr_b16 v[162:163], v209 offset:12960
    s_add_u32 s16, s16, 24832
    s_cmp_eq_u32 s16, 74496
    s_cselect_b32 s16, 0, s16
    v_add_u32 v209, s16, v208
    s_waitcnt lgkmcnt(0)
g1c_loop1:
    s_barrier
    v_mfma_f32_16x16x32_bf16 v[112:115], v[160:163], v[116:119], v[112:115]
    ds_read_b128 v[136:139], v207 offset:0
    v_mfma_f32_16x16x32_bf16 v[72:75], v[116:119], v[172:175], v[72:75]
    ds_read_b64_tr_b16 v[188:189], v209 offset:1024
    v_mfma_f32_16x16x32_bf16 v[76:79], v[116:119], v[176:179], v[76:79]
    ds_read_b64_tr_b16 v[190:191], v209 offset:1536
    v_mfma_f32_16x16x32_bf16 v[40:43], v[164:167], v[120:123], v[40:43]
    ds_read_b128 v[140:143], v207 offset:10240
    v_mfma_f32_16x16x32_bf16 v[48:51], v[164:167], v[124:127], v[48:51]
    ds_read_b64_tr_b16 v[192:193], v209 offset:1056
    v_mfma_f32_16x16x32_bf16 v[56:59], v[164:167], v[128:131], v[56:59]
    ds_read_b64_tr_b16 v[194:195], v209 offset:1568
    v_mfma_f32_16x16x32_bf16 v[64:67], v[164:167], v[132:135], v[64:67]
    ds_read_b128 v[144:147], v207 offset:12288
    v_mfma_f32_16x16x32_bf16 v[44:47], v[168:171], v[120:123], v[44:47]
    ds_read_b64_tr_b16 v[196:197], v209 offset:2048
    v_mfma_f32_16x16x32_bf16 v[52:55], v[168:171], v[124:127], v[52:55]
    ds_read_b64_tr_b16 v[198:199], v209 offset:2560
    v_mfma_f32_16x16x32_bf16 v[60:63], v[168:171], v[128:131], v[60:63]
    ds_read_b128 v[148:151], v207 offset:14336
    v_mfma_f32_16x16x32_bf16 v[68:71], v[168:171], v[132:135], v[68:71]
    ds_read_b64_tr_b16 v[200:201], v209 offset:2080
    v_mfma_f32_16x16x32_bf16 v[80:83], v[120:123], v[172:175], v[80:83]
    ds_read_b64_tr_b16 v[202:203], v209 offset:2592
    v_mfma_f32_16x16x32_bf16 v[88:91], v[124:127], v[172:175], v[88:91]
    ds_read_b128 v[152:155], v207 offset:16384
    v_mfma_f32_16x16x32_bf16 v[96:99], v[128:131], v[172:175], v[96:99]
    ds_read_b64_tr_b16 v[180:181], v209 offset:0
    v_mfma_f32_16x16x32_bf16 v[104:107], v[132:135], v[172:175], v[104:107]
    ds_read_b64_tr_b16 v[182:183], v209 offset:512
    v_mfma_f32_16x16x32_bf16 v[84:87], v[120:123], v[176:179], v[84:87]
    ds_read_b64_tr_b16 v[184:185], v209 offset:32
    v_mfma_f32_16x16x32_bf16 v[92:95], v[124:127], v[176:179], v[92:95]
    ds_read_b64_tr_b16 v[186:187], v209 offset:544
    v_mfma_f32_16x16x32_bf16 v[100:103], v[128:131], v[176:179], v[100:103]
    v_mfma_f32_16x16x32_bf16 v[108:111], v[132:135], v[176:179], v[108:111]
    s_add_u32 s17, s17, 18432
    s_cmp_eq_u32 s17, 73728
    v_mfma_f32_16x16x32_bf16 v[0:3], v[156:159], v[120:123], v[0:3]
    v_mfma_f32_16x16x32_bf16 v[8:11], v[156:159], v[124:127], v[8:11]
    s_cselect_b32 s17, 0, s17
    v_mfma_f32_16x16x32_bf16 v[16:19], v[156:159], v[128:131], v[16:19]
    v_mfma_f32_16x16x32_bf16 v[24:27], v[156:159], v[132:135], v[24:27]
    v_add_u32 v206, s17, v204
    v_mfma_f32_16x16x32_bf16 v[4:7], v[160:163], v[120:123], v[4:7]
    v_mfma_f32_16x16x32_bf16 v[12:15], v[160:163], v[124:127], v[12:15]
    v_add_u32 v207, s17, v205
    v_mfma_f32_16x16x32_bf16 v[20:23], v[160:163], v[128:131], v[20:23]
    v_mfma_f32_16x16x32_bf16 v[28:31], v[160:163], v[132:135], v[28:31]
    s_waitcnt lgkmcnt(0)
    v_mfma_f32_16x16x32_bf16 v[112:115], v[184:187], v[136:139], v[112:115]
    ds_read_b128 v[116:119], v206 offset:0
    v_mfma_f32_16x16x32_bf16 v[72:75], v[136:139], v[196:199], v[72:75]
    ds_read_b64_tr_b16 v[164:165], v209 offset:13440
    v_mfma_f32_16x16x32_bf16 v[76:79], v[136:139], v[200:203], v[76:79]
    ds_read_b64_tr_b16 v[166:167], v209 offset:13952
    v_mfma_f32_16x16x32_bf16 v[40:43], v[188:191], v[140:143], v[40:43]
    ds_read_b128 v[120:123], v206 offset:10240
    v_mfma_f32_16x16x32_bf16 v[48:51], v[188:191], v[144:147], v[48:51]
    ds_read_b64_tr_b16 v[168:169], v209 offset:13472
    v_mfma_f32_16x16x32_bf16 v[56:59], v[188:191], v[148:151], v[56:59]
    ds_read_b64_tr_b16 v[170:171], v209 offset:13984
    v_mfma_f32_16x16x32_bf16 v[64:67], v[188:191], v[152:155], v[64:67]
    ds_read_b128 v[124:127], v206 offset:12288
    v_mfma_f32_16x16x32_bf16 v[44:47], v[192:195], v[140:143], v[44:47]
    ds_read_b64_tr_b16 v[172:173], v209 offset:14464
    v_mfma_f32_16x16x32_bf16 v[52:55], v[192:195], v[144:147], v[52:55]
    ds_read_b64_tr_b16 v[174:175], v209 offset:14976
    v_mfma_f32_16x16x32_bf16 v[60:63], v[192:195], v[148:151], v[60:63]
    ds_read_b128 v[128:131], v206 offset:14336
    v_mfma_f32_16x16x32_bf16 v[68:71], v[192:195], v[152:155], v[68:71]
    ds_read_b64_tr_b16 v[176:177], v209 offset:14496
    v_mfma_f32_16x16x32_bf16 v[80:83], v[140:143], v[196:199], v[80:83]
    ds_read_b64_tr_b16 v[178:179], v209 offset:15008
    v_mfma_f32_16x16x32_bf16 v[88:91], v[144:147], v[196:199], v[88:91]
    ds_read_b128 v[132:135], v206 offset:16384
    v_mfma_f32_16x16x32_bf16 v[96:99], v[148:151], v[196:199], v[96:99]
    ds_read_b64_tr_b16 v[156:157], v209 offset:12416
    v_mfma_f32_16x16x32_bf16 v[104:107], v[152:155], v[196:199], v[104:107]
    ds_read_b64_tr_b16 v[158:159], v209 offset:12928
    v_mfma_f32_16x16x32_bf16 v[84:87], v[140:143], v[200:203], v[84:87]
    ds_read_b64_tr_b16 v[160:161], v209 offset:12448
    v_mfma_f32_16x16x32_bf16 v[92:95], v[144:147], v[200:203], v[92:95]
    ds_read_b64_tr_b16 v[162:163], v209 offset:12960
    v_mfma_f32_16x16x32_bf16 v[100:103], v[148:151], v[200:203], v[100:103]
    v_mfma_f32_16x16x32_bf16 v[108:111], v[152:155], v[200:203], v[108:111]
    s_add_u32 s16, s16, 24832
    s_cmp_eq_u32 s16, 74496
    v_mfma_f32_16x16x32_bf16 v[0:3], v[180:183], v[140:143], v[0:3]
    v_mfma_f32_16x16x32_bf16 v[8:11], v[180:183], v[144:147], v[8:11]
    s_cselect_b32 s16, 0, s16
    v_mfma_f32_16x16x32_bf16 v[16:19], v[180:183], v[148:151], v[16:19]
    v_mfma_f32_16x16x32_bf16 v[24:27], v[180:183], v[152:155], v[24:27]
    v_add_u32 v209, s16, v208
    v_mfma_f32_16x16x32_bf16 v[4:7], v[184:187], v[140:143], v[4:7]
    v_mfma_f32_16x16x32_bf16 v[12:15], v[184:187], v[144:147], v[12:15]
    s_sub_u32 s18, s18, 1
    s_cmp_lg_u32 s18, 0
    v_mfma_f32_16x16x32_bf16 v[20:23], v[184:187], v[148:151], v[20:23]
    v_mfma_f32_16x16x32_bf16 v[28:31], v[184:187], v[152:155], v[28:31]
    s_waitcnt vmcnt(0) lgkmcnt(0)
    s_cbranch_scc1 g1c_loop1
    s_barrier
    s_mul_i32 s64, s19, 6144
    s_add_u32 s64, s64, 18432
    v_add_u32 v116, s64, v249
    s_mul_i32 s64, s19, 384
    s_add_u32 s64, s64, 162688
    v_lshlrev_b32 v117, 4, v251
    v_add_u32 v117, s64, v117
    v_lshlrev_b32 v119, 2, v252
    v_add_u32 v119, s64, v119
    ds_write_b128 v116, v[72:75] offset:4096
    ds_write_b128 v116, v[76:79] offset:5120
    s_mov_b32 exec_lo, 0x00010001
    s_mov_b32 exec_hi, 0x00010001
    ds_write_b128 v117, v[112:115] offset:64
    s_mov_b64 exec, 0xffff
    ds_write_b32 v119, v72 offset:256
    ds_write_b32 v119, v76 offset:320
    s_mov_b64 exec, -1
    s_lshl_b32 s64, s3, 2
    s_add_u32 s64, s64, 163472
    s_add_u32 s65, s75, 1
    v_mov_b32 v118, s64
    v_mov_b32 v120, s65
    ds_write_b32 v118, v120
    v_xor_b32 v118, 8, v118
    v_mov_b32 v121, 163456
    ds_read_b32 v121, v121
xs_4:
    ds_read_b32 v122, v118
    s_sub_u32 s79, s79, 1
    s_cbranch_scc1 L_abort
    s_waitcnt lgkmcnt(0)
    v_cmp_ne_u32 vcc, v120, v122
    s_cbranch_vccnz xs_4
    v_readfirstlane_b32 s78, v121
    s_mov_b32 s59, s78
    s_mul_i32 s60, s59, s75
    ds_read_b128 v[32:35], v116 offset:0
    ds_read_b128 v[36:39], v116 offset:1024
    ds_read_b128 v[72:75], v116 offset:2048
    ds_read_b128 v[76:79], v116 offset:3072
g1c_epi:
    ds_read_b128 v[156:159], v117 offset:0
    ds_read_b128 v[160:163], v117 offset:64
    ds_read_b128 v[164:167], v117 offset:128
    ds_read_b128 v[168:171], v117 offset:192
    ds_read_b32 v172, v119 offset:256
    ds_read_b32 v173, v119 offset:320
    s_lshl_b32 s64, s20, 9
    s_add_u32 s64, s64, 159744
    v_lshlrev_b32 v253, 3, v252
    v_add_u32 v253, s64, v253
    ds_read_b64 v[124:125], v253 offset:0
    ds_read_b64 v[126:127], v253 offset:128
    ds_read_b64 v[128:129], v253 offset:256
    ds_read_b64 v[130:131], v253 offset:384
    ds_read_b64 v[132:133], v253 offset:512
    v_lshlrev_b32 v254, 5, v251
    v_add_u32 v254, s64, v254
    ds_read_b128 v[228:231], v254 offset:0
    ds_read_b128 v[232:235], v254 offset:16
    ds_read_b128 v[236:239], v254 offset:128
    ds_read_b128 v[240:243], v254 offset:144
    s_waitcnt lgkmcnt(0)
    v_sub_f32 v244, 0, v124
    v_fmac_f32 v32, v244, v164
    v_fmac_f32 v33, v244, v165
    v_fmac_f32 v34, v244, v166
    v_fmac_f32 v35, v244, v167
    v_mul_f32 v32, v125, v32
    v_mul_f32 v33, v125, v33
    v_mul_f32 v34, v125, v34
    v_mul_f32 v35, v125, v35
    v_cvt_pk_bf16_f32 v136, v32, v33
    v_cvt_pk_bf16_f32 v137, v34, v35
    v_fmac_f32 v36, v244, v168
    v_fmac_f32 v37, v244, v169
    v_fmac_f32 v38, v244, v170
    v_fmac_f32 v39, v244, v171
    v_mul_f32 v36, v125, v36
    v_mul_f32 v37, v125, v37
    v_mul_f32 v38, v125, v38
    v_mul_f32 v39, v125, v39
    v_cvt_pk_bf16_f32 v138, v36, v37
    v_cvt_pk_bf16_f32 v139, v38, v39
    v_sub_f32 v244, 0, v126
    v_fmac_f32 v0, v244, v156
    v_fmac_f32 v1, v244, v157
    v_fmac_f32 v2, v244, v158
    v_fmac_f32 v3, v244, v159
    v_mul_f32 v0, v127, v0
    v_mul_f32 v1, v127, v1
    v_mul_f32 v2, v127, v2
    v_mul_f32 v3, v127, v3
    v_cvt_pk_bf16_f32 v212, v0, v1
    v_cvt_pk_bf16_f32 v213, v2, v3
    v_fmac_f32 v4, v244, v160
    v_fmac_f32 v5, v244, v161
    v_fmac_f32 v6, v244, v162
    v_fmac_f32 v7, v244, v163
    v_mul_f32 v4, v127, v4
    v_mul_f32 v5, v127, v5
    v_mul_f32 v6, v127, v6
    v_mul_f32 v7, v127, v7
    v_cvt_pk_bf16_f32 v214, v4, v5
    v_cvt_pk_bf16_f32 v215, v6, v7
    v_fmac_f32 v40, v244, v164
    v_fmac_f32 v41, v244, v165
    v_fmac_f32 v42, v244, v166
    v_fmac_f32 v43, v244, v167
    v_mul_f32 v40, v127, v40
    v_mul_f32 v41, v127, v41
    v_mul_f32 v42, v127, v42
    v_mul_f32 v43, v127, v43
    v_cvt_pk_bf16_f32 v140, v40, v41
    v_cvt_pk_bf16_f32 v141, v42, v43
    v_fmac_f32 v44, v244, v168
    v_fmac_f32 v45, v244, v169
    v_fmac_f32 v46, v244, v170
    v_fmac_f32 v47, v244, v171
    v_mul_f32 v44, v127, v44
    v_mul_f32 v45, v127, v45
    v_mul_f32 v46, v127, v46
    v_mul_f32 v47, v127, v47
    v_cvt_pk_bf16_f32 v142, v44, v45
    v_cvt_pk_bf16_f32 v143, v46, v47
    v_sub_f32 v244, 0, v128
    v_fmac_f32 v8, v244, v156
    v_fmac_f32 v9, v244, v157
    v_fmac_f32 v10, v244, v158
    v_fmac_f32 v11, v244, v159
    v_mul_f32 v8, v129, v8
    v_mul_f32 v9, v129, v9
    v_mul_f32 v10, v129, v10
    v_mul_f32 v11, v129, v11
    v_cvt_pk_bf16_f32 v216, v8, v9
    v_cvt_pk_bf16_f32 v217, v10, v11
    v_fmac_f32 v12, v244, v160
    v_fmac_f32 v13, v244, v161
    v_fmac_f32 v14, v244, v162
    v_fmac_f32 v15, v244, v163
    v_mul_f32 v12, v129, v12
    v_mul_f32 v13, v129, v13
    v_mul_f32 v14, v129, v14
    v_mul_f32 v15, v129, v15
    v_cvt_pk_bf16_f32 v218, v12, v13
    v_cvt_pk_bf16_f32 v219, v14, v15
    v_fmac_f32 v48, v244, v164
    v_fmac_f32 v49, v244, v165
    v_fmac_f32 v50, v244, v166
    v_fmac_f32 v51, v244, v167
    v_mul_f32 v48, v129, v48
    v_mul_f32 v49, v129, v49
    v_mul_f32 v50, v129, v50
    v_mul_f32 v51, v129, v51
    v_cvt_pk_bf16_f32 v144, v48, v49
    v_cvt_pk_bf16_f32 v145, v50, v51
    v_fmac_f32 v52, v244, v168
    v_fmac_f32 v53, v244, v169
    v_fmac_f32 v54, v244, v170
    v_fmac_f32 v55, v244, v171
    v_mul_f32 v52, v129, v52
    v_mul_f32 v53, v129, v53
    v_mul_f32 v54, v129, v54
    v_mul_f32 v55, v129, v55
    v_cvt_pk_bf16_f32 v146, v52, v53
    v_cvt_pk_bf16_f32 v147, v54, v55
    v_sub_f32 v244, 0, v130
    v_fmac_f32 v16, v244, v156
    v_fmac_f32 v17, v244, v157
    v_fmac_f32 v18, v244, v158
    v_fmac_f32 v19, v244, v159
    v_mul_f32 v16, v131, v16
    v_mul_f32 v17, v131, v17
    v_mul_f32 v18, v131, v18
    v_mul_f32 v19, v131, v19
    v_cvt_pk_bf16_f32 v220, v16, v17
    v_cvt_pk_bf16_f32 v221, v18, v19
    v_fmac_f32 v20, v244, v160
    v_fmac_f32 v21, v244, v161
    v_fmac_f32 v22, v244, v162
    v_fmac_f32 v23, v244, v163
    v_mul_f32 v20, v131, v20
    v_mul_f32 v21, v131, v21
    v_mul_f32 v22, v131, v22
    v_mul_f32 v23, v131, v23
    v_cvt_pk_bf16_f32 v222, v20, v21
    v_cvt_pk_bf16_f32 v223, v22, v23
    v_fmac_f32 v56, v244, v164
    v_fmac_f32 v57, v244, v165
    v_fmac_f32 v58, v244, v166
    v_fmac_f32 v59, v244, v167
    v_mul_f32 v56, v131, v56
    v_mul_f32 v57, v131, v57
    v_mul_f32 v58, v131, v58
    v_mul_f32 v59, v131, v59
    v_cvt_pk_bf16_f32 v148, v56, v57
    v_cvt_pk_bf16_f32 v149, v58, v59
    v_fmac_f32 v60, v244, v168
    v_fmac_f32 v61, v244, v169
    v_fmac_f32 v62, v244, v170
    v_fmac_f32 v63, v244, v171
    v_mul_f32 v60, v131, v60
    v_mul_f32 v61, v131, v61
    v_mul_f32 v62, v131, v62
    v_mul_f32 v63, v131, v63
    v_cvt_pk_bf16_f32 v150, v60, v61
    v_cvt_pk_bf16_f32 v151, v62, v63
    v_sub_f32 v244, 0, v132
    v_fmac_f32 v24, v244, v156
    v_fmac_f32 v25, v244, v157
    v_fmac_f32 v26, v244, v158
    v_fmac_f32 v27, v244, v159
    v_mul_f32 v24, v133, v24
    v_mul_f32 v25, v133, v25
    v_mul_f32 v26, v133, v26
    v_mul_f32 v27, v133, v27
    v_cvt_pk_bf16_f32 v224, v24, v25
    v_cvt_pk_bf16_f32 v225, v26, v27
    v_fmac_f32 v28, v244, v160
    v_fmac_f32 v29, v244, v161
    v_fmac_f32 v30, v244, v162
    v_fmac_f32 v31, v244, v163
    v_mul_f32 v28, v133, v28
    v_mul_f32 v29, v133, v29
    v_mul_f32 v30, v133, v30
    v_mul_f32 v31, v133, v31
    v_cvt_pk_bf16_f32 v226, v28, v29
    v_cvt_pk_bf16_f32 v227, v30, v31
    v_fmac_f32 v64, v244, v164
    v_fmac_f32 v65, v244, v165
    v_fmac_f32 v66, v244, v166
    v_fmac_f32 v67, v244, v167
    v_mul_f32 v64, v133, v64
    v_mul_f32 v65, v133, v65
    v_mul_f32 v66, v133, v66
    v_mul_f32 v67, v133, v67
    v_cvt_pk_bf16_f32 v152, v64, v65
    v_cvt_pk_bf16_f32 v153, v66, v67
    v_fmac_f32 v68, v244, v168
    v_fmac_f32 v69, v244, v169
    v_fmac_f32 v70, v244, v170
    v_fmac_f32 v71, v244, v171
    v_mul_f32 v68, v133, v68
    v_mul_f32 v69, v133, v69
    v_mul_f32 v70, v133, v70
    v_mul_f32 v71, v133, v71
    v_cvt_pk_bf16_f32 v154, v68, v69
    v_cvt_pk_bf16_f32 v155, v70, v71
    v_fma_f32 v72, -v228, v172, v72
    v_fma_f32 v73, -v230, v172, v73
    v_fma_f32 v74, -v232, v172, v74
    v_fma_f32 v75, -v234, v172, v75
    v_mul_f32 v72, v229, v72
    v_mul_f32 v73, v231, v73
    v_mul_f32 v74, v233, v74
    v_mul_f32 v75, v235, v75
    v_cvt_pk_bf16_f32 v180, v72, v73
    v_cvt_pk_bf16_f32 v181, v74, v75
    v_fma_f32 v76, -v228, v173, v76
    v_fma_f32 v77, -v230, v173, v77
    v_fma_f32 v78, -v232, v173, v78
    v_fma_f32 v79, -v234, v173, v79
    v_mul_f32 v76, v229, v76
    v_mul_f32 v77, v231, v77
    v_mul_f32 v78, v233, v78
    v_mul_f32 v79, v235, v79
    v_cvt_pk_bf16_f32 v190, v76, v77
    v_cvt_pk_bf16_f32 v191, v78, v79
    ds_read_b128 v[228:231], v254 offset:256
    ds_read_b128 v[232:235], v254 offset:272
    v_fma_f32 v80, -v236, v172, v80
    v_fma_f32 v81, -v238, v172, v81
    v_fma_f32 v82, -v240, v172, v82
    v_fma_f32 v83, -v242, v172, v83
    v_mul_f32 v80, v237, v80
    v_mul_f32 v81, v239, v81
    v_mul_f32 v82, v241, v82
    v_mul_f32 v83, v243, v83
    v_cvt_pk_bf16_f32 v182, v80, v81
    v_cvt_pk_bf16_f32 v183, v82, v83
    v_fma_f32 v84, -v236, v173, v84
    v_fma_f32 v85, -v238, v173, v85
    v_fma_f32 v86, -v240, v173, v86
    v_fma_f32 v87, -v242, v173, v87
    v_mul_f32 v84, v237, v84
    v_mul_f32 v85, v239, v85
    v_mul_f32 v86, v241, v86
    v_mul_f32 v87, v243, v87
    v_cvt_pk_bf16_f32 v192, v84, v85
    v_cvt_pk_bf16_f32 v193, v86, v87
    ds_read_b128 v[236:239], v254 offset:384
    ds_read_b128 v[240:243], v254 offset:400
    s_waitcnt lgkmcnt(2)
    v_fma_f32 v88, -v228, v172, v88
    v_fma_f32 v89, -v230, v172, v89
    v_fma_f32 v90, -v232, v172, v90
    v_fma_f32 v91, -v234, v172, v91
    v_mul_f32 v88, v229, v88
    v_mul_f32 v89, v231, v89
    v_mul_f32 v90, v233, v90
    v_mul_f32 v91, v235, v91
    v_cvt_pk_bf16_f32 v184, v88, v89
    v_cvt_pk_bf16_f32 v185, v90, v91
    v_fma_f32 v92, -v228, v173, v92
    v_fma_f32 v93, -v230, v173, v93
    v_fma_f32 v94, -v232, v173, v94
    v_fma_f32 v95, -v234, v173, v95
    v_mul_f32 v92, v229, v92
    v_mul_f32 v93, v231, v93
    v_mul_f32 v94, v233, v94
    v_mul_f32 v95, v235, v95
    v_cvt_pk_bf16_f32 v194, v92, v93
    v_cvt_pk_bf16_f32 v195, v94, v95
    ds_read_b128 v[228:231], v254 offset:512
    ds_read_b128 v[232:235], v254 offset:528
    s_waitcnt lgkmcnt(2)
    v_fma_f32 v96, -v236, v172, v96
    v_fma_f32 v97, -v238, v172, v97
    v_fma_f32 v98, -v240, v172, v98
    v_fma_f32 v99, -v242, v172, v99
    v_mul_f32 v96, v237, v96
    v_mul_f32 v97, v239, v97
    v_mul_f32 v98, v241, v98
    v_mul_f32 v99, v243, v99
    v_cvt_pk_bf16_f32 v186, v96, v97
    v_cvt_pk_bf16_f32 v187, v98, v99
    v_fma_f32 v100, -v236, v173, v100
    v_fma_f32 v101, -v238, v173, v101
    v_fma_f32 v102, -v240, v173, v102
    v_fma_f32 v103, -v242, v173, v103
    v_mul_f32 v100, v237, v100
    v_mul_f32 v101, v239, v101
    v_mul_f32 v102, v241, v102
    v_mul_f32 v103, v243, v103
    v_cvt_pk_bf16_f32 v196, v100, v101
    v_cvt_pk_bf16_f32 v197, v102, v103
    s_waitcnt lgkmcnt(0)
    v_fma_f32 v104, -v228, v172, v104
    v_fma_f32 v105, -v230, v172, v105
    v_fma_f32 v106, -v232, v172, v106
    v_fma_f32 v107, -v234, v172, v107
    v_mul_f32 v104, v229, v104
    v_mul_f32 v105, v231, v105
    v_mul_f32 v106, v233, v106
    v_mul_f32 v107, v235, v107
    v_cvt_pk_bf16_f32 v188, v104, v105
    v_cvt_pk_bf16_f32 v189, v106, v107
    v_fma_f32 v108, -v228, v173, v108
    v_fma_f32 v109, -v230, v173, v109
    v_fma_f32 v110, -v232, v173, v110
    v_fma_f32 v111, -v234, v173, v111
    v_mul_f32 v108, v229, v108
    v_mul_f32 v109, v231, v109
    v_mul_f32 v110, v233, v110
    v_mul_f32 v111, v235, v111
    v_cvt_pk_bf16_f32 v198, v108, v109
    v_cvt_pk_bf16_f32 v199, v110, v111
    v_mov_b32 v104, s24
    s_nop 1
    v_mfma_f32_16x16x32_bf16 v[0:3], v[140:143], v[212:215], 0
    v_mfma_f32_16x16x32_bf16 v[4:7], v[136:139], v[212:215], 0
    v_mfma_f32_16x16x32_bf16 v[8:11], v[144:147], v[216:219], 0
    v_mfma_f32_16x16x32_bf16 v[12:15], v[140:143], v[216:219], 0
    v_mfma_f32_16x16x32_bf16 v[16:19], v[148:151], v[220:223], 0
    v_mfma_f32_16x16x32_bf16 v[20:23], v[144:147], v[220:223], 0
    v_mfma_f32_16x16x32_bf16 v[24:27], v[152:155], v[224:227], 0
    v_mfma_f32_16x16x32_bf16 v[28:31], v[148:151], v[224:227], 0
    s_nop 1
    v_mul_f32 v0, s23, v0
    v_mul_f32 v1, s23, v1
    v_mul_f32 v2, s23, v2
    v_mul_f32 v3, s23, v3
    v_mul_f32 v4, s23, v4
    v_mul_f32 v5, s23, v5
    v_mul_f32 v6, s23, v6
    v_mul_f32 v7, s23, v7
    v_mul_f32 v8, s23, v8
    v_mul_f32 v9, s23, v9
    v_mul_f32 v10, s23, v10
    v_mul_f32 v11, s23, v11
    v_mul_f32 v12, s23, v12
    v_mul_f32 v13, s23, v13
    v_mul_f32 v14, s23, v14
    v_mul_f32 v15, s23, v15
    v_mul_f32 v16, s23, v16
    v_mul_f32 v17, s23, v17
    v_mul_f32 v18, s23, v18
    v_mul_f32 v19, s23, v19
    v_mul_f32 v20, s23, v20
    v_mul_f32 v21, s23, v21
    v_mul_f32 v22, s23, v22
    v_mul_f32 v23, s23, v23
    v_mul_f32 v24, s23, v24
    v_mul_f32 v25, s23, v25
    v_mul_f32 v26, s23, v26
    v_mul_f32 v27, s23, v27
    v_mul_f32 v28, s23, v28
    v_mul_f32 v29, s23, v29
    v_mul_f32 v30, s23, v30
    v_mul_f32 v31, s23, v31
    v_cndmask_b32 v0, v104, v0, s[28:29]
    v_cndmask_b32 v4, v104, v4, s[44:45]
    v_cndmask_b32 v1, v104, v1, s[30:31]
    v_cndmask_b32 v5, v104, v5, s[46:47]
    v_cndmask_b32 v2, v104, v2, s[32:33]
    v_cndmask_b32 v6, v104, v6, s[48:49]
    v_cndmask_b32 v3, v104, v3, s[34:35]
    v_cndmask_b32 v7, v104, v7, s[50:51]
    v_cndmask_b32 v8, v104, v8, s[28:29]
    v_cndmask_b32 v12, v104, v12, s[36:37]
    v_cndmask_b32 v9, v104, v9, s[30:31]
    v_cndmask_b32 v13, v104, v13, s[38:39]
    v_cndmask_b32 v10, v104, v10, s[32:33]
    v_cndmask_b32 v14, v104, v14, s[40:41]
    v_cndmask_b32 v11, v104, v11, s[34:35]
    v_cndmask_b32 v15, v104, v15, s[42:43]
    v_cndmask_b32 v16, v104, v16, s[28:29]
    v_cndmask_b32 v20, v104, v20, s[36:37]
    v_cndmask_b32 v17, v104, v17, s[30:31]
    v_cndmask_b32 v21, v104, v21, s[38:39]
    v_cndmask_b32 v18, v104, v18, s[32:33]
    v_cndmask_b32 v22, v104, v22, s[40:41]
    v_cndmask_b32 v19, v104, v19, s[34:35]
    v_cndmask_b32 v23, v104, v23, s[42:43]
    v_cndmask_b32 v24, v104, v24, s[28:29]
    v_cndmask_b32 v28, v104, v28, s[36:37]
    v_cndmask_b32 v25, v104, v25, s[30:31]
    v_cndmask_b32 v29, v104, v29, s[38:39]
    v_cndmask_b32 v26, v104, v26, s[32:33]
    v_cndmask_b32 v30, v104, v30, s[40:41]
    v_cndmask_b32 v27, v104, v27, s[34:35]
    v_cndmask_b32 v31, v104, v31, s[42:43]
    v_max3_f32 v96, v0, v1, v2
    v_max3_f32 v100, v3, v4, v5
    v_max3_f32 v96, v96, v6, v7
    v_max_f32 v96, v96, v100
    v_max3_f32 v97, v8, v9, v10
    v_max3_f32 v101, v11, v12, v13
    v_max3_f32 v97, v97, v14, v15
    v_max_f32 v97, v97, v101
    v_max3_f32 v98, v16, v17, v18
    v_max3_f32 v102, v19, v20, v21
    v_max3_f32 v98, v98, v22, v23
    v_max_f32 v98, v98, v102
    v_max3_f32 v99, v24, v25, v26
    v_max3_f32 v103, v27, v28, v29
    v_max3_f32 v99, v99, v30, v31
    v_max_f32 v99, v99, v103
    v_mov_b32 v100, v96
    v_mov_b32 v101, v97
    v_mov_b32 v102, v98
    v_mov_b32 v103, v99
    s_nop 1
    v_permlane16_swap_b32 v96, v100
    v_permlane16_swap_b32 v97, v101
    v_permlane16_swap_b32 v98, v102
    v_permlane16_swap_b32 v99, v103
    v_max_f32 v96, v96, v100
    v_max_f32 v97, v97, v101
    v_max_f32 v98, v98, v102
    v_max_f32 v99, v99, v103
    v_mov_b32 v100, v96
    v_mov_b32 v101, v97
    v_mov_b32 v102, v98
    v_mov_b32 v103, v99
    s_nop 1
    v_permlane32_swap_b32 v96, v100
    v_permlane32_swap_b32 v97, v101
    v_permlane32_swap_b32 v98, v102
    v_permlane32_swap_b32 v99, v103
    v_max_f32 v96, v96, v100
    v_max_f32 v97, v97, v101
    v_max_f32 v98, v98, v102
    v_max_f32 v99, v99, v103
    v_sub_f32 v0, v0, v96
    v_sub_f32 v1, v1, v96
    v_sub_f32 v2, v2, v96
    v_sub_f32 v3, v3, v96
    v_sub_f32 v4, v4, v96
    v_sub_f32 v5, v5, v96
    v_sub_f32 v6, v6, v96
    v_sub_f32 v7, v7, v96
    v_sub_f32 v8, v8, v97
    v_sub_f32 v9, v9, v97
    v_sub_f32 v10, v10, v97
    v_sub_f32 v11, v11, v97
    v_sub_f32 v12, v12, v97
    v_sub_f32 v13, v13, v97
    v_sub_f32 v14, v14, v97
    v_sub_f32 v15, v15, v97
    v_sub_f32 v16, v16, v98
    v_sub_f32 v17, v17, v98
    v_sub_f32 v18, v18, v98
    v_sub_f32 v19, v19, v98
    v_sub_f32 v20, v20, v98
    v_sub_f32 v21, v21, v98
    v_sub_f32 v22, v22, v98
    v_sub_f32 v23, v23, v98
    v_sub_f32 v24, v24, v99
    v_sub_f32 v25, v25, v99
    v_sub_f32 v26, v26, v99
    v_sub_f32 v27, v27, v99
    v_sub_f32 v28, v28, v99
    v_sub_f32 v29, v29, v99
    v_sub_f32 v30, v30, v99
    v_sub_f32 v31, v31, v99
    v_exp_f32 v0, v0
    v_exp_f32 v1, v1
    v_exp_f32 v2, v2
    v_exp_f32 v3, v3
    v_exp_f32 v4, v4
    v_exp_f32 v5, v5
    v_exp_f32 v6, v6
    v_exp_f32 v7, v7
    v_exp_f32 v8, v8
    v_exp_f32 v9, v9
    v_exp_f32 v10, v10
    v_exp_f32 v11, v11
    v_exp_f32 v12, v12
    v_exp_f32 v13, v13
    v_exp_f32 v14, v14
    v_exp_f32 v15, v15
    v_exp_f32 v16, v16
    v_exp_f32 v17, v17
    v_exp_f32 v18, v18
    v_exp_f32 v19, v19
    v_exp_f32 v20, v20
    v_exp_f32 v21, v21
    v_exp_f32 v22, v22
    v_exp_f32 v23, v23
    v_exp_f32 v24, v24
    v_exp_f32 v25, v25
    v_exp_f32 v26, v26
    v_exp_f32 v27, v27
    v_exp_f32 v28, v28
    v_exp_f32 v29, v29
    v_exp_f32 v30, v30
    v_exp_f32 v31, v31
    s_nop 0
    v_add_f32 v96, v0, v1
    v_add_f32 v96, v96, v2
    v_add_f32 v96, v96, v3
    v_add_f32 v96, v96, v4
    v_add_f32 v96, v96, v5
    v_add_f32 v96, v96, v6
    v_add_f32 v96, v96, v7
    v_add_f32 v97, v8, v9
    v_add_f32 v97, v97, v10
    v_add_f32 v97, v97, v11
    v_add_f32 v97, v97, v12
    v_add_f32 v97, v97, v13
    v_add_f32 v97, v97, v14
    v_add_f32 v97, v97, v15
    v_add_f32 v98, v16, v17
    v_add_f32 v98, v98, v18
    v_add_f32 v98, v98, v19
    v_add_f32 v98, v98, v20
    v_add_f32 v98, v98, v21
    v_add_f32 v98, v98, v22
    v_add_f32 v98, v98, v23
    v_add_f32 v99, v24, v25
    v_add_f32 v99, v99, v26
    v_add_f32 v99, v99, v27
    v_add_f32 v99, v99, v28
    v_add_f32 v99, v99, v29
    v_add_f32 v99, v99, v30
    v_add_f32 v99, v99, v31
    v_mov_b32 v100, v96
    v_mov_b32 v101, v97
    v_mov_b32 v102, v98
    v_mov_b32 v103, v99
    s_nop 1
    v_permlane16_swap_b32 v96, v100
    v_permlane16_swap_b32 v97, v101
    v_permlane16_swap_b32 v98, v102
    v_permlane16_swap_b32 v99, v103
    v_add_f32 v96, v96, v100
    v_add_f32 v97, v97, v101
    v_add_f32 v98, v98, v102
    v_add_f32 v99, v99, v103
    v_mov_b32 v100, v96
    v_mov_b32 v101, v97
    v_mov_b32 v102, v98
    v_mov_b32 v103, v99
    s_nop 1
    v_permlane32_swap_b32 v96, v100
    v_permlane32_swap_b32 v97, v101
    v_permlane32_swap_b32 v98, v102
    v_permlane32_swap_b32 v99, v103
    v_add_f32 v96, v96, v100
    v_add_f32 v97, v97, v101
    v_add_f32 v98, v98, v102
    v_add_f32 v99, v99, v103
    v_rcp_f32 v96, v96
    v_rcp_f32 v97, v97
    v_rcp_f32 v98, v98
    v_rcp_f32 v99, v99
    s_nop 0
    v_mul_f32 v0, v0, v96
    v_mul_f32 v1, v1, v96
    v_mul_f32 v2, v2, v96
    v_mul_f32 v3, v3, v96
    v_mul_f32 v4, v4, v96
    v_mul_f32 v5, v5, v96
    v_mul_f32 v6, v6, v96
    v_mul_f32 v7, v7, v96
    v_cvt_pk_bf16_f32 v32, v4, v5
    v_cvt_pk_bf16_f32 v33, v6, v7
    v_cvt_pk_bf16_f32 v34, v0, v1
    v_cvt_pk_bf16_f32 v35, v2, v3
    v_mul_f32 v8, v8, v97
    v_mul_f32 v9, v9, v97
    v_mul_f32 v10, v10, v97
    v_mul_f32 v11, v11, v97
    v_mul_f32 v12, v12, v97
    v_mul_f32 v13, v13, v97
    v_mul_f32 v14, v14, v97
    v_mul_f32 v15, v15, v97
    v_cvt_pk_bf16_f32 v36, v12, v13
    v_cvt_pk_bf16_f32 v37, v14, v15
    v_cvt_pk_bf16_f32 v38, v8, v9
    v_cvt_pk_bf16_f32 v39, v10, v11
    v_mul_f32 v16, v16, v98
    v_mul_f32 v17, v17, v98
    v_mul_f32 v18, v18, v98
    v_mul_f32 v19, v19, v98
    v_mul_f32 v20, v20, v98
    v_mul_f32 v21, v21, v98
    v_mul_f32 v22, v22, v98
    v_mul_f32 v23, v23, v98
    v_cvt_pk_bf16_f32 v40, v20, v21
    v_cvt_pk_bf16_f32 v41, v22, v23
    v_cvt_pk_bf16_f32 v42, v16, v17
    v_cvt_pk_bf16_f32 v43, v18, v19
    v_mul_f32 v24, v24, v99
    v_mul_f32 v25, v25, v99
    v_mul_f32 v26, v26, v99
    v_mul_f32 v27, v27, v99
    v_mul_f32 v28, v28, v99
    v_mul_f32 v29, v29, v99
    v_mul_f32 v30, v30, v99
    v_mul_f32 v31, v31, v99
    v_cvt_pk_bf16_f32 v44, v28, v29
    v_cvt_pk_bf16_f32 v45, v30, v31
    v_cvt_pk_bf16_f32 v46, v24, v25
    v_cvt_pk_bf16_f32 v47, v26, v27
    s_nop 1
    v_mfma_f32_16x16x32_bf16 v[48:51], v[180:183], v[32:35], 0
    v_mfma_f32_16x16x32_bf16 v[52:55], v[190:193], v[32:35], 0
    v_mfma_f32_16x16x32_bf16 v[56:59], v[182:185], v[36:39], 0
    v_mfma_f32_16x16x32_bf16 v[60:63], v[192:195], v[36:39], 0
    v_mfma_f32_16x16x32_bf16 v[64:67], v[184:187], v[40:43], 0
    v_mfma_f32_16x16x32_bf16 v[68:71], v[194:197], v[40:43], 0
    v_mfma_f32_16x16x32_bf16 v[72:75], v[186:189], v[44:47], 0
    v_mfma_f32_16x16x32_bf16 v[76:79], v[196:199], v[44:47], 0
    s_nop 1
    v_cvt_pk_bf16_f32 v80, v48, v49
    v_cvt_pk_bf16_f32 v81, v50, v51
    v_cvt_pk_bf16_f32 v82, v52, v53
    v_cvt_pk_bf16_f32 v83, v54, v55
    buffer_store_dwordx4 v[80:83], v249, s[80:83], s21 offen offset:0
    v_cvt_pk_bf16_f32 v84, v56, v57
    v_cvt_pk_bf16_f32 v85, v58, v59
    v_cvt_pk_bf16_f32 v86, v60, v61
    v_cvt_pk_bf16_f32 v87, v62, v63
    buffer_store_dwordx4 v[84:87], v249, s[80:83], s21 offen offset:1024
    v_cvt_pk_bf16_f32 v88, v64, v65
    v_cvt_pk_bf16_f32 v89, v66, v67
    v_cvt_pk_bf16_f32 v90, v68, v69
    v_cvt_pk_bf16_f32 v91, v70, v71
    buffer_store_dwordx4 v[88:91], v249, s[80:83], s21 offen offset:2048
    s_nop 0
    v_cvt_pk_bf16_f32 v92, v72, v73
    v_cvt_pk_bf16_f32 v93, v74, v75
    v_cvt_pk_bf16_f32 v94, v76, v77
    v_cvt_pk_bf16_f32 v95, v78, v79
    buffer_store_dwordx4 v[92:95], v249, s[80:83], s21 offen offset:3072
    s_lshl_b32 s64, s75, 15
    s_lshl_b32 s66, s73, 9
    s_add_u32 s64, s64, s66
    s_add_u32 s64, s64, 75497472
    s_lshl_b32 s65, s72, 5
    s_add_u32 s64, s64, s65
    s_lshl_b32 s65, s3, 2
    s_add_u32 s64, s64, s65
    v_mov_b32 v108, 0
    v_mov_b32 v109, 1
    s_cmp_lg_u32 s78, 0
    s_cbranch_scc1 sg_5_slow
    s_waitcnt vmcnt(0)
    s_mov_b64 exec, 1
    buffer_store_dword v109, v108, s[80:83], s64 offen
    s_mov_b64 exec, -1
sg_5_done:
    s_lshr_b32 s64, s3, 1
    s_lshl_b32 s64, s64, 12
    v_add_u32 v240, s64, v249
    v_lshrrev_b32 v253, 2, v252
    v_mul_u32_u24 v253, 1056, v253
    v_lshl_add_u32 v253, v251, 7, v253
    v_and_b32 v254, 3, v252
    v_lshl_add_u32 v253, v254, 3, v253
    s_and_b32 s64, s3, 1
    s_lshl_b32 s64, s64, 6
    s_add_u32 s64, s64, 65536
    v_add_u32 v241, s64, v253
    s_mov_b32 s16, 50688
    v_add_u32 v242, s16, v241
    s_and_b32 s64, s3, 1
    s_lshl_b32 s64, s64, 13
    s_lshr_b32 s65, s3, 1
    s_lshl_b32 s65, s65, 12
    s_add_u32 s17, s64, s65
    s_lshl_b32 s19, s73, 4
    s_add_u32 s19, s19, s72
    s_lshl_b32 s19, s19, 14
    s_mul_i32 s66, s60, 8388608
    s_add_u32 s19, s19, s66
    s_add_u32 s19, s19, s17
    s_cmp_lg_u32 s75, 0
    s_cbranch_scc1 xo_6_f
    s_mov_b32 s8, s84
    s_mov_b32 s9, s85
    s_mov_b32 s10, 4194304
    s_mov_b32 s11, 0x00020000
    s_lshl_b32 s64, s73, 1
    s_lshr_b32 s65, s3, 1
    s_add_u32 s64, s64, s65
    s_lshl_b32 s64, s64, 17
    s_lshl_b32 s65, s72, 7
    s_add_u32 s64, s64, s65
    s_and_b32 s65, s3, 1
    s_lshl_b32 s65, s65, 6
    s_add_u32 s64, s64, s65
    v_lshlrev_b32 v243, 11, v252
    v_add_u32 v243, s64, v243
    v_lshl_add_u32 v243, v251, 3, v243
    s_mov_b32 s64, 0
    buffer_load_dwordx2 v[128:129], v243, s[8:11], s64 offen
    buffer_load_dwordx2 v[130:131], v243, s[8:11], s64 offen offset:32
    s_mov_b32 s64, 32768
    buffer_load_dwordx2 v[132:133], v243, s[8:11], s64 offen
    buffer_load_dwordx2 v[134:135], v243, s[8:11], s64 offen offset:32
    s_mov_b32 s64, 65536
    buffer_load_dwordx2 v[136:137], v243, s[8:11], s64 offen
    buffer_load_dwordx2 v[138:139], v243, s[8:11], s64 offen offset:32
    s_mov_b32 s64, 98304
    buffer_load_dwordx2 v[140:141], v243, s[8:11], s64 offen
    buffer_load_dwordx2 v[142:143], v243, s[8:11], s64 offen offset:32
    s_branch xo_6_d
xo_6_f:
    s_lshl_b32 s18, s73, 4
    s_add_u32 s18, s18, s72
    s_lshl_b32 s18, s18, 14
    s_mul_i32 s66, s59, 4194304
    s_add_u32 s18, s18, s66
    s_add_u32 s18, s18, s17
    buffer_load_dwordx4 v[128:131], v249, s[80:83], s18 offen offset:0 sc1
    buffer_load_dwordx4 v[132:135], v249, s[80:83], s18 offen offset:1024 sc1
    buffer_load_dwordx4 v[136:139], v249, s[80:83], s18 offen offset:2048 sc1
    buffer_load_dwordx4 v[140:143], v249, s[80:83], s18 offen offset:3072 sc1
xo_6_d:
    v_mov_b32 v208, 0
    v_mov_b32 v209, 0
    v_mov_b32 v210, 0
    v_mov_b32 v211, 0
    s_nop 1
    v_mfma_f32_32x32x16_bf16 v[0:15], v[208:211], v[208:211], 0
    v_mfma_f32_32x32x16_bf16 v[16:31], v[208:211], v[208:211], 0
    s_mov_b32 s17, 8
    s_mov_b64 vcc, 0
    s_barrier
    ds_read_b128 v[32:35], v240 offset:0
    ds_read_b64_tr_b16 v[48:49], v242 offset:0
    ds_read_b64_tr_b16 v[50:51], v242 offset:512
    ds_read_b128 v[36:39], v240 offset:1024
    ds_read_b64_tr_b16 v[52:53], v242 offset:32
    ds_read_b64_tr_b16 v[54:55], v242 offset:544
    ds_read_b128 v[40:43], v240 offset:2048
    ds_read_b128 v[44:47], v240 offset:3072
    ds_read_b128 v[56:59], v240 offset:8192
    ds_read_b64_tr_b16 v[72:73], v242 offset:4224
    ds_read_b64_tr_b16 v[74:75], v242 offset:4736
    ds_read_b128 v[60:63], v240 offset:9216
    ds_read_b64_tr_b16 v[76:77], v242 offset:4256
    ds_read_b64_tr_b16 v[78:79], v242 offset:4768
    ds_read_b128 v[64:67], v240 offset:10240
    ds_read_b128 v[68:71], v240 offset:11264
    v_add_u16 v240, 0x4000, v240
    s_add_u32 s16, s16, 8448
    s_cmp_eq_u32 s16, 92928
    s_cselect_b32 s16, 0, s16
    v_add_u32 v242, s16, v241
    s_waitcnt lgkmcnt(0)
r1_loop:
    s_cbranch_vccnz r1_nb0
    s_barrier
r1_nb0:
    v_mfma_f32_16x16x32_bf16 v[0:3], v[48:51], v[32:35], v[0:3]
    ds_read_b128 v[80:83], v240 offset:0
    ds_read_b64_tr_b16 v[96:97], v242 offset:0
    v_mfma_f32_16x16x32_bf16 v[4:7], v[48:51], v[36:39], v[4:7]
    ds_read_b64_tr_b16 v[98:99], v242 offset:512
    v_mfma_f32_16x16x32_bf16 v[8:11], v[48:51], v[40:43], v[8:11]
    ds_read_b128 v[84:87], v240 offset:1024
    ds_read_b64_tr_b16 v[100:101], v242 offset:32
    v_mfma_f32_16x16x32_bf16 v[12:15], v[48:51], v[44:47], v[12:15]
    ds_read_b64_tr_b16 v[102:103], v242 offset:544
    v_mfma_f32_16x16x32_bf16 v[16:19], v[52:55], v[32:35], v[16:19]
    ds_read_b128 v[88:91], v240 offset:2048
    ds_read_b128 v[92:95], v240 offset:3072
    v_mfma_f32_16x16x32_bf16 v[20:23], v[52:55], v[36:39], v[20:23]
    ds_read_b128 v[104:107], v240 offset:8192
    v_mfma_f32_16x16x32_bf16 v[24:27], v[52:55], v[40:43], v[24:27]
    ds_read_b64_tr_b16 v[120:121], v242 offset:4224
    ds_read_b64_tr_b16 v[122:123], v242 offset:4736
    v_mfma_f32_16x16x32_bf16 v[28:31], v[52:55], v[44:47], v[28:31]
    ds_read_b128 v[108:111], v240 offset:9216
    v_mfma_f32_16x16x32_bf16 v[0:3], v[72:75], v[56:59], v[0:3]
    ds_read_b64_tr_b16 v[124:125], v242 offset:4256
    ds_read_b64_tr_b16 v[126:127], v242 offset:4768
    v_mfma_f32_16x16x32_bf16 v[4:7], v[72:75], v[60:63], v[4:7]
    ds_read_b128 v[112:115], v240 offset:10240
    v_mfma_f32_16x16x32_bf16 v[8:11], v[72:75], v[64:67], v[8:11]
    ds_read_b128 v[116:119], v240 offset:11264
    v_mfma_f32_16x16x32_bf16 v[12:15], v[72:75], v[68:71], v[12:15]
    v_add_u16 v240, 0x4000, v240
    v_mfma_f32_16x16x32_bf16 v[16:19], v[76:79], v[56:59], v[16:19]
    s_add_u32 s16, s16, 8448
    s_cmp_eq_u32 s16, 92928
    v_mfma_f32_16x16x32_bf16 v[20:23], v[76:79], v[60:63], v[20:23]
    s_cselect_b32 s16, 0, s16
    v_mfma_f32_16x16x32_bf16 v[24:27], v[76:79], v[64:67], v[24:27]
    v_add_u32 v242, s16, v241
    v_mfma_f32_16x16x32_bf16 v[28:31], v[76:79], v[68:71], v[28:31]
    s_waitcnt lgkmcnt(0)
    s_cbranch_vccnz r1_nb1
    s_barrier
r1_nb1:
    v_mfma_f32_16x16x32_bf16 v[0:3], v[96:99], v[80:83], v[0:3]
    ds_read_b128 v[32:35], v240 offset:0
    ds_read_b64_tr_b16 v[48:49], v242 offset:0
    v_mfma_f32_16x16x32_bf16 v[4:7], v[96:99], v[84:87], v[4:7]
    ds_read_b64_tr_b16 v[50:51], v242 offset:512
    v_mfma_f32_16x16x32_bf16 v[8:11], v[96:99], v[88:91], v[8:11]
    ds_read_b128 v[36:39], v240 offset:1024
    ds_read_b64_tr_b16 v[52:53], v242 offset:32
    v_mfma_f32_16x16x32_bf16 v[12:15], v[96:99], v[92:95], v[12:15]
    ds_read_b64_tr_b16 v[54:55], v242 offset:544
    v_mfma_f32_16x16x32_bf16 v[16:19], v[100:103], v[80:83], v[16:19]
    ds_read_b128 v[40:43], v240 offset:2048
    ds_read_b128 v[44:47], v240 offset:3072
    v_mfma_f32_16x16x32_bf16 v[20:23], v[100:103], v[84:87], v[20:23]
    ds_read_b128 v[56:59], v240 offset:8192
    v_mfma_f32_16x16x32_bf16 v[24:27], v[100:103], v[88:91], v[24:27]
    ds_read_b64_tr_b16 v[72:73], v242 offset:4224
    ds_read_b64_tr_b16 v[74:75], v242 offset:4736
    v_mfma_f32_16x16x32_bf16 v[28:31], v[100:103], v[92:95], v[28:31]
    ds_read_b128 v[60:63], v240 offset:9216
    v_mfma_f32_16x16x32_bf16 v[0:3], v[120:123], v[104:107], v[0:3]
    ds_read_b64_tr_b16 v[76:77], v242 offset:4256
    ds_read_b64_tr_b16 v[78:79], v242 offset:4768
    v_mfma_f32_16x16x32_bf16 v[4:7], v[120:123], v[108:111], v[4:7]
    ds_read_b128 v[64:67], v240 offset:10240
    v_mfma_f32_16x16x32_bf16 v[8:11], v[120:123], v[112:115], v[8:11]
    ds_read_b128 v[68:71], v240 offset:11264
    v_mfma_f32_16x16x32_bf16 v[12:15], v[120:123], v[116:119], v[12:15]
    v_add_u16 v240, 0x4000, v240
    s_add_u32 s16, s16, 8448
    s_cmp_eq_u32 s16, 92928
    v_mfma_f32_16x16x32_bf16 v[16:19], v[124:127], v[104:107], v[16:19]
    s_cselect_b32 s16, 0, s16
    v_mfma_f32_16x16x32_bf16 v[20:23], v[124:127], v[108:111], v[20:23]
    v_add_u32 v242, s16, v241
    v_mfma_f32_16x16x32_bf16 v[24:27], v[124:127], v[112:115], v[24:27]
    s_cmp_eq_u32 s17, 2
    s_cselect_b64 vcc, -1, 0
    s_sub_u32 s17, s17, 1
    s_cmp_lg_u32 s17, 0
    v_mfma_f32_16x16x32_bf16 v[28:31], v[124:127], v[116:119], v[28:31]
    s_waitcnt lgkmcnt(0)
    s_cbranch_scc1 r1_loop
    s_nop 4
    s_waitcnt vmcnt(0)
    v_lshlrev_b32 v144, 16, v128
    v_and_b32 v145, 0xffff0000, v128
    v_lshlrev_b32 v146, 16, v129
    v_and_b32 v147, 0xffff0000, v129
    v_lshlrev_b32 v148, 16, v130
    v_and_b32 v149, 0xffff0000, v130
    v_lshlrev_b32 v150, 16, v131
    v_and_b32 v151, 0xffff0000, v131
    v_lshlrev_b32 v152, 16, v132
    v_and_b32 v153, 0xffff0000, v132
    v_lshlrev_b32 v154, 16, v133
    v_and_b32 v155, 0xffff0000, v133
    v_lshlrev_b32 v156, 16, v134
    v_and_b32 v157, 0xffff0000, v134
    v_lshlrev_b32 v158, 16, v135
    v_and_b32 v159, 0xffff0000, v135
    v_lshlrev_b32 v160, 16, v136
    v_and_b32 v161, 0xffff0000, v136
    v_lshlrev_b32 v162, 16, v137
    v_and_b32 v163, 0xffff0000, v137
    v_lshlrev_b32 v164, 16, v138
    v_and_b32 v165, 0xffff0000, v138
    v_lshlrev_b32 v166, 16, v139
    v_and_b32 v167, 0xffff0000, v139
    v_lshlrev_b32 v168, 16, v140
    v_and_b32 v169, 0xffff0000, v140
    v_lshlrev_b32 v170, 16, v141
    v_and_b32 v171, 0xffff0000, v141
    v_lshlrev_b32 v172, 16, v142
    v_and_b32 v173, 0xffff0000, v142
    v_lshlrev_b32 v174, 16, v143
    v_and_b32 v175, 0xffff0000, v143
    v_mov_b32 v88, 0x3f803f80
    v_cvt_pk_bf16_f32 v208, v0, v1
    v_cvt_pk_bf16_f32 v209, v2, v3
    v_cvt_pk_bf16_f32 v210, v16, v17
    v_cvt_pk_bf16_f32 v211, v18, v19
    v_lshlrev_b32 v212, 16, v208
    v_and_b32 v213, 0xffff0000, v208
    v_lshlrev_b32 v214, 16, v209
    v_and_b32 v215, 0xffff0000, v209
    v_lshlrev_b32 v216, 16, v210
    v_and_b32 v217, 0xffff0000, v210
    v_lshlrev_b32 v218, 16, v211
    v_and_b32 v219, 0xffff0000, v211
    v_pk_add_f32 v[212:213], v[212:213], v[144:145]
    v_pk_add_f32 v[214:215], v[214:215], v[146:147]
    v_pk_add_f32 v[216:217], v[216:217], v[148:149]
    v_pk_add_f32 v[218:219], v[218:219], v[150:151]
    v_cvt_pk_bf16_f32 v64, v212, v213
    v_cvt_pk_bf16_f32 v65, v214, v215
    v_cvt_pk_bf16_f32 v66, v216, v217
    v_cvt_pk_bf16_f32 v67, v218, v219
    buffer_store_dwordx4 v[64:67], v249, s[80:83], s19 offen offset:0
    v_cvt_pk_bf16_f32 v208, v4, v5
    v_cvt_pk_bf16_f32 v209, v6, v7
    v_cvt_pk_bf16_f32 v210, v20, v21
    v_cvt_pk_bf16_f32 v211, v22, v23
    v_lshlrev_b32 v212, 16, v208
    v_and_b32 v213, 0xffff0000, v208
    v_lshlrev_b32 v214, 16, v209
    v_and_b32 v215, 0xffff0000, v209
    v_lshlrev_b32 v216, 16, v210
    v_and_b32 v217, 0xffff0000, v210
    v_lshlrev_b32 v218, 16, v211
    v_and_b32 v219, 0xffff0000, v211
    v_pk_add_f32 v[212:213], v[212:213], v[152:153]
    v_pk_add_f32 v[214:215], v[214:215], v[154:155]
    v_pk_add_f32 v[216:217], v[216:217], v[156:157]
    v_pk_add_f32 v[218:219], v[218:219], v[158:159]
    v_cvt_pk_bf16_f32 v68, v212, v213
    v_cvt_pk_bf16_f32 v69, v214, v215
    v_cvt_pk_bf16_f32 v70, v216, v217
    v_cvt_pk_bf16_f32 v71, v218, v219
    buffer_store_dwordx4 v[68:71], v249, s[80:83], s19 offen offset:1024
    v_cvt_pk_bf16_f32 v208, v8, v9
    v_cvt_pk_bf16_f32 v209, v10, v11
    v_cvt_pk_bf16_f32 v210, v24, v25
    v_cvt_pk_bf16_f32 v211, v26, v27
    v_lshlrev_b32 v212, 16, v208
    v_and_b32 v213, 0xffff0000, v208
    v_lshlrev_b32 v214, 16, v209
    v_and_b32 v215, 0xffff0000, v209
    v_lshlrev_b32 v216, 16, v210
    v_and_b32 v217, 0xffff0000, v210
    v_lshlrev_b32 v218, 16, v211
    v_and_b32 v219, 0xffff0000, v211
    v_pk_add_f32 v[212:213], v[212:213], v[160:161]
    v_pk_add_f32 v[214:215], v[214:215], v[162:163]
    v_pk_add_f32 v[216:217], v[216:217], v[164:165]
    v_pk_add_f32 v[218:219], v[218:219], v[166:167]
    v_cvt_pk_bf16_f32 v72, v212, v213
    v_cvt_pk_bf16_f32 v73, v214, v215
    v_cvt_pk_bf16_f32 v74, v216, v217
    v_cvt_pk_bf16_f32 v75, v218, v219
    buffer_store_dwordx4 v[72:75], v249, s[80:83], s19 offen offset:2048
    v_cvt_pk_bf16_f32 v208, v12, v13
    v_cvt_pk_bf16_f32 v209, v14, v15
    v_cvt_pk_bf16_f32 v210, v28, v29
    v_cvt_pk_bf16_f32 v211, v30, v31
    v_lshlrev_b32 v212, 16, v208
    v_and_b32 v213, 0xffff0000, v208
    v_lshlrev_b32 v214, 16, v209
    v_and_b32 v215, 0xffff0000, v209
    v_lshlrev_b32 v216, 16, v210
    v_and_b32 v217, 0xffff0000, v210
    v_lshlrev_b32 v218, 16, v211
    v_and_b32 v219, 0xffff0000, v211
    v_pk_add_f32 v[212:213], v[212:213], v[168:169]
    v_pk_add_f32 v[214:215], v[214:215], v[170:171]
    v_pk_add_f32 v[216:217], v[216:217], v[172:173]
    v_pk_add_f32 v[218:219], v[218:219], v[174:175]
    v_cvt_pk_bf16_f32 v76, v212, v213
    v_cvt_pk_bf16_f32 v77, v214, v215
    v_cvt_pk_bf16_f32 v78, v216, v217
    v_cvt_pk_bf16_f32 v79, v218, v219
    buffer_store_dwordx4 v[76:79], v249, s[80:83], s19 offen offset:3072
    v_dot2_f32_bf16 v80, v64, v88, 0
    v_dot2_f32_bf16 v84, v64, v64, 0
    v_dot2_f32_bf16 v80, v65, v88, v80
    v_dot2_f32_bf16 v84, v65, v65, v84
    v_dot2_f32_bf16 v80, v66, v88, v80
    v_dot2_f32_bf16 v84, v66, v66, v84
    v_dot2_f32_bf16 v80, v67, v88, v80
    v_dot2_f32_bf16 v84, v67, v67, v84
    v_dot2_f32_bf16 v81, v68, v88, 0
    v_dot2_f32_bf16 v85, v68, v68, 0
    v_dot2_f32_bf16 v81, v69, v88, v81
    v_dot2_f32_bf16 v85, v69, v69, v85
    v_dot2_f32_bf16 v81, v70, v88, v81
    v_dot2_f32_bf16 v85, v70, v70, v85
    v_dot2_f32_bf16 v81, v71, v88, v81
    v_dot2_f32_bf16 v85, v71, v71, v85
    v_dot2_f32_bf16 v82, v72, v88, 0
    v_dot2_f32_bf16 v86, v72, v72, 0
    v_dot2_f32_bf16 v82, v73, v88, v82
    v_dot2_f32_bf16 v86, v73, v73, v86
    v_dot2_f32_bf16 v82, v74, v88, v82
    v_dot2_f32_bf16 v86, v74, v74, v86
    v_dot2_f32_bf16 v82, v75, v88, v82
    v_dot2_f32_bf16 v86, v75, v75, v86
    v_dot2_f32_bf16 v83, v76, v88, 0
    v_dot2_f32_bf16 v87, v76, v76, 0
    v_dot2_f32_bf16 v83, v77, v88, v83
    v_dot2_f32_bf16 v87, v77, v77, v87
    v_dot2_f32_bf16 v83, v78, v88, v83
    v_dot2_f32_bf16 v87, v78, v78, v87
    v_dot2_f32_bf16 v83, v79, v88, v83
    v_dot2_f32_bf16 v87, v79, v79, v87
    s_lshl_b32 s64, s73, 4
    s_add_u32 s64, s64, s72
    s_lshl_b32 s18, s64, 8
    s_lshl_b32 s64, s64, 11
    s_lshl_b32 s65, s75, 20
    s_add_u32 s64, s64, s65
    s_add_u32 s64, s64, 71303168
    s_lshr_b32 s65, s3, 1
    s_lshl_b32 s65, s65, 10
    s_add_u32 s64, s64, s65
    s_and_b32 s65, s3, 1
    s_lshl_b32 s65, s65, 3
    s_add_u32 s64, s64, s65
    s_add_u32 s18, s18, s65
    v_permlane16_swap_b32 v80, v81
    v_permlane16_swap_b32 v82, v83
    v_permlane16_swap_b32 v84, v85
    v_permlane16_swap_b32 v86, v87
    v_add_f32 v80, v80, v81
    v_add_f32 v82, v82, v83
    v_add_f32 v84, v84, v85
    v_add_f32 v86, v86, v87
    s_nop 1
    v_permlane32_swap_b32 v80, v82
    v_permlane32_swap_b32 v84, v86
    v_add_f32 v80, v80, v82
    v_add_f32 v81, v84, v86
    buffer_store_dwordx2 v[80:81], v249, s[80:83], s64 offen
    s_lshl_b32 s64, s75, 15
    s_lshl_b32 s66, s73, 9
    s_add_u32 s64, s64, s66
    s_add_u32 s64, s64, 75505664
    s_lshl_b32 s65, s72, 5
    s_add_u32 s64, s64, s65
    s_lshl_b32 s65, s3, 2
    s_add_u32 s64, s64, s65
    v_mov_b32 v208, 0
    v_mov_b32 v209, 1
    s_cmp_lg_u32 s78, 0
    s_cbranch_scc1 sg_8_slow
    s_waitcnt vmcnt(0)
    s_mov_b64 exec, 1
    buffer_store_dword v209, v208, s[80:83], s64 offen
    s_mov_b64 exec, -1
sg_8_done:
    s_and_b32 s64, s3, 1
    s_cmp_eq_u32 s64, 0
    s_cselect_b32 s8, s92, s94
    s_cselect_b32 s9, s93, s95
    s_mov_b32 s10, 7340032
    s_mov_b32 s11, 0x00020000
    s_mul_i32 s19, s64, 14400
    s_lshr_b32 s64, s69, 1
    s_mul_i32 s65, s64, 7200
    s_add_u32 s19, s19, s65
    s_add_u32 s19, s19, 36736
    s_mul_i32 s17, s64, 28672
    s_mul_i32 s65, s74, 448
    s_add_u32 s17, s17, s65
    s_add_u32 s18, s17, 7340032
    s_lshl_b32 s64, s57, 1
    s_add_u32 s64, s64, 4
    s_and_b32 s64, s64, 31
    s_mul_i32 s65, s64, 229376
    s_add_u32 s16, s17, s65
    s_lshl_b32 s20, s64, 13
    s_mov_b32 s66, 2341
    v_add_u32 v253, 256, v250
    v_mul_lo_u32 v254, v253, s66
    v_lshrrev_b32 v254, 16, v254
    v_mul_u32_u24 v224, 28, v254
    v_sub_u32 v253, v253, v224
    v_and_b32 v224, 12, v254
    v_add_u32 v254, v254, v224
    v_mul_u32_u24 v254, 7168, v254
    v_lshl_add_u32 v224, v253, 4, v254
    v_add_u32 v253, 320, v250
    v_mul_lo_u32 v254, v253, s66
    v_lshrrev_b32 v254, 16, v254
    v_mul_u32_u24 v225, 28, v254
    v_sub_u32 v253, v253, v225
    v_and_b32 v225, 12, v254
    v_add_u32 v254, v254, v225
    v_mul_u32_u24 v254, 7168, v254
    v_lshl_add_u32 v225, v253, 4, v254
    v_add_u32 v253, 384, v250
    v_mul_lo_u32 v254, v253, s66
    v_lshrrev_b32 v254, 16, v254
    v_mul_u32_u24 v226, 28, v254
    v_sub_u32 v253, v253, v226
    v_and_b32 v226, 12, v254
    v_add_u32 v254, v254, v226
    v_mul_u32_u24 v254, 7168, v254
    v_lshl_add_u32 v226, v253, 4, v254
    s_lshl_b32 s21, s60, 23
    s_lshl_b32 s64, s73, 18
    s_add_u32 s21, s21, s64
    s_lshl_b32 s23, s3, 10
    s_add_u32 s21, s21, s23
    s_add_u32 s22, s21, 262144
    s_add_u32 s20, s20, s21
    s_and_b32 s64, s3, 1
    s_lshl_b32 s64, s64, 12
    v_add_u32 v231, s64, v249
    v_lshrrev_b32 v253, 1, v251
    v_lshrrev_b32 v254, 2, v252
    v_lshl_add_u32 v253, v253, 2, v254
    v_mul_u32_u24 v253, 448, v253
    v_and_b32 v254, 1, v251
    v_mul_u32_u24 v254, 7200, v254
    v_add_u32 v253, v253, v254
    v_and_b32 v254, 3, v252
    v_lshl_add_u32 v253, v254, 3, v253
    v_add_u32 v253, 36736, v253
    s_lshr_b32 s64, s69, 1
    s_lshl_b32 s28, s64, 2
    s_lshl_b32 s65, s28, 5
    v_add_u32 v232, s65, v253
    v_add_u32 v233, 57600, v232
    s_mul_i32 s25, s73, 112
    s_mul_i32 s64, s74, 7
    s_add_u32 s25, s25, s64
    s_lshl_b32 s25, s25, 13
    s_lshl_b32 s64, s60, 24
    s_add_u32 s25, s25, s64
    s_add_u32 s25, s25, 20971520
    v_mov_b32 v192, 0
    v_mov_b32 v193, 0
    v_mov_b32 v194, 0
    v_mov_b32 v195, 0
    s_nop 1
    v_mfma_f32_32x32x16_bf16 v[0:15], v[192:195], v[192:195], 0
    v_mfma_f32_32x32x16_bf16 v[16:31], v[192:195], v[192:195], 0
    v_mfma_f32_32x32x16_bf16 v[32:47], v[192:195], v[192:195], 0
    v_mfma_f32_32x32x16_bf16 v[48:63], v[192:195], v[192:195], 0
    v_mfma_f32_32x32x16_bf16 v[64:79], v[192:195], v[192:195], 0
    v_mfma_f32_32x32x16_bf16 v[80:95], v[192:195], v[192:195], 0
    v_mfma_f32_32x32x16_bf16 v[96:111], v[192:195], v[192:195], 0
    v_mfma_f32_32x32x16_bf16 v[112:127], v[192:195], v[192:195], 0
    s_barrier
    ds_read_b128 v[192:195], v231 offset:0
    ds_read_b128 v[196:199], v231 offset:1024
    ds_read_b128 v[200:203], v231 offset:2048
    ds_read_b128 v[204:207], v231 offset:3072
    ds_read_b64_tr_b16 v[128:129], v232 offset:28800
    ds_read_b64_tr_b16 v[130:131], v232 offset:32384
    ds_read_b64_tr_b16 v[144:145], v232 offset:43200
    ds_read_b64_tr_b16 v[146:147], v232 offset:46784
    ds_read_b64_tr_b16 v[132:133], v232 offset:28832
    ds_read_b64_tr_b16 v[134:135], v232 offset:32416
    ds_read_b64_tr_b16 v[148:149], v232 offset:43232
    ds_read_b64_tr_b16 v[150:151], v232 offset:46816
    ds_read_b64_tr_b16 v[136:137], v232 offset:28864
    ds_read_b64_tr_b16 v[138:139], v232 offset:32448
    ds_read_b64_tr_b16 v[152:153], v232 offset:43264
    ds_read_b64_tr_b16 v[154:155], v232 offset:46848
    ds_read_b64_tr_b16 v[140:141], v232 offset:28896
    ds_read_b64_tr_b16 v[142:143], v232 offset:32480
    ds_read_b64_tr_b16 v[156:157], v232 offset:43296
    ds_read_b64_tr_b16 v[158:159], v232 offset:46880
    s_mov_b32 s24, 7
g3c0_loop:
    s_waitcnt vmcnt(8) lgkmcnt(0)
    s_barrier
    v_mfma_f32_16x16x32_bf16 v[0:3], v[128:131], v[192:195], v[0:3]
    ds_read_b128 v[208:211], v231 offset:8192
    v_mfma_f32_16x16x32_bf16 v[4:7], v[128:131], v[196:199], v[4:7]
    ds_read_b128 v[212:215], v231 offset:9216
    v_mfma_f32_16x16x32_bf16 v[8:11], v[128:131], v[200:203], v[8:11]
    ds_read_b128 v[216:219], v231 offset:10240
    v_mfma_f32_16x16x32_bf16 v[12:15], v[128:131], v[204:207], v[12:15]
    ds_read_b128 v[220:223], v231 offset:11264
    v_mfma_f32_16x16x32_bf16 v[64:67], v[144:147], v[192:195], v[64:67]
    ds_read_b64_tr_b16 v[160:161], v233 offset:0
    v_mfma_f32_16x16x32_bf16 v[68:71], v[144:147], v[196:199], v[68:71]
    s_add_u32 m0, s19, 32896
    s_nop 0
    buffer_load_dwordx4 v224, s[8:11], s16 offen lds
    v_mfma_f32_16x16x32_bf16 v[72:75], v[144:147], v[200:203], v[72:75]
    ds_read_b64_tr_b16 v[162:163], v233 offset:3584
    v_mfma_f32_16x16x32_bf16 v[76:79], v[144:147], v[204:207], v[76:79]
    ds_read_b64_tr_b16 v[176:177], v233 offset:14400
    v_mfma_f32_16x16x32_bf16 v[16:19], v[132:135], v[192:195], v[16:19]
    ds_read_b64_tr_b16 v[178:179], v233 offset:17984
    v_mfma_f32_16x16x32_bf16 v[20:23], v[132:135], v[196:199], v[20:23]
    ds_read_b64_tr_b16 v[164:165], v233 offset:32
    v_mfma_f32_16x16x32_bf16 v[24:27], v[132:135], v[200:203], v[24:27]
    ds_read_b64_tr_b16 v[166:167], v233 offset:3616
    v_mfma_f32_16x16x32_bf16 v[28:31], v[132:135], v[204:207], v[28:31]
    s_add_u32 m0, s19, 33920
    s_nop 0
    buffer_load_dwordx4 v225, s[8:11], s16 offen lds
    v_mfma_f32_16x16x32_bf16 v[80:83], v[148:151], v[192:195], v[80:83]
    v_mfma_f32_16x16x32_bf16 v[84:87], v[148:151], v[196:199], v[84:87]
    ds_read_b64_tr_b16 v[180:181], v233 offset:14432
    v_mfma_f32_16x16x32_bf16 v[88:91], v[148:151], v[200:203], v[88:91]
    ds_read_b64_tr_b16 v[182:183], v233 offset:18016
    v_mfma_f32_16x16x32_bf16 v[92:95], v[148:151], v[204:207], v[92:95]
    ds_read_b64_tr_b16 v[168:169], v233 offset:64
    v_mfma_f32_16x16x32_bf16 v[32:35], v[136:139], v[192:195], v[32:35]
    ds_read_b64_tr_b16 v[170:171], v233 offset:3648
    v_mfma_f32_16x16x32_bf16 v[36:39], v[136:139], v[196:199], v[36:39]
    ds_read_b64_tr_b16 v[184:185], v233 offset:14464
    v_mfma_f32_16x16x32_bf16 v[40:43], v[136:139], v[200:203], v[40:43]
    s_add_u32 m0, s19, 34944
    s_nop 0
    buffer_load_dwordx4 v226, s[8:11], s16 offen lds
    s_add_u32 s16, s16, 229376
    s_cmp_eq_u32 s16, s18
    s_cselect_b32 s16, s17, s16
    v_mfma_f32_16x16x32_bf16 v[44:47], v[136:139], v[204:207], v[44:47]
    ds_read_b64_tr_b16 v[186:187], v233 offset:18048
    v_mfma_f32_16x16x32_bf16 v[96:99], v[152:155], v[192:195], v[96:99]
    ds_read_b64_tr_b16 v[172:173], v233 offset:96
    v_mfma_f32_16x16x32_bf16 v[100:103], v[152:155], v[196:199], v[100:103]
    ds_read_b64_tr_b16 v[174:175], v233 offset:3680
    v_mfma_f32_16x16x32_bf16 v[104:107], v[152:155], v[200:203], v[104:107]
    ds_read_b64_tr_b16 v[188:189], v233 offset:14496
    v_mfma_f32_16x16x32_bf16 v[108:111], v[152:155], v[204:207], v[108:111]
    ds_read_b64_tr_b16 v[190:191], v233 offset:18080
    v_mfma_f32_16x16x32_bf16 v[48:51], v[140:143], v[192:195], v[48:51]
    s_add_u32 m0, s23, 0
    s_nop 0
    buffer_load_dwordx4 v249, s[80:83], s20 offen sc1 lds
    s_add_u32 s20, s20, 8192
    s_cmp_eq_u32 s20, s22
    s_cselect_b32 s20, s21, s20
    v_mfma_f32_16x16x32_bf16 v[52:55], v[140:143], v[196:199], v[52:55]
    v_mfma_f32_16x16x32_bf16 v[56:59], v[140:143], v[200:203], v[56:59]
    v_mfma_f32_16x16x32_bf16 v[60:63], v[140:143], v[204:207], v[60:63]
    v_mfma_f32_16x16x32_bf16 v[112:115], v[156:159], v[192:195], v[112:115]
    v_mfma_f32_16x16x32_bf16 v[116:119], v[156:159], v[196:199], v[116:119]
    v_mfma_f32_16x16x32_bf16 v[120:123], v[156:159], v[200:203], v[120:123]
    v_mfma_f32_16x16x32_bf16 v[124:127], v[156:159], v[204:207], v[124:127]
    s_waitcnt vmcnt(8) lgkmcnt(0)
    s_barrier
    v_mfma_f32_16x16x32_bf16 v[0:3], v[160:163], v[208:211], v[0:3]
    ds_read_b128 v[192:195], v231 offset:16384
    v_mfma_f32_16x16x32_bf16 v[4:7], v[160:163], v[212:215], v[4:7]
    ds_read_b128 v[196:199], v231 offset:17408
    v_mfma_f32_16x16x32_bf16 v[8:11], v[160:163], v[216:219], v[8:11]
    ds_read_b128 v[200:203], v231 offset:18432
    v_mfma_f32_16x16x32_bf16 v[12:15], v[160:163], v[220:223], v[12:15]
    ds_read_b128 v[204:207], v231 offset:19456
    v_mfma_f32_16x16x32_bf16 v[64:67], v[176:179], v[208:211], v[64:67]
    ds_read_b64_tr_b16 v[128:129], v233 offset:28800
    v_mfma_f32_16x16x32_bf16 v[68:71], v[176:179], v[212:215], v[68:71]
    s_add_u32 m0, s19, 61696
    s_nop 0
    buffer_load_dwordx4 v224, s[8:11], s16 offen lds
    v_mfma_f32_16x16x32_bf16 v[72:75], v[176:179], v[216:219], v[72:75]
    ds_read_b64_tr_b16 v[130:131], v233 offset:32384
    v_mfma_f32_16x16x32_bf16 v[76:79], v[176:179], v[220:223], v[76:79]
    ds_read_b64_tr_b16 v[144:145], v233 offset:43200
    v_mfma_f32_16x16x32_bf16 v[16:19], v[164:167], v[208:211], v[16:19]
    ds_read_b64_tr_b16 v[146:147], v233 offset:46784
    v_mfma_f32_16x16x32_bf16 v[20:23], v[164:167], v[212:215], v[20:23]
    ds_read_b64_tr_b16 v[132:133], v233 offset:28832
    v_mfma_f32_16x16x32_bf16 v[24:27], v[164:167], v[216:219], v[24:27]
    ds_read_b64_tr_b16 v[134:135], v233 offset:32416
    v_mfma_f32_16x16x32_bf16 v[28:31], v[164:167], v[220:223], v[28:31]
    s_add_u32 m0, s19, 62720
    s_nop 0
    buffer_load_dwordx4 v225, s[8:11], s16 offen lds
    v_mfma_f32_16x16x32_bf16 v[80:83], v[180:183], v[208:211], v[80:83]
    v_mfma_f32_16x16x32_bf16 v[84:87], v[180:183], v[212:215], v[84:87]
    ds_read_b64_tr_b16 v[148:149], v233 offset:43232
    v_mfma_f32_16x16x32_bf16 v[88:91], v[180:183], v[216:219], v[88:91]
    ds_read_b64_tr_b16 v[150:151], v233 offset:46816
    v_mfma_f32_16x16x32_bf16 v[92:95], v[180:183], v[220:223], v[92:95]
    ds_read_b64_tr_b16 v[136:137], v233 offset:28864
    v_mfma_f32_16x16x32_bf16 v[32:35], v[168:171], v[208:211], v[32:35]
    ds_read_b64_tr_b16 v[138:139], v233 offset:32448
    v_mfma_f32_16x16x32_bf16 v[36:39], v[168:171], v[212:215], v[36:39]
    ds_read_b64_tr_b16 v[152:153], v233 offset:43264
    v_mfma_f32_16x16x32_bf16 v[40:43], v[168:171], v[216:219], v[40:43]
    s_add_u32 m0, s19, 63744
    s_nop 0
    buffer_load_dwordx4 v226, s[8:11], s16 offen lds
    s_add_u32 s16, s16, 229376
    s_cmp_eq_u32 s16, s18
    s_cselect_b32 s16, s17, s16
    v_mfma_f32_16x16x32_bf16 v[44:47], v[168:171], v[220:223], v[44:47]
    ds_read_b64_tr_b16 v[154:155], v233 offset:46848
    v_mfma_f32_16x16x32_bf16 v[96:99], v[184:187], v[208:211], v[96:99]
    ds_read_b64_tr_b16 v[140:141], v233 offset:28896
    v_mfma_f32_16x16x32_bf16 v[100:103], v[184:187], v[212:215], v[100:103]
    ds_read_b64_tr_b16 v[142:143], v233 offset:32480
    v_mfma_f32_16x16x32_bf16 v[104:107], v[184:187], v[216:219], v[104:107]
    ds_read_b64_tr_b16 v[156:157], v233 offset:43296
    v_mfma_f32_16x16x32_bf16 v[108:111], v[184:187], v[220:223], v[108:111]
    ds_read_b64_tr_b16 v[158:159], v233 offset:46880
    v_mfma_f32_16x16x32_bf16 v[48:51], v[172:175], v[208:211], v[48:51]
    s_add_u32 m0, s23, 8192
    s_nop 0
    buffer_load_dwordx4 v249, s[80:83], s20 offen sc1 lds
    s_add_u32 s20, s20, 8192
    s_cmp_eq_u32 s20, s22
    s_cselect_b32 s20, s21, s20
    v_mfma_f32_16x16x32_bf16 v[52:55], v[172:175], v[212:215], v[52:55]
    v_mfma_f32_16x16x32_bf16 v[56:59], v[172:175], v[216:219], v[56:59]
    v_mfma_f32_16x16x32_bf16 v[60:63], v[172:175], v[220:223], v[60:63]
    v_mfma_f32_16x16x32_bf16 v[112:115], v[188:191], v[208:211], v[112:115]
    v_mfma_f32_16x16x32_bf16 v[116:119], v[188:191], v[212:215], v[116:119]
    v_mfma_f32_16x16x32_bf16 v[120:123], v[188:191], v[216:219], v[120:123]
    v_mfma_f32_16x16x32_bf16 v[124:127], v[188:191], v[220:223], v[124:127]
    s_waitcnt vmcnt(8) lgkmcnt(0)
    s_barrier
    v_mfma_f32_16x16x32_bf16 v[0:3], v[128:131], v[192:195], v[0:3]
    ds_read_b128 v[208:211], v231 offset:24576
    v_mfma_f32_16x16x32_bf16 v[4:7], v[128:131], v[196:199], v[4:7]
    ds_read_b128 v[212:215], v231 offset:25600
    v_mfma_f32_16x16x32_bf16 v[8:11], v[128:131], v[200:203], v[8:11]
    ds_read_b128 v[216:219], v231 offset:26624
    v_mfma_f32_16x16x32_bf16 v[12:15], v[128:131], v[204:207], v[12:15]
    ds_read_b128 v[220:223], v231 offset:27648
    v_mfma_f32_16x16x32_bf16 v[64:67], v[144:147], v[192:195], v[64:67]
    ds_read_b64_tr_b16 v[160:161], v232 offset:0
    v_mfma_f32_16x16x32_bf16 v[68:71], v[144:147], v[196:199], v[68:71]
    s_add_u32 m0, s19, 90496
    s_nop 0
    buffer_load_dwordx4 v224, s[8:11], s16 offen lds
    v_mfma_f32_16x16x32_bf16 v[72:75], v[144:147], v[200:203], v[72:75]
    ds_read_b64_tr_b16 v[162:163], v232 offset:3584
    v_mfma_f32_16x16x32_bf16 v[76:79], v[144:147], v[204:207], v[76:79]
    ds_read_b64_tr_b16 v[176:177], v232 offset:14400
    v_mfma_f32_16x16x32_bf16 v[16:19], v[132:135], v[192:195], v[16:19]
    ds_read_b64_tr_b16 v[178:179], v232 offset:17984
    v_mfma_f32_16x16x32_bf16 v[20:23], v[132:135], v[196:199], v[20:23]
    ds_read_b64_tr_b16 v[164:165], v232 offset:32
    v_mfma_f32_16x16x32_bf16 v[24:27], v[132:135], v[200:203], v[24:27]
    ds_read_b64_tr_b16 v[166:167], v232 offset:3616
    v_mfma_f32_16x16x32_bf16 v[28:31], v[132:135], v[204:207], v[28:31]
    s_add_u32 m0, s19, 91520
    s_nop 0
    buffer_load_dwordx4 v225, s[8:11], s16 offen lds
    v_mfma_f32_16x16x32_bf16 v[80:83], v[148:151], v[192:195], v[80:83]
    v_mfma_f32_16x16x32_bf16 v[84:87], v[148:151], v[196:199], v[84:87]
    ds_read_b64_tr_b16 v[180:181], v232 offset:14432
    v_mfma_f32_16x16x32_bf16 v[88:91], v[148:151], v[200:203], v[88:91]
    ds_read_b64_tr_b16 v[182:183], v232 offset:18016
    v_mfma_f32_16x16x32_bf16 v[92:95], v[148:151], v[204:207], v[92:95]
    ds_read_b64_tr_b16 v[168:169], v232 offset:64
    v_mfma_f32_16x16x32_bf16 v[32:35], v[136:139], v[192:195], v[32:35]
    ds_read_b64_tr_b16 v[170:171], v232 offset:3648
    v_mfma_f32_16x16x32_bf16 v[36:39], v[136:139], v[196:199], v[36:39]
    ds_read_b64_tr_b16 v[184:185], v232 offset:14464
    v_mfma_f32_16x16x32_bf16 v[40:43], v[136:139], v[200:203], v[40:43]
    s_add_u32 m0, s19, 92544
    s_nop 0
    buffer_load_dwordx4 v226, s[8:11], s16 offen lds
    s_add_u32 s16, s16, 229376
    s_cmp_eq_u32 s16, s18
    s_cselect_b32 s16, s17, s16
    v_mfma_f32_16x16x32_bf16 v[44:47], v[136:139], v[204:207], v[44:47]
    ds_read_b64_tr_b16 v[186:187], v232 offset:18048
    v_mfma_f32_16x16x32_bf16 v[96:99], v[152:155], v[192:195], v[96:99]
    ds_read_b64_tr_b16 v[172:173], v232 offset:96
    v_mfma_f32_16x16x32_bf16 v[100:103], v[152:155], v[196:199], v[100:103]
    ds_read_b64_tr_b16 v[174:175], v232 offset:3680
    v_mfma_f32_16x16x32_bf16 v[104:107], v[152:155], v[200:203], v[104:107]
    ds_read_b64_tr_b16 v[188:189], v232 offset:14496
    v_mfma_f32_16x16x32_bf16 v[108:111], v[152:155], v[204:207], v[108:111]
    ds_read_b64_tr_b16 v[190:191], v232 offset:18080
    v_mfma_f32_16x16x32_bf16 v[48:51], v[140:143], v[192:195], v[48:51]
    s_add_u32 m0, s23, 16384
    s_nop 0
    buffer_load_dwordx4 v249, s[80:83], s20 offen sc1 lds
    s_add_u32 s20, s20, 8192
    s_cmp_eq_u32 s20, s22
    s_cselect_b32 s20, s21, s20
    v_mfma_f32_16x16x32_bf16 v[52:55], v[140:143], v[196:199], v[52:55]
    v_mfma_f32_16x16x32_bf16 v[56:59], v[140:143], v[200:203], v[56:59]
    v_mfma_f32_16x16x32_bf16 v[60:63], v[140:143], v[204:207], v[60:63]
    v_mfma_f32_16x16x32_bf16 v[112:115], v[156:159], v[192:195], v[112:115]
    v_mfma_f32_16x16x32_bf16 v[116:119], v[156:159], v[196:199], v[116:119]
    v_mfma_f32_16x16x32_bf16 v[120:123], v[156:159], v[200:203], v[120:123]
    v_mfma_f32_16x16x32_bf16 v[124:127], v[156:159], v[204:207], v[124:127]
    s_waitcnt vmcnt(8) lgkmcnt(0)
    s_barrier
    v_mfma_f32_16x16x32_bf16 v[0:3], v[160:163], v[208:211], v[0:3]
    ds_read_b128 v[192:195], v231 offset:0
    v_mfma_f32_16x16x32_bf16 v[4:7], v[160:163], v[212:215], v[4:7]
    ds_read_b128 v[196:199], v231 offset:1024
    v_mfma_f32_16x16x32_bf16 v[8:11], v[160:163], v[216:219], v[8:11]
    ds_read_b128 v[200:203], v231 offset:2048
    v_mfma_f32_16x16x32_bf16 v[12:15], v[160:163], v[220:223], v[12:15]
    ds_read_b128 v[204:207], v231 offset:3072
    v_mfma_f32_16x16x32_bf16 v[64:67], v[176:179], v[208:211], v[64:67]
    ds_read_b64_tr_b16 v[128:129], v232 offset:28800
    v_mfma_f32_16x16x32_bf16 v[68:71], v[176:179], v[212:215], v[68:71]
    s_add_u32 m0, s19, 4096
    s_nop 0
    buffer_load_dwordx4 v224, s[8:11], s16 offen lds
    v_mfma_f32_16x16x32_bf16 v[72:75], v[176:179], v[216:219], v[72:75]
    ds_read_b64_tr_b16 v[130:131], v232 offset:32384
    v_mfma_f32_16x16x32_bf16 v[76:79], v[176:179], v[220:223], v[76:79]
    ds_read_b64_tr_b16 v[144:145], v232 offset:43200
    v_mfma_f32_16x16x32_bf16 v[16:19], v[164:167], v[208:211], v[16:19]
    ds_read_b64_tr_b16 v[146:147], v232 offset:46784
    v_mfma_f32_16x16x32_bf16 v[20:23], v[164:167], v[212:215], v[20:23]
    ds_read_b64_tr_b16 v[132:133], v232 offset:28832
    v_mfma_f32_16x16x32_bf16 v[24:27], v[164:167], v[216:219], v[24:27]
    ds_read_b64_tr_b16 v[134:135], v232 offset:32416
    v_mfma_f32_16x16x32_bf16 v[28:31], v[164:167], v[220:223], v[28:31]
    s_add_u32 m0, s19, 5120
    s_nop 0
    buffer_load_dwordx4 v225, s[8:11], s16 offen lds
    v_mfma_f32_16x16x32_bf16 v[80:83], v[180:183], v[208:211], v[80:83]
    v_mfma_f32_16x16x32_bf16 v[84:87], v[180:183], v[212:215], v[84:87]
    ds_read_b64_tr_b16 v[148:149], v232 offset:43232
    v_mfma_f32_16x16x32_bf16 v[88:91], v[180:183], v[216:219], v[88:91]
    ds_read_b64_tr_b16 v[150:151], v232 offset:46816
    v_mfma_f32_16x16x32_bf16 v[92:95], v[180:183], v[220:223], v[92:95]
    ds_read_b64_tr_b16 v[136:137], v232 offset:28864
    v_mfma_f32_16x16x32_bf16 v[32:35], v[168:171], v[208:211], v[32:35]
    ds_read_b64_tr_b16 v[138:139], v232 offset:32448
    v_mfma_f32_16x16x32_bf16 v[36:39], v[168:171], v[212:215], v[36:39]
    ds_read_b64_tr_b16 v[152:153], v232 offset:43264
    v_mfma_f32_16x16x32_bf16 v[40:43], v[168:171], v[216:219], v[40:43]
    s_add_u32 m0, s19, 6144
    s_nop 0
    buffer_load_dwordx4 v226, s[8:11], s16 offen lds
    s_add_u32 s16, s16, 229376
    s_cmp_eq_u32 s16, s18
    s_cselect_b32 s16, s17, s16
    v_mfma_f32_16x16x32_bf16 v[44:47], v[168:171], v[220:223], v[44:47]
    ds_read_b64_tr_b16 v[154:155], v232 offset:46848
    v_mfma_f32_16x16x32_bf16 v[96:99], v[184:187], v[208:211], v[96:99]
    ds_read_b64_tr_b16 v[140:141], v232 offset:28896
    v_mfma_f32_16x16x32_bf16 v[100:103], v[184:187], v[212:215], v[100:103]
    ds_read_b64_tr_b16 v[142:143], v232 offset:32480
    v_mfma_f32_16x16x32_bf16 v[104:107], v[184:187], v[216:219], v[104:107]
    ds_read_b64_tr_b16 v[156:157], v232 offset:43296
    v_mfma_f32_16x16x32_bf16 v[108:111], v[184:187], v[220:223], v[108:111]
    ds_read_b64_tr_b16 v[158:159], v232 offset:46880
    v_mfma_f32_16x16x32_bf16 v[48:51], v[172:175], v[208:211], v[48:51]
    s_add_u32 m0, s23, 24576
    s_nop 0
    buffer_load_dwordx4 v249, s[80:83], s20 offen sc1 lds
    s_add_u32 s20, s20, 8192
    s_cmp_eq_u32 s20, s22
    s_cselect_b32 s20, s21, s20
    v_mfma_f32_16x16x32_bf16 v[52:55], v[172:175], v[212:215], v[52:55]
    v_mfma_f32_16x16x32_bf16 v[56:59], v[172:175], v[216:219], v[56:59]
    v_mfma_f32_16x16x32_bf16 v[60:63], v[172:175], v[220:223], v[60:63]
    v_mfma_f32_16x16x32_bf16 v[112:115], v[188:191], v[208:211], v[112:115]
    v_mfma_f32_16x16x32_bf16 v[116:119], v[188:191], v[212:215], v[116:119]
    v_mfma_f32_16x16x32_bf16 v[120:123], v[188:191], v[216:219], v[120:123]
    v_mfma_f32_16x16x32_bf16 v[124:127], v[188:191], v[220:223], v[124:127]
    s_sub_u32 s24, s24, 1
    s_cmp_lg_u32 s24, 0
    s_cbranch_scc1 g3c0_loop
    s_sub_u32 s27, s74, s58
    s_and_b32 s27, s27, 7
    s_cmp_lt_u32 s27, 4
    s_cselect_b32 s27, 14, 0
    s_waitcnt vmcnt(8) lgkmcnt(0)
    s_barrier
    v_mfma_f32_16x16x32_bf16 v[0:3], v[128:131], v[192:195], v[0:3]
    ds_read_b128 v[208:211], v231 offset:8192
    v_mfma_f32_16x16x32_bf16 v[4:7], v[128:131], v[196:199], v[4:7]
    ds_read_b128 v[212:215], v231 offset:9216
    v_lshlrev_b32 v224, 7, v250
    s_add_u32 s64, s3, 0
    s_lshl_b32 s65, s64, 12
    s_add_u32 s65, s65, s25
    s_cmp_lt_u32 s64, s27
    s_cselect_b32 s65, s65, 0x7f000000
    s_mov_b64 exec, 0xffffffff
    buffer_load_dword v225, v224, s[80:83], s65 offen sc1
    s_mov_b64 exec, -1
    v_mfma_f32_16x16x32_bf16 v[8:11], v[128:131], v[200:203], v[8:11]
    ds_read_b128 v[216:219], v231 offset:10240
    v_mfma_f32_16x16x32_bf16 v[12:15], v[128:131], v[204:207], v[12:15]
    ds_read_b128 v[220:223], v231 offset:11264
    v_mfma_f32_16x16x32_bf16 v[64:67], v[144:147], v[192:195], v[64:67]
    v_mfma_f32_16x16x32_bf16 v[68:71], v[144:147], v[196:199], v[68:71]
    ds_read_b64_tr_b16 v[160:161], v233 offset:0
    v_mfma_f32_16x16x32_bf16 v[72:75], v[144:147], v[200:203], v[72:75]
    ds_read_b64_tr_b16 v[162:163], v233 offset:3584
    v_mfma_f32_16x16x32_bf16 v[76:79], v[144:147], v[204:207], v[76:79]
    ds_read_b64_tr_b16 v[176:177], v233 offset:14400
    v_mfma_f32_16x16x32_bf16 v[16:19], v[132:135], v[192:195], v[16:19]
    v_mfma_f32_16x16x32_bf16 v[20:23], v[132:135], v[196:199], v[20:23]
    ds_read_b64_tr_b16 v[178:179], v233 offset:17984
    v_mfma_f32_16x16x32_bf16 v[24:27], v[132:135], v[200:203], v[24:27]
    ds_read_b64_tr_b16 v[164:165], v233 offset:32
    v_mfma_f32_16x16x32_bf16 v[28:31], v[132:135], v[204:207], v[28:31]
    ds_read_b64_tr_b16 v[166:167], v233 offset:3616
    v_mfma_f32_16x16x32_bf16 v[80:83], v[148:151], v[192:195], v[80:83]
    v_mfma_f32_16x16x32_bf16 v[84:87], v[148:151], v[196:199], v[84:87]
    ds_read_b64_tr_b16 v[180:181], v233 offset:14432
    v_mfma_f32_16x16x32_bf16 v[88:91], v[148:151], v[200:203], v[88:91]
    ds_read_b64_tr_b16 v[182:183], v233 offset:18016
    v_mfma_f32_16x16x32_bf16 v[92:95], v[148:151], v[204:207], v[92:95]
    ds_read_b64_tr_b16 v[168:169], v233 offset:64
    v_mfma_f32_16x16x32_bf16 v[32:35], v[136:139], v[192:195], v[32:35]
    ds_read_b64_tr_b16 v[170:171], v233 offset:3648
    v_mfma_f32_16x16x32_bf16 v[36:39], v[136:139], v[196:199], v[36:39]
    v_mfma_f32_16x16x32_bf16 v[40:43], v[136:139], v[200:203], v[40:43]
    ds_read_b64_tr_b16 v[184:185], v233 offset:14464
    v_mfma_f32_16x16x32_bf16 v[44:47], v[136:139], v[204:207], v[44:47]
    ds_read_b64_tr_b16 v[186:187], v233 offset:18048
    v_mfma_f32_16x16x32_bf16 v[96:99], v[152:155], v[192:195], v[96:99]
    ds_read_b64_tr_b16 v[172:173], v233 offset:96
    v_mfma_f32_16x16x32_bf16 v[100:103], v[152:155], v[196:199], v[100:103]
    v_mfma_f32_16x16x32_bf16 v[104:107], v[152:155], v[200:203], v[104:107]
    ds_read_b64_tr_b16 v[174:175], v233 offset:3680
    v_mfma_f32_16x16x32_bf16 v[108:111], v[152:155], v[204:207], v[108:111]
    ds_read_b64_tr_b16 v[188:189], v233 offset:14496
    v_mfma_f32_16x16x32_bf16 v[48:51], v[140:143], v[192:195], v[48:51]
    ds_read_b64_tr_b16 v[190:191], v233 offset:18080
    v_mfma_f32_16x16x32_bf16 v[52:55], v[140:143], v[196:199], v[52:55]
    v_mfma_f32_16x16x32_bf16 v[56:59], v[140:143], v[200:203], v[56:59]
    v_mfma_f32_16x16x32_bf16 v[60:63], v[140:143], v[204:207], v[60:63]
    v_mfma_f32_16x16x32_bf16 v[112:115], v[156:159], v[192:195], v[112:115]
    v_mfma_f32_16x16x32_bf16 v[116:119], v[156:159], v[196:199], v[116:119]
    v_mfma_f32_16x16x32_bf16 v[120:123], v[156:159], v[200:203], v[120:123]
    v_mfma_f32_16x16x32_bf16 v[124:127], v[156:159], v[204:207], v[124:127]
    s_waitcnt vmcnt(5) lgkmcnt(0)
    s_barrier
    v_mfma_f32_16x16x32_bf16 v[0:3], v[160:163], v[208:211], v[0:3]
    ds_read_b128 v[192:195], v231 offset:16384
    v_mfma_f32_16x16x32_bf16 v[4:7], v[160:163], v[212:215], v[4:7]
    ds_read_b128 v[196:199], v231 offset:17408
    v_mfma_f32_16x16x32_bf16 v[8:11], v[160:163], v[216:219], v[8:11]
    ds_read_b128 v[200:203], v231 offset:18432
    v_mfma_f32_16x16x32_bf16 v[12:15], v[160:163], v[220:223], v[12:15]
    ds_read_b128 v[204:207], v231 offset:19456
    v_mfma_f32_16x16x32_bf16 v[64:67], v[176:179], v[208:211], v[64:67]
    v_mfma_f32_16x16x32_bf16 v[68:71], v[176:179], v[212:215], v[68:71]
    ds_read_b64_tr_b16 v[128:129], v233 offset:28800
    v_mfma_f32_16x16x32_bf16 v[72:75], v[176:179], v[216:219], v[72:75]
    ds_read_b64_tr_b16 v[130:131], v233 offset:32384
    v_mfma_f32_16x16x32_bf16 v[76:79], v[176:179], v[220:223], v[76:79]
    ds_read_b64_tr_b16 v[144:145], v233 offset:43200
    v_mfma_f32_16x16x32_bf16 v[16:19], v[164:167], v[208:211], v[16:19]
    v_mfma_f32_16x16x32_bf16 v[20:23], v[164:167], v[212:215], v[20:23]
    ds_read_b64_tr_b16 v[146:147], v233 offset:46784
    v_mfma_f32_16x16x32_bf16 v[24:27], v[164:167], v[216:219], v[24:27]
    ds_read_b64_tr_b16 v[132:133], v233 offset:28832
    v_mfma_f32_16x16x32_bf16 v[28:31], v[164:167], v[220:223], v[28:31]
    ds_read_b64_tr_b16 v[134:135], v233 offset:32416
    v_mfma_f32_16x16x32_bf16 v[80:83], v[180:183], v[208:211], v[80:83]
    v_mfma_f32_16x16x32_bf16 v[84:87], v[180:183], v[212:215], v[84:87]
    ds_read_b64_tr_b16 v[148:149], v233 offset:43232
    v_mfma_f32_16x16x32_bf16 v[88:91], v[180:183], v[216:219], v[88:91]
    ds_read_b64_tr_b16 v[150:151], v233 offset:46816
    v_mfma_f32_16x16x32_bf16 v[92:95], v[180:183], v[220:223], v[92:95]
    ds_read_b64_tr_b16 v[136:137], v233 offset:28864
    v_mfma_f32_16x16x32_bf16 v[32:35], v[168:171], v[208:211], v[32:35]
    ds_read_b64_tr_b16 v[138:139], v233 offset:32448
    v_mfma_f32_16x16x32_bf16 v[36:39], v[168:171], v[212:215], v[36:39]
    v_mfma_f32_16x16x32_bf16 v[40:43], v[168:171], v[216:219], v[40:43]
    ds_read_b64_tr_b16 v[152:153], v233 offset:43264
    v_mfma_f32_16x16x32_bf16 v[44:47], v[168:171], v[220:223], v[44:47]
    ds_read_b64_tr_b16 v[154:155], v233 offset:46848
    v_mfma_f32_16x16x32_bf16 v[96:99], v[184:187], v[208:211], v[96:99]
    ds_read_b64_tr_b16 v[140:141], v233 offset:28896
    v_mfma_f32_16x16x32_bf16 v[100:103], v[184:187], v[212:215], v[100:103]
    v_lshlrev_b32 v224, 7, v250
    s_add_u32 s64, s3, 8
    s_lshl_b32 s65, s64, 12
    s_add_u32 s65, s65, s25
    s_cmp_lt_u32 s64, s27
    s_cselect_b32 s65, s65, 0x7f000000
    s_mov_b64 exec, 0xffffffff
    buffer_load_dword v226, v224, s[80:83], s65 offen sc1
    s_mov_b64 exec, -1
    v_mfma_f32_16x16x32_bf16 v[104:107], v[184:187], v[216:219], v[104:107]
    ds_read_b64_tr_b16 v[142:143], v233 offset:32480
    v_mfma_f32_16x16x32_bf16 v[108:111], v[184:187], v[220:223], v[108:111]
    ds_read_b64_tr_b16 v[156:157], v233 offset:43296
    v_mfma_f32_16x16x32_bf16 v[48:51], v[172:175], v[208:211], v[48:51]
    ds_read_b64_tr_b16 v[158:159], v233 offset:46880
    v_mfma_f32_16x16x32_bf16 v[52:55], v[172:175], v[212:215], v[52:55]
    v_mfma_f32_16x16x32_bf16 v[56:59], v[172:175], v[216:219], v[56:59]
    v_mfma_f32_16x16x32_bf16 v[60:63], v[172:175], v[220:223], v[60:63]
    v_mfma_f32_16x16x32_bf16 v[112:115], v[188:191], v[208:211], v[112:115]
    v_mfma_f32_16x16x32_bf16 v[116:119], v[188:191], v[212:215], v[116:119]
    v_mfma_f32_16x16x32_bf16 v[120:123], v[188:191], v[216:219], v[120:123]
    v_mfma_f32_16x16x32_bf16 v[124:127], v[188:191], v[220:223], v[124:127]
    s_waitcnt vmcnt(2) lgkmcnt(0)
    s_barrier
    v_mfma_f32_16x16x32_bf16 v[0:3], v[128:131], v[192:195], v[0:3]
    ds_read_b128 v[208:211], v231 offset:24576
    v_mfma_f32_16x16x32_bf16 v[4:7], v[128:131], v[196:199], v[4:7]
    ds_read_b128 v[212:215], v231 offset:25600
    v_mfma_f32_16x16x32_bf16 v[8:11], v[128:131], v[200:203], v[8:11]
    ds_read_b128 v[216:219], v231 offset:26624
    v_mfma_f32_16x16x32_bf16 v[12:15], v[128:131], v[204:207], v[12:15]
    ds_read_b128 v[220:223], v231 offset:27648
    v_mfma_f32_16x16x32_bf16 v[64:67], v[144:147], v[192:195], v[64:67]
    v_mfma_f32_16x16x32_bf16 v[68:71], v[144:147], v[196:199], v[68:71]
    ds_read_b64_tr_b16 v[160:161], v232 offset:0
    v_mfma_f32_16x16x32_bf16 v[72:75], v[144:147], v[200:203], v[72:75]
    ds_read_b64_tr_b16 v[162:163], v232 offset:3584
    v_mfma_f32_16x16x32_bf16 v[76:79], v[144:147], v[204:207], v[76:79]
    ds_read_b64_tr_b16 v[176:177], v232 offset:14400
    v_mfma_f32_16x16x32_bf16 v[16:19], v[132:135], v[192:195], v[16:19]
    v_mfma_f32_16x16x32_bf16 v[20:23], v[132:135], v[196:199], v[20:23]
    ds_read_b64_tr_b16 v[178:179], v232 offset:17984
    v_mfma_f32_16x16x32_bf16 v[24:27], v[132:135], v[200:203], v[24:27]
    ds_read_b64_tr_b16 v[164:165], v232 offset:32
    v_mfma_f32_16x16x32_bf16 v[28:31], v[132:135], v[204:207], v[28:31]
    ds_read_b64_tr_b16 v[166:167], v232 offset:3616
    v_mfma_f32_16x16x32_bf16 v[80:83], v[148:151], v[192:195], v[80:83]
    v_mfma_f32_16x16x32_bf16 v[84:87], v[148:151], v[196:199], v[84:87]
    ds_read_b64_tr_b16 v[180:181], v232 offset:14432
    v_mfma_f32_16x16x32_bf16 v[88:91], v[148:151], v[200:203], v[88:91]
    ds_read_b64_tr_b16 v[182:183], v232 offset:18016
    v_mfma_f32_16x16x32_bf16 v[92:95], v[148:151], v[204:207], v[92:95]
    ds_read_b64_tr_b16 v[168:169], v232 offset:64
    v_mfma_f32_16x16x32_bf16 v[32:35], v[136:139], v[192:195], v[32:35]
    ds_read_b64_tr_b16 v[170:171], v232 offset:3648
    v_mfma_f32_16x16x32_bf16 v[36:39], v[136:139], v[196:199], v[36:39]
    v_mfma_f32_16x16x32_bf16 v[40:43], v[136:139], v[200:203], v[40:43]
    ds_read_b64_tr_b16 v[184:185], v232 offset:14464
    v_mfma_f32_16x16x32_bf16 v[44:47], v[136:139], v[204:207], v[44:47]
    ds_read_b64_tr_b16 v[186:187], v232 offset:18048
    v_mfma_f32_16x16x32_bf16 v[96:99], v[152:155], v[192:195], v[96:99]
    ds_read_b64_tr_b16 v[172:173], v232 offset:96
    v_mfma_f32_16x16x32_bf16 v[100:103], v[152:155], v[196:199], v[100:103]
    v_mfma_f32_16x16x32_bf16 v[104:107], v[152:155], v[200:203], v[104:107]
    ds_read_b64_tr_b16 v[174:175], v232 offset:3680
    v_mfma_f32_16x16x32_bf16 v[108:111], v[152:155], v[204:207], v[108:111]
    ds_read_b64_tr_b16 v[188:189], v232 offset:14496
    v_mfma_f32_16x16x32_bf16 v[48:51], v[140:143], v[192:195], v[48:51]
    ds_read_b64_tr_b16 v[190:191], v232 offset:18080
    v_mfma_f32_16x16x32_bf16 v[52:55], v[140:143], v[196:199], v[52:55]
    v_mfma_f32_16x16x32_bf16 v[56:59], v[140:143], v[200:203], v[56:59]
    v_mfma_f32_16x16x32_bf16 v[60:63], v[140:143], v[204:207], v[60:63]
    v_mfma_f32_16x16x32_bf16 v[112:115], v[156:159], v[192:195], v[112:115]
    v_mfma_f32_16x16x32_bf16 v[116:119], v[156:159], v[196:199], v[116:119]
    v_mfma_f32_16x16x32_bf16 v[120:123], v[156:159], v[200:203], v[120:123]
    v_mfma_f32_16x16x32_bf16 v[124:127], v[156:159], v[204:207], v[124:127]
    s_waitcnt lgkmcnt(0)
    s_and_b32 s64, s3, 1
    s_lshl_b32 s64, s64, 9
    s_add_u32 s64, s64, 159744
    v_lshlrev_b32 v253, 3, v252
    v_add_u32 v253, s64, v253
    s_lshl_b32 s64, s28, 6
    s_add_u32 s64, s64, 160896
    v_lshlrev_b32 v254, 4, v251
    v_add_u32 v231, s64, v254
    v_mfma_f32_16x16x32_bf16 v[0:3], v[160:163], v[208:211], v[0:3]
    ds_read_b64 v[192:193], v253 offset:0
    v_mfma_f32_16x16x32_bf16 v[4:7], v[160:163], v[212:215], v[4:7]
    ds_read_b64 v[194:195], v253 offset:128
    v_mfma_f32_16x16x32_bf16 v[8:11], v[160:163], v[216:219], v[8:11]
    ds_read_b64 v[196:197], v253 offset:256
    v_mfma_f32_16x16x32_bf16 v[12:15], v[160:163], v[220:223], v[12:15]
    v_mfma_f32_16x16x32_bf16 v[64:67], v[176:179], v[208:211], v[64:67]
    ds_read_b64 v[198:199], v253 offset:384
    v_mfma_f32_16x16x32_bf16 v[68:71], v[176:179], v[212:215], v[68:71]
    ds_read_b128 v[128:131], v231 offset:0
    v_mfma_f32_16x16x32_bf16 v[72:75], v[176:179], v[216:219], v[72:75]
    v_mfma_f32_16x16x32_bf16 v[76:79], v[176:179], v[220:223], v[76:79]
    ds_read_b128 v[132:135], v231 offset:64
    v_mfma_f32_16x16x32_bf16 v[16:19], v[164:167], v[208:211], v[16:19]
    ds_read_b128 v[136:139], v231 offset:128
    v_mfma_f32_16x16x32_bf16 v[20:23], v[164:167], v[212:215], v[20:23]
    ds_read_b128 v[140:143], v231 offset:192
    v_mfma_f32_16x16x32_bf16 v[24:27], v[164:167], v[216:219], v[24:27]
    v_mfma_f32_16x16x32_bf16 v[28:31], v[164:167], v[220:223], v[28:31]
    ds_read_b128 v[144:147], v231 offset:896
    v_mfma_f32_16x16x32_bf16 v[80:83], v[180:183], v[208:211], v[80:83]
    ds_read_b128 v[148:151], v231 offset:960
    v_mfma_f32_16x16x32_bf16 v[84:87], v[180:183], v[212:215], v[84:87]
    v_mfma_f32_16x16x32_bf16 v[88:91], v[180:183], v[216:219], v[88:91]
    ds_read_b128 v[152:155], v231 offset:1024
    v_mfma_f32_16x16x32_bf16 v[92:95], v[180:183], v[220:223], v[92:95]
    ds_read_b128 v[156:159], v231 offset:1088
    v_mfma_f32_16x16x32_bf16 v[32:35], v[168:171], v[208:211], v[32:35]
    v_mfma_f32_16x16x32_bf16 v[36:39], v[168:171], v[212:215], v[36:39]
    v_mfma_f32_16x16x32_bf16 v[40:43], v[168:171], v[216:219], v[40:43]
    v_mfma_f32_16x16x32_bf16 v[44:47], v[168:171], v[220:223], v[44:47]
    v_mfma_f32_16x16x32_bf16 v[96:99], v[184:187], v[208:211], v[96:99]
    v_mfma_f32_16x16x32_bf16 v[100:103], v[184:187], v[212:215], v[100:103]
    v_mfma_f32_16x16x32_bf16 v[104:107], v[184:187], v[216:219], v[104:107]
    v_mfma_f32_16x16x32_bf16 v[108:111], v[184:187], v[220:223], v[108:111]
    v_mfma_f32_16x16x32_bf16 v[48:51], v[172:175], v[208:211], v[48:51]
    v_mfma_f32_16x16x32_bf16 v[52:55], v[172:175], v[212:215], v[52:55]
    v_mfma_f32_16x16x32_bf16 v[56:59], v[172:175], v[216:219], v[56:59]
    v_mfma_f32_16x16x32_bf16 v[60:63], v[172:175], v[220:223], v[60:63]
    v_mfma_f32_16x16x32_bf16 v[112:115], v[188:191], v[208:211], v[112:115]
    v_mfma_f32_16x16x32_bf16 v[116:119], v[188:191], v[212:215], v[116:119]
    v_mfma_f32_16x16x32_bf16 v[120:123], v[188:191], v[216:219], v[120:123]
    v_mfma_f32_16x16x32_bf16 v[124:127], v[188:191], v[220:223], v[124:127]
    s_and_b32 s64, s3, 1
    s_lshl_b32 s64, s64, 12
    s_add_u32 s25, s25, s64
    s_lshr_b32 s64, s69, 1
    s_lshl_b32 s64, s64, 14
    s_add_u32 s25, s25, s64
    s_add_u32 s26, s25, 8192
    s_waitcnt lgkmcnt(0)
    s_mov_b32 s64, 0xbfb8aa3b
    v_mul_f32 v176, v193, v193
    v_sub_f32 v160, 0, v192
    v_mul_f32 v168, s64, v193
    v_sub_f32 v161, 0, v192
    v_mul_f32 v169, s64, v193
    v_mul_f32 v178, v195, v195
    v_sub_f32 v162, 0, v194
    v_mul_f32 v170, s64, v195
    v_sub_f32 v163, 0, v194
    v_mul_f32 v171, s64, v195
    v_mul_f32 v180, v197, v197
    v_sub_f32 v164, 0, v196
    v_mul_f32 v172, s64, v197
    v_sub_f32 v165, 0, v196
    v_mul_f32 v173, s64, v197
    v_mul_f32 v182, v199, v199
    v_sub_f32 v166, 0, v198
    v_mul_f32 v174, s64, v199
    v_sub_f32 v167, 0, v198
    v_mul_f32 v175, s64, v199
    v_rcp_f32 v177, v176
    v_rcp_f32 v176, v176
    v_rcp_f32 v179, v178
    v_rcp_f32 v178, v178
    v_rcp_f32 v181, v180
    v_rcp_f32 v180, v180
    v_rcp_f32 v183, v182
    v_rcp_f32 v182, v182
    v_pk_fma_f32 v[0:1], v[160:161], v[128:129], v[0:1]
    v_pk_fma_f32 v[2:3], v[160:161], v[130:131], v[2:3]
    v_pk_mul_f32 v[212:213], v[168:169], v[0:1]
    v_pk_mul_f32 v[214:215], v[168:169], v[2:3]
    v_exp_f32 v212, v212
    v_exp_f32 v213, v213
    v_exp_f32 v214, v214
    v_exp_f32 v215, v215
    v_pk_fma_f32 v[64:65], v[160:161], v[144:145], v[64:65]
    v_pk_fma_f32 v[66:67], v[160:161], v[146:147], v[66:67]
    v_pk_fma_f32 v[212:213], v[212:213], v[176:177], v[176:177]
    v_pk_fma_f32 v[214:215], v[214:215], v[176:177], v[176:177]
    v_rcp_f32 v212, v212
    v_rcp_f32 v213, v213
    v_rcp_f32 v214, v214
    v_rcp_f32 v215, v215
    v_pk_mul_f32 v[0:1], v[0:1], v[64:65]
    v_pk_mul_f32 v[2:3], v[2:3], v[66:67]
    v_pk_mul_f32 v[0:1], v[0:1], v[212:213]
    v_pk_mul_f32 v[2:3], v[2:3], v[214:215]
    v_cvt_pk_bf16_f32 v216, v0, v1
    v_cvt_pk_bf16_f32 v217, v2, v3
    v_pk_fma_f32 v[16:17], v[160:161], v[132:133], v[16:17]
    v_pk_fma_f32 v[18:19], v[160:161], v[134:135], v[18:19]
    v_pk_mul_f32 v[212:213], v[168:169], v[16:17]
    v_pk_mul_f32 v[214:215], v[168:169], v[18:19]
    v_exp_f32 v212, v212
    v_exp_f32 v213, v213
    v_exp_f32 v214, v214
    v_exp_f32 v215, v215
    v_pk_fma_f32 v[80:81], v[160:161], v[148:149], v[80:81]
    v_pk_fma_f32 v[82:83], v[160:161], v[150:151], v[82:83]
    v_pk_fma_f32 v[212:213], v[212:213], v[176:177], v[176:177]
    v_pk_fma_f32 v[214:215], v[214:215], v[176:177], v[176:177]
    v_rcp_f32 v212, v212
    v_rcp_f32 v213, v213
    v_rcp_f32 v214, v214
    v_rcp_f32 v215, v215
    v_pk_mul_f32 v[16:17], v[16:17], v[80:81]
    v_pk_mul_f32 v[18:19], v[18:19], v[82:83]
    v_pk_mul_f32 v[16:17], v[16:17], v[212:213]
    v_pk_mul_f32 v[18:19], v[18:19], v[214:215]
    v_cvt_pk_bf16_f32 v218, v16, v17
    v_cvt_pk_bf16_f32 v219, v18, v19
    buffer_store_dwordx4 v[216:219], v249, s[80:83], s25 offen offset:0
    v_pk_fma_f32 v[32:33], v[160:161], v[136:137], v[32:33]
    v_pk_fma_f32 v[34:35], v[160:161], v[138:139], v[34:35]
    v_pk_mul_f32 v[212:213], v[168:169], v[32:33]
    v_pk_mul_f32 v[214:215], v[168:169], v[34:35]
    v_exp_f32 v212, v212
    v_exp_f32 v213, v213
    v_exp_f32 v214, v214
    v_exp_f32 v215, v215
    v_pk_fma_f32 v[96:97], v[160:161], v[152:153], v[96:97]
    v_pk_fma_f32 v[98:99], v[160:161], v[154:155], v[98:99]
    v_pk_fma_f32 v[212:213], v[212:213], v[176:177], v[176:177]
    v_pk_fma_f32 v[214:215], v[214:215], v[176:177], v[176:177]
    v_rcp_f32 v212, v212
    v_rcp_f32 v213, v213
    v_rcp_f32 v214, v214
    v_rcp_f32 v215, v215
    v_pk_mul_f32 v[32:33], v[32:33], v[96:97]
    v_pk_mul_f32 v[34:35], v[34:35], v[98:99]
    v_pk_mul_f32 v[32:33], v[32:33], v[212:213]
    v_pk_mul_f32 v[34:35], v[34:35], v[214:215]
    v_cvt_pk_bf16_f32 v220, v32, v33
    v_cvt_pk_bf16_f32 v221, v34, v35
    v_pk_fma_f32 v[48:49], v[160:161], v[140:141], v[48:49]
    v_pk_fma_f32 v[50:51], v[160:161], v[142:143], v[50:51]
    v_pk_mul_f32 v[212:213], v[168:169], v[48:49]
    v_pk_mul_f32 v[214:215], v[168:169], v[50:51]
    v_exp_f32 v212, v212
    v_exp_f32 v213, v213
    v_exp_f32 v214, v214
    v_exp_f32 v215, v215
    v_pk_fma_f32 v[112:113], v[160:161], v[156:157], v[112:113]
    v_pk_fma_f32 v[114:115], v[160:161], v[158:159], v[114:115]
    v_pk_fma_f32 v[212:213], v[212:213], v[176:177], v[176:177]
    v_pk_fma_f32 v[214:215], v[214:215], v[176:177], v[176:177]
    v_rcp_f32 v212, v212
    v_rcp_f32 v213, v213
    v_rcp_f32 v214, v214
    v_rcp_f32 v215, v215
    v_pk_mul_f32 v[48:49], v[48:49], v[112:113]
    v_pk_mul_f32 v[50:51], v[50:51], v[114:115]
    v_pk_mul_f32 v[48:49], v[48:49], v[212:213]
    v_pk_mul_f32 v[50:51], v[50:51], v[214:215]
    v_cvt_pk_bf16_f32 v222, v48, v49
    v_cvt_pk_bf16_f32 v223, v50, v51
    buffer_store_dwordx4 v[220:223], v249, s[80:83], s26 offen offset:0
    v_pk_fma_f32 v[4:5], v[162:163], v[128:129], v[4:5]
    v_pk_fma_f32 v[6:7], v[162:163], v[130:131], v[6:7]
    v_pk_mul_f32 v[212:213], v[170:171], v[4:5]
    v_pk_mul_f32 v[214:215], v[170:171], v[6:7]
    v_exp_f32 v212, v212
    v_exp_f32 v213, v213
    v_exp_f32 v214, v214
    v_exp_f32 v215, v215
    v_pk_fma_f32 v[68:69], v[162:163], v[144:145], v[68:69]
    v_pk_fma_f32 v[70:71], v[162:163], v[146:147], v[70:71]
    v_pk_fma_f32 v[212:213], v[212:213], v[178:179], v[178:179]
    v_pk_fma_f32 v[214:215], v[214:215], v[178:179], v[178:179]
    v_rcp_f32 v212, v212
    v_rcp_f32 v213, v213
    v_rcp_f32 v214, v214
    v_rcp_f32 v215, v215
    v_pk_mul_f32 v[4:5], v[4:5], v[68:69]
    v_pk_mul_f32 v[6:7], v[6:7], v[70:71]
    v_pk_mul_f32 v[4:5], v[4:5], v[212:213]
    v_pk_mul_f32 v[6:7], v[6:7], v[214:215]
    v_cvt_pk_bf16_f32 v216, v4, v5
    v_cvt_pk_bf16_f32 v217, v6, v7
    v_pk_fma_f32 v[20:21], v[162:163], v[132:133], v[20:21]
    v_pk_fma_f32 v[22:23], v[162:163], v[134:135], v[22:23]
    v_pk_mul_f32 v[212:213], v[170:171], v[20:21]
    v_pk_mul_f32 v[214:215], v[170:171], v[22:23]
    v_exp_f32 v212, v212
    v_exp_f32 v213, v213
    v_exp_f32 v214, v214
    v_exp_f32 v215, v215
    v_pk_fma_f32 v[84:85], v[162:163], v[148:149], v[84:85]
    v_pk_fma_f32 v[86:87], v[162:163], v[150:151], v[86:87]
    v_pk_fma_f32 v[212:213], v[212:213], v[178:179], v[178:179]
    v_pk_fma_f32 v[214:215], v[214:215], v[178:179], v[178:179]
    v_rcp_f32 v212, v212
    v_rcp_f32 v213, v213
    v_rcp_f32 v214, v214
    v_rcp_f32 v215, v215
    v_pk_mul_f32 v[20:21], v[20:21], v[84:85]
    v_pk_mul_f32 v[22:23], v[22:23], v[86:87]
    v_pk_mul_f32 v[20:21], v[20:21], v[212:213]
    v_pk_mul_f32 v[22:23], v[22:23], v[214:215]
    v_cvt_pk_bf16_f32 v218, v20, v21
    v_cvt_pk_bf16_f32 v219, v22, v23
    buffer_store_dwordx4 v[216:219], v249, s[80:83], s25 offen offset:1024
    v_pk_fma_f32 v[36:37], v[162:163], v[136:137], v[36:37]
    v_pk_fma_f32 v[38:39], v[162:163], v[138:139], v[38:39]
    v_pk_mul_f32 v[212:213], v[170:171], v[36:37]
    v_pk_mul_f32 v[214:215], v[170:171], v[38:39]
    v_exp_f32 v212, v212
    v_exp_f32 v213, v213
    v_exp_f32 v214, v214
    v_exp_f32 v215, v215
    v_pk_fma_f32 v[100:101], v[162:163], v[152:153], v[100:101]
    v_pk_fma_f32 v[102:103], v[162:163], v[154:155], v[102:103]
    v_pk_fma_f32 v[212:213], v[212:213], v[178:179], v[178:179]
    v_pk_fma_f32 v[214:215], v[214:215], v[178:179], v[178:179]
    v_rcp_f32 v212, v212
    v_rcp_f32 v213, v213
    v_rcp_f32 v214, v214
    v_rcp_f32 v215, v215
    v_pk_mul_f32 v[36:37], v[36:37], v[100:101]
    v_pk_mul_f32 v[38:39], v[38:39], v[102:103]
    v_pk_mul_f32 v[36:37], v[36:37], v[212:213]
    v_pk_mul_f32 v[38:39], v[38:39], v[214:215]
    v_cvt_pk_bf16_f32 v220, v36, v37
    v_cvt_pk_bf16_f32 v221, v38, v39
    v_pk_fma_f32 v[52:53], v[162:163], v[140:141], v[52:53]
    v_pk_fma_f32 v[54:55], v[162:163], v[142:143], v[54:55]
    v_pk_mul_f32 v[212:213], v[170:171], v[52:53]
    v_pk_mul_f32 v[214:215], v[170:171], v[54:55]
    v_exp_f32 v212, v212
    v_exp_f32 v213, v213
    v_exp_f32 v214, v214
    v_exp_f32 v215, v215
    v_pk_fma_f32 v[116:117], v[162:163], v[156:157], v[116:117]
    v_pk_fma_f32 v[118:119], v[162:163], v[158:159], v[118:119]
    v_pk_fma_f32 v[212:213], v[212:213], v[178:179], v[178:179]
    v_pk_fma_f32 v[214:215], v[214:215], v[178:179], v[178:179]
    v_rcp_f32 v212, v212
    v_rcp_f32 v213, v213
    v_rcp_f32 v214, v214
    v_rcp_f32 v215, v215
    v_pk_mul_f32 v[52:53], v[52:53], v[116:117]
    v_pk_mul_f32 v[54:55], v[54:55], v[118:119]
    v_pk_mul_f32 v[52:53], v[52:53], v[212:213]
    v_pk_mul_f32 v[54:55], v[54:55], v[214:215]
    v_cvt_pk_bf16_f32 v222, v52, v53
    v_cvt_pk_bf16_f32 v223, v54, v55
    buffer_store_dwordx4 v[220:223], v249, s[80:83], s26 offen offset:1024
    v_pk_fma_f32 v[8:9], v[164:165], v[128:129], v[8:9]
    v_pk_fma_f32 v[10:11], v[164:165], v[130:131], v[10:11]
    v_pk_mul_f32 v[212:213], v[172:173], v[8:9]
    v_pk_mul_f32 v[214:215], v[172:173], v[10:11]
    v_exp_f32 v212, v212
    v_exp_f32 v213, v213
    v_exp_f32 v214, v214
    v_exp_f32 v215, v215
    v_pk_fma_f32 v[72:73], v[164:165], v[144:145], v[72:73]
    v_pk_fma_f32 v[74:75], v[164:165], v[146:147], v[74:75]
    v_pk_fma_f32 v[212:213], v[212:213], v[180:181], v[180:181]
    v_pk_fma_f32 v[214:215], v[214:215], v[180:181], v[180:181]
    v_rcp_f32 v212, v212
    v_rcp_f32 v213, v213
    v_rcp_f32 v214, v214
    v_rcp_f32 v215, v215
    v_pk_mul_f32 v[8:9], v[8:9], v[72:73]
    v_pk_mul_f32 v[10:11], v[10:11], v[74:75]
    v_pk_mul_f32 v[8:9], v[8:9], v[212:213]
    v_pk_mul_f32 v[10:11], v[10:11], v[214:215]
    v_cvt_pk_bf16_f32 v216, v8, v9
    v_cvt_pk_bf16_f32 v217, v10, v11
    v_pk_fma_f32 v[24:25], v[164:165], v[132:133], v[24:25]
    v_pk_fma_f32 v[26:27], v[164:165], v[134:135], v[26:27]
    v_pk_mul_f32 v[212:213], v[172:173], v[24:25]
    v_pk_mul_f32 v[214:215], v[172:173], v[26:27]
    v_exp_f32 v212, v212
    v_exp_f32 v213, v213
    v_exp_f32 v214, v214
    v_exp_f32 v215, v215
    v_pk_fma_f32 v[88:89], v[164:165], v[148:149], v[88:89]
    v_pk_fma_f32 v[90:91], v[164:165], v[150:151], v[90:91]
    v_pk_fma_f32 v[212:213], v[212:213], v[180:181], v[180:181]
    v_pk_fma_f32 v[214:215], v[214:215], v[180:181], v[180:181]
    v_rcp_f32 v212, v212
    v_rcp_f32 v213, v213
    v_rcp_f32 v214, v214
    v_rcp_f32 v215, v215
    v_pk_mul_f32 v[24:25], v[24:25], v[88:89]
    v_pk_mul_f32 v[26:27], v[26:27], v[90:91]
    v_pk_mul_f32 v[24:25], v[24:25], v[212:213]
    v_pk_mul_f32 v[26:27], v[26:27], v[214:215]
    v_cvt_pk_bf16_f32 v218, v24, v25
    v_cvt_pk_bf16_f32 v219, v26, v27
    buffer_store_dwordx4 v[216:219], v249, s[80:83], s25 offen offset:2048
    v_pk_fma_f32 v[40:41], v[164:165], v[136:137], v[40:41]
    v_pk_fma_f32 v[42:43], v[164:165], v[138:139], v[42:43]
    v_pk_mul_f32 v[212:213], v[172:173], v[40:41]
    v_pk_mul_f32 v[214:215], v[172:173], v[42:43]
    v_exp_f32 v212, v212
    v_exp_f32 v213, v213
    v_exp_f32 v214, v214
    v_exp_f32 v215, v215
    v_pk_fma_f32 v[104:105], v[164:165], v[152:153], v[104:105]
    v_pk_fma_f32 v[106:107], v[164:165], v[154:155], v[106:107]
    v_pk_fma_f32 v[212:213], v[212:213], v[180:181], v[180:181]
    v_pk_fma_f32 v[214:215], v[214:215], v[180:181], v[180:181]
    v_rcp_f32 v212, v212
    v_rcp_f32 v213, v213
    v_rcp_f32 v214, v214
    v_rcp_f32 v215, v215
    v_pk_mul_f32 v[40:41], v[40:41], v[104:105]
    v_pk_mul_f32 v[42:43], v[42:43], v[106:107]
    v_pk_mul_f32 v[40:41], v[40:41], v[212:213]
    v_pk_mul_f32 v[42:43], v[42:43], v[214:215]
    v_cvt_pk_bf16_f32 v220, v40, v41
    v_cvt_pk_bf16_f32 v221, v42, v43
    v_pk_fma_f32 v[56:57], v[164:165], v[140:141], v[56:57]
    v_pk_fma_f32 v[58:59], v[164:165], v[142:143], v[58:59]
    v_pk_mul_f32 v[212:213], v[172:173], v[56:57]
    v_pk_mul_f32 v[214:215], v[172:173], v[58:59]
    v_exp_f32 v212, v212
    v_exp_f32 v213, v213
    v_exp_f32 v214, v214
    v_exp_f32 v215, v215
    v_pk_fma_f32 v[120:121], v[164:165], v[156:157], v[120:121]
    v_pk_fma_f32 v[122:123], v[164:165], v[158:159], v[122:123]
    v_pk_fma_f32 v[212:213], v[212:213], v[180:181], v[180:181]
    v_pk_fma_f32 v[214:215], v[214:215], v[180:181], v[180:181]
    v_rcp_f32 v212, v212
    v_rcp_f32 v213, v213
    v_rcp_f32 v214, v214
    v_rcp_f32 v215, v215
    v_pk_mul_f32 v[56:57], v[56:57], v[120:121]
    v_pk_mul_f32 v[58:59], v[58:59], v[122:123]
    v_pk_mul_f32 v[56:57], v[56:57], v[212:213]
    v_pk_mul_f32 v[58:59], v[58:59], v[214:215]
    v_cvt_pk_bf16_f32 v222, v56, v57
    v_cvt_pk_bf16_f32 v223, v58, v59
    buffer_store_dwordx4 v[220:223], v249, s[80:83], s26 offen offset:2048
    v_pk_fma_f32 v[12:13], v[166:167], v[128:129], v[12:13]
    v_pk_fma_f32 v[14:15], v[166:167], v[130:131], v[14:15]
    v_pk_mul_f32 v[212:213], v[174:175], v[12:13]
    v_pk_mul_f32 v[214:215], v[174:175], v[14:15]
    v_exp_f32 v212, v212
    v_exp_f32 v213, v213
    v_exp_f32 v214, v214
    v_exp_f32 v215, v215
    v_pk_fma_f32 v[76:77], v[166:167], v[144:145], v[76:77]
    v_pk_fma_f32 v[78:79], v[166:167], v[146:147], v[78:79]
    v_pk_fma_f32 v[212:213], v[212:213], v[182:183], v[182:183]
    v_pk_fma_f32 v[214:215], v[214:215], v[182:183], v[182:183]
    v_rcp_f32 v212, v212
    v_rcp_f32 v213, v213
    v_rcp_f32 v214, v214
    v_rcp_f32 v215, v215
    v_pk_mul_f32 v[12:13], v[12:13], v[76:77]
    v_pk_mul_f32 v[14:15], v[14:15], v[78:79]
    v_pk_mul_f32 v[12:13], v[12:13], v[212:213]
    v_pk_mul_f32 v[14:15], v[14:15], v[214:215]
    v_cvt_pk_bf16_f32 v216, v12, v13
    v_cvt_pk_bf16_f32 v217, v14, v15
    v_pk_fma_f32 v[28:29], v[166:167], v[132:133], v[28:29]
    v_pk_fma_f32 v[30:31], v[166:167], v[134:135], v[30:31]
    v_pk_mul_f32 v[212:213], v[174:175], v[28:29]
    v_pk_mul_f32 v[214:215], v[174:175], v[30:31]
    v_exp_f32 v212, v212
    v_exp_f32 v213, v213
    v_exp_f32 v214, v214
    v_exp_f32 v215, v215
    v_pk_fma_f32 v[92:93], v[166:167], v[148:149], v[92:93]
    v_pk_fma_f32 v[94:95], v[166:167], v[150:151], v[94:95]
    v_pk_fma_f32 v[212:213], v[212:213], v[182:183], v[182:183]
    v_pk_fma_f32 v[214:215], v[214:215], v[182:183], v[182:183]
    v_rcp_f32 v212, v212
    v_rcp_f32 v213, v213
    v_rcp_f32 v214, v214
    v_rcp_f32 v215, v215
    v_pk_mul_f32 v[28:29], v[28:29], v[92:93]
    v_pk_mul_f32 v[30:31], v[30:31], v[94:95]
    v_pk_mul_f32 v[28:29], v[28:29], v[212:213]
    v_pk_mul_f32 v[30:31], v[30:31], v[214:215]
    v_cvt_pk_bf16_f32 v218, v28, v29
    v_cvt_pk_bf16_f32 v219, v30, v31
    buffer_store_dwordx4 v[216:219], v249, s[80:83], s25 offen offset:3072
    v_pk_fma_f32 v[44:45], v[166:167], v[136:137], v[44:45]
    v_pk_fma_f32 v[46:47], v[166:167], v[138:139], v[46:47]
    v_pk_mul_f32 v[212:213], v[174:175], v[44:45]
    v_pk_mul_f32 v[214:215], v[174:175], v[46:47]
    v_exp_f32 v212, v212
    v_exp_f32 v213, v213
    v_exp_f32 v214, v214
    v_exp_f32 v215, v215
    v_pk_fma_f32 v[108:109], v[166:167], v[152:153], v[108:109]
    v_pk_fma_f32 v[110:111], v[166:167], v[154:155], v[110:111]
    v_pk_fma_f32 v[212:213], v[212:213], v[182:183], v[182:183]
    v_pk_fma_f32 v[214:215], v[214:215], v[182:183], v[182:183]
    v_rcp_f32 v212, v212
    v_rcp_f32 v213, v213
    v_rcp_f32 v214, v214
    v_rcp_f32 v215, v215
    v_pk_mul_f32 v[44:45], v[44:45], v[108:109]
    v_pk_mul_f32 v[46:47], v[46:47], v[110:111]
    v_pk_mul_f32 v[44:45], v[44:45], v[212:213]
    v_pk_mul_f32 v[46:47], v[46:47], v[214:215]
    v_cvt_pk_bf16_f32 v220, v44, v45
    v_cvt_pk_bf16_f32 v221, v46, v47
    v_pk_fma_f32 v[60:61], v[166:167], v[140:141], v[60:61]
    v_pk_fma_f32 v[62:63], v[166:167], v[142:143], v[62:63]
    v_pk_mul_f32 v[212:213], v[174:175], v[60:61]
    v_pk_mul_f32 v[214:215], v[174:175], v[62:63]
    v_exp_f32 v212, v212
    v_exp_f32 v213, v213
    v_exp_f32 v214, v214
    v_exp_f32 v215, v215
    v_pk_fma_f32 v[124:125], v[166:167], v[156:157], v[124:125]
    v_pk_fma_f32 v[126:127], v[166:167], v[158:159], v[126:127]
    v_pk_fma_f32 v[212:213], v[212:213], v[182:183], v[182:183]
    v_pk_fma_f32 v[214:215], v[214:215], v[182:183], v[182:183]
    v_rcp_f32 v212, v212
    v_rcp_f32 v213, v213
    v_rcp_f32 v214, v214
    v_rcp_f32 v215, v215
    v_pk_mul_f32 v[60:61], v[60:61], v[124:125]
    v_pk_mul_f32 v[62:63], v[62:63], v[126:127]
    v_pk_mul_f32 v[60:61], v[60:61], v[212:213]
    v_pk_mul_f32 v[62:63], v[62:63], v[214:215]
    v_cvt_pk_bf16_f32 v222, v60, v61
    v_cvt_pk_bf16_f32 v223, v62, v63
    buffer_store_dwordx4 v[220:223], v249, s[80:83], s26 offen offset:3072
    s_lshl_b32 s64, s75, 15
    s_lshl_b32 s66, s73, 9
    s_add_u32 s64, s64, s66
    s_add_u32 s64, s64, 75513856
    s_lshl_b32 s65, s72, 5
    s_add_u32 s64, s64, s65
    s_lshl_b32 s65, s3, 2
    s_add_u32 s64, s64, s65
    v_mov_b32 v192, 0
    v_mov_b32 v193, 1
    s_cmp_lg_u32 s78, 0
    s_cbranch_scc1 sg_9_slow
    s_waitcnt vmcnt(0)
    s_mov_b64 exec, 1
    buffer_store_dword v193, v192, s[80:83], s64 offen
    s_mov_b64 exec, -1
sg_9_done:
    s_lshr_b32 s64, s3, 1
    s_lshl_b32 s64, s64, 12
    s_add_u32 s64, s64, 49152
    v_add_u32 v240, s64, v249
    v_lshrrev_b32 v253, 2, v252
    v_and_b32 v254, 1, v251
    v_lshl_add_u32 v253, v254, 2, v253
    v_mul_u32_u24 v253, 1056, v253
    v_lshrrev_b32 v254, 1, v251
    v_lshl_add_u32 v253, v254, 8, v253
    v_and_b32 v254, 3, v252
    v_lshl_add_u32 v253, v254, 3, v253
    s_and_b32 s64, s3, 1
    s_lshl_b32 s64, s64, 6
    s_add_u32 s64, s64, 65536
    v_add_u32 v241, s64, v253
    s_mov_b32 s16, 33792
    v_add_u32 v242, s16, v241
    s_and_b32 s64, s3, 1
    s_lshl_b32 s64, s64, 13
    s_lshr_b32 s65, s3, 1
    s_lshl_b32 s65, s65, 12
    s_add_u32 s17, s64, s65
    s_lshl_b32 s19, s73, 4
    s_add_u32 s19, s19, s68
    s_lshl_b32 s19, s19, 14
    s_mul_i32 s66, s59, 4194304
    s_add_u32 s19, s19, s66
    s_add_u32 s19, s19, s17
    s_lshl_b32 s18, s73, 4
    s_add_u32 s18, s18, s68
    s_lshl_b32 s18, s18, 14
    s_mul_i32 s66, s60, 8388608
    s_add_u32 s18, s18, s66
    s_add_u32 s18, s18, s17
    buffer_load_dwordx4 v[128:131], v249, s[80:83], s18 offen offset:0 sc1
    buffer_load_dwordx4 v[132:135], v249, s[80:83], s18 offen offset:1024 sc1
    buffer_load_dwordx4 v[136:139], v249, s[80:83], s18 offen offset:2048 sc1
    buffer_load_dwordx4 v[140:143], v249, s[80:83], s18 offen offset:3072 sc1
    v_mov_b32 v208, 0
    v_mov_b32 v209, 0
    v_mov_b32 v210, 0
    v_mov_b32 v211, 0
    s_nop 1
    v_mfma_f32_32x32x16_bf16 v[0:15], v[208:211], v[208:211], 0
    v_mfma_f32_32x32x16_bf16 v[16:31], v[208:211], v[208:211], 0
    v_mfma_f32_32x32x16_bf16 v[32:47], v[208:211], v[208:211], 0
    v_mfma_f32_32x32x16_bf16 v[48:63], v[208:211], v[208:211], 0
    s_mov_b32 s17, 14
    s_mov_b64 vcc, 0
    s_barrier
    ds_read_b128 v[64:67], v240 offset:8192
    ds_read_b64_tr_b16 v[80:81], v242 offset:8448
    ds_read_b64_tr_b16 v[82:83], v242 offset:8960
    ds_read_b128 v[68:71], v240 offset:9216
    ds_read_b64_tr_b16 v[84:85], v242 offset:8480
    ds_read_b64_tr_b16 v[86:87], v242 offset:8992
    ds_read_b128 v[72:75], v240 offset:10240
    ds_read_b64_tr_b16 v[88:89], v242 offset:8576
    ds_read_b64_tr_b16 v[90:91], v242 offset:9088
    ds_read_b128 v[76:79], v240 offset:11264
    ds_read_b64_tr_b16 v[92:93], v242 offset:8608
    ds_read_b64_tr_b16 v[94:95], v242 offset:9120
    v_add_u16 v240, 0x4000, v240
    s_add_u32 s16, s16, 16896
    s_cmp_eq_u32 s16, 84480
    s_cselect_b32 s16, 0, s16
    v_add_u32 v242, s16, v241
    s_waitcnt lgkmcnt(0)
r3_loop:
    s_barrier
r3_nb0:
    v_mfma_f32_16x16x32_bf16 v[32:35], v[88:91], v[64:67], v[32:35]
    ds_read_b128 v[96:99], v240 offset:0
    ds_read_b64_tr_b16 v[112:113], v242 offset:0
    v_mfma_f32_16x16x32_bf16 v[36:39], v[88:91], v[68:71], v[36:39]
    ds_read_b64_tr_b16 v[114:115], v242 offset:512
    v_mfma_f32_16x16x32_bf16 v[40:43], v[88:91], v[72:75], v[40:43]
    ds_read_b128 v[100:103], v240 offset:1024
    v_mfma_f32_16x16x32_bf16 v[44:47], v[88:91], v[76:79], v[44:47]
    ds_read_b64_tr_b16 v[116:117], v242 offset:32
    v_mfma_f32_16x16x32_bf16 v[48:51], v[92:95], v[64:67], v[48:51]
    ds_read_b64_tr_b16 v[118:119], v242 offset:544
    v_mfma_f32_16x16x32_bf16 v[52:55], v[92:95], v[68:71], v[52:55]
    ds_read_b128 v[104:107], v240 offset:2048
    ds_read_b64_tr_b16 v[120:121], v242 offset:128
    v_mfma_f32_16x16x32_bf16 v[56:59], v[92:95], v[72:75], v[56:59]
    ds_read_b64_tr_b16 v[122:123], v242 offset:640
    v_mfma_f32_16x16x32_bf16 v[60:63], v[92:95], v[76:79], v[60:63]
    ds_read_b128 v[108:111], v240 offset:3072
    v_mfma_f32_16x16x32_bf16 v[0:3], v[80:83], v[64:67], v[0:3]
    ds_read_b64_tr_b16 v[124:125], v242 offset:160
    v_mfma_f32_16x16x32_bf16 v[4:7], v[80:83], v[68:71], v[4:7]
    ds_read_b64_tr_b16 v[126:127], v242 offset:672
    v_mfma_f32_16x16x32_bf16 v[8:11], v[80:83], v[72:75], v[8:11]
    v_mfma_f32_16x16x32_bf16 v[12:15], v[80:83], v[76:79], v[12:15]
    v_mfma_f32_16x16x32_bf16 v[16:19], v[84:87], v[64:67], v[16:19]
    v_mfma_f32_16x16x32_bf16 v[20:23], v[84:87], v[68:71], v[20:23]
    v_mfma_f32_16x16x32_bf16 v[24:27], v[84:87], v[72:75], v[24:27]
    v_mfma_f32_16x16x32_bf16 v[28:31], v[84:87], v[76:79], v[28:31]
    s_waitcnt lgkmcnt(0)
    v_mfma_f32_16x16x32_bf16 v[32:35], v[120:123], v[96:99], v[32:35]
    ds_read_b128 v[64:67], v240 offset:8192
    ds_read_b64_tr_b16 v[80:81], v242 offset:8448
    v_mfma_f32_16x16x32_bf16 v[36:39], v[120:123], v[100:103], v[36:39]
    ds_read_b64_tr_b16 v[82:83], v242 offset:8960
    v_mfma_f32_16x16x32_bf16 v[40:43], v[120:123], v[104:107], v[40:43]
    ds_read_b128 v[68:71], v240 offset:9216
    v_mfma_f32_16x16x32_bf16 v[44:47], v[120:123], v[108:111], v[44:47]
    ds_read_b64_tr_b16 v[84:85], v242 offset:8480
    v_mfma_f32_16x16x32_bf16 v[48:51], v[124:127], v[96:99], v[48:51]
    ds_read_b64_tr_b16 v[86:87], v242 offset:8992
    v_mfma_f32_16x16x32_bf16 v[52:55], v[124:127], v[100:103], v[52:55]
    ds_read_b128 v[72:75], v240 offset:10240
    ds_read_b64_tr_b16 v[88:89], v242 offset:8576
    v_mfma_f32_16x16x32_bf16 v[56:59], v[124:127], v[104:107], v[56:59]
    ds_read_b64_tr_b16 v[90:91], v242 offset:9088
    v_mfma_f32_16x16x32_bf16 v[60:63], v[124:127], v[108:111], v[60:63]
    ds_read_b128 v[76:79], v240 offset:11264
    v_mfma_f32_16x16x32_bf16 v[0:3], v[112:115], v[96:99], v[0:3]
    ds_read_b64_tr_b16 v[92:93], v242 offset:8608
    v_mfma_f32_16x16x32_bf16 v[4:7], v[112:115], v[100:103], v[4:7]
    ds_read_b64_tr_b16 v[94:95], v242 offset:9120
    v_mfma_f32_16x16x32_bf16 v[8:11], v[112:115], v[104:107], v[8:11]
    v_add_u16 v240, 0x4000, v240
    v_mfma_f32_16x16x32_bf16 v[12:15], v[112:115], v[108:111], v[12:15]
    s_add_u32 s16, s16, 16896
    s_cmp_eq_u32 s16, 84480
    v_mfma_f32_16x16x32_bf16 v[16:19], v[116:119], v[96:99], v[16:19]
    s_cselect_b32 s16, 0, s16
    v_mfma_f32_16x16x32_bf16 v[20:23], v[116:119], v[100:103], v[20:23]
    v_add_u32 v242, s16, v241
    v_mfma_f32_16x16x32_bf16 v[24:27], v[116:119], v[104:107], v[24:27]
    v_mfma_f32_16x16x32_bf16 v[28:31], v[116:119], v[108:111], v[28:31]
    s_waitcnt lgkmcnt(0)
    s_cbranch_vccnz r3_nb1
    s_barrier
r3_nb1:
    v_mfma_f32_16x16x32_bf16 v[32:35], v[88:91], v[64:67], v[32:35]
    ds_read_b128 v[96:99], v240 offset:0
    ds_read_b64_tr_b16 v[112:113], v242 offset:0
    v_mfma_f32_16x16x32_bf16 v[36:39], v[88:91], v[68:71], v[36:39]
    ds_read_b64_tr_b16 v[114:115], v242 offset:512
    v_mfma_f32_16x16x32_bf16 v[40:43], v[88:91], v[72:75], v[40:43]
    ds_read_b128 v[100:103], v240 offset:1024
    v_mfma_f32_16x16x32_bf16 v[44:47], v[88:91], v[76:79], v[44:47]
    ds_read_b64_tr_b16 v[116:117], v242 offset:32
    v_mfma_f32_16x16x32_bf16 v[48:51], v[92:95], v[64:67], v[48:51]
    ds_read_b64_tr_b16 v[118:119], v242 offset:544
    v_mfma_f32_16x16x32_bf16 v[52:55], v[92:95], v[68:71], v[52:55]
    ds_read_b128 v[104:107], v240 offset:2048
    ds_read_b64_tr_b16 v[120:121], v242 offset:128
    v_mfma_f32_16x16x32_bf16 v[56:59], v[92:95], v[72:75], v[56:59]
    ds_read_b64_tr_b16 v[122:123], v242 offset:640
    v_mfma_f32_16x16x32_bf16 v[60:63], v[92:95], v[76:79], v[60:63]
    ds_read_b128 v[108:111], v240 offset:3072
    v_mfma_f32_16x16x32_bf16 v[0:3], v[80:83], v[64:67], v[0:3]
    ds_read_b64_tr_b16 v[124:125], v242 offset:160
    v_mfma_f32_16x16x32_bf16 v[4:7], v[80:83], v[68:71], v[4:7]
    ds_read_b64_tr_b16 v[126:127], v242 offset:672
    v_mfma_f32_16x16x32_bf16 v[8:11], v[80:83], v[72:75], v[8:11]
    v_mfma_f32_16x16x32_bf16 v[12:15], v[80:83], v[76:79], v[12:15]
    v_mfma_f32_16x16x32_bf16 v[16:19], v[84:87], v[64:67], v[16:19]
    v_mfma_f32_16x16x32_bf16 v[20:23], v[84:87], v[68:71], v[20:23]
    v_mfma_f32_16x16x32_bf16 v[24:27], v[84:87], v[72:75], v[24:27]
    v_mfma_f32_16x16x32_bf16 v[28:31], v[84:87], v[76:79], v[28:31]
    s_waitcnt lgkmcnt(0)
    v_mfma_f32_16x16x32_bf16 v[32:35], v[120:123], v[96:99], v[32:35]
    ds_read_b128 v[64:67], v240 offset:8192
    ds_read_b64_tr_b16 v[80:81], v242 offset:8448
    v_mfma_f32_16x16x32_bf16 v[36:39], v[120:123], v[100:103], v[36:39]
    ds_read_b64_tr_b16 v[82:83], v242 offset:8960
    v_mfma_f32_16x16x32_bf16 v[40:43], v[120:123], v[104:107], v[40:43]
    ds_read_b128 v[68:71], v240 offset:9216
    v_mfma_f32_16x16x32_bf16 v[44:47], v[120:123], v[108:111], v[44:47]
    ds_read_b64_tr_b16 v[84:85], v242 offset:8480
    v_mfma_f32_16x16x32_bf16 v[48:51], v[124:127], v[96:99], v[48:51]
    ds_read_b64_tr_b16 v[86:87], v242 offset:8992
    v_mfma_f32_16x16x32_bf16 v[52:55], v[124:127], v[100:103], v[52:55]
    ds_read_b128 v[72:75], v240 offset:10240
    ds_read_b64_tr_b16 v[88:89], v242 offset:8576
    v_mfma_f32_16x16x32_bf16 v[56:59], v[124:127], v[104:107], v[56:59]
    ds_read_b64_tr_b16 v[90:91], v242 offset:9088
    v_mfma_f32_16x16x32_bf16 v[60:63], v[124:127], v[108:111], v[60:63]
    ds_read_b128 v[76:79], v240 offset:11264
    v_mfma_f32_16x16x32_bf16 v[0:3], v[112:115], v[96:99], v[0:3]
    ds_read_b64_tr_b16 v[92:93], v242 offset:8608
    v_mfma_f32_16x16x32_bf16 v[4:7], v[112:115], v[100:103], v[4:7]
    ds_read_b64_tr_b16 v[94:95], v242 offset:9120
    v_mfma_f32_16x16x32_bf16 v[8:11], v[112:115], v[104:107], v[8:11]
    v_add_u16 v240, 0x4000, v240
    v_mfma_f32_16x16x32_bf16 v[12:15], v[112:115], v[108:111], v[12:15]
    s_add_u32 s16, s16, 16896
    s_cmp_eq_u32 s16, 84480
    v_mfma_f32_16x16x32_bf16 v[16:19], v[116:119], v[96:99], v[16:19]
    s_cselect_b32 s16, 0, s16
    v_mfma_f32_16x16x32_bf16 v[20:23], v[116:119], v[100:103], v[20:23]
    v_add_u32 v242, s16, v241
    v_mfma_f32_16x16x32_bf16 v[24:27], v[116:119], v[104:107], v[24:27]
    s_cmp_eq_u32 s17, 2
    s_cselect_b64 vcc, -1, 0
    s_sub_u32 s17, s17, 1
    s_cmp_lg_u32 s17, 0
    v_mfma_f32_16x16x32_bf16 v[28:31], v[116:119], v[108:111], v[28:31]
    s_waitcnt lgkmcnt(0)
    s_cbranch_scc1 r3_loop
    s_lshl_b32 s20, s73, 4
    s_add_u32 s20, s20, s74
    s_lshl_b32 s20, s20, 2
    s_add_u32 s20, s20, s3
    s_lshl_b32 s20, s20, 13
    s_lshl_b32 s66, s60, 23
    s_add_u32 s20, s20, s66
    s_add_u32 s20, s20, 54525952
    s_add_u32 s65, s20, 4096
    buffer_store_dwordx4 v[32:35], v249, s[80:83], s20 offen offset:0
    buffer_store_dwordx4 v[36:39], v249, s[80:83], s20 offen offset:1024
    buffer_store_dwordx4 v[40:43], v249, s[80:83], s20 offen offset:2048
    buffer_store_dwordx4 v[44:47], v249, s[80:83], s20 offen offset:3072
    buffer_store_dwordx4 v[48:51], v249, s[80:83], s65 offen offset:0
    buffer_store_dwordx4 v[52:55], v249, s[80:83], s65 offen offset:1024
    buffer_store_dwordx4 v[56:59], v249, s[80:83], s65 offen offset:2048
    buffer_store_dwordx4 v[60:63], v249, s[80:83], s65 offen offset:3072
    s_lshl_b32 s21, s75, 4
    s_add_u32 s21, s21, s73
    s_lshl_b32 s21, s21, 4
    s_add_u32 s21, s21, s74
    s_lshl_b32 s21, s21, 2
    s_add_u32 s21, s21, s3
    s_lshl_b32 s21, s21, 2
    s_add_u32 s21, s21, 75563008
    s_waitcnt vmcnt(8)
    v_lshlrev_b32 v144, 16, v128
    v_and_b32 v145, 0xffff0000, v128
    v_lshlrev_b32 v146, 16, v129
    v_and_b32 v147, 0xffff0000, v129
    v_lshlrev_b32 v148, 16, v130
    v_and_b32 v149, 0xffff0000, v130
    v_lshlrev_b32 v150, 16, v131
    v_and_b32 v151, 0xffff0000, v131
    v_lshlrev_b32 v152, 16, v132
    v_and_b32 v153, 0xffff0000, v132
    v_lshlrev_b32 v154, 16, v133
    v_and_b32 v155, 0xffff0000, v133
    v_lshlrev_b32 v156, 16, v134
    v_and_b32 v157, 0xffff0000, v134
    v_lshlrev_b32 v158, 16, v135
    v_and_b32 v159, 0xffff0000, v135
    v_lshlrev_b32 v160, 16, v136
    v_and_b32 v161, 0xffff0000, v136
    v_lshlrev_b32 v162, 16, v137
    v_and_b32 v163, 0xffff0000, v137
    v_lshlrev_b32 v164, 16, v138
    v_and_b32 v165, 0xffff0000, v138
    v_lshlrev_b32 v166, 16, v139
    v_and_b32 v167, 0xffff0000, v139
    v_lshlrev_b32 v168, 16, v140
    v_and_b32 v169, 0xffff0000, v140
    v_lshlrev_b32 v170, 16, v141
    v_and_b32 v171, 0xffff0000, v141
    v_lshlrev_b32 v172, 16, v142
    v_and_b32 v173, 0xffff0000, v142
    v_lshlrev_b32 v174, 16, v143
    v_and_b32 v175, 0xffff0000, v143
    v_mov_b32 v208, 0
    v_mov_b32 v209, 1
    s_cmp_lg_u32 s78, 0
    s_cbranch_scc1 sg_10_slow
    s_waitcnt vmcnt(0)
    s_mov_b64 exec, 1
    buffer_store_dword v209, v208, s[80:83], s21 offen
    s_mov_b64 exec, -1
sg_10_done:
    s_xor_b32 s21, s21, 128
    s_xor_b32 s20, s20, 262144
    s_mov_b64 exec, 1
pl_11:
    buffer_load_dword v210, v208, s[80:83], s21 offen sc1
    s_sub_u32 s79, s79, 1
    s_cbranch_scc1 L_abort
    s_waitcnt vmcnt(0)
    v_cmp_ne_u32 vcc, 1, v210
    s_cbranch_vccnz pl_11
    s_mov_b64 exec, -1
    s_cmp_lg_u32 s78, 0
    s_cbranch_scc1 pl_11_acq
pl_11_ok:
    s_add_u32 s65, s20, 4096
    buffer_load_dwordx4 v[176:179], v249, s[80:83], s20 offen offset:0 sc1
    buffer_load_dwordx4 v[180:183], v249, s[80:83], s20 offen offset:1024 sc1
    buffer_load_dwordx4 v[184:187], v249, s[80:83], s20 offen offset:2048 sc1
    buffer_load_dwordx4 v[188:191], v249, s[80:83], s20 offen offset:3072 sc1
    buffer_load_dwordx4 v[192:195], v249, s[80:83], s65 offen offset:0 sc1
    buffer_load_dwordx4 v[196:199], v249, s[80:83], s65 offen offset:1024 sc1
    buffer_load_dwordx4 v[200:203], v249, s[80:83], s65 offen offset:2048 sc1
    buffer_load_dwordx4 v[204:207], v249, s[80:83], s65 offen offset:3072 sc1
    v_mov_b32 v88, 0x3f803f80
    s_cmp_lg_u32 s75, 0
    s_cbranch_scc1 fo_12_out
    s_waitcnt vmcnt(3)
    v_pk_add_f32 v[0:1], v[0:1], v[176:177]
    v_pk_add_f32 v[2:3], v[2:3], v[178:179]
    v_pk_add_f32 v[16:17], v[16:17], v[192:193]
    v_pk_add_f32 v[18:19], v[18:19], v[194:195]
    v_cvt_pk_bf16_f32 v208, v0, v1
    v_cvt_pk_bf16_f32 v209, v2, v3
    v_cvt_pk_bf16_f32 v210, v16, v17
    v_cvt_pk_bf16_f32 v211, v18, v19
    v_lshlrev_b32 v212, 16, v208
    v_and_b32 v213, 0xffff0000, v208
    v_lshlrev_b32 v214, 16, v209
    v_and_b32 v215, 0xffff0000, v209
    v_lshlrev_b32 v216, 16, v210
    v_and_b32 v217, 0xffff0000, v210
    v_lshlrev_b32 v218, 16, v211
    v_and_b32 v219, 0xffff0000, v211
    v_pk_add_f32 v[212:213], v[212:213], v[144:145]
    v_pk_add_f32 v[214:215], v[214:215], v[146:147]
    v_pk_add_f32 v[216:217], v[216:217], v[148:149]
    v_pk_add_f32 v[218:219], v[218:219], v[150:151]
    v_cvt_pk_bf16_f32 v64, v212, v213
    v_cvt_pk_bf16_f32 v65, v214, v215
    v_cvt_pk_bf16_f32 v66, v216, v217
    v_cvt_pk_bf16_f32 v67, v218, v219
    buffer_store_dwordx4 v[64:67], v249, s[80:83], s19 offen offset:0
    s_waitcnt vmcnt(3)
    v_pk_add_f32 v[4:5], v[4:5], v[180:181]
    v_pk_add_f32 v[6:7], v[6:7], v[182:183]
    v_pk_add_f32 v[20:21], v[20:21], v[196:197]
    v_pk_add_f32 v[22:23], v[22:23], v[198:199]
    v_cvt_pk_bf16_f32 v208, v4, v5
    v_cvt_pk_bf16_f32 v209, v6, v7
    v_cvt_pk_bf16_f32 v210, v20, v21
    v_cvt_pk_bf16_f32 v211, v22, v23
    v_lshlrev_b32 v212, 16, v208
    v_and_b32 v213, 0xffff0000, v208
    v_lshlrev_b32 v214, 16, v209
    v_and_b32 v215, 0xffff0000, v209
    v_lshlrev_b32 v216, 16, v210
    v_and_b32 v217, 0xffff0000, v210
    v_lshlrev_b32 v218, 16, v211
    v_and_b32 v219, 0xffff0000, v211
    v_pk_add_f32 v[212:213], v[212:213], v[152:153]
    v_pk_add_f32 v[214:215], v[214:215], v[154:155]
    v_pk_add_f32 v[216:217], v[216:217], v[156:157]
    v_pk_add_f32 v[218:219], v[218:219], v[158:159]
    v_cvt_pk_bf16_f32 v68, v212, v213
    v_cvt_pk_bf16_f32 v69, v214, v215
    v_cvt_pk_bf16_f32 v70, v216, v217
    v_cvt_pk_bf16_f32 v71, v218, v219
    buffer_store_dwordx4 v[68:71], v249, s[80:83], s19 offen offset:1024
    s_waitcnt vmcnt(3)
    v_pk_add_f32 v[8:9], v[8:9], v[184:185]
    v_pk_add_f32 v[10:11], v[10:11], v[186:187]
    v_pk_add_f32 v[24:25], v[24:25], v[200:201]
    v_pk_add_f32 v[26:27], v[26:27], v[202:203]
    v_cvt_pk_bf16_f32 v208, v8, v9
    v_cvt_pk_bf16_f32 v209, v10, v11
    v_cvt_pk_bf16_f32 v210, v24, v25
    v_cvt_pk_bf16_f32 v211, v26, v27
    v_lshlrev_b32 v212, 16, v208
    v_and_b32 v213, 0xffff0000, v208
    v_lshlrev_b32 v214, 16, v209
    v_and_b32 v215, 0xffff0000, v209
    v_lshlrev_b32 v216, 16, v210
    v_and_b32 v217, 0xffff0000, v210
    v_lshlrev_b32 v218, 16, v211
    v_and_b32 v219, 0xffff0000, v211
    v_pk_add_f32 v[212:213], v[212:213], v[160:161]
    v_pk_add_f32 v[214:215], v[214:215], v[162:163]
    v_pk_add_f32 v[216:217], v[216:217], v[164:165]
    v_pk_add_f32 v[218:219], v[218:219], v[166:167]
    v_cvt_pk_bf16_f32 v72, v212, v213
    v_cvt_pk_bf16_f32 v73, v214, v215
    v_cvt_pk_bf16_f32 v74, v216, v217
    v_cvt_pk_bf16_f32 v75, v218, v219
    buffer_store_dwordx4 v[72:75], v249, s[80:83], s19 offen offset:2048
    s_waitcnt vmcnt(3)
    v_pk_add_f32 v[12:13], v[12:13], v[188:189]
    v_pk_add_f32 v[14:15], v[14:15], v[190:191]
    v_pk_add_f32 v[28:29], v[28:29], v[204:205]
    v_pk_add_f32 v[30:31], v[30:31], v[206:207]
    v_cvt_pk_bf16_f32 v208, v12, v13
    v_cvt_pk_bf16_f32 v209, v14, v15
    v_cvt_pk_bf16_f32 v210, v28, v29
    v_cvt_pk_bf16_f32 v211, v30, v31
    v_lshlrev_b32 v212, 16, v208
    v_and_b32 v213, 0xffff0000, v208
    v_lshlrev_b32 v214, 16, v209
    v_and_b32 v215, 0xffff0000, v209
    v_lshlrev_b32 v216, 16, v210
    v_and_b32 v217, 0xffff0000, v210
    v_lshlrev_b32 v218, 16, v211
    v_and_b32 v219, 0xffff0000, v211
    v_pk_add_f32 v[212:213], v[212:213], v[168:169]
    v_pk_add_f32 v[214:215], v[214:215], v[170:171]
    v_pk_add_f32 v[216:217], v[216:217], v[172:173]
    v_pk_add_f32 v[218:219], v[218:219], v[174:175]
    v_cvt_pk_bf16_f32 v76, v212, v213
    v_cvt_pk_bf16_f32 v77, v214, v215
    v_cvt_pk_bf16_f32 v78, v216, v217
    v_cvt_pk_bf16_f32 v79, v218, v219
    buffer_store_dwordx4 v[76:79], v249, s[80:83], s19 offen offset:3072
    v_dot2_f32_bf16 v80, v64, v88, 0
    v_dot2_f32_bf16 v84, v64, v64, 0
    v_dot2_f32_bf16 v80, v65, v88, v80
    v_dot2_f32_bf16 v84, v65, v65, v84
    v_dot2_f32_bf16 v80, v66, v88, v80
    v_dot2_f32_bf16 v84, v66, v66, v84
    v_dot2_f32_bf16 v80, v67, v88, v80
    v_dot2_f32_bf16 v84, v67, v67, v84
    v_dot2_f32_bf16 v81, v68, v88, 0
    v_dot2_f32_bf16 v85, v68, v68, 0
    v_dot2_f32_bf16 v81, v69, v88, v81
    v_dot2_f32_bf16 v85, v69, v69, v85
    v_dot2_f32_bf16 v81, v70, v88, v81
    v_dot2_f32_bf16 v85, v70, v70, v85
    v_dot2_f32_bf16 v81, v71, v88, v81
    v_dot2_f32_bf16 v85, v71, v71, v85
    v_dot2_f32_bf16 v82, v72, v88, 0
    v_dot2_f32_bf16 v86, v72, v72, 0
    v_dot2_f32_bf16 v82, v73, v88, v82
    v_dot2_f32_bf16 v86, v73, v73, v86
    v_dot2_f32_bf16 v82, v74, v88, v82
    v_dot2_f32_bf16 v86, v74, v74, v86
    v_dot2_f32_bf16 v82, v75, v88, v82
    v_dot2_f32_bf16 v86, v75, v75, v86
    v_dot2_f32_bf16 v83, v76, v88, 0
    v_dot2_f32_bf16 v87, v76, v76, 0
    v_dot2_f32_bf16 v83, v77, v88, v83
    v_dot2_f32_bf16 v87, v77, v77, v87
    v_dot2_f32_bf16 v83, v78, v88, v83
    v_dot2_f32_bf16 v87, v78, v78, v87
    v_dot2_f32_bf16 v83, v79, v88, v83
    v_dot2_f32_bf16 v87, v79, v79, v87
    s_lshl_b32 s64, s73, 4
    s_add_u32 s64, s64, s68
    s_lshl_b32 s18, s64, 8
    s_lshl_b32 s64, s64, 11
    s_add_u32 s64, s64, 71827456
    s_lshr_b32 s65, s3, 1
    s_lshl_b32 s65, s65, 10
    s_add_u32 s64, s64, s65
    s_and_b32 s65, s3, 1
    s_lshl_b32 s65, s65, 3
    s_add_u32 s64, s64, s65
    s_add_u32 s18, s18, s65
    v_permlane16_swap_b32 v80, v81
    v_permlane16_swap_b32 v82, v83
    v_permlane16_swap_b32 v84, v85
    v_permlane16_swap_b32 v86, v87
    v_add_f32 v80, v80, v81
    v_add_f32 v82, v82, v83
    v_add_f32 v84, v84, v85
    v_add_f32 v86, v86, v87
    s_nop 1
    v_permlane32_swap_b32 v80, v82
    v_permlane32_swap_b32 v84, v86
    v_add_f32 v80, v80, v82
    v_add_f32 v81, v84, v86
    buffer_store_dwordx2 v[80:81], v249, s[80:83], s64 offen
    s_cmp_lt_u32 s3, 2
    s_cbranch_scc1 hl_13_no
    v_cmp_eq_u32 vcc, 0, v252
    s_lshl_b32 s64, s73, 4
    s_add_u32 s64, s64, s68
    s_lshl_b32 s64, s64, 1
    s_and_b32 s65, s3, 1
    s_add_u32 s64, s64, s65
    s_lshl_b32 s64, s64, 10
    s_add_u32 s64, s64, 73400320
    v_cndmask_b32 v212, v76, v88, vcc
    v_cndmask_b32 v213, v77, v88, vcc
    v_cndmask_b32 v214, v78, v88, vcc
    v_cndmask_b32 v215, v79, v88, vcc
    buffer_store_dwordx4 v[212:215], v249, s[80:83], s64 offen sc0 sc1
    s_add_u32 s18, s18, 73923840
    s_mov_b32 exec_lo, 0
    s_mov_b32 exec_hi, 0xffff0000
    buffer_store_dwordx2 v[80:81], v249, s[80:83], s18 offen sc0 sc1
    s_mov_b64 exec, -1
    s_lshl_b32 s64, s75, 15
    s_lshl_b32 s66, s73, 9
    s_add_u32 s64, s64, s66
    s_add_u32 s64, s64, 75522048
    s_lshl_b32 s65, s72, 5
    s_add_u32 s64, s64, s65
    s_lshl_b32 s65, s3, 2
    s_add_u32 s64, s64, s65
    v_mov_b32 v208, 0
    v_mov_b32 v209, 1
    s_cmp_lg_u32 s78, 0
    s_cbranch_scc1 sg_14_slow
    s_waitcnt vmcnt(2)
    s_mov_b64 exec, 1
    buffer_store_dword v209, v208, s[80:83], s64 offen
    s_mov_b64 exec, -1
sg_14_done:
    s_lshl_b32 s64, s73, 4
    s_add_u32 s64, s64, s72
    s_lshl_b32 s64, s64, 5
    s_and_b32 s65, s3, 1
    s_lshl_b32 s65, s65, 2
    s_add_u32 s64, s64, s65
    s_add_u32 s64, s64, 75571200
    s_waitcnt vmcnt(1)
    s_mov_b64 exec, 1
    buffer_store_dword v209, v208, s[80:83], s64 offen sc0 sc1
    s_mov_b64 exec, -1
    s_branch hl_13_done
hl_13_no:
    s_lshl_b32 s64, s75, 15
    s_lshl_b32 s66, s73, 9
    s_add_u32 s64, s64, s66
    s_add_u32 s64, s64, 75522048
    s_lshl_b32 s65, s72, 5
    s_add_u32 s64, s64, s65
    s_lshl_b32 s65, s3, 2
    s_add_u32 s64, s64, s65
    v_mov_b32 v208, 0
    v_mov_b32 v209, 1
    s_cmp_lg_u32 s78, 0
    s_cbranch_scc1 sg_15_slow
    s_waitcnt vmcnt(0)
    s_mov_b64 exec, 1
    buffer_store_dword v209, v208, s[80:83], s64 offen
    s_mov_b64 exec, -1
sg_15_done:
hl_13_done:
    s_branch fo_12_end
fo_12_out:
    s_mov_b32 s8, s98
    s_mov_b32 s9, s99
    s_mov_b32 s10, 4194304
    s_mov_b32 s11, 0x00020000
    s_lshl_b32 s64, s73, 1
    s_lshr_b32 s65, s3, 1
    s_add_u32 s64, s64, s65
    s_lshl_b32 s64, s64, 17
    s_lshl_b32 s65, s68, 7
    s_add_u32 s64, s64, s65
    s_and_b32 s65, s3, 1
    s_lshl_b32 s65, s65, 6
    s_add_u32 s64, s64, s65
    v_lshlrev_b32 v243, 11, v252
    v_add_u32 v243, s64, v243
    v_and_b32 v253, 1, v251
    v_lshl_add_u32 v243, v253, 5, v243
    v_lshrrev_b32 v253, 1, v251
    v_lshl_add_u32 v243, v253, 4, v243
    s_waitcnt vmcnt(3)
    v_pk_add_f32 v[0:1], v[0:1], v[176:177]
    v_pk_add_f32 v[2:3], v[2:3], v[178:179]
    v_pk_add_f32 v[16:17], v[16:17], v[192:193]
    v_pk_add_f32 v[18:19], v[18:19], v[194:195]
    v_cvt_pk_bf16_f32 v208, v0, v1
    v_cvt_pk_bf16_f32 v209, v2, v3
    v_cvt_pk_bf16_f32 v210, v16, v17
    v_cvt_pk_bf16_f32 v211, v18, v19
    v_lshlrev_b32 v212, 16, v208
    v_and_b32 v213, 0xffff0000, v208
    v_lshlrev_b32 v214, 16, v209
    v_and_b32 v215, 0xffff0000, v209
    v_lshlrev_b32 v216, 16, v210
    v_and_b32 v217, 0xffff0000, v210
    v_lshlrev_b32 v218, 16, v211
    v_and_b32 v219, 0xffff0000, v211
    v_pk_add_f32 v[212:213], v[212:213], v[144:145]
    v_pk_add_f32 v[214:215], v[214:215], v[146:147]
    v_pk_add_f32 v[216:217], v[216:217], v[148:149]
    v_pk_add_f32 v[218:219], v[218:219], v[150:151]
    v_cvt_pk_bf16_f32 v64, v212, v213
    v_cvt_pk_bf16_f32 v65, v214, v215
    v_cvt_pk_bf16_f32 v66, v216, v217
    v_cvt_pk_bf16_f32 v67, v218, v219
    s_mov_b32 s64, 0
    s_nop 0
    v_permlane16_swap_b32 v64, v66
    v_permlane16_swap_b32 v65, v67
    buffer_store_dwordx4 v[64:67], v243, s[8:11], s64 offen
    s_waitcnt vmcnt(3)
    v_pk_add_f32 v[4:5], v[4:5], v[180:181]
    v_pk_add_f32 v[6:7], v[6:7], v[182:183]
    v_pk_add_f32 v[20:21], v[20:21], v[196:197]
    v_pk_add_f32 v[22:23], v[22:23], v[198:199]
    v_cvt_pk_bf16_f32 v208, v4, v5
    v_cvt_pk_bf16_f32 v209, v6, v7
    v_cvt_pk_bf16_f32 v210, v20, v21
    v_cvt_pk_bf16_f32 v211, v22, v23
    v_lshlrev_b32 v212, 16, v208
    v_and_b32 v213, 0xffff0000, v208
    v_lshlrev_b32 v214, 16, v209
    v_and_b32 v215, 0xffff0000, v209
    v_lshlrev_b32 v216, 16, v210
    v_and_b32 v217, 0xffff0000, v210
    v_lshlrev_b32 v218, 16, v211
    v_and_b32 v219, 0xffff0000, v211
    v_pk_add_f32 v[212:213], v[212:213], v[152:153]
    v_pk_add_f32 v[214:215], v[214:215], v[154:155]
    v_pk_add_f32 v[216:217], v[216:217], v[156:157]
    v_pk_add_f32 v[218:219], v[218:219], v[158:159]
    v_cvt_pk_bf16_f32 v68, v212, v213
    v_cvt_pk_bf16_f32 v69, v214, v215
    v_cvt_pk_bf16_f32 v70, v216, v217
    v_cvt_pk_bf16_f32 v71, v218, v219
    s_mov_b32 s64, 32768
    s_nop 0
    v_permlane16_swap_b32 v68, v70
    v_permlane16_swap_b32 v69, v71
    buffer_store_dwordx4 v[68:71], v243, s[8:11], s64 offen
    s_waitcnt vmcnt(3)
    v_pk_add_f32 v[8:9], v[8:9], v[184:185]
    v_pk_add_f32 v[10:11], v[10:11], v[186:187]
    v_pk_add_f32 v[24:25], v[24:25], v[200:201]
    v_pk_add_f32 v[26:27], v[26:27], v[202:203]
    v_cvt_pk_bf16_f32 v208, v8, v9
    v_cvt_pk_bf16_f32 v209, v10, v11
    v_cvt_pk_bf16_f32 v210, v24, v25
    v_cvt_pk_bf16_f32 v211, v26, v27
    v_lshlrev_b32 v212, 16, v208
    v_and_b32 v213, 0xffff0000, v208
    v_lshlrev_b32 v214, 16, v209
    v_and_b32 v215, 0xffff0000, v209
    v_lshlrev_b32 v216, 16, v210
    v_and_b32 v217, 0xffff0000, v210
    v_lshlrev_b32 v218, 16, v211
    v_and_b32 v219, 0xffff0000, v211
    v_pk_add_f32 v[212:213], v[212:213], v[160:161]
    v_pk_add_f32 v[214:215], v[214:215], v[162:163]
    v_pk_add_f32 v[216:217], v[216:217], v[164:165]
    v_pk_add_f32 v[218:219], v[218:219], v[166:167]
    v_cvt_pk_bf16_f32 v72, v212, v213
    v_cvt_pk_bf16_f32 v73, v214, v215
    v_cvt_pk_bf16_f32 v74, v216, v217
    v_cvt_pk_bf16_f32 v75, v218, v219
    s_mov_b32 s64, 65536
    s_nop 0
    v_permlane16_swap_b32 v72, v74
    v_permlane16_swap_b32 v73, v75
    buffer_store_dwordx4 v[72:75], v243, s[8:11], s64 offen
    s_waitcnt vmcnt(3)
    v_pk_add_f32 v[12:13], v[12:13], v[188:189]
    v_pk_add_f32 v[14:15], v[14:15], v[190:191]
    v_pk_add_f32 v[28:29], v[28:29], v[204:205]
    v_pk_add_f32 v[30:31], v[30:31], v[206:207]
    v_cvt_pk_bf16_f32 v208, v12, v13
    v_cvt_pk_bf16_f32 v209, v14, v15
    v_cvt_pk_bf16_f32 v210, v28, v29
    v_cvt_pk_bf16_f32 v211, v30, v31
    v_lshlrev_b32 v212, 16, v208
    v_and_b32 v213, 0xffff0000, v208
    v_lshlrev_b32 v214, 16, v209
    v_and_b32 v215, 0xffff0000, v209
    v_lshlrev_b32 v216, 16, v210
    v_and_b32 v217, 0xffff0000, v210
    v_lshlrev_b32 v218, 16, v211
    v_and_b32 v219, 0xffff0000, v211
    v_pk_add_f32 v[212:213], v[212:213], v[168:169]
    v_pk_add_f32 v[214:215], v[214:215], v[170:171]
    v_pk_add_f32 v[216:217], v[216:217], v[172:173]
    v_pk_add_f32 v[218:219], v[218:219], v[174:175]
    v_cvt_pk_bf16_f32 v76, v212, v213
    v_cvt_pk_bf16_f32 v77, v214, v215
    v_cvt_pk_bf16_f32 v78, v216, v217
    v_cvt_pk_bf16_f32 v79, v218, v219
    s_mov_b32 s64, 98304
    s_nop 0
    v_permlane16_swap_b32 v76, v78
    v_permlane16_swap_b32 v77, v79
    buffer_store_dwordx4 v[76:79], v243, s[8:11], s64 offen
fo_12_end:
    s_add_u32 s75, s75, 1
    s_mov_b32 s59, s78
    s_mul_i32 s60, s59, s75
    s_cmp_lt_u32 s75, 2
    s_cbranch_scc1 C_layer
    s_branch L_fin
sg_5_slow:
    s_waitcnt vmcnt(0)
    buffer_wbl2 sc1
    s_waitcnt vmcnt(0)
    s_mov_b64 exec, 1
    buffer_store_dword v109, v108, s[80:83], s64 offen sc0 sc1
    s_mov_b64 exec, -1
    s_branch sg_5_done
sg_8_slow:
    s_waitcnt vmcnt(0)
    buffer_wbl2 sc1
    s_waitcnt vmcnt(0)
    s_mov_b64 exec, 1
    buffer_store_dword v209, v208, s[80:83], s64 offen sc0 sc1
    s_mov_b64 exec, -1
    s_branch sg_8_done
sg_9_slow:
    s_waitcnt vmcnt(0)
    buffer_wbl2 sc1
    s_waitcnt vmcnt(0)
    s_mov_b64 exec, 1
    buffer_store_dword v193, v192, s[80:83], s64 offen sc0 sc1
    s_mov_b64 exec, -1
    s_branch sg_9_done
sg_10_slow:
    s_waitcnt vmcnt(0)
    buffer_wbl2 sc1
    s_waitcnt vmcnt(0)
    s_mov_b64 exec, 1
    buffer_store_dword v209, v208, s[80:83], s21 offen sc0 sc1
    s_mov_b64 exec, -1
    s_branch sg_10_done
pl_11_acq:
    buffer_inv sc1
    s_waitcnt vmcnt(0)
    s_branch pl_11_ok
sg_14_slow:
    s_waitcnt vmcnt(0)
    buffer_wbl2 sc1
    s_waitcnt vmcnt(0)
    s_mov_b64 exec, 1
    buffer_store_dword v209, v208, s[80:83], s64 offen sc0 sc1
    s_mov_b64 exec, -1
    s_branch sg_14_done
sg_15_slow:
    s_waitcnt vmcnt(0)
    buffer_wbl2 sc1
    s_waitcnt vmcnt(0)
    s_mov_b64 exec, 1
    buffer_store_dword v209, v208, s[80:83], s64 offen sc0 sc1
    s_mov_b64 exec, -1
    s_branch sg_15_done
L_load:
    s_setprio 3
    s_mov_b32 s8, s86
    s_mov_b32 s9, s87
    s_mov_b32 s10, 6291456
    s_mov_b32 s11, 0x00020000
    v_lshrrev_b32 v253, 3, v250
    v_and_b32 v254, 3, v253
    v_lshlrev_b32 v254, 3, v254
    v_and_b32 v253, 4, v253
    v_add_u32 v253, v253, v254
    v_add_u32 v253, s69, v253
    v_mul_u32_u24 v253, 6144, v253
    v_and_b32 v254, 7, v250
    v_lshl_add_u32 v10, v254, 4, v253
    v_add_u32 v11, 2048, v10
    v_add_u32 v12, 4096, v10
    s_mul_i32 s19, s69, 3104
    s_lshl_b32 s17, s67, 7
    s_add_u32 s18, s17, 6291456
    s_lshl_b32 s64, s70, 1
    s_mul_i32 s64, s64, 393216
    s_add_u32 s16, s17, s64
    s_add_u32 m0, s19, 86400
    s_nop 0
    buffer_load_dwordx4 v10, s[8:11], s16 offen lds
    s_add_u32 m0, s19, 87424
    s_nop 0
    buffer_load_dwordx4 v11, s[8:11], s16 offen lds
    s_add_u32 m0, s19, 88448
    s_nop 0
    buffer_load_dwordx4 v12, s[8:11], s16 offen lds
    s_add_u32 s16, s16, 196608
    s_cmp_eq_u32 s16, s18
    s_cselect_b32 s16, s17, s16
    s_mov_b32 s12, s84
    s_mov_b32 s13, s85
    s_mov_b32 s14, 4194304
    s_mov_b32 s15, 0x00020000
    v_lshrrev_b32 v253, 3, v250
    v_and_b32 v254, 6, v253
    v_and_b32 v13, 7, v250
    v_xor_b32 v254, v254, v13
    v_lshlrev_b32 v254, 4, v254
    v_lshl_add_u32 v13, v253, 11, v254
    v_add_u32 v14, 16384, v13
    v_add_u32 v15, 32768, v13
    v_add_u32 v16, 49152, v13
    s_lshl_b32 s21, s73, 18
    s_lshl_b32 s64, s69, 16
    s_add_u32 s21, s21, s64
    s_add_u32 s22, s21, 2048
    s_lshl_b32 s64, s70, 1
    s_lshl_b32 s64, s64, 7
    s_add_u32 s20, s21, s64
    s_mul_i32 s24, s69, 4294918144
    s_sub_u32 s24, s24, 32768
    s_cmp_eq_u32 s73, 0
    s_cselect_b32 s24, 0x7f000000, s24
    s_lshl_b32 s23, s69, 12
    s_add_u32 s23, s23, 2048
    s_lshl_b32 s25, s69, 10
    s_cmp_eq_u32 s69, 0
    s_cselect_b32 s26, 0xffffff00, -1
    s_mov_b32 s27, -1
    s_mov_b32 s28, s90
    s_mov_b32 s29, s91
    s_mov_b32 s30, 256
    s_mov_b32 s31, 0x00020000
    s_getreg_b32 s32, hwreg(HW_REG_XCC_ID)
    s_and_b32 s32, s32, 15
    s_or_b32 s32, s32, 0x80
    s_lshr_b32 s33, s72, 1
    s_cmp_eq_u32 s69, 3
    s_cselect_b32 s33, s33, 64
    s_cmp_ge_u32 s69, 2
    s_cbranch_scc1 nh_16
    s_add_u32 m0, s25, 18432
    s_add_u32 s64, s20, s24
    s_mov_b64 exec, s[26:27]
    buffer_load_dwordx4 v13, s[12:15], s64 offen lds
    s_mov_b64 exec, -1
nh_16:
    s_add_u32 m0, s23, 18432
    s_nop 0
    buffer_load_dwordx4 v13, s[12:15], s20 offen lds
    s_add_u32 m0, s23, 19456
    s_nop 0
    buffer_load_dwordx4 v14, s[12:15], s20 offen lds
    s_add_u32 m0, s23, 20480
    s_nop 0
    buffer_load_dwordx4 v15, s[12:15], s20 offen lds
    s_add_u32 m0, s23, 21504
    s_nop 0
    buffer_load_dwordx4 v16, s[12:15], s20 offen lds
    s_add_u32 s20, s20, 128
    s_cmp_eq_u32 s20, s22
    s_cselect_b32 s20, s21, s20
    s_add_u32 m0, s19, 98816
    s_nop 0
    buffer_load_dwordx4 v10, s[8:11], s16 offen lds
    s_add_u32 m0, s19, 99840
    s_nop 0
    buffer_load_dwordx4 v11, s[8:11], s16 offen lds
    s_add_u32 m0, s19, 100864
    s_nop 0
    buffer_load_dwordx4 v12, s[8:11], s16 offen lds
    s_add_u32 s16, s16, 196608
    s_cmp_eq_u32 s16, s18
    s_cselect_b32 s16, s17, s16
    s_add_u32 m0, s19, 111232
    s_nop 0
    buffer_load_dwordx4 v10, s[8:11], s16 offen lds
    s_add_u32 m0, s19, 112256
    s_nop 0
    buffer_load_dwordx4 v11, s[8:11], s16 offen lds
    s_add_u32 m0, s19, 113280
    s_nop 0
    buffer_load_dwordx4 v12, s[8:11], s16 offen lds
    s_add_u32 s16, s16, 196608
    s_cmp_eq_u32 s16, s18
    s_cselect_b32 s16, s17, s16
    s_cmp_ge_u32 s69, 2
    s_cbranch_scc1 nh_17
    s_add_u32 m0, s25, 36864
    s_add_u32 s64, s20, s24
    s_mov_b64 exec, s[26:27]
    buffer_load_dwordx4 v13, s[12:15], s64 offen lds
    s_mov_b64 exec, -1
nh_17:
    s_add_u32 m0, s23, 36864
    s_nop 0
    buffer_load_dwordx4 v13, s[12:15], s20 offen lds
    s_add_u32 m0, s23, 37888
    s_nop 0
    buffer_load_dwordx4 v14, s[12:15], s20 offen lds
    s_add_u32 m0, s23, 38912
    s_nop 0
    buffer_load_dwordx4 v15, s[12:15], s20 offen lds
    s_add_u32 m0, s23, 39936
    s_nop 0
    buffer_load_dwordx4 v16, s[12:15], s20 offen lds
    s_add_u32 s20, s20, 128
    s_cmp_eq_u32 s20, s22
    s_cselect_b32 s20, s21, s20
    s_add_u32 m0, s19, 123648
    s_nop 0
    buffer_load_dwordx4 v10, s[8:11], s16 offen lds
    s_add_u32 m0, s19, 124672
    s_nop 0
    buffer_load_dwordx4 v11, s[8:11], s16 offen lds
    s_add_u32 m0, s19, 125696
    s_nop 0
    buffer_load_dwordx4 v12, s[8:11], s16 offen lds
    s_add_u32 s16, s16, 196608
    s_cmp_eq_u32 s16, s18
    s_cselect_b32 s16, s17, s16
    s_add_u32 m0, s19, 136064
    s_nop 0
    buffer_load_dwordx4 v10, s[8:11], s16 offen lds
    s_add_u32 m0, s19, 137088
    s_nop 0
    buffer_load_dwordx4 v11, s[8:11], s16 offen lds
    s_add_u32 m0, s19, 138112
    s_nop 0
    buffer_load_dwordx4 v12, s[8:11], s16 offen lds
    s_add_u32 s16, s16, 196608
    s_cmp_eq_u32 s16, s18
    s_cselect_b32 s16, s17, s16
    s_waitcnt vmcnt(16) lgkmcnt(0)
    s_barrier
    s_cmp_ge_u32 s69, 2
    s_cbranch_scc1 nh_18
    s_add_u32 m0, s25, 55296
    s_add_u32 s64, s20, s24
    s_mov_b64 exec, s[26:27]
    buffer_load_dwordx4 v13, s[12:15], s64 offen lds
    s_mov_b64 exec, -1
nh_18:
    s_add_u32 m0, s23, 55296
    s_nop 0
    buffer_load_dwordx4 v13, s[12:15], s20 offen lds
    s_add_u32 m0, s23, 56320
    s_nop 0
    buffer_load_dwordx4 v14, s[12:15], s20 offen lds
    s_add_u32 m0, s23, 57344
    s_nop 0
    buffer_load_dwordx4 v15, s[12:15], s20 offen lds
    s_add_u32 m0, s23, 58368
    s_nop 0
    buffer_load_dwordx4 v16, s[12:15], s20 offen lds
    s_add_u32 s20, s20, 128
    s_cmp_eq_u32 s20, s22
    s_cselect_b32 s20, s21, s20
    s_add_u32 m0, s19, 73984
    s_nop 0
    buffer_load_dwordx4 v10, s[8:11], s16 offen lds
    s_add_u32 m0, s19, 75008
    s_nop 0
    buffer_load_dwordx4 v11, s[8:11], s16 offen lds
    s_add_u32 m0, s19, 76032
    s_nop 0
    buffer_load_dwordx4 v12, s[8:11], s16 offen lds
    s_add_u32 s16, s16, 196608
    s_cmp_eq_u32 s16, s18
    s_cselect_b32 s16, s17, s16
    s_waitcnt vmcnt(13) lgkmcnt(0)
    s_barrier
    s_cmp_ge_u32 s69, 2
    s_cbranch_scc1 nh_19
    s_add_u32 m0, s25, 0
    s_add_u32 s64, s20, s24
    s_mov_b64 exec, s[26:27]
    buffer_load_dwordx4 v13, s[12:15], s64 offen lds
    s_mov_b64 exec, -1
nh_19:
    s_add_u32 m0, s23, 0
    s_nop 0
    buffer_load_dwordx4 v13, s[12:15], s20 offen lds
    s_add_u32 m0, s23, 1024
    s_nop 0
    buffer_load_dwordx4 v14, s[12:15], s20 offen lds
    s_add_u32 m0, s23, 2048
    s_nop 0
    buffer_load_dwordx4 v15, s[12:15], s20 offen lds
    s_add_u32 m0, s23, 3072
    s_nop 0
    buffer_load_dwordx4 v16, s[12:15], s20 offen lds
    s_add_u32 s20, s20, 128
    s_cmp_eq_u32 s20, s22
    s_cselect_b32 s20, s21, s20
    s_add_u32 m0, s19, 86400
    s_nop 0
    buffer_load_dwordx4 v10, s[8:11], s16 offen lds
    s_add_u32 m0, s19, 87424
    s_nop 0
    buffer_load_dwordx4 v11, s[8:11], s16 offen lds
    s_add_u32 m0, s19, 88448
    s_nop 0
    buffer_load_dwordx4 v12, s[8:11], s16 offen lds
    s_add_u32 s16, s16, 196608
    s_cmp_eq_u32 s16, s18
    s_cselect_b32 s16, s17, s16
    s_waitcnt vmcnt(10) lgkmcnt(0)
    s_barrier
    s_add_u32 m0, s19, 98816
    s_nop 0
    buffer_load_dwordx4 v10, s[8:11], s16 offen lds
    s_add_u32 m0, s19, 99840
    s_nop 0
    buffer_load_dwordx4 v11, s[8:11], s16 offen lds
    s_add_u32 m0, s19, 100864
    s_nop 0
    buffer_load_dwordx4 v12, s[8:11], s16 offen lds
    s_add_u32 s16, s16, 196608
    s_cmp_eq_u32 s16, s18
    s_cselect_b32 s16, s17, s16
    s_cmp_ge_u32 s69, 2
    s_cbranch_scc1 nh_20
    s_add_u32 m0, s25, 18432
    s_add_u32 s64, s20, s24
    s_mov_b64 exec, s[26:27]
    buffer_load_dwordx4 v13, s[12:15], s64 offen lds
    s_mov_b64 exec, -1
nh_20:
    s_add_u32 m0, s23, 18432
    s_nop 0
    buffer_load_dwordx4 v13, s[12:15], s20 offen lds
    s_add_u32 m0, s23, 19456
    s_nop 0
    buffer_load_dwordx4 v14, s[12:15], s20 offen lds
    s_add_u32 m0, s23, 20480
    s_nop 0
    buffer_load_dwordx4 v15, s[12:15], s20 offen lds
    s_add_u32 m0, s23, 21504
    s_nop 0
    buffer_load_dwordx4 v16, s[12:15], s20 offen lds
    s_add_u32 s20, s20, 128
    s_cmp_eq_u32 s20, s22
    s_cselect_b32 s20, s21, s20
    s_add_u32 m0, s19, 111232
    s_nop 0
    buffer_load_dwordx4 v10, s[8:11], s16 offen lds
    s_add_u32 m0, s19, 112256
    s_nop 0
    buffer_load_dwordx4 v11, s[8:11], s16 offen lds
    s_add_u32 m0, s19, 113280
    s_nop 0
    buffer_load_dwordx4 v12, s[8:11], s16 offen lds
    s_add_u32 s16, s16, 196608
    s_cmp_eq_u32 s16, s18
    s_cselect_b32 s16, s17, s16
    s_waitcnt vmcnt(10) lgkmcnt(0)
    s_barrier
    s_add_u32 m0, s19, 123648
    s_nop 0
    buffer_load_dwordx4 v10, s[8:11], s16 offen lds
    s_add_u32 m0, s19, 124672
    s_nop 0
    buffer_load_dwordx4 v11, s[8:11], s16 offen lds
    s_add_u32 m0, s19, 125696
    s_nop 0
    buffer_load_dwordx4 v12, s[8:11], s16 offen lds
    s_add_u32 s16, s16, 196608
    s_cmp_eq_u32 s16, s18
    s_cselect_b32 s16, s17, s16
    s_cmp_ge_u32 s69, 2
    s_cbranch_scc1 nh_21
    s_add_u32 m0, s25, 36864
    s_add_u32 s64, s20, s24
    s_mov_b64 exec, s[26:27]
    buffer_load_dwordx4 v13, s[12:15], s64 offen lds
    s_mov_b64 exec, -1
nh_21:
    s_add_u32 m0, s23, 36864
    s_nop 0
    buffer_load_dwordx4 v13, s[12:15], s20 offen lds
    s_add_u32 m0, s23, 37888
    s_nop 0
    buffer_load_dwordx4 v14, s[12:15], s20 offen lds
    s_add_u32 m0, s23, 38912
    s_nop 0
    buffer_load_dwordx4 v15, s[12:15], s20 offen lds
    s_add_u32 m0, s23, 39936
    s_nop 0
    buffer_load_dwordx4 v16, s[12:15], s20 offen lds
    s_add_u32 s20, s20, 128
    s_cmp_eq_u32 s20, s22
    s_cselect_b32 s20, s21, s20
    s_add_u32 m0, s19, 136064
    s_nop 0
    buffer_load_dwordx4 v10, s[8:11], s16 offen lds
    s_add_u32 m0, s19, 137088
    s_nop 0
    buffer_load_dwordx4 v11, s[8:11], s16 offen lds
    s_add_u32 m0, s19, 138112
    s_nop 0
    buffer_load_dwordx4 v12, s[8:11], s16 offen lds
    s_add_u32 s16, s16, 196608
    s_cmp_eq_u32 s16, s18
    s_cselect_b32 s16, s17, s16
    s_cmp_eq_u32 s33, 0
    s_cbranch_scc1 ar_22
ar_22_b:
    s_waitcnt vmcnt(10) lgkmcnt(0)
    s_barrier
    s_add_u32 m0, s19, 73984
    s_nop 0
    buffer_load_dwordx4 v10, s[8:11], s16 offen lds
    s_add_u32 m0, s19, 75008
    s_nop 0
    buffer_load_dwordx4 v11, s[8:11], s16 offen lds
    s_add_u32 m0, s19, 76032
    s_nop 0
    buffer_load_dwordx4 v12, s[8:11], s16 offen lds
    s_add_u32 s16, s16, 196608
    s_cmp_eq_u32 s16, s18
    s_cselect_b32 s16, s17, s16
    s_cmp_ge_u32 s69, 2
    s_cbranch_scc1 nh_23
    s_add_u32 m0, s25, 55296
    s_add_u32 s64, s20, s24
    s_mov_b64 exec, s[26:27]
    buffer_load_dwordx4 v13, s[12:15], s64 offen lds
    s_mov_b64 exec, -1
nh_23:
    s_add_u32 m0, s23, 55296
    s_nop 0
    buffer_load_dwordx4 v13, s[12:15], s20 offen lds
    s_add_u32 m0, s23, 56320
    s_nop 0
    buffer_load_dwordx4 v14, s[12:15], s20 offen lds
    s_add_u32 m0, s23, 57344
    s_nop 0
    buffer_load_dwordx4 v15, s[12:15], s20 offen lds
    s_add_u32 m0, s23, 58368
    s_nop 0
    buffer_load_dwordx4 v16, s[12:15], s20 offen lds
    s_add_u32 s20, s20, 128
    s_cmp_eq_u32 s20, s22
    s_cselect_b32 s20, s21, s20
    s_add_u32 m0, s19, 86400
    s_nop 0
    buffer_load_dwordx4 v10, s[8:11], s16 offen lds
    s_add_u32 m0, s19, 87424
    s_nop 0
    buffer_load_dwordx4 v11, s[8:11], s16 offen lds
    s_add_u32 m0, s19, 88448
    s_nop 0
    buffer_load_dwordx4 v12, s[8:11], s16 offen lds
    s_add_u32 s16, s16, 196608
    s_cmp_eq_u32 s16, s18
    s_cselect_b32 s16, s17, s16
    s_cmp_eq_u32 s33, 1
    s_cbranch_scc1 ar_24
ar_24_b:
    s_waitcnt vmcnt(10) lgkmcnt(0)
    s_barrier
    s_add_u32 m0, s19, 98816
    s_nop 0
    buffer_load_dwordx4 v10, s[8:11], s16 offen lds
    s_add_u32 m0, s19, 99840
    s_nop 0
    buffer_load_dwordx4 v11, s[8:11], s16 offen lds
    s_add_u32 m0, s19, 100864
    s_nop 0
    buffer_load_dwordx4 v12, s[8:11], s16 offen lds
    s_add_u32 s16, s16, 196608
    s_cmp_eq_u32 s16, s18
    s_cselect_b32 s16, s17, s16
    s_cmp_ge_u32 s69, 2
    s_cbranch_scc1 nh_25
    s_add_u32 m0, s25, 0
    s_add_u32 s64, s20, s24
    s_mov_b64 exec, s[26:27]
    buffer_load_dwordx4 v13, s[12:15], s64 offen lds
    s_mov_b64 exec, -1
nh_25:
    s_add_u32 m0, s23, 0
    s_nop 0
    buffer_load_dwordx4 v13, s[12:15], s20 offen lds
    s_add_u32 m0, s23, 1024
    s_nop 0
    buffer_load_dwordx4 v14, s[12:15], s20 offen lds
    s_add_u32 m0, s23, 2048
    s_nop 0
    buffer_load_dwordx4 v15, s[12:15], s20 offen lds
    s_add_u32 m0, s23, 3072
    s_nop 0
    buffer_load_dwordx4 v16, s[12:15], s20 offen lds
    s_add_u32 s20, s20, 128
    s_cmp_eq_u32 s20, s22
    s_cselect_b32 s20, s21, s20
    s_add_u32 m0, s19, 111232
    s_nop 0
    buffer_load_dwordx4 v10, s[8:11], s16 offen lds
    s_add_u32 m0, s19, 112256
    s_nop 0
    buffer_load_dwordx4 v11, s[8:11], s16 offen lds
    s_add_u32 m0, s19, 113280
    s_nop 0
    buffer_load_dwordx4 v12, s[8:11], s16 offen lds
    s_add_u32 s16, s16, 196608
    s_cmp_eq_u32 s16, s18
    s_cselect_b32 s16, s17, s16
    s_cmp_eq_u32 s33, 2
    s_cbranch_scc1 ar_26
ar_26_b:
    s_waitcnt vmcnt(10) lgkmcnt(0)
    s_barrier
    s_add_u32 m0, s19, 123648
    s_nop 0
    buffer_load_dwordx4 v10, s[8:11], s16 offen lds
    s_add_u32 m0, s19, 124672
    s_nop 0
    buffer_load_dwordx4 v11, s[8:11], s16 offen lds
    s_add_u32 m0, s19, 125696
    s_nop 0
    buffer_load_dwordx4 v12, s[8:11], s16 offen lds
    s_add_u32 s16, s16, 196608
    s_cmp_eq_u32 s16, s18
    s_cselect_b32 s16, s17, s16
    s_cmp_ge_u32 s69, 2
    s_cbranch_scc1 nh_27
    s_add_u32 m0, s25, 18432
    s_add_u32 s64, s20, s24
    s_mov_b64 exec, s[26:27]
    buffer_load_dwordx4 v13, s[12:15], s64 offen lds
    s_mov_b64 exec, -1
nh_27:
    s_add_u32 m0, s23, 18432
    s_nop 0
    buffer_load_dwordx4 v13, s[12:15], s20 offen lds
    s_add_u32 m0, s23, 19456
    s_nop 0
    buffer_load_dwordx4 v14, s[12:15], s20 offen lds
    s_add_u32 m0, s23, 20480
    s_nop 0
    buffer_load_dwordx4 v15, s[12:15], s20 offen lds
    s_add_u32 m0, s23, 21504
    s_nop 0
    buffer_load_dwordx4 v16, s[12:15], s20 offen lds
    s_add_u32 s20, s20, 128
    s_cmp_eq_u32 s20, s22
    s_cselect_b32 s20, s21, s20
    s_add_u32 m0, s19, 136064
    s_nop 0
    buffer_load_dwordx4 v10, s[8:11], s16 offen lds
    s_add_u32 m0, s19, 137088
    s_nop 0
    buffer_load_dwordx4 v11, s[8:11], s16 offen lds
    s_add_u32 m0, s19, 138112
    s_nop 0
    buffer_load_dwordx4 v12, s[8:11], s16 offen lds
    s_add_u32 s16, s16, 196608
    s_cmp_eq_u32 s16, s18
    s_cselect_b32 s16, s17, s16
    s_cmp_eq_u32 s33, 3
    s_cbranch_scc1 ar_28
ar_28_b:
    s_waitcnt vmcnt(10) lgkmcnt(0)
    s_barrier
    s_add_u32 m0, s19, 73984
    s_nop 0
    buffer_load_dwordx4 v10, s[8:11], s16 offen lds
    s_add_u32 m0, s19, 75008
    s_nop 0
    buffer_load_dwordx4 v11, s[8:11], s16 offen lds
    s_add_u32 m0, s19, 76032
    s_nop 0
    buffer_load_dwordx4 v12, s[8:11], s16 offen lds
    s_add_u32 s16, s16, 196608
    s_cmp_eq_u32 s16, s18
    s_cselect_b32 s16, s17, s16
    s_cmp_ge_u32 s69, 2
    s_cbranch_scc1 nh_29
    s_add_u32 m0, s25, 36864
    s_add_u32 s64, s20, s24
    s_mov_b64 exec, s[26:27]
    buffer_load_dwordx4 v13, s[12:15], s64 offen lds
    s_mov_b64 exec, -1
nh_29:
    s_add_u32 m0, s23, 36864
    s_nop 0
    buffer_load_dwordx4 v13, s[12:15], s20 offen lds
    s_add_u32 m0, s23, 37888
    s_nop 0
    buffer_load_dwordx4 v14, s[12:15], s20 offen lds
    s_add_u32 m0, s23, 38912
    s_nop 0
    buffer_load_dwordx4 v15, s[12:15], s20 offen lds
    s_add_u32 m0, s23, 39936
    s_nop 0
    buffer_load_dwordx4 v16, s[12:15], s20 offen lds
    s_add_u32 s20, s20, 128
    s_cmp_eq_u32 s20, s22
    s_cselect_b32 s20, s21, s20
    s_add_u32 m0, s19, 86400
    s_nop 0
    buffer_load_dwordx4 v10, s[8:11], s16 offen lds
    s_add_u32 m0, s19, 87424
    s_nop 0
    buffer_load_dwordx4 v11, s[8:11], s16 offen lds
    s_add_u32 m0, s19, 88448
    s_nop 0
    buffer_load_dwordx4 v12, s[8:11], s16 offen lds
    s_add_u32 s16, s16, 196608
    s_cmp_eq_u32 s16, s18
    s_cselect_b32 s16, s17, s16
    s_cmp_eq_u32 s33, 4
    s_cbranch_scc1 ar_30
ar_30_b:
    s_waitcnt vmcnt(10) lgkmcnt(0)
    s_barrier
    s_add_u32 m0, s19, 98816
    s_nop 0
    buffer_load_dwordx4 v10, s[8:11], s16 offen lds
    s_add_u32 m0, s19, 99840
    s_nop 0
    buffer_load_dwordx4 v11, s[8:11], s16 offen lds
    s_add_u32 m0, s19, 100864
    s_nop 0
    buffer_load_dwordx4 v12, s[8:11], s16 offen lds
    s_add_u32 s16, s16, 196608
    s_cmp_eq_u32 s16, s18
    s_cselect_b32 s16, s17, s16
    s_cmp_ge_u32 s69, 2
    s_cbranch_scc1 nh_31
    s_add_u32 m0, s25, 55296
    s_add_u32 s64, s20, s24
    s_mov_b64 exec, s[26:27]
    buffer_load_dwordx4 v13, s[12:15], s64 offen lds
    s_mov_b64 exec, -1
nh_31:
    s_add_u32 m0, s23, 55296
    s_nop 0
    buffer_load_dwordx4 v13, s[12:15], s20 offen lds
    s_add_u32 m0, s23, 56320
    s_nop 0
    buffer_load_dwordx4 v14, s[12:15], s20 offen lds
    s_add_u32 m0, s23, 57344
    s_nop 0
    buffer_load_dwordx4 v15, s[12:15], s20 offen lds
    s_add_u32 m0, s23, 58368
    s_nop 0
    buffer_load_dwordx4 v16, s[12:15], s20 offen lds
    s_add_u32 s20, s20, 128
    s_cmp_eq_u32 s20, s22
    s_cselect_b32 s20, s21, s20
    s_add_u32 m0, s19, 111232
    s_nop 0
    buffer_load_dwordx4 v10, s[8:11], s16 offen lds
    s_add_u32 m0, s19, 112256
    s_nop 0
    buffer_load_dwordx4 v11, s[8:11], s16 offen lds
    s_add_u32 m0, s19, 113280
    s_nop 0
    buffer_load_dwordx4 v12, s[8:11], s16 offen lds
    s_add_u32 s16, s16, 196608
    s_cmp_eq_u32 s16, s18
    s_cselect_b32 s16, s17, s16
    s_cmp_eq_u32 s33, 5
    s_cbranch_scc1 ar_32
ar_32_b:
    s_waitcnt vmcnt(10) lgkmcnt(0)
    s_barrier
    s_add_u32 m0, s19, 123648
    s_nop 0
    buffer_load_dwordx4 v10, s[8:11], s16 offen lds
    s_add_u32 m0, s19, 124672
    s_nop 0
    buffer_load_dwordx4 v11, s[8:11], s16 offen lds
    s_add_u32 m0, s19, 125696
    s_nop 0
    buffer_load_dwordx4 v12, s[8:11], s16 offen lds
    s_add_u32 s16, s16, 196608
    s_cmp_eq_u32 s16, s18
    s_cselect_b32 s16, s17, s16
    s_cmp_ge_u32 s69, 2
    s_cbranch_scc1 nh_33
    s_add_u32 m0, s25, 0
    s_add_u32 s64, s20, s24
    s_mov_b64 exec, s[26:27]
    buffer_load_dwordx4 v13, s[12:15], s64 offen lds
    s_mov_b64 exec, -1
nh_33:
    s_add_u32 m0, s23, 0
    s_nop 0
    buffer_load_dwordx4 v13, s[12:15], s20 offen lds
    s_add_u32 m0, s23, 1024
    s_nop 0
    buffer_load_dwordx4 v14, s[12:15], s20 offen lds
    s_add_u32 m0, s23, 2048
    s_nop 0
    buffer_load_dwordx4 v15, s[12:15], s20 offen lds
    s_add_u32 m0, s23, 3072
    s_nop 0
    buffer_load_dwordx4 v16, s[12:15], s20 offen lds
    s_add_u32 s20, s20, 128
    s_cmp_eq_u32 s20, s22
    s_cselect_b32 s20, s21, s20
    s_add_u32 m0, s19, 136064
    s_nop 0
    buffer_load_dwordx4 v10, s[8:11], s16 offen lds
    s_add_u32 m0, s19, 137088
    s_nop 0
    buffer_load_dwordx4 v11, s[8:11], s16 offen lds
    s_add_u32 m0, s19, 138112
    s_nop 0
    buffer_load_dwordx4 v12, s[8:11], s16 offen lds
    s_add_u32 s16, s16, 196608
    s_cmp_eq_u32 s16, s18
    s_cselect_b32 s16, s17, s16
    s_cmp_eq_u32 s33, 6
    s_cbranch_scc1 ar_34
ar_34_b:
    s_waitcnt vmcnt(10) lgkmcnt(0)
    s_barrier
    s_add_u32 m0, s19, 73984
    s_nop 0
    buffer_load_dwordx4 v10, s[8:11], s16 offen lds
    s_add_u32 m0, s19, 75008
    s_nop 0
    buffer_load_dwordx4 v11, s[8:11], s16 offen lds
    s_add_u32 m0, s19, 76032
    s_nop 0
    buffer_load_dwordx4 v12, s[8:11], s16 offen lds
    s_add_u32 s16, s16, 196608
    s_cmp_eq_u32 s16, s18
    s_cselect_b32 s16, s17, s16
    s_cmp_ge_u32 s69, 2
    s_cbranch_scc1 nh_35
    s_add_u32 m0, s25, 18432
    s_add_u32 s64, s20, s24
    s_mov_b64 exec, s[26:27]
    buffer_load_dwordx4 v13, s[12:15], s64 offen lds
    s_mov_b64 exec, -1
nh_35:
    s_add_u32 m0, s23, 18432
    s_nop 0
    buffer_load_dwordx4 v13, s[12:15], s20 offen lds
    s_add_u32 m0, s23, 19456
    s_nop 0
    buffer_load_dwordx4 v14, s[12:15], s20 offen lds
    s_add_u32 m0, s23, 20480
    s_nop 0
    buffer_load_dwordx4 v15, s[12:15], s20 offen lds
    s_add_u32 m0, s23, 21504
    s_nop 0
    buffer_load_dwordx4 v16, s[12:15], s20 offen lds
    s_add_u32 s20, s20, 128
    s_cmp_eq_u32 s20, s22
    s_cselect_b32 s20, s21, s20
    s_add_u32 m0, s19, 86400
    s_nop 0
    buffer_load_dwordx4 v10, s[8:11], s16 offen lds
    s_add_u32 m0, s19, 87424
    s_nop 0
    buffer_load_dwordx4 v11, s[8:11], s16 offen lds
    s_add_u32 m0, s19, 88448
    s_nop 0
    buffer_load_dwordx4 v12, s[8:11], s16 offen lds
    s_add_u32 s16, s16, 196608
    s_cmp_eq_u32 s16, s18
    s_cselect_b32 s16, s17, s16
    s_cmp_eq_u32 s33, 7
    s_cbranch_scc1 ar_36
ar_36_b:
    s_waitcnt vmcnt(10) lgkmcnt(0)
    s_barrier
    s_add_u32 m0, s19, 98816
    s_nop 0
    buffer_load_dwordx4 v10, s[8:11], s16 offen lds
    s_add_u32 m0, s19, 99840
    s_nop 0
    buffer_load_dwordx4 v11, s[8:11], s16 offen lds
    s_add_u32 m0, s19, 100864
    s_nop 0
    buffer_load_dwordx4 v12, s[8:11], s16 offen lds
    s_add_u32 s16, s16, 196608
    s_cmp_eq_u32 s16, s18
    s_cselect_b32 s16, s17, s16
    s_cmp_ge_u32 s69, 2
    s_cbranch_scc1 nh_37
    s_add_u32 m0, s25, 36864
    s_add_u32 s64, s20, s24
    s_mov_b64 exec, s[26:27]
    buffer_load_dwordx4 v13, s[12:15], s64 offen lds
    s_mov_b64 exec, -1
nh_37:
    s_add_u32 m0, s23, 36864
    s_nop 0
    buffer_load_dwordx4 v13, s[12:15], s20 offen lds
    s_add_u32 m0, s23, 37888
    s_nop 0
    buffer_load_dwordx4 v14, s[12:15], s20 offen lds
    s_add_u32 m0, s23, 38912
    s_nop 0
    buffer_load_dwordx4 v15, s[12:15], s20 offen lds
    s_add_u32 m0, s23, 39936
    s_nop 0
    buffer_load_dwordx4 v16, s[12:15], s20 offen lds
    s_add_u32 s20, s20, 128
    s_cmp_eq_u32 s20, s22
    s_cselect_b32 s20, s21, s20
    s_add_u32 m0, s19, 111232
    s_nop 0
    buffer_load_dwordx4 v10, s[8:11], s16 offen lds
    s_add_u32 m0, s19, 112256
    s_nop 0
    buffer_load_dwordx4 v11, s[8:11], s16 offen lds
    s_add_u32 m0, s19, 113280
    s_nop 0
    buffer_load_dwordx4 v12, s[8:11], s16 offen lds
    s_add_u32 s16, s16, 196608
    s_cmp_eq_u32 s16, s18
    s_cselect_b32 s16, s17, s16
    s_waitcnt vmcnt(10) lgkmcnt(0)
    s_barrier
    s_add_u32 m0, s19, 123648
    s_nop 0
    buffer_load_dwordx4 v10, s[8:11], s16 offen lds
    s_add_u32 m0, s19, 124672
    s_nop 0
    buffer_load_dwordx4 v11, s[8:11], s16 offen lds
    s_add_u32 m0, s19, 125696
    s_nop 0
    buffer_load_dwordx4 v12, s[8:11], s16 offen lds
    s_add_u32 s16, s16, 196608
    s_cmp_eq_u32 s16, s18
    s_cselect_b32 s16, s17, s16
    s_cmp_ge_u32 s69, 2
    s_cbranch_scc1 nh_38
    s_add_u32 m0, s25, 55296
    s_add_u32 s64, s20, s24
    s_mov_b64 exec, s[26:27]
    buffer_load_dwordx4 v13, s[12:15], s64 offen lds
    s_mov_b64 exec, -1
nh_38:
    s_add_u32 m0, s23, 55296
    s_nop 0
    buffer_load_dwordx4 v13, s[12:15], s20 offen lds
    s_add_u32 m0, s23, 56320
    s_nop 0
    buffer_load_dwordx4 v14, s[12:15], s20 offen lds
    s_add_u32 m0, s23, 57344
    s_nop 0
    buffer_load_dwordx4 v15, s[12:15], s20 offen lds
    s_add_u32 m0, s23, 58368
    s_nop 0
    buffer_load_dwordx4 v16, s[12:15], s20 offen lds
    s_add_u32 s20, s20, 128
    s_cmp_eq_u32 s20, s22
    s_cselect_b32 s20, s21, s20
    s_add_u32 m0, s19, 136064
    s_nop 0
    buffer_load_dwordx4 v10, s[8:11], s16 offen lds
    s_add_u32 m0, s19, 137088
    s_nop 0
    buffer_load_dwordx4 v11, s[8:11], s16 offen lds
    s_add_u32 m0, s19, 138112
    s_nop 0
    buffer_load_dwordx4 v12, s[8:11], s16 offen lds
    s_add_u32 s16, s16, 196608
    s_cmp_eq_u32 s16, s18
    s_cselect_b32 s16, s17, s16
    s_waitcnt vmcnt(10) lgkmcnt(0)
    s_barrier
    s_add_u32 m0, s19, 73984
    s_nop 0
    buffer_load_dwordx4 v10, s[8:11], s16 offen lds
    s_add_u32 m0, s19, 75008
    s_nop 0
    buffer_load_dwordx4 v11, s[8:11], s16 offen lds
    s_add_u32 m0, s19, 76032
    s_nop 0
    buffer_load_dwordx4 v12, s[8:11], s16 offen lds
    s_add_u32 s16, s16, 196608
    s_cmp_eq_u32 s16, s18
    s_cselect_b32 s16, s17, s16
    s_cmp_ge_u32 s69, 2
    s_cbranch_scc1 nh_39
    s_add_u32 m0, s25, 0
    s_add_u32 s64, s20, s24
    s_mov_b64 exec, s[26:27]
    buffer_load_dwordx4 v13, s[12:15], s64 offen lds
    s_mov_b64 exec, -1
nh_39:
    s_add_u32 m0, s23, 0
    s_nop 0
    buffer_load_dwordx4 v13, s[12:15], s20 offen lds
    s_add_u32 m0, s23, 1024
    s_nop 0
    buffer_load_dwordx4 v14, s[12:15], s20 offen lds
    s_add_u32 m0, s23, 2048
    s_nop 0
    buffer_load_dwordx4 v15, s[12:15], s20 offen lds
    s_add_u32 m0, s23, 3072
    s_nop 0
    buffer_load_dwordx4 v16, s[12:15], s20 offen lds
    s_add_u32 s20, s20, 128
    s_cmp_eq_u32 s20, s22
    s_cselect_b32 s20, s21, s20
    s_add_u32 m0, s19, 86400
    s_nop 0
    buffer_load_dwordx4 v10, s[8:11], s16 offen lds
    s_add_u32 m0, s19, 87424
    s_nop 0
    buffer_load_dwordx4 v11, s[8:11], s16 offen lds
    s_add_u32 m0, s19, 88448
    s_nop 0
    buffer_load_dwordx4 v12, s[8:11], s16 offen lds
    s_add_u32 s16, s16, 196608
    s_cmp_eq_u32 s16, s18
    s_cselect_b32 s16, s17, s16
    s_waitcnt vmcnt(10) lgkmcnt(0)
    s_barrier
    s_add_u32 m0, s19, 98816
    s_nop 0
    buffer_load_dwordx4 v10, s[8:11], s16 offen lds
    s_add_u32 m0, s19, 99840
    s_nop 0
    buffer_load_dwordx4 v11, s[8:11], s16 offen lds
    s_add_u32 m0, s19, 100864
    s_nop 0
    buffer_load_dwordx4 v12, s[8:11], s16 offen lds
    s_add_u32 s16, s16, 196608
    s_cmp_eq_u32 s16, s18
    s_cselect_b32 s16, s17, s16
    s_lshl_b32 s64, s73, 4
    s_add_u32 s64, s64, s67
    s_lshl_b32 s64, s64, 2
    s_add_u32 s64, s64, s69
    s_lshl_b32 s64, s64, 12
    s_lshl_b32 s65, s60, 22
    s_add_u32 s64, s64, s65
    s_add_u32 s64, s64, 12582912
    v_lshlrev_b32 v253, 7, v250
    s_mov_b64 exec, 0xffffffff
    buffer_load_dword v9, v253, s[80:83], s64 offen sc1
    s_mov_b64 exec, -1
    s_mov_b32 s12, s88
    s_mov_b32 s13, s89
    s_mov_b32 s14, 2097152
    s_mov_b32 s15, 0x00020000
    v_lshrrev_b32 v253, 3, v250
    v_lshlrev_b32 v253, 13, v253
    v_and_b32 v254, 7, v250
    v_lshl_add_u32 v253, v254, 4, v253
    s_lshl_b32 s64, s69, 11
    v_add_u32 v244, s64, v253
    s_mul_i32 s51, s69, 1056
    s_lshl_b32 s49, s72, 7
    s_lshl_b32 s64, s67, 17
    s_add_u32 s50, s49, 2097152
    s_add_u32 s48, s49, s64
    s_add_u32 m0, s51, 116224
    s_nop 0
    buffer_load_dwordx4 v244, s[12:15], s48 offen lds
    s_add_u32 s48, s48, 65536
    s_cmp_eq_u32 s48, s50
    s_cselect_b32 s48, s49, s48
    s_waitcnt vmcnt(5) lgkmcnt(0)
    s_barrier
    s_cmp_lg_u32 s69, 0
    s_cbranch_scc1 hs_40_d
    v_lshlrev_b32 v253, 2, v250
hs_40:
    buffer_load_dword v72, v253, s[28:31], 0 offen sc1
    s_sub_u32 s79, s79, 1
    s_cbranch_scc1 L_abort
    s_waitcnt vmcnt(0)
    v_and_b32 v73, 0x80808080, v72
    v_cmp_ne_u32 vcc, 0x80808080, v73
    s_cbranch_vccnz hs_40
    s_lshl_b32 s64, s73, 11
    s_add_u32 s64, s64, 74186752
    buffer_load_dwordx4 v[76:79], v249, s[80:83], s64 offen sc0 sc1
    s_mov_b64 exec, 0xff
    buffer_load_dwordx4 v[80:83], v249, s[80:83], s64 offen offset:1024 sc0 sc1
    s_mov_b64 exec, -1
    s_and_b32 s64, s70, 3
    s_lshl_b32 s64, s64, 3
    v_bfe_u32 v72, v72, s64, 8
    v_cmp_ne_u32 vcc, s32, v72
    s_lshr_b32 s64, s70, 2
    s_lshl_b32 s65, 0x55555555, s64
    s_or_b32 s64, vcc_lo, vcc_hi
    s_and_b32 s64, s64, s65
    s_cselect_b32 s64, 1, 0
    v_mov_b32 v72, s64
    v_mov_b32 v73, 163456
    ds_write_b32 v73, v72
    v_add_u32 v73, 159744, v249
    s_waitcnt vmcnt(0)
    ds_write_b128 v73, v[76:79]
    s_mov_b64 exec, 0xff
    ds_write_b128 v73, v[80:83] offset:1024
    s_mov_b64 exec, -1
hs_40_d:
    s_add_u32 m0, s51, 120448
    s_nop 0
    buffer_load_dwordx4 v244, s[12:15], s48 offen lds
    s_add_u32 s48, s48, 65536
    s_cmp_eq_u32 s48, s50
    s_cselect_b32 s48, s49, s48
    s_add_u32 m0, s51, 124672
    s_nop 0
    buffer_load_dwordx4 v244, s[12:15], s48 offen lds
    s_add_u32 s48, s48, 65536
    s_cmp_eq_u32 s48, s50
    s_cselect_b32 s48, s49, s48
    s_add_u32 m0, s51, 128896
    s_nop 0
    buffer_load_dwordx4 v244, s[12:15], s48 offen lds
    s_add_u32 s48, s48, 65536
    s_cmp_eq_u32 s48, s50
    s_cselect_b32 s48, s49, s48
    s_add_u32 m0, s51, 133120
    s_nop 0
    buffer_load_dwordx4 v244, s[12:15], s48 offen lds
    s_add_u32 s48, s48, 65536
    s_cmp_eq_u32 s48, s50
    s_cselect_b32 s48, s49, s48
    s_add_u32 m0, s51, 137344
    s_nop 0
    buffer_load_dwordx4 v244, s[12:15], s48 offen lds
    s_add_u32 s48, s48, 65536
    s_cmp_eq_u32 s48, s50
    s_cselect_b32 s48, s49, s48
    s_add_u32 m0, s51, 141568
    s_nop 0
    buffer_load_dwordx4 v244, s[12:15], s48 offen lds
    s_add_u32 s48, s48, 65536
    s_cmp_eq_u32 s48, s50
    s_cselect_b32 s48, s49, s48
    s_add_u32 m0, s51, 145792
    s_nop 0
    buffer_load_dwordx4 v244, s[12:15], s48 offen lds
    s_add_u32 s48, s48, 65536
    s_cmp_eq_u32 s48, s50
    s_cselect_b32 s48, s49, s48
    s_add_u32 m0, s51, 150016
    s_nop 0
    buffer_load_dwordx4 v244, s[12:15], s48 offen lds
    s_add_u32 s48, s48, 65536
    s_cmp_eq_u32 s48, s50
    s_cselect_b32 s48, s49, s48
    s_waitcnt vmcnt(10) lgkmcnt(0)
    s_barrier
    s_add_u32 m0, s51, 154240
    s_nop 0
    buffer_load_dwordx4 v244, s[12:15], s48 offen lds
    s_add_u32 s48, s48, 65536
    s_cmp_eq_u32 s48, s50
    s_cselect_b32 s48, s49, s48
    s_add_u32 m0, s51, 65536
    s_nop 0
    buffer_load_dwordx4 v244, s[12:15], s48 offen lds
    s_add_u32 s48, s48, 65536
    s_cmp_eq_u32 s48, s50
    s_cselect_b32 s48, s49, s48
    s_add_u32 m0, s51, 69760
    s_nop 0
    buffer_load_dwordx4 v244, s[12:15], s48 offen lds
    s_add_u32 s48, s48, 65536
    s_cmp_eq_u32 s48, s50
    s_cselect_b32 s48, s49, s48
    s_add_u32 m0, s51, 73984
    s_nop 0
    buffer_load_dwordx4 v244, s[12:15], s48 offen lds
    s_add_u32 s48, s48, 65536
    s_cmp_eq_u32 s48, s50
    s_cselect_b32 s48, s49, s48
    s_add_u32 m0, s51, 78208
    s_nop 0
    buffer_load_dwordx4 v244, s[12:15], s48 offen lds
    s_add_u32 s48, s48, 65536
    s_cmp_eq_u32 s48, s50
    s_cselect_b32 s48, s49, s48
    s_add_u32 m0, s51, 82432
    s_nop 0
    buffer_load_dwordx4 v244, s[12:15], s48 offen lds
    s_add_u32 s48, s48, 65536
    s_cmp_eq_u32 s48, s50
    s_cselect_b32 s48, s49, s48
    s_add_u32 m0, s51, 86656
    s_nop 0
    buffer_load_dwordx4 v244, s[12:15], s48 offen lds
    s_add_u32 s48, s48, 65536
    s_cmp_eq_u32 s48, s50
    s_cselect_b32 s48, s49, s48
    s_add_u32 m0, s51, 90880
    s_nop 0
    buffer_load_dwordx4 v244, s[12:15], s48 offen lds
    s_add_u32 s48, s48, 65536
    s_cmp_eq_u32 s48, s50
    s_cselect_b32 s48, s49, s48
    s_waitcnt lgkmcnt(0)
    s_barrier
    s_add_u32 m0, s51, 95104
    s_nop 0
    buffer_load_dwordx4 v244, s[12:15], s48 offen lds
    s_add_u32 s48, s48, 65536
    s_cmp_eq_u32 s48, s50
    s_cselect_b32 s48, s49, s48
    s_add_u32 m0, s51, 99328
    s_nop 0
    buffer_load_dwordx4 v244, s[12:15], s48 offen lds
    s_add_u32 s48, s48, 65536
    s_cmp_eq_u32 s48, s50
    s_cselect_b32 s48, s49, s48
    s_add_u32 m0, s51, 103552
    s_nop 0
    buffer_load_dwordx4 v244, s[12:15], s48 offen lds
    s_add_u32 s48, s48, 65536
    s_cmp_eq_u32 s48, s50
    s_cselect_b32 s48, s49, s48
    s_add_u32 m0, s51, 107776
    s_nop 0
    buffer_load_dwordx4 v244, s[12:15], s48 offen lds
    s_add_u32 s48, s48, 65536
    s_cmp_eq_u32 s48, s50
    s_cselect_b32 s48, s49, s48
    s_add_u32 m0, s51, 112000
    s_nop 0
    buffer_load_dwordx4 v244, s[12:15], s48 offen lds
    s_add_u32 s48, s48, 65536
    s_cmp_eq_u32 s48, s50
    s_cselect_b32 s48, s49, s48
    v_mov_b32 v253, 163456
    ds_read_b32 v253, v253
    s_waitcnt lgkmcnt(0)
    v_readfirstlane_b32 s78, v253
    s_mov_b32 s59, s78
    s_mul_i32 s60, s59, s75
L_g2:
    s_cmp_ge_u32 s69, 2
    s_cbranch_scc1 pt_41
    s_lshl_b32 s64, s73, 4
    s_add_u32 s64, s64, s72
    s_lshl_b32 s64, s64, 14
    s_mul_i32 s66, s60, 8388608
    s_add_u32 s64, s64, s66
    v_lshlrev_b32 v253, 7, v250
    s_lshl_b32 s65, s69, 13
    s_add_u32 s64, s64, s65
    buffer_load_dword v254, v253, s[80:83], s64 offen sc1
pt_41:
    s_lshl_b32 s53, s60, 22
    s_lshl_b32 s64, s73, 18
    s_add_u32 s53, s53, s64
    s_add_u32 s53, s53, 12582912
    s_lshl_b32 s65, s67, 14
    s_lshl_b32 s55, s69, 11
    s_add_u32 s53, s53, s55
    s_add_u32 s54, s53, 262144
    s_add_u32 s52, s53, s65
    s_lshl_b32 s64, s75, 15
    s_lshl_b32 s66, s73, 9
    s_add_u32 s64, s64, s66
    s_add_u32 s64, s64, 75497472
    v_lshlrev_b32 v246, 5, v250
    s_mov_b64 exec, 0xffff
pl_42:
    buffer_load_dwordx4 v[240:243], v246, s[80:83], s64 offen sc1
    s_sub_u32 s79, s79, 1
    s_cbranch_scc1 L_abort
    s_waitcnt vmcnt(0)
    v_and_b32 v240, v240, v241
    v_and_b32 v242, v242, v243
    v_and_b32 v240, v240, v242
    v_cmp_ne_u32 vcc, 1, v240
    s_cbranch_vccnz pl_42
    s_mov_b64 exec, -1
    s_cmp_lg_u32 s78, 0
    s_cbranch_scc1 pl_42_acq
pl_42_ok:
    s_add_u32 m0, s55, 0
    s_nop 0
    buffer_load_dwordx4 v249, s[80:83], s52 offen offset:0 sc1 lds
    buffer_load_dwordx4 v249, s[80:83], s52 offen offset:1024 sc1 lds
    s_add_u32 s52, s52, 8192
    s_cmp_eq_u32 s52, s54
    s_cselect_b32 s52, s53, s52
    s_add_u32 m0, s55, 8192
    s_nop 0
    buffer_load_dwordx4 v249, s[80:83], s52 offen offset:0 sc1 lds
    buffer_load_dwordx4 v249, s[80:83], s52 offen offset:1024 sc1 lds
    s_add_u32 s52, s52, 8192
    s_cmp_eq_u32 s52, s54
    s_cselect_b32 s52, s53, s52
    s_add_u32 m0, s55, 16384
    s_nop 0
    buffer_load_dwordx4 v249, s[80:83], s52 offen offset:0 sc1 lds
    buffer_load_dwordx4 v249, s[80:83], s52 offen offset:1024 sc1 lds
    s_add_u32 s52, s52, 8192
    s_cmp_eq_u32 s52, s54
    s_cselect_b32 s52, s53, s52
    s_add_u32 m0, s55, 24576
    s_nop 0
    buffer_load_dwordx4 v249, s[80:83], s52 offen offset:0 sc1 lds
    buffer_load_dwordx4 v249, s[80:83], s52 offen offset:1024 sc1 lds
    s_add_u32 s52, s52, 8192
    s_cmp_eq_u32 s52, s54
    s_cselect_b32 s52, s53, s52
    s_waitcnt vmcnt(4) lgkmcnt(0)
    s_barrier
    s_add_u32 m0, s55, 32768
    s_nop 0
    buffer_load_dwordx4 v249, s[80:83], s52 offen offset:0 sc1 lds
    buffer_load_dwordx4 v249, s[80:83], s52 offen offset:1024 sc1 lds
    s_add_u32 s52, s52, 8192
    s_cmp_eq_u32 s52, s54
    s_cselect_b32 s52, s53, s52
    s_add_u32 m0, s55, 40960
    s_nop 0
    buffer_load_dwordx4 v249, s[80:83], s52 offen offset:0 sc1 lds
    buffer_load_dwordx4 v249, s[80:83], s52 offen offset:1024 sc1 lds
    s_add_u32 s52, s52, 8192
    s_cmp_eq_u32 s52, s54
    s_cselect_b32 s52, s53, s52
    s_add_u32 m0, s55, 49152
    s_nop 0
    buffer_load_dwordx4 v249, s[80:83], s52 offen offset:0 sc1 lds
    buffer_load_dwordx4 v249, s[80:83], s52 offen offset:1024 sc1 lds
    s_add_u32 s52, s52, 8192
    s_cmp_eq_u32 s52, s54
    s_cselect_b32 s52, s53, s52
    s_waitcnt vmcnt(6) lgkmcnt(0)
    s_barrier
    s_add_u32 m0, s55, 57344
    s_nop 0
    buffer_load_dwordx4 v249, s[80:83], s52 offen offset:0 sc1 lds
    buffer_load_dwordx4 v249, s[80:83], s52 offen offset:1024 sc1 lds
    s_add_u32 s52, s52, 8192
    s_cmp_eq_u32 s52, s54
    s_cselect_b32 s52, s53, s52
    s_add_u32 m0, s55, 0
    s_nop 0
    buffer_load_dwordx4 v249, s[80:83], s52 offen offset:0 sc1 lds
    buffer_load_dwordx4 v249, s[80:83], s52 offen offset:1024 sc1 lds
    s_add_u32 s52, s52, 8192
    s_cmp_eq_u32 s52, s54
    s_cselect_b32 s52, s53, s52
    s_add_u32 m0, s55, 8192
    s_nop 0
    buffer_load_dwordx4 v249, s[80:83], s52 offen offset:0 sc1 lds
    buffer_load_dwordx4 v249, s[80:83], s52 offen offset:1024 sc1 lds
    s_add_u32 s52, s52, 8192
    s_cmp_eq_u32 s52, s54
    s_cselect_b32 s52, s53, s52
    s_waitcnt vmcnt(8) lgkmcnt(0)
    s_barrier
    s_add_u32 m0, s55, 16384
    s_nop 0
    buffer_load_dwordx4 v249, s[80:83], s52 offen offset:0 sc1 lds
    buffer_load_dwordx4 v249, s[80:83], s52 offen offset:1024 sc1 lds
    s_add_u32 s52, s52, 8192
    s_cmp_eq_u32 s52, s54
    s_cselect_b32 s52, s53, s52
    s_add_u32 m0, s55, 24576
    s_nop 0
    buffer_load_dwordx4 v249, s[80:83], s52 offen offset:0 sc1 lds
    buffer_load_dwordx4 v249, s[80:83], s52 offen offset:1024 sc1 lds
    s_add_u32 s52, s52, 8192
    s_cmp_eq_u32 s52, s54
    s_cselect_b32 s52, s53, s52
    s_waitcnt vmcnt(8) lgkmcnt(0)
    s_barrier
    s_add_u32 m0, s55, 32768
    s_nop 0
    buffer_load_dwordx4 v249, s[80:83], s52 offen offset:0 sc1 lds
    buffer_load_dwordx4 v249, s[80:83], s52 offen offset:1024 sc1 lds
    s_add_u32 s52, s52, 8192
    s_cmp_eq_u32 s52, s54
    s_cselect_b32 s52, s53, s52
    s_add_u32 m0, s55, 40960
    s_nop 0
    buffer_load_dwordx4 v249, s[80:83], s52 offen offset:0 sc1 lds
    buffer_load_dwordx4 v249, s[80:83], s52 offen offset:1024 sc1 lds
    s_add_u32 s52, s52, 8192
    s_cmp_eq_u32 s52, s54
    s_cselect_b32 s52, s53, s52
    s_add_u32 m0, s51, 116224
    s_nop 0
    buffer_load_dwordx4 v244, s[12:15], s48 offen lds
    s_add_u32 s48, s48, 65536
    s_cmp_eq_u32 s48, s50
    s_cselect_b32 s48, s49, s48
    s_and_b32 s64, s3, 1
    s_cmp_eq_u32 s64, 0
    s_cselect_b32 s8, s92, s94
    s_cselect_b32 s9, s93, s95
    s_mov_b32 s10, 7340032
    s_mov_b32 s11, 0x00020000
    s_mul_i32 s19, s64, 14400
    s_lshr_b32 s64, s69, 1
    s_mul_i32 s65, s64, 7200
    s_add_u32 s19, s19, s65
    s_add_u32 s19, s19, 36736
    s_mul_i32 s17, s64, 28672
    s_mul_i32 s65, s74, 448
    s_add_u32 s17, s17, s65
    s_add_u32 s18, s17, 7340032
    s_lshl_b32 s64, s57, 1
    s_mul_i32 s65, s64, 229376
    s_add_u32 s16, s17, s65
    s_lshl_b32 s20, s64, 13
    s_mov_b32 s66, 2341
    v_add_u32 v253, 0, v250
    v_mul_lo_u32 v254, v253, s66
    v_lshrrev_b32 v254, 16, v254
    v_mul_u32_u24 v228, 28, v254
    v_sub_u32 v253, v253, v228
    v_and_b32 v228, 12, v254
    v_add_u32 v254, v254, v228
    v_mul_u32_u24 v254, 7168, v254
    v_lshl_add_u32 v228, v253, 4, v254
    v_add_u32 v253, 64, v250
    v_mul_lo_u32 v254, v253, s66
    v_lshrrev_b32 v254, 16, v254
    v_mul_u32_u24 v229, 28, v254
    v_sub_u32 v253, v253, v229
    v_and_b32 v229, 12, v254
    v_add_u32 v254, v254, v229
    v_mul_u32_u24 v254, 7168, v254
    v_lshl_add_u32 v229, v253, 4, v254
    v_add_u32 v253, 128, v250
    v_mul_lo_u32 v254, v253, s66
    v_lshrrev_b32 v254, 16, v254
    v_mul_u32_u24 v230, 28, v254
    v_sub_u32 v253, v253, v230
    v_and_b32 v230, 12, v254
    v_add_u32 v254, v254, v230
    v_mul_u32_u24 v254, 7168, v254
    v_lshl_add_u32 v230, v253, 4, v254
    v_add_u32 v253, 192, v250
    v_mul_lo_u32 v254, v253, s66
    v_lshrrev_b32 v254, 16, v254
    v_mul_u32_u24 v231, 28, v254
    v_sub_u32 v253, v253, v231
    v_and_b32 v231, 12, v254
    v_add_u32 v254, v254, v231
    v_mul_u32_u24 v254, 7168, v254
    v_lshl_add_u32 v231, v253, 4, v254
    v_add_u32 v253, 256, v250
    v_mul_lo_u32 v254, v253, s66
    v_lshrrev_b32 v254, 16, v254
    v_mul_u32_u24 v232, 28, v254
    v_sub_u32 v253, v253, v232
    v_and_b32 v232, 12, v254
    v_add_u32 v254, v254, v232
    v_mul_u32_u24 v254, 7168, v254
    v_lshl_add_u32 v232, v253, 4, v254
    v_add_u32 v253, 320, v250
    v_mul_lo_u32 v254, v253, s66
    v_lshrrev_b32 v254, 16, v254
    v_mul_u32_u24 v233, 28, v254
    v_sub_u32 v253, v253, v233
    v_and_b32 v233, 12, v254
    v_add_u32 v254, v254, v233
    v_mul_u32_u24 v254, 7168, v254
    v_lshl_add_u32 v233, v253, 4, v254
    v_add_u32 v253, 384, v250
    v_mul_lo_u32 v254, v253, s66
    v_lshrrev_b32 v254, 16, v254
    v_mul_u32_u24 v234, 28, v254
    v_sub_u32 v253, v253, v234
    v_and_b32 v234, 12, v254
    v_add_u32 v254, v254, v234
    v_mul_u32_u24 v254, 7168, v254
    v_lshl_add_u32 v234, v253, 4, v254
    s_waitcnt vmcnt(9) lgkmcnt(0)
    s_barrier
    s_add_u32 m0, s55, 49152
    s_nop 0
    buffer_load_dwordx4 v249, s[80:83], s52 offen offset:0 sc1 lds
    buffer_load_dwordx4 v249, s[80:83], s52 offen offset:1024 sc1 lds
    s_add_u32 s52, s52, 8192
    s_cmp_eq_u32 s52, s54
    s_cselect_b32 s52, s53, s52
    s_add_u32 m0, s55, 57344
    s_nop 0
    buffer_load_dwordx4 v249, s[80:83], s52 offen offset:0 sc1 lds
    buffer_load_dwordx4 v249, s[80:83], s52 offen offset:1024 sc1 lds
    s_add_u32 s52, s52, 8192
    s_cmp_eq_u32 s52, s54
    s_cselect_b32 s52, s53, s52
    s_add_u32 m0, s51, 120448
    s_nop 0
    buffer_load_dwordx4 v244, s[12:15], s48 offen lds
    s_add_u32 s48, s48, 65536
    s_cmp_eq_u32 s48, s50
    s_cselect_b32 s48, s49, s48
    s_waitcnt vmcnt(10) lgkmcnt(0)
    s_barrier
    s_add_u32 m0, s55, 0
    s_nop 0
    buffer_load_dwordx4 v249, s[80:83], s52 offen offset:0 sc1 lds
    buffer_load_dwordx4 v249, s[80:83], s52 offen offset:1024 sc1 lds
    s_add_u32 s52, s52, 8192
    s_cmp_eq_u32 s52, s54
    s_cselect_b32 s52, s53, s52
    s_add_u32 m0, s55, 8192
    s_nop 0
    buffer_load_dwordx4 v249, s[80:83], s52 offen offset:0 sc1 lds
    buffer_load_dwordx4 v249, s[80:83], s52 offen offset:1024 sc1 lds
    s_add_u32 s52, s52, 8192
    s_cmp_eq_u32 s52, s54
    s_cselect_b32 s52, s53, s52
    s_add_u32 m0, s51, 124672
    s_nop 0
    buffer_load_dwordx4 v244, s[12:15], s48 offen lds
    s_add_u32 s48, s48, 65536
    s_cmp_eq_u32 s48, s50
    s_cselect_b32 s48, s49, s48
    s_waitcnt vmcnt(11) lgkmcnt(0)
    s_barrier
    s_add_u32 m0, s55, 16384
    s_nop 0
    buffer_load_dwordx4 v249, s[80:83], s52 offen offset:0 sc1 lds
    buffer_load_dwordx4 v249, s[80:83], s52 offen offset:1024 sc1 lds
    s_add_u32 s52, s52, 8192
    s_cmp_eq_u32 s52, s54
    s_cselect_b32 s52, s53, s52
    s_add_u32 m0, s55, 24576
    s_nop 0
    buffer_load_dwordx4 v249, s[80:83], s52 offen offset:0 sc1 lds
    buffer_load_dwordx4 v249, s[80:83], s52 offen offset:1024 sc1 lds
    s_add_u32 s52, s52, 8192
    s_cmp_eq_u32 s52, s54
    s_cselect_b32 s52, s53, s52
    s_add_u32 m0, s51, 128896
    s_nop 0
    buffer_load_dwordx4 v244, s[12:15], s48 offen lds
    s_add_u32 s48, s48, 65536
    s_cmp_eq_u32 s48, s50
    s_cselect_b32 s48, s49, s48
    s_waitcnt vmcnt(11) lgkmcnt(0)
    s_barrier
    s_add_u32 m0, s55, 32768
    s_nop 0
    buffer_load_dwordx4 v249, s[80:83], s52 offen offset:0 sc1 lds
    buffer_load_dwordx4 v249, s[80:83], s52 offen offset:1024 sc1 lds
    s_add_u32 s52, s52, 8192
    s_cmp_eq_u32 s52, s54
    s_cselect_b32 s52, s53, s52
    s_add_u32 m0, s55, 40960
    s_nop 0
    buffer_load_dwordx4 v249, s[80:83], s52 offen offset:0 sc1 lds
    buffer_load_dwordx4 v249, s[80:83], s52 offen offset:1024 sc1 lds
    s_add_u32 s52, s52, 8192
    s_cmp_eq_u32 s52, s54
    s_cselect_b32 s52, s53, s52
    s_add_u32 m0, s51, 133120
    s_nop 0
    buffer_load_dwordx4 v244, s[12:15], s48 offen lds
    s_add_u32 s48, s48, 65536
    s_cmp_eq_u32 s48, s50
    s_cselect_b32 s48, s49, s48
    s_waitcnt vmcnt(11) lgkmcnt(0)
    s_barrier
    s_add_u32 m0, s55, 49152
    s_nop 0
    buffer_load_dwordx4 v249, s[80:83], s52 offen offset:0 sc1 lds
    buffer_load_dwordx4 v249, s[80:83], s52 offen offset:1024 sc1 lds
    s_add_u32 s52, s52, 8192
    s_cmp_eq_u32 s52, s54
    s_cselect_b32 s52, s53, s52
    s_add_u32 m0, s55, 57344
    s_nop 0
    buffer_load_dwordx4 v249, s[80:83], s52 offen offset:0 sc1 lds
    buffer_load_dwordx4 v249, s[80:83], s52 offen offset:1024 sc1 lds
    s_add_u32 s52, s52, 8192
    s_cmp_eq_u32 s52, s54
    s_cselect_b32 s52, s53, s52
    s_add_u32 m0, s51, 137344
    s_nop 0
    buffer_load_dwordx4 v244, s[12:15], s48 offen lds
    s_add_u32 s48, s48, 65536
    s_cmp_eq_u32 s48, s50
    s_cselect_b32 s48, s49, s48
    s_waitcnt vmcnt(11) lgkmcnt(0)
    s_barrier
    s_add_u32 m0, s55, 0
    s_nop 0
    buffer_load_dwordx4 v249, s[80:83], s52 offen offset:0 sc1 lds
    buffer_load_dwordx4 v249, s[80:83], s52 offen offset:1024 sc1 lds
    s_add_u32 s52, s52, 8192
    s_cmp_eq_u32 s52, s54
    s_cselect_b32 s52, s53, s52
    s_add_u32 m0, s55, 8192
    s_nop 0
    buffer_load_dwordx4 v249, s[80:83], s52 offen offset:0 sc1 lds
    buffer_load_dwordx4 v249, s[80:83], s52 offen offset:1024 sc1 lds
    s_add_u32 s52, s52, 8192
    s_cmp_eq_u32 s52, s54
    s_cselect_b32 s52, s53, s52
    s_add_u32 m0, s51, 141568
    s_nop 0
    buffer_load_dwordx4 v244, s[12:15], s48 offen lds
    s_add_u32 s48, s48, 65536
    s_cmp_eq_u32 s48, s50
    s_cselect_b32 s48, s49, s48
    s_waitcnt vmcnt(11) lgkmcnt(0)
    s_barrier
    s_add_u32 m0, s55, 16384
    s_nop 0
    buffer_load_dwordx4 v249, s[80:83], s52 offen offset:0 sc1 lds
    buffer_load_dwordx4 v249, s[80:83], s52 offen offset:1024 sc1 lds
    s_add_u32 s52, s52, 8192
    s_cmp_eq_u32 s52, s54
    s_cselect_b32 s52, s53, s52
    s_add_u32 m0, s55, 24576
    s_nop 0
    buffer_load_dwordx4 v249, s[80:83], s52 offen offset:0 sc1 lds
    buffer_load_dwordx4 v249, s[80:83], s52 offen offset:1024 sc1 lds
    s_add_u32 s52, s52, 8192
    s_cmp_eq_u32 s52, s54
    s_cselect_b32 s52, s53, s52
    s_add_u32 m0, s51, 145792
    s_nop 0
    buffer_load_dwordx4 v244, s[12:15], s48 offen lds
    s_add_u32 s48, s48, 65536
    s_cmp_eq_u32 s48, s50
    s_cselect_b32 s48, s49, s48
    s_waitcnt vmcnt(11) lgkmcnt(0)
    s_barrier
    s_add_u32 m0, s55, 32768
    s_nop 0
    buffer_load_dwordx4 v249, s[80:83], s52 offen offset:0 sc1 lds
    buffer_load_dwordx4 v249, s[80:83], s52 offen offset:1024 sc1 lds
    s_add_u32 s52, s52, 8192
    s_cmp_eq_u32 s52, s54
    s_cselect_b32 s52, s53, s52
    s_add_u32 m0, s55, 40960
    s_nop 0
    buffer_load_dwordx4 v249, s[80:83], s52 offen offset:0 sc1 lds
    buffer_load_dwordx4 v249, s[80:83], s52 offen offset:1024 sc1 lds
    s_add_u32 s52, s52, 8192
    s_cmp_eq_u32 s52, s54
    s_cselect_b32 s52, s53, s52
    s_add_u32 m0, s51, 150016
    s_nop 0
    buffer_load_dwordx4 v244, s[12:15], s48 offen lds
    s_add_u32 s48, s48, 65536
    s_cmp_eq_u32 s48, s50
    s_cselect_b32 s48, s49, s48
    s_waitcnt vmcnt(11) lgkmcnt(0)
    s_barrier
    s_add_u32 m0, s55, 49152
    s_nop 0
    buffer_load_dwordx4 v249, s[80:83], s52 offen offset:0 sc1 lds
    buffer_load_dwordx4 v249, s[80:83], s52 offen offset:1024 sc1 lds
    s_add_u32 s52, s52, 8192
    s_cmp_eq_u32 s52, s54
    s_cselect_b32 s52, s53, s52
    s_add_u32 m0, s55, 57344
    s_nop 0
    buffer_load_dwordx4 v249, s[80:83], s52 offen offset:0 sc1 lds
    buffer_load_dwordx4 v249, s[80:83], s52 offen offset:1024 sc1 lds
    s_add_u32 s52, s52, 8192
    s_cmp_eq_u32 s52, s54
    s_cselect_b32 s52, s53, s52
    s_add_u32 m0, s51, 154240
    s_nop 0
    buffer_load_dwordx4 v244, s[12:15], s48 offen lds
    s_add_u32 s48, s48, 65536
    s_cmp_eq_u32 s48, s50
    s_cselect_b32 s48, s49, s48
    s_waitcnt vmcnt(11) lgkmcnt(0)
    s_barrier
    s_add_u32 m0, s19, 28800
    s_nop 0
    buffer_load_dwordx4 v228, s[8:11], s16 offen lds
    s_add_u32 m0, s19, 29824
    s_nop 0
    buffer_load_dwordx4 v229, s[8:11], s16 offen lds
    s_add_u32 m0, s19, 30848
    s_nop 0
    buffer_load_dwordx4 v230, s[8:11], s16 offen lds
    s_waitcnt vmcnt(3) lgkmcnt(0)
    s_barrier
    s_add_u32 m0, s19, 31872
    s_nop 0
    buffer_load_dwordx4 v231, s[8:11], s16 offen lds
    s_add_u32 m0, s19, 32896
    s_nop 0
    buffer_load_dwordx4 v232, s[8:11], s16 offen lds
    s_add_u32 m0, s19, 33920
    s_nop 0
    buffer_load_dwordx4 v233, s[8:11], s16 offen lds
    s_add_u32 m0, s19, 34944
    s_nop 0
    buffer_load_dwordx4 v234, s[8:11], s16 offen lds
    s_add_u32 s16, s16, 229376
    s_cmp_eq_u32 s16, s18
    s_cselect_b32 s16, s17, s16
    s_add_u32 m0, s19, 57600
    s_nop 0
    buffer_load_dwordx4 v228, s[8:11], s16 offen lds
    s_add_u32 m0, s19, 58624
    s_nop 0
    buffer_load_dwordx4 v229, s[8:11], s16 offen lds
    s_add_u32 m0, s19, 59648
    s_nop 0
    buffer_load_dwordx4 v230, s[8:11], s16 offen lds
    s_add_u32 m0, s19, 60672
    s_nop 0
    buffer_load_dwordx4 v231, s[8:11], s16 offen lds
    s_add_u32 m0, s19, 61696
    s_nop 0
    buffer_load_dwordx4 v232, s[8:11], s16 offen lds
    s_add_u32 m0, s19, 62720
    s_nop 0
    buffer_load_dwordx4 v233, s[8:11], s16 offen lds
    s_add_u32 m0, s19, 63744
    s_nop 0
    buffer_load_dwordx4 v234, s[8:11], s16 offen lds
    s_add_u32 s16, s16, 229376
    s_cmp_eq_u32 s16, s18
    s_cselect_b32 s16, s17, s16
    s_setprio 0
    s_lshl_b32 s21, s60, 23
    s_lshl_b32 s64, s73, 18
    s_add_u32 s21, s21, s64
    s_lshl_b32 s23, s3, 10
    s_add_u32 s21, s21, s23
    s_add_u32 s22, s21, 262144
    s_add_u32 s20, s20, s21
    s_and_b32 s64, s3, 1
    s_lshl_b32 s64, s64, 12
    v_add_u32 v235, s64, v249
    v_lshrrev_b32 v253, 1, v251
    v_lshrrev_b32 v254, 2, v252
    v_lshl_add_u32 v253, v253, 2, v254
    v_mul_u32_u24 v253, 448, v253
    v_and_b32 v254, 1, v251
    v_mul_u32_u24 v254, 7200, v254
    v_add_u32 v253, v253, v254
    v_and_b32 v254, 3, v252
    v_lshl_add_u32 v253, v254, 3, v253
    v_add_u32 v253, 36736, v253
    s_lshr_b32 s64, s69, 1
    s_lshl_b32 s28, s64, 2
    s_add_u32 s28, s28, 8
    s_lshl_b32 s65, s28, 5
    v_add_u32 v236, s65, v253
    v_add_u32 v237, 57600, v236
    s_add_u32 s65, s64, 10
    s_lshl_b32 s65, s65, 5
    v_add_u32 v238, s65, v253
    v_add_u32 v239, 57600, v238
    s_mul_i32 s65, s64, 224
    s_and_b32 s64, s3, 1
    s_mul_i32 s64, s64, 14400
    s_add_u32 s65, s65, s64
    v_add_u32 v224, s65, v253
    v_mov_b32 v220, 0x3f803f80
    v_mov_b32 v221, 0x3f803f80
    v_mov_b32 v222, 0x3f803f80
    v_mov_b32 v223, 0x3f803f80
    s_mul_i32 s25, s73, 112
    s_mul_i32 s64, s74, 7
    s_add_u32 s25, s25, s64
    s_lshl_b32 s25, s25, 13
    s_lshl_b32 s64, s60, 24
    s_add_u32 s25, s25, s64
    s_add_u32 s25, s25, 20971520
    s_cmp_eq_u32 s75, 0
    s_cselect_b32 s27, s71, 7
    s_lshl_b32 s64, s75, 15
    s_lshl_b32 s66, s73, 9
    s_add_u32 s64, s64, s66
    s_add_u32 s64, s64, 75505664
    v_lshlrev_b32 v246, 5, v250
    s_mov_b64 exec, 0xffff
pl_43:
    buffer_load_dwordx4 v[240:243], v246, s[80:83], s64 offen sc1
    s_sub_u32 s79, s79, 1
    s_cbranch_scc1 L_abort
    s_waitcnt vmcnt(0)
    v_and_b32 v240, v240, v241
    v_and_b32 v242, v242, v243
    v_and_b32 v240, v240, v242
    v_cmp_ne_u32 vcc, 1, v240
    s_cbranch_vccnz pl_43
    s_mov_b64 exec, -1
    s_cmp_lg_u32 s78, 0
    s_cbranch_scc1 pl_43_acq
pl_43_ok:
    s_add_u32 m0, s23, 0
    s_sub_u32 s64, s20, 4096
    buffer_load_dwordx4 v249, s[80:83], s20 offen sc1 lds
    s_sub_u32 m0, m0, 4096
    s_nop 0
    buffer_load_dwordx4 v249, s[80:83], s64 offen sc1 lds
    s_add_u32 s20, s20, 8192
    s_cmp_eq_u32 s20, s22
    s_cselect_b32 s20, s21, s20
    s_add_u32 m0, s23, 8192
    s_sub_u32 s64, s20, 4096
    buffer_load_dwordx4 v249, s[80:83], s20 offen sc1 lds
    s_sub_u32 m0, m0, 4096
    s_nop 0
    buffer_load_dwordx4 v249, s[80:83], s64 offen sc1 lds
    s_add_u32 s20, s20, 8192
    s_cmp_eq_u32 s20, s22
    s_cselect_b32 s20, s21, s20
    s_waitcnt vmcnt(2)
    s_barrier
    ds_read_b128 v[144:147], v235 offset:0
    ds_read_b128 v[148:151], v235 offset:1024
    ds_read_b128 v[152:155], v235 offset:2048
    ds_read_b128 v[156:159], v235 offset:3072
    ds_read_b64_tr_b16 v[96:97], v236 offset:28800
    ds_read_b64_tr_b16 v[98:99], v236 offset:32384
    ds_read_b64_tr_b16 v[108:109], v236 offset:43200
    ds_read_b64_tr_b16 v[110:111], v236 offset:46784
    ds_read_b64_tr_b16 v[100:101], v236 offset:28832
    ds_read_b64_tr_b16 v[102:103], v236 offset:32416
    ds_read_b64_tr_b16 v[112:113], v236 offset:43232
    ds_read_b64_tr_b16 v[114:115], v236 offset:46816
    ds_read_b64_tr_b16 v[104:105], v238 offset:28800
    ds_read_b64_tr_b16 v[106:107], v238 offset:32384
    ds_read_b64_tr_b16 v[116:117], v238 offset:43200
    ds_read_b64_tr_b16 v[118:119], v238 offset:46784
    s_add_u32 m0, s23, 16384
    s_sub_u32 s64, s20, 4096
    buffer_load_dwordx4 v249, s[80:83], s20 offen sc1 lds
    s_sub_u32 m0, m0, 4096
    s_nop 0
    buffer_load_dwordx4 v249, s[80:83], s64 offen sc1 lds
    s_add_u32 s20, s20, 8192
    s_cmp_eq_u32 s20, s22
    s_cselect_b32 s20, s21, s20
    s_add_u32 m0, s19, 86400
    s_nop 0
    buffer_load_dwordx4 v228, s[8:11], s16 offen lds
    s_add_u32 m0, s19, 87424
    s_nop 0
    buffer_load_dwordx4 v229, s[8:11], s16 offen lds
    s_add_u32 m0, s19, 88448
    s_nop 0
    buffer_load_dwordx4 v230, s[8:11], s16 offen lds
    s_add_u32 m0, s19, 89472
    s_nop 0
    buffer_load_dwordx4 v231, s[8:11], s16 offen lds
    s_add_u32 m0, s19, 90496
    s_nop 0
    buffer_load_dwordx4 v232, s[8:11], s16 offen lds
    s_add_u32 m0, s19, 91520
    s_nop 0
    buffer_load_dwordx4 v233, s[8:11], s16 offen lds
    s_add_u32 m0, s19, 92544
    s_nop 0
    buffer_load_dwordx4 v234, s[8:11], s16 offen lds
    s_add_u32 s16, s16, 229376
    s_cmp_eq_u32 s16, s18
    s_cselect_b32 s16, s17, s16
    s_add_u32 m0, s23, 24576
    s_sub_u32 s64, s20, 4096
    buffer_load_dwordx4 v249, s[80:83], s20 offen sc1 lds
    s_sub_u32 m0, m0, 4096
    s_nop 0
    buffer_load_dwordx4 v249, s[80:83], s64 offen sc1 lds
    s_add_u32 s20, s20, 8192
    s_cmp_eq_u32 s20, s22
    s_cselect_b32 s20, s21, s20
    s_add_u32 m0, s19, 0
    s_nop 0
    buffer_load_dwordx4 v228, s[8:11], s16 offen lds
    s_add_u32 m0, s19, 1024
    s_nop 0
    buffer_load_dwordx4 v229, s[8:11], s16 offen lds
    s_add_u32 m0, s19, 2048
    s_nop 0
    buffer_load_dwordx4 v230, s[8:11], s16 offen lds
    s_add_u32 m0, s19, 3072
    s_nop 0
    buffer_load_dwordx4 v231, s[8:11], s16 offen lds
    s_add_u32 m0, s19, 4096
    s_nop 0
    buffer_load_dwordx4 v232, s[8:11], s16 offen lds
    s_add_u32 m0, s19, 5120
    s_nop 0
    buffer_load_dwordx4 v233, s[8:11], s16 offen lds
    s_add_u32 m0, s19, 6144
    s_nop 0
    buffer_load_dwordx4 v234, s[8:11], s16 offen lds
    s_add_u32 s16, s16, 229376
    s_cmp_eq_u32 s16, s18
    s_cselect_b32 s16, s17, s16
    s_cmp_eq_u32 s27, 0
    s_cbranch_scc1 cs_44
cs_44_b:
    s_waitcnt vmcnt(18) lgkmcnt(0)
    s_barrier
    s_cmp_eq_u32 s27, 0
    s_cbranch_scc1 cs_45
cs_45_b:
    v_mfma_f32_16x16x32_bf16 v[0:3], v[96:99], v[144:147], 0
    ds_read_b128 v[160:163], v235 offset:8192
    ds_read_b128 v[164:167], v235 offset:9216
    v_mfma_f32_16x16x32_bf16 v[4:7], v[96:99], v[148:151], 0
    ds_read_b128 v[168:171], v235 offset:10240
    v_mfma_f32_16x16x32_bf16 v[8:11], v[96:99], v[152:155], 0
    ds_read_b128 v[172:175], v235 offset:11264
    v_mfma_f32_16x16x32_bf16 v[12:15], v[96:99], v[156:159], 0
    s_add_u32 m0, s19, 28800
    s_nop 0
    buffer_load_dwordx4 v228, s[8:11], s16 offen lds
    v_mfma_f32_16x16x32_bf16 v[48:51], v[108:111], v[144:147], 0
    ds_read_b64_tr_b16 v[120:121], v237 offset:0
    v_mfma_f32_16x16x32_bf16 v[52:55], v[108:111], v[148:151], 0
    ds_read_b64_tr_b16 v[122:123], v237 offset:3584
    v_mfma_f32_16x16x32_bf16 v[56:59], v[108:111], v[152:155], 0
    ds_read_b64_tr_b16 v[132:133], v237 offset:14400
    v_mfma_f32_16x16x32_bf16 v[60:63], v[108:111], v[156:159], 0
    s_add_u32 m0, s19, 29824
    s_nop 0
    buffer_load_dwordx4 v229, s[8:11], s16 offen lds
    v_mfma_f32_16x16x32_bf16 v[16:19], v[100:103], v[144:147], 0
    ds_read_b64_tr_b16 v[134:135], v237 offset:17984
    v_mfma_f32_16x16x32_bf16 v[20:23], v[100:103], v[148:151], 0
    ds_read_b64_tr_b16 v[124:125], v237 offset:32
    v_mfma_f32_16x16x32_bf16 v[24:27], v[100:103], v[152:155], 0
    ds_read_b64_tr_b16 v[126:127], v237 offset:3616
    v_mfma_f32_16x16x32_bf16 v[28:31], v[100:103], v[156:159], 0
    s_add_u32 m0, s19, 30848
    s_nop 0
    buffer_load_dwordx4 v230, s[8:11], s16 offen lds
    v_mfma_f32_16x16x32_bf16 v[64:67], v[112:115], v[144:147], 0
    ds_read_b64_tr_b16 v[136:137], v237 offset:14432
    v_mfma_f32_16x16x32_bf16 v[68:71], v[112:115], v[148:151], 0
    ds_read_b64_tr_b16 v[138:139], v237 offset:18016
    v_mfma_f32_16x16x32_bf16 v[72:75], v[112:115], v[152:155], 0
    ds_read_b64_tr_b16 v[128:129], v239 offset:0
    v_mfma_f32_16x16x32_bf16 v[76:79], v[112:115], v[156:159], 0
    s_add_u32 m0, s19, 31872
    s_nop 0
    buffer_load_dwordx4 v231, s[8:11], s16 offen lds
    s_add_u32 s16, s16, 229376
    s_cmp_eq_u32 s16, s18
    s_cselect_b32 s16, s17, s16
    v_mfma_f32_16x16x32_bf16 v[32:35], v[104:107], v[144:147], 0
    ds_read_b64_tr_b16 v[130:131], v239 offset:3584
    v_mfma_f32_16x16x32_bf16 v[36:39], v[104:107], v[148:151], 0
    ds_read_b64_tr_b16 v[140:141], v239 offset:14400
    v_mfma_f32_16x16x32_bf16 v[40:43], v[104:107], v[152:155], 0
    ds_read_b64_tr_b16 v[142:143], v239 offset:17984
    v_mfma_f32_16x16x32_bf16 v[44:47], v[104:107], v[156:159], 0
    s_add_u32 m0, s23, 0
    s_nop 0
    buffer_load_dwordx4 v249, s[80:83], s20 offen sc1 lds
    s_add_u32 s20, s20, 8192
    s_cmp_eq_u32 s20, s22
    s_cselect_b32 s20, s21, s20
    v_mfma_f32_16x16x32_bf16 v[80:83], v[116:119], v[144:147], 0
    v_mfma_f32_16x16x32_bf16 v[84:87], v[116:119], v[148:151], 0
    v_mfma_f32_16x16x32_bf16 v[88:91], v[116:119], v[152:155], 0
    v_mfma_f32_16x16x32_bf16 v[92:95], v[116:119], v[156:159], 0
    s_waitcnt vmcnt(14) lgkmcnt(0)
    s_barrier
    s_cmp_eq_u32 s27, 1
    s_cbranch_scc1 cs_46
cs_46_b:
    v_mfma_f32_16x16x32_bf16 v[0:3], v[120:123], v[160:163], v[0:3]
    ds_read_b128 v[144:147], v235 offset:16384
    ds_read_b128 v[148:151], v235 offset:17408
    v_mfma_f32_16x16x32_bf16 v[4:7], v[120:123], v[164:167], v[4:7]
    ds_read_b128 v[152:155], v235 offset:18432
    v_mfma_f32_16x16x32_bf16 v[8:11], v[120:123], v[168:171], v[8:11]
    ds_read_b128 v[156:159], v235 offset:19456
    v_mfma_f32_16x16x32_bf16 v[12:15], v[120:123], v[172:175], v[12:15]
    s_add_u32 m0, s19, 57600
    s_nop 0
    buffer_load_dwordx4 v228, s[8:11], s16 offen lds
    v_mfma_f32_16x16x32_bf16 v[48:51], v[132:135], v[160:163], v[48:51]
    ds_read_b64_tr_b16 v[96:97], v237 offset:28800
    v_mfma_f32_16x16x32_bf16 v[52:55], v[132:135], v[164:167], v[52:55]
    ds_read_b64_tr_b16 v[98:99], v237 offset:32384
    v_mfma_f32_16x16x32_bf16 v[56:59], v[132:135], v[168:171], v[56:59]
    ds_read_b64_tr_b16 v[108:109], v237 offset:43200
    v_mfma_f32_16x16x32_bf16 v[60:63], v[132:135], v[172:175], v[60:63]
    s_add_u32 m0, s19, 58624
    s_nop 0
    buffer_load_dwordx4 v229, s[8:11], s16 offen lds
    v_mfma_f32_16x16x32_bf16 v[16:19], v[124:127], v[160:163], v[16:19]
    ds_read_b64_tr_b16 v[110:111], v237 offset:46784
    v_mfma_f32_16x16x32_bf16 v[20:23], v[124:127], v[164:167], v[20:23]
    ds_read_b64_tr_b16 v[100:101], v237 offset:28832
    v_mfma_f32_16x16x32_bf16 v[24:27], v[124:127], v[168:171], v[24:27]
    ds_read_b64_tr_b16 v[102:103], v237 offset:32416
    v_mfma_f32_16x16x32_bf16 v[28:31], v[124:127], v[172:175], v[28:31]
    s_add_u32 m0, s19, 59648
    s_nop 0
    buffer_load_dwordx4 v230, s[8:11], s16 offen lds
    v_mfma_f32_16x16x32_bf16 v[64:67], v[136:139], v[160:163], v[64:67]
    ds_read_b64_tr_b16 v[112:113], v237 offset:43232
    v_mfma_f32_16x16x32_bf16 v[68:71], v[136:139], v[164:167], v[68:71]
    ds_read_b64_tr_b16 v[114:115], v237 offset:46816
    v_mfma_f32_16x16x32_bf16 v[72:75], v[136:139], v[168:171], v[72:75]
    ds_read_b64_tr_b16 v[104:105], v239 offset:28800
    v_mfma_f32_16x16x32_bf16 v[76:79], v[136:139], v[172:175], v[76:79]
    s_add_u32 m0, s19, 60672
    s_nop 0
    buffer_load_dwordx4 v231, s[8:11], s16 offen lds
    s_add_u32 s16, s16, 229376
    s_cmp_eq_u32 s16, s18
    s_cselect_b32 s16, s17, s16
    v_mfma_f32_16x16x32_bf16 v[32:35], v[128:131], v[160:163], v[32:35]
    ds_read_b64_tr_b16 v[106:107], v239 offset:32384
    v_mfma_f32_16x16x32_bf16 v[36:39], v[128:131], v[164:167], v[36:39]
    ds_read_b64_tr_b16 v[116:117], v239 offset:43200
    v_mfma_f32_16x16x32_bf16 v[40:43], v[128:131], v[168:171], v[40:43]
    ds_read_b64_tr_b16 v[118:119], v239 offset:46784
    v_mfma_f32_16x16x32_bf16 v[44:47], v[128:131], v[172:175], v[44:47]
    s_add_u32 m0, s23, 8192
    s_nop 0
    buffer_load_dwordx4 v249, s[80:83], s20 offen sc1 lds
    s_add_u32 s20, s20, 8192
    s_cmp_eq_u32 s20, s22
    s_cselect_b32 s20, s21, s20
    v_mfma_f32_16x16x32_bf16 v[80:83], v[140:143], v[160:163], v[80:83]
    v_mfma_f32_16x16x32_bf16 v[84:87], v[140:143], v[164:167], v[84:87]
    v_mfma_f32_16x16x32_bf16 v[88:91], v[140:143], v[168:171], v[88:91]
    v_mfma_f32_16x16x32_bf16 v[92:95], v[140:143], v[172:175], v[92:95]
    s_waitcnt vmcnt(10) lgkmcnt(0)
    s_barrier
    s_cmp_eq_u32 s27, 1
    s_cbranch_scc1 cs_47
cs_47_b:
    v_mfma_f32_16x16x32_bf16 v[0:3], v[96:99], v[144:147], v[0:3]
    ds_read_b128 v[160:163], v235 offset:24576
    ds_read_b128 v[164:167], v235 offset:25600
    v_mfma_f32_16x16x32_bf16 v[4:7], v[96:99], v[148:151], v[4:7]
    ds_read_b128 v[168:171], v235 offset:26624
    v_mfma_f32_16x16x32_bf16 v[8:11], v[96:99], v[152:155], v[8:11]
    ds_read_b128 v[172:175], v235 offset:27648
    v_mfma_f32_16x16x32_bf16 v[12:15], v[96:99], v[156:159], v[12:15]
    s_add_u32 m0, s19, 86400
    s_nop 0
    buffer_load_dwordx4 v228, s[8:11], s16 offen lds
    v_mfma_f32_16x16x32_bf16 v[48:51], v[108:111], v[144:147], v[48:51]
    ds_read_b64_tr_b16 v[120:121], v236 offset:0
    v_mfma_f32_16x16x32_bf16 v[52:55], v[108:111], v[148:151], v[52:55]
    ds_read_b64_tr_b16 v[122:123], v236 offset:3584
    v_mfma_f32_16x16x32_bf16 v[56:59], v[108:111], v[152:155], v[56:59]
    ds_read_b64_tr_b16 v[132:133], v236 offset:14400
    v_mfma_f32_16x16x32_bf16 v[60:63], v[108:111], v[156:159], v[60:63]
    s_add_u32 m0, s19, 87424
    s_nop 0
    buffer_load_dwordx4 v229, s[8:11], s16 offen lds
    v_mfma_f32_16x16x32_bf16 v[16:19], v[100:103], v[144:147], v[16:19]
    ds_read_b64_tr_b16 v[134:135], v236 offset:17984
    v_mfma_f32_16x16x32_bf16 v[20:23], v[100:103], v[148:151], v[20:23]
    ds_read_b64_tr_b16 v[124:125], v236 offset:32
    v_mfma_f32_16x16x32_bf16 v[24:27], v[100:103], v[152:155], v[24:27]
    ds_read_b64_tr_b16 v[126:127], v236 offset:3616
    v_mfma_f32_16x16x32_bf16 v[28:31], v[100:103], v[156:159], v[28:31]
    s_add_u32 m0, s19, 88448
    s_nop 0
    buffer_load_dwordx4 v230, s[8:11], s16 offen lds
    v_mfma_f32_16x16x32_bf16 v[64:67], v[112:115], v[144:147], v[64:67]
    ds_read_b64_tr_b16 v[136:137], v236 offset:14432
    v_mfma_f32_16x16x32_bf16 v[68:71], v[112:115], v[148:151], v[68:71]
    ds_read_b64_tr_b16 v[138:139], v236 offset:18016
    v_mfma_f32_16x16x32_bf16 v[72:75], v[112:115], v[152:155], v[72:75]
    ds_read_b64_tr_b16 v[128:129], v238 offset:0
    v_mfma_f32_16x16x32_bf16 v[76:79], v[112:115], v[156:159], v[76:79]
    s_add_u32 m0, s19, 89472
    s_nop 0
    buffer_load_dwordx4 v231, s[8:11], s16 offen lds
    s_add_u32 s16, s16, 229376
    s_cmp_eq_u32 s16, s18
    s_cselect_b32 s16, s17, s16
    v_mfma_f32_16x16x32_bf16 v[32:35], v[104:107], v[144:147], v[32:35]
    ds_read_b64_tr_b16 v[130:131], v238 offset:3584
    v_mfma_f32_16x16x32_bf16 v[36:39], v[104:107], v[148:151], v[36:39]
    ds_read_b64_tr_b16 v[140:141], v238 offset:14400
    v_mfma_f32_16x16x32_bf16 v[40:43], v[104:107], v[152:155], v[40:43]
    ds_read_b64_tr_b16 v[142:143], v238 offset:17984
    v_mfma_f32_16x16x32_bf16 v[44:47], v[104:107], v[156:159], v[44:47]
    s_add_u32 m0, s23, 16384
    s_nop 0
    buffer_load_dwordx4 v249, s[80:83], s20 offen sc1 lds
    s_add_u32 s20, s20, 8192
    s_cmp_eq_u32 s20, s22
    s_cselect_b32 s20, s21, s20
    v_mfma_f32_16x16x32_bf16 v[80:83], v[116:119], v[144:147], v[80:83]
    v_mfma_f32_16x16x32_bf16 v[84:87], v[116:119], v[148:151], v[84:87]
    v_mfma_f32_16x16x32_bf16 v[88:91], v[116:119], v[152:155], v[88:91]
    v_mfma_f32_16x16x32_bf16 v[92:95], v[116:119], v[156:159], v[92:95]
    s_waitcnt vmcnt(10) lgkmcnt(0)
    s_barrier
    v_mfma_f32_16x16x32_bf16 v[0:3], v[120:123], v[160:163], v[0:3]
    ds_read_b128 v[144:147], v235 offset:0
    ds_read_b128 v[148:151], v235 offset:1024
    v_mfma_f32_16x16x32_bf16 v[4:7], v[120:123], v[164:167], v[4:7]
    ds_read_b128 v[152:155], v235 offset:2048
    v_mfma_f32_16x16x32_bf16 v[8:11], v[120:123], v[168:171], v[8:11]
    ds_read_b128 v[156:159], v235 offset:3072
    v_mfma_f32_16x16x32_bf16 v[12:15], v[120:123], v[172:175], v[12:15]
    s_add_u32 m0, s19, 0
    s_nop 0
    buffer_load_dwordx4 v228, s[8:11], s16 offen lds
    v_mfma_f32_16x16x32_bf16 v[48:51], v[132:135], v[160:163], v[48:51]
    ds_read_b64_tr_b16 v[96:97], v236 offset:28800
    v_mfma_f32_16x16x32_bf16 v[52:55], v[132:135], v[164:167], v[52:55]
    ds_read_b64_tr_b16 v[98:99], v236 offset:32384
    v_mfma_f32_16x16x32_bf16 v[56:59], v[132:135], v[168:171], v[56:59]
    ds_read_b64_tr_b16 v[108:109], v236 offset:43200
    v_mfma_f32_16x16x32_bf16 v[60:63], v[132:135], v[172:175], v[60:63]
    s_add_u32 m0, s19, 1024
    s_nop 0
    buffer_load_dwordx4 v229, s[8:11], s16 offen lds
    v_mfma_f32_16x16x32_bf16 v[16:19], v[124:127], v[160:163], v[16:19]
    ds_read_b64_tr_b16 v[110:111], v236 offset:46784
    v_mfma_f32_16x16x32_bf16 v[20:23], v[124:127], v[164:167], v[20:23]
    ds_read_b64_tr_b16 v[100:101], v236 offset:28832
    v_mfma_f32_16x16x32_bf16 v[24:27], v[124:127], v[168:171], v[24:27]
    ds_read_b64_tr_b16 v[102:103], v236 offset:32416
    v_mfma_f32_16x16x32_bf16 v[28:31], v[124:127], v[172:175], v[28:31]
    s_add_u32 m0, s19, 2048
    s_nop 0
    buffer_load_dwordx4 v230, s[8:11], s16 offen lds
    v_mfma_f32_16x16x32_bf16 v[64:67], v[136:139], v[160:163], v[64:67]
    ds_read_b64_tr_b16 v[112:113], v236 offset:43232
    v_mfma_f32_16x16x32_bf16 v[68:71], v[136:139], v[164:167], v[68:71]
    ds_read_b64_tr_b16 v[114:115], v236 offset:46816
    v_mfma_f32_16x16x32_bf16 v[72:75], v[136:139], v[168:171], v[72:75]
    ds_read_b64_tr_b16 v[104:105], v238 offset:28800
    v_mfma_f32_16x16x32_bf16 v[76:79], v[136:139], v[172:175], v[76:79]
    s_add_u32 m0, s19, 3072
    s_nop 0
    buffer_load_dwordx4 v231, s[8:11], s16 offen lds
    s_add_u32 s16, s16, 229376
    s_cmp_eq_u32 s16, s18
    s_cselect_b32 s16, s17, s16
    v_mfma_f32_16x16x32_bf16 v[32:35], v[128:131], v[160:163], v[32:35]
    ds_read_b64_tr_b16 v[106:107], v238 offset:32384
    v_mfma_f32_16x16x32_bf16 v[36:39], v[128:131], v[164:167], v[36:39]
    ds_read_b64_tr_b16 v[116:117], v238 offset:43200
    v_mfma_f32_16x16x32_bf16 v[40:43], v[128:131], v[168:171], v[40:43]
    ds_read_b64_tr_b16 v[118:119], v238 offset:46784
    v_mfma_f32_16x16x32_bf16 v[44:47], v[128:131], v[172:175], v[44:47]
    s_add_u32 m0, s23, 24576
    s_nop 0
    buffer_load_dwordx4 v249, s[80:83], s20 offen sc1 lds
    s_add_u32 s20, s20, 8192
    s_cmp_eq_u32 s20, s22
    s_cselect_b32 s20, s21, s20
    v_mfma_f32_16x16x32_bf16 v[80:83], v[140:143], v[160:163], v[80:83]
    v_mfma_f32_16x16x32_bf16 v[84:87], v[140:143], v[164:167], v[84:87]
    v_mfma_f32_16x16x32_bf16 v[88:91], v[140:143], v[168:171], v[88:91]
    v_mfma_f32_16x16x32_bf16 v[92:95], v[140:143], v[172:175], v[92:95]
    s_mov_b32 s24, 6
    s_cmp_eq_u32 s75, 0
    s_cselect_b32 s27, 6, 0
    s_or_b32 s27, s27, 0x60
g3c1_loop:
    s_waitcnt vmcnt(10) lgkmcnt(0)
    s_barrier
    s_bitcmp1_b32 s27, s24
    s_cbranch_scc1 g3c1_hook
g3c1_hb:
    v_mfma_f32_16x16x32_bf16 v[0:3], v[96:99], v[144:147], v[0:3]
    ds_read_b128 v[160:163], v235 offset:8192
    ds_read_b128 v[164:167], v235 offset:9216
    v_mfma_f32_16x16x32_bf16 v[4:7], v[96:99], v[148:151], v[4:7]
    ds_read_b128 v[168:171], v235 offset:10240
    v_mfma_f32_16x16x32_bf16 v[8:11], v[96:99], v[152:155], v[8:11]
    ds_read_b128 v[172:175], v235 offset:11264
    v_mfma_f32_16x16x32_bf16 v[12:15], v[96:99], v[156:159], v[12:15]
    s_add_u32 m0, s19, 28800
    s_nop 0
    buffer_load_dwordx4 v228, s[8:11], s16 offen lds
    v_mfma_f32_16x16x32_bf16 v[48:51], v[108:111], v[144:147], v[48:51]
    ds_read_b64_tr_b16 v[120:121], v237 offset:0
    v_mfma_f32_16x16x32_bf16 v[52:55], v[108:111], v[148:151], v[52:55]
    ds_read_b64_tr_b16 v[122:123], v237 offset:3584
    v_mfma_f32_16x16x32_bf16 v[56:59], v[108:111], v[152:155], v[56:59]
    ds_read_b64_tr_b16 v[132:133], v237 offset:14400
    v_mfma_f32_16x16x32_bf16 v[60:63], v[108:111], v[156:159], v[60:63]
    s_add_u32 m0, s19, 29824
    s_nop 0
    buffer_load_dwordx4 v229, s[8:11], s16 offen lds
    v_mfma_f32_16x16x32_bf16 v[16:19], v[100:103], v[144:147], v[16:19]
    ds_read_b64_tr_b16 v[134:135], v237 offset:17984
    v_mfma_f32_16x16x32_bf16 v[20:23], v[100:103], v[148:151], v[20:23]
    ds_read_b64_tr_b16 v[124:125], v237 offset:32
    v_mfma_f32_16x16x32_bf16 v[24:27], v[100:103], v[152:155], v[24:27]
    ds_read_b64_tr_b16 v[126:127], v237 offset:3616
    v_mfma_f32_16x16x32_bf16 v[28:31], v[100:103], v[156:159], v[28:31]
    s_add_u32 m0, s19, 30848
    s_nop 0
    buffer_load_dwordx4 v230, s[8:11], s16 offen lds
    v_mfma_f32_16x16x32_bf16 v[64:67], v[112:115], v[144:147], v[64:67]
    ds_read_b64_tr_b16 v[136:137], v237 offset:14432
    v_mfma_f32_16x16x32_bf16 v[68:71], v[112:115], v[148:151], v[68:71]
    ds_read_b64_tr_b16 v[138:139], v237 offset:18016
    v_mfma_f32_16x16x32_bf16 v[72:75], v[112:115], v[152:155], v[72:75]
    ds_read_b64_tr_b16 v[128:129], v239 offset:0
    v_mfma_f32_16x16x32_bf16 v[76:79], v[112:115], v[156:159], v[76:79]
    s_add_u32 m0, s19, 31872
    s_nop 0
    buffer_load_dwordx4 v231, s[8:11], s16 offen lds
    s_add_u32 s16, s16, 229376
    s_cmp_eq_u32 s16, s18
    s_cselect_b32 s16, s17, s16
    v_mfma_f32_16x16x32_bf16 v[32:35], v[104:107], v[144:147], v[32:35]
    ds_read_b64_tr_b16 v[130:131], v239 offset:3584
    v_mfma_f32_16x16x32_bf16 v[36:39], v[104:107], v[148:151], v[36:39]
    ds_read_b64_tr_b16 v[140:141], v239 offset:14400
    v_mfma_f32_16x16x32_bf16 v[40:43], v[104:107], v[152:155], v[40:43]
    ds_read_b64_tr_b16 v[142:143], v239 offset:17984
    v_mfma_f32_16x16x32_bf16 v[44:47], v[104:107], v[156:159], v[44:47]
    s_add_u32 m0, s23, 0
    s_nop 0
    buffer_load_dwordx4 v249, s[80:83], s20 offen sc1 lds
    s_add_u32 s20, s20, 8192
    s_cmp_eq_u32 s20, s22
    s_cselect_b32 s20, s21, s20
    v_mfma_f32_16x16x32_bf16 v[80:83], v[116:119], v[144:147], v[80:83]
    v_mfma_f32_16x16x32_bf16 v[84:87], v[116:119], v[148:151], v[84:87]
    v_mfma_f32_16x16x32_bf16 v[88:91], v[116:119], v[152:155], v[88:91]
    v_mfma_f32_16x16x32_bf16 v[92:95], v[116:119], v[156:159], v[92:95]
    s_waitcnt vmcnt(10) lgkmcnt(0)
    s_barrier
    v_mfma_f32_16x16x32_bf16 v[0:3], v[120:123], v[160:163], v[0:3]
    ds_read_b128 v[144:147], v235 offset:16384
    ds_read_b128 v[148:151], v235 offset:17408
    v_mfma_f32_16x16x32_bf16 v[4:7], v[120:123], v[164:167], v[4:7]
    ds_read_b128 v[152:155], v235 offset:18432
    v_mfma_f32_16x16x32_bf16 v[8:11], v[120:123], v[168:171], v[8:11]
    ds_read_b128 v[156:159], v235 offset:19456
    v_mfma_f32_16x16x32_bf16 v[12:15], v[120:123], v[172:175], v[12:15]
    s_add_u32 m0, s19, 57600
    s_nop 0
    buffer_load_dwordx4 v228, s[8:11], s16 offen lds
    v_mfma_f32_16x16x32_bf16 v[48:51], v[132:135], v[160:163], v[48:51]
    ds_read_b64_tr_b16 v[96:97], v237 offset:28800
    v_mfma_f32_16x16x32_bf16 v[52:55], v[132:135], v[164:167], v[52:55]
    ds_read_b64_tr_b16 v[98:99], v237 offset:32384
    v_mfma_f32_16x16x32_bf16 v[56:59], v[132:135], v[168:171], v[56:59]
    ds_read_b64_tr_b16 v[108:109], v237 offset:43200
    v_mfma_f32_16x16x32_bf16 v[60:63], v[132:135], v[172:175], v[60:63]
    s_add_u32 m0, s19, 58624
    s_nop 0
    buffer_load_dwordx4 v229, s[8:11], s16 offen lds
    v_mfma_f32_16x16x32_bf16 v[16:19], v[124:127], v[160:163], v[16:19]
    ds_read_b64_tr_b16 v[110:111], v237 offset:46784
    v_mfma_f32_16x16x32_bf16 v[20:23], v[124:127], v[164:167], v[20:23]
    ds_read_b64_tr_b16 v[100:101], v237 offset:28832
    v_mfma_f32_16x16x32_bf16 v[24:27], v[124:127], v[168:171], v[24:27]
    ds_read_b64_tr_b16 v[102:103], v237 offset:32416
    v_mfma_f32_16x16x32_bf16 v[28:31], v[124:127], v[172:175], v[28:31]
    s_add_u32 m0, s19, 59648
    s_nop 0
    buffer_load_dwordx4 v230, s[8:11], s16 offen lds
    v_mfma_f32_16x16x32_bf16 v[64:67], v[136:139], v[160:163], v[64:67]
    ds_read_b64_tr_b16 v[112:113], v237 offset:43232
    v_mfma_f32_16x16x32_bf16 v[68:71], v[136:139], v[164:167], v[68:71]
    ds_read_b64_tr_b16 v[114:115], v237 offset:46816
    v_mfma_f32_16x16x32_bf16 v[72:75], v[136:139], v[168:171], v[72:75]
    ds_read_b64_tr_b16 v[104:105], v239 offset:28800
    v_mfma_f32_16x16x32_bf16 v[76:79], v[136:139], v[172:175], v[76:79]
    s_add_u32 m0, s19, 60672
    s_nop 0
    buffer_load_dwordx4 v231, s[8:11], s16 offen lds
    s_add_u32 s16, s16, 229376
    s_cmp_eq_u32 s16, s18
    s_cselect_b32 s16, s17, s16
    v_mfma_f32_16x16x32_bf16 v[32:35], v[128:131], v[160:163], v[32:35]
    ds_read_b64_tr_b16 v[106:107], v239 offset:32384
    v_mfma_f32_16x16x32_bf16 v[36:39], v[128:131], v[164:167], v[36:39]
    ds_read_b64_tr_b16 v[116:117], v239 offset:43200
    v_mfma_f32_16x16x32_bf16 v[40:43], v[128:131], v[168:171], v[40:43]
    ds_read_b64_tr_b16 v[118:119], v239 offset:46784
    v_mfma_f32_16x16x32_bf16 v[44:47], v[128:131], v[172:175], v[44:47]
    s_add_u32 m0, s23, 8192
    s_nop 0
    buffer_load_dwordx4 v249, s[80:83], s20 offen sc1 lds
    s_add_u32 s20, s20, 8192
    s_cmp_eq_u32 s20, s22
    s_cselect_b32 s20, s21, s20
    v_mfma_f32_16x16x32_bf16 v[80:83], v[140:143], v[160:163], v[80:83]
    v_mfma_f32_16x16x32_bf16 v[84:87], v[140:143], v[164:167], v[84:87]
    v_mfma_f32_16x16x32_bf16 v[88:91], v[140:143], v[168:171], v[88:91]
    v_mfma_f32_16x16x32_bf16 v[92:95], v[140:143], v[172:175], v[92:95]
    s_waitcnt vmcnt(10) lgkmcnt(0)
    s_barrier
    v_mfma_f32_16x16x32_bf16 v[0:3], v[96:99], v[144:147], v[0:3]
    ds_read_b128 v[160:163], v235 offset:24576
    ds_read_b128 v[164:167], v235 offset:25600
    v_mfma_f32_16x16x32_bf16 v[4:7], v[96:99], v[148:151], v[4:7]
    ds_read_b128 v[168:171], v235 offset:26624
    v_mfma_f32_16x16x32_bf16 v[8:11], v[96:99], v[152:155], v[8:11]
    ds_read_b128 v[172:175], v235 offset:27648
    v_mfma_f32_16x16x32_bf16 v[12:15], v[96:99], v[156:159], v[12:15]
    s_add_u32 m0, s19, 86400
    s_nop 0
    buffer_load_dwordx4 v228, s[8:11], s16 offen lds
    v_mfma_f32_16x16x32_bf16 v[48:51], v[108:111], v[144:147], v[48:51]
    ds_read_b64_tr_b16 v[120:121], v236 offset:0
    v_mfma_f32_16x16x32_bf16 v[52:55], v[108:111], v[148:151], v[52:55]
    ds_read_b64_tr_b16 v[122:123], v236 offset:3584
    v_mfma_f32_16x16x32_bf16 v[56:59], v[108:111], v[152:155], v[56:59]
    ds_read_b64_tr_b16 v[132:133], v236 offset:14400
    v_mfma_f32_16x16x32_bf16 v[60:63], v[108:111], v[156:159], v[60:63]
    s_add_u32 m0, s19, 87424
    s_nop 0
    buffer_load_dwordx4 v229, s[8:11], s16 offen lds
    v_mfma_f32_16x16x32_bf16 v[16:19], v[100:103], v[144:147], v[16:19]
    ds_read_b64_tr_b16 v[134:135], v236 offset:17984
    v_mfma_f32_16x16x32_bf16 v[20:23], v[100:103], v[148:151], v[20:23]
    ds_read_b64_tr_b16 v[124:125], v236 offset:32
    v_mfma_f32_16x16x32_bf16 v[24:27], v[100:103], v[152:155], v[24:27]
    ds_read_b64_tr_b16 v[126:127], v236 offset:3616
    v_mfma_f32_16x16x32_bf16 v[28:31], v[100:103], v[156:159], v[28:31]
    s_add_u32 m0, s19, 88448
    s_nop 0
    buffer_load_dwordx4 v230, s[8:11], s16 offen lds
    v_mfma_f32_16x16x32_bf16 v[64:67], v[112:115], v[144:147], v[64:67]
    ds_read_b64_tr_b16 v[136:137], v236 offset:14432
    v_mfma_f32_16x16x32_bf16 v[68:71], v[112:115], v[148:151], v[68:71]
    ds_read_b64_tr_b16 v[138:139], v236 offset:18016
    v_mfma_f32_16x16x32_bf16 v[72:75], v[112:115], v[152:155], v[72:75]
    ds_read_b64_tr_b16 v[128:129], v238 offset:0
    v_mfma_f32_16x16x32_bf16 v[76:79], v[112:115], v[156:159], v[76:79]
    s_add_u32 m0, s19, 89472
    s_nop 0
    buffer_load_dwordx4 v231, s[8:11], s16 offen lds
    s_add_u32 s16, s16, 229376
    s_cmp_eq_u32 s16, s18
    s_cselect_b32 s16, s17, s16
    v_mfma_f32_16x16x32_bf16 v[32:35], v[104:107], v[144:147], v[32:35]
    ds_read_b64_tr_b16 v[130:131], v238 offset:3584
    v_mfma_f32_16x16x32_bf16 v[36:39], v[104:107], v[148:151], v[36:39]
    ds_read_b64_tr_b16 v[140:141], v238 offset:14400
    v_mfma_f32_16x16x32_bf16 v[40:43], v[104:107], v[152:155], v[40:43]
    ds_read_b64_tr_b16 v[142:143], v238 offset:17984
    v_mfma_f32_16x16x32_bf16 v[44:47], v[104:107], v[156:159], v[44:47]
    s_add_u32 m0, s23, 16384
    s_nop 0
    buffer_load_dwordx4 v249, s[80:83], s20 offen sc1 lds
    s_add_u32 s20, s20, 8192
    s_cmp_eq_u32 s20, s22
    s_cselect_b32 s20, s21, s20
    v_mfma_f32_16x16x32_bf16 v[80:83], v[116:119], v[144:147], v[80:83]
    v_mfma_f32_16x16x32_bf16 v[84:87], v[116:119], v[148:151], v[84:87]
    v_mfma_f32_16x16x32_bf16 v[88:91], v[116:119], v[152:155], v[88:91]
    v_mfma_f32_16x16x32_bf16 v[92:95], v[116:119], v[156:159], v[92:95]
    s_waitcnt vmcnt(10) lgkmcnt(0)
    s_barrier
    v_mfma_f32_16x16x32_bf16 v[0:3], v[120:123], v[160:163], v[0:3]
    ds_read_b128 v[144:147], v235 offset:0
    ds_read_b128 v[148:151], v235 offset:1024
    v_mfma_f32_16x16x32_bf16 v[4:7], v[120:123], v[164:167], v[4:7]
    ds_read_b128 v[152:155], v235 offset:2048
    v_mfma_f32_16x16x32_bf16 v[8:11], v[120:123], v[168:171], v[8:11]
    ds_read_b128 v[156:159], v235 offset:3072
    v_mfma_f32_16x16x32_bf16 v[12:15], v[120:123], v[172:175], v[12:15]
    s_add_u32 m0, s19, 0
    s_nop 0
    buffer_load_dwordx4 v228, s[8:11], s16 offen lds
    v_mfma_f32_16x16x32_bf16 v[48:51], v[132:135], v[160:163], v[48:51]
    ds_read_b64_tr_b16 v[96:97], v236 offset:28800
    v_mfma_f32_16x16x32_bf16 v[52:55], v[132:135], v[164:167], v[52:55]
    ds_read_b64_tr_b16 v[98:99], v236 offset:32384
    v_mfma_f32_16x16x32_bf16 v[56:59], v[132:135], v[168:171], v[56:59]
    ds_read_b64_tr_b16 v[108:109], v236 offset:43200
    v_mfma_f32_16x16x32_bf16 v[60:63], v[132:135], v[172:175], v[60:63]
    s_add_u32 m0, s19, 1024
    s_nop 0
    buffer_load_dwordx4 v229, s[8:11], s16 offen lds
    v_mfma_f32_16x16x32_bf16 v[16:19], v[124:127], v[160:163], v[16:19]
    ds_read_b64_tr_b16 v[110:111], v236 offset:46784
    v_mfma_f32_16x16x32_bf16 v[20:23], v[124:127], v[164:167], v[20:23]
    ds_read_b64_tr_b16 v[100:101], v236 offset:28832
    v_mfma_f32_16x16x32_bf16 v[24:27], v[124:127], v[168:171], v[24:27]
    ds_read_b64_tr_b16 v[102:103], v236 offset:32416
    v_mfma_f32_16x16x32_bf16 v[28:31], v[124:127], v[172:175], v[28:31]
    s_add_u32 m0, s19, 2048
    s_nop 0
    buffer_load_dwordx4 v230, s[8:11], s16 offen lds
    v_mfma_f32_16x16x32_bf16 v[64:67], v[136:139], v[160:163], v[64:67]
    ds_read_b64_tr_b16 v[112:113], v236 offset:43232
    v_mfma_f32_16x16x32_bf16 v[68:71], v[136:139], v[164:167], v[68:71]
    ds_read_b64_tr_b16 v[114:115], v236 offset:46816
    v_mfma_f32_16x16x32_bf16 v[72:75], v[136:139], v[168:171], v[72:75]
    ds_read_b64_tr_b16 v[104:105], v238 offset:28800
    v_mfma_f32_16x16x32_bf16 v[76:79], v[136:139], v[172:175], v[76:79]
    s_add_u32 m0, s19, 3072
    s_nop 0
    buffer_load_dwordx4 v231, s[8:11], s16 offen lds
    s_add_u32 s16, s16, 229376
    s_cmp_eq_u32 s16, s18
    s_cselect_b32 s16, s17, s16
    v_mfma_f32_16x16x32_bf16 v[32:35], v[128:131], v[160:163], v[32:35]
    ds_read_b64_tr_b16 v[106:107], v238 offset:32384
    v_mfma_f32_16x16x32_bf16 v[36:39], v[128:131], v[164:167], v[36:39]
    ds_read_b64_tr_b16 v[116:117], v238 offset:43200
    v_mfma_f32_16x16x32_bf16 v[40:43], v[128:131], v[168:171], v[40:43]
    ds_read_b64_tr_b16 v[118:119], v238 offset:46784
    v_mfma_f32_16x16x32_bf16 v[44:47], v[128:131], v[172:175], v[44:47]
    s_add_u32 m0, s23, 24576
    s_nop 0
    buffer_load_dwordx4 v249, s[80:83], s20 offen sc1 lds
    s_add_u32 s20, s20, 8192
    s_cmp_eq_u32 s20, s22
    s_cselect_b32 s20, s21, s20
    v_mfma_f32_16x16x32_bf16 v[80:83], v[140:143], v[160:163], v[80:83]
    v_mfma_f32_16x16x32_bf16 v[84:87], v[140:143], v[164:167], v[84:87]
    v_mfma_f32_16x16x32_bf16 v[88:91], v[140:143], v[168:171], v[88:91]
    v_mfma_f32_16x16x32_bf16 v[92:95], v[140:143], v[172:175], v[92:95]
    s_sub_u32 s24, s24, 1
    s_cmp_lg_u32 s24, 0
    s_cbranch_scc1 g3c1_loop
    s_sub_u32 s27, s74, s58
    s_and_b32 s27, s27, 7
    s_cmp_lt_u32 s27, 4
    s_cselect_b32 s27, 14, 0
    s_waitcnt vmcnt(10) lgkmcnt(0)
    s_barrier
    v_mfma_f32_16x16x32_bf16 v[0:3], v[96:99], v[144:147], v[0:3]
    ds_read_b128 v[160:163], v235 offset:8192
    v_mfma_f32_16x16x32_bf16 v[4:7], v[96:99], v[148:151], v[4:7]
    ds_read_b128 v[164:167], v235 offset:9216
    v_mfma_f32_16x16x32_bf16 v[8:11], v[96:99], v[152:155], v[8:11]
    ds_read_b128 v[168:171], v235 offset:10240
    v_mfma_f32_16x16x32_bf16 v[12:15], v[96:99], v[156:159], v[12:15]
    ds_read_b128 v[172:175], v235 offset:11264
    v_mfma_f32_16x16x32_bf16 v[48:51], v[108:111], v[144:147], v[48:51]
    v_mfma_f32_16x16x32_bf16 v[52:55], v[108:111], v[148:151], v[52:55]
    ds_read_b64_tr_b16 v[120:121], v237 offset:0
    v_mfma_f32_16x16x32_bf16 v[56:59], v[108:111], v[152:155], v[56:59]
    ds_read_b64_tr_b16 v[122:123], v237 offset:3584
    v_mfma_f32_16x16x32_bf16 v[60:63], v[108:111], v[156:159], v[60:63]
    ds_read_b64_tr_b16 v[132:133], v237 offset:14400
    v_mfma_f32_16x16x32_bf16 v[16:19], v[100:103], v[144:147], v[16:19]
    ds_read_b64_tr_b16 v[134:135], v237 offset:17984
    v_mfma_f32_16x16x32_bf16 v[20:23], v[100:103], v[148:151], v[20:23]
    v_mfma_f32_16x16x32_bf16 v[24:27], v[100:103], v[152:155], v[24:27]
    ds_read_b64_tr_b16 v[124:125], v237 offset:32
    v_mfma_f32_16x16x32_bf16 v[28:31], v[100:103], v[156:159], v[28:31]
    ds_read_b64_tr_b16 v[126:127], v237 offset:3616
    v_mfma_f32_16x16x32_bf16 v[64:67], v[112:115], v[144:147], v[64:67]
    ds_read_b64_tr_b16 v[136:137], v237 offset:14432
    v_mfma_f32_16x16x32_bf16 v[68:71], v[112:115], v[148:151], v[68:71]
    ds_read_b64_tr_b16 v[138:139], v237 offset:18016
    v_mfma_f32_16x16x32_bf16 v[72:75], v[112:115], v[152:155], v[72:75]
    v_mfma_f32_16x16x32_bf16 v[76:79], v[112:115], v[156:159], v[76:79]
    ds_read_b64_tr_b16 v[128:129], v239 offset:0
    v_mfma_f32_16x16x32_bf16 v[32:35], v[104:107], v[144:147], v[32:35]
    ds_read_b64_tr_b16 v[130:131], v239 offset:3584
    v_mfma_f32_16x16x32_bf16 v[36:39], v[104:107], v[148:151], v[36:39]
    ds_read_b64_tr_b16 v[140:141], v239 offset:14400
    v_mfma_f32_16x16x32_bf16 v[40:43], v[104:107], v[152:155], v[40:43]
    ds_read_b64_tr_b16 v[142:143], v239 offset:17984
    v_mfma_f32_16x16x32_bf16 v[44:47], v[104:107], v[156:159], v[44:47]
    v_mfma_f32_16x16x32_bf16 v[80:83], v[116:119], v[144:147], v[80:83]
    v_mfma_f32_16x16x32_bf16 v[84:87], v[116:119], v[148:151], v[84:87]
    v_lshlrev_b32 v228, 7, v250
    s_add_u32 s64, s3, 0
    s_lshl_b32 s65, s64, 12
    s_add_u32 s65, s65, s25
    s_cmp_lt_u32 s64, s27
    s_cselect_b32 s65, s65, 0x7f000000
    s_mov_b64 exec, 0xffffffff
    buffer_load_dword v229, v228, s[80:83], s65 offen sc1
    s_mov_b64 exec, -1
    v_mfma_f32_16x16x32_bf16 v[88:91], v[116:119], v[152:155], v[88:91]
    v_mfma_f32_16x16x32_bf16 v[92:95], v[116:119], v[156:159], v[92:95]
    s_waitcnt vmcnt(6) lgkmcnt(0)
    s_barrier
    v_mfma_f32_16x16x32_bf16 v[0:3], v[120:123], v[160:163], v[0:3]
    ds_read_b128 v[144:147], v235 offset:16384
    v_mfma_f32_16x16x32_bf16 v[4:7], v[120:123], v[164:167], v[4:7]
    ds_read_b128 v[148:151], v235 offset:17408
    v_mfma_f32_16x16x32_bf16 v[8:11], v[120:123], v[168:171], v[8:11]
    ds_read_b128 v[152:155], v235 offset:18432
    v_mfma_f32_16x16x32_bf16 v[12:15], v[120:123], v[172:175], v[12:15]
    ds_read_b128 v[156:159], v235 offset:19456
    v_mfma_f32_16x16x32_bf16 v[48:51], v[132:135], v[160:163], v[48:51]
    v_mfma_f32_16x16x32_bf16 v[52:55], v[132:135], v[164:167], v[52:55]
    ds_read_b64_tr_b16 v[96:97], v237 offset:28800
    v_mfma_f32_16x16x32_bf16 v[56:59], v[132:135], v[168:171], v[56:59]
    ds_read_b64_tr_b16 v[98:99], v237 offset:32384
    v_mfma_f32_16x16x32_bf16 v[60:63], v[132:135], v[172:175], v[60:63]
    ds_read_b64_tr_b16 v[108:109], v237 offset:43200
    v_mfma_f32_16x16x32_bf16 v[16:19], v[124:127], v[160:163], v[16:19]
    ds_read_b64_tr_b16 v[110:111], v237 offset:46784
    v_mfma_f32_16x16x32_bf16 v[20:23], v[124:127], v[164:167], v[20:23]
    v_mfma_f32_16x16x32_bf16 v[24:27], v[124:127], v[168:171], v[24:27]
    ds_read_b64_tr_b16 v[100:101], v237 offset:28832
    v_mfma_f32_16x16x32_bf16 v[28:31], v[124:127], v[172:175], v[28:31]
    ds_read_b64_tr_b16 v[102:103], v237 offset:32416
    v_mfma_f32_16x16x32_bf16 v[64:67], v[136:139], v[160:163], v[64:67]
    ds_read_b64_tr_b16 v[112:113], v237 offset:43232
    v_mfma_f32_16x16x32_bf16 v[68:71], v[136:139], v[164:167], v[68:71]
    ds_read_b64_tr_b16 v[114:115], v237 offset:46816
    v_mfma_f32_16x16x32_bf16 v[72:75], v[136:139], v[168:171], v[72:75]
    v_mfma_f32_16x16x32_bf16 v[76:79], v[136:139], v[172:175], v[76:79]
    ds_read_b64_tr_b16 v[104:105], v239 offset:28800
    v_mfma_f32_16x16x32_bf16 v[32:35], v[128:131], v[160:163], v[32:35]
    ds_read_b64_tr_b16 v[106:107], v239 offset:32384
    v_mfma_f32_16x16x32_bf16 v[36:39], v[128:131], v[164:167], v[36:39]
    ds_read_b64_tr_b16 v[116:117], v239 offset:43200
    v_mfma_f32_16x16x32_bf16 v[40:43], v[128:131], v[168:171], v[40:43]
    ds_read_b64_tr_b16 v[118:119], v239 offset:46784
    v_mfma_f32_16x16x32_bf16 v[44:47], v[128:131], v[172:175], v[44:47]
    v_mfma_f32_16x16x32_bf16 v[80:83], v[140:143], v[160:163], v[80:83]
    v_mfma_f32_16x16x32_bf16 v[84:87], v[140:143], v[164:167], v[84:87]
    v_mfma_f32_16x16x32_bf16 v[88:91], v[140:143], v[168:171], v[88:91]
    v_mfma_f32_16x16x32_bf16 v[92:95], v[140:143], v[172:175], v[92:95]
    s_mov_b32 s12, s96
    s_mov_b32 s13, s97
    s_mov_b32 s14, 7340032
    s_mov_b32 s15, 0x00020000
    s_and_b32 s64, s74, 8
    v_xor_b32 v254, s64, v252
    v_lshlrev_b32 v253, 14, v251
    v_lshl_add_u32 v253, v254, 4, v253
    s_lshl_b32 s64, s69, 12
    v_add_u32 v244, s64, v253
    v_add_u32 v245, 2048, v244
    s_mul_i32 s51, s69, 2112
    s_lshr_b32 s64, s74, 3
    s_mul_i32 s49, s64, 3670016
    s_lshl_b32 s65, s61, 8
    s_add_u32 s49, s49, s65
    s_mul_i32 s64, s58, 458752
    s_add_u32 s50, s49, 3670016
    s_add_u32 s48, s49, s64
    s_waitcnt vmcnt(1) lgkmcnt(0)
    s_barrier
    v_mfma_f32_16x16x32_bf16 v[0:3], v[96:99], v[144:147], v[0:3]
    ds_read_b128 v[160:163], v235 offset:24576
    v_mfma_f32_16x16x32_bf16 v[4:7], v[96:99], v[148:151], v[4:7]
    ds_read_b128 v[164:167], v235 offset:25600
    v_mfma_f32_16x16x32_bf16 v[8:11], v[96:99], v[152:155], v[8:11]
    ds_read_b128 v[168:171], v235 offset:26624
    v_mfma_f32_16x16x32_bf16 v[12:15], v[96:99], v[156:159], v[12:15]
    ds_read_b128 v[172:175], v235 offset:27648
    v_mfma_f32_16x16x32_bf16 v[48:51], v[108:111], v[144:147], v[48:51]
    v_mfma_f32_16x16x32_bf16 v[52:55], v[108:111], v[148:151], v[52:55]
    ds_read_b64_tr_b16 v[120:121], v236 offset:0
    v_mfma_f32_16x16x32_bf16 v[56:59], v[108:111], v[152:155], v[56:59]
    ds_read_b64_tr_b16 v[122:123], v236 offset:3584
    v_lshlrev_b32 v228, 7, v250
    s_add_u32 s64, s3, 8
    s_lshl_b32 s65, s64, 12
    s_add_u32 s65, s65, s25
    s_cmp_lt_u32 s64, s27
    s_cselect_b32 s65, s65, 0x7f000000
    s_mov_b64 exec, 0xffffffff
    buffer_load_dword v230, v228, s[80:83], s65 offen sc1
    s_mov_b64 exec, -1
    v_mfma_f32_16x16x32_bf16 v[60:63], v[108:111], v[156:159], v[60:63]
    ds_read_b64_tr_b16 v[132:133], v236 offset:14400
    v_mfma_f32_16x16x32_bf16 v[16:19], v[100:103], v[144:147], v[16:19]
    ds_read_b64_tr_b16 v[134:135], v236 offset:17984
    v_mfma_f32_16x16x32_bf16 v[20:23], v[100:103], v[148:151], v[20:23]
    v_mfma_f32_16x16x32_bf16 v[24:27], v[100:103], v[152:155], v[24:27]
    ds_read_b64_tr_b16 v[124:125], v236 offset:32
    s_add_u32 m0, s51, 107776
    s_nop 0
    buffer_load_dwordx4 v244, s[12:15], s48 offen lds
    v_mfma_f32_16x16x32_bf16 v[28:31], v[100:103], v[156:159], v[28:31]
    ds_read_b64_tr_b16 v[126:127], v236 offset:3616
    v_mfma_f32_16x16x32_bf16 v[64:67], v[112:115], v[144:147], v[64:67]
    ds_read_b64_tr_b16 v[136:137], v236 offset:14432
    v_mfma_f32_16x16x32_bf16 v[68:71], v[112:115], v[148:151], v[68:71]
    ds_read_b64_tr_b16 v[138:139], v236 offset:18016
    s_add_u32 m0, s51, 108832
    s_nop 0
    buffer_load_dwordx4 v245, s[12:15], s48 offen lds
    s_add_u32 s48, s48, 65536
    s_cmp_eq_u32 s48, s50
    s_cselect_b32 s48, s49, s48
    v_mfma_f32_16x16x32_bf16 v[72:75], v[112:115], v[152:155], v[72:75]
    v_mfma_f32_16x16x32_bf16 v[76:79], v[112:115], v[156:159], v[76:79]
    ds_read_b64_tr_b16 v[128:129], v238 offset:0
    v_mfma_f32_16x16x32_bf16 v[32:35], v[104:107], v[144:147], v[32:35]
    ds_read_b64_tr_b16 v[130:131], v238 offset:3584
    s_add_u32 m0, s51, 116224
    s_nop 0
    buffer_load_dwordx4 v244, s[12:15], s48 offen lds
    v_mfma_f32_16x16x32_bf16 v[36:39], v[104:107], v[148:151], v[36:39]
    ds_read_b64_tr_b16 v[140:141], v238 offset:14400
    v_mfma_f32_16x16x32_bf16 v[40:43], v[104:107], v[152:155], v[40:43]
    ds_read_b64_tr_b16 v[142:143], v238 offset:17984
    s_add_u32 m0, s51, 117280
    s_nop 0
    buffer_load_dwordx4 v245, s[12:15], s48 offen lds
    s_add_u32 s48, s48, 65536
    s_cmp_eq_u32 s48, s50
    s_cselect_b32 s48, s49, s48
    v_mfma_f32_16x16x32_bf16 v[44:47], v[104:107], v[156:159], v[44:47]
    v_mfma_f32_16x16x32_bf16 v[80:83], v[116:119], v[144:147], v[80:83]
    v_mfma_f32_16x16x32_bf16 v[84:87], v[116:119], v[148:151], v[84:87]
    v_mfma_f32_16x16x32_bf16 v[88:91], v[116:119], v[152:155], v[88:91]
    v_mfma_f32_16x16x32_bf16 v[92:95], v[116:119], v[156:159], v[92:95]
    s_waitcnt lgkmcnt(0)
    s_and_b32 s64, s3, 1
    s_lshl_b32 s64, s64, 9
    s_add_u32 s64, s64, 159744
    v_lshlrev_b32 v253, 3, v252
    v_add_u32 v253, s64, v253
    s_lshl_b32 s64, s28, 6
    s_add_u32 s64, s64, 160896
    v_lshlrev_b32 v254, 4, v251
    v_add_u32 v235, s64, v254
    s_lshr_b32 s64, s69, 1
    s_add_u32 s64, s64, 10
    s_lshl_b32 s64, s64, 6
    s_add_u32 s64, s64, 160896
    v_add_u32 v238, s64, v254
    v_mfma_f32_16x16x32_bf16 v[0:3], v[120:123], v[160:163], v[0:3]
    ds_read_b64 v[144:145], v253 offset:0
    s_add_u32 m0, s51, 124672
    s_nop 0
    buffer_load_dwordx4 v244, s[12:15], s48 offen lds
    v_mfma_f32_16x16x32_bf16 v[4:7], v[120:123], v[164:167], v[4:7]
    ds_read_b64 v[146:147], v253 offset:128
    v_mfma_f32_16x16x32_bf16 v[8:11], v[120:123], v[168:171], v[8:11]
    ds_read_b64 v[148:149], v253 offset:256
    v_mfma_f32_16x16x32_bf16 v[12:15], v[120:123], v[172:175], v[12:15]
    ds_read_b64 v[150:151], v253 offset:384
    s_add_u32 m0, s51, 125728
    s_nop 0
    buffer_load_dwordx4 v245, s[12:15], s48 offen lds
    s_add_u32 s48, s48, 65536
    s_cmp_eq_u32 s48, s50
    s_cselect_b32 s48, s49, s48
    v_mfma_f32_16x16x32_bf16 v[48:51], v[132:135], v[160:163], v[48:51]
    v_mfma_f32_16x16x32_bf16 v[52:55], v[132:135], v[164:167], v[52:55]
    ds_read_b128 v[96:99], v235 offset:0
    v_mfma_f32_16x16x32_bf16 v[56:59], v[132:135], v[168:171], v[56:59]
    ds_read_b128 v[100:103], v235 offset:64
    v_mfma_f32_16x16x32_bf16 v[60:63], v[132:135], v[172:175], v[60:63]
    ds_read_b128 v[104:107], v238 offset:0
    s_add_u32 m0, s51, 133120
    s_nop 0
    buffer_load_dwordx4 v244, s[12:15], s48 offen lds
    v_mfma_f32_16x16x32_bf16 v[16:19], v[124:127], v[160:163], v[16:19]
    v_mfma_f32_16x16x32_bf16 v[20:23], v[124:127], v[164:167], v[20:23]
    ds_read_b128 v[108:111], v235 offset:896
    v_mfma_f32_16x16x32_bf16 v[24:27], v[124:127], v[168:171], v[24:27]
    ds_read_b128 v[112:115], v235 offset:960
    v_mfma_f32_16x16x32_bf16 v[28:31], v[124:127], v[172:175], v[28:31]
    ds_read_b128 v[116:119], v238 offset:896
    s_add_u32 m0, s51, 134176
    s_nop 0
    buffer_load_dwordx4 v245, s[12:15], s48 offen lds
    s_add_u32 s48, s48, 65536
    s_cmp_eq_u32 s48, s50
    s_cselect_b32 s48, s49, s48
    v_mfma_f32_16x16x32_bf16 v[64:67], v[136:139], v[160:163], v[64:67]
    v_mfma_f32_16x16x32_bf16 v[68:71], v[136:139], v[164:167], v[68:71]
    v_mfma_f32_16x16x32_bf16 v[72:75], v[136:139], v[168:171], v[72:75]
    v_mfma_f32_16x16x32_bf16 v[76:79], v[136:139], v[172:175], v[76:79]
    s_add_u32 m0, s51, 141568
    s_nop 0
    buffer_load_dwordx4 v244, s[12:15], s48 offen lds
    v_mfma_f32_16x16x32_bf16 v[32:35], v[128:131], v[160:163], v[32:35]
    v_mfma_f32_16x16x32_bf16 v[36:39], v[128:131], v[164:167], v[36:39]
    v_mfma_f32_16x16x32_bf16 v[40:43], v[128:131], v[168:171], v[40:43]
    v_mfma_f32_16x16x32_bf16 v[44:47], v[128:131], v[172:175], v[44:47]
    s_add_u32 m0, s51, 142624
    s_nop 0
    buffer_load_dwordx4 v245, s[12:15], s48 offen lds
    s_add_u32 s48, s48, 65536
    s_cmp_eq_u32 s48, s50
    s_cselect_b32 s48, s49, s48
    v_mfma_f32_16x16x32_bf16 v[80:83], v[140:143], v[160:163], v[80:83]
    v_mfma_f32_16x16x32_bf16 v[84:87], v[140:143], v[164:167], v[84:87]
    v_mfma_f32_16x16x32_bf16 v[88:91], v[140:143], v[168:171], v[88:91]
    v_mfma_f32_16x16x32_bf16 v[92:95], v[140:143], v[172:175], v[92:95]
    s_and_b32 s64, s3, 1
    s_lshl_b32 s64, s64, 12
    s_add_u32 s25, s25, s64
    s_lshr_b32 s64, s69, 1
    s_lshl_b32 s65, s64, 3
    s_add_u32 s26, s25, s65
    s_add_u32 s26, s26, 40960
    s_lshl_b32 s64, s64, 14
    s_add_u32 s25, s25, s64
    s_add_u32 s25, s25, 32768
    s_waitcnt lgkmcnt(0)
    s_mov_b32 s64, 0xbfb8aa3b
    v_mul_f32 v136, v145, v145
    v_sub_f32 v120, 0, v144
    v_mul_f32 v128, s64, v145
    v_sub_f32 v121, 0, v144
    v_mul_f32 v129, s64, v145
    v_mul_f32 v138, v147, v147
    v_sub_f32 v122, 0, v146
    v_mul_f32 v130, s64, v147
    v_sub_f32 v123, 0, v146
    v_mul_f32 v131, s64, v147
    v_mul_f32 v140, v149, v149
    v_sub_f32 v124, 0, v148
    v_mul_f32 v132, s64, v149
    v_sub_f32 v125, 0, v148
    v_mul_f32 v133, s64, v149
    v_mul_f32 v142, v151, v151
    v_sub_f32 v126, 0, v150
    v_mul_f32 v134, s64, v151
    v_sub_f32 v127, 0, v150
    v_mul_f32 v135, s64, v151
    v_rcp_f32 v137, v136
    v_rcp_f32 v136, v136
    v_rcp_f32 v139, v138
    v_rcp_f32 v138, v138
    v_rcp_f32 v141, v140
    v_rcp_f32 v140, v140
    v_rcp_f32 v143, v142
    v_rcp_f32 v142, v142
    v_pk_fma_f32 v[0:1], v[120:121], v[96:97], v[0:1]
    s_add_u32 m0, s51, 65536
    s_nop 0
    buffer_load_dwordx4 v244, s[12:15], s48 offen lds
    v_pk_fma_f32 v[2:3], v[120:121], v[98:99], v[2:3]
    v_pk_mul_f32 v[164:165], v[128:129], v[0:1]
    v_pk_mul_f32 v[166:167], v[128:129], v[2:3]
    v_exp_f32 v164, v164
    v_exp_f32 v165, v165
    v_exp_f32 v166, v166
    v_exp_f32 v167, v167
    v_pk_fma_f32 v[48:49], v[120:121], v[108:109], v[48:49]
    v_pk_fma_f32 v[50:51], v[120:121], v[110:111], v[50:51]
    v_pk_fma_f32 v[164:165], v[164:165], v[136:137], v[136:137]
    v_pk_fma_f32 v[166:167], v[166:167], v[136:137], v[136:137]
    v_rcp_f32 v164, v164
    v_rcp_f32 v165, v165
    v_rcp_f32 v166, v166
    v_rcp_f32 v167, v167
    v_pk_mul_f32 v[0:1], v[0:1], v[48:49]
    s_add_u32 m0, s51, 66592
    s_nop 0
    buffer_load_dwordx4 v245, s[12:15], s48 offen lds
    s_add_u32 s48, s48, 65536
    s_cmp_eq_u32 s48, s50
    s_cselect_b32 s48, s49, s48
    v_pk_mul_f32 v[2:3], v[2:3], v[50:51]
    v_pk_mul_f32 v[0:1], v[0:1], v[164:165]
    v_pk_mul_f32 v[2:3], v[2:3], v[166:167]
    v_cvt_pk_bf16_f32 v168, v0, v1
    v_cvt_pk_bf16_f32 v169, v2, v3
    v_pk_fma_f32 v[16:17], v[120:121], v[100:101], v[16:17]
    v_pk_fma_f32 v[18:19], v[120:121], v[102:103], v[18:19]
    v_pk_mul_f32 v[164:165], v[128:129], v[16:17]
    v_pk_mul_f32 v[166:167], v[128:129], v[18:19]
    v_exp_f32 v164, v164
    v_exp_f32 v165, v165
    v_exp_f32 v166, v166
    v_exp_f32 v167, v167
    v_pk_fma_f32 v[64:65], v[120:121], v[112:113], v[64:65]
    v_pk_fma_f32 v[66:67], v[120:121], v[114:115], v[66:67]
    v_pk_fma_f32 v[164:165], v[164:165], v[136:137], v[136:137]
    s_add_u32 m0, s51, 73984
    s_nop 0
    buffer_load_dwordx4 v244, s[12:15], s48 offen lds
    v_pk_fma_f32 v[166:167], v[166:167], v[136:137], v[136:137]
    v_rcp_f32 v164, v164
    v_rcp_f32 v165, v165
    v_rcp_f32 v166, v166
    v_rcp_f32 v167, v167
    v_pk_mul_f32 v[16:17], v[16:17], v[64:65]
    v_pk_mul_f32 v[18:19], v[18:19], v[66:67]
    v_pk_mul_f32 v[16:17], v[16:17], v[164:165]
    v_pk_mul_f32 v[18:19], v[18:19], v[166:167]
    v_cvt_pk_bf16_f32 v170, v16, v17
    v_cvt_pk_bf16_f32 v171, v18, v19
    buffer_store_dwordx4 v[168:171], v249, s[80:83], s25 offen offset:0
    v_pk_fma_f32 v[32:33], v[120:121], v[104:105], v[32:33]
    v_pk_fma_f32 v[34:35], v[120:121], v[106:107], v[34:35]
    v_pk_mul_f32 v[164:165], v[128:129], v[32:33]
    v_pk_mul_f32 v[166:167], v[128:129], v[34:35]
    v_exp_f32 v164, v164
    s_add_u32 m0, s51, 75040
    s_nop 0
    buffer_load_dwordx4 v245, s[12:15], s48 offen lds
    s_add_u32 s48, s48, 65536
    s_cmp_eq_u32 s48, s50
    s_cselect_b32 s48, s49, s48
    v_exp_f32 v165, v165
    v_exp_f32 v166, v166
    v_exp_f32 v167, v167
    v_pk_fma_f32 v[80:81], v[120:121], v[116:117], v[80:81]
    v_pk_fma_f32 v[82:83], v[120:121], v[118:119], v[82:83]
    v_pk_fma_f32 v[164:165], v[164:165], v[136:137], v[136:137]
    v_pk_fma_f32 v[166:167], v[166:167], v[136:137], v[136:137]
    v_rcp_f32 v164, v164
    v_rcp_f32 v165, v165
    v_rcp_f32 v166, v166
    v_rcp_f32 v167, v167
    v_pk_mul_f32 v[32:33], v[32:33], v[80:81]
    v_pk_mul_f32 v[34:35], v[34:35], v[82:83]
    v_pk_mul_f32 v[32:33], v[32:33], v[164:165]
    v_pk_mul_f32 v[34:35], v[34:35], v[166:167]
    v_cvt_pk_bf16_f32 v172, v32, v33
    s_add_u32 m0, s51, 82432
    s_nop 0
    buffer_load_dwordx4 v244, s[12:15], s48 offen lds
    v_cvt_pk_bf16_f32 v173, v34, v35
    buffer_store_dwordx2 v[172:173], v249, s[80:83], s26 offen offset:0
    v_pk_fma_f32 v[4:5], v[122:123], v[96:97], v[4:5]
    v_pk_fma_f32 v[6:7], v[122:123], v[98:99], v[6:7]
    v_pk_mul_f32 v[164:165], v[130:131], v[4:5]
    v_pk_mul_f32 v[166:167], v[130:131], v[6:7]
    v_exp_f32 v164, v164
    v_exp_f32 v165, v165
    v_exp_f32 v166, v166
    v_exp_f32 v167, v167
    v_pk_fma_f32 v[52:53], v[122:123], v[108:109], v[52:53]
    v_pk_fma_f32 v[54:55], v[122:123], v[110:111], v[54:55]
    v_pk_fma_f32 v[164:165], v[164:165], v[138:139], v[138:139]
    v_pk_fma_f32 v[166:167], v[166:167], v[138:139], v[138:139]
    v_rcp_f32 v164, v164
    v_rcp_f32 v165, v165
    v_rcp_f32 v166, v166
    s_add_u32 m0, s51, 83488
    s_nop 0
    buffer_load_dwordx4 v245, s[12:15], s48 offen lds
    s_add_u32 s48, s48, 65536
    s_cmp_eq_u32 s48, s50
    s_cselect_b32 s48, s49, s48
    v_rcp_f32 v167, v167
    v_pk_mul_f32 v[4:5], v[4:5], v[52:53]
    v_pk_mul_f32 v[6:7], v[6:7], v[54:55]
    v_pk_mul_f32 v[4:5], v[4:5], v[164:165]
    v_pk_mul_f32 v[6:7], v[6:7], v[166:167]
    v_cvt_pk_bf16_f32 v168, v4, v5
    v_cvt_pk_bf16_f32 v169, v6, v7
    v_pk_fma_f32 v[20:21], v[122:123], v[100:101], v[20:21]
    v_pk_fma_f32 v[22:23], v[122:123], v[102:103], v[22:23]
    v_pk_mul_f32 v[164:165], v[130:131], v[20:21]
    v_pk_mul_f32 v[166:167], v[130:131], v[22:23]
    v_exp_f32 v164, v164
    v_exp_f32 v165, v165
    v_exp_f32 v166, v166
    v_exp_f32 v167, v167
    v_pk_fma_f32 v[68:69], v[122:123], v[112:113], v[68:69]
    s_add_u32 m0, s51, 90880
    s_nop 0
    buffer_load_dwordx4 v244, s[12:15], s48 offen lds
    v_pk_fma_f32 v[70:71], v[122:123], v[114:115], v[70:71]
    v_pk_fma_f32 v[164:165], v[164:165], v[138:139], v[138:139]
    v_pk_fma_f32 v[166:167], v[166:167], v[138:139], v[138:139]
    v_rcp_f32 v164, v164
    v_rcp_f32 v165, v165
    v_rcp_f32 v166, v166
    v_rcp_f32 v167, v167
    v_pk_mul_f32 v[20:21], v[20:21], v[68:69]
    v_pk_mul_f32 v[22:23], v[22:23], v[70:71]
    v_pk_mul_f32 v[20:21], v[20:21], v[164:165]
    v_pk_mul_f32 v[22:23], v[22:23], v[166:167]
    v_cvt_pk_bf16_f32 v170, v20, v21
    v_cvt_pk_bf16_f32 v171, v22, v23
    buffer_store_dwordx4 v[168:171], v249, s[80:83], s25 offen offset:1024
    v_pk_fma_f32 v[36:37], v[122:123], v[104:105], v[36:37]
    v_pk_fma_f32 v[38:39], v[122:123], v[106:107], v[38:39]
    s_add_u32 m0, s51, 91936
    s_nop 0
    buffer_load_dwordx4 v245, s[12:15], s48 offen lds
    s_add_u32 s48, s48, 65536
    s_cmp_eq_u32 s48, s50
    s_cselect_b32 s48, s49, s48
    v_pk_mul_f32 v[164:165], v[130:131], v[36:37]
    v_pk_mul_f32 v[166:167], v[130:131], v[38:39]
    v_exp_f32 v164, v164
    v_exp_f32 v165, v165
    v_exp_f32 v166, v166
    v_exp_f32 v167, v167
    v_pk_fma_f32 v[84:85], v[122:123], v[116:117], v[84:85]
    v_pk_fma_f32 v[86:87], v[122:123], v[118:119], v[86:87]
    v_pk_fma_f32 v[164:165], v[164:165], v[138:139], v[138:139]
    v_pk_fma_f32 v[166:167], v[166:167], v[138:139], v[138:139]
    v_rcp_f32 v164, v164
    v_rcp_f32 v165, v165
    v_rcp_f32 v166, v166
    v_rcp_f32 v167, v167
    v_pk_mul_f32 v[36:37], v[36:37], v[84:85]
    v_pk_mul_f32 v[38:39], v[38:39], v[86:87]
    v_pk_mul_f32 v[36:37], v[36:37], v[164:165]
    s_add_u32 m0, s51, 99328
    s_nop 0
    buffer_load_dwordx4 v244, s[12:15], s48 offen lds
    v_pk_mul_f32 v[38:39], v[38:39], v[166:167]
    v_cvt_pk_bf16_f32 v172, v36, v37
    v_cvt_pk_bf16_f32 v173, v38, v39
    buffer_store_dwordx2 v[172:173], v249, s[80:83], s26 offen offset:1024
    v_pk_fma_f32 v[8:9], v[124:125], v[96:97], v[8:9]
    v_pk_fma_f32 v[10:11], v[124:125], v[98:99], v[10:11]
    v_pk_mul_f32 v[164:165], v[132:133], v[8:9]
    v_pk_mul_f32 v[166:167], v[132:133], v[10:11]
    v_exp_f32 v164, v164
    v_exp_f32 v165, v165
    v_exp_f32 v166, v166
    v_exp_f32 v167, v167
    v_pk_fma_f32 v[56:57], v[124:125], v[108:109], v[56:57]
    v_pk_fma_f32 v[58:59], v[124:125], v[110:111], v[58:59]
    v_pk_fma_f32 v[164:165], v[164:165], v[140:141], v[140:141]
    v_pk_fma_f32 v[166:167], v[166:167], v[140:141], v[140:141]
    s_add_u32 m0, s51, 100384
    s_nop 0
    buffer_load_dwordx4 v245, s[12:15], s48 offen lds
    s_add_u32 s48, s48, 65536
    s_cmp_eq_u32 s48, s50
    s_cselect_b32 s48, s49, s48
    v_rcp_f32 v164, v164
    v_rcp_f32 v165, v165
    v_rcp_f32 v166, v166
    v_rcp_f32 v167, v167
    v_pk_mul_f32 v[8:9], v[8:9], v[56:57]
    v_pk_mul_f32 v[10:11], v[10:11], v[58:59]
    v_pk_mul_f32 v[8:9], v[8:9], v[164:165]
    v_pk_mul_f32 v[10:11], v[10:11], v[166:167]
    v_cvt_pk_bf16_f32 v168, v8, v9
    v_cvt_pk_bf16_f32 v169, v10, v11
    v_pk_fma_f32 v[24:25], v[124:125], v[100:101], v[24:25]
    v_pk_fma_f32 v[26:27], v[124:125], v[102:103], v[26:27]
    v_pk_mul_f32 v[164:165], v[132:133], v[24:25]
    v_pk_mul_f32 v[166:167], v[132:133], v[26:27]
    v_exp_f32 v164, v164
    v_exp_f32 v165, v165
    v_exp_f32 v166, v166
    v_exp_f32 v167, v167
    v_pk_fma_f32 v[72:73], v[124:125], v[112:113], v[72:73]
    v_pk_fma_f32 v[74:75], v[124:125], v[114:115], v[74:75]
    v_pk_fma_f32 v[164:165], v[164:165], v[140:141], v[140:141]
    v_pk_fma_f32 v[166:167], v[166:167], v[140:141], v[140:141]
    v_rcp_f32 v164, v164
    v_rcp_f32 v165, v165
    v_rcp_f32 v166, v166
    v_rcp_f32 v167, v167
    v_pk_mul_f32 v[24:25], v[24:25], v[72:73]
    v_pk_mul_f32 v[26:27], v[26:27], v[74:75]
    v_pk_mul_f32 v[24:25], v[24:25], v[164:165]
    v_pk_mul_f32 v[26:27], v[26:27], v[166:167]
    v_cvt_pk_bf16_f32 v170, v24, v25
    v_cvt_pk_bf16_f32 v171, v26, v27
    buffer_store_dwordx4 v[168:171], v249, s[80:83], s25 offen offset:2048
    v_pk_fma_f32 v[40:41], v[124:125], v[104:105], v[40:41]
    v_pk_fma_f32 v[42:43], v[124:125], v[106:107], v[42:43]
    v_pk_mul_f32 v[164:165], v[132:133], v[40:41]
    v_pk_mul_f32 v[166:167], v[132:133], v[42:43]
    v_exp_f32 v164, v164
    v_exp_f32 v165, v165
    v_exp_f32 v166, v166
    v_exp_f32 v167, v167
    v_pk_fma_f32 v[88:89], v[124:125], v[116:117], v[88:89]
    v_pk_fma_f32 v[90:91], v[124:125], v[118:119], v[90:91]
    v_pk_fma_f32 v[164:165], v[164:165], v[140:141], v[140:141]
    v_pk_fma_f32 v[166:167], v[166:167], v[140:141], v[140:141]
    v_rcp_f32 v164, v164
    v_rcp_f32 v165, v165
    v_rcp_f32 v166, v166
    v_rcp_f32 v167, v167
    v_pk_mul_f32 v[40:41], v[40:41], v[88:89]
    v_pk_mul_f32 v[42:43], v[42:43], v[90:91]
    v_pk_mul_f32 v[40:41], v[40:41], v[164:165]
    v_pk_mul_f32 v[42:43], v[42:43], v[166:167]
    v_cvt_pk_bf16_f32 v172, v40, v41
    v_cvt_pk_bf16_f32 v173, v42, v43
    buffer_store_dwordx2 v[172:173], v249, s[80:83], s26 offen offset:2048
    v_pk_fma_f32 v[12:13], v[126:127], v[96:97], v[12:13]
    v_pk_fma_f32 v[14:15], v[126:127], v[98:99], v[14:15]
    v_pk_mul_f32 v[164:165], v[134:135], v[12:13]
    v_pk_mul_f32 v[166:167], v[134:135], v[14:15]
    v_exp_f32 v164, v164
    v_exp_f32 v165, v165
    v_exp_f32 v166, v166
    v_exp_f32 v167, v167
    v_pk_fma_f32 v[60:61], v[126:127], v[108:109], v[60:61]
    v_pk_fma_f32 v[62:63], v[126:127], v[110:111], v[62:63]
    v_pk_fma_f32 v[164:165], v[164:165], v[142:143], v[142:143]
    v_pk_fma_f32 v[166:167], v[166:167], v[142:143], v[142:143]
    v_rcp_f32 v164, v164
    v_rcp_f32 v165, v165
    v_rcp_f32 v166, v166
    v_rcp_f32 v167, v167
    v_pk_mul_f32 v[12:13], v[12:13], v[60:61]
    v_pk_mul_f32 v[14:15], v[14:15], v[62:63]
    v_pk_mul_f32 v[12:13], v[12:13], v[164:165]
    v_pk_mul_f32 v[14:15], v[14:15], v[166:167]
    v_cvt_pk_bf16_f32 v168, v12, v13
    v_cvt_pk_bf16_f32 v169, v14, v15
    v_pk_fma_f32 v[28:29], v[126:127], v[100:101], v[28:29]
    v_pk_fma_f32 v[30:31], v[126:127], v[102:103], v[30:31]
    v_pk_mul_f32 v[164:165], v[134:135], v[28:29]
    v_pk_mul_f32 v[166:167], v[134:135], v[30:31]
    v_exp_f32 v164, v164
    v_exp_f32 v165, v165
    v_exp_f32 v166, v166
    v_exp_f32 v167, v167
    v_pk_fma_f32 v[76:77], v[126:127], v[112:113], v[76:77]
    v_pk_fma_f32 v[78:79], v[126:127], v[114:115], v[78:79]
    v_pk_fma_f32 v[164:165], v[164:165], v[142:143], v[142:143]
    v_pk_fma_f32 v[166:167], v[166:167], v[142:143], v[142:143]
    v_rcp_f32 v164, v164
    v_rcp_f32 v165, v165
    v_rcp_f32 v166, v166
    v_rcp_f32 v167, v167
    v_pk_mul_f32 v[28:29], v[28:29], v[76:77]
    v_pk_mul_f32 v[30:31], v[30:31], v[78:79]
    v_pk_mul_f32 v[28:29], v[28:29], v[164:165]
    v_pk_mul_f32 v[30:31], v[30:31], v[166:167]
    v_cvt_pk_bf16_f32 v170, v28, v29
    v_cvt_pk_bf16_f32 v171, v30, v31
    buffer_store_dwordx4 v[168:171], v249, s[80:83], s25 offen offset:3072
    v_pk_fma_f32 v[44:45], v[126:127], v[104:105], v[44:45]
    v_pk_fma_f32 v[46:47], v[126:127], v[106:107], v[46:47]
    v_pk_mul_f32 v[164:165], v[134:135], v[44:45]
    v_pk_mul_f32 v[166:167], v[134:135], v[46:47]
    v_exp_f32 v164, v164
    v_exp_f32 v165, v165
    v_exp_f32 v166, v166
    v_exp_f32 v167, v167
    v_pk_fma_f32 v[92:93], v[126:127], v[116:117], v[92:93]
    v_pk_fma_f32 v[94:95], v[126:127], v[118:119], v[94:95]
    v_pk_fma_f32 v[164:165], v[164:165], v[142:143], v[142:143]
    v_pk_fma_f32 v[166:167], v[166:167], v[142:143], v[142:143]
    v_rcp_f32 v164, v164
    v_rcp_f32 v165, v165
    v_rcp_f32 v166, v166
    v_rcp_f32 v167, v167
    v_pk_mul_f32 v[44:45], v[44:45], v[92:93]
    v_pk_mul_f32 v[46:47], v[46:47], v[94:95]
    v_pk_mul_f32 v[44:45], v[44:45], v[164:165]
    v_pk_mul_f32 v[46:47], v[46:47], v[166:167]
    v_cvt_pk_bf16_f32 v172, v44, v45
    v_cvt_pk_bf16_f32 v173, v46, v47
    buffer_store_dwordx2 v[172:173], v249, s[80:83], s26 offen offset:3072
    s_lshl_b32 s64, s75, 15
    s_lshl_b32 s66, s73, 9
    s_add_u32 s64, s64, s66
    s_add_u32 s64, s64, 75513856
    s_lshl_b32 s65, s72, 5
    s_add_u32 s64, s64, s65
    s_lshl_b32 s65, s3, 2
    s_add_u32 s64, s64, s65
    v_mov_b32 v144, 0
    v_mov_b32 v145, 1
    s_cmp_lg_u32 s78, 0
    s_cbranch_scc1 sg_1049_slow
    s_waitcnt vmcnt(0)
    s_mov_b64 exec, 1
    buffer_store_dword v145, v144, s[80:83], s64 offen
    s_mov_b64 exec, -1
sg_1049_done:
    s_setprio 3
    s_lshl_b32 s53, s60, 24
    s_mul_i32 s64, s73, 917504
    s_add_u32 s53, s53, s64
    s_lshr_b32 s64, s74, 3
    s_mul_i32 s64, s64, 458752
    s_add_u32 s53, s53, s64
    s_add_u32 s53, s53, 20971520
    s_mul_i32 s65, s58, 57344
    s_lshl_b32 s55, s69, 11
    s_add_u32 s53, s53, s55
    s_add_u32 s54, s53, 458752
    s_add_u32 s52, s53, s65
    s_lshl_b32 s64, s75, 15
    s_lshl_b32 s66, s73, 9
    s_add_u32 s64, s64, s66
    s_add_u32 s64, s64, 75513856
    v_lshlrev_b32 v246, 4, v250
    v_lshrrev_b32 v253, 1, v250
    s_lshl_b32 s65, s70, 1
    v_subrev_u32 v253, s65, v253
    v_xor_b32 v253, s74, v253
    v_and_b32 v253, 8, v253
    v_cmp_eq_u32 vcc, 0, v253
    s_mov_b32 s62, vcc_lo
    s_mov_b32 s63, 0
    s_mov_b64 exec, s[62:63]
pl_1050:
    buffer_load_dwordx4 v[240:243], v246, s[80:83], s64 offen sc1
    s_sub_u32 s79, s79, 1
    s_cbranch_scc1 L_abort
    s_waitcnt vmcnt(0)
    v_and_b32 v240, v240, v241
    v_and_b32 v242, v242, v243
    v_and_b32 v240, v240, v242
    v_cmp_ne_u32 vcc, 1, v240
    s_cbranch_vccnz pl_1050
    s_mov_b64 exec, -1
    s_cmp_lg_u32 s78, 0
    s_cbranch_scc1 pl_1050_acq
pl_1050_ok:
    s_add_u32 m0, s55, 57344
    s_nop 0
    buffer_load_dwordx4 v249, s[80:83], s52 offen offset:0 sc1 lds
    buffer_load_dwordx4 v249, s[80:83], s52 offen offset:1024 sc1 lds
    s_add_u32 s52, s52, 8192
    s_cmp_eq_u32 s52, s54
    s_cselect_b32 s52, s53, s52
    s_add_u32 m0, s55, 0
    s_nop 0
    buffer_load_dwordx4 v249, s[80:83], s52 offen offset:0 sc1 lds
    buffer_load_dwordx4 v249, s[80:83], s52 offen offset:1024 sc1 lds
    s_add_u32 s52, s52, 8192
    s_cmp_eq_u32 s52, s54
    s_cselect_b32 s52, s53, s52
    s_add_u32 m0, s55, 8192
    s_nop 0
    buffer_load_dwordx4 v249, s[80:83], s52 offen offset:0 sc1 lds
    buffer_load_dwordx4 v249, s[80:83], s52 offen offset:1024 sc1 lds
    s_add_u32 s52, s52, 8192
    s_cmp_eq_u32 s52, s54
    s_cselect_b32 s52, s53, s52
    s_waitcnt vmcnt(4) lgkmcnt(0)
    s_barrier
    s_add_u32 m0, s55, 16384
    s_nop 0
    buffer_load_dwordx4 v249, s[80:83], s52 offen offset:0 sc1 lds
    buffer_load_dwordx4 v249, s[80:83], s52 offen offset:1024 sc1 lds
    s_add_u32 s52, s52, 8192
    s_cmp_eq_u32 s52, s54
    s_cselect_b32 s52, s53, s52
    s_add_u32 m0, s55, 24576
    s_nop 0
    buffer_load_dwordx4 v249, s[80:83], s52 offen offset:0 sc1 lds
    buffer_load_dwordx4 v249, s[80:83], s52 offen offset:1024 sc1 lds
    s_add_u32 s52, s52, 8192
    s_cmp_eq_u32 s52, s54
    s_cselect_b32 s52, s53, s52
    s_waitcnt vmcnt(4) lgkmcnt(0)
    s_barrier
    s_add_u32 m0, s55, 32768
    s_nop 0
    buffer_load_dwordx4 v249, s[80:83], s52 offen offset:0 sc1 lds
    buffer_load_dwordx4 v249, s[80:83], s52 offen offset:1024 sc1 lds
    s_add_u32 s52, s52, 8192
    s_cmp_eq_u32 s52, s54
    s_cselect_b32 s52, s53, s52
    s_add_u32 m0, s55, 40960
    s_nop 0
    buffer_load_dwordx4 v249, s[80:83], s52 offen offset:0 sc1 lds
    buffer_load_dwordx4 v249, s[80:83], s52 offen offset:1024 sc1 lds
    s_add_u32 s52, s52, 8192
    s_cmp_eq_u32 s52, s54
    s_cselect_b32 s52, s53, s52
    s_add_u32 m0, s55, 49152
    s_nop 0
    buffer_load_dwordx4 v249, s[80:83], s52 offen offset:0 sc1 lds
    buffer_load_dwordx4 v249, s[80:83], s52 offen offset:1024 sc1 lds
    s_add_u32 s52, s52, 8192
    s_cmp_eq_u32 s52, s54
    s_cselect_b32 s52, s53, s52
    s_waitcnt vmcnt(6) lgkmcnt(0)
    s_barrier
    s_add_u32 m0, s55, 57344
    s_nop 0
    buffer_load_dwordx4 v249, s[80:83], s52 offen offset:0 sc1 lds
    buffer_load_dwordx4 v249, s[80:83], s52 offen offset:1024 sc1 lds
    s_add_u32 s52, s52, 8192
    s_cmp_eq_u32 s52, s54
    s_cselect_b32 s52, s53, s52
    s_add_u32 m0, s55, 0
    s_nop 0
    buffer_load_dwordx4 v249, s[80:83], s52 offen offset:0 sc1 lds
    buffer_load_dwordx4 v249, s[80:83], s52 offen offset:1024 sc1 lds
    s_add_u32 s52, s52, 8192
    s_cmp_eq_u32 s52, s54
    s_cselect_b32 s52, s53, s52
    s_mov_b32 s8, s86
    s_mov_b32 s9, s87
    s_mov_b32 s10, 6291456
    s_mov_b32 s11, 0x00020000
    v_lshrrev_b32 v253, 3, v250
    v_lshlrev_b32 v253, 2, v253
    v_add_u32 v253, s69, v253
    v_mul_u32_u24 v253, 6144, v253
    v_and_b32 v254, 7, v250
    v_lshl_add_u32 v10, v254, 4, v253
    v_add_u32 v11, 2048, v10
    v_add_u32 v12, 4096, v10
    s_mul_i32 s19, s69, 3104
    s_lshl_b32 s17, s67, 7
    s_add_u32 s18, s17, 6291456
    s_lshl_b32 s64, s70, 1
    s_mul_i32 s64, s64, 393216
    s_add_u32 s16, s17, s64
    s_waitcnt vmcnt(6) lgkmcnt(0)
    s_barrier
    s_add_u32 m0, s55, 8192
    s_nop 0
    buffer_load_dwordx4 v249, s[80:83], s52 offen offset:0 sc1 lds
    buffer_load_dwordx4 v249, s[80:83], s52 offen offset:1024 sc1 lds
    s_add_u32 s52, s52, 8192
    s_cmp_eq_u32 s52, s54
    s_cselect_b32 s52, s53, s52
    s_add_u32 m0, s51, 107776
    s_nop 0
    buffer_load_dwordx4 v244, s[12:15], s48 offen lds
    s_add_u32 m0, s51, 108832
    s_nop 0
    buffer_load_dwordx4 v245, s[12:15], s48 offen lds
    s_add_u32 s48, s48, 65536
    s_cmp_eq_u32 s48, s50
    s_cselect_b32 s48, s49, s48
    s_add_u32 m0, s55, 16384
    s_nop 0
    buffer_load_dwordx4 v249, s[80:83], s52 offen offset:0 sc1 lds
    buffer_load_dwordx4 v249, s[80:83], s52 offen offset:1024 sc1 lds
    s_add_u32 s52, s52, 8192
    s_cmp_eq_u32 s52, s54
    s_cselect_b32 s52, s53, s52
    s_add_u32 m0, s51, 116224
    s_nop 0
    buffer_load_dwordx4 v244, s[12:15], s48 offen lds
    s_add_u32 m0, s51, 117280
    s_nop 0
    buffer_load_dwordx4 v245, s[12:15], s48 offen lds
    s_add_u32 s48, s48, 65536
    s_cmp_eq_u32 s48, s50
    s_cselect_b32 s48, s49, s48
    s_waitcnt vmcnt(10) lgkmcnt(0)
    s_barrier
    s_add_u32 m0, s55, 24576
    s_nop 0
    buffer_load_dwordx4 v249, s[80:83], s52 offen offset:0 sc1 lds
    buffer_load_dwordx4 v249, s[80:83], s52 offen offset:1024 sc1 lds
    s_add_u32 s52, s52, 8192
    s_cmp_eq_u32 s52, s54
    s_cselect_b32 s52, s53, s52
    s_add_u32 m0, s51, 124672
    s_nop 0
    buffer_load_dwordx4 v244, s[12:15], s48 offen lds
    s_add_u32 m0, s51, 125728
    s_nop 0
    buffer_load_dwordx4 v245, s[12:15], s48 offen lds
    s_add_u32 s48, s48, 65536
    s_cmp_eq_u32 s48, s50
    s_cselect_b32 s48, s49, s48
    s_add_u32 m0, s55, 32768
    s_nop 0
    buffer_load_dwordx4 v249, s[80:83], s52 offen offset:0 sc1 lds
    buffer_load_dwordx4 v249, s[80:83], s52 offen offset:1024 sc1 lds
    s_add_u32 s52, s52, 8192
    s_cmp_eq_u32 s52, s54
    s_cselect_b32 s52, s53, s52
    s_add_u32 m0, s51, 133120
    s_nop 0
    buffer_load_dwordx4 v244, s[12:15], s48 offen lds
    s_add_u32 m0, s51, 134176
    s_nop 0
    buffer_load_dwordx4 v245, s[12:15], s48 offen lds
    s_add_u32 s48, s48, 65536
    s_cmp_eq_u32 s48, s50
    s_cselect_b32 s48, s49, s48
    s_waitcnt vmcnt(12) lgkmcnt(0)
    s_barrier
    s_add_u32 m0, s55, 40960
    s_nop 0
    buffer_load_dwordx4 v249, s[80:83], s52 offen offset:0 sc1 lds
    buffer_load_dwordx4 v249, s[80:83], s52 offen offset:1024 sc1 lds
    s_add_u32 s52, s52, 8192
    s_cmp_eq_u32 s52, s54
    s_cselect_b32 s52, s53, s52
    s_add_u32 m0, s51, 141568
    s_nop 0
    buffer_load_dwordx4 v244, s[12:15], s48 offen lds
    s_add_u32 m0, s51, 142624
    s_nop 0
    buffer_load_dwordx4 v245, s[12:15], s48 offen lds
    s_add_u32 s48, s48, 65536
    s_cmp_eq_u32 s48, s50
    s_cselect_b32 s48, s49, s48
    s_add_u32 m0, s55, 49152
    s_nop 0
    buffer_load_dwordx4 v249, s[80:83], s52 offen offset:0 sc1 lds
    buffer_load_dwordx4 v249, s[80:83], s52 offen offset:1024 sc1 lds
    s_add_u32 s52, s52, 8192
    s_cmp_eq_u32 s52, s54
    s_cselect_b32 s52, s53, s52
    s_add_u32 m0, s51, 65536
    s_nop 0
    buffer_load_dwordx4 v244, s[12:15], s48 offen lds
    s_add_u32 m0, s51, 66592
    s_nop 0
    buffer_load_dwordx4 v245, s[12:15], s48 offen lds
    s_add_u32 s48, s48, 65536
    s_cmp_eq_u32 s48, s50
    s_cselect_b32 s48, s49, s48
    s_waitcnt vmcnt(12) lgkmcnt(0)
    s_barrier
    s_add_u32 m0, s55, 57344
    s_nop 0
    buffer_load_dwordx4 v249, s[80:83], s52 offen offset:0 sc1 lds
    buffer_load_dwordx4 v249, s[80:83], s52 offen offset:1024 sc1 lds
    s_add_u32 s52, s52, 8192
    s_cmp_eq_u32 s52, s54
    s_cselect_b32 s52, s53, s52
    s_add_u32 m0, s51, 73984
    s_nop 0
    buffer_load_dwordx4 v244, s[12:15], s48 offen lds
    s_add_u32 m0, s51, 75040
    s_nop 0
    buffer_load_dwordx4 v245, s[12:15], s48 offen lds
    s_add_u32 s48, s48, 65536
    s_cmp_eq_u32 s48, s50
    s_cselect_b32 s48, s49, s48
    s_add_u32 m0, s55, 0
    s_nop 0
    buffer_load_dwordx4 v249, s[80:83], s52 offen offset:0 sc1 lds
    buffer_load_dwordx4 v249, s[80:83], s52 offen offset:1024 sc1 lds
    s_add_u32 s52, s52, 8192
    s_cmp_eq_u32 s52, s54
    s_cselect_b32 s52, s53, s52
    s_add_u32 m0, s51, 82432
    s_nop 0
    buffer_load_dwordx4 v244, s[12:15], s48 offen lds
    s_add_u32 m0, s51, 83488
    s_nop 0
    buffer_load_dwordx4 v245, s[12:15], s48 offen lds
    s_add_u32 s48, s48, 65536
    s_cmp_eq_u32 s48, s50
    s_cselect_b32 s48, s49, s48
    s_waitcnt vmcnt(12) lgkmcnt(0)
    s_barrier
    s_add_u32 m0, s55, 8192
    s_nop 0
    buffer_load_dwordx4 v249, s[80:83], s52 offen offset:0 sc1 lds
    buffer_load_dwordx4 v249, s[80:83], s52 offen offset:1024 sc1 lds
    s_add_u32 s52, s52, 8192
    s_cmp_eq_u32 s52, s54
    s_cselect_b32 s52, s53, s52
    s_add_u32 m0, s51, 90880
    s_nop 0
    buffer_load_dwordx4 v244, s[12:15], s48 offen lds
    s_add_u32 m0, s51, 91936
    s_nop 0
    buffer_load_dwordx4 v245, s[12:15], s48 offen lds
    s_add_u32 s48, s48, 65536
    s_cmp_eq_u32 s48, s50
    s_cselect_b32 s48, s49, s48
    s_add_u32 m0, s55, 16384
    s_nop 0
    buffer_load_dwordx4 v249, s[80:83], s52 offen offset:0 sc1 lds
    buffer_load_dwordx4 v249, s[80:83], s52 offen offset:1024 sc1 lds
    s_add_u32 s52, s52, 8192
    s_cmp_eq_u32 s52, s54
    s_cselect_b32 s52, s53, s52
    s_add_u32 m0, s51, 99328
    s_nop 0
    buffer_load_dwordx4 v244, s[12:15], s48 offen lds
    s_add_u32 m0, s51, 100384
    s_nop 0
    buffer_load_dwordx4 v245, s[12:15], s48 offen lds
    s_add_u32 s48, s48, 65536
    s_cmp_eq_u32 s48, s50
    s_cselect_b32 s48, s49, s48
    s_waitcnt vmcnt(12) lgkmcnt(0)
    s_barrier
    s_add_u32 m0, s55, 24576
    s_nop 0
    buffer_load_dwordx4 v249, s[80:83], s52 offen offset:0 sc1 lds
    buffer_load_dwordx4 v249, s[80:83], s52 offen offset:1024 sc1 lds
    s_add_u32 s52, s52, 8192
    s_cmp_eq_u32 s52, s54
    s_cselect_b32 s52, s53, s52
    s_add_u32 m0, s51, 107776
    s_nop 0
    buffer_load_dwordx4 v244, s[12:15], s48 offen lds
    s_add_u32 m0, s51, 108832
    s_nop 0
    buffer_load_dwordx4 v245, s[12:15], s48 offen lds
    s_add_u32 s48, s48, 65536
    s_cmp_eq_u32 s48, s50
    s_cselect_b32 s48, s49, s48
    s_add_u32 m0, s55, 32768
    s_nop 0
    buffer_load_dwordx4 v249, s[80:83], s52 offen offset:0 sc1 lds
    buffer_load_dwordx4 v249, s[80:83], s52 offen offset:1024 sc1 lds
    s_add_u32 s52, s52, 8192
    s_cmp_eq_u32 s52, s54
    s_cselect_b32 s52, s53, s52
    s_add_u32 m0, s51, 116224
    s_nop 0
    buffer_load_dwordx4 v244, s[12:15], s48 offen lds
    s_add_u32 m0, s51, 117280
    s_nop 0
    buffer_load_dwordx4 v245, s[12:15], s48 offen lds
    s_add_u32 s48, s48, 65536
    s_cmp_eq_u32 s48, s50
    s_cselect_b32 s48, s49, s48
    s_waitcnt vmcnt(12) lgkmcnt(0)
    s_barrier
    s_add_u32 m0, s55, 40960
    s_nop 0
    buffer_load_dwordx4 v249, s[80:83], s52 offen offset:0 sc1 lds
    buffer_load_dwordx4 v249, s[80:83], s52 offen offset:1024 sc1 lds
    s_add_u32 s52, s52, 8192
    s_cmp_eq_u32 s52, s54
    s_cselect_b32 s52, s53, s52
    s_add_u32 m0, s51, 124672
    s_nop 0
    buffer_load_dwordx4 v244, s[12:15], s48 offen lds
    s_add_u32 m0, s51, 125728
    s_nop 0
    buffer_load_dwordx4 v245, s[12:15], s48 offen lds
    s_add_u32 s48, s48, 65536
    s_cmp_eq_u32 s48, s50
    s_cselect_b32 s48, s49, s48
    s_add_u32 m0, s55, 49152
    s_nop 0
    buffer_load_dwordx4 v249, s[80:83], s52 offen offset:0 sc1 lds
    buffer_load_dwordx4 v249, s[80:83], s52 offen offset:1024 sc1 lds
    s_add_u32 s52, s52, 8192
    s_cmp_eq_u32 s52, s54
    s_cselect_b32 s52, s53, s52
    s_add_u32 m0, s51, 133120
    s_nop 0
    buffer_load_dwordx4 v244, s[12:15], s48 offen lds
    s_add_u32 m0, s51, 134176
    s_nop 0
    buffer_load_dwordx4 v245, s[12:15], s48 offen lds
    s_add_u32 s48, s48, 65536
    s_cmp_eq_u32 s48, s50
    s_cselect_b32 s48, s49, s48
    s_waitcnt vmcnt(12) lgkmcnt(0)
    s_barrier
    s_add_u32 m0, s55, 57344
    s_nop 0
    buffer_load_dwordx4 v249, s[80:83], s52 offen offset:0 sc1 lds
    buffer_load_dwordx4 v249, s[80:83], s52 offen offset:1024 sc1 lds
    s_add_u32 s52, s52, 8192
    s_cmp_eq_u32 s52, s54
    s_cselect_b32 s52, s53, s52
    s_add_u32 m0, s51, 141568
    s_nop 0
    buffer_load_dwordx4 v244, s[12:15], s48 offen lds
    s_add_u32 m0, s51, 142624
    s_nop 0
    buffer_load_dwordx4 v245, s[12:15], s48 offen lds
    s_add_u32 s48, s48, 65536
    s_cmp_eq_u32 s48, s50
    s_cselect_b32 s48, s49, s48
    s_add_u32 m0, s55, 0
    s_nop 0
    buffer_load_dwordx4 v249, s[80:83], s52 offen offset:0 sc1 lds
    buffer_load_dwordx4 v249, s[80:83], s52 offen offset:1024 sc1 lds
    s_add_u32 s52, s52, 8192
    s_cmp_eq_u32 s52, s54
    s_cselect_b32 s52, s53, s52
    s_add_u32 m0, s51, 65536
    s_nop 0
    buffer_load_dwordx4 v244, s[12:15], s48 offen lds
    s_add_u32 m0, s51, 66592
    s_nop 0
    buffer_load_dwordx4 v245, s[12:15], s48 offen lds
    s_add_u32 s48, s48, 65536
    s_cmp_eq_u32 s48, s50
    s_cselect_b32 s48, s49, s48
    s_waitcnt vmcnt(12) lgkmcnt(0)
    s_barrier
    s_add_u32 m0, s55, 8192
    s_nop 0
    buffer_load_dwordx4 v249, s[80:83], s52 offen offset:0 sc1 lds
    buffer_load_dwordx4 v249, s[80:83], s52 offen offset:1024 sc1 lds
    s_add_u32 s52, s52, 8192
    s_cmp_eq_u32 s52, s54
    s_cselect_b32 s52, s53, s52
    s_add_u32 m0, s51, 73984
    s_nop 0
    buffer_load_dwordx4 v244, s[12:15], s48 offen lds
    s_add_u32 m0, s51, 75040
    s_nop 0
    buffer_load_dwordx4 v245, s[12:15], s48 offen lds
    s_add_u32 s48, s48, 65536
    s_cmp_eq_u32 s48, s50
    s_cselect_b32 s48, s49, s48
    s_add_u32 m0, s55, 16384
    s_nop 0
    buffer_load_dwordx4 v249, s[80:83], s52 offen offset:0 sc1 lds
    buffer_load_dwordx4 v249, s[80:83], s52 offen offset:1024 sc1 lds
    s_add_u32 s52, s52, 8192
    s_cmp_eq_u32 s52, s54
    s_cselect_b32 s52, s53, s52
    s_add_u32 m0, s51, 82432
    s_nop 0
    buffer_load_dwordx4 v244, s[12:15], s48 offen lds
    s_add_u32 m0, s51, 83488
    s_nop 0
    buffer_load_dwordx4 v245, s[12:15], s48 offen lds
    s_add_u32 s48, s48, 65536
    s_cmp_eq_u32 s48, s50
    s_cselect_b32 s48, s49, s48
    s_waitcnt vmcnt(12) lgkmcnt(0)
    s_barrier
    s_add_u32 m0, s55, 24576
    s_nop 0
    buffer_load_dwordx4 v249, s[80:83], s52 offen offset:0 sc1 lds
    buffer_load_dwordx4 v249, s[80:83], s52 offen offset:1024 sc1 lds
    s_add_u32 s52, s52, 8192
    s_cmp_eq_u32 s52, s54
    s_cselect_b32 s52, s53, s52
    s_add_u32 m0, s51, 90880
    s_nop 0
    buffer_load_dwordx4 v244, s[12:15], s48 offen lds
    s_add_u32 m0, s51, 91936
    s_nop 0
    buffer_load_dwordx4 v245, s[12:15], s48 offen lds
    s_add_u32 s48, s48, 65536
    s_cmp_eq_u32 s48, s50
    s_cselect_b32 s48, s49, s48
    s_add_u32 m0, s55, 32768
    s_nop 0
    buffer_load_dwordx4 v249, s[80:83], s52 offen offset:0 sc1 lds
    buffer_load_dwordx4 v249, s[80:83], s52 offen offset:1024 sc1 lds
    s_add_u32 s52, s52, 8192
    s_cmp_eq_u32 s52, s54
    s_cselect_b32 s52, s53, s52
    s_add_u32 m0, s51, 99328
    s_nop 0
    buffer_load_dwordx4 v244, s[12:15], s48 offen lds
    s_add_u32 m0, s51, 100384
    s_nop 0
    buffer_load_dwordx4 v245, s[12:15], s48 offen lds
    s_add_u32 s48, s48, 65536
    s_cmp_eq_u32 s48, s50
    s_cselect_b32 s48, s49, s48
    s_waitcnt vmcnt(12) lgkmcnt(0)
    s_barrier
    s_add_u32 m0, s55, 40960
    s_nop 0
    buffer_load_dwordx4 v249, s[80:83], s52 offen offset:0 sc1 lds
    buffer_load_dwordx4 v249, s[80:83], s52 offen offset:1024 sc1 lds
    s_add_u32 s52, s52, 8192
    s_cmp_eq_u32 s52, s54
    s_cselect_b32 s52, s53, s52
    s_add_u32 m0, s51, 107776
    s_nop 0
    buffer_load_dwordx4 v244, s[12:15], s48 offen lds
    s_add_u32 m0, s51, 108832
    s_nop 0
    buffer_load_dwordx4 v245, s[12:15], s48 offen lds
    s_add_u32 s48, s48, 65536
    s_cmp_eq_u32 s48, s50
    s_cselect_b32 s48, s49, s48
    s_add_u32 m0, s55, 49152
    s_nop 0
    buffer_load_dwordx4 v249, s[80:83], s52 offen offset:0 sc1 lds
    buffer_load_dwordx4 v249, s[80:83], s52 offen offset:1024 sc1 lds
    s_add_u32 s52, s52, 8192
    s_cmp_eq_u32 s52, s54
    s_cselect_b32 s52, s53, s52
    s_add_u32 m0, s51, 116224
    s_nop 0
    buffer_load_dwordx4 v244, s[12:15], s48 offen lds
    s_add_u32 m0, s51, 117280
    s_nop 0
    buffer_load_dwordx4 v245, s[12:15], s48 offen lds
    s_add_u32 s48, s48, 65536
    s_cmp_eq_u32 s48, s50
    s_cselect_b32 s48, s49, s48
    s_waitcnt vmcnt(12) lgkmcnt(0)
    s_barrier
    s_add_u32 m0, s55, 57344
    s_nop 0
    buffer_load_dwordx4 v249, s[80:83], s52 offen offset:0 sc1 lds
    buffer_load_dwordx4 v249, s[80:83], s52 offen offset:1024 sc1 lds
    s_add_u32 s52, s52, 8192
    s_cmp_eq_u32 s52, s54
    s_cselect_b32 s52, s53, s52
    s_add_u32 m0, s51, 124672
    s_nop 0
    buffer_load_dwordx4 v244, s[12:15], s48 offen lds
    s_add_u32 m0, s51, 125728
    s_nop 0
    buffer_load_dwordx4 v245, s[12:15], s48 offen lds
    s_add_u32 s48, s48, 65536
    s_cmp_eq_u32 s48, s50
    s_cselect_b32 s48, s49, s48
    s_add_u32 m0, s55, 0
    s_nop 0
    buffer_load_dwordx4 v249, s[80:83], s52 offen offset:0 sc1 lds
    buffer_load_dwordx4 v249, s[80:83], s52 offen offset:1024 sc1 lds
    s_add_u32 s52, s52, 8192
    s_cmp_eq_u32 s52, s54
    s_cselect_b32 s52, s53, s52
    s_add_u32 m0, s51, 133120
    s_nop 0
    buffer_load_dwordx4 v244, s[12:15], s48 offen lds
    s_add_u32 m0, s51, 134176
    s_nop 0
    buffer_load_dwordx4 v245, s[12:15], s48 offen lds
    s_add_u32 s48, s48, 65536
    s_cmp_eq_u32 s48, s50
    s_cselect_b32 s48, s49, s48
    s_waitcnt vmcnt(12) lgkmcnt(0)
    s_barrier
    s_add_u32 m0, s55, 8192
    s_nop 0
    buffer_load_dwordx4 v249, s[80:83], s52 offen offset:0 sc1 lds
    buffer_load_dwordx4 v249, s[80:83], s52 offen offset:1024 sc1 lds
    s_add_u32 s52, s52, 8192
    s_cmp_eq_u32 s52, s54
    s_cselect_b32 s52, s53, s52
    s_add_u32 m0, s51, 141568
    s_nop 0
    buffer_load_dwordx4 v244, s[12:15], s48 offen lds
    s_add_u32 m0, s51, 142624
    s_nop 0
    buffer_load_dwordx4 v245, s[12:15], s48 offen lds
    s_add_u32 s48, s48, 65536
    s_cmp_eq_u32 s48, s50
    s_cselect_b32 s48, s49, s48
    s_add_u32 m0, s55, 16384
    s_nop 0
    buffer_load_dwordx4 v249, s[80:83], s52 offen offset:0 sc1 lds
    buffer_load_dwordx4 v249, s[80:83], s52 offen offset:1024 sc1 lds
    s_add_u32 s52, s52, 8192
    s_cmp_eq_u32 s52, s54
    s_cselect_b32 s52, s53, s52
    s_add_u32 m0, s51, 65536
    s_nop 0
    buffer_load_dwordx4 v244, s[12:15], s48 offen lds
    s_add_u32 m0, s51, 66592
    s_nop 0
    buffer_load_dwordx4 v245, s[12:15], s48 offen lds
    s_add_u32 s48, s48, 65536
    s_cmp_eq_u32 s48, s50
    s_cselect_b32 s48, s49, s48
    s_waitcnt vmcnt(12) lgkmcnt(0)
    s_barrier
    s_add_u32 m0, s55, 24576
    s_nop 0
    buffer_load_dwordx4 v249, s[80:83], s52 offen offset:0 sc1 lds
    buffer_load_dwordx4 v249, s[80:83], s52 offen offset:1024 sc1 lds
    s_add_u32 s52, s52, 8192
    s_cmp_eq_u32 s52, s54
    s_cselect_b32 s52, s53, s52
    s_add_u32 m0, s51, 73984
    s_nop 0
    buffer_load_dwordx4 v244, s[12:15], s48 offen lds
    s_add_u32 m0, s51, 75040
    s_nop 0
    buffer_load_dwordx4 v245, s[12:15], s48 offen lds
    s_add_u32 s48, s48, 65536
    s_cmp_eq_u32 s48, s50
    s_cselect_b32 s48, s49, s48
    s_add_u32 m0, s55, 32768
    s_nop 0
    buffer_load_dwordx4 v249, s[80:83], s52 offen offset:0 sc1 lds
    buffer_load_dwordx4 v249, s[80:83], s52 offen offset:1024 sc1 lds
    s_add_u32 s52, s52, 8192
    s_cmp_eq_u32 s52, s54
    s_cselect_b32 s52, s53, s52
    s_add_u32 m0, s51, 82432
    s_nop 0
    buffer_load_dwordx4 v244, s[12:15], s48 offen lds
    s_add_u32 m0, s51, 83488
    s_nop 0
    buffer_load_dwordx4 v245, s[12:15], s48 offen lds
    s_add_u32 s48, s48, 65536
    s_cmp_eq_u32 s48, s50
    s_cselect_b32 s48, s49, s48
    s_waitcnt vmcnt(12) lgkmcnt(0)
    s_barrier
    s_add_u32 m0, s55, 40960
    s_nop 0
    buffer_load_dwordx4 v249, s[80:83], s52 offen offset:0 sc1 lds
    buffer_load_dwordx4 v249, s[80:83], s52 offen offset:1024 sc1 lds
    s_add_u32 s52, s52, 8192
    s_cmp_eq_u32 s52, s54
    s_cselect_b32 s52, s53, s52
    s_add_u32 m0, s51, 90880
    s_nop 0
    buffer_load_dwordx4 v244, s[12:15], s48 offen lds
    s_add_u32 m0, s51, 91936
    s_nop 0
    buffer_load_dwordx4 v245, s[12:15], s48 offen lds
    s_add_u32 s48, s48, 65536
    s_cmp_eq_u32 s48, s50
    s_cselect_b32 s48, s49, s48
    s_add_u32 m0, s55, 49152
    s_nop 0
    buffer_load_dwordx4 v249, s[80:83], s52 offen offset:0 sc1 lds
    buffer_load_dwordx4 v249, s[80:83], s52 offen offset:1024 sc1 lds
    s_add_u32 s52, s52, 8192
    s_cmp_eq_u32 s52, s54
    s_cselect_b32 s52, s53, s52
    s_add_u32 m0, s51, 99328
    s_nop 0
    buffer_load_dwordx4 v244, s[12:15], s48 offen lds
    s_add_u32 m0, s51, 100384
    s_nop 0
    buffer_load_dwordx4 v245, s[12:15], s48 offen lds
    s_add_u32 s48, s48, 65536
    s_cmp_eq_u32 s48, s50
    s_cselect_b32 s48, s49, s48
    s_waitcnt vmcnt(12) lgkmcnt(0)
    s_barrier
    s_add_u32 m0, s55, 57344
    s_nop 0
    buffer_load_dwordx4 v249, s[80:83], s52 offen offset:0 sc1 lds
    buffer_load_dwordx4 v249, s[80:83], s52 offen offset:1024 sc1 lds
    s_add_u32 s52, s52, 8192
    s_cmp_eq_u32 s52, s54
    s_cselect_b32 s52, s53, s52
    s_add_u32 m0, s51, 107776
    s_nop 0
    buffer_load_dwordx4 v244, s[12:15], s48 offen lds
    s_add_u32 m0, s51, 108832
    s_nop 0
    buffer_load_dwordx4 v245, s[12:15], s48 offen lds
    s_add_u32 s48, s48, 65536
    s_cmp_eq_u32 s48, s50
    s_cselect_b32 s48, s49, s48
    s_add_u32 m0, s55, 0
    s_nop 0
    buffer_load_dwordx4 v249, s[80:83], s52 offen offset:0 sc1 lds
    buffer_load_dwordx4 v249, s[80:83], s52 offen offset:1024 sc1 lds
    s_add_u32 s52, s52, 8192
    s_cmp_eq_u32 s52, s54
    s_cselect_b32 s52, s53, s52
    s_add_u32 m0, s51, 116224
    s_nop 0
    buffer_load_dwordx4 v244, s[12:15], s48 offen lds
    s_add_u32 m0, s51, 117280
    s_nop 0
    buffer_load_dwordx4 v245, s[12:15], s48 offen lds
    s_add_u32 s48, s48, 65536
    s_cmp_eq_u32 s48, s50
    s_cselect_b32 s48, s49, s48
    s_waitcnt vmcnt(12) lgkmcnt(0)
    s_barrier
    s_add_u32 m0, s55, 8192
    s_nop 0
    buffer_load_dwordx4 v249, s[80:83], s52 offen offset:0 sc1 lds
    buffer_load_dwordx4 v249, s[80:83], s52 offen offset:1024 sc1 lds
    s_add_u32 s52, s52, 8192
    s_cmp_eq_u32 s52, s54
    s_cselect_b32 s52, s53, s52
    s_add_u32 m0, s51, 124672
    s_nop 0
    buffer_load_dwordx4 v244, s[12:15], s48 offen lds
    s_add_u32 m0, s51, 125728
    s_nop 0
    buffer_load_dwordx4 v245, s[12:15], s48 offen lds
    s_add_u32 s48, s48, 65536
    s_cmp_eq_u32 s48, s50
    s_cselect_b32 s48, s49, s48
    s_add_u32 m0, s55, 16384
    s_nop 0
    buffer_load_dwordx4 v249, s[80:83], s52 offen offset:0 sc1 lds
    buffer_load_dwordx4 v249, s[80:83], s52 offen offset:1024 sc1 lds
    s_add_u32 s52, s52, 8192
    s_cmp_eq_u32 s52, s54
    s_cselect_b32 s52, s53, s52
    s_add_u32 m0, s51, 133120
    s_nop 0
    buffer_load_dwordx4 v244, s[12:15], s48 offen lds
    s_add_u32 m0, s51, 134176
    s_nop 0
    buffer_load_dwordx4 v245, s[12:15], s48 offen lds
    s_add_u32 s48, s48, 65536
    s_cmp_eq_u32 s48, s50
    s_cselect_b32 s48, s49, s48
    s_waitcnt vmcnt(12) lgkmcnt(0)
    s_barrier
    s_add_u32 m0, s55, 24576
    s_nop 0
    buffer_load_dwordx4 v249, s[80:83], s52 offen offset:0 sc1 lds
    buffer_load_dwordx4 v249, s[80:83], s52 offen offset:1024 sc1 lds
    s_add_u32 s52, s52, 8192
    s_cmp_eq_u32 s52, s54
    s_cselect_b32 s52, s53, s52
    s_add_u32 m0, s51, 141568
    s_nop 0
    buffer_load_dwordx4 v244, s[12:15], s48 offen lds
    s_add_u32 m0, s51, 142624
    s_nop 0
    buffer_load_dwordx4 v245, s[12:15], s48 offen lds
    s_add_u32 s48, s48, 65536
    s_cmp_eq_u32 s48, s50
    s_cselect_b32 s48, s49, s48
    s_add_u32 m0, s55, 32768
    s_nop 0
    buffer_load_dwordx4 v249, s[80:83], s52 offen offset:0 sc1 lds
    buffer_load_dwordx4 v249, s[80:83], s52 offen offset:1024 sc1 lds
    s_add_u32 s52, s52, 8192
    s_cmp_eq_u32 s52, s54
    s_cselect_b32 s52, s53, s52
    s_add_u32 m0, s51, 65536
    s_nop 0
    buffer_load_dwordx4 v244, s[12:15], s48 offen lds
    s_add_u32 m0, s51, 66592
    s_nop 0
    buffer_load_dwordx4 v245, s[12:15], s48 offen lds
    s_add_u32 s48, s48, 65536
    s_cmp_eq_u32 s48, s50
    s_cselect_b32 s48, s49, s48
    s_waitcnt vmcnt(12) lgkmcnt(0)
    s_barrier
    s_add_u32 m0, s55, 40960
    s_nop 0
    buffer_load_dwordx4 v249, s[80:83], s52 offen offset:0 sc1 lds
    buffer_load_dwordx4 v249, s[80:83], s52 offen offset:1024 sc1 lds
    s_add_u32 s52, s52, 8192
    s_cmp_eq_u32 s52, s54
    s_cselect_b32 s52, s53, s52
    s_add_u32 m0, s51, 73984
    s_nop 0
    buffer_load_dwordx4 v244, s[12:15], s48 offen lds
    s_add_u32 m0, s51, 75040
    s_nop 0
    buffer_load_dwordx4 v245, s[12:15], s48 offen lds
    s_add_u32 s48, s48, 65536
    s_cmp_eq_u32 s48, s50
    s_cselect_b32 s48, s49, s48
    s_add_u32 m0, s55, 49152
    s_nop 0
    buffer_load_dwordx4 v249, s[80:83], s52 offen offset:0 sc1 lds
    buffer_load_dwordx4 v249, s[80:83], s52 offen offset:1024 sc1 lds
    s_add_u32 s52, s52, 8192
    s_cmp_eq_u32 s52, s54
    s_cselect_b32 s52, s53, s52
    s_add_u32 m0, s51, 82432
    s_nop 0
    buffer_load_dwordx4 v244, s[12:15], s48 offen lds
    s_add_u32 m0, s51, 83488
    s_nop 0
    buffer_load_dwordx4 v245, s[12:15], s48 offen lds
    s_add_u32 s48, s48, 65536
    s_cmp_eq_u32 s48, s50
    s_cselect_b32 s48, s49, s48
    s_waitcnt vmcnt(12) lgkmcnt(0)
    s_barrier
    s_add_u32 m0, s55, 57344
    s_nop 0
    buffer_load_dwordx4 v249, s[80:83], s52 offen offset:0 sc1 lds
    buffer_load_dwordx4 v249, s[80:83], s52 offen offset:1024 sc1 lds
    s_add_u32 s52, s52, 8192
    s_cmp_eq_u32 s52, s54
    s_cselect_b32 s52, s53, s52
    s_add_u32 m0, s51, 90880
    s_nop 0
    buffer_load_dwordx4 v244, s[12:15], s48 offen lds
    s_add_u32 m0, s51, 91936
    s_nop 0
    buffer_load_dwordx4 v245, s[12:15], s48 offen lds
    s_add_u32 s48, s48, 65536
    s_cmp_eq_u32 s48, s50
    s_cselect_b32 s48, s49, s48
    s_add_u32 m0, s55, 0
    s_nop 0
    buffer_load_dwordx4 v249, s[80:83], s52 offen offset:0 sc1 lds
    buffer_load_dwordx4 v249, s[80:83], s52 offen offset:1024 sc1 lds
    s_add_u32 s52, s52, 8192
    s_cmp_eq_u32 s52, s54
    s_cselect_b32 s52, s53, s52
    s_add_u32 m0, s51, 99328
    s_nop 0
    buffer_load_dwordx4 v244, s[12:15], s48 offen lds
    s_add_u32 m0, s51, 100384
    s_nop 0
    buffer_load_dwordx4 v245, s[12:15], s48 offen lds
    s_add_u32 s48, s48, 65536
    s_cmp_eq_u32 s48, s50
    s_cselect_b32 s48, s49, s48
    s_waitcnt vmcnt(12) lgkmcnt(0)
    s_barrier
    s_add_u32 m0, s55, 8192
    s_nop 0
    buffer_load_dwordx4 v249, s[80:83], s52 offen offset:0 sc1 lds
    buffer_load_dwordx4 v249, s[80:83], s52 offen offset:1024 sc1 lds
    s_add_u32 s52, s52, 8192
    s_cmp_eq_u32 s52, s54
    s_cselect_b32 s52, s53, s52
    s_add_u32 m0, s51, 107776
    s_nop 0
    buffer_load_dwordx4 v244, s[12:15], s48 offen lds
    s_add_u32 m0, s51, 108832
    s_nop 0
    buffer_load_dwordx4 v245, s[12:15], s48 offen lds
    s_add_u32 s48, s48, 65536
    s_cmp_eq_u32 s48, s50
    s_cselect_b32 s48, s49, s48
    s_add_u32 m0, s55, 16384
    s_nop 0
    buffer_load_dwordx4 v249, s[80:83], s52 offen offset:0 sc1 lds
    buffer_load_dwordx4 v249, s[80:83], s52 offen offset:1024 sc1 lds
    s_add_u32 s52, s52, 8192
    s_cmp_eq_u32 s52, s54
    s_cselect_b32 s52, s53, s52
    s_add_u32 m0, s51, 116224
    s_nop 0
    buffer_load_dwordx4 v244, s[12:15], s48 offen lds
    s_add_u32 m0, s51, 117280
    s_nop 0
    buffer_load_dwordx4 v245, s[12:15], s48 offen lds
    s_add_u32 s48, s48, 65536
    s_cmp_eq_u32 s48, s50
    s_cselect_b32 s48, s49, s48
    s_waitcnt vmcnt(12) lgkmcnt(0)
    s_barrier
    s_add_u32 m0, s55, 24576
    s_nop 0
    buffer_load_dwordx4 v249, s[80:83], s52 offen offset:0 sc1 lds
    buffer_load_dwordx4 v249, s[80:83], s52 offen offset:1024 sc1 lds
    s_add_u32 s52, s52, 8192
    s_cmp_eq_u32 s52, s54
    s_cselect_b32 s52, s53, s52
    s_add_u32 m0, s51, 124672
    s_nop 0
    buffer_load_dwordx4 v244, s[12:15], s48 offen lds
    s_add_u32 m0, s51, 125728
    s_nop 0
    buffer_load_dwordx4 v245, s[12:15], s48 offen lds
    s_add_u32 s48, s48, 65536
    s_cmp_eq_u32 s48, s50
    s_cselect_b32 s48, s49, s48
    s_add_u32 m0, s55, 32768
    s_nop 0
    buffer_load_dwordx4 v249, s[80:83], s52 offen offset:0 sc1 lds
    buffer_load_dwordx4 v249, s[80:83], s52 offen offset:1024 sc1 lds
    s_add_u32 s52, s52, 8192
    s_cmp_eq_u32 s52, s54
    s_cselect_b32 s52, s53, s52
    s_add_u32 m0, s51, 133120
    s_nop 0
    buffer_load_dwordx4 v244, s[12:15], s48 offen lds
    s_add_u32 m0, s51, 134176
    s_nop 0
    buffer_load_dwordx4 v245, s[12:15], s48 offen lds
    s_add_u32 s48, s48, 65536
    s_cmp_eq_u32 s48, s50
    s_cselect_b32 s48, s49, s48
    s_waitcnt vmcnt(12) lgkmcnt(0)
    s_barrier
    s_add_u32 m0, s55, 40960
    s_nop 0
    buffer_load_dwordx4 v249, s[80:83], s52 offen offset:0 sc1 lds
    buffer_load_dwordx4 v249, s[80:83], s52 offen offset:1024 sc1 lds
    s_add_u32 s52, s52, 8192
    s_cmp_eq_u32 s52, s54
    s_cselect_b32 s52, s53, s52
    s_add_u32 m0, s51, 141568
    s_nop 0
    buffer_load_dwordx4 v244, s[12:15], s48 offen lds
    s_add_u32 m0, s51, 142624
    s_nop 0
    buffer_load_dwordx4 v245, s[12:15], s48 offen lds
    s_add_u32 s48, s48, 65536
    s_cmp_eq_u32 s48, s50
    s_cselect_b32 s48, s49, s48
    s_add_u32 m0, s55, 49152
    s_nop 0
    buffer_load_dwordx4 v249, s[80:83], s52 offen offset:0 sc1 lds
    buffer_load_dwordx4 v249, s[80:83], s52 offen offset:1024 sc1 lds
    s_add_u32 s52, s52, 8192
    s_cmp_eq_u32 s52, s54
    s_cselect_b32 s52, s53, s52
    s_add_u32 m0, s51, 65536
    s_nop 0
    buffer_load_dwordx4 v244, s[12:15], s48 offen lds
    s_add_u32 m0, s51, 66592
    s_nop 0
    buffer_load_dwordx4 v245, s[12:15], s48 offen lds
    s_add_u32 s48, s48, 65536
    s_cmp_eq_u32 s48, s50
    s_cselect_b32 s48, s49, s48
    s_waitcnt vmcnt(12) lgkmcnt(0)
    s_barrier
    v_lshlrev_b32 v253, 7, v250
    s_lshl_b32 s64, s73, 4
    s_add_u32 s64, s64, s74
    s_lshl_b32 s64, s64, 2
    s_add_u32 s64, s64, s69
    s_lshl_b32 s64, s64, 13
    s_lshl_b32 s66, s60, 23
    s_add_u32 s64, s64, s66
    s_add_u32 s64, s64, 54525952
    buffer_load_dword v240, v253, s[80:83], s64 offen sc1
    s_lshl_b32 s64, s73, 4
    s_add_u32 s64, s64, s68
    s_lshl_b32 s64, s64, 14
    s_mul_i32 s66, s59, 4194304
    s_add_u32 s64, s64, s66
    s_lshl_b32 s65, s69, 12
    s_add_u32 s64, s64, s65
    s_lshl_b32 s65, s70, 1
    s_sub_u32 s65, s68, s65
    s_and_b32 s65, s65, 15
    s_cmp_lt_u32 s65, 16
    s_cselect_b32 s64, s64, 0x7f000000
    v_lshlrev_b32 v253, 7, v250
    s_mov_b64 exec, 0xffffffff
    buffer_load_dword v241, v253, s[80:83], s64 offen sc1
    s_mov_b64 exec, -1
    s_waitcnt vmcnt(2) lgkmcnt(0)
    s_barrier
    s_add_u32 m0, s19, 86400
    s_nop 0
    buffer_load_dwordx4 v10, s[8:11], s16 offen lds
    s_add_u32 m0, s19, 87424
    s_nop 0
    buffer_load_dwordx4 v11, s[8:11], s16 offen lds
    s_add_u32 m0, s19, 88448
    s_nop 0
    buffer_load_dwordx4 v12, s[8:11], s16 offen lds
    s_add_u32 s16, s16, 196608
    s_cmp_eq_u32 s16, s18
    s_cselect_b32 s16, s17, s16
    s_add_u32 m0, s19, 98816
    s_nop 0
    buffer_load_dwordx4 v10, s[8:11], s16 offen lds
    s_add_u32 m0, s19, 99840
    s_nop 0
    buffer_load_dwordx4 v11, s[8:11], s16 offen lds
    s_add_u32 m0, s19, 100864
    s_nop 0
    buffer_load_dwordx4 v12, s[8:11], s16 offen lds
    s_add_u32 s16, s16, 196608
    s_cmp_eq_u32 s16, s18
    s_cselect_b32 s16, s17, s16
    s_add_u32 m0, s19, 111232
    s_nop 0
    buffer_load_dwordx4 v10, s[8:11], s16 offen lds
    s_add_u32 m0, s19, 112256
    s_nop 0
    buffer_load_dwordx4 v11, s[8:11], s16 offen lds
    s_add_u32 m0, s19, 113280
    s_nop 0
    buffer_load_dwordx4 v12, s[8:11], s16 offen lds
    s_add_u32 s16, s16, 196608
    s_cmp_eq_u32 s16, s18
    s_cselect_b32 s16, s17, s16
    s_cmp_eq_u32 s75, 1
    s_cbranch_scc1 L_fin
    s_mov_b32 s75, 1
    s_mov_b32 s59, s78
    s_mul_i32 s60, s59, s75
    s_lshl_b32 s21, s73, 18
    s_lshl_b32 s64, s59, 22
    s_add_u32 s21, s21, s64
    s_lshl_b32 s64, s69, 11
    s_add_u32 s21, s21, s64
    s_lshl_b32 s23, s69, 12
    s_add_u32 s23, s23, 2048
    s_add_u32 s22, s21, 262144
    s_lshl_b32 s64, s70, 1
    s_lshl_b32 s65, s64, 14
    s_add_u32 s20, s21, s65
    s_sub_u32 s28, s73, 1
    s_and_b32 s28, s28, 15
    s_lshl_b32 s26, s28, 15
    s_add_u32 s26, s26, 73400320
    s_lshl_b32 s27, s64, 11
    s_lshl_b32 s64, s73, 9
    s_add_u32 s64, s64, 75522048
    v_lshlrev_b32 v246, 5, v250
    s_mov_b64 exec, 0xffff
pl_1051:
    buffer_load_dwordx4 v[240:243], v246, s[80:83], s64 offen sc1
    s_sub_u32 s79, s79, 1
    s_cbranch_scc1 L_abort
    s_waitcnt vmcnt(0)
    v_and_b32 v240, v240, v241
    v_and_b32 v242, v242, v243
    v_and_b32 v240, v240, v242
    v_cmp_ne_u32 vcc, 1, v240
    s_cbranch_vccnz pl_1051
    s_mov_b64 exec, -1
    s_cmp_lg_u32 s78, 0
    s_cbranch_scc1 pl_1051_acq
pl_1051_ok:
    s_lshl_b32 s64, s28, 9
    s_add_u32 s64, s64, 75571200
    s_mov_b64 exec, 0xffff
pl_1052:
    buffer_load_dwordx2 v[240:241], v246, s[80:83], s64 offen sc1
    s_sub_u32 s79, s79, 1
    s_cbranch_scc1 L_abort
    s_waitcnt vmcnt(0)
    v_and_b32 v240, v240, v241
    v_cmp_ne_u32 vcc, 1, v240
    s_cbranch_vccnz pl_1052
    s_mov_b64 exec, -1
    s_cmp_lg_u32 s78, 0
    s_cbranch_scc1 pl_1052_acq
pl_1052_ok:
    s_cmp_lg_u32 s69, 0
    s_cbranch_scc1 nh_1053
    s_add_u32 s64, s27, 0
    s_and_b32 s64, s64, 0x7fff
    s_mov_b32 m0, 18432
    s_add_u32 s64, s64, s26
    buffer_load_dwordx4 v249, s[80:83], s64 offen sc0 sc1 lds
nh_1053:
    s_add_u32 m0, s23, 18432
    s_nop 0
    buffer_load_dwordx4 v249, s[80:83], s20 offen offset:0 sc1 lds
    s_add_u32 m0, s23, 19456
    s_nop 0
    buffer_load_dwordx4 v249, s[80:83], s20 offen offset:1024 sc1 lds
    s_add_u32 s20, s20, 8192
    s_cmp_eq_u32 s20, s22
    s_cselect_b32 s20, s21, s20
    s_cmp_lg_u32 s69, 1
    s_cbranch_scc1 nh_1054
    s_add_u32 s64, s27, 1024
    s_and_b32 s64, s64, 0x7fff
    s_mov_b32 m0, 19456
    s_add_u32 s64, s64, s26
    buffer_load_dwordx4 v249, s[80:83], s64 offen sc0 sc1 lds
nh_1054:
    s_add_u32 m0, s23, 19456
    s_nop 0
    buffer_load_dwordx4 v249, s[80:83], s20 offen offset:0 sc1 lds
    s_add_u32 m0, s23, 20480
    s_nop 0
    buffer_load_dwordx4 v249, s[80:83], s20 offen offset:1024 sc1 lds
    s_add_u32 s20, s20, 8192
    s_cmp_eq_u32 s20, s22
    s_cselect_b32 s20, s21, s20
    s_cmp_lg_u32 s69, 2
    s_cbranch_scc1 nh_1055
    s_add_u32 s64, s27, 2048
    s_and_b32 s64, s64, 0x7fff
    s_mov_b32 m0, 36864
    s_add_u32 s64, s64, s26
    buffer_load_dwordx4 v249, s[80:83], s64 offen sc0 sc1 lds
nh_1055:
    s_add_u32 m0, s23, 36864
    s_nop 0
    buffer_load_dwordx4 v249, s[80:83], s20 offen offset:0 sc1 lds
    s_add_u32 m0, s23, 37888
    s_nop 0
    buffer_load_dwordx4 v249, s[80:83], s20 offen offset:1024 sc1 lds
    s_add_u32 s20, s20, 8192
    s_cmp_eq_u32 s20, s22
    s_cselect_b32 s20, s21, s20
    s_waitcnt vmcnt(4) lgkmcnt(0)
    s_barrier
    s_cmp_lg_u32 s69, 3
    s_cbranch_scc1 nh_1056
    s_add_u32 s64, s27, 3072
    s_and_b32 s64, s64, 0x7fff
    s_mov_b32 m0, 37888
    s_add_u32 s64, s64, s26
    buffer_load_dwordx4 v249, s[80:83], s64 offen sc0 sc1 lds
nh_1056:
    s_add_u32 m0, s23, 37888
    s_nop 0
    buffer_load_dwordx4 v249, s[80:83], s20 offen offset:0 sc1 lds
    s_add_u32 m0, s23, 38912
    s_nop 0
    buffer_load_dwordx4 v249, s[80:83], s20 offen offset:1024 sc1 lds
    s_add_u32 s20, s20, 8192
    s_cmp_eq_u32 s20, s22
    s_cselect_b32 s20, s21, s20
    s_add_u32 m0, s19, 123648
    s_nop 0
    buffer_load_dwordx4 v10, s[8:11], s16 offen lds
    s_add_u32 m0, s19, 124672
    s_nop 0
    buffer_load_dwordx4 v11, s[8:11], s16 offen lds
    s_add_u32 m0, s19, 125696
    s_nop 0
    buffer_load_dwordx4 v12, s[8:11], s16 offen lds
    s_add_u32 s16, s16, 196608
    s_cmp_eq_u32 s16, s18
    s_cselect_b32 s16, s17, s16
    s_waitcnt vmcnt(5) lgkmcnt(0)
    s_barrier
    s_cmp_lg_u32 s69, 0
    s_cbranch_scc1 nh_1057
    s_add_u32 s64, s27, 4096
    s_and_b32 s64, s64, 0x7fff
    s_mov_b32 m0, 55296
    s_add_u32 s64, s64, s26
    buffer_load_dwordx4 v249, s[80:83], s64 offen sc0 sc1 lds
nh_1057:
    s_add_u32 m0, s23, 55296
    s_nop 0
    buffer_load_dwordx4 v249, s[80:83], s20 offen offset:0 sc1 lds
    s_add_u32 m0, s23, 56320
    s_nop 0
    buffer_load_dwordx4 v249, s[80:83], s20 offen offset:1024 sc1 lds
    s_add_u32 s20, s20, 8192
    s_cmp_eq_u32 s20, s22
    s_cselect_b32 s20, s21, s20
    s_add_u32 m0, s19, 136064
    s_nop 0
    buffer_load_dwordx4 v10, s[8:11], s16 offen lds
    s_add_u32 m0, s19, 137088
    s_nop 0
    buffer_load_dwordx4 v11, s[8:11], s16 offen lds
    s_add_u32 m0, s19, 138112
    s_nop 0
    buffer_load_dwordx4 v12, s[8:11], s16 offen lds
    s_add_u32 s16, s16, 196608
    s_cmp_eq_u32 s16, s18
    s_cselect_b32 s16, s17, s16
    s_cmp_lg_u32 s69, 1
    s_cbranch_scc1 nh_1058
    s_add_u32 s64, s27, 5120
    s_and_b32 s64, s64, 0x7fff
    s_mov_b32 m0, 56320
    s_add_u32 s64, s64, s26
    buffer_load_dwordx4 v249, s[80:83], s64 offen sc0 sc1 lds
nh_1058:
    s_add_u32 m0, s23, 56320
    s_nop 0
    buffer_load_dwordx4 v249, s[80:83], s20 offen offset:0 sc1 lds
    s_add_u32 m0, s23, 57344
    s_nop 0
    buffer_load_dwordx4 v249, s[80:83], s20 offen offset:1024 sc1 lds
    s_add_u32 s20, s20, 8192
    s_cmp_eq_u32 s20, s22
    s_cselect_b32 s20, s21, s20
    s_add_u32 m0, s19, 73984
    s_nop 0
    buffer_load_dwordx4 v10, s[8:11], s16 offen lds
    s_add_u32 m0, s19, 75008
    s_nop 0
    buffer_load_dwordx4 v11, s[8:11], s16 offen lds
    s_add_u32 m0, s19, 76032
    s_nop 0
    buffer_load_dwordx4 v12, s[8:11], s16 offen lds
    s_add_u32 s16, s16, 196608
    s_cmp_eq_u32 s16, s18
    s_cselect_b32 s16, s17, s16
    s_cmp_lg_u32 s69, 2
    s_cbranch_scc1 nh_1059
    s_add_u32 s64, s27, 6144
    s_and_b32 s64, s64, 0x7fff
    s_mov_b32 m0, 0
    s_add_u32 s64, s64, s26
    buffer_load_dwordx4 v249, s[80:83], s64 offen sc0 sc1 lds
nh_1059:
    s_add_u32 m0, s23, 0
    s_nop 0
    buffer_load_dwordx4 v249, s[80:83], s20 offen offset:0 sc1 lds
    s_add_u32 m0, s23, 1024
    s_nop 0
    buffer_load_dwordx4 v249, s[80:83], s20 offen offset:1024 sc1 lds
    s_add_u32 s20, s20, 8192
    s_cmp_eq_u32 s20, s22
    s_cselect_b32 s20, s21, s20
    s_waitcnt vmcnt(7) lgkmcnt(0)
    s_barrier
    s_add_u32 m0, s19, 86400
    s_nop 0
    buffer_load_dwordx4 v10, s[8:11], s16 offen lds
    s_add_u32 m0, s19, 87424
    s_nop 0
    buffer_load_dwordx4 v11, s[8:11], s16 offen lds
    s_add_u32 m0, s19, 88448
    s_nop 0
    buffer_load_dwordx4 v12, s[8:11], s16 offen lds
    s_add_u32 s16, s16, 196608
    s_cmp_eq_u32 s16, s18
    s_cselect_b32 s16, s17, s16
    s_cmp_lg_u32 s69, 3
    s_cbranch_scc1 nh_1060
    s_add_u32 s64, s27, 7168
    s_and_b32 s64, s64, 0x7fff
    s_mov_b32 m0, 1024
    s_add_u32 s64, s64, s26
    buffer_load_dwordx4 v249, s[80:83], s64 offen sc0 sc1 lds
nh_1060:
    s_add_u32 m0, s23, 1024
    s_nop 0
    buffer_load_dwordx4 v249, s[80:83], s20 offen offset:0 sc1 lds
    s_add_u32 m0, s23, 2048
    s_nop 0
    buffer_load_dwordx4 v249, s[80:83], s20 offen offset:1024 sc1 lds
    s_add_u32 s20, s20, 8192
    s_cmp_eq_u32 s20, s22
    s_cselect_b32 s20, s21, s20
    s_add_u32 m0, s19, 98816
    s_nop 0
    buffer_load_dwordx4 v10, s[8:11], s16 offen lds
    s_add_u32 m0, s19, 99840
    s_nop 0
    buffer_load_dwordx4 v11, s[8:11], s16 offen lds
    s_add_u32 m0, s19, 100864
    s_nop 0
    buffer_load_dwordx4 v12, s[8:11], s16 offen lds
    s_add_u32 s16, s16, 196608
    s_cmp_eq_u32 s16, s18
    s_cselect_b32 s16, s17, s16
    s_cmp_lg_u32 s69, 0
    s_cbranch_scc1 nh_1061
    s_add_u32 s64, s27, 8192
    s_and_b32 s64, s64, 0x7fff
    s_mov_b32 m0, 18432
    s_add_u32 s64, s64, s26
    buffer_load_dwordx4 v249, s[80:83], s64 offen sc0 sc1 lds
nh_1061:
    s_add_u32 m0, s23, 18432
    s_nop 0
    buffer_load_dwordx4 v249, s[80:83], s20 offen offset:0 sc1 lds
    s_add_u32 m0, s23, 19456
    s_nop 0
    buffer_load_dwordx4 v249, s[80:83], s20 offen offset:1024 sc1 lds
    s_add_u32 s20, s20, 8192
    s_cmp_eq_u32 s20, s22
    s_cselect_b32 s20, s21, s20
    s_add_u32 m0, s19, 111232
    s_nop 0
    buffer_load_dwordx4 v10, s[8:11], s16 offen lds
    s_add_u32 m0, s19, 112256
    s_nop 0
    buffer_load_dwordx4 v11, s[8:11], s16 offen lds
    s_add_u32 m0, s19, 113280
    s_nop 0
    buffer_load_dwordx4 v12, s[8:11], s16 offen lds
    s_add_u32 s16, s16, 196608
    s_cmp_eq_u32 s16, s18
    s_cselect_b32 s16, s17, s16
    s_waitcnt vmcnt(10) lgkmcnt(0)
    s_barrier
    s_cmp_lg_u32 s69, 1
    s_cbranch_scc1 nh_1062
    s_add_u32 s64, s27, 9216
    s_and_b32 s64, s64, 0x7fff
    s_mov_b32 m0, 19456
    s_add_u32 s64, s64, s26
    buffer_load_dwordx4 v249, s[80:83], s64 offen sc0 sc1 lds
nh_1062:
    s_add_u32 m0, s23, 19456
    s_nop 0
    buffer_load_dwordx4 v249, s[80:83], s20 offen offset:0 sc1 lds
    s_add_u32 m0, s23, 20480
    s_nop 0
    buffer_load_dwordx4 v249, s[80:83], s20 offen offset:1024 sc1 lds
    s_add_u32 s20, s20, 8192
    s_cmp_eq_u32 s20, s22
    s_cselect_b32 s20, s21, s20
    s_add_u32 m0, s19, 123648
    s_nop 0
    buffer_load_dwordx4 v10, s[8:11], s16 offen lds
    s_add_u32 m0, s19, 124672
    s_nop 0
    buffer_load_dwordx4 v11, s[8:11], s16 offen lds
    s_add_u32 m0, s19, 125696
    s_nop 0
    buffer_load_dwordx4 v12, s[8:11], s16 offen lds
    s_add_u32 s16, s16, 196608
    s_cmp_eq_u32 s16, s18
    s_cselect_b32 s16, s17, s16
    s_cmp_lg_u32 s69, 2
    s_cbranch_scc1 nh_1063
    s_add_u32 s64, s27, 10240
    s_and_b32 s64, s64, 0x7fff
    s_mov_b32 m0, 36864
    s_add_u32 s64, s64, s26
    buffer_load_dwordx4 v249, s[80:83], s64 offen sc0 sc1 lds
nh_1063:
    s_add_u32 m0, s23, 36864
    s_nop 0
    buffer_load_dwordx4 v249, s[80:83], s20 offen offset:0 sc1 lds
    s_add_u32 m0, s23, 37888
    s_nop 0
    buffer_load_dwordx4 v249, s[80:83], s20 offen offset:1024 sc1 lds
    s_add_u32 s20, s20, 8192
    s_cmp_eq_u32 s20, s22
    s_cselect_b32 s20, s21, s20
    s_add_u32 m0, s19, 136064
    s_nop 0
    buffer_load_dwordx4 v10, s[8:11], s16 offen lds
    s_add_u32 m0, s19, 137088
    s_nop 0
    buffer_load_dwordx4 v11, s[8:11], s16 offen lds
    s_add_u32 m0, s19, 138112
    s_nop 0
    buffer_load_dwordx4 v12, s[8:11], s16 offen lds
    s_add_u32 s16, s16, 196608
    s_cmp_eq_u32 s16, s18
    s_cselect_b32 s16, s17, s16
    s_cmp_lg_u32 s69, 3
    s_cbranch_scc1 nh_1064
    s_add_u32 s64, s27, 11264
    s_and_b32 s64, s64, 0x7fff
    s_mov_b32 m0, 37888
    s_add_u32 s64, s64, s26
    buffer_load_dwordx4 v249, s[80:83], s64 offen sc0 sc1 lds
nh_1064:
    s_add_u32 m0, s23, 37888
    s_nop 0
    buffer_load_dwordx4 v249, s[80:83], s20 offen offset:0 sc1 lds
    s_add_u32 m0, s23, 38912
    s_nop 0
    buffer_load_dwordx4 v249, s[80:83], s20 offen offset:1024 sc1 lds
    s_add_u32 s20, s20, 8192
    s_cmp_eq_u32 s20, s22
    s_cselect_b32 s20, s21, s20
    s_waitcnt vmcnt(12) lgkmcnt(0)
    s_barrier
    s_add_u32 m0, s19, 73984
    s_nop 0
    buffer_load_dwordx4 v10, s[8:11], s16 offen lds
    s_add_u32 m0, s19, 75008
    s_nop 0
    buffer_load_dwordx4 v11, s[8:11], s16 offen lds
    s_add_u32 m0, s19, 76032
    s_nop 0
    buffer_load_dwordx4 v12, s[8:11], s16 offen lds
    s_add_u32 s16, s16, 196608
    s_cmp_eq_u32 s16, s18
    s_cselect_b32 s16, s17, s16
    s_cmp_lg_u32 s69, 0
    s_cbranch_scc1 nh_1065
    s_add_u32 s64, s27, 12288
    s_and_b32 s64, s64, 0x7fff
    s_mov_b32 m0, 55296
    s_add_u32 s64, s64, s26
    buffer_load_dwordx4 v249, s[80:83], s64 offen sc0 sc1 lds
nh_1065:
    s_add_u32 m0, s23, 55296
    s_nop 0
    buffer_load_dwordx4 v249, s[80:83], s20 offen offset:0 sc1 lds
    s_add_u32 m0, s23, 56320
    s_nop 0
    buffer_load_dwordx4 v249, s[80:83], s20 offen offset:1024 sc1 lds
    s_add_u32 s20, s20, 8192
    s_cmp_eq_u32 s20, s22
    s_cselect_b32 s20, s21, s20
    s_add_u32 m0, s19, 86400
    s_nop 0
    buffer_load_dwordx4 v10, s[8:11], s16 offen lds
    s_add_u32 m0, s19, 87424
    s_nop 0
    buffer_load_dwordx4 v11, s[8:11], s16 offen lds
    s_add_u32 m0, s19, 88448
    s_nop 0
    buffer_load_dwordx4 v12, s[8:11], s16 offen lds
    s_add_u32 s16, s16, 196608
    s_cmp_eq_u32 s16, s18
    s_cselect_b32 s16, s17, s16
    s_cmp_lg_u32 s69, 1
    s_cbranch_scc1 nh_1066
    s_add_u32 s64, s27, 13312
    s_and_b32 s64, s64, 0x7fff
    s_mov_b32 m0, 56320
    s_add_u32 s64, s64, s26
    buffer_load_dwordx4 v249, s[80:83], s64 offen sc0 sc1 lds
nh_1066:
    s_add_u32 m0, s23, 56320
    s_nop 0
    buffer_load_dwordx4 v249, s[80:83], s20 offen offset:0 sc1 lds
    s_add_u32 m0, s23, 57344
    s_nop 0
    buffer_load_dwordx4 v249, s[80:83], s20 offen offset:1024 sc1 lds
    s_add_u32 s20, s20, 8192
    s_cmp_eq_u32 s20, s22
    s_cselect_b32 s20, s21, s20
    s_waitcnt vmcnt(12) lgkmcnt(0)
    s_barrier
    s_add_u32 m0, s19, 98816
    s_nop 0
    buffer_load_dwordx4 v10, s[8:11], s16 offen lds
    s_add_u32 m0, s19, 99840
    s_nop 0
    buffer_load_dwordx4 v11, s[8:11], s16 offen lds
    s_add_u32 m0, s19, 100864
    s_nop 0
    buffer_load_dwordx4 v12, s[8:11], s16 offen lds
    s_add_u32 s16, s16, 196608
    s_cmp_eq_u32 s16, s18
    s_cselect_b32 s16, s17, s16
    s_cmp_lg_u32 s69, 2
    s_cbranch_scc1 nh_1067
    s_add_u32 s64, s27, 14336
    s_and_b32 s64, s64, 0x7fff
    s_mov_b32 m0, 0
    s_add_u32 s64, s64, s26
    buffer_load_dwordx4 v249, s[80:83], s64 offen sc0 sc1 lds
nh_1067:
    s_add_u32 m0, s23, 0
    s_nop 0
    buffer_load_dwordx4 v249, s[80:83], s20 offen offset:0 sc1 lds
    s_add_u32 m0, s23, 1024
    s_nop 0
    buffer_load_dwordx4 v249, s[80:83], s20 offen offset:1024 sc1 lds
    s_add_u32 s20, s20, 8192
    s_cmp_eq_u32 s20, s22
    s_cselect_b32 s20, s21, s20
    s_add_u32 m0, s19, 111232
    s_nop 0
    buffer_load_dwordx4 v10, s[8:11], s16 offen lds
    s_add_u32 m0, s19, 112256
    s_nop 0
    buffer_load_dwordx4 v11, s[8:11], s16 offen lds
    s_add_u32 m0, s19, 113280
    s_nop 0
    buffer_load_dwordx4 v12, s[8:11], s16 offen lds
    s_add_u32 s16, s16, 196608
    s_cmp_eq_u32 s16, s18
    s_cselect_b32 s16, s17, s16
    s_cmp_lg_u32 s69, 3
    s_cbranch_scc1 nh_1068
    s_add_u32 s64, s27, 15360
    s_and_b32 s64, s64, 0x7fff
    s_mov_b32 m0, 1024
    s_add_u32 s64, s64, s26
    buffer_load_dwordx4 v249, s[80:83], s64 offen sc0 sc1 lds
nh_1068:
    s_add_u32 m0, s23, 1024
    s_nop 0
    buffer_load_dwordx4 v249, s[80:83], s20 offen offset:0 sc1 lds
    s_add_u32 m0, s23, 2048
    s_nop 0
    buffer_load_dwordx4 v249, s[80:83], s20 offen offset:1024 sc1 lds
    s_add_u32 s20, s20, 8192
    s_cmp_eq_u32 s20, s22
    s_cselect_b32 s20, s21, s20
    s_waitcnt vmcnt(12) lgkmcnt(0)
    s_barrier
    s_add_u32 m0, s19, 123648
    s_nop 0
    buffer_load_dwordx4 v10, s[8:11], s16 offen lds
    s_add_u32 m0, s19, 124672
    s_nop 0
    buffer_load_dwordx4 v11, s[8:11], s16 offen lds
    s_add_u32 m0, s19, 125696
    s_nop 0
    buffer_load_dwordx4 v12, s[8:11], s16 offen lds
    s_add_u32 s16, s16, 196608
    s_cmp_eq_u32 s16, s18
    s_cselect_b32 s16, s17, s16
    s_cmp_lg_u32 s69, 0
    s_cbranch_scc1 nh_1069
    s_add_u32 s64, s27, 16384
    s_and_b32 s64, s64, 0x7fff
    s_mov_b32 m0, 18432
    s_add_u32 s64, s64, s26
    buffer_load_dwordx4 v249, s[80:83], s64 offen sc0 sc1 lds
nh_1069:
    s_add_u32 m0, s23, 18432
    s_nop 0
    buffer_load_dwordx4 v249, s[80:83], s20 offen offset:0 sc1 lds
    s_add_u32 m0, s23, 19456
    s_nop 0
    buffer_load_dwordx4 v249, s[80:83], s20 offen offset:1024 sc1 lds
    s_add_u32 s20, s20, 8192
    s_cmp_eq_u32 s20, s22
    s_cselect_b32 s20, s21, s20
    s_add_u32 m0, s19, 136064
    s_nop 0
    buffer_load_dwordx4 v10, s[8:11], s16 offen lds
    s_add_u32 m0, s19, 137088
    s_nop 0
    buffer_load_dwordx4 v11, s[8:11], s16 offen lds
    s_add_u32 m0, s19, 138112
    s_nop 0
    buffer_load_dwordx4 v12, s[8:11], s16 offen lds
    s_add_u32 s16, s16, 196608
    s_cmp_eq_u32 s16, s18
    s_cselect_b32 s16, s17, s16
    s_cmp_lg_u32 s69, 1
    s_cbranch_scc1 nh_1070
    s_add_u32 s64, s27, 17408
    s_and_b32 s64, s64, 0x7fff
    s_mov_b32 m0, 19456
    s_add_u32 s64, s64, s26
    buffer_load_dwordx4 v249, s[80:83], s64 offen sc0 sc1 lds
nh_1070:
    s_add_u32 m0, s23, 19456
    s_nop 0
    buffer_load_dwordx4 v249, s[80:83], s20 offen offset:0 sc1 lds
    s_add_u32 m0, s23, 20480
    s_nop 0
    buffer_load_dwordx4 v249, s[80:83], s20 offen offset:1024 sc1 lds
    s_add_u32 s20, s20, 8192
    s_cmp_eq_u32 s20, s22
    s_cselect_b32 s20, s21, s20
    s_waitcnt vmcnt(12) lgkmcnt(0)
    s_barrier
    s_add_u32 m0, s19, 73984
    s_nop 0
    buffer_load_dwordx4 v10, s[8:11], s16 offen lds
    s_add_u32 m0, s19, 75008
    s_nop 0
    buffer_load_dwordx4 v11, s[8:11], s16 offen lds
    s_add_u32 m0, s19, 76032
    s_nop 0
    buffer_load_dwordx4 v12, s[8:11], s16 offen lds
    s_add_u32 s16, s16, 196608
    s_cmp_eq_u32 s16, s18
    s_cselect_b32 s16, s17, s16
    s_cmp_lg_u32 s69, 2
    s_cbranch_scc1 nh_1071
    s_add_u32 s64, s27, 18432
    s_and_b32 s64, s64, 0x7fff
    s_mov_b32 m0, 36864
    s_add_u32 s64, s64, s26
    buffer_load_dwordx4 v249, s[80:83], s64 offen sc0 sc1 lds
nh_1071:
    s_add_u32 m0, s23, 36864
    s_nop 0
    buffer_load_dwordx4 v249, s[80:83], s20 offen offset:0 sc1 lds
    s_add_u32 m0, s23, 37888
    s_nop 0
    buffer_load_dwordx4 v249, s[80:83], s20 offen offset:1024 sc1 lds
    s_add_u32 s20, s20, 8192
    s_cmp_eq_u32 s20, s22
    s_cselect_b32 s20, s21, s20
    s_add_u32 m0, s19, 86400
    s_nop 0
    buffer_load_dwordx4 v10, s[8:11], s16 offen lds
    s_add_u32 m0, s19, 87424
    s_nop 0
    buffer_load_dwordx4 v11, s[8:11], s16 offen lds
    s_add_u32 m0, s19, 88448
    s_nop 0
    buffer_load_dwordx4 v12, s[8:11], s16 offen lds
    s_add_u32 s16, s16, 196608
    s_cmp_eq_u32 s16, s18
    s_cselect_b32 s16, s17, s16
    s_cmp_lg_u32 s69, 3
    s_cbranch_scc1 nh_1072
    s_add_u32 s64, s27, 19456
    s_and_b32 s64, s64, 0x7fff
    s_mov_b32 m0, 37888
    s_add_u32 s64, s64, s26
    buffer_load_dwordx4 v249, s[80:83], s64 offen sc0 sc1 lds
nh_1072:
    s_add_u32 m0, s23, 37888
    s_nop 0
    buffer_load_dwordx4 v249, s[80:83], s20 offen offset:0 sc1 lds
    s_add_u32 m0, s23, 38912
    s_nop 0
    buffer_load_dwordx4 v249, s[80:83], s20 offen offset:1024 sc1 lds
    s_add_u32 s20, s20, 8192
    s_cmp_eq_u32 s20, s22
    s_cselect_b32 s20, s21, s20
    s_waitcnt vmcnt(12) lgkmcnt(0)
    s_barrier
    s_add_u32 m0, s19, 98816
    s_nop 0
    buffer_load_dwordx4 v10, s[8:11], s16 offen lds
    s_add_u32 m0, s19, 99840
    s_nop 0
    buffer_load_dwordx4 v11, s[8:11], s16 offen lds
    s_add_u32 m0, s19, 100864
    s_nop 0
    buffer_load_dwordx4 v12, s[8:11], s16 offen lds
    s_add_u32 s16, s16, 196608
    s_cmp_eq_u32 s16, s18
    s_cselect_b32 s16, s17, s16
    s_cmp_lg_u32 s69, 0
    s_cbranch_scc1 nh_1073
    s_add_u32 s64, s27, 20480
    s_and_b32 s64, s64, 0x7fff
    s_mov_b32 m0, 55296
    s_add_u32 s64, s64, s26
    buffer_load_dwordx4 v249, s[80:83], s64 offen sc0 sc1 lds
nh_1073:
    s_add_u32 m0, s23, 55296
    s_nop 0
    buffer_load_dwordx4 v249, s[80:83], s20 offen offset:0 sc1 lds
    s_add_u32 m0, s23, 56320
    s_nop 0
    buffer_load_dwordx4 v249, s[80:83], s20 offen offset:1024 sc1 lds
    s_add_u32 s20, s20, 8192
    s_cmp_eq_u32 s20, s22
    s_cselect_b32 s20, s21, s20
    s_add_u32 m0, s19, 111232
    s_nop 0
    buffer_load_dwordx4 v10, s[8:11], s16 offen lds
    s_add_u32 m0, s19, 112256
    s_nop 0
    buffer_load_dwordx4 v11, s[8:11], s16 offen lds
    s_add_u32 m0, s19, 113280
    s_nop 0
    buffer_load_dwordx4 v12, s[8:11], s16 offen lds
    s_add_u32 s16, s16, 196608
    s_cmp_eq_u32 s16, s18
    s_cselect_b32 s16, s17, s16
    s_cmp_lg_u32 s69, 1
    s_cbranch_scc1 nh_1074
    s_add_u32 s64, s27, 21504
    s_and_b32 s64, s64, 0x7fff
    s_mov_b32 m0, 56320
    s_add_u32 s64, s64, s26
    buffer_load_dwordx4 v249, s[80:83], s64 offen sc0 sc1 lds
nh_1074:
    s_add_u32 m0, s23, 56320
    s_nop 0
    buffer_load_dwordx4 v249, s[80:83], s20 offen offset:0 sc1 lds
    s_add_u32 m0, s23, 57344
    s_nop 0
    buffer_load_dwordx4 v249, s[80:83], s20 offen offset:1024 sc1 lds
    s_add_u32 s20, s20, 8192
    s_cmp_eq_u32 s20, s22
    s_cselect_b32 s20, s21, s20
    s_waitcnt vmcnt(12) lgkmcnt(0)
    s_barrier
    s_add_u32 m0, s19, 123648
    s_nop 0
    buffer_load_dwordx4 v10, s[8:11], s16 offen lds
    s_add_u32 m0, s19, 124672
    s_nop 0
    buffer_load_dwordx4 v11, s[8:11], s16 offen lds
    s_add_u32 m0, s19, 125696
    s_nop 0
    buffer_load_dwordx4 v12, s[8:11], s16 offen lds
    s_add_u32 s16, s16, 196608
    s_cmp_eq_u32 s16, s18
    s_cselect_b32 s16, s17, s16
    s_cmp_lg_u32 s69, 2
    s_cbranch_scc1 nh_1075
    s_add_u32 s64, s27, 22528
    s_and_b32 s64, s64, 0x7fff
    s_mov_b32 m0, 0
    s_add_u32 s64, s64, s26
    buffer_load_dwordx4 v249, s[80:83], s64 offen sc0 sc1 lds
nh_1075:
    s_add_u32 m0, s23, 0
    s_nop 0
    buffer_load_dwordx4 v249, s[80:83], s20 offen offset:0 sc1 lds
    s_add_u32 m0, s23, 1024
    s_nop 0
    buffer_load_dwordx4 v249, s[80:83], s20 offen offset:1024 sc1 lds
    s_add_u32 s20, s20, 8192
    s_cmp_eq_u32 s20, s22
    s_cselect_b32 s20, s21, s20
    s_add_u32 m0, s19, 136064
    s_nop 0
    buffer_load_dwordx4 v10, s[8:11], s16 offen lds
    s_add_u32 m0, s19, 137088
    s_nop 0
    buffer_load_dwordx4 v11, s[8:11], s16 offen lds
    s_add_u32 m0, s19, 138112
    s_nop 0
    buffer_load_dwordx4 v12, s[8:11], s16 offen lds
    s_add_u32 s16, s16, 196608
    s_cmp_eq_u32 s16, s18
    s_cselect_b32 s16, s17, s16
    s_cmp_lg_u32 s69, 3
    s_cbranch_scc1 nh_1076
    s_add_u32 s64, s27, 23552
    s_and_b32 s64, s64, 0x7fff
    s_mov_b32 m0, 1024
    s_add_u32 s64, s64, s26
    buffer_load_dwordx4 v249, s[80:83], s64 offen sc0 sc1 lds
nh_1076:
    s_add_u32 m0, s23, 1024
    s_nop 0
    buffer_load_dwordx4 v249, s[80:83], s20 offen offset:0 sc1 lds
    s_add_u32 m0, s23, 2048
    s_nop 0
    buffer_load_dwordx4 v249, s[80:83], s20 offen offset:1024 sc1 lds
    s_add_u32 s20, s20, 8192
    s_cmp_eq_u32 s20, s22
    s_cselect_b32 s20, s21, s20
    s_waitcnt vmcnt(12) lgkmcnt(0)
    s_barrier
    s_add_u32 m0, s19, 73984
    s_nop 0
    buffer_load_dwordx4 v10, s[8:11], s16 offen lds
    s_add_u32 m0, s19, 75008
    s_nop 0
    buffer_load_dwordx4 v11, s[8:11], s16 offen lds
    s_add_u32 m0, s19, 76032
    s_nop 0
    buffer_load_dwordx4 v12, s[8:11], s16 offen lds
    s_add_u32 s16, s16, 196608
    s_cmp_eq_u32 s16, s18
    s_cselect_b32 s16, s17, s16
    s_cmp_lg_u32 s69, 0
    s_cbranch_scc1 nh_1077
    s_add_u32 s64, s27, 24576
    s_and_b32 s64, s64, 0x7fff
    s_mov_b32 m0, 18432
    s_add_u32 s64, s64, s26
    buffer_load_dwordx4 v249, s[80:83], s64 offen sc0 sc1 lds
nh_1077:
    s_add_u32 m0, s23, 18432
    s_nop 0
    buffer_load_dwordx4 v249, s[80:83], s20 offen offset:0 sc1 lds
    s_add_u32 m0, s23, 19456
    s_nop 0
    buffer_load_dwordx4 v249, s[80:83], s20 offen offset:1024 sc1 lds
    s_add_u32 s20, s20, 8192
    s_cmp_eq_u32 s20, s22
    s_cselect_b32 s20, s21, s20
    s_add_u32 m0, s19, 86400
    s_nop 0
    buffer_load_dwordx4 v10, s[8:11], s16 offen lds
    s_add_u32 m0, s19, 87424
    s_nop 0
    buffer_load_dwordx4 v11, s[8:11], s16 offen lds
    s_add_u32 m0, s19, 88448
    s_nop 0
    buffer_load_dwordx4 v12, s[8:11], s16 offen lds
    s_add_u32 s16, s16, 196608
    s_cmp_eq_u32 s16, s18
    s_cselect_b32 s16, s17, s16
    s_cmp_lg_u32 s69, 1
    s_cbranch_scc1 nh_1078
    s_add_u32 s64, s27, 25600
    s_and_b32 s64, s64, 0x7fff
    s_mov_b32 m0, 19456
    s_add_u32 s64, s64, s26
    buffer_load_dwordx4 v249, s[80:83], s64 offen sc0 sc1 lds
nh_1078:
    s_add_u32 m0, s23, 19456
    s_nop 0
    buffer_load_dwordx4 v249, s[80:83], s20 offen offset:0 sc1 lds
    s_add_u32 m0, s23, 20480
    s_nop 0
    buffer_load_dwordx4 v249, s[80:83], s20 offen offset:1024 sc1 lds
    s_add_u32 s20, s20, 8192
    s_cmp_eq_u32 s20, s22
    s_cselect_b32 s20, s21, s20
    s_waitcnt vmcnt(12) lgkmcnt(0)
    s_barrier
    s_add_u32 m0, s19, 98816
    s_nop 0
    buffer_load_dwordx4 v10, s[8:11], s16 offen lds
    s_add_u32 m0, s19, 99840
    s_nop 0
    buffer_load_dwordx4 v11, s[8:11], s16 offen lds
    s_add_u32 m0, s19, 100864
    s_nop 0
    buffer_load_dwordx4 v12, s[8:11], s16 offen lds
    s_add_u32 s16, s16, 196608
    s_cmp_eq_u32 s16, s18
    s_cselect_b32 s16, s17, s16
    s_cmp_lg_u32 s69, 2
    s_cbranch_scc1 nh_1079
    s_add_u32 s64, s27, 26624
    s_and_b32 s64, s64, 0x7fff
    s_mov_b32 m0, 36864
    s_add_u32 s64, s64, s26
    buffer_load_dwordx4 v249, s[80:83], s64 offen sc0 sc1 lds
nh_1079:
    s_add_u32 m0, s23, 36864
    s_nop 0
    buffer_load_dwordx4 v249, s[80:83], s20 offen offset:0 sc1 lds
    s_add_u32 m0, s23, 37888
    s_nop 0
    buffer_load_dwordx4 v249, s[80:83], s20 offen offset:1024 sc1 lds
    s_add_u32 s20, s20, 8192
    s_cmp_eq_u32 s20, s22
    s_cselect_b32 s20, s21, s20
    s_add_u32 m0, s19, 111232
    s_nop 0
    buffer_load_dwordx4 v10, s[8:11], s16 offen lds
    s_add_u32 m0, s19, 112256
    s_nop 0
    buffer_load_dwordx4 v11, s[8:11], s16 offen lds
    s_add_u32 m0, s19, 113280
    s_nop 0
    buffer_load_dwordx4 v12, s[8:11], s16 offen lds
    s_add_u32 s16, s16, 196608
    s_cmp_eq_u32 s16, s18
    s_cselect_b32 s16, s17, s16
    s_cmp_lg_u32 s69, 3
    s_cbranch_scc1 nh_1080
    s_add_u32 s64, s27, 27648
    s_and_b32 s64, s64, 0x7fff
    s_mov_b32 m0, 37888
    s_add_u32 s64, s64, s26
    buffer_load_dwordx4 v249, s[80:83], s64 offen sc0 sc1 lds
nh_1080:
    s_add_u32 m0, s23, 37888
    s_nop 0
    buffer_load_dwordx4 v249, s[80:83], s20 offen offset:0 sc1 lds
    s_add_u32 m0, s23, 38912
    s_nop 0
    buffer_load_dwordx4 v249, s[80:83], s20 offen offset:1024 sc1 lds
    s_add_u32 s20, s20, 8192
    s_cmp_eq_u32 s20, s22
    s_cselect_b32 s20, s21, s20
    s_lshl_b32 s64, s28, 12
    s_add_u32 s64, s64, 73924608
    v_lshlrev_b32 v81, 4, v252
    v_lshl_add_u32 v81, v251, 10, v81
    s_cmp_lg_u32 s69, 3
    s_cbranch_scc1 hs_1081
    buffer_load_dwordx4 v[64:67], v81, s[80:83], s64 offen offset:0 sc0 sc1
    buffer_load_dwordx4 v[68:71], v81, s[80:83], s64 offen offset:256 sc0 sc1
    buffer_load_dwordx4 v[72:75], v81, s[80:83], s64 offen offset:512 sc0 sc1
    buffer_load_dwordx4 v[76:79], v81, s[80:83], s64 offen offset:768 sc0 sc1
hs_1081:
    s_lshl_b32 s64, s73, 15
    s_lshl_b32 s65, s69, 9
    s_add_u32 s64, s64, s65
    s_add_u32 s64, s64, 71827456
    v_and_b32 v80, 31, v250
    v_lshlrev_b32 v80, 4, v80
    v_lshrrev_b32 v253, 5, v250
    v_lshl_add_u32 v80, v253, 14, v80
    buffer_load_dwordx4 v[32:35], v80, s[80:83], s64 offen offset:0 sc1
    buffer_load_dwordx4 v[36:39], v80, s[80:83], s64 offen offset:2048 sc1
    s_add_u32 s64, s64, 4096
    buffer_load_dwordx4 v[40:43], v80, s[80:83], s64 offen offset:0 sc1
    buffer_load_dwordx4 v[44:47], v80, s[80:83], s64 offen offset:2048 sc1
    s_add_u32 s64, s64, 4096
    buffer_load_dwordx4 v[48:51], v80, s[80:83], s64 offen offset:0 sc1
    buffer_load_dwordx4 v[52:55], v80, s[80:83], s64 offen offset:2048 sc1
    s_add_u32 s64, s64, 4096
    buffer_load_dwordx4 v[56:59], v80, s[80:83], s64 offen offset:0 sc1
    buffer_load_dwordx4 v[60:63], v80, s[80:83], s64 offen offset:2048 sc1
    s_add_u32 s64, s64, 4096
    s_waitcnt vmcnt(20) lgkmcnt(0)
    s_barrier
    s_add_u32 m0, s19, 123648
    s_nop 0
    buffer_load_dwordx4 v10, s[8:11], s16 offen lds
    s_add_u32 m0, s19, 124672
    s_nop 0
    buffer_load_dwordx4 v11, s[8:11], s16 offen lds
    s_add_u32 m0, s19, 125696
    s_nop 0
    buffer_load_dwordx4 v12, s[8:11], s16 offen lds
    s_add_u32 s16, s16, 196608
    s_cmp_eq_u32 s16, s18
    s_cselect_b32 s16, s17, s16
    s_cmp_lg_u32 s69, 0
    s_cbranch_scc1 nh_1082
    s_add_u32 s64, s27, 28672
    s_and_b32 s64, s64, 0x7fff
    s_mov_b32 m0, 55296
    s_add_u32 s64, s64, s26
    buffer_load_dwordx4 v249, s[80:83], s64 offen sc0 sc1 lds
nh_1082:
    s_add_u32 m0, s23, 55296
    s_nop 0
    buffer_load_dwordx4 v249, s[80:83], s20 offen offset:0 sc1 lds
    s_add_u32 m0, s23, 56320
    s_nop 0
    buffer_load_dwordx4 v249, s[80:83], s20 offen offset:1024 sc1 lds
    s_add_u32 s20, s20, 8192
    s_cmp_eq_u32 s20, s22
    s_cselect_b32 s20, s21, s20
    s_add_u32 m0, s19, 136064
    s_nop 0
    buffer_load_dwordx4 v10, s[8:11], s16 offen lds
    s_add_u32 m0, s19, 137088
    s_nop 0
    buffer_load_dwordx4 v11, s[8:11], s16 offen lds
    s_add_u32 m0, s19, 138112
    s_nop 0
    buffer_load_dwordx4 v12, s[8:11], s16 offen lds
    s_add_u32 s16, s16, 196608
    s_cmp_eq_u32 s16, s18
    s_cselect_b32 s16, s17, s16
    s_cmp_lg_u32 s69, 1
    s_cbranch_scc1 nh_1083
    s_add_u32 s64, s27, 29696
    s_and_b32 s64, s64, 0x7fff
    s_mov_b32 m0, 56320
    s_add_u32 s64, s64, s26
    buffer_load_dwordx4 v249, s[80:83], s64 offen sc0 sc1 lds
nh_1083:
    s_add_u32 m0, s23, 56320
    s_nop 0
    buffer_load_dwordx4 v249, s[80:83], s20 offen offset:0 sc1 lds
    s_add_u32 m0, s23, 57344
    s_nop 0
    buffer_load_dwordx4 v249, s[80:83], s20 offen offset:1024 sc1 lds
    s_add_u32 s20, s20, 8192
    s_cmp_eq_u32 s20, s22
    s_cselect_b32 s20, s21, s20
    s_waitcnt vmcnt(20) lgkmcnt(0)
    s_barrier
    s_add_u32 m0, s19, 73984
    s_nop 0
    buffer_load_dwordx4 v10, s[8:11], s16 offen lds
    s_add_u32 m0, s19, 75008
    s_nop 0
    buffer_load_dwordx4 v11, s[8:11], s16 offen lds
    s_add_u32 m0, s19, 76032
    s_nop 0
    buffer_load_dwordx4 v12, s[8:11], s16 offen lds
    s_add_u32 s16, s16, 196608
    s_cmp_eq_u32 s16, s18
    s_cselect_b32 s16, s17, s16
    s_cmp_lg_u32 s69, 2
    s_cbranch_scc1 nh_1084
    s_add_u32 s64, s27, 30720
    s_and_b32 s64, s64, 0x7fff
    s_mov_b32 m0, 0
    s_add_u32 s64, s64, s26
    buffer_load_dwordx4 v249, s[80:83], s64 offen sc0 sc1 lds
nh_1084:
    s_add_u32 m0, s23, 0
    s_nop 0
    buffer_load_dwordx4 v249, s[80:83], s20 offen offset:0 sc1 lds
    s_add_u32 m0, s23, 1024
    s_nop 0
    buffer_load_dwordx4 v249, s[80:83], s20 offen offset:1024 sc1 lds
    s_add_u32 s20, s20, 8192
    s_cmp_eq_u32 s20, s22
    s_cselect_b32 s20, s21, s20
    s_add_u32 m0, s19, 86400
    s_nop 0
    buffer_load_dwordx4 v10, s[8:11], s16 offen lds
    s_add_u32 m0, s19, 87424
    s_nop 0
    buffer_load_dwordx4 v11, s[8:11], s16 offen lds
    s_add_u32 m0, s19, 88448
    s_nop 0
    buffer_load_dwordx4 v12, s[8:11], s16 offen lds
    s_add_u32 s16, s16, 196608
    s_cmp_eq_u32 s16, s18
    s_cselect_b32 s16, s17, s16
    s_cmp_lg_u32 s69, 3
    s_cbranch_scc1 nh_1085
    s_add_u32 s64, s27, 31744
    s_and_b32 s64, s64, 0x7fff
    s_mov_b32 m0, 1024
    s_add_u32 s64, s64, s26
    buffer_load_dwordx4 v249, s[80:83], s64 offen sc0 sc1 lds
nh_1085:
    s_add_u32 m0, s23, 1024
    s_nop 0
    buffer_load_dwordx4 v249, s[80:83], s20 offen offset:0 sc1 lds
    s_add_u32 m0, s23, 2048
    s_nop 0
    buffer_load_dwordx4 v249, s[80:83], s20 offen offset:1024 sc1 lds
    s_add_u32 s20, s20, 8192
    s_cmp_eq_u32 s20, s22
    s_cselect_b32 s20, s21, s20
    s_waitcnt vmcnt(12) lgkmcnt(0)
    s_barrier
    s_add_u32 m0, s19, 98816
    s_nop 0
    buffer_load_dwordx4 v10, s[8:11], s16 offen lds
    s_add_u32 m0, s19, 99840
    s_nop 0
    buffer_load_dwordx4 v11, s[8:11], s16 offen lds
    s_add_u32 m0, s19, 100864
    s_nop 0
    buffer_load_dwordx4 v12, s[8:11], s16 offen lds
    s_add_u32 s16, s16, 196608
    s_cmp_eq_u32 s16, s18
    s_cselect_b32 s16, s17, s16
    s_lshl_b32 s64, s73, 4
    s_add_u32 s64, s64, s67
    s_lshl_b32 s64, s64, 2
    s_add_u32 s64, s64, s69
    s_lshl_b32 s64, s64, 12
    s_lshl_b32 s65, s60, 22
    s_add_u32 s64, s64, s65
    s_add_u32 s64, s64, 12582912
    v_lshlrev_b32 v253, 7, v250
    s_mov_b64 exec, 0xffffffff
    buffer_load_dword v9, v253, s[80:83], s64 offen sc1
    s_mov_b64 exec, -1
    s_mov_b32 s12, s88
    s_mov_b32 s13, s89
    s_mov_b32 s14, 2097152
    s_mov_b32 s15, 0x00020000
    v_lshrrev_b32 v253, 3, v250
    v_lshlrev_b32 v253, 13, v253
    v_and_b32 v254, 7, v250
    v_lshl_add_u32 v253, v254, 4, v253
    s_lshl_b32 s64, s69, 11
    v_add_u32 v244, s64, v253
    s_mul_i32 s51, s69, 1056
    s_lshl_b32 s49, s72, 7
    s_lshl_b32 s64, s67, 17
    s_add_u32 s50, s49, 2097152
    s_add_u32 s48, s49, s64
    v_pk_add_f32 v[32:33], v[32:33], v[48:49]
    v_pk_add_f32 v[34:35], v[34:35], v[50:51]
    v_pk_add_f32 v[36:37], v[36:37], v[52:53]
    v_pk_add_f32 v[38:39], v[38:39], v[54:55]
    v_pk_add_f32 v[40:41], v[40:41], v[56:57]
    v_pk_add_f32 v[42:43], v[42:43], v[58:59]
    v_pk_add_f32 v[44:45], v[44:45], v[60:61]
    v_pk_add_f32 v[46:47], v[46:47], v[62:63]
    v_pk_add_f32 v[32:33], v[32:33], v[40:41]
    v_pk_add_f32 v[34:35], v[34:35], v[42:43]
    v_pk_add_f32 v[36:37], v[36:37], v[44:45]
    v_pk_add_f32 v[38:39], v[38:39], v[46:47]
    v_pk_add_f32 v[32:33], v[32:33], v[36:37]
    v_pk_add_f32 v[34:35], v[34:35], v[38:39]
    v_add_f32 v32, v32, v34
    v_add_f32 v33, v33, v35
    v_mov_b32 v34, v32
    v_mov_b32 v35, v33
    s_nop 1
    v_permlane32_swap_b32 v32, v34
    v_permlane32_swap_b32 v33, v35
    v_add_f32 v32, v32, v34
    v_add_f32 v33, v33, v35
    v_mul_f32 v32, 0x3a800000, v32
    v_mul_f32 v33, 0x3a800000, v33
    v_fma_f32 v33, -v32, v32, v33
    v_max_f32 v33, 0, v33
    v_cvt_pk_bf16_f32 v32, v32, v32
    v_lshlrev_b32 v32, 16, v32
    v_cvt_pk_bf16_f32 v33, v33, v33
    v_lshlrev_b32 v33, 16, v33
    v_add_f32 v33, 0x3727c5ac, v33
    v_cvt_pk_bf16_f32 v33, v33, v33
    v_lshlrev_b32 v33, 16, v33
    v_sqrt_f32 v33, v33
    s_nop 0
    v_cvt_pk_bf16_f32 v33, v33, v33
    v_lshlrev_b32 v33, 16, v33
    v_rcp_f32 v33, v33
    s_nop 0
    v_and_b32 v80, 31, v250
    s_lshl_b32 s64, s69, 8
    s_add_u32 s64, s64, 159872
    v_lshlrev_b32 v80, 3, v80
    v_add_u32 v80, s64, v80
    ds_write_b64 v80, v[32:33]
    s_cmp_lg_u32 s69, 3
    s_cbranch_scc1 hf_1086
    v_pk_add_f32 v[64:65], v[64:65], v[72:73]
    v_pk_add_f32 v[66:67], v[66:67], v[74:75]
    v_pk_add_f32 v[68:69], v[68:69], v[76:77]
    v_pk_add_f32 v[70:71], v[70:71], v[78:79]
    v_pk_add_f32 v[64:65], v[64:65], v[68:69]
    v_pk_add_f32 v[66:67], v[66:67], v[70:71]
    v_add_f32 v64, v64, v66
    v_add_f32 v65, v65, v67
    v_mov_b32 v66, v64
    v_mov_b32 v67, v65
    s_nop 1
    v_permlane16_swap_b32 v64, v66
    v_permlane16_swap_b32 v65, v67
    v_add_f32 v64, v64, v66
    v_add_f32 v65, v65, v67
    v_mov_b32 v66, v64
    v_mov_b32 v67, v65
    s_nop 1
    v_permlane32_swap_b32 v64, v66
    v_permlane32_swap_b32 v65, v67
    v_add_f32 v64, v64, v66
    v_add_f32 v65, v65, v67
    v_mul_f32 v64, 0x3a800000, v64
    v_mul_f32 v65, 0x3a800000, v65
    v_fma_f32 v65, -v64, v64, v65
    v_max_f32 v65, 0, v65
    v_cvt_pk_bf16_f32 v64, v64, v64
    v_lshlrev_b32 v64, 16, v64
    v_cvt_pk_bf16_f32 v65, v65, v65
    v_lshlrev_b32 v65, 16, v65
    v_add_f32 v65, 0x3727c5ac, v65
    v_cvt_pk_bf16_f32 v65, v65, v65
    v_lshlrev_b32 v65, 16, v65
    v_sqrt_f32 v65, v65
    s_nop 0
    v_cvt_pk_bf16_f32 v65, v65, v65
    v_lshlrev_b32 v65, 16, v65
    v_rcp_f32 v65, v65
    s_nop 0
    v_lshlrev_b32 v80, 3, v252
    v_add_u32 v80, 159744, v80
    ds_write_b64 v80, v[64:65]
hf_1086:
    s_add_u32 m0, s51, 116224
    s_nop 0
    buffer_load_dwordx4 v244, s[12:15], s48 offen lds
    s_add_u32 s48, s48, 65536
    s_cmp_eq_u32 s48, s50
    s_cselect_b32 s48, s49, s48
    s_waitcnt vmcnt(7) lgkmcnt(0)
    s_barrier
    s_add_u32 m0, s51, 120448
    s_nop 0
    buffer_load_dwordx4 v244, s[12:15], s48 offen lds
    s_add_u32 s48, s48, 65536
    s_cmp_eq_u32 s48, s50
    s_cselect_b32 s48, s49, s48
    s_add_u32 m0, s51, 124672
    s_nop 0
    buffer_load_dwordx4 v244, s[12:15], s48 offen lds
    s_add_u32 s48, s48, 65536
    s_cmp_eq_u32 s48, s50
    s_cselect_b32 s48, s49, s48
    s_add_u32 m0, s51, 128896
    s_nop 0
    buffer_load_dwordx4 v244, s[12:15], s48 offen lds
    s_add_u32 s48, s48, 65536
    s_cmp_eq_u32 s48, s50
    s_cselect_b32 s48, s49, s48
    s_add_u32 m0, s51, 133120
    s_nop 0
    buffer_load_dwordx4 v244, s[12:15], s48 offen lds
    s_add_u32 s48, s48, 65536
    s_cmp_eq_u32 s48, s50
    s_cselect_b32 s48, s49, s48
    s_add_u32 m0, s51, 137344
    s_nop 0
    buffer_load_dwordx4 v244, s[12:15], s48 offen lds
    s_add_u32 s48, s48, 65536
    s_cmp_eq_u32 s48, s50
    s_cselect_b32 s48, s49, s48
    s_add_u32 m0, s51, 141568
    s_nop 0
    buffer_load_dwordx4 v244, s[12:15], s48 offen lds
    s_add_u32 s48, s48, 65536
    s_cmp_eq_u32 s48, s50
    s_cselect_b32 s48, s49, s48
    s_add_u32 m0, s51, 145792
    s_nop 0
    buffer_load_dwordx4 v244, s[12:15], s48 offen lds
    s_add_u32 s48, s48, 65536
    s_cmp_eq_u32 s48, s50
    s_cselect_b32 s48, s49, s48
    s_add_u32 m0, s51, 150016
    s_nop 0
    buffer_load_dwordx4 v244, s[12:15], s48 offen lds
    s_add_u32 s48, s48, 65536
    s_cmp_eq_u32 s48, s50
    s_cselect_b32 s48, s49, s48
    s_waitcnt vmcnt(10) lgkmcnt(0)
    s_barrier
    s_add_u32 m0, s51, 154240
    s_nop 0
    buffer_load_dwordx4 v244, s[12:15], s48 offen lds
    s_add_u32 s48, s48, 65536
    s_cmp_eq_u32 s48, s50
    s_cselect_b32 s48, s49, s48
    s_add_u32 m0, s51, 65536
    s_nop 0
    buffer_load_dwordx4 v244, s[12:15], s48 offen lds
    s_add_u32 s48, s48, 65536
    s_cmp_eq_u32 s48, s50
    s_cselect_b32 s48, s49, s48
    s_add_u32 m0, s51, 69760
    s_nop 0
    buffer_load_dwordx4 v244, s[12:15], s48 offen lds
    s_add_u32 s48, s48, 65536
    s_cmp_eq_u32 s48, s50
    s_cselect_b32 s48, s49, s48
    s_add_u32 m0, s51, 73984
    s_nop 0
    buffer_load_dwordx4 v244, s[12:15], s48 offen lds
    s_add_u32 s48, s48, 65536
    s_cmp_eq_u32 s48, s50
    s_cselect_b32 s48, s49, s48
    s_add_u32 m0, s51, 78208
    s_nop 0
    buffer_load_dwordx4 v244, s[12:15], s48 offen lds
    s_add_u32 s48, s48, 65536
    s_cmp_eq_u32 s48, s50
    s_cselect_b32 s48, s49, s48
    s_add_u32 m0, s51, 82432
    s_nop 0
    buffer_load_dwordx4 v244, s[12:15], s48 offen lds
    s_add_u32 s48, s48, 65536
    s_cmp_eq_u32 s48, s50
    s_cselect_b32 s48, s49, s48
    s_add_u32 m0, s51, 86656
    s_nop 0
    buffer_load_dwordx4 v244, s[12:15], s48 offen lds
    s_add_u32 s48, s48, 65536
    s_cmp_eq_u32 s48, s50
    s_cselect_b32 s48, s49, s48
    s_add_u32 m0, s51, 90880
    s_nop 0
    buffer_load_dwordx4 v244, s[12:15], s48 offen lds
    s_add_u32 s48, s48, 65536
    s_cmp_eq_u32 s48, s50
    s_cselect_b32 s48, s49, s48
    s_waitcnt lgkmcnt(0)
    s_barrier
    s_add_u32 m0, s51, 95104
    s_nop 0
    buffer_load_dwordx4 v244, s[12:15], s48 offen lds
    s_add_u32 s48, s48, 65536
    s_cmp_eq_u32 s48, s50
    s_cselect_b32 s48, s49, s48
    s_add_u32 m0, s51, 99328
    s_nop 0
    buffer_load_dwordx4 v244, s[12:15], s48 offen lds
    s_add_u32 s48, s48, 65536
    s_cmp_eq_u32 s48, s50
    s_cselect_b32 s48, s49, s48
    s_add_u32 m0, s51, 103552
    s_nop 0
    buffer_load_dwordx4 v244, s[12:15], s48 offen lds
    s_add_u32 s48, s48, 65536
    s_cmp_eq_u32 s48, s50
    s_cselect_b32 s48, s49, s48
    s_add_u32 m0, s51, 107776
    s_nop 0
    buffer_load_dwordx4 v244, s[12:15], s48 offen lds
    s_add_u32 s48, s48, 65536
    s_cmp_eq_u32 s48, s50
    s_cselect_b32 s48, s49, s48
    s_add_u32 m0, s51, 112000
    s_nop 0
    buffer_load_dwordx4 v244, s[12:15], s48 offen lds
    s_add_u32 s48, s48, 65536
    s_cmp_eq_u32 s48, s50
    s_cselect_b32 s48, s49, s48
    s_branch L_g2
ar_22:
    v_mov_b32 v72, s32
    v_mov_b32 v73, 0
    s_mov_b64 exec, 1
    buffer_store_byte v72, v73, s[28:31], s2 offen sc0 sc1
    s_mov_b64 exec, -1
    s_branch ar_22_b
ar_24:
    v_mov_b32 v72, s32
    v_mov_b32 v73, 0
    s_mov_b64 exec, 1
    buffer_store_byte v72, v73, s[28:31], s2 offen sc0 sc1
    s_mov_b64 exec, -1
    s_branch ar_24_b
ar_26:
    v_mov_b32 v72, s32
    v_mov_b32 v73, 0
    s_mov_b64 exec, 1
    buffer_store_byte v72, v73, s[28:31], s2 offen sc0 sc1
    s_mov_b64 exec, -1
    s_branch ar_26_b
ar_28:
    v_mov_b32 v72, s32
    v_mov_b32 v73, 0
    s_mov_b64 exec, 1
    buffer_store_byte v72, v73, s[28:31], s2 offen sc0 sc1
    s_mov_b64 exec, -1
    s_branch ar_28_b
ar_30:
    v_mov_b32 v72, s32
    v_mov_b32 v73, 0
    s_mov_b64 exec, 1
    buffer_store_byte v72, v73, s[28:31], s2 offen sc0 sc1
    s_mov_b64 exec, -1
    s_branch ar_30_b
ar_32:
    v_mov_b32 v72, s32
    v_mov_b32 v73, 0
    s_mov_b64 exec, 1
    buffer_store_byte v72, v73, s[28:31], s2 offen sc0 sc1
    s_mov_b64 exec, -1
    s_branch ar_32_b
ar_34:
    v_mov_b32 v72, s32
    v_mov_b32 v73, 0
    s_mov_b64 exec, 1
    buffer_store_byte v72, v73, s[28:31], s2 offen sc0 sc1
    s_mov_b64 exec, -1
    s_branch ar_34_b
ar_36:
    v_mov_b32 v72, s32
    v_mov_b32 v73, 0
    s_mov_b64 exec, 1
    buffer_store_byte v72, v73, s[28:31], s2 offen sc0 sc1
    s_mov_b64 exec, -1
    s_branch ar_36_b
pl_42_acq:
    buffer_inv sc1
    s_waitcnt vmcnt(0)
    s_branch pl_42_ok
pl_43_acq:
    buffer_inv sc1
    s_waitcnt vmcnt(0)
    s_branch pl_43_ok
cs_44:
    v_add_u32 v225, 28800, v224
    ds_read_b64_tr_b16 v[204:205], v225 offset:0
    ds_read_b64_tr_b16 v[206:207], v225 offset:3584
    ds_read_b64_tr_b16 v[208:209], v225 offset:32
    ds_read_b64_tr_b16 v[210:211], v225 offset:3616
    ds_read_b64_tr_b16 v[212:213], v225 offset:64
    ds_read_b64_tr_b16 v[214:215], v225 offset:3648
    ds_read_b64_tr_b16 v[216:217], v225 offset:96
    ds_read_b64_tr_b16 v[218:219], v225 offset:3680
    s_waitcnt lgkmcnt(0)
    v_mfma_f32_16x16x32_bf16 v[176:179], v[204:207], v[220:223], 0
    v_mfma_f32_16x16x32_bf16 v[180:183], v[208:211], v[220:223], 0
    v_mfma_f32_16x16x32_bf16 v[184:187], v[212:215], v[220:223], 0
    v_mfma_f32_16x16x32_bf16 v[188:191], v[216:219], v[220:223], 0
    s_nop 7
    ds_read_b64_tr_b16 v[204:205], v225 offset:128
    ds_read_b64_tr_b16 v[206:207], v225 offset:3712
    ds_read_b64_tr_b16 v[208:209], v225 offset:160
    ds_read_b64_tr_b16 v[210:211], v225 offset:3744
    ds_read_b64_tr_b16 v[212:213], v225 offset:192
    ds_read_b64_tr_b16 v[214:215], v225 offset:3776
    s_waitcnt lgkmcnt(0)
    v_mfma_f32_16x16x32_bf16 v[192:195], v[204:207], v[220:223], 0
    v_mfma_f32_16x16x32_bf16 v[196:199], v[208:211], v[220:223], 0
    v_mfma_f32_16x16x32_bf16 v[200:203], v[212:215], v[220:223], 0
    s_nop 7
    s_branch cs_44_b
cs_45:
    v_add_u32 v225, 57600, v224
    ds_read_b64_tr_b16 v[204:205], v225 offset:0
    ds_read_b64_tr_b16 v[206:207], v225 offset:3584
    ds_read_b64_tr_b16 v[208:209], v225 offset:32
    ds_read_b64_tr_b16 v[210:211], v225 offset:3616
    ds_read_b64_tr_b16 v[212:213], v225 offset:64
    ds_read_b64_tr_b16 v[214:215], v225 offset:3648
    ds_read_b64_tr_b16 v[216:217], v225 offset:96
    ds_read_b64_tr_b16 v[218:219], v225 offset:3680
    s_waitcnt lgkmcnt(0)
    v_mfma_f32_16x16x32_bf16 v[176:179], v[204:207], v[220:223], v[176:179]
    v_mfma_f32_16x16x32_bf16 v[180:183], v[208:211], v[220:223], v[180:183]
    v_mfma_f32_16x16x32_bf16 v[184:187], v[212:215], v[220:223], v[184:187]
    v_mfma_f32_16x16x32_bf16 v[188:191], v[216:219], v[220:223], v[188:191]
    s_nop 7
    ds_read_b64_tr_b16 v[204:205], v225 offset:128
    ds_read_b64_tr_b16 v[206:207], v225 offset:3712
    ds_read_b64_tr_b16 v[208:209], v225 offset:160
    ds_read_b64_tr_b16 v[210:211], v225 offset:3744
    ds_read_b64_tr_b16 v[212:213], v225 offset:192
    ds_read_b64_tr_b16 v[214:215], v225 offset:3776
    s_waitcnt lgkmcnt(0)
    v_mfma_f32_16x16x32_bf16 v[192:195], v[204:207], v[220:223], v[192:195]
    v_mfma_f32_16x16x32_bf16 v[196:199], v[208:211], v[220:223], v[196:199]
    v_mfma_f32_16x16x32_bf16 v[200:203], v[212:215], v[220:223], v[200:203]
    s_nop 7
    s_lshl_b32 s64, s73, 1
    s_and_b32 s65, s3, 1
    s_add_u32 s64, s64, s65
    s_mul_i32 s64, s64, 14336
    s_mul_i32 s65, s74, 896
    s_add_u32 s64, s64, s65
    s_lshr_b32 s65, s69, 1
    s_mul_i32 s65, s65, 448
    s_add_u32 s64, s64, s65
    s_add_u32 s64, s64, 74448896
    v_lshlrev_b32 v225, 4, v251
    s_mov_b32 exec_lo, 0x00010001
    s_mov_b32 exec_hi, 0x00010001
    buffer_store_dwordx4 v[176:179], v225, s[80:83], s64 offen offset:0 sc0 sc1
    buffer_store_dwordx4 v[180:183], v225, s[80:83], s64 offen offset:64 sc0 sc1
    buffer_store_dwordx4 v[184:187], v225, s[80:83], s64 offen offset:128 sc0 sc1
    buffer_store_dwordx4 v[188:191], v225, s[80:83], s64 offen offset:192 sc0 sc1
    buffer_store_dwordx4 v[192:195], v225, s[80:83], s64 offen offset:256 sc0 sc1
    buffer_store_dwordx4 v[196:199], v225, s[80:83], s64 offen offset:320 sc0 sc1
    buffer_store_dwordx4 v[200:203], v225, s[80:83], s64 offen offset:384 sc0 sc1
    s_mov_b64 exec, -1
    s_nop 3
    s_branch cs_45_b
cs_46:
    v_add_u32 v225, 86400, v224
    ds_read_b64_tr_b16 v[204:205], v225 offset:0
    ds_read_b64_tr_b16 v[206:207], v225 offset:3584
    ds_read_b64_tr_b16 v[208:209], v225 offset:32
    ds_read_b64_tr_b16 v[210:211], v225 offset:3616
    ds_read_b64_tr_b16 v[212:213], v225 offset:64
    ds_read_b64_tr_b16 v[214:215], v225 offset:3648
    ds_read_b64_tr_b16 v[216:217], v225 offset:96
    ds_read_b64_tr_b16 v[218:219], v225 offset:3680
    s_waitcnt lgkmcnt(0)
    v_mfma_f32_16x16x32_bf16 v[176:179], v[204:207], v[220:223], 0
    v_mfma_f32_16x16x32_bf16 v[180:183], v[208:211], v[220:223], 0
    v_mfma_f32_16x16x32_bf16 v[184:187], v[212:215], v[220:223], 0
    v_mfma_f32_16x16x32_bf16 v[188:191], v[216:219], v[220:223], 0
    s_nop 7
    ds_read_b64_tr_b16 v[204:205], v225 offset:128
    ds_read_b64_tr_b16 v[206:207], v225 offset:3712
    ds_read_b64_tr_b16 v[208:209], v225 offset:160
    ds_read_b64_tr_b16 v[210:211], v225 offset:3744
    ds_read_b64_tr_b16 v[212:213], v225 offset:192
    ds_read_b64_tr_b16 v[214:215], v225 offset:3776
    s_waitcnt lgkmcnt(0)
    v_mfma_f32_16x16x32_bf16 v[192:195], v[204:207], v[220:223], 0
    v_mfma_f32_16x16x32_bf16 v[196:199], v[208:211], v[220:223], 0
    v_mfma_f32_16x16x32_bf16 v[200:203], v[212:215], v[220:223], 0
    s_nop 7
    s_branch cs_46_b
cs_47:
    v_add_u32 v225, 0, v224
    ds_read_b64_tr_b16 v[204:205], v225 offset:0
    ds_read_b64_tr_b16 v[206:207], v225 offset:3584
    ds_read_b64_tr_b16 v[208:209], v225 offset:32
    ds_read_b64_tr_b16 v[210:211], v225 offset:3616
    ds_read_b64_tr_b16 v[212:213], v225 offset:64
    ds_read_b64_tr_b16 v[214:215], v225 offset:3648
    ds_read_b64_tr_b16 v[216:217], v225 offset:96
    ds_read_b64_tr_b16 v[218:219], v225 offset:3680
    s_waitcnt lgkmcnt(0)
    v_mfma_f32_16x16x32_bf16 v[176:179], v[204:207], v[220:223], v[176:179]
    v_mfma_f32_16x16x32_bf16 v[180:183], v[208:211], v[220:223], v[180:183]
    v_mfma_f32_16x16x32_bf16 v[184:187], v[212:215], v[220:223], v[184:187]
    v_mfma_f32_16x16x32_bf16 v[188:191], v[216:219], v[220:223], v[188:191]
    s_nop 7
    ds_read_b64_tr_b16 v[204:205], v225 offset:128
    ds_read_b64_tr_b16 v[206:207], v225 offset:3712
    ds_read_b64_tr_b16 v[208:209], v225 offset:160
    ds_read_b64_tr_b16 v[210:211], v225 offset:3744
    ds_read_b64_tr_b16 v[212:213], v225 offset:192
    ds_read_b64_tr_b16 v[214:215], v225 offset:3776
    s_waitcnt lgkmcnt(0)
    v_mfma_f32_16x16x32_bf16 v[192:195], v[204:207], v[220:223], v[192:195]
    v_mfma_f32_16x16x32_bf16 v[196:199], v[208:211], v[220:223], v[196:199]
    v_mfma_f32_16x16x32_bf16 v[200:203], v[212:215], v[220:223], v[200:203]
    s_nop 7
    s_lshl_b32 s64, s73, 1
    s_and_b32 s65, s3, 1
    s_add_u32 s64, s64, s65
    s_mul_i32 s64, s64, 14336
    s_mul_i32 s65, s74, 896
    s_add_u32 s64, s64, s65
    s_lshr_b32 s65, s69, 1
    s_mul_i32 s65, s65, 448
    s_add_u32 s64, s64, s65
    s_add_u32 s64, s64, 74448896
    v_lshlrev_b32 v225, 4, v251
    s_mov_b32 exec_lo, 0x00010001
    s_mov_b32 exec_hi, 0x00010001
    buffer_store_dwordx4 v[176:179], v225, s[80:83], s64 offen offset:0 sc0 sc1
    buffer_store_dwordx4 v[180:183], v225, s[80:83], s64 offen offset:64 sc0 sc1
    buffer_store_dwordx4 v[184:187], v225, s[80:83], s64 offen offset:128 sc0 sc1
    buffer_store_dwordx4 v[188:191], v225, s[80:83], s64 offen offset:192 sc0 sc1
    buffer_store_dwordx4 v[192:195], v225, s[80:83], s64 offen offset:256 sc0 sc1
    buffer_store_dwordx4 v[196:199], v225, s[80:83], s64 offen offset:320 sc0 sc1
    buffer_store_dwordx4 v[200:203], v225, s[80:83], s64 offen offset:384 sc0 sc1
    s_mov_b64 exec, -1
    s_nop 3
    s_branch cs_47_b
g3c1_hook:
    s_cmp_eq_u32 s24, 5
    s_cbranch_scc1 g3c1_h5
    s_cmp_eq_u32 s24, 2
    s_cbranch_scc1 g3c1_h2
    s_cmp_eq_u32 s24, 1
    s_cbranch_scc1 g3c1_h1
    s_lshl_b32 s64, s73, 15
    s_lshl_b32 s65, s75, 20
    s_add_u32 s64, s64, s65
    s_lshl_b32 s65, s69, 9
    s_add_u32 s64, s64, s65
    s_add_u32 s64, s64, 71303168
    v_and_b32 v225, 31, v250
    v_lshlrev_b32 v225, 4, v225
    v_lshrrev_b32 v253, 5, v250
    v_lshl_add_u32 v225, v253, 14, v225
    buffer_load_dwordx4 v[176:179], v225, s[80:83], s64 offen offset:0 sc1
    buffer_load_dwordx4 v[180:183], v225, s[80:83], s64 offen offset:2048 sc1
    s_add_u32 s64, s64, 4096
    buffer_load_dwordx4 v[184:187], v225, s[80:83], s64 offen offset:0 sc1
    buffer_load_dwordx4 v[188:191], v225, s[80:83], s64 offen offset:2048 sc1
    s_add_u32 s64, s64, 4096
    buffer_load_dwordx4 v[192:195], v225, s[80:83], s64 offen offset:0 sc1
    buffer_load_dwordx4 v[196:199], v225, s[80:83], s64 offen offset:2048 sc1
    s_add_u32 s64, s64, 4096
    buffer_load_dwordx4 v[200:203], v225, s[80:83], s64 offen offset:0 sc1
    buffer_load_dwordx4 v[204:207], v225, s[80:83], s64 offen offset:2048 sc1
    s_add_u32 s64, s64, 4096
    s_branch g3c1_hb
g3c1_h5:
    s_cmp_lg_u32 s75, 0
    s_cbranch_scc1 g3c1_h5b
    s_lshl_b32 s64, s74, 4
    s_add_u32 s64, s64, s73
    s_lshl_b32 s64, s64, 3
    s_add_u32 s64, s64, s69
    s_lshl_b32 s64, s64, 2
    s_add_u32 s64, s64, 75579392
    v_mov_b32 v216, 0
    v_mov_b32 v217, 1
    s_mov_b64 exec, 1
    buffer_store_dword v217, v216, s[80:83], s64 offen sc0 sc1
    s_mov_b64 exec, -1
g3c1_h5b:
    v_pk_add_f32 v[176:177], v[176:177], v[192:193]
    v_pk_add_f32 v[178:179], v[178:179], v[194:195]
    v_pk_add_f32 v[180:181], v[180:181], v[196:197]
    v_pk_add_f32 v[182:183], v[182:183], v[198:199]
    v_pk_add_f32 v[184:185], v[184:185], v[200:201]
    v_pk_add_f32 v[186:187], v[186:187], v[202:203]
    v_pk_add_f32 v[188:189], v[188:189], v[204:205]
    v_pk_add_f32 v[190:191], v[190:191], v[206:207]
    v_pk_add_f32 v[176:177], v[176:177], v[184:185]
    v_pk_add_f32 v[178:179], v[178:179], v[186:187]
    v_pk_add_f32 v[180:181], v[180:181], v[188:189]
    v_pk_add_f32 v[182:183], v[182:183], v[190:191]
    v_pk_add_f32 v[176:177], v[176:177], v[180:181]
    v_pk_add_f32 v[178:179], v[178:179], v[182:183]
    v_add_f32 v176, v176, v178
    v_add_f32 v177, v177, v179
    v_mov_b32 v178, v176
    v_mov_b32 v179, v177
    s_nop 1
    v_permlane32_swap_b32 v176, v178
    v_permlane32_swap_b32 v177, v179
    v_add_f32 v176, v176, v178
    v_add_f32 v177, v177, v179
    v_mul_f32 v176, 0x3a800000, v176
    v_mul_f32 v177, 0x3a800000, v177
    v_fma_f32 v177, -v176, v176, v177
    v_max_f32 v177, 0, v177
    v_cvt_pk_bf16_f32 v176, v176, v176
    v_lshlrev_b32 v176, 16, v176
    v_cvt_pk_bf16_f32 v177, v177, v177
    v_lshlrev_b32 v177, 16, v177
    v_add_f32 v177, 0x3727c5ac, v177
    v_cvt_pk_bf16_f32 v177, v177, v177
    v_lshlrev_b32 v177, 16, v177
    v_sqrt_f32 v177, v177
    s_nop 0
    v_cvt_pk_bf16_f32 v177, v177, v177
    v_lshlrev_b32 v177, 16, v177
    v_rcp_f32 v177, v177
    s_nop 0
    v_and_b32 v225, 31, v250
    s_lshl_b32 s64, s69, 8
    s_add_u32 s64, s64, 159744
    v_lshlrev_b32 v225, 3, v225
    v_add_u32 v225, s64, v225
    ds_write_b64 v225, v[176:177]
    s_branch g3c1_hb
g3c1_h2:
    s_lshl_b32 s64, s74, 9
    s_add_u32 s64, s64, 75579392
    v_lshlrev_b32 v225, 5, v250
    s_mov_b64 exec, 0xffff
pl_1048:
    buffer_load_dwordx4 v[216:219], v225, s[80:83], s64 offen sc1
    s_sub_u32 s79, s79, 1
    s_cbranch_scc1 L_abort
    s_waitcnt vmcnt(0)
    v_and_b32 v216, v216, v217
    v_and_b32 v218, v218, v219
    v_and_b32 v216, v216, v218
    v_cmp_ne_u32 vcc, 1, v216
    s_cbranch_vccnz pl_1048
    s_mov_b64 exec, -1
    s_and_b32 s64, s3, 1
    s_mul_i32 s64, s64, 14336
    s_mul_i32 s65, s74, 896
    s_add_u32 s64, s64, s65
    s_lshr_b32 s65, s69, 1
    s_mul_i32 s65, s65, 448
    s_add_u32 s64, s64, s65
    s_add_u32 s64, s64, 74448896
    v_and_b32 v225, 31, v250
    v_lshlrev_b32 v225, 4, v225
    v_lshrrev_b32 v253, 5, v250
    v_mul_u32_u24 v253, 229376, v253
    v_add_u32 v225, v253, v225
    s_mov_b32 exec_lo, 0x0fffffff
    s_mov_b32 exec_hi, 0x0fffffff
    buffer_load_dwordx4 v[176:179], v225, s[80:83], s64 offen sc0 sc1
    s_add_u32 s64, s64, 28672
    buffer_load_dwordx4 v[180:183], v225, s[80:83], s64 offen sc0 sc1
    s_add_u32 s64, s64, 28672
    buffer_load_dwordx4 v[184:187], v225, s[80:83], s64 offen sc0 sc1
    s_add_u32 s64, s64, 28672
    buffer_load_dwordx4 v[188:191], v225, s[80:83], s64 offen sc0 sc1
    s_add_u32 s64, s64, 28672
    buffer_load_dwordx4 v[192:195], v225, s[80:83], s64 offen sc0 sc1
    s_add_u32 s64, s64, 28672
    buffer_load_dwordx4 v[196:199], v225, s[80:83], s64 offen sc0 sc1
    s_add_u32 s64, s64, 28672
    buffer_load_dwordx4 v[200:203], v225, s[80:83], s64 offen sc0 sc1
    s_add_u32 s64, s64, 28672
    buffer_load_dwordx4 v[204:207], v225, s[80:83], s64 offen sc0 sc1
    s_add_u32 s64, s64, 28672
    s_mov_b64 exec, -1
    s_branch g3c1_hb
g3c1_h1:
    v_pk_add_f32 v[176:177], v[176:177], v[192:193]
    v_pk_add_f32 v[178:179], v[178:179], v[194:195]
    v_pk_add_f32 v[180:181], v[180:181], v[196:197]
    v_pk_add_f32 v[182:183], v[182:183], v[198:199]
    v_pk_add_f32 v[184:185], v[184:185], v[200:201]
    v_pk_add_f32 v[186:187], v[186:187], v[202:203]
    v_pk_add_f32 v[188:189], v[188:189], v[204:205]
    v_pk_add_f32 v[190:191], v[190:191], v[206:207]
    v_pk_add_f32 v[176:177], v[176:177], v[184:185]
    v_pk_add_f32 v[178:179], v[178:179], v[186:187]
    v_pk_add_f32 v[180:181], v[180:181], v[188:189]
    v_pk_add_f32 v[182:183], v[182:183], v[190:191]
    v_pk_add_f32 v[176:177], v[176:177], v[180:181]
    v_pk_add_f32 v[178:179], v[178:179], v[182:183]
    v_mov_b32 v180, v176
    v_mov_b32 v181, v177
    v_mov_b32 v182, v178
    v_mov_b32 v183, v179
    s_nop 1
    v_permlane32_swap_b32 v176, v180
    v_permlane32_swap_b32 v177, v181
    v_permlane32_swap_b32 v178, v182
    v_permlane32_swap_b32 v179, v183
    v_add_f32 v176, v176, v180
    v_add_f32 v177, v177, v181
    v_add_f32 v178, v178, v182
    v_add_f32 v179, v179, v183
    s_and_b32 s64, s3, 1
    s_mul_i32 s64, s64, 896
    s_lshr_b32 s65, s69, 1
    s_mul_i32 s65, s65, 448
    s_add_u32 s64, s64, s65
    s_add_u32 s64, s64, 160896
    v_add_u32 v225, s64, v249
    s_mov_b64 exec, 0x0fffffff
    ds_write_b128 v225, v[176:179]
    s_mov_b64 exec, -1
    s_branch g3c1_hb
sg_1049_slow:
    s_waitcnt vmcnt(0)
    buffer_wbl2 sc1
    s_waitcnt vmcnt(0)
    s_mov_b64 exec, 1
    buffer_store_dword v145, v144, s[80:83], s64 offen sc0 sc1
    s_mov_b64 exec, -1
    s_branch sg_1049_done
pl_1050_acq:
    buffer_inv sc1
    s_waitcnt vmcnt(0)
    s_branch pl_1050_ok
pl_1051_acq:
    buffer_inv sc1
    s_waitcnt vmcnt(0)
    s_branch pl_1051_ok
pl_1052_acq:
    buffer_inv sc1
    s_waitcnt vmcnt(0)
    s_branch pl_1052_ok
L_fin:
L_abort:
L_end:
    s_endpgm
.section .rodata,"a"
.p2align 6
.amdhsa_kernel interleave_layers__sliding_local_dilated__glu_gated_swiglu__prompt_kernel
  .amdhsa_next_free_vgpr 256
  .amdhsa_next_free_sgpr 102
  .amdhsa_accum_offset 256
  .amdhsa_group_segment_fixed_size 0
  .amdhsa_kernarg_size 80
  .amdhsa_user_sgpr_count 2
  .amdhsa_user_sgpr_kernarg_segment_ptr 1
  .amdhsa_system_sgpr_workgroup_id_x 1
.end_amdhsa_kernel
```

```asm
; @launch grid=(256,1,1) block=(512,1,1) lds=163840
.amdgcn_target "amdgcn-amd-amdhsa--gfx950"
.text
.globl interleave_layers__sliding_local_dilated__glu_gated_swiglu__prompt_kernel
.p2align 8
.type interleave_layers__sliding_local_dilated__glu_gated_swiglu__prompt_kernel,@function
interleave_layers__sliding_local_dilated__glu_gated_swiglu__prompt_kernel:
    s_cmp_ge_u32 s2, 256
    s_cbranch_scc1 L_end
    s_load_dwordx4 s[84:87], s[0:1], 0
    s_load_dwordx2 s[4:5], s[0:1], 72
    s_load_dwordx2 s[88:89], s[0:1], 16
    s_load_dwordx4 s[92:95], s[0:1], 32
    s_load_dwordx4 s[96:99], s[0:1], 48
    s_load_dwordx2 s[90:91], s[0:1], 64
    v_lshrrev_b32 v1, 6, v0
    v_and_b32 v250, 63, v0
    v_readfirstlane_b32 s3, v1
    v_lshrrev_b32 v251, 4, v250
    v_and_b32 v252, 15, v250
    v_lshlrev_b32 v249, 4, v250
    s_and_b32 s70, s2, 7
    s_lshr_b32 s72, s2, 4
    s_lshr_b32 s71, s2, 3
    s_and_b32 s71, s71, 1
    s_lshl_b32 s73, s70, 1
    s_sub_u32 s74, s72, s73
    s_and_b32 s74, s74, 15
    s_add_u32 s73, s73, s71
    s_sub_u32 s61, s74, s70
    s_add_u32 s61, s61, 3
    s_and_b32 s61, s61, 7
    s_and_b32 s64, s74, 8
    s_add_u32 s68, s61, s64
    s_lshl_b32 s67, s70, 1
    s_add_u32 s67, s67, s72
    s_and_b32 s67, s67, 15
    s_mov_b32 s60, 0
    s_mov_b32 s59, 1
    s_mov_b32 s57, s72
    s_mov_b32 s58, s70
    s_and_b32 s69, s3, 3
    s_mov_b32 s75, 0
    s_mov_b32 s78, 1
    s_mov_b32 s79, 4194304
    s_waitcnt lgkmcnt(0)
    s_mov_b32 s80, s4
    s_mov_b32 s81, s5
    s_mov_b32 s82, 79691776
    s_mov_b32 s83, 0x00020000
    s_cmp_ge_u32 s3, 4
    s_cbranch_scc1 L_load
    s_mul_i32 s64, s3, 18432
    v_add_u32 v8, s64, v249
    v_mov_b32 v4, 0x3f803f80
    v_mov_b32 v5, 0x3f803f80
    v_mov_b32 v6, 0x3f803f80
    v_mov_b32 v7, 0x3f803f80
    s_mov_b64 exec, 0xff
    ds_write_b128 v8, v[4:7]
    s_mov_b64 exec, -1
    v_mov_b32 v0, 0
    s_cmp_lg_u32 s3, 3
    s_cbranch_scc1 L_noinit
    v_mov_b32 v1, 0
    v_mov_b32 v2, 0
    v_mov_b32 v3, 0
    v_lshrrev_b32 v8, 1, v250
    v_lshlrev_b32 v8, 13, v8
    v_and_b32 v9, 1, v250
    v_lshl_add_u32 v8, v9, 4, v8
    s_lshl_b32 s64, s73, 4
    s_add_u32 s64, s64, s72
    s_lshl_b32 s64, s64, 5
    s_add_u32 s65, s64, 75497472
    s_mov_b64 exec, 0xffff
    buffer_store_dwordx4 v[0:3], v8, s[80:83], s65 offen sc0 sc1
    s_mov_b64 exec, 3
    s_add_u32 s65, s64, 75571200
    buffer_store_dwordx4 v[0:3], v249, s[80:83], s65 offen sc0 sc1
    s_lshl_b32 s64, s74, 4
    s_add_u32 s64, s64, s73
    s_lshl_b32 s64, s64, 5
    s_add_u32 s65, s64, 75579392
    buffer_store_dwordx4 v[0:3], v249, s[80:83], s65 offen sc0 sc1
    s_lshl_b32 s64, s73, 4
    s_add_u32 s64, s64, s74
    s_lshl_b32 s64, s64, 4
    s_add_u32 s65, s64, 75563008
    v_lshlrev_b32 v8, 12, v250
    buffer_store_dwordx4 v[0:3], v8, s[80:83], s65 offen sc0 sc1
    s_mov_b64 exec, -1
L_noinit:
    s_mov_b32 s8, s84
    s_mov_b32 s9, s85
    s_mov_b32 s10, 4194304
    s_mov_b32 s11, 0x00020000
    s_lshl_b32 s16, s72, 2
    s_add_u32 s16, s16, s3
    s_lshl_b32 s16, s16, 1
    s_lshl_b32 s17, s73, 7
    s_add_u32 s18, s17, s16
    s_lshl_b32 s18, s18, 11
    s_add_u32 s19, s17, s72
    s_sub_u32 s19, s19, 16
    s_lshl_b32 s19, s19, 11
    s_cmp_eq_u32 s73, 0
    s_cselect_b32 s19, 0x7f000000, s19
    s_cmp_lg_u32 s3, 0
    s_cselect_b32 s19, 0x7f000000, s19
    buffer_load_dwordx4 v[16:19], v249, s[8:11], s18 offen offset:0
    buffer_load_dwordx4 v[20:23], v249, s[8:11], s18 offen offset:1024
    buffer_load_dwordx4 v[24:27], v249, s[8:11], s18 offen offset:2048
    buffer_load_dwordx4 v[28:31], v249, s[8:11], s18 offen offset:3072
    v_mov_b32 v32, 0
    v_mov_b32 v33, 0
    v_mov_b32 v34, 0
    v_mov_b32 v35, 0
    v_mov_b32 v36, 0
    v_mov_b32 v37, 0
    v_mov_b32 v38, 0
    v_mov_b32 v39, 0
    s_cbranch_scc1 xs_1
    buffer_load_dwordx4 v[32:35], v249, s[8:11], s19 offen offset:0
    buffer_load_dwordx4 v[36:39], v249, s[8:11], s19 offen offset:1024
xs_1:
    v_mov_b32 v56, 0x3f803f80
    s_waitcnt vmcnt(0)
    v_dot2_f32_bf16 v48, v16, v56, 0
    v_dot2_f32_bf16 v49, v16, v16, 0
    v_dot2_f32_bf16 v48, v17, v56, v48
    v_dot2_f32_bf16 v49, v17, v17, v49
    v_dot2_f32_bf16 v48, v18, v56, v48
    v_dot2_f32_bf16 v49, v18, v18, v49
    v_dot2_f32_bf16 v48, v19, v56, v48
    v_dot2_f32_bf16 v49, v19, v19, v49
    v_dot2_f32_bf16 v48, v20, v56, v48
    v_dot2_f32_bf16 v49, v20, v20, v49
    v_dot2_f32_bf16 v48, v21, v56, v48
    v_dot2_f32_bf16 v49, v21, v21, v49
    v_dot2_f32_bf16 v48, v22, v56, v48
    v_dot2_f32_bf16 v49, v22, v22, v49
    v_dot2_f32_bf16 v48, v23, v56, v48
    v_dot2_f32_bf16 v49, v23, v23, v49
    v_dot2_f32_bf16 v50, v24, v56, 0
    v_dot2_f32_bf16 v51, v24, v24, 0
    v_dot2_f32_bf16 v50, v25, v56, v50
    v_dot2_f32_bf16 v51, v25, v25, v51
    v_dot2_f32_bf16 v50, v26, v56, v50
    v_dot2_f32_bf16 v51, v26, v26, v51
    v_dot2_f32_bf16 v50, v27, v56, v50
    v_dot2_f32_bf16 v51, v27, v27, v51
    v_dot2_f32_bf16 v50, v28, v56, v50
    v_dot2_f32_bf16 v51, v28, v28, v51
    v_dot2_f32_bf16 v50, v29, v56, v50
    v_dot2_f32_bf16 v51, v29, v29, v51
    v_dot2_f32_bf16 v50, v30, v56, v50
    v_dot2_f32_bf16 v51, v30, v30, v51
    v_dot2_f32_bf16 v50, v31, v56, v50
    v_dot2_f32_bf16 v51, v31, v31, v51
    v_dot2_f32_bf16 v52, v32, v56, 0
    v_dot2_f32_bf16 v53, v32, v32, 0
    v_dot2_f32_bf16 v52, v33, v56, v52
    v_dot2_f32_bf16 v53, v33, v33, v53
    v_dot2_f32_bf16 v52, v34, v56, v52
    v_dot2_f32_bf16 v53, v34, v34, v53
    v_dot2_f32_bf16 v52, v35, v56, v52
    v_dot2_f32_bf16 v53, v35, v35, v53
    v_dot2_f32_bf16 v52, v36, v56, v52
    v_dot2_f32_bf16 v53, v36, v36, v53
    v_dot2_f32_bf16 v52, v37, v56, v52
    v_dot2_f32_bf16 v53, v37, v37, v53
    v_dot2_f32_bf16 v52, v38, v56, v52
    v_dot2_f32_bf16 v53, v38, v38, v53
    v_dot2_f32_bf16 v52, v39, v56, v52
    v_dot2_f32_bf16 v53, v39, v39, v53
    s_nop 2
    v_add_f32_dpp v48, v48, v48 quad_perm:[1,0,3,2] row_mask:0xf bank_mask:0xf
    v_add_f32_dpp v49, v49, v49 quad_perm:[1,0,3,2] row_mask:0xf bank_mask:0xf
    v_add_f32_dpp v50, v50, v50 quad_perm:[1,0,3,2] row_mask:0xf bank_mask:0xf
    v_add_f32_dpp v51, v51, v51 quad_perm:[1,0,3,2] row_mask:0xf bank_mask:0xf
    v_add_f32_dpp v52, v52, v52 quad_perm:[1,0,3,2] row_mask:0xf bank_mask:0xf
    v_add_f32_dpp v53, v53, v53 quad_perm:[1,0,3,2] row_mask:0xf bank_mask:0xf
    v_add_f32_dpp v48, v48, v48 quad_perm:[2,3,0,1] row_mask:0xf bank_mask:0xf
    v_add_f32_dpp v49, v49, v49 quad_perm:[2,3,0,1] row_mask:0xf bank_mask:0xf
    v_add_f32_dpp v50, v50, v50 quad_perm:[2,3,0,1] row_mask:0xf bank_mask:0xf
    v_add_f32_dpp v51, v51, v51 quad_perm:[2,3,0,1] row_mask:0xf bank_mask:0xf
    v_add_f32_dpp v52, v52, v52 quad_perm:[2,3,0,1] row_mask:0xf bank_mask:0xf
    v_add_f32_dpp v53, v53, v53 quad_perm:[2,3,0,1] row_mask:0xf bank_mask:0xf
    v_add_f32_dpp v48, v48, v48 row_half_mirror row_mask:0xf bank_mask:0xf
    v_add_f32_dpp v49, v49, v49 row_half_mirror row_mask:0xf bank_mask:0xf
    v_add_f32_dpp v50, v50, v50 row_half_mirror row_mask:0xf bank_mask:0xf
    v_add_f32_dpp v51, v51, v51 row_half_mirror row_mask:0xf bank_mask:0xf
    v_add_f32_dpp v52, v52, v52 row_half_mirror row_mask:0xf bank_mask:0xf
    v_add_f32_dpp v53, v53, v53 row_half_mirror row_mask:0xf bank_mask:0xf
    v_add_f32_dpp v48, v48, v48 row_mirror row_mask:0xf bank_mask:0xf
    v_add_f32_dpp v49, v49, v49 row_mirror row_mask:0xf bank_mask:0xf
    v_add_f32_dpp v50, v50, v50 row_mirror row_mask:0xf bank_mask:0xf
    v_add_f32_dpp v51, v51, v51 row_mirror row_mask:0xf bank_mask:0xf
    v_add_f32_dpp v52, v52, v52 row_mirror row_mask:0xf bank_mask:0xf
    v_add_f32_dpp v53, v53, v53 row_mirror row_mask:0xf bank_mask:0xf
    v_mov_b32 v16, v48
    v_mov_b32 v17, v49
    v_mov_b32 v18, v50
    v_mov_b32 v19, v51
    v_mov_b32 v20, v52
    v_mov_b32 v21, v53
    s_nop 1
    v_permlane16_swap_b32 v48, v16
    v_permlane16_swap_b32 v49, v17
    v_permlane16_swap_b32 v50, v18
    v_permlane16_swap_b32 v51, v19
    v_permlane16_swap_b32 v52, v20
    v_permlane16_swap_b32 v53, v21
    v_add_f32 v48, v48, v16
    v_add_f32 v49, v49, v17
    v_add_f32 v50, v50, v18
    v_add_f32 v51, v51, v19
    v_add_f32 v52, v52, v20
    v_add_f32 v53, v53, v21
    v_mov_b32 v16, v48
    v_mov_b32 v17, v49
    v_mov_b32 v18, v50
    v_mov_b32 v19, v51
    v_mov_b32 v20, v52
    v_mov_b32 v21, v53
    s_nop 1
    v_permlane32_swap_b32 v48, v16
    v_permlane32_swap_b32 v49, v17
    v_permlane32_swap_b32 v50, v18
    v_permlane32_swap_b32 v51, v19
    v_permlane32_swap_b32 v52, v20
    v_permlane32_swap_b32 v53, v21
    v_add_f32 v48, v48, v16
    v_add_f32 v49, v49, v17
    v_add_f32 v50, v50, v18
    v_add_f32 v51, v51, v19
    v_add_f32 v52, v52, v20
    v_add_f32 v53, v53, v21
    v_cmp_eq_u32 vcc, 1, v250
    s_nop 1
    v_cndmask_b32 v48, v48, v50, vcc
    v_cndmask_b32 v49, v49, v51, vcc
    v_cmp_eq_u32 vcc, 2, v250
    s_nop 1
    v_cndmask_b32 v48, v48, v52, vcc
    v_cndmask_b32 v49, v49, v53, vcc
    v_mul_f32 v48, 0x3a800000, v48
    v_mul_f32 v49, 0x3a800000, v49
    v_fma_f32 v49, -v48, v48, v49
    v_max_f32 v49, 0, v49
    v_cvt_pk_bf16_f32 v48, v48, v48
    v_lshlrev_b32 v48, 16, v48
    v_cvt_pk_bf16_f32 v49, v49, v49
    v_lshlrev_b32 v49, 16, v49
    v_add_f32 v49, 0x3727c5ac, v49
    v_cvt_pk_bf16_f32 v49, v49, v49
    v_lshlrev_b32 v49, 16, v49
    v_sqrt_f32 v49, v49
    s_nop 0
    v_cvt_pk_bf16_f32 v49, v49, v49
    v_lshlrev_b32 v49, 16, v49
    v_rcp_f32 v49, v49
    s_nop 0
    s_add_u32 s16, s16, 16
    v_add_u32 v16, s16, v250
    v_mov_b32 v17, s72
    v_cndmask_b32 v16, v16, v17, vcc
    v_lshlrev_b32 v16, 3, v16
    s_lshl_b32 s17, s73, 11
    s_add_u32 s17, s17, 74186752
    s_cmp_eq_u32 s3, 0
    s_cselect_b64 exec, 7, 3
    buffer_store_dwordx2 v[48:49], v16, s[80:83], s17 offen sc0 sc1
    s_mov_b64 exec, -1
    s_waitcnt lgkmcnt(0)
C_layer:
    s_and_b32 s19, s3, 1
    s_lshr_b32 s20, s3, 1
    s_cmp_lg_u32 s75, 0
    s_cbranch_scc1 ad_2_f
    v_lshlrev_b32 v253, 7, v252
    v_and_b32 v254, 6, v250
    v_xor_b32 v254, v254, v251
    v_lshl_add_u32 v204, v254, 4, v253
    v_xor_b32 v205, 64, v204
    s_branch ad_2_d
ad_2_f:
    v_mov_b32 v204, v249
    v_add_u32 v205, 1024, v249
ad_2_d:
    v_lshrrev_b32 v253, 2, v252
    v_mul_u32_u24 v253, 3104, v253
    v_lshl_add_u32 v253, v251, 7, v253
    v_and_b32 v254, 3, v252
    v_lshl_add_u32 v253, v254, 3, v253
    s_lshl_b32 s64, s19, 6
    s_add_u32 s64, s64, 73984
    v_add_u32 v208, s64, v253
    v_mov_b32 v209, v208
    s_mov_b32 s16, 0
    s_mov_b32 s17, 18432
    v_add_u32 v206, s17, v204
    v_add_u32 v207, s17, v205
    s_lshl_b32 s21, s73, 4
    s_add_u32 s21, s21, s67
    s_lshl_b32 s21, s21, 1
    s_add_u32 s21, s21, s19
    s_lshl_b32 s21, s21, 1
    s_add_u32 s21, s21, s20
    s_lshl_b32 s21, s21, 12
    s_lshl_b32 s64, s60, 22
    s_add_u32 s21, s21, s64
    s_add_u32 s21, s21, 12582912
    v_and_b32 v254, 1, v252
    v_cmp_eq_u32 s[28:29], 1, v254
    v_lshlrev_b32 v253, 2, v251
    v_sub_u32 v253, v252, v253
    v_sub_u32 v253, v253, v254
    v_lshlrev_b32 v254, 4, v254
    v_mov_b32 v210, 0xffff
    v_lshlrev_b32 v210, v254, v210
    v_cmp_le_i32 s[30:31], 0, v253
    v_cmp_le_i32 s[32:33], 2, v253
    s_or_b32 s22, s73, s20
    s_cmp_eq_u32 s22, 0
    s_cselect_b64 s[34:35], s[30:31], -1
    s_cselect_b64 s[36:37], s[32:33], -1
    v_cndmask_b32 v232, v210, 0, s[30:31]
    v_cndmask_b32 v234, 0, v210, s[30:31]
    v_cndmask_b32 v233, v210, 0, s[32:33]
    v_cndmask_b32 v235, 0, v210, s[32:33]
    s_mov_b32 s23, 0x3e8293ee
    s_mul_i32 s64, s19, 6144
    s_add_u32 s64, s64, 18432
    v_add_u32 v236, s64, v249
    s_mul_i32 s64, s19, 384
    s_add_u32 s64, s64, 162688
    v_lshlrev_b32 v237, 4, v251
    v_add_u32 v237, s64, v237
    v_lshlrev_b32 v238, 2, v252
    v_add_u32 v238, s64, v238
    s_lshl_b32 s64, s20, 9
    s_add_u32 s64, s64, 159744
    v_lshlrev_b32 v239, 3, v252
    v_add_u32 v239, s64, v239
    v_lshlrev_b32 v240, 5, v251
    v_add_u32 v240, s64, v240
    v_mov_b32 v241, 163456
    v_mov_b32 v212, 0
    v_mov_b32 v213, 0
    v_mov_b32 v214, 0
    v_mov_b32 v215, 0
    s_mov_b32 s18, 16
    s_nop 0
    v_mfma_f32_32x32x16_bf16 v[0:15], v[212:215], v[212:215], 0
    v_mfma_f32_32x32x16_bf16 v[16:31], v[212:215], v[212:215], 0
    v_mfma_f32_32x32x16_bf16 v[32:47], v[212:215], v[212:215], 0
    v_mfma_f32_32x32x16_bf16 v[48:63], v[212:215], v[212:215], 0
    v_mfma_f32_32x32x16_bf16 v[64:79], v[212:215], v[212:215], 0
    v_mfma_f32_32x32x16_bf16 v[80:95], v[212:215], v[212:215], 0
    v_mfma_f32_32x32x16_bf16 v[96:111], v[212:215], v[212:215], 0
    v_mfma_f32_32x32x16_bf16 v[112:127], v[212:215], v[212:215], 0
    s_nop 7
    s_nop 3
    s_cmp_eq_u32 s20, 1
    s_cbranch_scc1 g1c_r1
    s_barrier
    ds_read_b128 v[116:119], v206 offset:0
    ds_read_b64_tr_b16 v[164:165], v209 offset:13440
    ds_read_b64_tr_b16 v[166:167], v209 offset:13952
    ds_read_b128 v[120:123], v206 offset:2048
    ds_read_b64_tr_b16 v[168:169], v209 offset:13472
    ds_read_b64_tr_b16 v[170:171], v209 offset:13984
    ds_read_b128 v[124:127], v206 offset:4096
    ds_read_b64_tr_b16 v[172:173], v209 offset:14464
    ds_read_b64_tr_b16 v[174:175], v209 offset:14976
    ds_read_b128 v[128:131], v206 offset:6144
    ds_read_b64_tr_b16 v[176:177], v209 offset:14496
    ds_read_b64_tr_b16 v[178:179], v209 offset:15008
    ds_read_b128 v[132:135], v206 offset:8192
    ds_read_b64_tr_b16 v[156:157], v209 offset:12416
    ds_read_b64_tr_b16 v[158:159], v209 offset:12928
    ds_read_b64_tr_b16 v[160:161], v209 offset:12448
    ds_read_b64_tr_b16 v[162:163], v209 offset:12960
    s_add_u32 s16, s16, 24832
    s_cmp_eq_u32 s16, 74496
    s_cselect_b32 s16, 0, s16
    v_add_u32 v209, s16, v208
    s_waitcnt lgkmcnt(0)
g1c_loop0:
    s_barrier
    v_mfma_f32_16x16x32_bf16 v[112:115], v[156:159], v[116:119], v[112:115]
    ds_read_b128 v[136:139], v207 offset:0
    v_mfma_f32_16x16x32_bf16 v[32:35], v[164:167], v[116:119], v[32:35]
    ds_read_b64_tr_b16 v[188:189], v209 offset:1024
    v_mfma_f32_16x16x32_bf16 v[36:39], v[168:171], v[116:119], v[36:39]
    ds_read_b64_tr_b16 v[190:191], v209 offset:1536
    v_mfma_f32_16x16x32_bf16 v[40:43], v[164:167], v[120:123], v[40:43]
    ds_read_b128 v[140:143], v207 offset:2048
    v_mfma_f32_16x16x32_bf16 v[48:51], v[164:167], v[124:127], v[48:51]
    ds_read_b64_tr_b16 v[192:193], v209 offset:1056
    v_mfma_f32_16x16x32_bf16 v[56:59], v[164:167], v[128:131], v[56:59]
    ds_read_b64_tr_b16 v[194:195], v209 offset:1568
    v_mfma_f32_16x16x32_bf16 v[64:67], v[164:167], v[132:135], v[64:67]
    ds_read_b128 v[144:147], v207 offset:4096
    v_mfma_f32_16x16x32_bf16 v[44:47], v[168:171], v[120:123], v[44:47]
    ds_read_b64_tr_b16 v[196:197], v209 offset:2048
    v_mfma_f32_16x16x32_bf16 v[52:55], v[168:171], v[124:127], v[52:55]
    ds_read_b64_tr_b16 v[198:199], v209 offset:2560
    v_mfma_f32_16x16x32_bf16 v[60:63], v[168:171], v[128:131], v[60:63]
    ds_read_b128 v[148:151], v207 offset:6144
    v_mfma_f32_16x16x32_bf16 v[68:71], v[168:171], v[132:135], v[68:71]
    ds_read_b64_tr_b16 v[200:201], v209 offset:2080
    v_mfma_f32_16x16x32_bf16 v[80:83], v[120:123], v[172:175], v[80:83]
    ds_read_b64_tr_b16 v[202:203], v209 offset:2592
    v_mfma_f32_16x16x32_bf16 v[88:91], v[124:127], v[172:175], v[88:91]
    ds_read_b128 v[152:155], v207 offset:8192
    v_mfma_f32_16x16x32_bf16 v[96:99], v[128:131], v[172:175], v[96:99]
    ds_read_b64_tr_b16 v[180:181], v209 offset:0
    v_mfma_f32_16x16x32_bf16 v[104:107], v[132:135], v[172:175], v[104:107]
    ds_read_b64_tr_b16 v[182:183], v209 offset:512
    v_mfma_f32_16x16x32_bf16 v[84:87], v[120:123], v[176:179], v[84:87]
    ds_read_b64_tr_b16 v[184:185], v209 offset:32
    v_mfma_f32_16x16x32_bf16 v[92:95], v[124:127], v[176:179], v[92:95]
    ds_read_b64_tr_b16 v[186:187], v209 offset:544
    v_mfma_f32_16x16x32_bf16 v[100:103], v[128:131], v[176:179], v[100:103]
    v_mfma_f32_16x16x32_bf16 v[108:111], v[132:135], v[176:179], v[108:111]
    s_add_u32 s17, s17, 18432
    s_cmp_eq_u32 s17, 73728
    v_mfma_f32_16x16x32_bf16 v[0:3], v[156:159], v[120:123], v[0:3]
    v_mfma_f32_16x16x32_bf16 v[8:11], v[156:159], v[124:127], v[8:11]
    s_cselect_b32 s17, 0, s17
    v_mfma_f32_16x16x32_bf16 v[16:19], v[156:159], v[128:131], v[16:19]
    v_mfma_f32_16x16x32_bf16 v[24:27], v[156:159], v[132:135], v[24:27]
    v_add_u32 v206, s17, v204
    v_mfma_f32_16x16x32_bf16 v[4:7], v[160:163], v[120:123], v[4:7]
    v_mfma_f32_16x16x32_bf16 v[12:15], v[160:163], v[124:127], v[12:15]
    v_add_u32 v207, s17, v205
    v_mfma_f32_16x16x32_bf16 v[20:23], v[160:163], v[128:131], v[20:23]
    v_mfma_f32_16x16x32_bf16 v[28:31], v[160:163], v[132:135], v[28:31]
    s_waitcnt lgkmcnt(0)
    v_mfma_f32_16x16x32_bf16 v[112:115], v[180:183], v[136:139], v[112:115]
    ds_read_b128 v[116:119], v206 offset:0
    v_mfma_f32_16x16x32_bf16 v[32:35], v[188:191], v[136:139], v[32:35]
    ds_read_b64_tr_b16 v[164:165], v209 offset:13440
    v_mfma_f32_16x16x32_bf16 v[36:39], v[192:195], v[136:139], v[36:39]
    ds_read_b64_tr_b16 v[166:167], v209 offset:13952
    v_mfma_f32_16x16x32_bf16 v[40:43], v[188:191], v[140:143], v[40:43]
    ds_read_b128 v[120:123], v206 offset:2048
    v_mfma_f32_16x16x32_bf16 v[48:51], v[188:191], v[144:147], v[48:51]
    ds_read_b64_tr_b16 v[168:169], v209 offset:13472
    v_mfma_f32_16x16x32_bf16 v[56:59], v[188:191], v[148:151], v[56:59]
    ds_read_b64_tr_b16 v[170:171], v209 offset:13984
    v_mfma_f32_16x16x32_bf16 v[64:67], v[188:191], v[152:155], v[64:67]
    ds_read_b128 v[124:127], v206 offset:4096
    v_mfma_f32_16x16x32_bf16 v[44:47], v[192:195], v[140:143], v[44:47]
    ds_read_b64_tr_b16 v[172:173], v209 offset:14464
    v_mfma_f32_16x16x32_bf16 v[52:55], v[192:195], v[144:147], v[52:55]
    ds_read_b64_tr_b16 v[174:175], v209 offset:14976
    v_mfma_f32_16x16x32_bf16 v[60:63], v[192:195], v[148:151], v[60:63]
    ds_read_b128 v[128:131], v206 offset:6144
    v_mfma_f32_16x16x32_bf16 v[68:71], v[192:195], v[152:155], v[68:71]
    ds_read_b64_tr_b16 v[176:177], v209 offset:14496
    v_mfma_f32_16x16x32_bf16 v[80:83], v[140:143], v[196:199], v[80:83]
    ds_read_b64_tr_b16 v[178:179], v209 offset:15008
    v_mfma_f32_16x16x32_bf16 v[88:91], v[144:147], v[196:199], v[88:91]
    ds_read_b128 v[132:135], v206 offset:8192
    v_mfma_f32_16x16x32_bf16 v[96:99], v[148:151], v[196:199], v[96:99]
    ds_read_b64_tr_b16 v[156:157], v209 offset:12416
    v_mfma_f32_16x16x32_bf16 v[104:107], v[152:155], v[196:199], v[104:107]
    ds_read_b64_tr_b16 v[158:159], v209 offset:12928
    v_mfma_f32_16x16x32_bf16 v[84:87], v[140:143], v[200:203], v[84:87]
    ds_read_b64_tr_b16 v[160:161], v209 offset:12448
    v_mfma_f32_16x16x32_bf16 v[92:95], v[144:147], v[200:203], v[92:95]
    ds_read_b64_tr_b16 v[162:163], v209 offset:12960
    v_mfma_f32_16x16x32_bf16 v[100:103], v[148:151], v[200:203], v[100:103]
    v_mfma_f32_16x16x32_bf16 v[108:111], v[152:155], v[200:203], v[108:111]
    s_add_u32 s16, s16, 24832
    s_cmp_eq_u32 s16, 74496
    v_mfma_f32_16x16x32_bf16 v[0:3], v[180:183], v[140:143], v[0:3]
    v_mfma_f32_16x16x32_bf16 v[8:11], v[180:183], v[144:147], v[8:11]
    s_cselect_b32 s16, 0, s16
    v_mfma_f32_16x16x32_bf16 v[16:19], v[180:183], v[148:151], v[16:19]
    v_mfma_f32_16x16x32_bf16 v[24:27], v[180:183], v[152:155], v[24:27]
    v_add_u32 v209, s16, v208
    v_mfma_f32_16x16x32_bf16 v[4:7], v[184:187], v[140:143], v[4:7]
    v_mfma_f32_16x16x32_bf16 v[12:15], v[184:187], v[144:147], v[12:15]
    s_sub_u32 s18, s18, 1
    s_cmp_lg_u32 s18, 0
    v_mfma_f32_16x16x32_bf16 v[20:23], v[184:187], v[148:151], v[20:23]
    v_mfma_f32_16x16x32_bf16 v[28:31], v[184:187], v[152:155], v[28:31]
    s_waitcnt vmcnt(0) lgkmcnt(0)
    s_cbranch_scc1 g1c_loop0
    ds_write_b128 v236, v[64:67] offset:0
    ds_write_b128 v236, v[68:71] offset:1024
    ds_write_b128 v236, v[104:107] offset:2048
    ds_write_b128 v236, v[108:111] offset:3072
    s_mov_b32 exec_lo, 0x00010001
    s_mov_b32 exec_hi, 0x00010001
    ds_write_b128 v237, v[112:115]
    ds_write_b128 v237, v[32:35] offset:128
    ds_write_b128 v237, v[36:39] offset:192
    s_mov_b64 exec, -1
    s_waitcnt lgkmcnt(0)
    s_barrier
    ds_read_b128 v[116:119], v237 offset:0
    ds_read_b128 v[120:123], v237 offset:64
    ds_read_b128 v[124:127], v237 offset:128
    ds_read_b128 v[128:131], v237 offset:192
    ds_read2_b32 v[136:137], v239 offset0:32 offset1:32
    ds_read2_b32 v[138:139], v239 offset0:33 offset1:33
    ds_read2_b32 v[140:141], v239 offset0:64 offset1:64
    ds_read2_b32 v[142:143], v239 offset0:65 offset1:65
    ds_read2_b32 v[144:145], v239 offset0:96 offset1:96
    ds_read2_b32 v[146:147], v239 offset0:97 offset1:97
    ds_read2_b32 v[148:149], v239 offset0:128 offset1:128
    ds_read2_b32 v[150:151], v239 offset0:129 offset1:129
    ds_read2_b32 v[132:133], v239 offset0:0 offset1:0
    ds_read2_b32 v[134:135], v239 offset0:1 offset1:1
    s_waitcnt lgkmcnt(2)
    ds_read_b128 v[72:75], v236 offset:4096
    ds_read_b128 v[76:79], v236 offset:5120
    s_branch g1c_epi
g1c_r1:
    s_barrier
    ds_read_b128 v[116:119], v206 offset:0
    ds_read_b64_tr_b16 v[164:165], v209 offset:13440
    ds_read_b64_tr_b16 v[166:167], v209 offset:13952
    ds_read_b128 v[120:123], v206 offset:10240
    ds_read_b64_tr_b16 v[168:169], v209 offset:13472
    ds_read_b64_tr_b16 v[170:171], v209 offset:13984
    ds_read_b128 v[124:127], v206 offset:12288
    ds_read_b64_tr_b16 v[172:173], v209 offset:14464
    ds_read_b64_tr_b16 v[174:175], v209 offset:14976
    ds_read_b128 v[128:131], v206 offset:14336
    ds_read_b64_tr_b16 v[176:177], v209 offset:14496
    ds_read_b64_tr_b16 v[178:179], v209 offset:15008
    ds_read_b128 v[132:135], v206 offset:16384
    ds_read_b64_tr_b16 v[156:157], v209 offset:12416
    ds_read_b64_tr_b16 v[158:159], v209 offset:12928
    ds_read_b64_tr_b16 v[160:161], v209 offset:12448
    ds_read_b64_tr_b16 v[162:163], v209 offset:12960
    s_add_u32 s16, s16, 24832
    s_cmp_eq_u32 s16, 74496
    s_cselect_b32 s16, 0, s16
    v_add_u32 v209, s16, v208
    s_waitcnt lgkmcnt(0)
g1c_loop1:
    s_barrier
    v_mfma_f32_16x16x32_bf16 v[112:115], v[160:163], v[116:119], v[112:115]
    ds_read_b128 v[136:139], v207 offset:0
    v_mfma_f32_16x16x32_bf16 v[72:75], v[116:119], v[172:175], v[72:75]
    ds_read_b64_tr_b16 v[188:189], v209 offset:1024
    v_mfma_f32_16x16x32_bf16 v[76:79], v[116:119], v[176:179], v[76:79]
    ds_read_b64_tr_b16 v[190:191], v209 offset:1536
    v_mfma_f32_16x16x32_bf16 v[40:43], v[164:167], v[120:123], v[40:43]
    ds_read_b128 v[140:143], v207 offset:10240
    v_mfma_f32_16x16x32_bf16 v[48:51], v[164:167], v[124:127], v[48:51]
    ds_read_b64_tr_b16 v[192:193], v209 offset:1056
    v_mfma_f32_16x16x32_bf16 v[56:59], v[164:167], v[128:131], v[56:59]
    ds_read_b64_tr_b16 v[194:195], v209 offset:1568
    v_mfma_f32_16x16x32_bf16 v[64:67], v[164:167], v[132:135], v[64:67]
    ds_read_b128 v[144:147], v207 offset:12288
    v_mfma_f32_16x16x32_bf16 v[44:47], v[168:171], v[120:123], v[44:47]
    ds_read_b64_tr_b16 v[196:197], v209 offset:2048
    v_mfma_f32_16x16x32_bf16 v[52:55], v[168:171], v[124:127], v[52:55]
    ds_read_b64_tr_b16 v[198:199], v209 offset:2560
    v_mfma_f32_16x16x32_bf16 v[60:63], v[168:171], v[128:131], v[60:63]
    ds_read_b128 v[148:151], v207 offset:14336
    v_mfma_f32_16x16x32_bf16 v[68:71], v[168:171], v[132:135], v[68:71]
    ds_read_b64_tr_b16 v[200:201], v209 offset:2080
    v_mfma_f32_16x16x32_bf16 v[80:83], v[120:123], v[172:175], v[80:83]
    ds_read_b64_tr_b16 v[202:203], v209 offset:2592
    v_mfma_f32_16x16x32_bf16 v[88:91], v[124:127], v[172:175], v[88:91]
    ds_read_b128 v[152:155], v207 offset:16384
    v_mfma_f32_16x16x32_bf16 v[96:99], v[128:131], v[172:175], v[96:99]
    ds_read_b64_tr_b16 v[180:181], v209 offset:0
    v_mfma_f32_16x16x32_bf16 v[104:107], v[132:135], v[172:175], v[104:107]
    ds_read_b64_tr_b16 v[182:183], v209 offset:512
    v_mfma_f32_16x16x32_bf16 v[84:87], v[120:123], v[176:179], v[84:87]
    ds_read_b64_tr_b16 v[184:185], v209 offset:32
    v_mfma_f32_16x16x32_bf16 v[92:95], v[124:127], v[176:179], v[92:95]
    ds_read_b64_tr_b16 v[186:187], v209 offset:544
    v_mfma_f32_16x16x32_bf16 v[100:103], v[128:131], v[176:179], v[100:103]
    v_mfma_f32_16x16x32_bf16 v[108:111], v[132:135], v[176:179], v[108:111]
    s_add_u32 s17, s17, 18432
    s_cmp_eq_u32 s17, 73728
    v_mfma_f32_16x16x32_bf16 v[0:3], v[156:159], v[120:123], v[0:3]
    v_mfma_f32_16x16x32_bf16 v[8:11], v[156:159], v[124:127], v[8:11]
    s_cselect_b32 s17, 0, s17
    v_mfma_f32_16x16x32_bf16 v[16:19], v[156:159], v[128:131], v[16:19]
    v_mfma_f32_16x16x32_bf16 v[24:27], v[156:159], v[132:135], v[24:27]
    v_add_u32 v206, s17, v204
    v_mfma_f32_16x16x32_bf16 v[4:7], v[160:163], v[120:123], v[4:7]
    v_mfma_f32_16x16x32_bf16 v[12:15], v[160:163], v[124:127], v[12:15]
    v_add_u32 v207, s17, v205
    v_mfma_f32_16x16x32_bf16 v[20:23], v[160:163], v[128:131], v[20:23]
    v_mfma_f32_16x16x32_bf16 v[28:31], v[160:163], v[132:135], v[28:31]
    s_waitcnt lgkmcnt(0)
    v_mfma_f32_16x16x32_bf16 v[112:115], v[184:187], v[136:139], v[112:115]
    ds_read_b128 v[116:119], v206 offset:0
    v_mfma_f32_16x16x32_bf16 v[72:75], v[136:139], v[196:199], v[72:75]
    ds_read_b64_tr_b16 v[164:165], v209 offset:13440
    v_mfma_f32_16x16x32_bf16 v[76:79], v[136:139], v[200:203], v[76:79]
    ds_read_b64_tr_b16 v[166:167], v209 offset:13952
    v_mfma_f32_16x16x32_bf16 v[40:43], v[188:191], v[140:143], v[40:43]
    ds_read_b128 v[120:123], v206 offset:10240
    v_mfma_f32_16x16x32_bf16 v[48:51], v[188:191], v[144:147], v[48:51]
    ds_read_b64_tr_b16 v[168:169], v209 offset:13472
    v_mfma_f32_16x16x32_bf16 v[56:59], v[188:191], v[148:151], v[56:59]
    ds_read_b64_tr_b16 v[170:171], v209 offset:13984
    v_mfma_f32_16x16x32_bf16 v[64:67], v[188:191], v[152:155], v[64:67]
    ds_read_b128 v[124:127], v206 offset:12288
    v_mfma_f32_16x16x32_bf16 v[44:47], v[192:195], v[140:143], v[44:47]
    ds_read_b64_tr_b16 v[172:173], v209 offset:14464
    v_mfma_f32_16x16x32_bf16 v[52:55], v[192:195], v[144:147], v[52:55]
    ds_read_b64_tr_b16 v[174:175], v209 offset:14976
    v_mfma_f32_16x16x32_bf16 v[60:63], v[192:195], v[148:151], v[60:63]
    ds_read_b128 v[128:131], v206 offset:14336
    v_mfma_f32_16x16x32_bf16 v[68:71], v[192:195], v[152:155], v[68:71]
    ds_read_b64_tr_b16 v[176:177], v209 offset:14496
    v_mfma_f32_16x16x32_bf16 v[80:83], v[140:143], v[196:199], v[80:83]
    ds_read_b64_tr_b16 v[178:179], v209 offset:15008
    v_mfma_f32_16x16x32_bf16 v[88:91], v[144:147], v[196:199], v[88:91]
    ds_read_b128 v[132:135], v206 offset:16384
    v_mfma_f32_16x16x32_bf16 v[96:99], v[148:151], v[196:199], v[96:99]
    ds_read_b64_tr_b16 v[156:157], v209 offset:12416
    v_mfma_f32_16x16x32_bf16 v[104:107], v[152:155], v[196:199], v[104:107]
    ds_read_b64_tr_b16 v[158:159], v209 offset:12928
    v_mfma_f32_16x16x32_bf16 v[84:87], v[140:143], v[200:203], v[84:87]
    ds_read_b64_tr_b16 v[160:161], v209 offset:12448
    v_mfma_f32_16x16x32_bf16 v[92:95], v[144:147], v[200:203], v[92:95]
    ds_read_b64_tr_b16 v[162:163], v209 offset:12960
    v_mfma_f32_16x16x32_bf16 v[100:103], v[148:151], v[200:203], v[100:103]
    v_mfma_f32_16x16x32_bf16 v[108:111], v[152:155], v[200:203], v[108:111]
    s_add_u32 s16, s16, 24832
    s_cmp_eq_u32 s16, 74496
    v_mfma_f32_16x16x32_bf16 v[0:3], v[180:183], v[140:143], v[0:3]
    v_mfma_f32_16x16x32_bf16 v[8:11], v[180:183], v[144:147], v[8:11]
    s_cselect_b32 s16, 0, s16
    v_mfma_f32_16x16x32_bf16 v[16:19], v[180:183], v[148:151], v[16:19]
    v_mfma_f32_16x16x32_bf16 v[24:27], v[180:183], v[152:155], v[24:27]
    v_add_u32 v209, s16, v208
    v_mfma_f32_16x16x32_bf16 v[4:7], v[184:187], v[140:143], v[4:7]
    v_mfma_f32_16x16x32_bf16 v[12:15], v[184:187], v[144:147], v[12:15]
    s_sub_u32 s18, s18, 1
    s_cmp_lg_u32 s18, 0
    v_mfma_f32_16x16x32_bf16 v[20:23], v[184:187], v[148:151], v[20:23]
    v_mfma_f32_16x16x32_bf16 v[28:31], v[184:187], v[152:155], v[28:31]
    s_waitcnt vmcnt(0) lgkmcnt(0)
    s_cbranch_scc1 g1c_loop1
    ds_write_b128 v236, v[72:75] offset:4096
    ds_write_b128 v236, v[76:79] offset:5120
    s_mov_b32 exec_lo, 0x00010001
    s_mov_b32 exec_hi, 0x00010001
    ds_write_b128 v237, v[112:115] offset:64
    s_mov_b64 exec, 0xffff
    ds_write_b32 v238, v72 offset:256
    ds_write_b32 v238, v76 offset:320
    s_mov_b64 exec, -1
    s_waitcnt lgkmcnt(0)
    s_barrier
    ds_read_b128 v[116:119], v237 offset:0
    ds_read_b128 v[120:123], v237 offset:64
    ds_read_b128 v[124:127], v237 offset:128
    ds_read_b128 v[128:131], v237 offset:192
    ds_read2_b32 v[136:137], v239 offset0:32 offset1:32
    ds_read2_b32 v[138:139], v239 offset0:33 offset1:33
    ds_read2_b32 v[140:141], v239 offset0:64 offset1:64
    ds_read2_b32 v[142:143], v239 offset0:65 offset1:65
    ds_read2_b32 v[144:145], v239 offset0:96 offset1:96
    ds_read2_b32 v[146:147], v239 offset0:97 offset1:97
    ds_read2_b32 v[148:149], v239 offset0:128 offset1:128
    ds_read2_b32 v[150:151], v239 offset0:129 offset1:129
    ds_read2_b32 v[132:133], v239 offset0:0 offset1:0
    ds_read2_b32 v[134:135], v239 offset0:1 offset1:1
    s_waitcnt lgkmcnt(2)
    ds_read_b128 v[32:35], v236 offset:0
    ds_read_b128 v[36:39], v236 offset:1024
    ds_read_b128 v[72:75], v236 offset:2048
    ds_read_b128 v[76:79], v236 offset:3072
g1c_epi:
    ds_read_b32 v241, v241
    ds_read2_b32 v[196:197], v238 offset0:64 offset1:64
    ds_read2_b32 v[198:199], v238 offset0:80 offset1:80
    v_pk_fma_f32 v[0:1], v[136:137], v[116:117], v[0:1] neg_lo:[1,0,0] neg_hi:[1,0,0]
    v_pk_fma_f32 v[2:3], v[136:137], v[118:119], v[2:3] neg_lo:[1,0,0] neg_hi:[1,0,0]
    v_pk_fma_f32 v[4:5], v[136:137], v[120:121], v[4:5] neg_lo:[1,0,0] neg_hi:[1,0,0]
    v_pk_fma_f32 v[6:7], v[136:137], v[122:123], v[6:7] neg_lo:[1,0,0] neg_hi:[1,0,0]
    v_cvt_pk_bf16_f32 v0, v0, v1
    v_cvt_pk_bf16_f32 v1, v2, v3
    v_cvt_pk_bf16_f32 v2, v4, v5
    v_cvt_pk_bf16_f32 v3, v6, v7
    v_mul_f32 v200, s23, v138
    ds_read2_b32 v[164:165], v240 offset0:32 offset1:34
    ds_read2_b32 v[166:167], v240 offset0:36 offset1:38
    ds_read2_b32 v[168:169], v240 offset0:33 offset1:35
    ds_read2_b32 v[170:171], v240 offset0:37 offset1:39
    v_pk_fma_f32 v[40:41], v[136:137], v[124:125], v[40:41] neg_lo:[1,0,0] neg_hi:[1,0,0]
    v_pk_fma_f32 v[42:43], v[136:137], v[126:127], v[42:43] neg_lo:[1,0,0] neg_hi:[1,0,0]
    v_pk_fma_f32 v[44:45], v[136:137], v[128:129], v[44:45] neg_lo:[1,0,0] neg_hi:[1,0,0]
    v_pk_fma_f32 v[46:47], v[136:137], v[130:131], v[46:47] neg_lo:[1,0,0] neg_hi:[1,0,0]
    v_pk_mul_f32 v[40:41], v[138:139], v[40:41]
    v_pk_mul_f32 v[42:43], v[138:139], v[42:43]
    v_pk_mul_f32 v[44:45], v[138:139], v[44:45]
    v_pk_mul_f32 v[46:47], v[138:139], v[46:47]
    v_cvt_pk_bf16_f32 v40, v40, v41
    v_cvt_pk_bf16_f32 v41, v42, v43
    v_cvt_pk_bf16_f32 v42, v44, v45
    v_cvt_pk_bf16_f32 v43, v46, v47
    v_pk_fma_f32 v[8:9], v[140:141], v[116:117], v[8:9] neg_lo:[1,0,0] neg_hi:[1,0,0]
    v_pk_fma_f32 v[10:11], v[140:141], v[118:119], v[10:11] neg_lo:[1,0,0] neg_hi:[1,0,0]
    v_pk_fma_f32 v[12:13], v[140:141], v[120:121], v[12:13] neg_lo:[1,0,0] neg_hi:[1,0,0]
    v_pk_fma_f32 v[14:15], v[140:141], v[122:123], v[14:15] neg_lo:[1,0,0] neg_hi:[1,0,0]
    v_cvt_pk_bf16_f32 v8, v8, v9
    v_cvt_pk_bf16_f32 v9, v10, v11
    v_cvt_pk_bf16_f32 v10, v12, v13
    v_cvt_pk_bf16_f32 v11, v14, v15
    v_mul_f32 v201, s23, v142
    ds_read2_b32 v[172:173], v240 offset0:64 offset1:66
    ds_read2_b32 v[174:175], v240 offset0:68 offset1:70
    ds_read2_b32 v[176:177], v240 offset0:65 offset1:67
    ds_read2_b32 v[178:179], v240 offset0:69 offset1:71
    v_pk_fma_f32 v[48:49], v[140:141], v[124:125], v[48:49] neg_lo:[1,0,0] neg_hi:[1,0,0]
    v_pk_fma_f32 v[50:51], v[140:141], v[126:127], v[50:51] neg_lo:[1,0,0] neg_hi:[1,0,0]
    v_pk_fma_f32 v[52:53], v[140:141], v[128:129], v[52:53] neg_lo:[1,0,0] neg_hi:[1,0,0]
    v_pk_fma_f32 v[54:55], v[140:141], v[130:131], v[54:55] neg_lo:[1,0,0] neg_hi:[1,0,0]
    v_pk_mul_f32 v[48:49], v[142:143], v[48:49]
    v_pk_mul_f32 v[50:51], v[142:143], v[50:51]
    v_pk_mul_f32 v[52:53], v[142:143], v[52:53]
    v_pk_mul_f32 v[54:55], v[142:143], v[54:55]
    v_cvt_pk_bf16_f32 v48, v48, v49
    v_cvt_pk_bf16_f32 v49, v50, v51
    v_cvt_pk_bf16_f32 v50, v52, v53
    v_cvt_pk_bf16_f32 v51, v54, v55
    s_waitcnt lgkmcnt(4)
    v_pk_fma_f32 v[16:17], v[144:145], v[116:117], v[16:17] neg_lo:[1,0,0] neg_hi:[1,0,0]
    v_pk_fma_f32 v[18:19], v[144:145], v[118:119], v[18:19] neg_lo:[1,0,0] neg_hi:[1,0,0]
    v_pk_fma_f32 v[20:21], v[144:145], v[120:121], v[20:21] neg_lo:[1,0,0] neg_hi:[1,0,0]
    v_pk_fma_f32 v[22:23], v[144:145], v[122:123], v[22:23] neg_lo:[1,0,0] neg_hi:[1,0,0]
    v_cvt_pk_bf16_f32 v16, v16, v17
    v_cvt_pk_bf16_f32 v17, v18, v19
    v_cvt_pk_bf16_f32 v18, v20, v21
    v_cvt_pk_bf16_f32 v19, v22, v23
    v_mul_f32 v202, s23, v146
    ds_read2_b32 v[180:181], v240 offset0:96 offset1:98
    ds_read2_b32 v[182:183], v240 offset0:100 offset1:102
    ds_read2_b32 v[184:185], v240 offset0:97 offset1:99
    ds_read2_b32 v[186:187], v240 offset0:101 offset1:103
    v_pk_fma_f32 v[56:57], v[144:145], v[124:125], v[56:57] neg_lo:[1,0,0] neg_hi:[1,0,0]
    v_pk_fma_f32 v[58:59], v[144:145], v[126:127], v[58:59] neg_lo:[1,0,0] neg_hi:[1,0,0]
    v_pk_fma_f32 v[60:61], v[144:145], v[128:129], v[60:61] neg_lo:[1,0,0] neg_hi:[1,0,0]
    v_pk_fma_f32 v[62:63], v[144:145], v[130:131], v[62:63] neg_lo:[1,0,0] neg_hi:[1,0,0]
    v_pk_mul_f32 v[56:57], v[146:147], v[56:57]
    v_pk_mul_f32 v[58:59], v[146:147], v[58:59]
    v_pk_mul_f32 v[60:61], v[146:147], v[60:61]
    v_pk_mul_f32 v[62:63], v[146:147], v[62:63]
    v_cvt_pk_bf16_f32 v56, v56, v57
    v_cvt_pk_bf16_f32 v57, v58, v59
    v_cvt_pk_bf16_f32 v58, v60, v61
    v_cvt_pk_bf16_f32 v59, v62, v63
    v_pk_fma_f32 v[24:25], v[148:149], v[116:117], v[24:25] neg_lo:[1,0,0] neg_hi:[1,0,0]
    v_pk_fma_f32 v[26:27], v[148:149], v[118:119], v[26:27] neg_lo:[1,0,0] neg_hi:[1,0,0]
    v_pk_fma_f32 v[28:29], v[148:149], v[120:121], v[28:29] neg_lo:[1,0,0] neg_hi:[1,0,0]
    v_pk_fma_f32 v[30:31], v[148:149], v[122:123], v[30:31] neg_lo:[1,0,0] neg_hi:[1,0,0]
    v_cvt_pk_bf16_f32 v24, v24, v25
    v_cvt_pk_bf16_f32 v25, v26, v27
    v_cvt_pk_bf16_f32 v26, v28, v29
    v_cvt_pk_bf16_f32 v27, v30, v31
    v_mul_f32 v203, s23, v150
    ds_read2_b32 v[188:189], v240 offset0:128 offset1:130
    ds_read2_b32 v[190:191], v240 offset0:132 offset1:134
    ds_read2_b32 v[192:193], v240 offset0:129 offset1:131
    ds_read2_b32 v[194:195], v240 offset0:133 offset1:135
    v_pk_fma_f32 v[64:65], v[148:149], v[124:125], v[64:65] neg_lo:[1,0,0] neg_hi:[1,0,0]
    v_pk_fma_f32 v[66:67], v[148:149], v[126:127], v[66:67] neg_lo:[1,0,0] neg_hi:[1,0,0]
    v_pk_fma_f32 v[68:69], v[148:149], v[128:129], v[68:69] neg_lo:[1,0,0] neg_hi:[1,0,0]
    v_pk_fma_f32 v[70:71], v[148:149], v[130:131], v[70:71] neg_lo:[1,0,0] neg_hi:[1,0,0]
    v_pk_mul_f32 v[64:65], v[150:151], v[64:65]
    v_pk_mul_f32 v[66:67], v[150:151], v[66:67]
    v_pk_mul_f32 v[68:69], v[150:151], v[68:69]
    v_pk_mul_f32 v[70:71], v[150:151], v[70:71]
    v_cvt_pk_bf16_f32 v64, v64, v65
    v_cvt_pk_bf16_f32 v65, v66, v67
    v_cvt_pk_bf16_f32 v66, v68, v69
    v_cvt_pk_bf16_f32 v67, v70, v71
    ds_read2_b32 v[156:157], v240 offset0:0 offset1:2
    ds_read2_b32 v[158:159], v240 offset0:4 offset1:6
    ds_read2_b32 v[160:161], v240 offset0:1 offset1:3
    ds_read2_b32 v[162:163], v240 offset0:5 offset1:7
    s_waitcnt lgkmcnt(4)
    v_pk_fma_f32 v[32:33], v[132:133], v[124:125], v[32:33] neg_lo:[1,0,0] neg_hi:[1,0,0]
    v_pk_fma_f32 v[34:35], v[132:133], v[126:127], v[34:35] neg_lo:[1,0,0] neg_hi:[1,0,0]
    v_pk_fma_f32 v[36:37], v[132:133], v[128:129], v[36:37] neg_lo:[1,0,0] neg_hi:[1,0,0]
    v_pk_fma_f32 v[38:39], v[132:133], v[130:131], v[38:39] neg_lo:[1,0,0] neg_hi:[1,0,0]
    v_pk_mul_f32 v[32:33], v[134:135], v[32:33]
    v_pk_mul_f32 v[34:35], v[134:135], v[34:35]
    v_pk_mul_f32 v[36:37], v[134:135], v[36:37]
    v_pk_mul_f32 v[38:39], v[134:135], v[38:39]
    v_cvt_pk_bf16_f32 v32, v32, v33
    v_cvt_pk_bf16_f32 v33, v34, v35
    v_cvt_pk_bf16_f32 v34, v36, v37
    v_cvt_pk_bf16_f32 v35, v38, v39
    v_readfirstlane_b32 s78, v241
    s_mov_b32 s59, s78
    s_mul_i32 s60, s59, s75
    v_mfma_f32_16x16x32_bf16 v[116:119], v[40:43], v[0:3], 0
    v_mfma_f32_16x16x32_bf16 v[120:123], v[32:35], v[0:3], 0
    v_mfma_f32_16x16x32_bf16 v[124:127], v[48:51], v[8:11], 0
    v_mfma_f32_16x16x32_bf16 v[128:131], v[40:43], v[8:11], 0
    v_mfma_f32_16x16x32_bf16 v[132:135], v[56:59], v[16:19], 0
    v_mfma_f32_16x16x32_bf16 v[136:139], v[48:51], v[16:19], 0
    v_mfma_f32_16x16x32_bf16 v[140:143], v[64:67], v[24:27], 0
    v_mfma_f32_16x16x32_bf16 v[144:147], v[56:59], v[24:27], 0
    v_pk_fma_f32 v[80:81], v[164:165], v[196:197], v[80:81] neg_lo:[1,0,0] neg_hi:[1,0,0]
    v_pk_fma_f32 v[82:83], v[166:167], v[196:197], v[82:83] neg_lo:[1,0,0] neg_hi:[1,0,0]
    v_pk_mul_f32 v[80:81], v[168:169], v[80:81]
    v_pk_mul_f32 v[82:83], v[170:171], v[82:83]
    v_cvt_pk_bf16_f32 v214, v80, v81
    v_cvt_pk_bf16_f32 v215, v82, v83
    v_pk_fma_f32 v[84:85], v[164:165], v[198:199], v[84:85] neg_lo:[1,0,0] neg_hi:[1,0,0]
    v_pk_fma_f32 v[86:87], v[166:167], v[198:199], v[86:87] neg_lo:[1,0,0] neg_hi:[1,0,0]
    v_pk_mul_f32 v[84:85], v[168:169], v[84:85]
    v_pk_mul_f32 v[86:87], v[170:171], v[86:87]
    v_cvt_pk_bf16_f32 v224, v84, v85
    v_cvt_pk_bf16_f32 v225, v86, v87
    v_pk_fma_f32 v[88:89], v[172:173], v[196:197], v[88:89] neg_lo:[1,0,0] neg_hi:[1,0,0]
    v_pk_fma_f32 v[90:91], v[174:175], v[196:197], v[90:91] neg_lo:[1,0,0] neg_hi:[1,0,0]
    v_pk_mul_f32 v[88:89], v[176:177], v[88:89]
    v_pk_mul_f32 v[90:91], v[178:179], v[90:91]
    v_cvt_pk_bf16_f32 v216, v88, v89
    v_cvt_pk_bf16_f32 v217, v90, v91
    v_pk_fma_f32 v[92:93], v[172:173], v[198:199], v[92:93] neg_lo:[1,0,0] neg_hi:[1,0,0]
    v_pk_fma_f32 v[94:95], v[174:175], v[198:199], v[94:95] neg_lo:[1,0,0] neg_hi:[1,0,0]
    v_pk_mul_f32 v[92:93], v[176:177], v[92:93]
    v_pk_mul_f32 v[94:95], v[178:179], v[94:95]
    v_cvt_pk_bf16_f32 v226, v92, v93
    v_cvt_pk_bf16_f32 v227, v94, v95
    v_pk_fma_f32 v[96:97], v[180:181], v[196:197], v[96:97] neg_lo:[1,0,0] neg_hi:[1,0,0]
    v_pk_fma_f32 v[98:99], v[182:183], v[196:197], v[98:99] neg_lo:[1,0,0] neg_hi:[1,0,0]
    v_pk_mul_f32 v[96:97], v[184:185], v[96:97]
    v_pk_mul_f32 v[98:99], v[186:187], v[98:99]
    v_cvt_pk_bf16_f32 v218, v96, v97
    v_cvt_pk_bf16_f32 v219, v98, v99
    v_pk_fma_f32 v[100:101], v[180:181], v[198:199], v[100:101] neg_lo:[1,0,0] neg_hi:[1,0,0]
    v_pk_fma_f32 v[102:103], v[182:183], v[198:199], v[102:103] neg_lo:[1,0,0] neg_hi:[1,0,0]
    v_pk_mul_f32 v[100:101], v[184:185], v[100:101]
    v_pk_mul_f32 v[102:103], v[186:187], v[102:103]
    v_cvt_pk_bf16_f32 v228, v100, v101
    v_cvt_pk_bf16_f32 v229, v102, v103
    v_pk_fma_f32 v[104:105], v[188:189], v[196:197], v[104:105] neg_lo:[1,0,0] neg_hi:[1,0,0]
    v_pk_fma_f32 v[106:107], v[190:191], v[196:197], v[106:107] neg_lo:[1,0,0] neg_hi:[1,0,0]
    v_pk_mul_f32 v[104:105], v[192:193], v[104:105]
    v_pk_mul_f32 v[106:107], v[194:195], v[106:107]
    v_cvt_pk_bf16_f32 v220, v104, v105
    v_cvt_pk_bf16_f32 v221, v106, v107
    v_pk_fma_f32 v[108:109], v[188:189], v[198:199], v[108:109] neg_lo:[1,0,0] neg_hi:[1,0,0]
    v_pk_fma_f32 v[110:111], v[190:191], v[198:199], v[110:111] neg_lo:[1,0,0] neg_hi:[1,0,0]
    v_pk_mul_f32 v[108:109], v[192:193], v[108:109]
    v_pk_mul_f32 v[110:111], v[194:195], v[110:111]
    v_cvt_pk_bf16_f32 v230, v108, v109
    v_cvt_pk_bf16_f32 v231, v110, v111
    s_waitcnt lgkmcnt(0)
    v_pk_fma_f32 v[72:73], v[156:157], v[196:197], v[72:73] neg_lo:[1,0,0] neg_hi:[1,0,0]
    v_pk_fma_f32 v[74:75], v[158:159], v[196:197], v[74:75] neg_lo:[1,0,0] neg_hi:[1,0,0]
    v_pk_mul_f32 v[72:73], v[160:161], v[72:73]
    v_pk_mul_f32 v[74:75], v[162:163], v[74:75]
    v_cvt_pk_bf16_f32 v212, v72, v73
    v_cvt_pk_bf16_f32 v213, v74, v75
    v_pk_fma_f32 v[76:77], v[156:157], v[198:199], v[76:77] neg_lo:[1,0,0] neg_hi:[1,0,0]
    v_pk_fma_f32 v[78:79], v[158:159], v[198:199], v[78:79] neg_lo:[1,0,0] neg_hi:[1,0,0]
    v_pk_mul_f32 v[76:77], v[160:161], v[76:77]
    v_pk_mul_f32 v[78:79], v[162:163], v[78:79]
    v_cvt_pk_bf16_f32 v222, v76, v77
    v_cvt_pk_bf16_f32 v223, v78, v79
    s_mov_b64 vcc, s[28:29]
    v_mov_b32 v4, 0xf149f2ca
    v_cndmask_b32 v116, v116, v117, vcc
    v_cndmask_b32 v120, v120, v121, vcc
    v_cndmask_b32 v118, v118, v119, vcc
    v_cndmask_b32 v122, v122, v123, vcc
    v_cndmask_b32 v148, v120, v116, s[30:31]
    v_cndmask_b32 v149, v122, v118, s[32:33]
    v_cndmask_b32 v124, v124, v125, vcc
    v_cndmask_b32 v128, v128, v129, vcc
    v_cndmask_b32 v126, v126, v127, vcc
    v_cndmask_b32 v130, v130, v131, vcc
    v_cndmask_b32 v150, v128, v124, s[30:31]
    v_cndmask_b32 v151, v130, v126, s[32:33]
    v_cndmask_b32 v132, v132, v133, vcc
    v_cndmask_b32 v136, v136, v137, vcc
    v_cndmask_b32 v134, v134, v135, vcc
    v_cndmask_b32 v138, v138, v139, vcc
    v_cndmask_b32 v152, v136, v132, s[30:31]
    v_cndmask_b32 v153, v138, v134, s[32:33]
    v_cndmask_b32 v140, v140, v141, vcc
    v_cndmask_b32 v144, v144, v145, vcc
    v_cndmask_b32 v142, v142, v143, vcc
    v_cndmask_b32 v146, v146, v147, vcc
    v_cndmask_b32 v154, v144, v140, s[30:31]
    v_cndmask_b32 v155, v146, v142, s[32:33]
    v_cndmask_b32 v148, v4, v148, s[34:35]
    v_cndmask_b32 v149, v4, v149, s[36:37]
    v_max_f32 v0, v148, v149
    v_max_f32 v1, v150, v151
    v_max_f32 v2, v152, v153
    v_max_f32 v3, v154, v155
    s_nop 0
    v_permlane16_swap_b32 v0, v1
    v_permlane16_swap_b32 v2, v3
    v_max_f32 v0, v0, v1
    v_max_f32 v2, v2, v3
    s_nop 1
    v_permlane32_swap_b32 v0, v2
    v_max_f32 v0, v0, v2
    v_mov_b32 v2, v0
    s_nop 1
    v_permlane32_swap_b32 v0, v2
    v_mov_b32 v1, v0
    v_mov_b32 v3, v2
    s_nop 0
    v_permlane16_swap_b32 v0, v1
    v_permlane16_swap_b32 v2, v3
    v_sub_f32 v148, v148, v0
    v_sub_f32 v149, v149, v0
    v_sub_f32 v150, v150, v1
    v_sub_f32 v151, v151, v1
    v_sub_f32 v152, v152, v2
    v_sub_f32 v153, v153, v2
    v_sub_f32 v154, v154, v3
    v_sub_f32 v155, v155, v3
    v_mul_f32 v148, v200, v148
    v_mul_f32 v149, v200, v149
    v_mul_f32 v150, v201, v150
    v_mul_f32 v151, v201, v151
    v_mul_f32 v152, v202, v152
    v_mul_f32 v153, v202, v153
    v_mul_f32 v154, v203, v154
    v_mul_f32 v155, v203, v155
    v_exp_f32 v148, v148
    v_exp_f32 v149, v149
    v_exp_f32 v150, v150
    v_exp_f32 v151, v151
    v_exp_f32 v152, v152
    v_exp_f32 v153, v153
    v_exp_f32 v154, v154
    v_exp_f32 v155, v155
    v_add_f32 v0, v148, v149
    v_add_f32 v1, v150, v151
    v_add_f32 v2, v152, v153
    v_add_f32 v3, v154, v155
    s_nop 0
    v_permlane16_swap_b32 v0, v1
    v_permlane16_swap_b32 v2, v3
    v_add_f32 v0, v0, v1
    v_add_f32 v2, v2, v3
    s_nop 1
    v_permlane32_swap_b32 v0, v2
    v_add_f32 v0, v0, v2
    v_rcp_f32 v0, v0
    s_nop 0
    v_mov_b32 v2, v0
    s_nop 1
    v_permlane32_swap_b32 v0, v2
    v_mov_b32 v1, v0
    v_mov_b32 v3, v2
    s_nop 0
    v_permlane16_swap_b32 v0, v1
    v_permlane16_swap_b32 v2, v3
    v_mul_f32 v148, v148, v0
    v_mul_f32 v149, v149, v0
    v_cvt_pk_bf16_f32 v148, v148, v148
    v_cvt_pk_bf16_f32 v149, v149, v149
    v_and_b32 v8, v148, v232
    v_and_b32 v9, v149, v233
    v_and_b32 v10, v148, v234
    v_and_b32 v11, v149, v235
    v_mul_f32 v150, v150, v1
    v_mul_f32 v151, v151, v1
    v_cvt_pk_bf16_f32 v150, v150, v150
    v_cvt_pk_bf16_f32 v151, v151, v151
    v_and_b32 v12, v150, v232
    v_and_b32 v13, v151, v233
    v_and_b32 v14, v150, v234
    v_and_b32 v15, v151, v235
    v_mfma_f32_16x16x32_bf16 v[24:27], v[212:215], v[8:11], 0
    v_mfma_f32_16x16x32_bf16 v[28:31], v[222:225], v[8:11], 0
    v_mul_f32 v152, v152, v2
    v_mul_f32 v153, v153, v2
    v_cvt_pk_bf16_f32 v152, v152, v152
    v_cvt_pk_bf16_f32 v153, v153, v153
    v_and_b32 v16, v152, v232
    v_and_b32 v17, v153, v233
    v_and_b32 v18, v152, v234
    v_and_b32 v19, v153, v235
    v_mfma_f32_16x16x32_bf16 v[32:35], v[214:217], v[12:15], 0
    v_mfma_f32_16x16x32_bf16 v[36:39], v[224:227], v[12:15], 0
    v_mul_f32 v154, v154, v3
    v_mul_f32 v155, v155, v3
    v_cvt_pk_bf16_f32 v154, v154, v154
    v_cvt_pk_bf16_f32 v155, v155, v155
    v_and_b32 v20, v154, v232
    v_and_b32 v21, v155, v233
    v_and_b32 v22, v154, v234
    v_and_b32 v23, v155, v235
    v_mfma_f32_16x16x32_bf16 v[40:43], v[216:219], v[16:19], 0
    v_mfma_f32_16x16x32_bf16 v[44:47], v[226:229], v[16:19], 0
    v_mfma_f32_16x16x32_bf16 v[48:51], v[218:221], v[20:23], 0
    v_mfma_f32_16x16x32_bf16 v[52:55], v[228:231], v[20:23], 0
    v_cvt_pk_bf16_f32 v56, v24, v25
    v_cvt_pk_bf16_f32 v57, v26, v27
    v_cvt_pk_bf16_f32 v58, v28, v29
    v_cvt_pk_bf16_f32 v59, v30, v31
    buffer_store_dwordx4 v[56:59], v249, s[80:83], s21 offen offset:0
    v_cvt_pk_bf16_f32 v60, v32, v33
    v_cvt_pk_bf16_f32 v61, v34, v35
    v_cvt_pk_bf16_f32 v62, v36, v37
    v_cvt_pk_bf16_f32 v63, v38, v39
    buffer_store_dwordx4 v[60:63], v249, s[80:83], s21 offen offset:1024
    v_cvt_pk_bf16_f32 v64, v40, v41
    v_cvt_pk_bf16_f32 v65, v42, v43
    v_cvt_pk_bf16_f32 v66, v44, v45
    v_cvt_pk_bf16_f32 v67, v46, v47
    buffer_store_dwordx4 v[64:67], v249, s[80:83], s21 offen offset:2048
    v_cvt_pk_bf16_f32 v68, v48, v49
    v_cvt_pk_bf16_f32 v69, v50, v51
    v_cvt_pk_bf16_f32 v70, v52, v53
    v_cvt_pk_bf16_f32 v71, v54, v55
    buffer_store_dwordx4 v[68:71], v249, s[80:83], s21 offen offset:3072
    s_lshl_b32 s64, s75, 15
    s_lshl_b32 s66, s73, 9
    s_add_u32 s64, s64, s66
    s_add_u32 s64, s64, 75497472
    s_lshl_b32 s65, s72, 5
    s_add_u32 s64, s64, s65
    s_lshl_b32 s65, s3, 2
    s_add_u32 s64, s64, s65
    v_mov_b32 v108, 0
    v_mov_b32 v109, 1
    s_cmp_lg_u32 s78, 0
    s_cbranch_scc1 sg_3_slow
    s_waitcnt vmcnt(0)
    s_mov_b64 exec, 1
    buffer_store_dword v109, v108, s[80:83], s64 offen
    s_mov_b64 exec, -1
sg_3_done:
    s_lshr_b32 s64, s3, 1
    s_lshl_b32 s64, s64, 12
    v_add_u32 v240, s64, v249
    v_lshrrev_b32 v253, 2, v252
    v_mul_u32_u24 v253, 1056, v253
    v_lshl_add_u32 v253, v251, 7, v253
    v_and_b32 v254, 3, v252
    v_lshl_add_u32 v253, v254, 3, v253
    s_and_b32 s64, s3, 1
    s_lshl_b32 s64, s64, 6
    s_add_u32 s64, s64, 65536
    v_add_u32 v241, s64, v253
    s_mov_b32 s16, 50688
    v_add_u32 v242, s16, v241
    s_and_b32 s64, s3, 1
    s_lshl_b32 s64, s64, 13
    s_lshr_b32 s65, s3, 1
    s_lshl_b32 s65, s65, 12
    s_add_u32 s17, s64, s65
    s_lshl_b32 s19, s73, 4
    s_add_u32 s19, s19, s72
    s_lshl_b32 s19, s19, 14
    s_mul_i32 s66, s60, 8388608
    s_add_u32 s19, s19, s66
    s_add_u32 s19, s19, s17
    v_add_u32 v239, s17, v249
    s_cmp_lg_u32 s75, 0
    s_cbranch_scc1 xo_4_f
    s_mov_b32 s8, s84
    s_mov_b32 s9, s85
    s_mov_b32 s10, 4194304
    s_mov_b32 s11, 0x00020000
    s_lshl_b32 s64, s73, 1
    s_lshr_b32 s65, s3, 1
    s_add_u32 s64, s64, s65
    s_lshl_b32 s64, s64, 17
    s_lshl_b32 s65, s72, 7
    s_add_u32 s64, s64, s65
    s_and_b32 s65, s3, 1
    s_lshl_b32 s65, s65, 6
    s_add_u32 s64, s64, s65
    v_lshlrev_b32 v243, 11, v252
    v_add_u32 v243, s64, v243
    v_lshl_add_u32 v243, v251, 3, v243
    s_mov_b32 s64, 0
    buffer_load_dwordx2 v[128:129], v243, s[8:11], s64 offen
    buffer_load_dwordx2 v[130:131], v243, s[8:11], s64 offen offset:32
    s_mov_b32 s64, 32768
    buffer_load_dwordx2 v[132:133], v243, s[8:11], s64 offen
    buffer_load_dwordx2 v[134:135], v243, s[8:11], s64 offen offset:32
    s_mov_b32 s64, 65536
    buffer_load_dwordx2 v[136:137], v243, s[8:11], s64 offen
    buffer_load_dwordx2 v[138:139], v243, s[8:11], s64 offen offset:32
    s_mov_b32 s64, 98304
    buffer_load_dwordx2 v[140:141], v243, s[8:11], s64 offen
    buffer_load_dwordx2 v[142:143], v243, s[8:11], s64 offen offset:32
    s_branch xo_4_d
xo_4_f:
    s_lshl_b32 s18, s73, 4
    s_add_u32 s18, s18, s72
    s_lshl_b32 s18, s18, 14
    s_mul_i32 s66, s59, 4194304
    s_add_u32 s18, s18, s66
    s_add_u32 s18, s18, s17
    buffer_load_dwordx4 v[128:131], v249, s[80:83], s18 offen offset:0 sc1
    buffer_load_dwordx4 v[132:135], v249, s[80:83], s18 offen offset:1024 sc1
    buffer_load_dwordx4 v[136:139], v249, s[80:83], s18 offen offset:2048 sc1
    buffer_load_dwordx4 v[140:143], v249, s[80:83], s18 offen offset:3072 sc1
xo_4_d:
    v_mov_b32 v208, 0
    v_mov_b32 v209, 0
    v_mov_b32 v210, 0
    v_mov_b32 v211, 0
    s_nop 1
    v_mfma_f32_32x32x16_bf16 v[0:15], v[208:211], v[208:211], 0
    v_mfma_f32_32x32x16_bf16 v[16:31], v[208:211], v[208:211], 0
    s_mov_b32 s17, 8
    s_waitcnt lgkmcnt(0)
    s_barrier
    ds_read_b128 v[32:35], v240 offset:0
    ds_read_b64_tr_b16 v[48:49], v242 offset:0
    ds_read_b64_tr_b16 v[50:51], v242 offset:512
    ds_read_b128 v[36:39], v240 offset:1024
    ds_read_b64_tr_b16 v[52:53], v242 offset:32
    ds_read_b64_tr_b16 v[54:55], v242 offset:544
    ds_read_b128 v[40:43], v240 offset:2048
    ds_read_b128 v[44:47], v240 offset:3072
    ds_read_b128 v[56:59], v240 offset:8192
    ds_read_b64_tr_b16 v[72:73], v242 offset:4224
    ds_read_b64_tr_b16 v[74:75], v242 offset:4736
    ds_read_b128 v[60:63], v240 offset:9216
    ds_read_b64_tr_b16 v[76:77], v242 offset:4256
    ds_read_b64_tr_b16 v[78:79], v242 offset:4768
    ds_read_b128 v[64:67], v240 offset:10240
    ds_read_b128 v[68:71], v240 offset:11264
    v_add_u16 v240, 0x4000, v240
    s_add_u32 s16, s16, 8448
    s_cmp_eq_u32 s16, 92928
    s_cselect_b32 s16, 0, s16
    v_add_u32 v242, s16, v241
    s_waitcnt lgkmcnt(0)
r1_loop:
    s_bitcmp1_b32 2, s17
    s_cbranch_scc1 r1_nb0
    s_barrier
r1_nb0:
    v_mfma_f32_16x16x32_bf16 v[0:3], v[48:51], v[32:35], v[0:3]
    ds_read_b128 v[80:83], v240 offset:0
    ds_read_b64_tr_b16 v[96:97], v242 offset:0
    v_mfma_f32_16x16x32_bf16 v[4:7], v[48:51], v[36:39], v[4:7]
    ds_read_b64_tr_b16 v[98:99], v242 offset:512
    v_mfma_f32_16x16x32_bf16 v[8:11], v[48:51], v[40:43], v[8:11]
    ds_read_b128 v[84:87], v240 offset:1024
    ds_read_b64_tr_b16 v[100:101], v242 offset:32
    v_mfma_f32_16x16x32_bf16 v[12:15], v[48:51], v[44:47], v[12:15]
    ds_read_b64_tr_b16 v[102:103], v242 offset:544
    v_mfma_f32_16x16x32_bf16 v[16:19], v[52:55], v[32:35], v[16:19]
    ds_read_b128 v[88:91], v240 offset:2048
    ds_read_b128 v[92:95], v240 offset:3072
    v_mfma_f32_16x16x32_bf16 v[20:23], v[52:55], v[36:39], v[20:23]
    ds_read_b128 v[104:107], v240 offset:8192
    v_mfma_f32_16x16x32_bf16 v[24:27], v[52:55], v[40:43], v[24:27]
    ds_read_b64_tr_b16 v[120:121], v242 offset:4224
    ds_read_b64_tr_b16 v[122:123], v242 offset:4736
    v_mfma_f32_16x16x32_bf16 v[28:31], v[52:55], v[44:47], v[28:31]
    ds_read_b128 v[108:111], v240 offset:9216
    v_mfma_f32_16x16x32_bf16 v[0:3], v[72:75], v[56:59], v[0:3]
    ds_read_b64_tr_b16 v[124:125], v242 offset:4256
    ds_read_b64_tr_b16 v[126:127], v242 offset:4768
    v_mfma_f32_16x16x32_bf16 v[4:7], v[72:75], v[60:63], v[4:7]
    ds_read_b128 v[112:115], v240 offset:10240
    v_mfma_f32_16x16x32_bf16 v[8:11], v[72:75], v[64:67], v[8:11]
    ds_read_b128 v[116:119], v240 offset:11264
    v_mfma_f32_16x16x32_bf16 v[12:15], v[72:75], v[68:71], v[12:15]
    v_add_u16 v240, 0x4000, v240
    v_mfma_f32_16x16x32_bf16 v[16:19], v[76:79], v[56:59], v[16:19]
    s_add_u32 s16, s16, 8448
    s_cmp_eq_u32 s16, 92928
    v_mfma_f32_16x16x32_bf16 v[20:23], v[76:79], v[60:63], v[20:23]
    s_cselect_b32 s16, 0, s16
    v_mfma_f32_16x16x32_bf16 v[24:27], v[76:79], v[64:67], v[24:27]
    v_add_u32 v242, s16, v241
    v_mfma_f32_16x16x32_bf16 v[28:31], v[76:79], v[68:71], v[28:31]
    s_waitcnt lgkmcnt(0)
    s_bitcmp1_b32 2, s17
    s_cbranch_scc1 r1_nb1
    s_barrier
r1_nb1:
    v_mfma_f32_16x16x32_bf16 v[0:3], v[96:99], v[80:83], v[0:3]
    ds_read_b128 v[32:35], v240 offset:0
    ds_read_b64_tr_b16 v[48:49], v242 offset:0
    v_mfma_f32_16x16x32_bf16 v[4:7], v[96:99], v[84:87], v[4:7]
    ds_read_b64_tr_b16 v[50:51], v242 offset:512
    v_mfma_f32_16x16x32_bf16 v[8:11], v[96:99], v[88:91], v[8:11]
    ds_read_b128 v[36:39], v240 offset:1024
    ds_read_b64_tr_b16 v[52:53], v242 offset:32
    v_mfma_f32_16x16x32_bf16 v[12:15], v[96:99], v[92:95], v[12:15]
    ds_read_b64_tr_b16 v[54:55], v242 offset:544
    v_mfma_f32_16x16x32_bf16 v[16:19], v[100:103], v[80:83], v[16:19]
    ds_read_b128 v[40:43], v240 offset:2048
    ds_read_b128 v[44:47], v240 offset:3072
    v_mfma_f32_16x16x32_bf16 v[20:23], v[100:103], v[84:87], v[20:23]
    ds_read_b128 v[56:59], v240 offset:8192
    v_mfma_f32_16x16x32_bf16 v[24:27], v[100:103], v[88:91], v[24:27]
    ds_read_b64_tr_b16 v[72:73], v242 offset:4224
    ds_read_b64_tr_b16 v[74:75], v242 offset:4736
    v_mfma_f32_16x16x32_bf16 v[28:31], v[100:103], v[92:95], v[28:31]
    ds_read_b128 v[60:63], v240 offset:9216
    v_mfma_f32_16x16x32_bf16 v[0:3], v[120:123], v[104:107], v[0:3]
    ds_read_b64_tr_b16 v[76:77], v242 offset:4256
    ds_read_b64_tr_b16 v[78:79], v242 offset:4768
    v_mfma_f32_16x16x32_bf16 v[4:7], v[120:123], v[108:111], v[4:7]
    ds_read_b128 v[64:67], v240 offset:10240
    v_mfma_f32_16x16x32_bf16 v[8:11], v[120:123], v[112:115], v[8:11]
    ds_read_b128 v[68:71], v240 offset:11264
    v_mfma_f32_16x16x32_bf16 v[12:15], v[120:123], v[116:119], v[12:15]
    v_add_u16 v240, 0x4000, v240
    s_add_u32 s16, s16, 8448
    s_cmp_eq_u32 s16, 92928
    v_mfma_f32_16x16x32_bf16 v[16:19], v[124:127], v[104:107], v[16:19]
    s_cselect_b32 s16, 0, s16
    v_mfma_f32_16x16x32_bf16 v[20:23], v[124:127], v[108:111], v[20:23]
    v_add_u32 v242, s16, v241
    v_mfma_f32_16x16x32_bf16 v[24:27], v[124:127], v[112:115], v[24:27]
    s_sub_u32 s17, s17, 1
    s_cmp_lg_u32 s17, 0
    v_mfma_f32_16x16x32_bf16 v[28:31], v[124:127], v[116:119], v[28:31]
    s_waitcnt lgkmcnt(0)
    s_cbranch_scc1 r1_loop
    s_nop 4
    s_waitcnt vmcnt(0)
    v_lshlrev_b32 v144, 16, v128
    v_and_b32 v145, 0xffff0000, v128
    v_lshlrev_b32 v146, 16, v129
    v_and_b32 v147, 0xffff0000, v129
    v_lshlrev_b32 v148, 16, v130
    v_and_b32 v149, 0xffff0000, v130
    v_lshlrev_b32 v150, 16, v131
    v_and_b32 v151, 0xffff0000, v131
    v_lshlrev_b32 v152, 16, v132
    v_and_b32 v153, 0xffff0000, v132
    v_lshlrev_b32 v154, 16, v133
    v_and_b32 v155, 0xffff0000, v133
    v_lshlrev_b32 v156, 16, v134
    v_and_b32 v157, 0xffff0000, v134
    v_lshlrev_b32 v158, 16, v135
    v_and_b32 v159, 0xffff0000, v135
    v_lshlrev_b32 v160, 16, v136
    v_and_b32 v161, 0xffff0000, v136
    v_lshlrev_b32 v162, 16, v137
    v_and_b32 v163, 0xffff0000, v137
    v_lshlrev_b32 v164, 16, v138
    v_and_b32 v165, 0xffff0000, v138
    v_lshlrev_b32 v166, 16, v139
    v_and_b32 v167, 0xffff0000, v139
    v_lshlrev_b32 v168, 16, v140
    v_and_b32 v169, 0xffff0000, v140
    v_lshlrev_b32 v170, 16, v141
    v_and_b32 v171, 0xffff0000, v141
    v_lshlrev_b32 v172, 16, v142
    v_and_b32 v173, 0xffff0000, v142
    v_lshlrev_b32 v174, 16, v143
    v_and_b32 v175, 0xffff0000, v143
    v_mov_b32 v88, 0x3f803f80
    v_cvt_pk_bf16_f32 v208, v0, v1
    v_cvt_pk_bf16_f32 v209, v2, v3
    v_cvt_pk_bf16_f32 v210, v16, v17
    v_cvt_pk_bf16_f32 v211, v18, v19
    v_lshlrev_b32 v212, 16, v208
    v_and_b32 v213, 0xffff0000, v208
    v_lshlrev_b32 v214, 16, v209
    v_and_b32 v215, 0xffff0000, v209
    v_lshlrev_b32 v216, 16, v210
    v_and_b32 v217, 0xffff0000, v210
    v_lshlrev_b32 v218, 16, v211
    v_and_b32 v219, 0xffff0000, v211
    v_pk_add_f32 v[212:213], v[212:213], v[144:145]
    v_pk_add_f32 v[214:215], v[214:215], v[146:147]
    v_pk_add_f32 v[216:217], v[216:217], v[148:149]
    v_pk_add_f32 v[218:219], v[218:219], v[150:151]
    v_cvt_pk_bf16_f32 v64, v212, v213
    v_cvt_pk_bf16_f32 v65, v214, v215
    v_cvt_pk_bf16_f32 v66, v216, v217
    v_cvt_pk_bf16_f32 v67, v218, v219
    buffer_store_dwordx4 v[64:67], v249, s[80:83], s19 offen offset:0
    ds_write_b128 v239, v[64:67] offset:0
    v_cvt_pk_bf16_f32 v208, v4, v5
    v_cvt_pk_bf16_f32 v209, v6, v7
    v_cvt_pk_bf16_f32 v210, v20, v21
    v_cvt_pk_bf16_f32 v211, v22, v23
    v_lshlrev_b32 v212, 16, v208
    v_and_b32 v213, 0xffff0000, v208
    v_lshlrev_b32 v214, 16, v209
    v_and_b32 v215, 0xffff0000, v209
    v_lshlrev_b32 v216, 16, v210
    v_and_b32 v217, 0xffff0000, v210
    v_lshlrev_b32 v218, 16, v211
    v_and_b32 v219, 0xffff0000, v211
    v_pk_add_f32 v[212:213], v[212:213], v[152:153]
    v_pk_add_f32 v[214:215], v[214:215], v[154:155]
    v_pk_add_f32 v[216:217], v[216:217], v[156:157]
    v_pk_add_f32 v[218:219], v[218:219], v[158:159]
    v_cvt_pk_bf16_f32 v68, v212, v213
    v_cvt_pk_bf16_f32 v69, v214, v215
    v_cvt_pk_bf16_f32 v70, v216, v217
    v_cvt_pk_bf16_f32 v71, v218, v219
    buffer_store_dwordx4 v[68:71], v249, s[80:83], s19 offen offset:1024
    ds_write_b128 v239, v[68:71] offset:1024
    v_cvt_pk_bf16_f32 v208, v8, v9
    v_cvt_pk_bf16_f32 v209, v10, v11
    v_cvt_pk_bf16_f32 v210, v24, v25
    v_cvt_pk_bf16_f32 v211, v26, v27
    v_lshlrev_b32 v212, 16, v208
    v_and_b32 v213, 0xffff0000, v208
    v_lshlrev_b32 v214, 16, v209
    v_and_b32 v215, 0xffff0000, v209
    v_lshlrev_b32 v216, 16, v210
    v_and_b32 v217, 0xffff0000, v210
    v_lshlrev_b32 v218, 16, v211
    v_and_b32 v219, 0xffff0000, v211
    v_pk_add_f32 v[212:213], v[212:213], v[160:161]
    v_pk_add_f32 v[214:215], v[214:215], v[162:163]
    v_pk_add_f32 v[216:217], v[216:217], v[164:165]
    v_pk_add_f32 v[218:219], v[218:219], v[166:167]
    v_cvt_pk_bf16_f32 v72, v212, v213
    v_cvt_pk_bf16_f32 v73, v214, v215
    v_cvt_pk_bf16_f32 v74, v216, v217
    v_cvt_pk_bf16_f32 v75, v218, v219
    buffer_store_dwordx4 v[72:75], v249, s[80:83], s19 offen offset:2048
    ds_write_b128 v239, v[72:75] offset:2048
    v_cvt_pk_bf16_f32 v208, v12, v13
    v_cvt_pk_bf16_f32 v209, v14, v15
    v_cvt_pk_bf16_f32 v210, v28, v29
    v_cvt_pk_bf16_f32 v211, v30, v31
    v_lshlrev_b32 v212, 16, v208
    v_and_b32 v213, 0xffff0000, v208
    v_lshlrev_b32 v214, 16, v209
    v_and_b32 v215, 0xffff0000, v209
    v_lshlrev_b32 v216, 16, v210
    v_and_b32 v217, 0xffff0000, v210
    v_lshlrev_b32 v218, 16, v211
    v_and_b32 v219, 0xffff0000, v211
    v_pk_add_f32 v[212:213], v[212:213], v[168:169]
    v_pk_add_f32 v[214:215], v[214:215], v[170:171]
    v_pk_add_f32 v[216:217], v[216:217], v[172:173]
    v_pk_add_f32 v[218:219], v[218:219], v[174:175]
    v_cvt_pk_bf16_f32 v76, v212, v213
    v_cvt_pk_bf16_f32 v77, v214, v215
    v_cvt_pk_bf16_f32 v78, v216, v217
    v_cvt_pk_bf16_f32 v79, v218, v219
    buffer_store_dwordx4 v[76:79], v249, s[80:83], s19 offen offset:3072
    ds_write_b128 v239, v[76:79] offset:3072
    v_dot2_f32_bf16 v80, v64, v88, 0
    v_dot2_f32_bf16 v84, v64, v64, 0
    v_dot2_f32_bf16 v80, v65, v88, v80
    v_dot2_f32_bf16 v84, v65, v65, v84
    v_dot2_f32_bf16 v80, v66, v88, v80
    v_dot2_f32_bf16 v84, v66, v66, v84
    v_dot2_f32_bf16 v80, v67, v88, v80
    v_dot2_f32_bf16 v84, v67, v67, v84
    v_dot2_f32_bf16 v81, v68, v88, 0
    v_dot2_f32_bf16 v85, v68, v68, 0
    v_dot2_f32_bf16 v81, v69, v88, v81
    v_dot2_f32_bf16 v85, v69, v69, v85
    v_dot2_f32_bf16 v81, v70, v88, v81
    v_dot2_f32_bf16 v85, v70, v70, v85
    v_dot2_f32_bf16 v81, v71, v88, v81
    v_dot2_f32_bf16 v85, v71, v71, v85
    v_dot2_f32_bf16 v82, v72, v88, 0
    v_dot2_f32_bf16 v86, v72, v72, 0
    v_dot2_f32_bf16 v82, v73, v88, v82
    v_dot2_f32_bf16 v86, v73, v73, v86
    v_dot2_f32_bf16 v82, v74, v88, v82
    v_dot2_f32_bf16 v86, v74, v74, v86
    v_dot2_f32_bf16 v82, v75, v88, v82
    v_dot2_f32_bf16 v86, v75, v75, v86
    v_dot2_f32_bf16 v83, v76, v88, 0
    v_dot2_f32_bf16 v87, v76, v76, 0
    v_dot2_f32_bf16 v83, v77, v88, v83
    v_dot2_f32_bf16 v87, v77, v77, v87
    v_dot2_f32_bf16 v83, v78, v88, v83
    v_dot2_f32_bf16 v87, v78, v78, v87
    v_dot2_f32_bf16 v83, v79, v88, v83
    v_dot2_f32_bf16 v87, v79, v79, v87
    s_lshl_b32 s64, s73, 4
    s_add_u32 s64, s64, s72
    s_lshl_b32 s18, s64, 8
    s_lshl_b32 s64, s64, 11
    s_lshl_b32 s65, s75, 20
    s_add_u32 s64, s64, s65
    s_add_u32 s64, s64, 71303168
    s_lshr_b32 s65, s3, 1
    s_lshl_b32 s65, s65, 10
    s_add_u32 s64, s64, s65
    s_and_b32 s65, s3, 1
    s_lshl_b32 s65, s65, 3
    s_add_u32 s64, s64, s65
    s_add_u32 s18, s18, s65
    v_permlane16_swap_b32 v80, v81
    v_permlane16_swap_b32 v82, v83
    v_permlane16_swap_b32 v84, v85
    v_permlane16_swap_b32 v86, v87
    v_add_f32 v80, v80, v81
    v_add_f32 v82, v82, v83
    v_add_f32 v84, v84, v85
    v_add_f32 v86, v86, v87
    s_nop 1
    v_permlane32_swap_b32 v80, v82
    v_permlane32_swap_b32 v84, v86
    v_add_f32 v80, v80, v82
    v_add_f32 v81, v84, v86
    buffer_store_dwordx2 v[80:81], v249, s[80:83], s64 offen
    s_and_b32 s64, s3, 1
    s_cmp_eq_u32 s64, 0
    s_cselect_b32 s8, s92, s94
    s_cselect_b32 s9, s93, s95
    s_mov_b32 s10, 7340032
    s_mov_b32 s11, 0x00020000
    s_mul_i32 s19, s64, 14400
    s_lshr_b32 s64, s69, 1
    s_mul_i32 s65, s64, 7200
    s_add_u32 s19, s19, s65
    s_add_u32 s19, s19, 36736
    s_mul_i32 s17, s64, 28672
    s_mul_i32 s65, s74, 448
    s_add_u32 s17, s17, s65
    s_add_u32 s18, s17, 7340032
    s_lshl_b32 s64, s57, 1
    s_add_u32 s64, s64, 3
    s_and_b32 s64, s64, 31
    s_mul_i32 s65, s64, 229376
    s_add_u32 s16, s17, s65
    s_mov_b32 s66, 2341
    v_add_u32 v253, 192, v250
    v_mul_lo_u32 v254, v253, s66
    v_lshrrev_b32 v254, 16, v254
    v_mul_u32_u24 v224, 28, v254
    v_sub_u32 v253, v253, v224
    v_and_b32 v224, 12, v254
    v_add_u32 v254, v254, v224
    v_mul_u32_u24 v254, 7168, v254
    v_lshl_add_u32 v224, v253, 4, v254
    v_add_u32 v253, 256, v250
    v_mul_lo_u32 v254, v253, s66
    v_lshrrev_b32 v254, 16, v254
    v_mul_u32_u24 v225, 28, v254
    v_sub_u32 v253, v253, v225
    v_and_b32 v225, 12, v254
    v_add_u32 v254, v254, v225
    v_mul_u32_u24 v254, 7168, v254
    v_lshl_add_u32 v225, v253, 4, v254
    v_add_u32 v253, 320, v250
    v_mul_lo_u32 v254, v253, s66
    v_lshrrev_b32 v254, 16, v254
    v_mul_u32_u24 v226, 28, v254
    v_sub_u32 v253, v253, v226
    v_and_b32 v226, 12, v254
    v_add_u32 v254, v254, v226
    v_mul_u32_u24 v254, 7168, v254
    v_lshl_add_u32 v226, v253, 4, v254
    v_add_u32 v253, 384, v250
    v_mul_lo_u32 v254, v253, s66
    v_lshrrev_b32 v254, 16, v254
    v_mul_u32_u24 v227, 28, v254
    v_sub_u32 v253, v253, v227
    v_and_b32 v227, 12, v254
    v_add_u32 v254, v254, v227
    v_mul_u32_u24 v254, 7168, v254
    v_lshl_add_u32 v227, v253, 4, v254
    s_and_b32 s64, s3, 1
    s_lshl_b32 s64, s64, 12
    v_add_u32 v231, s64, v249
    v_lshrrev_b32 v253, 1, v251
    v_lshrrev_b32 v254, 2, v252
    v_lshl_add_u32 v253, v253, 2, v254
    v_mul_u32_u24 v253, 448, v253
    v_and_b32 v254, 1, v251
    v_mul_u32_u24 v254, 7200, v254
    v_add_u32 v253, v253, v254
    v_and_b32 v254, 3, v252
    v_lshl_add_u32 v253, v254, 3, v253
    v_add_u32 v253, 36736, v253
    s_lshr_b32 s64, s69, 1
    s_lshl_b32 s28, s64, 2
    s_lshl_b32 s65, s28, 5
    v_add_u32 v232, s65, v253
    v_add_u32 v233, 57600, v232
    s_mul_i32 s25, s73, 112
    s_mul_i32 s64, s74, 7
    s_add_u32 s25, s25, s64
    s_lshl_b32 s25, s25, 13
    s_lshl_b32 s64, s60, 24
    s_add_u32 s25, s25, s64
    s_add_u32 s25, s25, 20971520
    v_mov_b32 v192, 0
    v_mov_b32 v193, 0
    v_mov_b32 v194, 0
    v_mov_b32 v195, 0
    s_nop 1
    v_mfma_f32_32x32x16_bf16 v[0:15], v[192:195], v[192:195], 0
    v_mfma_f32_32x32x16_bf16 v[16:31], v[192:195], v[192:195], 0
    v_mfma_f32_32x32x16_bf16 v[32:47], v[192:195], v[192:195], 0
    v_mfma_f32_32x32x16_bf16 v[48:63], v[192:195], v[192:195], 0
    v_mfma_f32_32x32x16_bf16 v[64:79], v[192:195], v[192:195], 0
    v_mfma_f32_32x32x16_bf16 v[80:95], v[192:195], v[192:195], 0
    v_mfma_f32_32x32x16_bf16 v[96:111], v[192:195], v[192:195], 0
    v_mfma_f32_32x32x16_bf16 v[112:127], v[192:195], v[192:195], 0
    s_lshl_b32 s64, s75, 15
    s_lshl_b32 s66, s73, 9
    s_add_u32 s64, s64, s66
    s_add_u32 s64, s64, 75505664
    s_lshl_b32 s65, s72, 5
    s_add_u32 s64, s64, s65
    s_lshl_b32 s65, s3, 2
    s_add_u32 s64, s64, s65
    v_mov_b32 v236, 0
    v_mov_b32 v237, 1
    s_cmp_lg_u32 s78, 0
    s_cbranch_scc1 sg_6_slow
    s_waitcnt vmcnt(0)
    s_mov_b64 exec, 1
    buffer_store_dword v237, v236, s[80:83], s64 offen
    s_mov_b64 exec, -1
sg_6_done:
    s_waitcnt lgkmcnt(0)
    s_barrier
    ds_read_b128 v[192:195], v231 offset:0
    ds_read_b128 v[196:199], v231 offset:1024
    ds_read_b128 v[200:203], v231 offset:2048
    ds_read_b128 v[204:207], v231 offset:3072
    ds_read_b64_tr_b16 v[128:129], v232 offset:28800
    ds_read_b64_tr_b16 v[130:131], v232 offset:32384
    ds_read_b64_tr_b16 v[144:145], v232 offset:43200
    ds_read_b64_tr_b16 v[146:147], v232 offset:46784
    ds_read_b64_tr_b16 v[132:133], v232 offset:28832
    ds_read_b64_tr_b16 v[134:135], v232 offset:32416
    ds_read_b64_tr_b16 v[148:149], v232 offset:43232
    ds_read_b64_tr_b16 v[150:151], v232 offset:46816
    ds_read_b64_tr_b16 v[136:137], v232 offset:28864
    ds_read_b64_tr_b16 v[138:139], v232 offset:32448
    ds_read_b64_tr_b16 v[152:153], v232 offset:43264
    ds_read_b64_tr_b16 v[154:155], v232 offset:46848
    ds_read_b64_tr_b16 v[140:141], v232 offset:28896
    ds_read_b64_tr_b16 v[142:143], v232 offset:32480
    ds_read_b64_tr_b16 v[156:157], v232 offset:43296
    ds_read_b64_tr_b16 v[158:159], v232 offset:46880
    s_mov_b32 s24, 7
g3c0_loop:
    s_waitcnt vmcnt(4) lgkmcnt(0)
    s_barrier
    v_mfma_f32_16x16x32_bf16 v[0:3], v[128:131], v[192:195], v[0:3]
    ds_read_b128 v[208:211], v231 offset:8192
    v_mfma_f32_16x16x32_bf16 v[4:7], v[128:131], v[196:199], v[4:7]
    ds_read_b128 v[212:215], v231 offset:9216
    v_mfma_f32_16x16x32_bf16 v[8:11], v[128:131], v[200:203], v[8:11]
    ds_read_b128 v[216:219], v231 offset:10240
    v_mfma_f32_16x16x32_bf16 v[12:15], v[128:131], v[204:207], v[12:15]
    ds_read_b128 v[220:223], v231 offset:11264
    v_mfma_f32_16x16x32_bf16 v[64:67], v[144:147], v[192:195], v[64:67]
    ds_read_b64_tr_b16 v[160:161], v233 offset:0
    v_mfma_f32_16x16x32_bf16 v[68:71], v[144:147], v[196:199], v[68:71]
    s_add_u32 m0, s19, 3072
    s_nop 0
    buffer_load_dwordx4 v224, s[8:11], s16 offen lds
    v_mfma_f32_16x16x32_bf16 v[72:75], v[144:147], v[200:203], v[72:75]
    ds_read_b64_tr_b16 v[162:163], v233 offset:3584
    v_mfma_f32_16x16x32_bf16 v[76:79], v[144:147], v[204:207], v[76:79]
    ds_read_b64_tr_b16 v[176:177], v233 offset:14400
    v_mfma_f32_16x16x32_bf16 v[16:19], v[132:135], v[192:195], v[16:19]
    ds_read_b64_tr_b16 v[178:179], v233 offset:17984
    v_mfma_f32_16x16x32_bf16 v[20:23], v[132:135], v[196:199], v[20:23]
    ds_read_b64_tr_b16 v[164:165], v233 offset:32
    v_mfma_f32_16x16x32_bf16 v[24:27], v[132:135], v[200:203], v[24:27]
    ds_read_b64_tr_b16 v[166:167], v233 offset:3616
    v_mfma_f32_16x16x32_bf16 v[28:31], v[132:135], v[204:207], v[28:31]
    s_add_u32 m0, s19, 4096
    s_nop 0
    buffer_load_dwordx4 v225, s[8:11], s16 offen lds
    v_mfma_f32_16x16x32_bf16 v[80:83], v[148:151], v[192:195], v[80:83]
    v_mfma_f32_16x16x32_bf16 v[84:87], v[148:151], v[196:199], v[84:87]
    ds_read_b64_tr_b16 v[180:181], v233 offset:14432
    v_mfma_f32_16x16x32_bf16 v[88:91], v[148:151], v[200:203], v[88:91]
    ds_read_b64_tr_b16 v[182:183], v233 offset:18016
    v_mfma_f32_16x16x32_bf16 v[92:95], v[148:151], v[204:207], v[92:95]
    ds_read_b64_tr_b16 v[168:169], v233 offset:64
    v_mfma_f32_16x16x32_bf16 v[32:35], v[136:139], v[192:195], v[32:35]
    ds_read_b64_tr_b16 v[170:171], v233 offset:3648
    v_mfma_f32_16x16x32_bf16 v[36:39], v[136:139], v[196:199], v[36:39]
    ds_read_b64_tr_b16 v[184:185], v233 offset:14464
    v_mfma_f32_16x16x32_bf16 v[40:43], v[136:139], v[200:203], v[40:43]
    s_add_u32 m0, s19, 5120
    s_nop 0
    buffer_load_dwordx4 v226, s[8:11], s16 offen lds
    v_mfma_f32_16x16x32_bf16 v[44:47], v[136:139], v[204:207], v[44:47]
    ds_read_b64_tr_b16 v[186:187], v233 offset:18048
    v_mfma_f32_16x16x32_bf16 v[96:99], v[152:155], v[192:195], v[96:99]
    ds_read_b64_tr_b16 v[172:173], v233 offset:96
    v_mfma_f32_16x16x32_bf16 v[100:103], v[152:155], v[196:199], v[100:103]
    ds_read_b64_tr_b16 v[174:175], v233 offset:3680
    v_mfma_f32_16x16x32_bf16 v[104:107], v[152:155], v[200:203], v[104:107]
    ds_read_b64_tr_b16 v[188:189], v233 offset:14496
    v_mfma_f32_16x16x32_bf16 v[108:111], v[152:155], v[204:207], v[108:111]
    ds_read_b64_tr_b16 v[190:191], v233 offset:18080
    v_mfma_f32_16x16x32_bf16 v[48:51], v[140:143], v[192:195], v[48:51]
    s_add_u32 m0, s19, 6144
    s_nop 0
    buffer_load_dwordx4 v227, s[8:11], s16 offen lds
    s_add_u32 s16, s16, 229376
    s_cmp_eq_u32 s16, s18
    s_cselect_b32 s16, s17, s16
    v_mfma_f32_16x16x32_bf16 v[52:55], v[140:143], v[196:199], v[52:55]
    v_mfma_f32_16x16x32_bf16 v[56:59], v[140:143], v[200:203], v[56:59]
    v_mfma_f32_16x16x32_bf16 v[60:63], v[140:143], v[204:207], v[60:63]
    v_mfma_f32_16x16x32_bf16 v[112:115], v[156:159], v[192:195], v[112:115]
    v_mfma_f32_16x16x32_bf16 v[116:119], v[156:159], v[196:199], v[116:119]
    v_mfma_f32_16x16x32_bf16 v[120:123], v[156:159], v[200:203], v[120:123]
    v_mfma_f32_16x16x32_bf16 v[124:127], v[156:159], v[204:207], v[124:127]
    s_waitcnt vmcnt(4) lgkmcnt(0)
    s_barrier
    v_mfma_f32_16x16x32_bf16 v[0:3], v[160:163], v[208:211], v[0:3]
    ds_read_b128 v[192:195], v231 offset:16384
    v_mfma_f32_16x16x32_bf16 v[4:7], v[160:163], v[212:215], v[4:7]
    ds_read_b128 v[196:199], v231 offset:17408
    v_mfma_f32_16x16x32_bf16 v[8:11], v[160:163], v[216:219], v[8:11]
    ds_read_b128 v[200:203], v231 offset:18432
    v_mfma_f32_16x16x32_bf16 v[12:15], v[160:163], v[220:223], v[12:15]
    ds_read_b128 v[204:207], v231 offset:19456
    v_mfma_f32_16x16x32_bf16 v[64:67], v[176:179], v[208:211], v[64:67]
    ds_read_b64_tr_b16 v[128:129], v233 offset:28800
    v_mfma_f32_16x16x32_bf16 v[68:71], v[176:179], v[212:215], v[68:71]
    s_add_u32 m0, s19, 31872
    s_nop 0
    buffer_load_dwordx4 v224, s[8:11], s16 offen lds
    v_mfma_f32_16x16x32_bf16 v[72:75], v[176:179], v[216:219], v[72:75]
    ds_read_b64_tr_b16 v[130:131], v233 offset:32384
    v_mfma_f32_16x16x32_bf16 v[76:79], v[176:179], v[220:223], v[76:79]
    ds_read_b64_tr_b16 v[144:145], v233 offset:43200
    v_mfma_f32_16x16x32_bf16 v[16:19], v[164:167], v[208:211], v[16:19]
    ds_read_b64_tr_b16 v[146:147], v233 offset:46784
    v_mfma_f32_16x16x32_bf16 v[20:23], v[164:167], v[212:215], v[20:23]
    ds_read_b64_tr_b16 v[132:133], v233 offset:28832
    v_mfma_f32_16x16x32_bf16 v[24:27], v[164:167], v[216:219], v[24:27]
    ds_read_b64_tr_b16 v[134:135], v233 offset:32416
    v_mfma_f32_16x16x32_bf16 v[28:31], v[164:167], v[220:223], v[28:31]
    s_add_u32 m0, s19, 32896
    s_nop 0
    buffer_load_dwordx4 v225, s[8:11], s16 offen lds
    v_mfma_f32_16x16x32_bf16 v[80:83], v[180:183], v[208:211], v[80:83]
    v_mfma_f32_16x16x32_bf16 v[84:87], v[180:183], v[212:215], v[84:87]
    ds_read_b64_tr_b16 v[148:149], v233 offset:43232
    v_mfma_f32_16x16x32_bf16 v[88:91], v[180:183], v[216:219], v[88:91]
    ds_read_b64_tr_b16 v[150:151], v233 offset:46816
    v_mfma_f32_16x16x32_bf16 v[92:95], v[180:183], v[220:223], v[92:95]
    ds_read_b64_tr_b16 v[136:137], v233 offset:28864
    v_mfma_f32_16x16x32_bf16 v[32:35], v[168:171], v[208:211], v[32:35]
    ds_read_b64_tr_b16 v[138:139], v233 offset:32448
    v_mfma_f32_16x16x32_bf16 v[36:39], v[168:171], v[212:215], v[36:39]
    ds_read_b64_tr_b16 v[152:153], v233 offset:43264
    v_mfma_f32_16x16x32_bf16 v[40:43], v[168:171], v[216:219], v[40:43]
    s_add_u32 m0, s19, 33920
    s_nop 0
    buffer_load_dwordx4 v226, s[8:11], s16 offen lds
    v_mfma_f32_16x16x32_bf16 v[44:47], v[168:171], v[220:223], v[44:47]
    ds_read_b64_tr_b16 v[154:155], v233 offset:46848
    v_mfma_f32_16x16x32_bf16 v[96:99], v[184:187], v[208:211], v[96:99]
    ds_read_b64_tr_b16 v[140:141], v233 offset:28896
    v_mfma_f32_16x16x32_bf16 v[100:103], v[184:187], v[212:215], v[100:103]
    ds_read_b64_tr_b16 v[142:143], v233 offset:32480
    v_mfma_f32_16x16x32_bf16 v[104:107], v[184:187], v[216:219], v[104:107]
    ds_read_b64_tr_b16 v[156:157], v233 offset:43296
    v_mfma_f32_16x16x32_bf16 v[108:111], v[184:187], v[220:223], v[108:111]
    ds_read_b64_tr_b16 v[158:159], v233 offset:46880
    v_mfma_f32_16x16x32_bf16 v[48:51], v[172:175], v[208:211], v[48:51]
    s_add_u32 m0, s19, 34944
    s_nop 0
    buffer_load_dwordx4 v227, s[8:11], s16 offen lds
    s_add_u32 s16, s16, 229376
    s_cmp_eq_u32 s16, s18
    s_cselect_b32 s16, s17, s16
    v_mfma_f32_16x16x32_bf16 v[52:55], v[172:175], v[212:215], v[52:55]
    v_mfma_f32_16x16x32_bf16 v[56:59], v[172:175], v[216:219], v[56:59]
    v_mfma_f32_16x16x32_bf16 v[60:63], v[172:175], v[220:223], v[60:63]
    v_mfma_f32_16x16x32_bf16 v[112:115], v[188:191], v[208:211], v[112:115]
    v_mfma_f32_16x16x32_bf16 v[116:119], v[188:191], v[212:215], v[116:119]
    v_mfma_f32_16x16x32_bf16 v[120:123], v[188:191], v[216:219], v[120:123]
    v_mfma_f32_16x16x32_bf16 v[124:127], v[188:191], v[220:223], v[124:127]
    s_waitcnt vmcnt(4) lgkmcnt(0)
    s_barrier
    v_mfma_f32_16x16x32_bf16 v[0:3], v[128:131], v[192:195], v[0:3]
    ds_read_b128 v[208:211], v231 offset:24576
    v_mfma_f32_16x16x32_bf16 v[4:7], v[128:131], v[196:199], v[4:7]
    ds_read_b128 v[212:215], v231 offset:25600
    v_mfma_f32_16x16x32_bf16 v[8:11], v[128:131], v[200:203], v[8:11]
    ds_read_b128 v[216:219], v231 offset:26624
    v_mfma_f32_16x16x32_bf16 v[12:15], v[128:131], v[204:207], v[12:15]
    ds_read_b128 v[220:223], v231 offset:27648
    v_mfma_f32_16x16x32_bf16 v[64:67], v[144:147], v[192:195], v[64:67]
    ds_read_b64_tr_b16 v[160:161], v232 offset:0
    v_mfma_f32_16x16x32_bf16 v[68:71], v[144:147], v[196:199], v[68:71]
    s_add_u32 m0, s19, 60672
    s_nop 0
    buffer_load_dwordx4 v224, s[8:11], s16 offen lds
    v_mfma_f32_16x16x32_bf16 v[72:75], v[144:147], v[200:203], v[72:75]
    ds_read_b64_tr_b16 v[162:163], v232 offset:3584
    v_mfma_f32_16x16x32_bf16 v[76:79], v[144:147], v[204:207], v[76:79]
    ds_read_b64_tr_b16 v[176:177], v232 offset:14400
    v_mfma_f32_16x16x32_bf16 v[16:19], v[132:135], v[192:195], v[16:19]
    ds_read_b64_tr_b16 v[178:179], v232 offset:17984
    v_mfma_f32_16x16x32_bf16 v[20:23], v[132:135], v[196:199], v[20:23]
    ds_read_b64_tr_b16 v[164:165], v232 offset:32
    v_mfma_f32_16x16x32_bf16 v[24:27], v[132:135], v[200:203], v[24:27]
    ds_read_b64_tr_b16 v[166:167], v232 offset:3616
    v_mfma_f32_16x16x32_bf16 v[28:31], v[132:135], v[204:207], v[28:31]
    s_add_u32 m0, s19, 61696
    s_nop 0
    buffer_load_dwordx4 v225, s[8:11], s16 offen lds
    v_mfma_f32_16x16x32_bf16 v[80:83], v[148:151], v[192:195], v[80:83]
    v_mfma_f32_16x16x32_bf16 v[84:87], v[148:151], v[196:199], v[84:87]
    ds_read_b64_tr_b16 v[180:181], v232 offset:14432
    v_mfma_f32_16x16x32_bf16 v[88:91], v[148:151], v[200:203], v[88:91]
    ds_read_b64_tr_b16 v[182:183], v232 offset:18016
    v_mfma_f32_16x16x32_bf16 v[92:95], v[148:151], v[204:207], v[92:95]
    ds_read_b64_tr_b16 v[168:169], v232 offset:64
    v_mfma_f32_16x16x32_bf16 v[32:35], v[136:139], v[192:195], v[32:35]
    ds_read_b64_tr_b16 v[170:171], v232 offset:3648
    v_mfma_f32_16x16x32_bf16 v[36:39], v[136:139], v[196:199], v[36:39]
    ds_read_b64_tr_b16 v[184:185], v232 offset:14464
    v_mfma_f32_16x16x32_bf16 v[40:43], v[136:139], v[200:203], v[40:43]
    s_add_u32 m0, s19, 62720
    s_nop 0
    buffer_load_dwordx4 v226, s[8:11], s16 offen lds
    v_mfma_f32_16x16x32_bf16 v[44:47], v[136:139], v[204:207], v[44:47]
    ds_read_b64_tr_b16 v[186:187], v232 offset:18048
    v_mfma_f32_16x16x32_bf16 v[96:99], v[152:155], v[192:195], v[96:99]
    ds_read_b64_tr_b16 v[172:173], v232 offset:96
    v_mfma_f32_16x16x32_bf16 v[100:103], v[152:155], v[196:199], v[100:103]
    ds_read_b64_tr_b16 v[174:175], v232 offset:3680
    v_mfma_f32_16x16x32_bf16 v[104:107], v[152:155], v[200:203], v[104:107]
    ds_read_b64_tr_b16 v[188:189], v232 offset:14496
    v_mfma_f32_16x16x32_bf16 v[108:111], v[152:155], v[204:207], v[108:111]
    ds_read_b64_tr_b16 v[190:191], v232 offset:18080
    v_mfma_f32_16x16x32_bf16 v[48:51], v[140:143], v[192:195], v[48:51]
    s_add_u32 m0, s19, 63744
    s_nop 0
    buffer_load_dwordx4 v227, s[8:11], s16 offen lds
    s_add_u32 s16, s16, 229376
    s_cmp_eq_u32 s16, s18
    s_cselect_b32 s16, s17, s16
    v_mfma_f32_16x16x32_bf16 v[52:55], v[140:143], v[196:199], v[52:55]
    v_mfma_f32_16x16x32_bf16 v[56:59], v[140:143], v[200:203], v[56:59]
    v_mfma_f32_16x16x32_bf16 v[60:63], v[140:143], v[204:207], v[60:63]
    v_mfma_f32_16x16x32_bf16 v[112:115], v[156:159], v[192:195], v[112:115]
    v_mfma_f32_16x16x32_bf16 v[116:119], v[156:159], v[196:199], v[116:119]
    v_mfma_f32_16x16x32_bf16 v[120:123], v[156:159], v[200:203], v[120:123]
    v_mfma_f32_16x16x32_bf16 v[124:127], v[156:159], v[204:207], v[124:127]
    s_waitcnt vmcnt(4) lgkmcnt(0)
    s_barrier
    v_mfma_f32_16x16x32_bf16 v[0:3], v[160:163], v[208:211], v[0:3]
    ds_read_b128 v[192:195], v231 offset:0
    v_mfma_f32_16x16x32_bf16 v[4:7], v[160:163], v[212:215], v[4:7]
    ds_read_b128 v[196:199], v231 offset:1024
    v_mfma_f32_16x16x32_bf16 v[8:11], v[160:163], v[216:219], v[8:11]
    ds_read_b128 v[200:203], v231 offset:2048
    v_mfma_f32_16x16x32_bf16 v[12:15], v[160:163], v[220:223], v[12:15]
    ds_read_b128 v[204:207], v231 offset:3072
    v_mfma_f32_16x16x32_bf16 v[64:67], v[176:179], v[208:211], v[64:67]
    ds_read_b64_tr_b16 v[128:129], v232 offset:28800
    v_mfma_f32_16x16x32_bf16 v[68:71], v[176:179], v[212:215], v[68:71]
    s_add_u32 m0, s19, 89472
    s_nop 0
    buffer_load_dwordx4 v224, s[8:11], s16 offen lds
    v_mfma_f32_16x16x32_bf16 v[72:75], v[176:179], v[216:219], v[72:75]
    ds_read_b64_tr_b16 v[130:131], v232 offset:32384
    v_mfma_f32_16x16x32_bf16 v[76:79], v[176:179], v[220:223], v[76:79]
    ds_read_b64_tr_b16 v[144:145], v232 offset:43200
    v_mfma_f32_16x16x32_bf16 v[16:19], v[164:167], v[208:211], v[16:19]
    ds_read_b64_tr_b16 v[146:147], v232 offset:46784
    v_mfma_f32_16x16x32_bf16 v[20:23], v[164:167], v[212:215], v[20:23]
    ds_read_b64_tr_b16 v[132:133], v232 offset:28832
    v_mfma_f32_16x16x32_bf16 v[24:27], v[164:167], v[216:219], v[24:27]
    ds_read_b64_tr_b16 v[134:135], v232 offset:32416
    v_mfma_f32_16x16x32_bf16 v[28:31], v[164:167], v[220:223], v[28:31]
    s_add_u32 m0, s19, 90496
    s_nop 0
    buffer_load_dwordx4 v225, s[8:11], s16 offen lds
    v_mfma_f32_16x16x32_bf16 v[80:83], v[180:183], v[208:211], v[80:83]
    v_mfma_f32_16x16x32_bf16 v[84:87], v[180:183], v[212:215], v[84:87]
    ds_read_b64_tr_b16 v[148:149], v232 offset:43232
    v_mfma_f32_16x16x32_bf16 v[88:91], v[180:183], v[216:219], v[88:91]
    ds_read_b64_tr_b16 v[150:151], v232 offset:46816
    v_mfma_f32_16x16x32_bf16 v[92:95], v[180:183], v[220:223], v[92:95]
    ds_read_b64_tr_b16 v[136:137], v232 offset:28864
    v_mfma_f32_16x16x32_bf16 v[32:35], v[168:171], v[208:211], v[32:35]
    ds_read_b64_tr_b16 v[138:139], v232 offset:32448
    v_mfma_f32_16x16x32_bf16 v[36:39], v[168:171], v[212:215], v[36:39]
    ds_read_b64_tr_b16 v[152:153], v232 offset:43264
    v_mfma_f32_16x16x32_bf16 v[40:43], v[168:171], v[216:219], v[40:43]
    s_add_u32 m0, s19, 91520
    s_nop 0
    buffer_load_dwordx4 v226, s[8:11], s16 offen lds
    v_mfma_f32_16x16x32_bf16 v[44:47], v[168:171], v[220:223], v[44:47]
    ds_read_b64_tr_b16 v[154:155], v232 offset:46848
    v_mfma_f32_16x16x32_bf16 v[96:99], v[184:187], v[208:211], v[96:99]
    ds_read_b64_tr_b16 v[140:141], v232 offset:28896
    v_mfma_f32_16x16x32_bf16 v[100:103], v[184:187], v[212:215], v[100:103]
    ds_read_b64_tr_b16 v[142:143], v232 offset:32480
    v_mfma_f32_16x16x32_bf16 v[104:107], v[184:187], v[216:219], v[104:107]
    ds_read_b64_tr_b16 v[156:157], v232 offset:43296
    v_mfma_f32_16x16x32_bf16 v[108:111], v[184:187], v[220:223], v[108:111]
    ds_read_b64_tr_b16 v[158:159], v232 offset:46880
    v_mfma_f32_16x16x32_bf16 v[48:51], v[172:175], v[208:211], v[48:51]
    s_add_u32 m0, s19, 92544
    s_nop 0
    buffer_load_dwordx4 v227, s[8:11], s16 offen lds
    s_add_u32 s16, s16, 229376
    s_cmp_eq_u32 s16, s18
    s_cselect_b32 s16, s17, s16
    v_mfma_f32_16x16x32_bf16 v[52:55], v[172:175], v[212:215], v[52:55]
    v_mfma_f32_16x16x32_bf16 v[56:59], v[172:175], v[216:219], v[56:59]
    v_mfma_f32_16x16x32_bf16 v[60:63], v[172:175], v[220:223], v[60:63]
    v_mfma_f32_16x16x32_bf16 v[112:115], v[188:191], v[208:211], v[112:115]
    v_mfma_f32_16x16x32_bf16 v[116:119], v[188:191], v[212:215], v[116:119]
    v_mfma_f32_16x16x32_bf16 v[120:123], v[188:191], v[216:219], v[120:123]
    v_mfma_f32_16x16x32_bf16 v[124:127], v[188:191], v[220:223], v[124:127]
    s_sub_u32 s24, s24, 1
    s_cmp_lg_u32 s24, 0
    s_cbranch_scc1 g3c0_loop
    s_sub_u32 s27, s74, s58
    s_and_b32 s27, s27, 7
    s_cmp_lt_u32 s27, 4
    s_cselect_b32 s27, 14, 0
    s_waitcnt vmcnt(4) lgkmcnt(0)
    s_barrier
    v_mfma_f32_16x16x32_bf16 v[0:3], v[128:131], v[192:195], v[0:3]
    ds_read_b128 v[208:211], v231 offset:8192
    v_mfma_f32_16x16x32_bf16 v[4:7], v[128:131], v[196:199], v[4:7]
    ds_read_b128 v[212:215], v231 offset:9216
    v_mfma_f32_16x16x32_bf16 v[8:11], v[128:131], v[200:203], v[8:11]
    ds_read_b128 v[216:219], v231 offset:10240
    v_mfma_f32_16x16x32_bf16 v[12:15], v[128:131], v[204:207], v[12:15]
    ds_read_b128 v[220:223], v231 offset:11264
    v_mfma_f32_16x16x32_bf16 v[64:67], v[144:147], v[192:195], v[64:67]
    ds_read_b64_tr_b16 v[160:161], v233 offset:0
    v_mfma_f32_16x16x32_bf16 v[68:71], v[144:147], v[196:199], v[68:71]
    s_add_u32 m0, s19, 3072
    s_nop 0
    buffer_load_dwordx4 v224, s[8:11], s16 offen lds
    v_mfma_f32_16x16x32_bf16 v[72:75], v[144:147], v[200:203], v[72:75]
    ds_read_b64_tr_b16 v[162:163], v233 offset:3584
    v_mfma_f32_16x16x32_bf16 v[76:79], v[144:147], v[204:207], v[76:79]
    ds_read_b64_tr_b16 v[176:177], v233 offset:14400
    v_mfma_f32_16x16x32_bf16 v[16:19], v[132:135], v[192:195], v[16:19]
    ds_read_b64_tr_b16 v[178:179], v233 offset:17984
    v_mfma_f32_16x16x32_bf16 v[20:23], v[132:135], v[196:199], v[20:23]
    ds_read_b64_tr_b16 v[164:165], v233 offset:32
    v_mfma_f32_16x16x32_bf16 v[24:27], v[132:135], v[200:203], v[24:27]
    ds_read_b64_tr_b16 v[166:167], v233 offset:3616
    v_mfma_f32_16x16x32_bf16 v[28:31], v[132:135], v[204:207], v[28:31]
    s_add_u32 m0, s19, 4096
    s_nop 0
    buffer_load_dwordx4 v225, s[8:11], s16 offen lds
    v_mfma_f32_16x16x32_bf16 v[80:83], v[148:151], v[192:195], v[80:83]
    v_mfma_f32_16x16x32_bf16 v[84:87], v[148:151], v[196:199], v[84:87]
    ds_read_b64_tr_b16 v[180:181], v233 offset:14432
    v_mfma_f32_16x16x32_bf16 v[88:91], v[148:151], v[200:203], v[88:91]
    ds_read_b64_tr_b16 v[182:183], v233 offset:18016
    v_mfma_f32_16x16x32_bf16 v[92:95], v[148:151], v[204:207], v[92:95]
    ds_read_b64_tr_b16 v[168:169], v233 offset:64
    v_mfma_f32_16x16x32_bf16 v[32:35], v[136:139], v[192:195], v[32:35]
    ds_read_b64_tr_b16 v[170:171], v233 offset:3648
    v_mfma_f32_16x16x32_bf16 v[36:39], v[136:139], v[196:199], v[36:39]
    ds_read_b64_tr_b16 v[184:185], v233 offset:14464
    v_mfma_f32_16x16x32_bf16 v[40:43], v[136:139], v[200:203], v[40:43]
    s_add_u32 m0, s19, 5120
    s_nop 0
    buffer_load_dwordx4 v226, s[8:11], s16 offen lds
    v_mfma_f32_16x16x32_bf16 v[44:47], v[136:139], v[204:207], v[44:47]
    ds_read_b64_tr_b16 v[186:187], v233 offset:18048
    v_mfma_f32_16x16x32_bf16 v[96:99], v[152:155], v[192:195], v[96:99]
    ds_read_b64_tr_b16 v[172:173], v233 offset:96
    v_mfma_f32_16x16x32_bf16 v[100:103], v[152:155], v[196:199], v[100:103]
    ds_read_b64_tr_b16 v[174:175], v233 offset:3680
    v_mfma_f32_16x16x32_bf16 v[104:107], v[152:155], v[200:203], v[104:107]
    ds_read_b64_tr_b16 v[188:189], v233 offset:14496
    v_mfma_f32_16x16x32_bf16 v[108:111], v[152:155], v[204:207], v[108:111]
    ds_read_b64_tr_b16 v[190:191], v233 offset:18080
    v_mfma_f32_16x16x32_bf16 v[48:51], v[140:143], v[192:195], v[48:51]
    s_add_u32 m0, s19, 6144
    s_nop 0
    buffer_load_dwordx4 v227, s[8:11], s16 offen lds
    s_add_u32 s16, s16, 229376
    s_cmp_eq_u32 s16, s18
    s_cselect_b32 s16, s17, s16
    v_mfma_f32_16x16x32_bf16 v[52:55], v[140:143], v[196:199], v[52:55]
    v_mfma_f32_16x16x32_bf16 v[56:59], v[140:143], v[200:203], v[56:59]
    v_mfma_f32_16x16x32_bf16 v[60:63], v[140:143], v[204:207], v[60:63]
    v_mfma_f32_16x16x32_bf16 v[112:115], v[156:159], v[192:195], v[112:115]
    v_mfma_f32_16x16x32_bf16 v[116:119], v[156:159], v[196:199], v[116:119]
    v_mfma_f32_16x16x32_bf16 v[120:123], v[156:159], v[200:203], v[120:123]
    v_mfma_f32_16x16x32_bf16 v[124:127], v[156:159], v[204:207], v[124:127]
    s_waitcnt vmcnt(4) lgkmcnt(0)
    s_barrier
    v_mfma_f32_16x16x32_bf16 v[0:3], v[160:163], v[208:211], v[0:3]
    ds_read_b128 v[192:195], v231 offset:16384
    v_mfma_f32_16x16x32_bf16 v[4:7], v[160:163], v[212:215], v[4:7]
    ds_read_b128 v[196:199], v231 offset:17408
    v_lshlrev_b32 v247, 7, v250
    s_add_u32 s29, s3, 0
    s_lshl_b32 s30, s29, 12
    s_add_u32 s30, s30, s25
    s_cmp_lt_u32 s29, s27
    s_cselect_b32 s30, s30, 0x7f000000
    s_mov_b64 exec, 0xffffffff
    buffer_load_dword v248, v247, s[80:83], s30 offen sc1
    s_mov_b64 exec, -1
    v_mfma_f32_16x16x32_bf16 v[8:11], v[160:163], v[216:219], v[8:11]
    ds_read_b128 v[200:203], v231 offset:18432
    v_mfma_f32_16x16x32_bf16 v[12:15], v[160:163], v[220:223], v[12:15]
    ds_read_b128 v[204:207], v231 offset:19456
    v_mfma_f32_16x16x32_bf16 v[64:67], v[176:179], v[208:211], v[64:67]
    v_mfma_f32_16x16x32_bf16 v[68:71], v[176:179], v[212:215], v[68:71]
    ds_read_b64_tr_b16 v[128:129], v233 offset:28800
    v_mfma_f32_16x16x32_bf16 v[72:75], v[176:179], v[216:219], v[72:75]
    ds_read_b64_tr_b16 v[130:131], v233 offset:32384
    v_mfma_f32_16x16x32_bf16 v[76:79], v[176:179], v[220:223], v[76:79]
    ds_read_b64_tr_b16 v[144:145], v233 offset:43200
    v_mfma_f32_16x16x32_bf16 v[16:19], v[164:167], v[208:211], v[16:19]
    v_mfma_f32_16x16x32_bf16 v[20:23], v[164:167], v[212:215], v[20:23]
    ds_read_b64_tr_b16 v[146:147], v233 offset:46784
    v_mfma_f32_16x16x32_bf16 v[24:27], v[164:167], v[216:219], v[24:27]
    ds_read_b64_tr_b16 v[132:133], v233 offset:28832
    v_mfma_f32_16x16x32_bf16 v[28:31], v[164:167], v[220:223], v[28:31]
    ds_read_b64_tr_b16 v[134:135], v233 offset:32416
    v_mfma_f32_16x16x32_bf16 v[80:83], v[180:183], v[208:211], v[80:83]
    v_mfma_f32_16x16x32_bf16 v[84:87], v[180:183], v[212:215], v[84:87]
    ds_read_b64_tr_b16 v[148:149], v233 offset:43232
    v_mfma_f32_16x16x32_bf16 v[88:91], v[180:183], v[216:219], v[88:91]
    ds_read_b64_tr_b16 v[150:151], v233 offset:46816
    v_mfma_f32_16x16x32_bf16 v[92:95], v[180:183], v[220:223], v[92:95]
    ds_read_b64_tr_b16 v[136:137], v233 offset:28864
    v_mfma_f32_16x16x32_bf16 v[32:35], v[168:171], v[208:211], v[32:35]
    ds_read_b64_tr_b16 v[138:139], v233 offset:32448
    v_mfma_f32_16x16x32_bf16 v[36:39], v[168:171], v[212:215], v[36:39]
    v_lshlrev_b32 v247, 7, v250
    s_add_u32 s29, s3, 8
    s_lshl_b32 s30, s29, 12
    s_add_u32 s30, s30, s25
    s_cmp_lt_u32 s29, s27
    s_cselect_b32 s30, s30, 0x7f000000
    s_mov_b64 exec, 0xffffffff
    buffer_load_dword v248, v247, s[80:83], s30 offen sc1
    s_mov_b64 exec, -1
    v_mfma_f32_16x16x32_bf16 v[40:43], v[168:171], v[216:219], v[40:43]
    ds_read_b64_tr_b16 v[152:153], v233 offset:43264
    v_mfma_f32_16x16x32_bf16 v[44:47], v[168:171], v[220:223], v[44:47]
    ds_read_b64_tr_b16 v[154:155], v233 offset:46848
    v_mfma_f32_16x16x32_bf16 v[96:99], v[184:187], v[208:211], v[96:99]
    ds_read_b64_tr_b16 v[140:141], v233 offset:28896
    v_mfma_f32_16x16x32_bf16 v[100:103], v[184:187], v[212:215], v[100:103]
    v_mfma_f32_16x16x32_bf16 v[104:107], v[184:187], v[216:219], v[104:107]
    ds_read_b64_tr_b16 v[142:143], v233 offset:32480
    v_mfma_f32_16x16x32_bf16 v[108:111], v[184:187], v[220:223], v[108:111]
    ds_read_b64_tr_b16 v[156:157], v233 offset:43296
    v_mfma_f32_16x16x32_bf16 v[48:51], v[172:175], v[208:211], v[48:51]
    ds_read_b64_tr_b16 v[158:159], v233 offset:46880
    v_mfma_f32_16x16x32_bf16 v[52:55], v[172:175], v[212:215], v[52:55]
    v_mfma_f32_16x16x32_bf16 v[56:59], v[172:175], v[216:219], v[56:59]
    v_mfma_f32_16x16x32_bf16 v[60:63], v[172:175], v[220:223], v[60:63]
    v_mfma_f32_16x16x32_bf16 v[112:115], v[188:191], v[208:211], v[112:115]
    v_mfma_f32_16x16x32_bf16 v[116:119], v[188:191], v[212:215], v[116:119]
    v_mfma_f32_16x16x32_bf16 v[120:123], v[188:191], v[216:219], v[120:123]
    v_mfma_f32_16x16x32_bf16 v[124:127], v[188:191], v[220:223], v[124:127]
    s_waitcnt vmcnt(2) lgkmcnt(0)
    s_barrier
    s_setprio 2
    v_mfma_f32_16x16x32_bf16 v[0:3], v[128:131], v[192:195], v[0:3]
    ds_read_b128 v[208:211], v231 offset:24576
    ds_read_b128 v[212:215], v231 offset:25600
    v_mfma_f32_16x16x32_bf16 v[4:7], v[128:131], v[196:199], v[4:7]
    ds_read_b128 v[216:219], v231 offset:26624
    v_mfma_f32_16x16x32_bf16 v[8:11], v[128:131], v[200:203], v[8:11]
    ds_read_b128 v[220:223], v231 offset:27648
    ds_read_b64_tr_b16 v[160:161], v232 offset:0
    v_mfma_f32_16x16x32_bf16 v[12:15], v[128:131], v[204:207], v[12:15]
    ds_read_b64_tr_b16 v[162:163], v232 offset:3584
    v_mfma_f32_16x16x32_bf16 v[64:67], v[144:147], v[192:195], v[64:67]
    ds_read_b64_tr_b16 v[176:177], v232 offset:14400
    ds_read_b64_tr_b16 v[178:179], v232 offset:17984
    v_mfma_f32_16x16x32_bf16 v[68:71], v[144:147], v[196:199], v[68:71]
    ds_read_b64_tr_b16 v[164:165], v232 offset:32
    v_mfma_f32_16x16x32_bf16 v[72:75], v[144:147], v[200:203], v[72:75]
    ds_read_b64_tr_b16 v[166:167], v232 offset:3616
    v_mfma_f32_16x16x32_bf16 v[76:79], v[144:147], v[204:207], v[76:79]
    ds_read_b64_tr_b16 v[180:181], v232 offset:14432
    ds_read_b64_tr_b16 v[182:183], v232 offset:18016
    v_mfma_f32_16x16x32_bf16 v[16:19], v[132:135], v[192:195], v[16:19]
    ds_read_b64_tr_b16 v[168:169], v232 offset:64
    v_mfma_f32_16x16x32_bf16 v[20:23], v[132:135], v[196:199], v[20:23]
    ds_read_b64_tr_b16 v[170:171], v232 offset:3648
    ds_read_b64_tr_b16 v[184:185], v232 offset:14464
    v_mfma_f32_16x16x32_bf16 v[24:27], v[132:135], v[200:203], v[24:27]
    ds_read_b64_tr_b16 v[186:187], v232 offset:18048
    v_mfma_f32_16x16x32_bf16 v[28:31], v[132:135], v[204:207], v[28:31]
    ds_read_b64_tr_b16 v[172:173], v232 offset:96
    ds_read_b64_tr_b16 v[174:175], v232 offset:3680
    v_mfma_f32_16x16x32_bf16 v[80:83], v[148:151], v[192:195], v[80:83]
    ds_read_b64_tr_b16 v[188:189], v232 offset:14496
    v_mfma_f32_16x16x32_bf16 v[84:87], v[148:151], v[196:199], v[84:87]
    ds_read_b64_tr_b16 v[190:191], v232 offset:18080
    v_mfma_f32_16x16x32_bf16 v[88:91], v[148:151], v[200:203], v[88:91]
    v_mfma_f32_16x16x32_bf16 v[92:95], v[148:151], v[204:207], v[92:95]
    v_mfma_f32_16x16x32_bf16 v[32:35], v[136:139], v[192:195], v[32:35]
    v_mfma_f32_16x16x32_bf16 v[36:39], v[136:139], v[196:199], v[36:39]
    v_mfma_f32_16x16x32_bf16 v[40:43], v[136:139], v[200:203], v[40:43]
    v_mfma_f32_16x16x32_bf16 v[44:47], v[136:139], v[204:207], v[44:47]
    v_mfma_f32_16x16x32_bf16 v[96:99], v[152:155], v[192:195], v[96:99]
    s_waitcnt lgkmcnt(0)
    s_barrier
    v_mfma_f32_16x16x32_bf16 v[100:103], v[152:155], v[196:199], v[100:103]
    v_mfma_f32_16x16x32_bf16 v[104:107], v[152:155], v[200:203], v[104:107]
    v_mfma_f32_16x16x32_bf16 v[108:111], v[152:155], v[204:207], v[108:111]
    v_mfma_f32_16x16x32_bf16 v[48:51], v[140:143], v[192:195], v[48:51]
    v_mfma_f32_16x16x32_bf16 v[52:55], v[140:143], v[196:199], v[52:55]
    v_mfma_f32_16x16x32_bf16 v[56:59], v[140:143], v[200:203], v[56:59]
    v_mfma_f32_16x16x32_bf16 v[60:63], v[140:143], v[204:207], v[60:63]
    v_mfma_f32_16x16x32_bf16 v[112:115], v[156:159], v[192:195], v[112:115]
    v_mfma_f32_16x16x32_bf16 v[116:119], v[156:159], v[196:199], v[116:119]
    v_mfma_f32_16x16x32_bf16 v[120:123], v[156:159], v[200:203], v[120:123]
    v_mfma_f32_16x16x32_bf16 v[124:127], v[156:159], v[204:207], v[124:127]
    s_and_b32 s64, s3, 1
    s_lshl_b32 s64, s64, 9
    s_add_u32 s64, s64, 159744
    v_lshlrev_b32 v253, 3, v252
    v_add_u32 v253, s64, v253
    s_lshl_b32 s64, s28, 6
    s_add_u32 s64, s64, 160896
    v_lshlrev_b32 v254, 4, v251
    v_add_u32 v231, s64, v254
    v_mfma_f32_16x16x32_bf16 v[0:3], v[160:163], v[208:211], v[0:3]
    ds_read_b64 v[192:193], v253 offset:0
    v_mfma_f32_16x16x32_bf16 v[4:7], v[160:163], v[212:215], v[4:7]
    ds_read_b64 v[194:195], v253 offset:128
    v_mfma_f32_16x16x32_bf16 v[8:11], v[160:163], v[216:219], v[8:11]
    ds_read_b64 v[196:197], v253 offset:256
    v_mfma_f32_16x16x32_bf16 v[12:15], v[160:163], v[220:223], v[12:15]
    v_mfma_f32_16x16x32_bf16 v[64:67], v[176:179], v[208:211], v[64:67]
    ds_read_b64 v[198:199], v253 offset:384
    v_mfma_f32_16x16x32_bf16 v[68:71], v[176:179], v[212:215], v[68:71]
    ds_read_b128 v[128:131], v231 offset:0
    v_mfma_f32_16x16x32_bf16 v[72:75], v[176:179], v[216:219], v[72:75]
    v_mfma_f32_16x16x32_bf16 v[76:79], v[176:179], v[220:223], v[76:79]
    ds_read_b128 v[132:135], v231 offset:64
    v_mfma_f32_16x16x32_bf16 v[16:19], v[164:167], v[208:211], v[16:19]
    ds_read_b128 v[136:139], v231 offset:128
    v_mfma_f32_16x16x32_bf16 v[20:23], v[164:167], v[212:215], v[20:23]
    ds_read_b128 v[140:143], v231 offset:192
    v_mfma_f32_16x16x32_bf16 v[24:27], v[164:167], v[216:219], v[24:27]
    v_mfma_f32_16x16x32_bf16 v[28:31], v[164:167], v[220:223], v[28:31]
    ds_read_b128 v[144:147], v231 offset:896
    v_mfma_f32_16x16x32_bf16 v[80:83], v[180:183], v[208:211], v[80:83]
    ds_read_b128 v[148:151], v231 offset:960
    v_mfma_f32_16x16x32_bf16 v[84:87], v[180:183], v[212:215], v[84:87]
    v_mfma_f32_16x16x32_bf16 v[88:91], v[180:183], v[216:219], v[88:91]
    ds_read_b128 v[152:155], v231 offset:1024
    v_mfma_f32_16x16x32_bf16 v[92:95], v[180:183], v[220:223], v[92:95]
    ds_read_b128 v[156:159], v231 offset:1088
    v_mfma_f32_16x16x32_bf16 v[32:35], v[168:171], v[208:211], v[32:35]
    v_mfma_f32_16x16x32_bf16 v[36:39], v[168:171], v[212:215], v[36:39]
    v_mfma_f32_16x16x32_bf16 v[40:43], v[168:171], v[216:219], v[40:43]
    v_mfma_f32_16x16x32_bf16 v[44:47], v[168:171], v[220:223], v[44:47]
    v_mfma_f32_16x16x32_bf16 v[96:99], v[184:187], v[208:211], v[96:99]
    v_mfma_f32_16x16x32_bf16 v[100:103], v[184:187], v[212:215], v[100:103]
    v_mfma_f32_16x16x32_bf16 v[104:107], v[184:187], v[216:219], v[104:107]
    v_mfma_f32_16x16x32_bf16 v[108:111], v[184:187], v[220:223], v[108:111]
    v_mfma_f32_16x16x32_bf16 v[48:51], v[172:175], v[208:211], v[48:51]
    v_mfma_f32_16x16x32_bf16 v[52:55], v[172:175], v[212:215], v[52:55]
    v_mfma_f32_16x16x32_bf16 v[56:59], v[172:175], v[216:219], v[56:59]
    v_mfma_f32_16x16x32_bf16 v[60:63], v[172:175], v[220:223], v[60:63]
    v_mfma_f32_16x16x32_bf16 v[112:115], v[188:191], v[208:211], v[112:115]
    v_mfma_f32_16x16x32_bf16 v[116:119], v[188:191], v[212:215], v[116:119]
    v_mfma_f32_16x16x32_bf16 v[120:123], v[188:191], v[216:219], v[120:123]
    v_mfma_f32_16x16x32_bf16 v[124:127], v[188:191], v[220:223], v[124:127]
    s_setprio 0
    s_and_b32 s64, s3, 1
    s_lshl_b32 s64, s64, 12
    s_add_u32 s25, s25, s64
    s_lshr_b32 s64, s69, 1
    s_lshl_b32 s64, s64, 14
    s_add_u32 s25, s25, s64
    s_add_u32 s26, s25, 8192
    s_and_b32 s64, s3, 1
    s_lshl_b32 s64, s64, 12
    s_lshr_b32 s65, s69, 1
    s_lshl_b32 s65, s65, 14
    s_add_u32 s64, s64, s65
    v_add_u32 v233, s64, v249
    v_add_u16 v232, 0xe000, v233
    s_waitcnt lgkmcnt(0)
    s_mov_b32 s64, 0xbfb8aa3b
    v_mul_f32 v176, v193, v193
    v_sub_f32 v160, 0, v192
    v_mul_f32 v168, s64, v193
    v_sub_f32 v161, 0, v192
    v_mul_f32 v169, s64, v193
    v_mul_f32 v178, v195, v195
    v_sub_f32 v162, 0, v194
    v_mul_f32 v170, s64, v195
    v_sub_f32 v163, 0, v194
    v_mul_f32 v171, s64, v195
    v_mul_f32 v180, v197, v197
    v_sub_f32 v164, 0, v196
    v_mul_f32 v172, s64, v197
    v_sub_f32 v165, 0, v196
    v_mul_f32 v173, s64, v197
    v_mul_f32 v182, v199, v199
    v_sub_f32 v166, 0, v198
    v_mul_f32 v174, s64, v199
    v_sub_f32 v167, 0, v198
    v_mul_f32 v175, s64, v199
    v_rcp_f32 v177, v176
    v_rcp_f32 v176, v176
    v_rcp_f32 v179, v178
    v_rcp_f32 v178, v178
    v_rcp_f32 v181, v180
    v_rcp_f32 v180, v180
    v_rcp_f32 v183, v182
    v_rcp_f32 v182, v182
    v_pk_fma_f32 v[0:1], v[160:161], v[128:129], v[0:1]
    v_pk_fma_f32 v[2:3], v[160:161], v[130:131], v[2:3]
    v_pk_mul_f32 v[212:213], v[168:169], v[0:1]
    v_pk_mul_f32 v[214:215], v[168:169], v[2:3]
    v_exp_f32 v212, v212
    v_exp_f32 v213, v213
    v_exp_f32 v214, v214
    v_exp_f32 v215, v215
    v_pk_fma_f32 v[64:65], v[160:161], v[144:145], v[64:65]
    v_pk_fma_f32 v[66:67], v[160:161], v[146:147], v[66:67]
    v_pk_fma_f32 v[212:213], v[212:213], v[176:177], v[176:177]
    v_pk_fma_f32 v[214:215], v[214:215], v[176:177], v[176:177]
    v_rcp_f32 v212, v212
    v_rcp_f32 v213, v213
    v_rcp_f32 v214, v214
    v_rcp_f32 v215, v215
    v_pk_mul_f32 v[0:1], v[0:1], v[64:65]
    v_pk_mul_f32 v[2:3], v[2:3], v[66:67]
    v_pk_mul_f32 v[0:1], v[0:1], v[212:213]
    v_pk_mul_f32 v[2:3], v[2:3], v[214:215]
    v_cvt_pk_bf16_f32 v216, v0, v1
    v_cvt_pk_bf16_f32 v217, v2, v3
    v_pk_fma_f32 v[16:17], v[160:161], v[132:133], v[16:17]
    v_pk_fma_f32 v[18:19], v[160:161], v[134:135], v[18:19]
    v_pk_mul_f32 v[212:213], v[168:169], v[16:17]
    v_pk_mul_f32 v[214:215], v[168:169], v[18:19]
    v_exp_f32 v212, v212
    v_exp_f32 v213, v213
    v_exp_f32 v214, v214
    v_exp_f32 v215, v215
    v_pk_fma_f32 v[80:81], v[160:161], v[148:149], v[80:81]
    v_pk_fma_f32 v[82:83], v[160:161], v[150:151], v[82:83]
    v_pk_fma_f32 v[212:213], v[212:213], v[176:177], v[176:177]
    v_pk_fma_f32 v[214:215], v[214:215], v[176:177], v[176:177]
    v_rcp_f32 v212, v212
    v_rcp_f32 v213, v213
    v_rcp_f32 v214, v214
    v_rcp_f32 v215, v215
    v_pk_mul_f32 v[16:17], v[16:17], v[80:81]
    v_pk_mul_f32 v[18:19], v[18:19], v[82:83]
    v_pk_mul_f32 v[16:17], v[16:17], v[212:213]
    v_pk_mul_f32 v[18:19], v[18:19], v[214:215]
    v_cvt_pk_bf16_f32 v218, v16, v17
    v_cvt_pk_bf16_f32 v219, v18, v19
    buffer_store_dwordx4 v[216:219], v249, s[80:83], s25 offen offset:0
    ds_write_b128 v232, v[216:219] offset:0
    v_pk_fma_f32 v[32:33], v[160:161], v[136:137], v[32:33]
    v_pk_fma_f32 v[34:35], v[160:161], v[138:139], v[34:35]
    v_pk_mul_f32 v[212:213], v[168:169], v[32:33]
    v_pk_mul_f32 v[214:215], v[168:169], v[34:35]
    v_exp_f32 v212, v212
    v_exp_f32 v213, v213
    v_exp_f32 v214, v214
    v_exp_f32 v215, v215
    v_pk_fma_f32 v[96:97], v[160:161], v[152:153], v[96:97]
    v_pk_fma_f32 v[98:99], v[160:161], v[154:155], v[98:99]
    v_pk_fma_f32 v[212:213], v[212:213], v[176:177], v[176:177]
    v_pk_fma_f32 v[214:215], v[214:215], v[176:177], v[176:177]
    v_rcp_f32 v212, v212
    v_rcp_f32 v213, v213
    v_rcp_f32 v214, v214
    v_rcp_f32 v215, v215
    v_pk_mul_f32 v[32:33], v[32:33], v[96:97]
    v_pk_mul_f32 v[34:35], v[34:35], v[98:99]
    v_pk_mul_f32 v[32:33], v[32:33], v[212:213]
    v_pk_mul_f32 v[34:35], v[34:35], v[214:215]
    v_cvt_pk_bf16_f32 v220, v32, v33
    v_cvt_pk_bf16_f32 v221, v34, v35
    v_pk_fma_f32 v[48:49], v[160:161], v[140:141], v[48:49]
    v_pk_fma_f32 v[50:51], v[160:161], v[142:143], v[50:51]
    v_pk_mul_f32 v[212:213], v[168:169], v[48:49]
    v_pk_mul_f32 v[214:215], v[168:169], v[50:51]
    v_exp_f32 v212, v212
    v_exp_f32 v213, v213
    v_exp_f32 v214, v214
    v_exp_f32 v215, v215
    v_pk_fma_f32 v[112:113], v[160:161], v[156:157], v[112:113]
    v_pk_fma_f32 v[114:115], v[160:161], v[158:159], v[114:115]
    v_pk_fma_f32 v[212:213], v[212:213], v[176:177], v[176:177]
    v_pk_fma_f32 v[214:215], v[214:215], v[176:177], v[176:177]
    v_rcp_f32 v212, v212
    v_rcp_f32 v213, v213
    v_rcp_f32 v214, v214
    v_rcp_f32 v215, v215
    v_pk_mul_f32 v[48:49], v[48:49], v[112:113]
    v_pk_mul_f32 v[50:51], v[50:51], v[114:115]
    v_pk_mul_f32 v[48:49], v[48:49], v[212:213]
    v_pk_mul_f32 v[50:51], v[50:51], v[214:215]
    v_cvt_pk_bf16_f32 v222, v48, v49
    v_cvt_pk_bf16_f32 v223, v50, v51
    buffer_store_dwordx4 v[220:223], v249, s[80:83], s26 offen offset:0
    ds_write_b128 v233, v[220:223] offset:0
    v_pk_fma_f32 v[4:5], v[162:163], v[128:129], v[4:5]
    v_pk_fma_f32 v[6:7], v[162:163], v[130:131], v[6:7]
    v_pk_mul_f32 v[212:213], v[170:171], v[4:5]
    v_pk_mul_f32 v[214:215], v[170:171], v[6:7]
    v_exp_f32 v212, v212
    v_exp_f32 v213, v213
    v_exp_f32 v214, v214
    v_exp_f32 v215, v215
    v_pk_fma_f32 v[68:69], v[162:163], v[144:145], v[68:69]
    v_pk_fma_f32 v[70:71], v[162:163], v[146:147], v[70:71]
    v_pk_fma_f32 v[212:213], v[212:213], v[178:179], v[178:179]
    v_pk_fma_f32 v[214:215], v[214:215], v[178:179], v[178:179]
    v_rcp_f32 v212, v212
    v_rcp_f32 v213, v213
    v_rcp_f32 v214, v214
    v_rcp_f32 v215, v215
    v_pk_mul_f32 v[4:5], v[4:5], v[68:69]
    v_pk_mul_f32 v[6:7], v[6:7], v[70:71]
    v_pk_mul_f32 v[4:5], v[4:5], v[212:213]
    v_pk_mul_f32 v[6:7], v[6:7], v[214:215]
    v_cvt_pk_bf16_f32 v216, v4, v5
    v_cvt_pk_bf16_f32 v217, v6, v7
    v_pk_fma_f32 v[20:21], v[162:163], v[132:133], v[20:21]
    v_pk_fma_f32 v[22:23], v[162:163], v[134:135], v[22:23]
    v_pk_mul_f32 v[212:213], v[170:171], v[20:21]
    v_pk_mul_f32 v[214:215], v[170:171], v[22:23]
    v_exp_f32 v212, v212
    v_exp_f32 v213, v213
    v_exp_f32 v214, v214
    v_exp_f32 v215, v215
    v_pk_fma_f32 v[84:85], v[162:163], v[148:149], v[84:85]
    v_pk_fma_f32 v[86:87], v[162:163], v[150:151], v[86:87]
    v_pk_fma_f32 v[212:213], v[212:213], v[178:179], v[178:179]
    v_pk_fma_f32 v[214:215], v[214:215], v[178:179], v[178:179]
    v_rcp_f32 v212, v212
    v_rcp_f32 v213, v213
    v_rcp_f32 v214, v214
    v_rcp_f32 v215, v215
    v_pk_mul_f32 v[20:21], v[20:21], v[84:85]
    v_pk_mul_f32 v[22:23], v[22:23], v[86:87]
    v_pk_mul_f32 v[20:21], v[20:21], v[212:213]
    v_pk_mul_f32 v[22:23], v[22:23], v[214:215]
    v_cvt_pk_bf16_f32 v218, v20, v21
    v_cvt_pk_bf16_f32 v219, v22, v23
    buffer_store_dwordx4 v[216:219], v249, s[80:83], s25 offen offset:1024
    ds_write_b128 v232, v[216:219] offset:1024
    v_pk_fma_f32 v[36:37], v[162:163], v[136:137], v[36:37]
    v_pk_fma_f32 v[38:39], v[162:163], v[138:139], v[38:39]
    v_pk_mul_f32 v[212:213], v[170:171], v[36:37]
    v_pk_mul_f32 v[214:215], v[170:171], v[38:39]
    v_exp_f32 v212, v212
    v_exp_f32 v213, v213
    v_exp_f32 v214, v214
    v_exp_f32 v215, v215
    v_pk_fma_f32 v[100:101], v[162:163], v[152:153], v[100:101]
    v_pk_fma_f32 v[102:103], v[162:163], v[154:155], v[102:103]
    v_pk_fma_f32 v[212:213], v[212:213], v[178:179], v[178:179]
    v_pk_fma_f32 v[214:215], v[214:215], v[178:179], v[178:179]
    v_rcp_f32 v212, v212
    v_rcp_f32 v213, v213
    v_rcp_f32 v214, v214
    v_rcp_f32 v215, v215
    v_pk_mul_f32 v[36:37], v[36:37], v[100:101]
    v_pk_mul_f32 v[38:39], v[38:39], v[102:103]
    v_pk_mul_f32 v[36:37], v[36:37], v[212:213]
    v_pk_mul_f32 v[38:39], v[38:39], v[214:215]
    v_cvt_pk_bf16_f32 v220, v36, v37
    v_cvt_pk_bf16_f32 v221, v38, v39
    v_pk_fma_f32 v[52:53], v[162:163], v[140:141], v[52:53]
    v_pk_fma_f32 v[54:55], v[162:163], v[142:143], v[54:55]
    v_pk_mul_f32 v[212:213], v[170:171], v[52:53]
    v_pk_mul_f32 v[214:215], v[170:171], v[54:55]
    v_exp_f32 v212, v212
    v_exp_f32 v213, v213
    v_exp_f32 v214, v214
    v_exp_f32 v215, v215
    v_pk_fma_f32 v[116:117], v[162:163], v[156:157], v[116:117]
    v_pk_fma_f32 v[118:119], v[162:163], v[158:159], v[118:119]
    v_pk_fma_f32 v[212:213], v[212:213], v[178:179], v[178:179]
    v_pk_fma_f32 v[214:215], v[214:215], v[178:179], v[178:179]
    v_rcp_f32 v212, v212
    v_rcp_f32 v213, v213
    v_rcp_f32 v214, v214
    v_rcp_f32 v215, v215
    v_pk_mul_f32 v[52:53], v[52:53], v[116:117]
    v_pk_mul_f32 v[54:55], v[54:55], v[118:119]
    v_pk_mul_f32 v[52:53], v[52:53], v[212:213]
    v_pk_mul_f32 v[54:55], v[54:55], v[214:215]
    v_cvt_pk_bf16_f32 v222, v52, v53
    v_cvt_pk_bf16_f32 v223, v54, v55
    buffer_store_dwordx4 v[220:223], v249, s[80:83], s26 offen offset:1024
    ds_write_b128 v233, v[220:223] offset:1024
    v_pk_fma_f32 v[8:9], v[164:165], v[128:129], v[8:9]
    v_pk_fma_f32 v[10:11], v[164:165], v[130:131], v[10:11]
    v_pk_mul_f32 v[212:213], v[172:173], v[8:9]
    v_pk_mul_f32 v[214:215], v[172:173], v[10:11]
    v_exp_f32 v212, v212
    v_exp_f32 v213, v213
    v_exp_f32 v214, v214
    v_exp_f32 v215, v215
    v_pk_fma_f32 v[72:73], v[164:165], v[144:145], v[72:73]
    v_pk_fma_f32 v[74:75], v[164:165], v[146:147], v[74:75]
    v_pk_fma_f32 v[212:213], v[212:213], v[180:181], v[180:181]
    v_pk_fma_f32 v[214:215], v[214:215], v[180:181], v[180:181]
    v_rcp_f32 v212, v212
    v_rcp_f32 v213, v213
    v_rcp_f32 v214, v214
    v_rcp_f32 v215, v215
    v_pk_mul_f32 v[8:9], v[8:9], v[72:73]
    v_pk_mul_f32 v[10:11], v[10:11], v[74:75]
    v_pk_mul_f32 v[8:9], v[8:9], v[212:213]
    v_pk_mul_f32 v[10:11], v[10:11], v[214:215]
    v_cvt_pk_bf16_f32 v216, v8, v9
    v_cvt_pk_bf16_f32 v217, v10, v11
    v_pk_fma_f32 v[24:25], v[164:165], v[132:133], v[24:25]
    v_pk_fma_f32 v[26:27], v[164:165], v[134:135], v[26:27]
    v_pk_mul_f32 v[212:213], v[172:173], v[24:25]
    v_pk_mul_f32 v[214:215], v[172:173], v[26:27]
    v_exp_f32 v212, v212
    v_exp_f32 v213, v213
    v_exp_f32 v214, v214
    v_exp_f32 v215, v215
    v_pk_fma_f32 v[88:89], v[164:165], v[148:149], v[88:89]
    v_pk_fma_f32 v[90:91], v[164:165], v[150:151], v[90:91]
    v_pk_fma_f32 v[212:213], v[212:213], v[180:181], v[180:181]
    v_pk_fma_f32 v[214:215], v[214:215], v[180:181], v[180:181]
    v_rcp_f32 v212, v212
    v_rcp_f32 v213, v213
    v_rcp_f32 v214, v214
    v_rcp_f32 v215, v215
    v_pk_mul_f32 v[24:25], v[24:25], v[88:89]
    v_pk_mul_f32 v[26:27], v[26:27], v[90:91]
    v_pk_mul_f32 v[24:25], v[24:25], v[212:213]
    v_pk_mul_f32 v[26:27], v[26:27], v[214:215]
    v_cvt_pk_bf16_f32 v218, v24, v25
    v_cvt_pk_bf16_f32 v219, v26, v27
    buffer_store_dwordx4 v[216:219], v249, s[80:83], s25 offen offset:2048
    ds_write_b128 v232, v[216:219] offset:2048
    v_pk_fma_f32 v[40:41], v[164:165], v[136:137], v[40:41]
    v_pk_fma_f32 v[42:43], v[164:165], v[138:139], v[42:43]
    v_pk_mul_f32 v[212:213], v[172:173], v[40:41]
    v_pk_mul_f32 v[214:215], v[172:173], v[42:43]
    v_exp_f32 v212, v212
    v_exp_f32 v213, v213
    v_exp_f32 v214, v214
    v_exp_f32 v215, v215
    v_pk_fma_f32 v[104:105], v[164:165], v[152:153], v[104:105]
    v_pk_fma_f32 v[106:107], v[164:165], v[154:155], v[106:107]
    v_pk_fma_f32 v[212:213], v[212:213], v[180:181], v[180:181]
    v_pk_fma_f32 v[214:215], v[214:215], v[180:181], v[180:181]
    v_rcp_f32 v212, v212
    v_rcp_f32 v213, v213
    v_rcp_f32 v214, v214
    v_rcp_f32 v215, v215
    v_pk_mul_f32 v[40:41], v[40:41], v[104:105]
    v_pk_mul_f32 v[42:43], v[42:43], v[106:107]
    v_pk_mul_f32 v[40:41], v[40:41], v[212:213]
    v_pk_mul_f32 v[42:43], v[42:43], v[214:215]
    v_cvt_pk_bf16_f32 v220, v40, v41
    v_cvt_pk_bf16_f32 v221, v42, v43
    v_pk_fma_f32 v[56:57], v[164:165], v[140:141], v[56:57]
    v_pk_fma_f32 v[58:59], v[164:165], v[142:143], v[58:59]
    v_pk_mul_f32 v[212:213], v[172:173], v[56:57]
    v_pk_mul_f32 v[214:215], v[172:173], v[58:59]
    v_exp_f32 v212, v212
    v_exp_f32 v213, v213
    v_exp_f32 v214, v214
    v_exp_f32 v215, v215
    v_pk_fma_f32 v[120:121], v[164:165], v[156:157], v[120:121]
    v_pk_fma_f32 v[122:123], v[164:165], v[158:159], v[122:123]
    v_pk_fma_f32 v[212:213], v[212:213], v[180:181], v[180:181]
    v_pk_fma_f32 v[214:215], v[214:215], v[180:181], v[180:181]
    v_rcp_f32 v212, v212
    v_rcp_f32 v213, v213
    v_rcp_f32 v214, v214
    v_rcp_f32 v215, v215
    v_pk_mul_f32 v[56:57], v[56:57], v[120:121]
    v_pk_mul_f32 v[58:59], v[58:59], v[122:123]
    v_pk_mul_f32 v[56:57], v[56:57], v[212:213]
    v_pk_mul_f32 v[58:59], v[58:59], v[214:215]
    v_cvt_pk_bf16_f32 v222, v56, v57
    v_cvt_pk_bf16_f32 v223, v58, v59
    buffer_store_dwordx4 v[220:223], v249, s[80:83], s26 offen offset:2048
    ds_write_b128 v233, v[220:223] offset:2048
    v_pk_fma_f32 v[12:13], v[166:167], v[128:129], v[12:13]
    v_pk_fma_f32 v[14:15], v[166:167], v[130:131], v[14:15]
    v_pk_mul_f32 v[212:213], v[174:175], v[12:13]
    v_pk_mul_f32 v[214:215], v[174:175], v[14:15]
    v_exp_f32 v212, v212
    v_exp_f32 v213, v213
    v_exp_f32 v214, v214
    v_exp_f32 v215, v215
    v_pk_fma_f32 v[76:77], v[166:167], v[144:145], v[76:77]
    v_pk_fma_f32 v[78:79], v[166:167], v[146:147], v[78:79]
    v_pk_fma_f32 v[212:213], v[212:213], v[182:183], v[182:183]
    v_pk_fma_f32 v[214:215], v[214:215], v[182:183], v[182:183]
    v_rcp_f32 v212, v212
    v_rcp_f32 v213, v213
    v_rcp_f32 v214, v214
    v_rcp_f32 v215, v215
    v_pk_mul_f32 v[12:13], v[12:13], v[76:77]
    v_pk_mul_f32 v[14:15], v[14:15], v[78:79]
    v_pk_mul_f32 v[12:13], v[12:13], v[212:213]
    v_pk_mul_f32 v[14:15], v[14:15], v[214:215]
    v_cvt_pk_bf16_f32 v216, v12, v13
    v_cvt_pk_bf16_f32 v217, v14, v15
    v_pk_fma_f32 v[28:29], v[166:167], v[132:133], v[28:29]
    v_pk_fma_f32 v[30:31], v[166:167], v[134:135], v[30:31]
    v_pk_mul_f32 v[212:213], v[174:175], v[28:29]
    v_pk_mul_f32 v[214:215], v[174:175], v[30:31]
    v_exp_f32 v212, v212
    v_exp_f32 v213, v213
    v_exp_f32 v214, v214
    v_exp_f32 v215, v215
    v_pk_fma_f32 v[92:93], v[166:167], v[148:149], v[92:93]
    v_pk_fma_f32 v[94:95], v[166:167], v[150:151], v[94:95]
    v_pk_fma_f32 v[212:213], v[212:213], v[182:183], v[182:183]
    v_pk_fma_f32 v[214:215], v[214:215], v[182:183], v[182:183]
    v_rcp_f32 v212, v212
    v_rcp_f32 v213, v213
    v_rcp_f32 v214, v214
    v_rcp_f32 v215, v215
    v_pk_mul_f32 v[28:29], v[28:29], v[92:93]
    v_pk_mul_f32 v[30:31], v[30:31], v[94:95]
    v_pk_mul_f32 v[28:29], v[28:29], v[212:213]
    v_pk_mul_f32 v[30:31], v[30:31], v[214:215]
    v_cvt_pk_bf16_f32 v218, v28, v29
    v_cvt_pk_bf16_f32 v219, v30, v31
    buffer_store_dwordx4 v[216:219], v249, s[80:83], s25 offen offset:3072
    ds_write_b128 v232, v[216:219] offset:3072
    v_pk_fma_f32 v[44:45], v[166:167], v[136:137], v[44:45]
    v_pk_fma_f32 v[46:47], v[166:167], v[138:139], v[46:47]
    v_pk_mul_f32 v[212:213], v[174:175], v[44:45]
    v_pk_mul_f32 v[214:215], v[174:175], v[46:47]
    v_exp_f32 v212, v212
    v_exp_f32 v213, v213
    v_exp_f32 v214, v214
    v_exp_f32 v215, v215
    v_pk_fma_f32 v[108:109], v[166:167], v[152:153], v[108:109]
    v_pk_fma_f32 v[110:111], v[166:167], v[154:155], v[110:111]
    v_pk_fma_f32 v[212:213], v[212:213], v[182:183], v[182:183]
    v_pk_fma_f32 v[214:215], v[214:215], v[182:183], v[182:183]
    v_rcp_f32 v212, v212
    v_rcp_f32 v213, v213
    v_rcp_f32 v214, v214
    v_rcp_f32 v215, v215
    v_pk_mul_f32 v[44:45], v[44:45], v[108:109]
    v_pk_mul_f32 v[46:47], v[46:47], v[110:111]
    v_pk_mul_f32 v[44:45], v[44:45], v[212:213]
    v_pk_mul_f32 v[46:47], v[46:47], v[214:215]
    v_cvt_pk_bf16_f32 v220, v44, v45
    v_cvt_pk_bf16_f32 v221, v46, v47
    v_pk_fma_f32 v[60:61], v[166:167], v[140:141], v[60:61]
    v_pk_fma_f32 v[62:63], v[166:167], v[142:143], v[62:63]
    v_pk_mul_f32 v[212:213], v[174:175], v[60:61]
    v_pk_mul_f32 v[214:215], v[174:175], v[62:63]
    v_exp_f32 v212, v212
    v_exp_f32 v213, v213
    v_exp_f32 v214, v214
    v_exp_f32 v215, v215
    v_pk_fma_f32 v[124:125], v[166:167], v[156:157], v[124:125]
    v_pk_fma_f32 v[126:127], v[166:167], v[158:159], v[126:127]
    v_pk_fma_f32 v[212:213], v[212:213], v[182:183], v[182:183]
    v_pk_fma_f32 v[214:215], v[214:215], v[182:183], v[182:183]
    v_rcp_f32 v212, v212
    v_rcp_f32 v213, v213
    v_rcp_f32 v214, v214
    v_rcp_f32 v215, v215
    v_pk_mul_f32 v[60:61], v[60:61], v[124:125]
    v_pk_mul_f32 v[62:63], v[62:63], v[126:127]
    v_pk_mul_f32 v[60:61], v[60:61], v[212:213]
    v_pk_mul_f32 v[62:63], v[62:63], v[214:215]
    v_cvt_pk_bf16_f32 v222, v60, v61
    v_cvt_pk_bf16_f32 v223, v62, v63
    buffer_store_dwordx4 v[220:223], v249, s[80:83], s26 offen offset:3072
    ds_write_b128 v233, v[220:223] offset:3072
    s_lshr_b32 s64, s3, 1
    s_lshl_b32 s64, s64, 12
    s_add_u32 s64, s64, 49152
    v_add_u32 v240, s64, v249
    v_lshrrev_b32 v253, 2, v252
    v_and_b32 v254, 1, v251
    v_lshl_add_u32 v253, v254, 2, v253
    v_mul_u32_u24 v253, 1056, v253
    v_lshrrev_b32 v254, 1, v251
    v_lshl_add_u32 v253, v254, 8, v253
    v_and_b32 v254, 3, v252
    v_lshl_add_u32 v253, v254, 3, v253
    s_and_b32 s64, s3, 1
    s_lshl_b32 s64, s64, 6
    s_add_u32 s64, s64, 65536
    v_add_u32 v241, s64, v253
    s_mov_b32 s16, 33792
    v_add_u32 v242, s16, v241
    s_and_b32 s64, s3, 1
    s_lshl_b32 s64, s64, 13
    s_lshr_b32 s65, s3, 1
    s_lshl_b32 s65, s65, 12
    s_add_u32 s17, s64, s65
    s_lshl_b32 s19, s73, 4
    s_add_u32 s19, s19, s68
    s_lshl_b32 s19, s19, 14
    s_mul_i32 s66, s59, 4194304
    s_add_u32 s19, s19, s66
    s_add_u32 s19, s19, s17
    s_lshl_b32 s18, s73, 4
    s_add_u32 s18, s18, s68
    s_lshl_b32 s18, s18, 14
    s_mul_i32 s66, s60, 8388608
    s_add_u32 s18, s18, s66
    s_add_u32 s18, s18, s17
    buffer_load_dwordx4 v[128:131], v249, s[80:83], s18 offen offset:0 sc1
    buffer_load_dwordx4 v[132:135], v249, s[80:83], s18 offen offset:1024 sc1
    buffer_load_dwordx4 v[136:139], v249, s[80:83], s18 offen offset:2048 sc1
    buffer_load_dwordx4 v[140:143], v249, s[80:83], s18 offen offset:3072 sc1
    v_mov_b32 v208, 0
    v_mov_b32 v209, 0
    v_mov_b32 v210, 0
    v_mov_b32 v211, 0
    s_nop 1
    v_mfma_f32_32x32x16_bf16 v[0:15], v[208:211], v[208:211], 0
    v_mfma_f32_32x32x16_bf16 v[16:31], v[208:211], v[208:211], 0
    v_mfma_f32_32x32x16_bf16 v[32:47], v[208:211], v[208:211], 0
    v_mfma_f32_32x32x16_bf16 v[48:63], v[208:211], v[208:211], 0
    s_mov_b32 s17, 14
    s_lshl_b32 s64, s75, 15
    s_lshl_b32 s66, s73, 9
    s_add_u32 s64, s64, s66
    s_add_u32 s64, s64, 75513856
    s_lshl_b32 s65, s72, 5
    s_add_u32 s64, s64, s65
    s_lshl_b32 s65, s3, 2
    s_add_u32 s64, s64, s65
    v_mov_b32 v236, 0
    v_mov_b32 v237, 1
    s_cmp_lg_u32 s78, 0
    s_cbranch_scc1 sg_7_slow
    s_waitcnt vmcnt(4)
    s_mov_b64 exec, 1
    buffer_store_dword v237, v236, s[80:83], s64 offen
    s_mov_b64 exec, -1
sg_7_done:
    s_waitcnt lgkmcnt(0)
    s_barrier
    ds_read_b128 v[64:67], v240 offset:8192
    ds_read_b64_tr_b16 v[80:81], v242 offset:8448
    ds_read_b64_tr_b16 v[82:83], v242 offset:8960
    ds_read_b128 v[68:71], v240 offset:9216
    ds_read_b64_tr_b16 v[84:85], v242 offset:8480
    ds_read_b64_tr_b16 v[86:87], v242 offset:8992
    ds_read_b128 v[72:75], v240 offset:10240
    ds_read_b64_tr_b16 v[88:89], v242 offset:8576
    ds_read_b64_tr_b16 v[90:91], v242 offset:9088
    ds_read_b128 v[76:79], v240 offset:11264
    ds_read_b64_tr_b16 v[92:93], v242 offset:8608
    ds_read_b64_tr_b16 v[94:95], v242 offset:9120
    v_add_u16 v240, 0x4000, v240
    s_add_u32 s16, s16, 16896
    s_cmp_eq_u32 s16, 84480
    s_cselect_b32 s16, 0, s16
    v_add_u32 v242, s16, v241
    s_waitcnt lgkmcnt(0)
r3_loop:
    s_bitcmp1_b32 24576, s17
    s_cbranch_scc1 r3_nb0
    s_barrier
r3_nb0:
    v_mfma_f32_16x16x32_bf16 v[32:35], v[88:91], v[64:67], v[32:35]
    ds_read_b128 v[96:99], v240 offset:0
    ds_read_b64_tr_b16 v[112:113], v242 offset:0
    v_mfma_f32_16x16x32_bf16 v[36:39], v[88:91], v[68:71], v[36:39]
    ds_read_b64_tr_b16 v[114:115], v242 offset:512
    v_mfma_f32_16x16x32_bf16 v[40:43], v[88:91], v[72:75], v[40:43]
    ds_read_b128 v[100:103], v240 offset:1024
    v_mfma_f32_16x16x32_bf16 v[44:47], v[88:91], v[76:79], v[44:47]
    ds_read_b64_tr_b16 v[116:117], v242 offset:32
    v_mfma_f32_16x16x32_bf16 v[48:51], v[92:95], v[64:67], v[48:51]
    ds_read_b64_tr_b16 v[118:119], v242 offset:544
    v_mfma_f32_16x16x32_bf16 v[52:55], v[92:95], v[68:71], v[52:55]
    ds_read_b128 v[104:107], v240 offset:2048
    ds_read_b64_tr_b16 v[120:121], v242 offset:128
    v_mfma_f32_16x16x32_bf16 v[56:59], v[92:95], v[72:75], v[56:59]
    ds_read_b64_tr_b16 v[122:123], v242 offset:640
    v_mfma_f32_16x16x32_bf16 v[60:63], v[92:95], v[76:79], v[60:63]
    ds_read_b128 v[108:111], v240 offset:3072
    v_mfma_f32_16x16x32_bf16 v[0:3], v[80:83], v[64:67], v[0:3]
    ds_read_b64_tr_b16 v[124:125], v242 offset:160
    v_mfma_f32_16x16x32_bf16 v[4:7], v[80:83], v[68:71], v[4:7]
    ds_read_b64_tr_b16 v[126:127], v242 offset:672
    v_mfma_f32_16x16x32_bf16 v[8:11], v[80:83], v[72:75], v[8:11]
    v_mfma_f32_16x16x32_bf16 v[12:15], v[80:83], v[76:79], v[12:15]
    v_mfma_f32_16x16x32_bf16 v[16:19], v[84:87], v[64:67], v[16:19]
    v_mfma_f32_16x16x32_bf16 v[20:23], v[84:87], v[68:71], v[20:23]
    v_mfma_f32_16x16x32_bf16 v[24:27], v[84:87], v[72:75], v[24:27]
    v_mfma_f32_16x16x32_bf16 v[28:31], v[84:87], v[76:79], v[28:31]
    s_waitcnt lgkmcnt(0)
    v_mfma_f32_16x16x32_bf16 v[32:35], v[120:123], v[96:99], v[32:35]
    ds_read_b128 v[64:67], v240 offset:8192
    ds_read_b64_tr_b16 v[80:81], v242 offset:8448
    v_mfma_f32_16x16x32_bf16 v[36:39], v[120:123], v[100:103], v[36:39]
    ds_read_b64_tr_b16 v[82:83], v242 offset:8960
    v_mfma_f32_16x16x32_bf16 v[40:43], v[120:123], v[104:107], v[40:43]
    ds_read_b128 v[68:71], v240 offset:9216
    v_mfma_f32_16x16x32_bf16 v[44:47], v[120:123], v[108:111], v[44:47]
    ds_read_b64_tr_b16 v[84:85], v242 offset:8480
    v_mfma_f32_16x16x32_bf16 v[48:51], v[124:127], v[96:99], v[48:51]
    ds_read_b64_tr_b16 v[86:87], v242 offset:8992
    v_mfma_f32_16x16x32_bf16 v[52:55], v[124:127], v[100:103], v[52:55]
    ds_read_b128 v[72:75], v240 offset:10240
    ds_read_b64_tr_b16 v[88:89], v242 offset:8576
    v_mfma_f32_16x16x32_bf16 v[56:59], v[124:127], v[104:107], v[56:59]
    ds_read_b64_tr_b16 v[90:91], v242 offset:9088
    v_mfma_f32_16x16x32_bf16 v[60:63], v[124:127], v[108:111], v[60:63]
    ds_read_b128 v[76:79], v240 offset:11264
    v_mfma_f32_16x16x32_bf16 v[0:3], v[112:115], v[96:99], v[0:3]
    ds_read_b64_tr_b16 v[92:93], v242 offset:8608
    v_mfma_f32_16x16x32_bf16 v[4:7], v[112:115], v[100:103], v[4:7]
    ds_read_b64_tr_b16 v[94:95], v242 offset:9120
    v_mfma_f32_16x16x32_bf16 v[8:11], v[112:115], v[104:107], v[8:11]
    v_add_u16 v240, 0x4000, v240
    v_mfma_f32_16x16x32_bf16 v[12:15], v[112:115], v[108:111], v[12:15]
    s_add_u32 s16, s16, 16896
    s_cmp_eq_u32 s16, 84480
    v_mfma_f32_16x16x32_bf16 v[16:19], v[116:119], v[96:99], v[16:19]
    s_cselect_b32 s16, 0, s16
    v_mfma_f32_16x16x32_bf16 v[20:23], v[116:119], v[100:103], v[20:23]
    v_add_u32 v242, s16, v241
    v_mfma_f32_16x16x32_bf16 v[24:27], v[116:119], v[104:107], v[24:27]
    v_mfma_f32_16x16x32_bf16 v[28:31], v[116:119], v[108:111], v[28:31]
    s_waitcnt lgkmcnt(0)
    s_bitcmp1_b32 2, s17
    s_cbranch_scc1 r3_nb1
    s_barrier
r3_nb1:
    v_mfma_f32_16x16x32_bf16 v[32:35], v[88:91], v[64:67], v[32:35]
    ds_read_b128 v[96:99], v240 offset:0
    ds_read_b64_tr_b16 v[112:113], v242 offset:0
    v_mfma_f32_16x16x32_bf16 v[36:39], v[88:91], v[68:71], v[36:39]
    ds_read_b64_tr_b16 v[114:115], v242 offset:512
    v_mfma_f32_16x16x32_bf16 v[40:43], v[88:91], v[72:75], v[40:43]
    ds_read_b128 v[100:103], v240 offset:1024
    v_mfma_f32_16x16x32_bf16 v[44:47], v[88:91], v[76:79], v[44:47]
    ds_read_b64_tr_b16 v[116:117], v242 offset:32
    v_mfma_f32_16x16x32_bf16 v[48:51], v[92:95], v[64:67], v[48:51]
    ds_read_b64_tr_b16 v[118:119], v242 offset:544
    v_mfma_f32_16x16x32_bf16 v[52:55], v[92:95], v[68:71], v[52:55]
    ds_read_b128 v[104:107], v240 offset:2048
    ds_read_b64_tr_b16 v[120:121], v242 offset:128
    v_mfma_f32_16x16x32_bf16 v[56:59], v[92:95], v[72:75], v[56:59]
    ds_read_b64_tr_b16 v[122:123], v242 offset:640
    v_mfma_f32_16x16x32_bf16 v[60:63], v[92:95], v[76:79], v[60:63]
    ds_read_b128 v[108:111], v240 offset:3072
    v_mfma_f32_16x16x32_bf16 v[0:3], v[80:83], v[64:67], v[0:3]
    ds_read_b64_tr_b16 v[124:125], v242 offset:160
    v_mfma_f32_16x16x32_bf16 v[4:7], v[80:83], v[68:71], v[4:7]
    ds_read_b64_tr_b16 v[126:127], v242 offset:672
    v_mfma_f32_16x16x32_bf16 v[8:11], v[80:83], v[72:75], v[8:11]
    v_mfma_f32_16x16x32_bf16 v[12:15], v[80:83], v[76:79], v[12:15]
    v_mfma_f32_16x16x32_bf16 v[16:19], v[84:87], v[64:67], v[16:19]
    v_mfma_f32_16x16x32_bf16 v[20:23], v[84:87], v[68:71], v[20:23]
    v_mfma_f32_16x16x32_bf16 v[24:27], v[84:87], v[72:75], v[24:27]
    v_mfma_f32_16x16x32_bf16 v[28:31], v[84:87], v[76:79], v[28:31]
    s_waitcnt lgkmcnt(0)
    v_mfma_f32_16x16x32_bf16 v[32:35], v[120:123], v[96:99], v[32:35]
    ds_read_b128 v[64:67], v240 offset:8192
    ds_read_b64_tr_b16 v[80:81], v242 offset:8448
    v_mfma_f32_16x16x32_bf16 v[36:39], v[120:123], v[100:103], v[36:39]
    ds_read_b64_tr_b16 v[82:83], v242 offset:8960
    v_mfma_f32_16x16x32_bf16 v[40:43], v[120:123], v[104:107], v[40:43]
    ds_read_b128 v[68:71], v240 offset:9216
    v_mfma_f32_16x16x32_bf16 v[44:47], v[120:123], v[108:111], v[44:47]
    ds_read_b64_tr_b16 v[84:85], v242 offset:8480
    v_mfma_f32_16x16x32_bf16 v[48:51], v[124:127], v[96:99], v[48:51]
    ds_read_b64_tr_b16 v[86:87], v242 offset:8992
    v_mfma_f32_16x16x32_bf16 v[52:55], v[124:127], v[100:103], v[52:55]
    ds_read_b128 v[72:75], v240 offset:10240
    ds_read_b64_tr_b16 v[88:89], v242 offset:8576
    v_mfma_f32_16x16x32_bf16 v[56:59], v[124:127], v[104:107], v[56:59]
    ds_read_b64_tr_b16 v[90:91], v242 offset:9088
    v_mfma_f32_16x16x32_bf16 v[60:63], v[124:127], v[108:111], v[60:63]
    ds_read_b128 v[76:79], v240 offset:11264
    v_mfma_f32_16x16x32_bf16 v[0:3], v[112:115], v[96:99], v[0:3]
    ds_read_b64_tr_b16 v[92:93], v242 offset:8608
    v_mfma_f32_16x16x32_bf16 v[4:7], v[112:115], v[100:103], v[4:7]
    ds_read_b64_tr_b16 v[94:95], v242 offset:9120
    v_mfma_f32_16x16x32_bf16 v[8:11], v[112:115], v[104:107], v[8:11]
    v_add_u16 v240, 0x4000, v240
    v_mfma_f32_16x16x32_bf16 v[12:15], v[112:115], v[108:111], v[12:15]
    s_add_u32 s16, s16, 16896
    s_cmp_eq_u32 s16, 84480
    v_mfma_f32_16x16x32_bf16 v[16:19], v[116:119], v[96:99], v[16:19]
    s_cselect_b32 s16, 0, s16
    v_mfma_f32_16x16x32_bf16 v[20:23], v[116:119], v[100:103], v[20:23]
    v_add_u32 v242, s16, v241
    v_mfma_f32_16x16x32_bf16 v[24:27], v[116:119], v[104:107], v[24:27]
    s_sub_u32 s17, s17, 1
    s_cmp_lg_u32 s17, 0
    v_mfma_f32_16x16x32_bf16 v[28:31], v[116:119], v[108:111], v[28:31]
    s_waitcnt lgkmcnt(0)
    s_cbranch_scc1 r3_loop
    s_lshl_b32 s20, s73, 4
    s_add_u32 s20, s20, s74
    s_lshl_b32 s20, s20, 2
    s_add_u32 s20, s20, s3
    s_lshl_b32 s20, s20, 13
    s_lshl_b32 s66, s60, 23
    s_add_u32 s20, s20, s66
    s_add_u32 s20, s20, 54525952
    s_add_u32 s65, s20, 4096
    buffer_store_dwordx4 v[32:35], v249, s[80:83], s20 offen offset:0
    buffer_store_dwordx4 v[36:39], v249, s[80:83], s20 offen offset:1024
    buffer_store_dwordx4 v[40:43], v249, s[80:83], s20 offen offset:2048
    buffer_store_dwordx4 v[44:47], v249, s[80:83], s20 offen offset:3072
    buffer_store_dwordx4 v[48:51], v249, s[80:83], s65 offen offset:0
    buffer_store_dwordx4 v[52:55], v249, s[80:83], s65 offen offset:1024
    buffer_store_dwordx4 v[56:59], v249, s[80:83], s65 offen offset:2048
    buffer_store_dwordx4 v[60:63], v249, s[80:83], s65 offen offset:3072
    s_lshl_b32 s21, s75, 4
    s_add_u32 s21, s21, s73
    s_lshl_b32 s21, s21, 4
    s_add_u32 s21, s21, s74
    s_lshl_b32 s21, s21, 2
    s_add_u32 s21, s21, s3
    s_lshl_b32 s21, s21, 2
    s_add_u32 s21, s21, 75563008
    s_waitcnt vmcnt(8)
    v_lshlrev_b32 v144, 16, v128
    v_and_b32 v145, 0xffff0000, v128
    v_lshlrev_b32 v146, 16, v129
    v_and_b32 v147, 0xffff0000, v129
    v_lshlrev_b32 v148, 16, v130
    v_and_b32 v149, 0xffff0000, v130
    v_lshlrev_b32 v150, 16, v131
    v_and_b32 v151, 0xffff0000, v131
    v_lshlrev_b32 v152, 16, v132
    v_and_b32 v153, 0xffff0000, v132
    v_lshlrev_b32 v154, 16, v133
    v_and_b32 v155, 0xffff0000, v133
    v_lshlrev_b32 v156, 16, v134
    v_and_b32 v157, 0xffff0000, v134
    v_lshlrev_b32 v158, 16, v135
    v_and_b32 v159, 0xffff0000, v135
    v_lshlrev_b32 v160, 16, v136
    v_and_b32 v161, 0xffff0000, v136
    v_lshlrev_b32 v162, 16, v137
    v_and_b32 v163, 0xffff0000, v137
    v_lshlrev_b32 v164, 16, v138
    v_and_b32 v165, 0xffff0000, v138
    v_lshlrev_b32 v166, 16, v139
    v_and_b32 v167, 0xffff0000, v139
    v_lshlrev_b32 v168, 16, v140
    v_and_b32 v169, 0xffff0000, v140
    v_lshlrev_b32 v170, 16, v141
    v_and_b32 v171, 0xffff0000, v141
    v_lshlrev_b32 v172, 16, v142
    v_and_b32 v173, 0xffff0000, v142
    v_lshlrev_b32 v174, 16, v143
    v_and_b32 v175, 0xffff0000, v143
    v_mov_b32 v208, 0
    v_mov_b32 v209, 1
    s_cmp_lg_u32 s78, 0
    s_cbranch_scc1 sg_8_slow
    s_waitcnt vmcnt(0)
    s_mov_b64 exec, 1
    buffer_store_dword v209, v208, s[80:83], s21 offen
    s_mov_b64 exec, -1
sg_8_done:
    s_xor_b32 s21, s21, 128
    s_xor_b32 s20, s20, 262144
    s_mov_b64 exec, 1
pl_9:
    buffer_load_dword v210, v208, s[80:83], s21 offen sc1
    s_sub_u32 s79, s79, 1
    s_cbranch_scc1 L_abort
    s_waitcnt vmcnt(0)
    v_cmp_ne_u32 vcc, 1, v210
    s_cbranch_vccnz pl_9
    s_mov_b64 exec, -1
    s_cmp_lg_u32 s78, 0
    s_cbranch_scc1 pl_9_acq
pl_9_ok:
    s_add_u32 s65, s20, 4096
    buffer_load_dwordx4 v[176:179], v249, s[80:83], s20 offen offset:0 sc1
    buffer_load_dwordx4 v[180:183], v249, s[80:83], s20 offen offset:1024 sc1
    buffer_load_dwordx4 v[184:187], v249, s[80:83], s20 offen offset:2048 sc1
    buffer_load_dwordx4 v[188:191], v249, s[80:83], s20 offen offset:3072 sc1
    buffer_load_dwordx4 v[192:195], v249, s[80:83], s65 offen offset:0 sc1
    buffer_load_dwordx4 v[196:199], v249, s[80:83], s65 offen offset:1024 sc1
    buffer_load_dwordx4 v[200:203], v249, s[80:83], s65 offen offset:2048 sc1
    buffer_load_dwordx4 v[204:207], v249, s[80:83], s65 offen offset:3072 sc1
    v_mov_b32 v88, 0x3f803f80
    s_cmp_lg_u32 s75, 0
    s_cbranch_scc1 fo_10_out
    s_waitcnt vmcnt(3)
    v_pk_add_f32 v[0:1], v[0:1], v[176:177]
    v_pk_add_f32 v[2:3], v[2:3], v[178:179]
    v_pk_add_f32 v[16:17], v[16:17], v[192:193]
    v_pk_add_f32 v[18:19], v[18:19], v[194:195]
    v_cvt_pk_bf16_f32 v208, v0, v1
    v_cvt_pk_bf16_f32 v209, v2, v3
    v_cvt_pk_bf16_f32 v210, v16, v17
    v_cvt_pk_bf16_f32 v211, v18, v19
    v_lshlrev_b32 v212, 16, v208
    v_and_b32 v213, 0xffff0000, v208
    v_lshlrev_b32 v214, 16, v209
    v_and_b32 v215, 0xffff0000, v209
    v_lshlrev_b32 v216, 16, v210
    v_and_b32 v217, 0xffff0000, v210
    v_lshlrev_b32 v218, 16, v211
    v_and_b32 v219, 0xffff0000, v211
    v_pk_add_f32 v[212:213], v[212:213], v[144:145]
    v_pk_add_f32 v[214:215], v[214:215], v[146:147]
    v_pk_add_f32 v[216:217], v[216:217], v[148:149]
    v_pk_add_f32 v[218:219], v[218:219], v[150:151]
    v_cvt_pk_bf16_f32 v64, v212, v213
    v_cvt_pk_bf16_f32 v65, v214, v215
    v_cvt_pk_bf16_f32 v66, v216, v217
    v_cvt_pk_bf16_f32 v67, v218, v219
    buffer_store_dwordx4 v[64:67], v249, s[80:83], s19 offen offset:0
    s_waitcnt vmcnt(3)
    v_pk_add_f32 v[4:5], v[4:5], v[180:181]
    v_pk_add_f32 v[6:7], v[6:7], v[182:183]
    v_pk_add_f32 v[20:21], v[20:21], v[196:197]
    v_pk_add_f32 v[22:23], v[22:23], v[198:199]
    v_cvt_pk_bf16_f32 v208, v4, v5
    v_cvt_pk_bf16_f32 v209, v6, v7
    v_cvt_pk_bf16_f32 v210, v20, v21
    v_cvt_pk_bf16_f32 v211, v22, v23
    v_lshlrev_b32 v212, 16, v208
    v_and_b32 v213, 0xffff0000, v208
    v_lshlrev_b32 v214, 16, v209
    v_and_b32 v215, 0xffff0000, v209
    v_lshlrev_b32 v216, 16, v210
    v_and_b32 v217, 0xffff0000, v210
    v_lshlrev_b32 v218, 16, v211
    v_and_b32 v219, 0xffff0000, v211
    v_pk_add_f32 v[212:213], v[212:213], v[152:153]
    v_pk_add_f32 v[214:215], v[214:215], v[154:155]
    v_pk_add_f32 v[216:217], v[216:217], v[156:157]
    v_pk_add_f32 v[218:219], v[218:219], v[158:159]
    v_cvt_pk_bf16_f32 v68, v212, v213
    v_cvt_pk_bf16_f32 v69, v214, v215
    v_cvt_pk_bf16_f32 v70, v216, v217
    v_cvt_pk_bf16_f32 v71, v218, v219
    buffer_store_dwordx4 v[68:71], v249, s[80:83], s19 offen offset:1024
    s_waitcnt vmcnt(3)
    v_pk_add_f32 v[8:9], v[8:9], v[184:185]
    v_pk_add_f32 v[10:11], v[10:11], v[186:187]
    v_pk_add_f32 v[24:25], v[24:25], v[200:201]
    v_pk_add_f32 v[26:27], v[26:27], v[202:203]
    v_cvt_pk_bf16_f32 v208, v8, v9
    v_cvt_pk_bf16_f32 v209, v10, v11
    v_cvt_pk_bf16_f32 v210, v24, v25
    v_cvt_pk_bf16_f32 v211, v26, v27
    v_lshlrev_b32 v212, 16, v208
    v_and_b32 v213, 0xffff0000, v208
    v_lshlrev_b32 v214, 16, v209
    v_and_b32 v215, 0xffff0000, v209
    v_lshlrev_b32 v216, 16, v210
    v_and_b32 v217, 0xffff0000, v210
    v_lshlrev_b32 v218, 16, v211
    v_and_b32 v219, 0xffff0000, v211
    v_pk_add_f32 v[212:213], v[212:213], v[160:161]
    v_pk_add_f32 v[214:215], v[214:215], v[162:163]
    v_pk_add_f32 v[216:217], v[216:217], v[164:165]
    v_pk_add_f32 v[218:219], v[218:219], v[166:167]
    v_cvt_pk_bf16_f32 v72, v212, v213
    v_cvt_pk_bf16_f32 v73, v214, v215
    v_cvt_pk_bf16_f32 v74, v216, v217
    v_cvt_pk_bf16_f32 v75, v218, v219
    buffer_store_dwordx4 v[72:75], v249, s[80:83], s19 offen offset:2048
    s_waitcnt vmcnt(3)
    v_pk_add_f32 v[12:13], v[12:13], v[188:189]
    v_pk_add_f32 v[14:15], v[14:15], v[190:191]
    v_pk_add_f32 v[28:29], v[28:29], v[204:205]
    v_pk_add_f32 v[30:31], v[30:31], v[206:207]
    v_cvt_pk_bf16_f32 v208, v12, v13
    v_cvt_pk_bf16_f32 v209, v14, v15
    v_cvt_pk_bf16_f32 v210, v28, v29
    v_cvt_pk_bf16_f32 v211, v30, v31
    v_lshlrev_b32 v212, 16, v208
    v_and_b32 v213, 0xffff0000, v208
    v_lshlrev_b32 v214, 16, v209
    v_and_b32 v215, 0xffff0000, v209
    v_lshlrev_b32 v216, 16, v210
    v_and_b32 v217, 0xffff0000, v210
    v_lshlrev_b32 v218, 16, v211
    v_and_b32 v219, 0xffff0000, v211
    v_pk_add_f32 v[212:213], v[212:213], v[168:169]
    v_pk_add_f32 v[214:215], v[214:215], v[170:171]
    v_pk_add_f32 v[216:217], v[216:217], v[172:173]
    v_pk_add_f32 v[218:219], v[218:219], v[174:175]
    v_cvt_pk_bf16_f32 v76, v212, v213
    v_cvt_pk_bf16_f32 v77, v214, v215
    v_cvt_pk_bf16_f32 v78, v216, v217
    v_cvt_pk_bf16_f32 v79, v218, v219
    buffer_store_dwordx4 v[76:79], v249, s[80:83], s19 offen offset:3072
    v_dot2_f32_bf16 v80, v64, v88, 0
    v_dot2_f32_bf16 v84, v64, v64, 0
    v_dot2_f32_bf16 v80, v65, v88, v80
    v_dot2_f32_bf16 v84, v65, v65, v84
    v_dot2_f32_bf16 v80, v66, v88, v80
    v_dot2_f32_bf16 v84, v66, v66, v84
    v_dot2_f32_bf16 v80, v67, v88, v80
    v_dot2_f32_bf16 v84, v67, v67, v84
    v_dot2_f32_bf16 v81, v68, v88, 0
    v_dot2_f32_bf16 v85, v68, v68, 0
    v_dot2_f32_bf16 v81, v69, v88, v81
    v_dot2_f32_bf16 v85, v69, v69, v85
    v_dot2_f32_bf16 v81, v70, v88, v81
    v_dot2_f32_bf16 v85, v70, v70, v85
    v_dot2_f32_bf16 v81, v71, v88, v81
    v_dot2_f32_bf16 v85, v71, v71, v85
    v_dot2_f32_bf16 v82, v72, v88, 0
    v_dot2_f32_bf16 v86, v72, v72, 0
    v_dot2_f32_bf16 v82, v73, v88, v82
    v_dot2_f32_bf16 v86, v73, v73, v86
    v_dot2_f32_bf16 v82, v74, v88, v82
    v_dot2_f32_bf16 v86, v74, v74, v86
    v_dot2_f32_bf16 v82, v75, v88, v82
    v_dot2_f32_bf16 v86, v75, v75, v86
    v_dot2_f32_bf16 v83, v76, v88, 0
    v_dot2_f32_bf16 v87, v76, v76, 0
    v_dot2_f32_bf16 v83, v77, v88, v83
    v_dot2_f32_bf16 v87, v77, v77, v87
    v_dot2_f32_bf16 v83, v78, v88, v83
    v_dot2_f32_bf16 v87, v78, v78, v87
    v_dot2_f32_bf16 v83, v79, v88, v83
    v_dot2_f32_bf16 v87, v79, v79, v87
    s_lshl_b32 s64, s73, 4
    s_add_u32 s64, s64, s68
    s_lshl_b32 s18, s64, 8
    s_lshl_b32 s64, s64, 11
    s_add_u32 s64, s64, 71827456
    s_lshr_b32 s65, s3, 1
    s_lshl_b32 s65, s65, 10
    s_add_u32 s64, s64, s65
    s_and_b32 s65, s3, 1
    s_lshl_b32 s65, s65, 3
    s_add_u32 s64, s64, s65
    s_add_u32 s18, s18, s65
    v_permlane16_swap_b32 v80, v81
    v_permlane16_swap_b32 v82, v83
    v_permlane16_swap_b32 v84, v85
    v_permlane16_swap_b32 v86, v87
    v_add_f32 v80, v80, v81
    v_add_f32 v82, v82, v83
    v_add_f32 v84, v84, v85
    v_add_f32 v86, v86, v87
    s_nop 1
    v_permlane32_swap_b32 v80, v82
    v_permlane32_swap_b32 v84, v86
    v_add_f32 v80, v80, v82
    v_add_f32 v81, v84, v86
    buffer_store_dwordx2 v[80:81], v249, s[80:83], s64 offen
    s_cmp_lt_u32 s3, 2
    s_cbranch_scc1 hl_11_no
    v_cmp_eq_u32 vcc, 0, v252
    s_lshl_b32 s64, s73, 4
    s_add_u32 s64, s64, s68
    s_lshl_b32 s64, s64, 1
    s_and_b32 s65, s3, 1
    s_add_u32 s64, s64, s65
    s_lshl_b32 s64, s64, 10
    s_add_u32 s64, s64, 73400320
    v_cndmask_b32 v212, v76, v88, vcc
    v_cndmask_b32 v213, v77, v88, vcc
    v_cndmask_b32 v214, v78, v88, vcc
    v_cndmask_b32 v215, v79, v88, vcc
    buffer_store_dwordx4 v[212:215], v249, s[80:83], s64 offen sc0 sc1
    s_add_u32 s18, s18, 73923840
    s_mov_b32 exec_lo, 0
    s_mov_b32 exec_hi, 0xffff0000
    buffer_store_dwordx2 v[80:81], v249, s[80:83], s18 offen sc0 sc1
    s_mov_b64 exec, -1
    s_lshl_b32 s64, s75, 15
    s_lshl_b32 s66, s73, 9
    s_add_u32 s64, s64, s66
    s_add_u32 s64, s64, 75522048
    s_lshl_b32 s65, s72, 5
    s_add_u32 s64, s64, s65
    s_lshl_b32 s65, s3, 2
    s_add_u32 s64, s64, s65
    v_mov_b32 v208, 0
    v_mov_b32 v209, 1
    s_cmp_lg_u32 s78, 0
    s_cbranch_scc1 sg_12_slow
    s_waitcnt vmcnt(2)
    s_mov_b64 exec, 1
    buffer_store_dword v209, v208, s[80:83], s64 offen
    s_mov_b64 exec, -1
sg_12_done:
    s_lshl_b32 s64, s73, 4
    s_add_u32 s64, s64, s72
    s_lshl_b32 s64, s64, 5
    s_and_b32 s65, s3, 1
    s_lshl_b32 s65, s65, 2
    s_add_u32 s64, s64, s65
    s_add_u32 s64, s64, 75571200
    s_waitcnt vmcnt(1)
    s_mov_b64 exec, 1
    buffer_store_dword v209, v208, s[80:83], s64 offen sc0 sc1
    s_mov_b64 exec, -1
    s_branch hl_11_done
hl_11_no:
    s_lshl_b32 s64, s75, 15
    s_lshl_b32 s66, s73, 9
    s_add_u32 s64, s64, s66
    s_add_u32 s64, s64, 75522048
    s_lshl_b32 s65, s72, 5
    s_add_u32 s64, s64, s65
    s_lshl_b32 s65, s3, 2
    s_add_u32 s64, s64, s65
    v_mov_b32 v208, 0
    v_mov_b32 v209, 1
    s_cmp_lg_u32 s78, 0
    s_cbranch_scc1 sg_13_slow
    s_waitcnt vmcnt(0)
    s_mov_b64 exec, 1
    buffer_store_dword v209, v208, s[80:83], s64 offen
    s_mov_b64 exec, -1
sg_13_done:
hl_11_done:
    s_branch fo_10_end
fo_10_out:
    s_mov_b32 s8, s98
    s_mov_b32 s9, s99
    s_mov_b32 s10, 4194304
    s_mov_b32 s11, 0x00020000
    s_lshl_b32 s64, s73, 1
    s_lshr_b32 s65, s3, 1
    s_add_u32 s64, s64, s65
    s_lshl_b32 s64, s64, 17
    s_lshl_b32 s65, s68, 7
    s_add_u32 s64, s64, s65
    s_and_b32 s65, s3, 1
    s_lshl_b32 s65, s65, 6
    s_add_u32 s64, s64, s65
    v_lshlrev_b32 v243, 11, v252
    v_add_u32 v243, s64, v243
    v_and_b32 v253, 1, v251
    v_lshl_add_u32 v243, v253, 5, v243
    v_lshrrev_b32 v253, 1, v251
    v_lshl_add_u32 v243, v253, 4, v243
    s_waitcnt vmcnt(3)
    v_pk_add_f32 v[0:1], v[0:1], v[176:177]
    v_pk_add_f32 v[2:3], v[2:3], v[178:179]
    v_pk_add_f32 v[16:17], v[16:17], v[192:193]
    v_pk_add_f32 v[18:19], v[18:19], v[194:195]
    v_cvt_pk_bf16_f32 v208, v0, v1
    v_cvt_pk_bf16_f32 v209, v2, v3
    v_cvt_pk_bf16_f32 v210, v16, v17
    v_cvt_pk_bf16_f32 v211, v18, v19
    v_lshlrev_b32 v212, 16, v208
    v_and_b32 v213, 0xffff0000, v208
    v_lshlrev_b32 v214, 16, v209
    v_and_b32 v215, 0xffff0000, v209
    v_lshlrev_b32 v216, 16, v210
    v_and_b32 v217, 0xffff0000, v210
    v_lshlrev_b32 v218, 16, v211
    v_and_b32 v219, 0xffff0000, v211
    v_pk_add_f32 v[212:213], v[212:213], v[144:145]
    v_pk_add_f32 v[214:215], v[214:215], v[146:147]
    v_pk_add_f32 v[216:217], v[216:217], v[148:149]
    v_pk_add_f32 v[218:219], v[218:219], v[150:151]
    v_cvt_pk_bf16_f32 v64, v212, v213
    v_cvt_pk_bf16_f32 v65, v214, v215
    v_cvt_pk_bf16_f32 v66, v216, v217
    v_cvt_pk_bf16_f32 v67, v218, v219
    s_mov_b32 s64, 0
    s_nop 0
    v_permlane16_swap_b32 v64, v66
    v_permlane16_swap_b32 v65, v67
    buffer_store_dwordx4 v[64:67], v243, s[8:11], s64 offen
    s_waitcnt vmcnt(3)
    v_pk_add_f32 v[4:5], v[4:5], v[180:181]
    v_pk_add_f32 v[6:7], v[6:7], v[182:183]
    v_pk_add_f32 v[20:21], v[20:21], v[196:197]
    v_pk_add_f32 v[22:23], v[22:23], v[198:199]
    v_cvt_pk_bf16_f32 v208, v4, v5
    v_cvt_pk_bf16_f32 v209, v6, v7
    v_cvt_pk_bf16_f32 v210, v20, v21
    v_cvt_pk_bf16_f32 v211, v22, v23
    v_lshlrev_b32 v212, 16, v208
    v_and_b32 v213, 0xffff0000, v208
    v_lshlrev_b32 v214, 16, v209
    v_and_b32 v215, 0xffff0000, v209
    v_lshlrev_b32 v216, 16, v210
    v_and_b32 v217, 0xffff0000, v210
    v_lshlrev_b32 v218, 16, v211
    v_and_b32 v219, 0xffff0000, v211
    v_pk_add_f32 v[212:213], v[212:213], v[152:153]
    v_pk_add_f32 v[214:215], v[214:215], v[154:155]
    v_pk_add_f32 v[216:217], v[216:217], v[156:157]
    v_pk_add_f32 v[218:219], v[218:219], v[158:159]
    v_cvt_pk_bf16_f32 v68, v212, v213
    v_cvt_pk_bf16_f32 v69, v214, v215
    v_cvt_pk_bf16_f32 v70, v216, v217
    v_cvt_pk_bf16_f32 v71, v218, v219
    s_mov_b32 s64, 32768
    s_nop 0
    v_permlane16_swap_b32 v68, v70
    v_permlane16_swap_b32 v69, v71
    buffer_store_dwordx4 v[68:71], v243, s[8:11], s64 offen
    s_waitcnt vmcnt(3)
    v_pk_add_f32 v[8:9], v[8:9], v[184:185]
    v_pk_add_f32 v[10:11], v[10:11], v[186:187]
    v_pk_add_f32 v[24:25], v[24:25], v[200:201]
    v_pk_add_f32 v[26:27], v[26:27], v[202:203]
    v_cvt_pk_bf16_f32 v208, v8, v9
    v_cvt_pk_bf16_f32 v209, v10, v11
    v_cvt_pk_bf16_f32 v210, v24, v25
    v_cvt_pk_bf16_f32 v211, v26, v27
    v_lshlrev_b32 v212, 16, v208
    v_and_b32 v213, 0xffff0000, v208
    v_lshlrev_b32 v214, 16, v209
    v_and_b32 v215, 0xffff0000, v209
    v_lshlrev_b32 v216, 16, v210
    v_and_b32 v217, 0xffff0000, v210
    v_lshlrev_b32 v218, 16, v211
    v_and_b32 v219, 0xffff0000, v211
    v_pk_add_f32 v[212:213], v[212:213], v[160:161]
    v_pk_add_f32 v[214:215], v[214:215], v[162:163]
    v_pk_add_f32 v[216:217], v[216:217], v[164:165]
    v_pk_add_f32 v[218:219], v[218:219], v[166:167]
    v_cvt_pk_bf16_f32 v72, v212, v213
    v_cvt_pk_bf16_f32 v73, v214, v215
    v_cvt_pk_bf16_f32 v74, v216, v217
    v_cvt_pk_bf16_f32 v75, v218, v219
    s_mov_b32 s64, 65536
    s_nop 0
    v_permlane16_swap_b32 v72, v74
    v_permlane16_swap_b32 v73, v75
    buffer_store_dwordx4 v[72:75], v243, s[8:11], s64 offen
    s_waitcnt vmcnt(3)
    v_pk_add_f32 v[12:13], v[12:13], v[188:189]
    v_pk_add_f32 v[14:15], v[14:15], v[190:191]
    v_pk_add_f32 v[28:29], v[28:29], v[204:205]
    v_pk_add_f32 v[30:31], v[30:31], v[206:207]
    v_cvt_pk_bf16_f32 v208, v12, v13
    v_cvt_pk_bf16_f32 v209, v14, v15
    v_cvt_pk_bf16_f32 v210, v28, v29
    v_cvt_pk_bf16_f32 v211, v30, v31
    v_lshlrev_b32 v212, 16, v208
    v_and_b32 v213, 0xffff0000, v208
    v_lshlrev_b32 v214, 16, v209
    v_and_b32 v215, 0xffff0000, v209
    v_lshlrev_b32 v216, 16, v210
    v_and_b32 v217, 0xffff0000, v210
    v_lshlrev_b32 v218, 16, v211
    v_and_b32 v219, 0xffff0000, v211
    v_pk_add_f32 v[212:213], v[212:213], v[168:169]
    v_pk_add_f32 v[214:215], v[214:215], v[170:171]
    v_pk_add_f32 v[216:217], v[216:217], v[172:173]
    v_pk_add_f32 v[218:219], v[218:219], v[174:175]
    v_cvt_pk_bf16_f32 v76, v212, v213
    v_cvt_pk_bf16_f32 v77, v214, v215
    v_cvt_pk_bf16_f32 v78, v216, v217
    v_cvt_pk_bf16_f32 v79, v218, v219
    s_mov_b32 s64, 98304
    s_nop 0
    v_permlane16_swap_b32 v76, v78
    v_permlane16_swap_b32 v77, v79
    buffer_store_dwordx4 v[76:79], v243, s[8:11], s64 offen
fo_10_end:
    s_add_u32 s75, s75, 1
    s_mov_b32 s59, s78
    s_mul_i32 s60, s59, s75
    s_cmp_lt_u32 s75, 2
    s_cbranch_scc1 C_layer
    s_branch L_fin
sg_3_slow:
    s_waitcnt vmcnt(0)
    buffer_wbl2 sc1
    s_waitcnt vmcnt(0)
    s_mov_b64 exec, 1
    buffer_store_dword v109, v108, s[80:83], s64 offen sc0 sc1
    s_mov_b64 exec, -1
    s_branch sg_3_done
sg_6_slow:
    s_waitcnt vmcnt(0)
    buffer_wbl2 sc1
    s_waitcnt vmcnt(0)
    s_mov_b64 exec, 1
    buffer_store_dword v237, v236, s[80:83], s64 offen sc0 sc1
    s_mov_b64 exec, -1
    s_branch sg_6_done
sg_7_slow:
    s_waitcnt vmcnt(0)
    buffer_wbl2 sc1
    s_waitcnt vmcnt(0)
    s_mov_b64 exec, 1
    buffer_store_dword v237, v236, s[80:83], s64 offen sc0 sc1
    s_mov_b64 exec, -1
    s_branch sg_7_done
sg_8_slow:
    s_waitcnt vmcnt(0)
    buffer_wbl2 sc1
    s_waitcnt vmcnt(0)
    s_mov_b64 exec, 1
    buffer_store_dword v209, v208, s[80:83], s21 offen sc0 sc1
    s_mov_b64 exec, -1
    s_branch sg_8_done
pl_9_acq:
    buffer_inv sc1
    s_waitcnt vmcnt(0)
    s_branch pl_9_ok
sg_12_slow:
    s_waitcnt vmcnt(0)
    buffer_wbl2 sc1
    s_waitcnt vmcnt(0)
    s_mov_b64 exec, 1
    buffer_store_dword v209, v208, s[80:83], s64 offen sc0 sc1
    s_mov_b64 exec, -1
    s_branch sg_12_done
sg_13_slow:
    s_waitcnt vmcnt(0)
    buffer_wbl2 sc1
    s_waitcnt vmcnt(0)
    s_mov_b64 exec, 1
    buffer_store_dword v209, v208, s[80:83], s64 offen sc0 sc1
    s_mov_b64 exec, -1
    s_branch sg_13_done
L_load:
    s_setprio 3
    s_mov_b32 s8, s86
    s_mov_b32 s9, s87
    s_mov_b32 s10, 6291456
    s_mov_b32 s11, 0x00020000
    v_lshrrev_b32 v253, 3, v250
    v_and_b32 v254, 3, v253
    v_lshlrev_b32 v254, 3, v254
    v_and_b32 v253, 4, v253
    v_add_u32 v253, v253, v254
    v_add_u32 v253, s69, v253
    v_mul_u32_u24 v253, 6144, v253
    v_and_b32 v254, 7, v250
    v_lshl_add_u32 v10, v254, 4, v253
    v_add_u32 v11, 2048, v10
    v_add_u32 v12, 4096, v10
    s_mul_i32 s19, s69, 3104
    s_lshl_b32 s17, s67, 7
    s_add_u32 s18, s17, 6291456
    s_lshl_b32 s64, s70, 1
    s_mul_i32 s64, s64, 393216
    s_add_u32 s16, s17, s64
    s_add_u32 m0, s19, 86400
    s_nop 0
    buffer_load_dwordx4 v10, s[8:11], s16 offen lds
    s_add_u32 m0, s19, 87424
    s_nop 0
    buffer_load_dwordx4 v11, s[8:11], s16 offen lds
    s_add_u32 m0, s19, 88448
    s_nop 0
    buffer_load_dwordx4 v12, s[8:11], s16 offen lds
    s_add_u32 s16, s16, 196608
    s_cmp_eq_u32 s16, s18
    s_cselect_b32 s16, s17, s16
    s_mov_b32 s12, s84
    s_mov_b32 s13, s85
    s_mov_b32 s14, 4194304
    s_mov_b32 s15, 0x00020000
    v_lshrrev_b32 v253, 3, v250
    v_and_b32 v254, 6, v253
    v_and_b32 v13, 7, v250
    v_xor_b32 v254, v254, v13
    v_lshlrev_b32 v254, 4, v254
    v_lshl_add_u32 v13, v253, 11, v254
    v_add_u32 v14, 16384, v13
    v_add_u32 v15, 32768, v13
    v_add_u32 v16, 49152, v13
    s_lshl_b32 s21, s73, 18
    s_lshl_b32 s64, s69, 16
    s_add_u32 s21, s21, s64
    s_add_u32 s22, s21, 2048
    s_lshl_b32 s64, s70, 1
    s_lshl_b32 s64, s64, 7
    s_add_u32 s20, s21, s64
    s_mul_i32 s24, s69, 4294918144
    s_sub_u32 s24, s24, 32768
    s_cmp_eq_u32 s73, 0
    s_cselect_b32 s24, 0x7f000000, s24
    s_lshl_b32 s23, s69, 12
    s_add_u32 s23, s23, 2048
    s_lshl_b32 s25, s69, 10
    s_cmp_eq_u32 s69, 0
    s_cselect_b32 s26, 0xffffff00, -1
    s_mov_b32 s27, -1
    s_mov_b32 s28, s90
    s_mov_b32 s29, s91
    s_mov_b32 s30, 256
    s_mov_b32 s31, 0x00020000
    s_getreg_b32 s32, hwreg(HW_REG_XCC_ID)
    s_and_b32 s32, s32, 15
    s_or_b32 s32, s32, 0x80
    s_lshr_b32 s33, s72, 2
    s_cmp_eq_u32 s69, 3
    s_cselect_b32 s33, s33, 64
    s_lshr_b32 s40, s2, 3
    s_lshl_b32 s40, s40, 2
    s_add_u32 s40, s40, s69
    s_and_b32 s41, s40, 63
    s_mul_i32 s41, s41, 6144
    s_lshr_b32 s40, s40, 6
    s_lshl_b32 s40, s40, 10
    s_add_u32 s40, s40, s41
    s_add_u32 s40, s40, 384
    s_add_u32 s40, s86, s40
    s_addc_u32 s41, s87, 0
    s_cmp_ge_u32 s69, 2
    s_cbranch_scc1 nh_14
    s_add_u32 m0, s25, 18432
    s_add_u32 s64, s20, s24
    s_mov_b64 exec, s[26:27]
    buffer_load_dwordx4 v13, s[12:15], s64 offen lds
    s_mov_b64 exec, -1
nh_14:
    s_add_u32 m0, s23, 18432
    s_nop 0
    buffer_load_dwordx4 v13, s[12:15], s20 offen lds
    s_add_u32 m0, s23, 19456
    s_nop 0
    buffer_load_dwordx4 v14, s[12:15], s20 offen lds
    s_add_u32 m0, s23, 20480
    s_nop 0
    buffer_load_dwordx4 v15, s[12:15], s20 offen lds
    s_add_u32 m0, s23, 21504
    s_nop 0
    buffer_load_dwordx4 v16, s[12:15], s20 offen lds
    s_add_u32 s20, s20, 128
    s_cmp_eq_u32 s20, s22
    s_cselect_b32 s20, s21, s20
    s_add_u32 m0, s19, 98816
    s_nop 0
    buffer_load_dwordx4 v10, s[8:11], s16 offen lds
    s_add_u32 m0, s19, 99840
    s_nop 0
    buffer_load_dwordx4 v11, s[8:11], s16 offen lds
    s_add_u32 m0, s19, 100864
    s_nop 0
    buffer_load_dwordx4 v12, s[8:11], s16 offen lds
    s_add_u32 s16, s16, 196608
    s_cmp_eq_u32 s16, s18
    s_cselect_b32 s16, s17, s16
    s_add_u32 m0, s19, 111232
    s_nop 0
    buffer_load_dwordx4 v10, s[8:11], s16 offen lds
    s_add_u32 m0, s19, 112256
    s_nop 0
    buffer_load_dwordx4 v11, s[8:11], s16 offen lds
    s_add_u32 m0, s19, 113280
    s_nop 0
    buffer_load_dwordx4 v12, s[8:11], s16 offen lds
    s_add_u32 s16, s16, 196608
    s_cmp_eq_u32 s16, s18
    s_cselect_b32 s16, s17, s16
    s_cmp_ge_u32 s69, 2
    s_cbranch_scc1 nh_15
    s_add_u32 m0, s25, 36864
    s_add_u32 s64, s20, s24
    s_mov_b64 exec, s[26:27]
    buffer_load_dwordx4 v13, s[12:15], s64 offen lds
    s_mov_b64 exec, -1
nh_15:
    s_add_u32 m0, s23, 36864
    s_nop 0
    buffer_load_dwordx4 v13, s[12:15], s20 offen lds
    s_add_u32 m0, s23, 37888
    s_nop 0
    buffer_load_dwordx4 v14, s[12:15], s20 offen lds
    s_add_u32 m0, s23, 38912
    s_nop 0
    buffer_load_dwordx4 v15, s[12:15], s20 offen lds
    s_add_u32 m0, s23, 39936
    s_nop 0
    buffer_load_dwordx4 v16, s[12:15], s20 offen lds
    s_add_u32 s20, s20, 128
    s_cmp_eq_u32 s20, s22
    s_cselect_b32 s20, s21, s20
    s_add_u32 m0, s19, 123648
    s_nop 0
    buffer_load_dwordx4 v10, s[8:11], s16 offen lds
    s_add_u32 m0, s19, 124672
    s_nop 0
    buffer_load_dwordx4 v11, s[8:11], s16 offen lds
    s_add_u32 m0, s19, 125696
    s_nop 0
    buffer_load_dwordx4 v12, s[8:11], s16 offen lds
    s_add_u32 s16, s16, 196608
    s_cmp_eq_u32 s16, s18
    s_cselect_b32 s16, s17, s16
    s_add_u32 m0, s19, 136064
    s_nop 0
    buffer_load_dwordx4 v10, s[8:11], s16 offen lds
    s_add_u32 m0, s19, 137088
    s_nop 0
    buffer_load_dwordx4 v11, s[8:11], s16 offen lds
    s_add_u32 m0, s19, 138112
    s_nop 0
    buffer_load_dwordx4 v12, s[8:11], s16 offen lds
    s_add_u32 s16, s16, 196608
    s_cmp_eq_u32 s16, s18
    s_cselect_b32 s16, s17, s16
    s_waitcnt vmcnt(16)
    s_barrier
    s_cmp_ge_u32 s69, 2
    s_cbranch_scc1 nh_16
    s_add_u32 m0, s25, 55296
    s_add_u32 s64, s20, s24
    s_mov_b64 exec, s[26:27]
    buffer_load_dwordx4 v13, s[12:15], s64 offen lds
    s_mov_b64 exec, -1
nh_16:
    s_add_u32 m0, s23, 55296
    s_nop 0
    buffer_load_dwordx4 v13, s[12:15], s20 offen lds
    s_add_u32 m0, s23, 56320
    s_nop 0
    buffer_load_dwordx4 v14, s[12:15], s20 offen lds
    s_add_u32 m0, s23, 57344
    s_nop 0
    buffer_load_dwordx4 v15, s[12:15], s20 offen lds
    s_add_u32 m0, s23, 58368
    s_nop 0
    buffer_load_dwordx4 v16, s[12:15], s20 offen lds
    s_add_u32 s20, s20, 128
    s_cmp_eq_u32 s20, s22
    s_cselect_b32 s20, s21, s20
    s_add_u32 m0, s19, 73984
    s_nop 0
    buffer_load_dwordx4 v10, s[8:11], s16 offen lds
    s_add_u32 m0, s19, 75008
    s_nop 0
    buffer_load_dwordx4 v11, s[8:11], s16 offen lds
    s_add_u32 m0, s19, 76032
    s_nop 0
    buffer_load_dwordx4 v12, s[8:11], s16 offen lds
    s_add_u32 s16, s16, 196608
    s_cmp_eq_u32 s16, s18
    s_cselect_b32 s16, s17, s16
    s_lshl_b32 s42, s70, 1
    s_add_u32 s42, s42, 2
    s_and_b32 s42, s42, 15
    s_mul_i32 s42, s42, 393216
    s_add_u32 s44, s40, s42
    s_addc_u32 s45, s41, 0
    s_load_dword s43, s[44:45], 0
    s_load_dword s43, s[44:45], 64
    s_load_dword s43, s[44:45], 2048
    s_load_dword s43, s[44:45], 2112
    s_load_dword s43, s[44:45], 4096
    s_load_dword s43, s[44:45], 4160
    s_lshl_b32 s42, s70, 1
    s_add_u32 s42, s42, 3
    s_and_b32 s42, s42, 15
    s_mul_i32 s42, s42, 393216
    s_add_u32 s44, s40, s42
    s_addc_u32 s45, s41, 0
    s_load_dword s43, s[44:45], 0
    s_load_dword s43, s[44:45], 64
    s_load_dword s43, s[44:45], 2048
    s_load_dword s43, s[44:45], 2112
    s_load_dword s43, s[44:45], 4096
    s_load_dword s43, s[44:45], 4160
    s_waitcnt vmcnt(13)
    s_barrier
    s_cmp_ge_u32 s69, 2
    s_cbranch_scc1 nh_17
    s_add_u32 m0, s25, 0
    s_add_u32 s64, s20, s24
    s_mov_b64 exec, s[26:27]
    buffer_load_dwordx4 v13, s[12:15], s64 offen lds
    s_mov_b64 exec, -1
nh_17:
    s_add_u32 m0, s23, 0
    s_nop 0
    buffer_load_dwordx4 v13, s[12:15], s20 offen lds
    s_add_u32 m0, s23, 1024
    s_nop 0
    buffer_load_dwordx4 v14, s[12:15], s20 offen lds
    s_add_u32 m0, s23, 2048
    s_nop 0
    buffer_load_dwordx4 v15, s[12:15], s20 offen lds
    s_add_u32 m0, s23, 3072
    s_nop 0
    buffer_load_dwordx4 v16, s[12:15], s20 offen lds
    s_add_u32 s20, s20, 128
    s_cmp_eq_u32 s20, s22
    s_cselect_b32 s20, s21, s20
    s_add_u32 m0, s19, 86400
    s_nop 0
    buffer_load_dwordx4 v10, s[8:11], s16 offen lds
    s_add_u32 m0, s19, 87424
    s_nop 0
    buffer_load_dwordx4 v11, s[8:11], s16 offen lds
    s_add_u32 m0, s19, 88448
    s_nop 0
    buffer_load_dwordx4 v12, s[8:11], s16 offen lds
    s_add_u32 s16, s16, 196608
    s_cmp_eq_u32 s16, s18
    s_cselect_b32 s16, s17, s16
    s_lshl_b32 s42, s70, 1
    s_add_u32 s42, s42, 4
    s_and_b32 s42, s42, 15
    s_mul_i32 s42, s42, 393216
    s_add_u32 s44, s40, s42
    s_addc_u32 s45, s41, 0
    s_load_dword s43, s[44:45], 0
    s_load_dword s43, s[44:45], 64
    s_load_dword s43, s[44:45], 2048
    s_load_dword s43, s[44:45], 2112
    s_load_dword s43, s[44:45], 4096
    s_load_dword s43, s[44:45], 4160
    s_waitcnt vmcnt(10)
    s_barrier
    s_add_u32 m0, s19, 98816
    s_nop 0
    buffer_load_dwordx4 v10, s[8:11], s16 offen lds
    s_add_u32 m0, s19, 99840
    s_nop 0
    buffer_load_dwordx4 v11, s[8:11], s16 offen lds
    s_add_u32 m0, s19, 100864
    s_nop 0
    buffer_load_dwordx4 v12, s[8:11], s16 offen lds
    s_add_u32 s16, s16, 196608
    s_cmp_eq_u32 s16, s18
    s_cselect_b32 s16, s17, s16
    s_cmp_ge_u32 s69, 2
    s_cbranch_scc1 nh_18
    s_add_u32 m0, s25, 18432
    s_add_u32 s64, s20, s24
    s_mov_b64 exec, s[26:27]
    buffer_load_dwordx4 v13, s[12:15], s64 offen lds
    s_mov_b64 exec, -1
nh_18:
    s_add_u32 m0, s23, 18432
    s_nop 0
    buffer_load_dwordx4 v13, s[12:15], s20 offen lds
    s_add_u32 m0, s23, 19456
    s_nop 0
    buffer_load_dwordx4 v14, s[12:15], s20 offen lds
    s_add_u32 m0, s23, 20480
    s_nop 0
    buffer_load_dwordx4 v15, s[12:15], s20 offen lds
    s_add_u32 m0, s23, 21504
    s_nop 0
    buffer_load_dwordx4 v16, s[12:15], s20 offen lds
    s_add_u32 s20, s20, 128
    s_cmp_eq_u32 s20, s22
    s_cselect_b32 s20, s21, s20
    s_add_u32 m0, s19, 111232
    s_nop 0
    buffer_load_dwordx4 v10, s[8:11], s16 offen lds
    s_add_u32 m0, s19, 112256
    s_nop 0
    buffer_load_dwordx4 v11, s[8:11], s16 offen lds
    s_add_u32 m0, s19, 113280
    s_nop 0
    buffer_load_dwordx4 v12, s[8:11], s16 offen lds
    s_add_u32 s16, s16, 196608
    s_cmp_eq_u32 s16, s18
    s_cselect_b32 s16, s17, s16
    s_lshl_b32 s42, s70, 1
    s_add_u32 s42, s42, 5
    s_and_b32 s42, s42, 15
    s_mul_i32 s42, s42, 393216
    s_add_u32 s44, s40, s42
    s_addc_u32 s45, s41, 0
    s_load_dword s43, s[44:45], 0
    s_load_dword s43, s[44:45], 64
    s_load_dword s43, s[44:45], 2048
    s_load_dword s43, s[44:45], 2112
    s_load_dword s43, s[44:45], 4096
    s_load_dword s43, s[44:45], 4160
    s_cmp_eq_u32 s33, 0
    s_cbranch_scc1 ar_19
ar_19_b:
    s_waitcnt vmcnt(10)
    s_barrier
    s_add_u32 m0, s19, 123648
    s_nop 0
    buffer_load_dwordx4 v10, s[8:11], s16 offen lds
    s_add_u32 m0, s19, 124672
    s_nop 0
    buffer_load_dwordx4 v11, s[8:11], s16 offen lds
    s_add_u32 m0, s19, 125696
    s_nop 0
    buffer_load_dwordx4 v12, s[8:11], s16 offen lds
    s_add_u32 s16, s16, 196608
    s_cmp_eq_u32 s16, s18
    s_cselect_b32 s16, s17, s16
    s_cmp_ge_u32 s69, 2
    s_cbranch_scc1 nh_20
    s_add_u32 m0, s25, 36864
    s_add_u32 s64, s20, s24
    s_mov_b64 exec, s[26:27]
    buffer_load_dwordx4 v13, s[12:15], s64 offen lds
    s_mov_b64 exec, -1
nh_20:
    s_add_u32 m0, s23, 36864
    s_nop 0
    buffer_load_dwordx4 v13, s[12:15], s20 offen lds
    s_add_u32 m0, s23, 37888
    s_nop 0
    buffer_load_dwordx4 v14, s[12:15], s20 offen lds
    s_add_u32 m0, s23, 38912
    s_nop 0
    buffer_load_dwordx4 v15, s[12:15], s20 offen lds
    s_add_u32 m0, s23, 39936
    s_nop 0
    buffer_load_dwordx4 v16, s[12:15], s20 offen lds
    s_add_u32 s20, s20, 128
    s_cmp_eq_u32 s20, s22
    s_cselect_b32 s20, s21, s20
    s_add_u32 m0, s19, 136064
    s_nop 0
    buffer_load_dwordx4 v10, s[8:11], s16 offen lds
    s_add_u32 m0, s19, 137088
    s_nop 0
    buffer_load_dwordx4 v11, s[8:11], s16 offen lds
    s_add_u32 m0, s19, 138112
    s_nop 0
    buffer_load_dwordx4 v12, s[8:11], s16 offen lds
    s_add_u32 s16, s16, 196608
    s_cmp_eq_u32 s16, s18
    s_cselect_b32 s16, s17, s16
    s_lshl_b32 s42, s70, 1
    s_add_u32 s42, s42, 6
    s_and_b32 s42, s42, 15
    s_mul_i32 s42, s42, 393216
    s_add_u32 s44, s40, s42
    s_addc_u32 s45, s41, 0
    s_load_dword s43, s[44:45], 0
    s_load_dword s43, s[44:45], 64
    s_load_dword s43, s[44:45], 2048
    s_load_dword s43, s[44:45], 2112
    s_load_dword s43, s[44:45], 4096
    s_load_dword s43, s[44:45], 4160
    s_cmp_eq_u32 s33, 1
    s_cbranch_scc1 ar_21
ar_21_b:
    s_waitcnt vmcnt(10)
    s_barrier
    s_add_u32 m0, s19, 73984
    s_nop 0
    buffer_load_dwordx4 v10, s[8:11], s16 offen lds
    s_add_u32 m0, s19, 75008
    s_nop 0
    buffer_load_dwordx4 v11, s[8:11], s16 offen lds
    s_add_u32 m0, s19, 76032
    s_nop 0
    buffer_load_dwordx4 v12, s[8:11], s16 offen lds
    s_add_u32 s16, s16, 196608
    s_cmp_eq_u32 s16, s18
    s_cselect_b32 s16, s17, s16
    s_cmp_ge_u32 s69, 2
    s_cbranch_scc1 nh_22
    s_add_u32 m0, s25, 55296
    s_add_u32 s64, s20, s24
    s_mov_b64 exec, s[26:27]
    buffer_load_dwordx4 v13, s[12:15], s64 offen lds
    s_mov_b64 exec, -1
nh_22:
    s_add_u32 m0, s23, 55296
    s_nop 0
    buffer_load_dwordx4 v13, s[12:15], s20 offen lds
    s_add_u32 m0, s23, 56320
    s_nop 0
    buffer_load_dwordx4 v14, s[12:15], s20 offen lds
    s_add_u32 m0, s23, 57344
    s_nop 0
    buffer_load_dwordx4 v15, s[12:15], s20 offen lds
    s_add_u32 m0, s23, 58368
    s_nop 0
    buffer_load_dwordx4 v16, s[12:15], s20 offen lds
    s_add_u32 s20, s20, 128
    s_cmp_eq_u32 s20, s22
    s_cselect_b32 s20, s21, s20
    s_add_u32 m0, s19, 86400
    s_nop 0
    buffer_load_dwordx4 v10, s[8:11], s16 offen lds
    s_add_u32 m0, s19, 87424
    s_nop 0
    buffer_load_dwordx4 v11, s[8:11], s16 offen lds
    s_add_u32 m0, s19, 88448
    s_nop 0
    buffer_load_dwordx4 v12, s[8:11], s16 offen lds
    s_add_u32 s16, s16, 196608
    s_cmp_eq_u32 s16, s18
    s_cselect_b32 s16, s17, s16
    s_lshl_b32 s42, s70, 1
    s_add_u32 s42, s42, 7
    s_and_b32 s42, s42, 15
    s_mul_i32 s42, s42, 393216
    s_add_u32 s44, s40, s42
    s_addc_u32 s45, s41, 0
    s_load_dword s43, s[44:45], 0
    s_load_dword s43, s[44:45], 64
    s_load_dword s43, s[44:45], 2048
    s_load_dword s43, s[44:45], 2112
    s_load_dword s43, s[44:45], 4096
    s_load_dword s43, s[44:45], 4160
    s_cmp_eq_u32 s33, 2
    s_cbranch_scc1 ar_23
ar_23_b:
    s_waitcnt vmcnt(10)
    s_barrier
    s_add_u32 m0, s19, 98816
    s_nop 0
    buffer_load_dwordx4 v10, s[8:11], s16 offen lds
    s_add_u32 m0, s19, 99840
    s_nop 0
    buffer_load_dwordx4 v11, s[8:11], s16 offen lds
    s_add_u32 m0, s19, 100864
    s_nop 0
    buffer_load_dwordx4 v12, s[8:11], s16 offen lds
    s_add_u32 s16, s16, 196608
    s_cmp_eq_u32 s16, s18
    s_cselect_b32 s16, s17, s16
    s_cmp_ge_u32 s69, 2
    s_cbranch_scc1 nh_24
    s_add_u32 m0, s25, 0
    s_add_u32 s64, s20, s24
    s_mov_b64 exec, s[26:27]
    buffer_load_dwordx4 v13, s[12:15], s64 offen lds
    s_mov_b64 exec, -1
nh_24:
    s_add_u32 m0, s23, 0
    s_nop 0
    buffer_load_dwordx4 v13, s[12:15], s20 offen lds
    s_add_u32 m0, s23, 1024
    s_nop 0
    buffer_load_dwordx4 v14, s[12:15], s20 offen lds
    s_add_u32 m0, s23, 2048
    s_nop 0
    buffer_load_dwordx4 v15, s[12:15], s20 offen lds
    s_add_u32 m0, s23, 3072
    s_nop 0
    buffer_load_dwordx4 v16, s[12:15], s20 offen lds
    s_add_u32 s20, s20, 128
    s_cmp_eq_u32 s20, s22
    s_cselect_b32 s20, s21, s20
    s_add_u32 m0, s19, 111232
    s_nop 0
    buffer_load_dwordx4 v10, s[8:11], s16 offen lds
    s_add_u32 m0, s19, 112256
    s_nop 0
    buffer_load_dwordx4 v11, s[8:11], s16 offen lds
    s_add_u32 m0, s19, 113280
    s_nop 0
    buffer_load_dwordx4 v12, s[8:11], s16 offen lds
    s_add_u32 s16, s16, 196608
    s_cmp_eq_u32 s16, s18
    s_cselect_b32 s16, s17, s16
    s_lshl_b32 s42, s70, 1
    s_add_u32 s42, s42, 8
    s_and_b32 s42, s42, 15
    s_mul_i32 s42, s42, 393216
    s_add_u32 s44, s40, s42
    s_addc_u32 s45, s41, 0
    s_load_dword s43, s[44:45], 0
    s_load_dword s43, s[44:45], 64
    s_load_dword s43, s[44:45], 2048
    s_load_dword s43, s[44:45], 2112
    s_load_dword s43, s[44:45], 4096
    s_load_dword s43, s[44:45], 4160
    s_cmp_eq_u32 s33, 3
    s_cbranch_scc1 ar_25
ar_25_b:
    s_waitcnt vmcnt(10)
    s_barrier
    s_add_u32 m0, s19, 123648
    s_nop 0
    buffer_load_dwordx4 v10, s[8:11], s16 offen lds
    s_add_u32 m0, s19, 124672
    s_nop 0
    buffer_load_dwordx4 v11, s[8:11], s16 offen lds
    s_add_u32 m0, s19, 125696
    s_nop 0
    buffer_load_dwordx4 v12, s[8:11], s16 offen lds
    s_add_u32 s16, s16, 196608
    s_cmp_eq_u32 s16, s18
    s_cselect_b32 s16, s17, s16
    s_cmp_ge_u32 s69, 2
    s_cbranch_scc1 nh_26
    s_add_u32 m0, s25, 18432
    s_add_u32 s64, s20, s24
    s_mov_b64 exec, s[26:27]
    buffer_load_dwordx4 v13, s[12:15], s64 offen lds
    s_mov_b64 exec, -1
nh_26:
    s_add_u32 m0, s23, 18432
    s_nop 0
    buffer_load_dwordx4 v13, s[12:15], s20 offen lds
    s_add_u32 m0, s23, 19456
    s_nop 0
    buffer_load_dwordx4 v14, s[12:15], s20 offen lds
    s_add_u32 m0, s23, 20480
    s_nop 0
    buffer_load_dwordx4 v15, s[12:15], s20 offen lds
    s_add_u32 m0, s23, 21504
    s_nop 0
    buffer_load_dwordx4 v16, s[12:15], s20 offen lds
    s_add_u32 s20, s20, 128
    s_cmp_eq_u32 s20, s22
    s_cselect_b32 s20, s21, s20
    s_add_u32 m0, s19, 136064
    s_nop 0
    buffer_load_dwordx4 v10, s[8:11], s16 offen lds
    s_add_u32 m0, s19, 137088
    s_nop 0
    buffer_load_dwordx4 v11, s[8:11], s16 offen lds
    s_add_u32 m0, s19, 138112
    s_nop 0
    buffer_load_dwordx4 v12, s[8:11], s16 offen lds
    s_add_u32 s16, s16, 196608
    s_cmp_eq_u32 s16, s18
    s_cselect_b32 s16, s17, s16
    s_lshl_b32 s42, s70, 1
    s_add_u32 s42, s42, 9
    s_and_b32 s42, s42, 15
    s_mul_i32 s42, s42, 393216
    s_add_u32 s44, s40, s42
    s_addc_u32 s45, s41, 0
    s_load_dword s43, s[44:45], 0
    s_load_dword s43, s[44:45], 64
    s_load_dword s43, s[44:45], 2048
    s_load_dword s43, s[44:45], 2112
    s_load_dword s43, s[44:45], 4096
    s_load_dword s43, s[44:45], 4160
    s_waitcnt vmcnt(10)
    s_barrier
    s_add_u32 m0, s19, 73984
    s_nop 0
    buffer_load_dwordx4 v10, s[8:11], s16 offen lds
    s_add_u32 m0, s19, 75008
    s_nop 0
    buffer_load_dwordx4 v11, s[8:11], s16 offen lds
    s_add_u32 m0, s19, 76032
    s_nop 0
    buffer_load_dwordx4 v12, s[8:11], s16 offen lds
    s_add_u32 s16, s16, 196608
    s_cmp_eq_u32 s16, s18
    s_cselect_b32 s16, s17, s16
    s_cmp_ge_u32 s69, 2
    s_cbranch_scc1 nh_27
    s_add_u32 m0, s25, 36864
    s_add_u32 s64, s20, s24
    s_mov_b64 exec, s[26:27]
    buffer_load_dwordx4 v13, s[12:15], s64 offen lds
    s_mov_b64 exec, -1
nh_27:
    s_add_u32 m0, s23, 36864
    s_nop 0
    buffer_load_dwordx4 v13, s[12:15], s20 offen lds
    s_add_u32 m0, s23, 37888
    s_nop 0
    buffer_load_dwordx4 v14, s[12:15], s20 offen lds
    s_add_u32 m0, s23, 38912
    s_nop 0
    buffer_load_dwordx4 v15, s[12:15], s20 offen lds
    s_add_u32 m0, s23, 39936
    s_nop 0
    buffer_load_dwordx4 v16, s[12:15], s20 offen lds
    s_add_u32 s20, s20, 128
    s_cmp_eq_u32 s20, s22
    s_cselect_b32 s20, s21, s20
    s_add_u32 m0, s19, 86400
    s_nop 0
    buffer_load_dwordx4 v10, s[8:11], s16 offen lds
    s_add_u32 m0, s19, 87424
    s_nop 0
    buffer_load_dwordx4 v11, s[8:11], s16 offen lds
    s_add_u32 m0, s19, 88448
    s_nop 0
    buffer_load_dwordx4 v12, s[8:11], s16 offen lds
    s_add_u32 s16, s16, 196608
    s_cmp_eq_u32 s16, s18
    s_cselect_b32 s16, s17, s16
    s_lshl_b32 s42, s70, 1
    s_add_u32 s42, s42, 10
    s_and_b32 s42, s42, 15
    s_mul_i32 s42, s42, 393216
    s_add_u32 s44, s40, s42
    s_addc_u32 s45, s41, 0
    s_load_dword s43, s[44:45], 0
    s_load_dword s43, s[44:45], 64
    s_load_dword s43, s[44:45], 2048
    s_load_dword s43, s[44:45], 2112
    s_load_dword s43, s[44:45], 4096
    s_load_dword s43, s[44:45], 4160
    s_waitcnt vmcnt(10)
    s_barrier
    s_add_u32 m0, s19, 98816
    s_nop 0
    buffer_load_dwordx4 v10, s[8:11], s16 offen lds
    s_add_u32 m0, s19, 99840
    s_nop 0
    buffer_load_dwordx4 v11, s[8:11], s16 offen lds
    s_add_u32 m0, s19, 100864
    s_nop 0
    buffer_load_dwordx4 v12, s[8:11], s16 offen lds
    s_add_u32 s16, s16, 196608
    s_cmp_eq_u32 s16, s18
    s_cselect_b32 s16, s17, s16
    s_cmp_ge_u32 s69, 2
    s_cbranch_scc1 nh_28
    s_add_u32 m0, s25, 55296
    s_add_u32 s64, s20, s24
    s_mov_b64 exec, s[26:27]
    buffer_load_dwordx4 v13, s[12:15], s64 offen lds
    s_mov_b64 exec, -1
nh_28:
    s_add_u32 m0, s23, 55296
    s_nop 0
    buffer_load_dwordx4 v13, s[12:15], s20 offen lds
    s_add_u32 m0, s23, 56320
    s_nop 0
    buffer_load_dwordx4 v14, s[12:15], s20 offen lds
    s_add_u32 m0, s23, 57344
    s_nop 0
    buffer_load_dwordx4 v15, s[12:15], s20 offen lds
    s_add_u32 m0, s23, 58368
    s_nop 0
    buffer_load_dwordx4 v16, s[12:15], s20 offen lds
    s_add_u32 s20, s20, 128
    s_cmp_eq_u32 s20, s22
    s_cselect_b32 s20, s21, s20
    s_add_u32 m0, s19, 111232
    s_nop 0
    buffer_load_dwordx4 v10, s[8:11], s16 offen lds
    s_add_u32 m0, s19, 112256
    s_nop 0
    buffer_load_dwordx4 v11, s[8:11], s16 offen lds
    s_add_u32 m0, s19, 113280
    s_nop 0
    buffer_load_dwordx4 v12, s[8:11], s16 offen lds
    s_add_u32 s16, s16, 196608
    s_cmp_eq_u32 s16, s18
    s_cselect_b32 s16, s17, s16
    s_lshl_b32 s42, s70, 1
    s_add_u32 s42, s42, 11
    s_and_b32 s42, s42, 15
    s_mul_i32 s42, s42, 393216
    s_add_u32 s44, s40, s42
    s_addc_u32 s45, s41, 0
    s_load_dword s43, s[44:45], 0
    s_load_dword s43, s[44:45], 64
    s_load_dword s43, s[44:45], 2048
    s_load_dword s43, s[44:45], 2112
    s_load_dword s43, s[44:45], 4096
    s_load_dword s43, s[44:45], 4160
    s_waitcnt vmcnt(10)
    s_barrier
    s_add_u32 m0, s19, 123648
    s_nop 0
    buffer_load_dwordx4 v10, s[8:11], s16 offen lds
    s_add_u32 m0, s19, 124672
    s_nop 0
    buffer_load_dwordx4 v11, s[8:11], s16 offen lds
    s_add_u32 m0, s19, 125696
    s_nop 0
    buffer_load_dwordx4 v12, s[8:11], s16 offen lds
    s_add_u32 s16, s16, 196608
    s_cmp_eq_u32 s16, s18
    s_cselect_b32 s16, s17, s16
    s_cmp_ge_u32 s69, 2
    s_cbranch_scc1 nh_29
    s_add_u32 m0, s25, 0
    s_add_u32 s64, s20, s24
    s_mov_b64 exec, s[26:27]
    buffer_load_dwordx4 v13, s[12:15], s64 offen lds
    s_mov_b64 exec, -1
nh_29:
    s_add_u32 m0, s23, 0
    s_nop 0
    buffer_load_dwordx4 v13, s[12:15], s20 offen lds
    s_add_u32 m0, s23, 1024
    s_nop 0
    buffer_load_dwordx4 v14, s[12:15], s20 offen lds
    s_add_u32 m0, s23, 2048
    s_nop 0
    buffer_load_dwordx4 v15, s[12:15], s20 offen lds
    s_add_u32 m0, s23, 3072
    s_nop 0
    buffer_load_dwordx4 v16, s[12:15], s20 offen lds
    s_add_u32 s20, s20, 128
    s_cmp_eq_u32 s20, s22
    s_cselect_b32 s20, s21, s20
    s_add_u32 m0, s19, 136064
    s_nop 0
    buffer_load_dwordx4 v10, s[8:11], s16 offen lds
    s_add_u32 m0, s19, 137088
    s_nop 0
    buffer_load_dwordx4 v11, s[8:11], s16 offen lds
    s_add_u32 m0, s19, 138112
    s_nop 0
    buffer_load_dwordx4 v12, s[8:11], s16 offen lds
    s_add_u32 s16, s16, 196608
    s_cmp_eq_u32 s16, s18
    s_cselect_b32 s16, s17, s16
    s_lshl_b32 s42, s70, 1
    s_add_u32 s42, s42, 12
    s_and_b32 s42, s42, 15
    s_mul_i32 s42, s42, 393216
    s_add_u32 s44, s40, s42
    s_addc_u32 s45, s41, 0
    s_load_dword s43, s[44:45], 0
    s_load_dword s43, s[44:45], 64
    s_load_dword s43, s[44:45], 2048
    s_load_dword s43, s[44:45], 2112
    s_load_dword s43, s[44:45], 4096
    s_load_dword s43, s[44:45], 4160
    s_waitcnt vmcnt(10)
    s_barrier
    s_add_u32 m0, s19, 73984
    s_nop 0
    buffer_load_dwordx4 v10, s[8:11], s16 offen lds
    s_add_u32 m0, s19, 75008
    s_nop 0
    buffer_load_dwordx4 v11, s[8:11], s16 offen lds
    s_add_u32 m0, s19, 76032
    s_nop 0
    buffer_load_dwordx4 v12, s[8:11], s16 offen lds
    s_add_u32 s16, s16, 196608
    s_cmp_eq_u32 s16, s18
    s_cselect_b32 s16, s17, s16
    s_cmp_ge_u32 s69, 2
    s_cbranch_scc1 nh_30
    s_add_u32 m0, s25, 18432
    s_add_u32 s64, s20, s24
    s_mov_b64 exec, s[26:27]
    buffer_load_dwordx4 v13, s[12:15], s64 offen lds
    s_mov_b64 exec, -1
nh_30:
    s_add_u32 m0, s23, 18432
    s_nop 0
    buffer_load_dwordx4 v13, s[12:15], s20 offen lds
    s_add_u32 m0, s23, 19456
    s_nop 0
    buffer_load_dwordx4 v14, s[12:15], s20 offen lds
    s_add_u32 m0, s23, 20480
    s_nop 0
    buffer_load_dwordx4 v15, s[12:15], s20 offen lds
    s_add_u32 m0, s23, 21504
    s_nop 0
    buffer_load_dwordx4 v16, s[12:15], s20 offen lds
    s_add_u32 s20, s20, 128
    s_cmp_eq_u32 s20, s22
    s_cselect_b32 s20, s21, s20
    s_add_u32 m0, s19, 86400
    s_nop 0
    buffer_load_dwordx4 v10, s[8:11], s16 offen lds
    s_add_u32 m0, s19, 87424
    s_nop 0
    buffer_load_dwordx4 v11, s[8:11], s16 offen lds
    s_add_u32 m0, s19, 88448
    s_nop 0
    buffer_load_dwordx4 v12, s[8:11], s16 offen lds
    s_add_u32 s16, s16, 196608
    s_cmp_eq_u32 s16, s18
    s_cselect_b32 s16, s17, s16
    s_lshl_b32 s42, s70, 1
    s_add_u32 s42, s42, 13
    s_and_b32 s42, s42, 15
    s_mul_i32 s42, s42, 393216
    s_add_u32 s44, s40, s42
    s_addc_u32 s45, s41, 0
    s_load_dword s43, s[44:45], 0
    s_load_dword s43, s[44:45], 64
    s_load_dword s43, s[44:45], 2048
    s_load_dword s43, s[44:45], 2112
    s_load_dword s43, s[44:45], 4096
    s_load_dword s43, s[44:45], 4160
    s_waitcnt vmcnt(10)
    s_barrier
    s_add_u32 m0, s19, 98816
    s_nop 0
    buffer_load_dwordx4 v10, s[8:11], s16 offen lds
    s_add_u32 m0, s19, 99840
    s_nop 0
    buffer_load_dwordx4 v11, s[8:11], s16 offen lds
    s_add_u32 m0, s19, 100864
    s_nop 0
    buffer_load_dwordx4 v12, s[8:11], s16 offen lds
    s_add_u32 s16, s16, 196608
    s_cmp_eq_u32 s16, s18
    s_cselect_b32 s16, s17, s16
    s_cmp_ge_u32 s69, 2
    s_cbranch_scc1 nh_31
    s_add_u32 m0, s25, 36864
    s_add_u32 s64, s20, s24
    s_mov_b64 exec, s[26:27]
    buffer_load_dwordx4 v13, s[12:15], s64 offen lds
    s_mov_b64 exec, -1
nh_31:
    s_add_u32 m0, s23, 36864
    s_nop 0
    buffer_load_dwordx4 v13, s[12:15], s20 offen lds
    s_add_u32 m0, s23, 37888
    s_nop 0
    buffer_load_dwordx4 v14, s[12:15], s20 offen lds
    s_add_u32 m0, s23, 38912
    s_nop 0
    buffer_load_dwordx4 v15, s[12:15], s20 offen lds
    s_add_u32 m0, s23, 39936
    s_nop 0
    buffer_load_dwordx4 v16, s[12:15], s20 offen lds
    s_add_u32 s20, s20, 128
    s_cmp_eq_u32 s20, s22
    s_cselect_b32 s20, s21, s20
    s_add_u32 m0, s19, 111232
    s_nop 0
    buffer_load_dwordx4 v10, s[8:11], s16 offen lds
    s_add_u32 m0, s19, 112256
    s_nop 0
    buffer_load_dwordx4 v11, s[8:11], s16 offen lds
    s_add_u32 m0, s19, 113280
    s_nop 0
    buffer_load_dwordx4 v12, s[8:11], s16 offen lds
    s_add_u32 s16, s16, 196608
    s_cmp_eq_u32 s16, s18
    s_cselect_b32 s16, s17, s16
    s_lshl_b32 s42, s70, 1
    s_add_u32 s42, s42, 14
    s_and_b32 s42, s42, 15
    s_mul_i32 s42, s42, 393216
    s_add_u32 s44, s40, s42
    s_addc_u32 s45, s41, 0
    s_load_dword s43, s[44:45], 0
    s_load_dword s43, s[44:45], 64
    s_load_dword s43, s[44:45], 2048
    s_load_dword s43, s[44:45], 2112
    s_load_dword s43, s[44:45], 4096
    s_load_dword s43, s[44:45], 4160
    s_waitcnt vmcnt(10)
    s_barrier
    s_add_u32 m0, s19, 123648
    s_nop 0
    buffer_load_dwordx4 v10, s[8:11], s16 offen lds
    s_add_u32 m0, s19, 124672
    s_nop 0
    buffer_load_dwordx4 v11, s[8:11], s16 offen lds
    s_add_u32 m0, s19, 125696
    s_nop 0
    buffer_load_dwordx4 v12, s[8:11], s16 offen lds
    s_add_u32 s16, s16, 196608
    s_cmp_eq_u32 s16, s18
    s_cselect_b32 s16, s17, s16
    s_cmp_ge_u32 s69, 2
    s_cbranch_scc1 nh_32
    s_add_u32 m0, s25, 55296
    s_add_u32 s64, s20, s24
    s_mov_b64 exec, s[26:27]
    buffer_load_dwordx4 v13, s[12:15], s64 offen lds
    s_mov_b64 exec, -1
nh_32:
    s_add_u32 m0, s23, 55296
    s_nop 0
    buffer_load_dwordx4 v13, s[12:15], s20 offen lds
    s_add_u32 m0, s23, 56320
    s_nop 0
    buffer_load_dwordx4 v14, s[12:15], s20 offen lds
    s_add_u32 m0, s23, 57344
    s_nop 0
    buffer_load_dwordx4 v15, s[12:15], s20 offen lds
    s_add_u32 m0, s23, 58368
    s_nop 0
    buffer_load_dwordx4 v16, s[12:15], s20 offen lds
    s_add_u32 s20, s20, 128
    s_cmp_eq_u32 s20, s22
    s_cselect_b32 s20, s21, s20
    s_add_u32 m0, s19, 136064
    s_nop 0
    buffer_load_dwordx4 v10, s[8:11], s16 offen lds
    s_add_u32 m0, s19, 137088
    s_nop 0
    buffer_load_dwordx4 v11, s[8:11], s16 offen lds
    s_add_u32 m0, s19, 138112
    s_nop 0
    buffer_load_dwordx4 v12, s[8:11], s16 offen lds
    s_add_u32 s16, s16, 196608
    s_cmp_eq_u32 s16, s18
    s_cselect_b32 s16, s17, s16
    s_lshl_b32 s42, s70, 1
    s_add_u32 s42, s42, 15
    s_and_b32 s42, s42, 15
    s_mul_i32 s42, s42, 393216
    s_add_u32 s44, s40, s42
    s_addc_u32 s45, s41, 0
    s_load_dword s43, s[44:45], 0
    s_load_dword s43, s[44:45], 64
    s_load_dword s43, s[44:45], 2048
    s_load_dword s43, s[44:45], 2112
    s_load_dword s43, s[44:45], 4096
    s_load_dword s43, s[44:45], 4160
    v_lshlrev_b32 v71, 2, v250
    buffer_load_dword v72, v71, s[28:31], 0 offen sc1
    s_waitcnt vmcnt(11)
    s_barrier
    s_add_u32 m0, s19, 73984
    s_nop 0
    buffer_load_dwordx4 v10, s[8:11], s16 offen lds
    s_add_u32 m0, s19, 75008
    s_nop 0
    buffer_load_dwordx4 v11, s[8:11], s16 offen lds
    s_add_u32 m0, s19, 76032
    s_nop 0
    buffer_load_dwordx4 v12, s[8:11], s16 offen lds
    s_add_u32 s16, s16, 196608
    s_cmp_eq_u32 s16, s18
    s_cselect_b32 s16, s17, s16
    s_cmp_ge_u32 s69, 2
    s_cbranch_scc1 nh_33
    s_add_u32 m0, s25, 0
    s_add_u32 s64, s20, s24
    s_mov_b64 exec, s[26:27]
    buffer_load_dwordx4 v13, s[12:15], s64 offen lds
    s_mov_b64 exec, -1
nh_33:
    s_add_u32 m0, s23, 0
    s_nop 0
    buffer_load_dwordx4 v13, s[12:15], s20 offen lds
    s_add_u32 m0, s23, 1024
    s_nop 0
    buffer_load_dwordx4 v14, s[12:15], s20 offen lds
    s_add_u32 m0, s23, 2048
    s_nop 0
    buffer_load_dwordx4 v15, s[12:15], s20 offen lds
    s_add_u32 m0, s23, 3072
    s_nop 0
    buffer_load_dwordx4 v16, s[12:15], s20 offen lds
    s_add_u32 s20, s20, 128
    s_cmp_eq_u32 s20, s22
    s_cselect_b32 s20, s21, s20
    s_add_u32 m0, s19, 86400
    s_nop 0
    buffer_load_dwordx4 v10, s[8:11], s16 offen lds
    s_add_u32 m0, s19, 87424
    s_nop 0
    buffer_load_dwordx4 v11, s[8:11], s16 offen lds
    s_add_u32 m0, s19, 88448
    s_nop 0
    buffer_load_dwordx4 v12, s[8:11], s16 offen lds
    s_add_u32 s16, s16, 196608
    s_cmp_eq_u32 s16, s18
    s_cselect_b32 s16, s17, s16
    s_waitcnt vmcnt(11)
    s_barrier
    s_add_u32 m0, s19, 98816
    s_nop 0
    buffer_load_dwordx4 v10, s[8:11], s16 offen lds
    s_add_u32 m0, s19, 99840
    s_nop 0
    buffer_load_dwordx4 v11, s[8:11], s16 offen lds
    s_add_u32 m0, s19, 100864
    s_nop 0
    buffer_load_dwordx4 v12, s[8:11], s16 offen lds
    s_add_u32 s16, s16, 196608
    s_cmp_eq_u32 s16, s18
    s_cselect_b32 s16, s17, s16
    s_lshl_b32 s64, s73, 4
    s_add_u32 s64, s64, s67
    s_lshl_b32 s64, s64, 2
    s_add_u32 s64, s64, s69
    s_lshl_b32 s64, s64, 12
    s_lshl_b32 s65, s60, 22
    s_add_u32 s64, s64, s65
    s_add_u32 s64, s64, 12582912
    v_lshlrev_b32 v253, 7, v250
    s_mov_b64 exec, 0xffffffff
    buffer_load_dword v9, v253, s[80:83], s64 offen sc1
    s_mov_b64 exec, -1
    s_mov_b32 s12, s88
    s_mov_b32 s13, s89
    s_mov_b32 s14, 2097152
    s_mov_b32 s15, 0x00020000
    v_lshrrev_b32 v253, 3, v250
    v_lshlrev_b32 v253, 13, v253
    v_and_b32 v254, 7, v250
    v_lshl_add_u32 v253, v254, 4, v253
    s_lshl_b32 s64, s69, 11
    v_add_u32 v244, s64, v253
    s_mul_i32 s51, s69, 1056
    s_lshl_b32 s49, s72, 7
    s_lshl_b32 s64, s67, 17
    s_add_u32 s50, s49, 2097152
    s_add_u32 s48, s49, s64
    s_waitcnt vmcnt(14)
    v_and_b32 v73, 0x80808080, v72
    v_cmp_ne_u32 vcc, 0x80808080, v73
    s_cbranch_vccnz hs_34
hs_34_b:
    s_lshl_b32 s64, s73, 11
    s_mul_i32 s65, s69, 288
    s_add_u32 s64, s64, s65
    s_add_u32 s64, s64, 74186752
    s_mov_b64 exec, 0x3ffff
    buffer_load_dwordx4 v[76:79], v249, s[80:83], s64 offen sc0 sc1
    s_mov_b64 exec, -1
    s_add_u32 s65, s65, 159744
    v_add_u32 v75, s65, v249
    s_and_b32 s64, s70, 3
    s_lshl_b32 s64, s64, 3
    v_bfe_u32 v72, v72, s64, 8
    v_cmp_ne_u32 vcc, s32, v72
    s_lshr_b32 s64, s70, 2
    s_lshl_b32 s65, 0x55555555, s64
    s_or_b32 s64, vcc_lo, vcc_hi
    s_and_b32 s64, s64, s65
    s_cselect_b32 s78, 1, 0
    s_mov_b32 s59, s78
    s_mul_i32 s60, s59, s75
    s_add_u32 m0, s51, 116224
    s_nop 0
    buffer_load_dwordx4 v244, s[12:15], s48 offen lds
    s_add_u32 s48, s48, 65536
    s_cmp_eq_u32 s48, s50
    s_cselect_b32 s48, s49, s48
    s_waitcnt vmcnt(6)
    s_barrier
    s_add_u32 m0, s51, 120448
    s_nop 0
    buffer_load_dwordx4 v244, s[12:15], s48 offen lds
    s_add_u32 s48, s48, 65536
    s_cmp_eq_u32 s48, s50
    s_cselect_b32 s48, s49, s48
    s_add_u32 m0, s51, 124672
    s_nop 0
    buffer_load_dwordx4 v244, s[12:15], s48 offen lds
    s_add_u32 s48, s48, 65536
    s_cmp_eq_u32 s48, s50
    s_cselect_b32 s48, s49, s48
    s_add_u32 m0, s51, 128896
    s_nop 0
    buffer_load_dwordx4 v244, s[12:15], s48 offen lds
    s_add_u32 s48, s48, 65536
    s_cmp_eq_u32 s48, s50
    s_cselect_b32 s48, s49, s48
    s_add_u32 m0, s51, 133120
    s_nop 0
    buffer_load_dwordx4 v244, s[12:15], s48 offen lds
    s_add_u32 s48, s48, 65536
    s_cmp_eq_u32 s48, s50
    s_cselect_b32 s48, s49, s48
    s_add_u32 m0, s51, 137344
    s_nop 0
    buffer_load_dwordx4 v244, s[12:15], s48 offen lds
    s_add_u32 s48, s48, 65536
    s_cmp_eq_u32 s48, s50
    s_cselect_b32 s48, s49, s48
    s_add_u32 m0, s51, 141568
    s_nop 0
    buffer_load_dwordx4 v244, s[12:15], s48 offen lds
    s_add_u32 s48, s48, 65536
    s_cmp_eq_u32 s48, s50
    s_cselect_b32 s48, s49, s48
    s_add_u32 m0, s51, 145792
    s_nop 0
    buffer_load_dwordx4 v244, s[12:15], s48 offen lds
    s_add_u32 s48, s48, 65536
    s_cmp_eq_u32 s48, s50
    s_cselect_b32 s48, s49, s48
    s_add_u32 m0, s51, 150016
    s_nop 0
    buffer_load_dwordx4 v244, s[12:15], s48 offen lds
    s_add_u32 s48, s48, 65536
    s_cmp_eq_u32 s48, s50
    s_cselect_b32 s48, s49, s48
    s_waitcnt vmcnt(11)
    s_barrier
    s_waitcnt vmcnt(9)
    v_mov_b32 v72, s78
    v_mov_b32 v73, 163456
    s_mov_b64 exec, 0x3ffff
    ds_write_b128 v75, v[76:79]
    ds_write_b32 v73, v72
    s_mov_b64 exec, -1
    s_add_u32 m0, s51, 154240
    s_nop 0
    buffer_load_dwordx4 v244, s[12:15], s48 offen lds
    s_add_u32 s48, s48, 65536
    s_cmp_eq_u32 s48, s50
    s_cselect_b32 s48, s49, s48
    s_add_u32 m0, s51, 65536
    s_nop 0
    buffer_load_dwordx4 v244, s[12:15], s48 offen lds
    s_add_u32 s48, s48, 65536
    s_cmp_eq_u32 s48, s50
    s_cselect_b32 s48, s49, s48
    s_add_u32 m0, s51, 69760
    s_nop 0
    buffer_load_dwordx4 v244, s[12:15], s48 offen lds
    s_add_u32 s48, s48, 65536
    s_cmp_eq_u32 s48, s50
    s_cselect_b32 s48, s49, s48
    s_add_u32 m0, s51, 73984
    s_nop 0
    buffer_load_dwordx4 v244, s[12:15], s48 offen lds
    s_add_u32 s48, s48, 65536
    s_cmp_eq_u32 s48, s50
    s_cselect_b32 s48, s49, s48
    s_add_u32 m0, s51, 78208
    s_nop 0
    buffer_load_dwordx4 v244, s[12:15], s48 offen lds
    s_add_u32 s48, s48, 65536
    s_cmp_eq_u32 s48, s50
    s_cselect_b32 s48, s49, s48
    s_add_u32 m0, s51, 82432
    s_nop 0
    buffer_load_dwordx4 v244, s[12:15], s48 offen lds
    s_add_u32 s48, s48, 65536
    s_cmp_eq_u32 s48, s50
    s_cselect_b32 s48, s49, s48
    s_add_u32 m0, s51, 86656
    s_nop 0
    buffer_load_dwordx4 v244, s[12:15], s48 offen lds
    s_add_u32 s48, s48, 65536
    s_cmp_eq_u32 s48, s50
    s_cselect_b32 s48, s49, s48
    s_add_u32 m0, s51, 90880
    s_nop 0
    buffer_load_dwordx4 v244, s[12:15], s48 offen lds
    s_add_u32 s48, s48, 65536
    s_cmp_eq_u32 s48, s50
    s_cselect_b32 s48, s49, s48
    s_waitcnt lgkmcnt(0)
    s_barrier
    s_add_u32 m0, s51, 95104
    s_nop 0
    buffer_load_dwordx4 v244, s[12:15], s48 offen lds
    s_add_u32 s48, s48, 65536
    s_cmp_eq_u32 s48, s50
    s_cselect_b32 s48, s49, s48
    s_add_u32 m0, s51, 99328
    s_nop 0
    buffer_load_dwordx4 v244, s[12:15], s48 offen lds
    s_add_u32 s48, s48, 65536
    s_cmp_eq_u32 s48, s50
    s_cselect_b32 s48, s49, s48
    s_add_u32 m0, s51, 103552
    s_nop 0
    buffer_load_dwordx4 v244, s[12:15], s48 offen lds
    s_add_u32 s48, s48, 65536
    s_cmp_eq_u32 s48, s50
    s_cselect_b32 s48, s49, s48
    s_add_u32 m0, s51, 107776
    s_nop 0
    buffer_load_dwordx4 v244, s[12:15], s48 offen lds
    s_add_u32 s48, s48, 65536
    s_cmp_eq_u32 s48, s50
    s_cselect_b32 s48, s49, s48
    s_add_u32 m0, s51, 112000
    s_nop 0
    buffer_load_dwordx4 v244, s[12:15], s48 offen lds
    s_add_u32 s48, s48, 65536
    s_cmp_eq_u32 s48, s50
    s_cselect_b32 s48, s49, s48
L_g2:
    s_and_b32 s64, s3, 1
    s_cmp_eq_u32 s64, 0
    s_cselect_b32 s8, s92, s94
    s_cselect_b32 s9, s93, s95
    s_mov_b32 s10, 7340032
    s_mov_b32 s11, 0x00020000
    s_mul_i32 s19, s64, 14400
    s_lshr_b32 s64, s69, 1
    s_mul_i32 s65, s64, 7200
    s_add_u32 s19, s19, s65
    s_add_u32 s19, s19, 36736
    s_mul_i32 s17, s64, 28672
    s_mul_i32 s65, s74, 448
    s_add_u32 s17, s17, s65
    s_add_u32 s18, s17, 7340032
    s_lshl_b32 s64, s57, 1
    s_mul_i32 s65, s64, 229376
    s_add_u32 s16, s17, s65
    s_mov_b32 s66, 2341
    v_add_u32 v253, 0, v250
    v_mul_lo_u32 v254, v253, s66
    v_lshrrev_b32 v254, 16, v254
    v_mul_u32_u24 v228, 28, v254
    v_sub_u32 v253, v253, v228
    v_and_b32 v228, 12, v254
    v_add_u32 v254, v254, v228
    v_mul_u32_u24 v254, 7168, v254
    v_lshl_add_u32 v228, v253, 4, v254
    v_add_u32 v253, 64, v250
    v_mul_lo_u32 v254, v253, s66
    v_lshrrev_b32 v254, 16, v254
    v_mul_u32_u24 v229, 28, v254
    v_sub_u32 v253, v253, v229
    v_and_b32 v229, 12, v254
    v_add_u32 v254, v254, v229
    v_mul_u32_u24 v254, 7168, v254
    v_lshl_add_u32 v229, v253, 4, v254
    v_add_u32 v253, 128, v250
    v_mul_lo_u32 v254, v253, s66
    v_lshrrev_b32 v254, 16, v254
    v_mul_u32_u24 v230, 28, v254
    v_sub_u32 v253, v253, v230
    v_and_b32 v230, 12, v254
    v_add_u32 v254, v254, v230
    v_mul_u32_u24 v254, 7168, v254
    v_lshl_add_u32 v230, v253, 4, v254
    v_add_u32 v253, 192, v250
    v_mul_lo_u32 v254, v253, s66
    v_lshrrev_b32 v254, 16, v254
    v_mul_u32_u24 v231, 28, v254
    v_sub_u32 v253, v253, v231
    v_and_b32 v231, 12, v254
    v_add_u32 v254, v254, v231
    v_mul_u32_u24 v254, 7168, v254
    v_lshl_add_u32 v231, v253, 4, v254
    v_add_u32 v253, 256, v250
    v_mul_lo_u32 v254, v253, s66
    v_lshrrev_b32 v254, 16, v254
    v_mul_u32_u24 v232, 28, v254
    v_sub_u32 v253, v253, v232
    v_and_b32 v232, 12, v254
    v_add_u32 v254, v254, v232
    v_mul_u32_u24 v254, 7168, v254
    v_lshl_add_u32 v232, v253, 4, v254
    v_add_u32 v253, 320, v250
    v_mul_lo_u32 v254, v253, s66
    v_lshrrev_b32 v254, 16, v254
    v_mul_u32_u24 v233, 28, v254
    v_sub_u32 v253, v253, v233
    v_and_b32 v233, 12, v254
    v_add_u32 v254, v254, v233
    v_mul_u32_u24 v254, 7168, v254
    v_lshl_add_u32 v233, v253, 4, v254
    v_add_u32 v253, 384, v250
    v_mul_lo_u32 v254, v253, s66
    v_lshrrev_b32 v254, 16, v254
    v_mul_u32_u24 v234, 28, v254
    v_sub_u32 v253, v253, v234
    v_and_b32 v234, 12, v254
    v_add_u32 v254, v254, v234
    v_mul_u32_u24 v254, 7168, v254
    v_lshl_add_u32 v234, v253, 4, v254
    s_cmp_ge_u32 s69, 2
    s_cbranch_scc1 pt_35
    s_lshl_b32 s64, s73, 4
    s_add_u32 s64, s64, s72
    s_lshl_b32 s64, s64, 14
    s_mul_i32 s66, s60, 8388608
    s_add_u32 s64, s64, s66
    v_lshlrev_b32 v253, 7, v250
    s_lshl_b32 s65, s69, 13
    s_add_u32 s64, s64, s65
    buffer_load_dword v254, v253, s[80:83], s64 offen sc1
pt_35:
    s_lshl_b32 s53, s60, 22
    s_lshl_b32 s64, s73, 18
    s_add_u32 s53, s53, s64
    s_add_u32 s53, s53, 12582912
    s_lshl_b32 s65, s67, 14
    s_lshl_b32 s55, s69, 11
    s_add_u32 s53, s53, s55
    s_add_u32 s54, s53, 262144
    s_add_u32 s52, s53, s65
    s_lshl_b32 s56, s75, 15
    s_lshl_b32 s66, s73, 9
    s_add_u32 s56, s56, s66
    s_add_u32 s56, s56, 75497472
    v_lshlrev_b32 v246, 5, v250
    s_cmp_ge_u32 s69, 2
    s_cbranch_scc1 vt_36
    s_lshl_b32 s34, s57, 1
    s_lshr_b32 s35, s69, 1
    s_add_u32 s34, s34, s35
    s_add_u32 s34, s34, 2
    s_and_b32 s34, s34, 31
    s_lshl_b32 s34, s34, 1
    s_add_u32 s34, s34, s71
    s_mul_i32 s34, s34, 114688
    s_mul_i32 s35, s74, 448
    s_and_b32 s35, s35, 0xffffff80
    s_add_u32 s34, s34, s35
    v_mul_u32_u24 v247, 7168, v252
    v_lshl_add_u32 v247, v251, 7, v247
    buffer_load_dword v248, v247, s[8:11], s34 offen
vt_36:
    s_mov_b64 exec, 0xffff
pl_37:
    buffer_load_dwordx4 v[240:243], v246, s[80:83], s56 offen sc1
    s_sub_u32 s79, s79, 1
    s_cbranch_scc1 L_abort
    s_waitcnt vmcnt(0)
    v_and_b32 v240, v240, v241
    v_and_b32 v242, v242, v243
    v_and_b32 v240, v240, v242
    v_cmp_ne_u32 vcc, 1, v240
    s_cbranch_vccnz pl_37
    s_mov_b64 exec, -1
    s_cmp_lg_u32 s78, 0
    s_cbranch_scc1 pl_37_acq
pl_37_ok:
    s_add_u32 m0, s55, 0
    s_nop 0
    buffer_load_dwordx4 v249, s[80:83], s52 offen offset:0 sc1 lds
    buffer_load_dwordx4 v249, s[80:83], s52 offen offset:1024 sc1 lds
    s_add_u32 s52, s52, 8192
    s_cmp_eq_u32 s52, s54
    s_cselect_b32 s52, s53, s52
    s_add_u32 m0, s55, 8192
    s_nop 0
    buffer_load_dwordx4 v249, s[80:83], s52 offen offset:0 sc1 lds
    buffer_load_dwordx4 v249, s[80:83], s52 offen offset:1024 sc1 lds
    s_add_u32 s52, s52, 8192
    s_cmp_eq_u32 s52, s54
    s_cselect_b32 s52, s53, s52
    s_add_u32 m0, s55, 16384
    s_nop 0
    buffer_load_dwordx4 v249, s[80:83], s52 offen offset:0 sc1 lds
    buffer_load_dwordx4 v249, s[80:83], s52 offen offset:1024 sc1 lds
    s_add_u32 s52, s52, 8192
    s_cmp_eq_u32 s52, s54
    s_cselect_b32 s52, s53, s52
    s_add_u32 m0, s55, 24576
    s_nop 0
    buffer_load_dwordx4 v249, s[80:83], s52 offen offset:0 sc1 lds
    buffer_load_dwordx4 v249, s[80:83], s52 offen offset:1024 sc1 lds
    s_add_u32 s52, s52, 8192
    s_cmp_eq_u32 s52, s54
    s_cselect_b32 s52, s53, s52
    s_waitcnt vmcnt(4)
    s_barrier
    s_add_u32 m0, s55, 32768
    s_nop 0
    buffer_load_dwordx4 v249, s[80:83], s52 offen offset:0 sc1 lds
    buffer_load_dwordx4 v249, s[80:83], s52 offen offset:1024 sc1 lds
    s_add_u32 s52, s52, 8192
    s_cmp_eq_u32 s52, s54
    s_cselect_b32 s52, s53, s52
    s_add_u32 m0, s55, 40960
    s_nop 0
    buffer_load_dwordx4 v249, s[80:83], s52 offen offset:0 sc1 lds
    buffer_load_dwordx4 v249, s[80:83], s52 offen offset:1024 sc1 lds
    s_add_u32 s52, s52, 8192
    s_cmp_eq_u32 s52, s54
    s_cselect_b32 s52, s53, s52
    s_add_u32 m0, s55, 49152
    s_nop 0
    buffer_load_dwordx4 v249, s[80:83], s52 offen offset:0 sc1 lds
    buffer_load_dwordx4 v249, s[80:83], s52 offen offset:1024 sc1 lds
    s_add_u32 s52, s52, 8192
    s_cmp_eq_u32 s52, s54
    s_cselect_b32 s52, s53, s52
    s_waitcnt vmcnt(6)
    s_barrier
    s_add_u32 m0, s55, 57344
    s_nop 0
    buffer_load_dwordx4 v249, s[80:83], s52 offen offset:0 sc1 lds
    buffer_load_dwordx4 v249, s[80:83], s52 offen offset:1024 sc1 lds
    s_add_u32 s52, s52, 8192
    s_cmp_eq_u32 s52, s54
    s_cselect_b32 s52, s53, s52
    s_add_u32 m0, s55, 0
    s_nop 0
    buffer_load_dwordx4 v249, s[80:83], s52 offen offset:0 sc1 lds
    buffer_load_dwordx4 v249, s[80:83], s52 offen offset:1024 sc1 lds
    s_add_u32 s52, s52, 8192
    s_cmp_eq_u32 s52, s54
    s_cselect_b32 s52, s53, s52
    s_add_u32 m0, s55, 8192
    s_nop 0
    buffer_load_dwordx4 v249, s[80:83], s52 offen offset:0 sc1 lds
    buffer_load_dwordx4 v249, s[80:83], s52 offen offset:1024 sc1 lds
    s_add_u32 s52, s52, 8192
    s_cmp_eq_u32 s52, s54
    s_cselect_b32 s52, s53, s52
    s_waitcnt vmcnt(8)
    s_barrier
    s_add_u32 m0, s55, 16384
    s_nop 0
    buffer_load_dwordx4 v249, s[80:83], s52 offen offset:0 sc1 lds
    buffer_load_dwordx4 v249, s[80:83], s52 offen offset:1024 sc1 lds
    s_add_u32 s52, s52, 8192
    s_cmp_eq_u32 s52, s54
    s_cselect_b32 s52, s53, s52
    s_add_u32 m0, s55, 24576
    s_nop 0
    buffer_load_dwordx4 v249, s[80:83], s52 offen offset:0 sc1 lds
    buffer_load_dwordx4 v249, s[80:83], s52 offen offset:1024 sc1 lds
    s_add_u32 s52, s52, 8192
    s_cmp_eq_u32 s52, s54
    s_cselect_b32 s52, s53, s52
    s_waitcnt vmcnt(8)
    s_barrier
    s_add_u32 m0, s55, 32768
    s_nop 0
    buffer_load_dwordx4 v249, s[80:83], s52 offen offset:0 sc1 lds
    buffer_load_dwordx4 v249, s[80:83], s52 offen offset:1024 sc1 lds
    s_add_u32 s52, s52, 8192
    s_cmp_eq_u32 s52, s54
    s_cselect_b32 s52, s53, s52
    s_add_u32 m0, s55, 40960
    s_nop 0
    buffer_load_dwordx4 v249, s[80:83], s52 offen offset:0 sc1 lds
    buffer_load_dwordx4 v249, s[80:83], s52 offen offset:1024 sc1 lds
    s_add_u32 s52, s52, 8192
    s_cmp_eq_u32 s52, s54
    s_cselect_b32 s52, s53, s52
    s_add_u32 m0, s51, 116224
    s_nop 0
    buffer_load_dwordx4 v244, s[12:15], s48 offen lds
    s_add_u32 s48, s48, 65536
    s_cmp_eq_u32 s48, s50
    s_cselect_b32 s48, s49, s48
    s_waitcnt vmcnt(9)
    s_barrier
    s_add_u32 m0, s55, 49152
    s_nop 0
    buffer_load_dwordx4 v249, s[80:83], s52 offen offset:0 sc1 lds
    buffer_load_dwordx4 v249, s[80:83], s52 offen offset:1024 sc1 lds
    s_add_u32 s52, s52, 8192
    s_cmp_eq_u32 s52, s54
    s_cselect_b32 s52, s53, s52
    s_add_u32 m0, s55, 57344
    s_nop 0
    buffer_load_dwordx4 v249, s[80:83], s52 offen offset:0 sc1 lds
    buffer_load_dwordx4 v249, s[80:83], s52 offen offset:1024 sc1 lds
    s_add_u32 s52, s52, 8192
    s_cmp_eq_u32 s52, s54
    s_cselect_b32 s52, s53, s52
    s_add_u32 m0, s51, 120448
    s_nop 0
    buffer_load_dwordx4 v244, s[12:15], s48 offen lds
    s_add_u32 s48, s48, 65536
    s_cmp_eq_u32 s48, s50
    s_cselect_b32 s48, s49, s48
    s_waitcnt vmcnt(10)
    s_barrier
    s_add_u32 m0, s55, 0
    s_nop 0
    buffer_load_dwordx4 v249, s[80:83], s52 offen offset:0 sc1 lds
    buffer_load_dwordx4 v249, s[80:83], s52 offen offset:1024 sc1 lds
    s_add_u32 s52, s52, 8192
    s_cmp_eq_u32 s52, s54
    s_cselect_b32 s52, s53, s52
    s_add_u32 m0, s55, 8192
    s_nop 0
    buffer_load_dwordx4 v249, s[80:83], s52 offen offset:0 sc1 lds
    buffer_load_dwordx4 v249, s[80:83], s52 offen offset:1024 sc1 lds
    s_add_u32 s52, s52, 8192
    s_cmp_eq_u32 s52, s54
    s_cselect_b32 s52, s53, s52
    s_add_u32 m0, s51, 124672
    s_nop 0
    buffer_load_dwordx4 v244, s[12:15], s48 offen lds
    s_add_u32 s48, s48, 65536
    s_cmp_eq_u32 s48, s50
    s_cselect_b32 s48, s49, s48
    s_waitcnt vmcnt(11)
    s_barrier
    s_add_u32 m0, s55, 16384
    s_nop 0
    buffer_load_dwordx4 v249, s[80:83], s52 offen offset:0 sc1 lds
    buffer_load_dwordx4 v249, s[80:83], s52 offen offset:1024 sc1 lds
    s_add_u32 s52, s52, 8192
    s_cmp_eq_u32 s52, s54
    s_cselect_b32 s52, s53, s52
    s_add_u32 m0, s55, 24576
    s_nop 0
    buffer_load_dwordx4 v249, s[80:83], s52 offen offset:0 sc1 lds
    buffer_load_dwordx4 v249, s[80:83], s52 offen offset:1024 sc1 lds
    s_add_u32 s52, s52, 8192
    s_cmp_eq_u32 s52, s54
    s_cselect_b32 s52, s53, s52
    s_add_u32 m0, s51, 128896
    s_nop 0
    buffer_load_dwordx4 v244, s[12:15], s48 offen lds
    s_add_u32 s48, s48, 65536
    s_cmp_eq_u32 s48, s50
    s_cselect_b32 s48, s49, s48
    s_waitcnt vmcnt(11)
    s_barrier
    s_add_u32 m0, s55, 32768
    s_nop 0
    buffer_load_dwordx4 v249, s[80:83], s52 offen offset:0 sc1 lds
    buffer_load_dwordx4 v249, s[80:83], s52 offen offset:1024 sc1 lds
    s_add_u32 s52, s52, 8192
    s_cmp_eq_u32 s52, s54
    s_cselect_b32 s52, s53, s52
    s_add_u32 m0, s55, 40960
    s_nop 0
    buffer_load_dwordx4 v249, s[80:83], s52 offen offset:0 sc1 lds
    buffer_load_dwordx4 v249, s[80:83], s52 offen offset:1024 sc1 lds
    s_add_u32 s52, s52, 8192
    s_cmp_eq_u32 s52, s54
    s_cselect_b32 s52, s53, s52
    s_add_u32 m0, s51, 133120
    s_nop 0
    buffer_load_dwordx4 v244, s[12:15], s48 offen lds
    s_add_u32 s48, s48, 65536
    s_cmp_eq_u32 s48, s50
    s_cselect_b32 s48, s49, s48
    s_waitcnt vmcnt(11)
    s_barrier
    s_add_u32 m0, s55, 49152
    s_nop 0
    buffer_load_dwordx4 v249, s[80:83], s52 offen offset:0 sc1 lds
    buffer_load_dwordx4 v249, s[80:83], s52 offen offset:1024 sc1 lds
    s_add_u32 s52, s52, 8192
    s_cmp_eq_u32 s52, s54
    s_cselect_b32 s52, s53, s52
    s_add_u32 m0, s55, 57344
    s_nop 0
    buffer_load_dwordx4 v249, s[80:83], s52 offen offset:0 sc1 lds
    buffer_load_dwordx4 v249, s[80:83], s52 offen offset:1024 sc1 lds
    s_add_u32 s52, s52, 8192
    s_cmp_eq_u32 s52, s54
    s_cselect_b32 s52, s53, s52
    s_add_u32 m0, s51, 137344
    s_nop 0
    buffer_load_dwordx4 v244, s[12:15], s48 offen lds
    s_add_u32 s48, s48, 65536
    s_cmp_eq_u32 s48, s50
    s_cselect_b32 s48, s49, s48
    s_waitcnt vmcnt(11)
    s_barrier
    s_add_u32 m0, s55, 0
    s_nop 0
    buffer_load_dwordx4 v249, s[80:83], s52 offen offset:0 sc1 lds
    buffer_load_dwordx4 v249, s[80:83], s52 offen offset:1024 sc1 lds
    s_add_u32 s52, s52, 8192
    s_cmp_eq_u32 s52, s54
    s_cselect_b32 s52, s53, s52
    s_add_u32 m0, s55, 8192
    s_nop 0
    buffer_load_dwordx4 v249, s[80:83], s52 offen offset:0 sc1 lds
    buffer_load_dwordx4 v249, s[80:83], s52 offen offset:1024 sc1 lds
    s_add_u32 s52, s52, 8192
    s_cmp_eq_u32 s52, s54
    s_cselect_b32 s52, s53, s52
    s_add_u32 m0, s51, 141568
    s_nop 0
    buffer_load_dwordx4 v244, s[12:15], s48 offen lds
    s_add_u32 s48, s48, 65536
    s_cmp_eq_u32 s48, s50
    s_cselect_b32 s48, s49, s48
    s_waitcnt vmcnt(11)
    s_barrier
    s_add_u32 m0, s55, 16384
    s_nop 0
    buffer_load_dwordx4 v249, s[80:83], s52 offen offset:0 sc1 lds
    buffer_load_dwordx4 v249, s[80:83], s52 offen offset:1024 sc1 lds
    s_add_u32 s52, s52, 8192
    s_cmp_eq_u32 s52, s54
    s_cselect_b32 s52, s53, s52
    s_add_u32 m0, s55, 24576
    s_nop 0
    buffer_load_dwordx4 v249, s[80:83], s52 offen offset:0 sc1 lds
    buffer_load_dwordx4 v249, s[80:83], s52 offen offset:1024 sc1 lds
    s_add_u32 s52, s52, 8192
    s_cmp_eq_u32 s52, s54
    s_cselect_b32 s52, s53, s52
    s_add_u32 m0, s51, 145792
    s_nop 0
    buffer_load_dwordx4 v244, s[12:15], s48 offen lds
    s_add_u32 s48, s48, 65536
    s_cmp_eq_u32 s48, s50
    s_cselect_b32 s48, s49, s48
    s_waitcnt vmcnt(11)
    s_barrier
    s_add_u32 m0, s55, 32768
    s_nop 0
    buffer_load_dwordx4 v249, s[80:83], s52 offen offset:0 sc1 lds
    buffer_load_dwordx4 v249, s[80:83], s52 offen offset:1024 sc1 lds
    s_add_u32 s52, s52, 8192
    s_cmp_eq_u32 s52, s54
    s_cselect_b32 s52, s53, s52
    s_add_u32 m0, s55, 40960
    s_nop 0
    buffer_load_dwordx4 v249, s[80:83], s52 offen offset:0 sc1 lds
    buffer_load_dwordx4 v249, s[80:83], s52 offen offset:1024 sc1 lds
    s_add_u32 s52, s52, 8192
    s_cmp_eq_u32 s52, s54
    s_cselect_b32 s52, s53, s52
    s_add_u32 m0, s51, 150016
    s_nop 0
    buffer_load_dwordx4 v244, s[12:15], s48 offen lds
    s_add_u32 s48, s48, 65536
    s_cmp_eq_u32 s48, s50
    s_cselect_b32 s48, s49, s48
    s_waitcnt vmcnt(11)
    s_barrier
    s_add_u32 m0, s55, 49152
    s_nop 0
    buffer_load_dwordx4 v249, s[80:83], s52 offen offset:0 sc1 lds
    buffer_load_dwordx4 v249, s[80:83], s52 offen offset:1024 sc1 lds
    s_add_u32 s52, s52, 8192
    s_cmp_eq_u32 s52, s54
    s_cselect_b32 s52, s53, s52
    s_add_u32 m0, s55, 57344
    s_nop 0
    buffer_load_dwordx4 v249, s[80:83], s52 offen offset:0 sc1 lds
    buffer_load_dwordx4 v249, s[80:83], s52 offen offset:1024 sc1 lds
    s_add_u32 s52, s52, 8192
    s_cmp_eq_u32 s52, s54
    s_cselect_b32 s52, s53, s52
    s_add_u32 m0, s51, 154240
    s_nop 0
    buffer_load_dwordx4 v244, s[12:15], s48 offen lds
    s_add_u32 s48, s48, 65536
    s_cmp_eq_u32 s48, s50
    s_cselect_b32 s48, s49, s48
    s_waitcnt vmcnt(11)
    s_barrier
    s_add_u32 m0, s19, 28800
    s_nop 0
    buffer_load_dwordx4 v228, s[8:11], s16 offen lds
    s_add_u32 m0, s19, 29824
    s_nop 0
    buffer_load_dwordx4 v229, s[8:11], s16 offen lds
    s_add_u32 m0, s19, 30848
    s_nop 0
    buffer_load_dwordx4 v230, s[8:11], s16 offen lds
    s_waitcnt vmcnt(3)
    s_barrier
    s_add_u32 m0, s19, 31872
    s_nop 0
    buffer_load_dwordx4 v231, s[8:11], s16 offen lds
    s_add_u32 m0, s19, 32896
    s_nop 0
    buffer_load_dwordx4 v232, s[8:11], s16 offen lds
    s_add_u32 m0, s19, 33920
    s_nop 0
    buffer_load_dwordx4 v233, s[8:11], s16 offen lds
    s_add_u32 m0, s19, 34944
    s_nop 0
    buffer_load_dwordx4 v234, s[8:11], s16 offen lds
    s_add_u32 s16, s16, 229376
    s_cmp_eq_u32 s16, s18
    s_cselect_b32 s16, s17, s16
    s_add_u32 m0, s19, 57600
    s_nop 0
    buffer_load_dwordx4 v228, s[8:11], s16 offen lds
    s_add_u32 m0, s19, 58624
    s_nop 0
    buffer_load_dwordx4 v229, s[8:11], s16 offen lds
    s_add_u32 m0, s19, 59648
    s_nop 0
    buffer_load_dwordx4 v230, s[8:11], s16 offen lds
    s_add_u32 m0, s19, 60672
    s_nop 0
    buffer_load_dwordx4 v231, s[8:11], s16 offen lds
    s_add_u32 m0, s19, 61696
    s_nop 0
    buffer_load_dwordx4 v232, s[8:11], s16 offen lds
    s_add_u32 m0, s19, 62720
    s_nop 0
    buffer_load_dwordx4 v233, s[8:11], s16 offen lds
    s_add_u32 m0, s19, 63744
    s_nop 0
    buffer_load_dwordx4 v234, s[8:11], s16 offen lds
    s_add_u32 s16, s16, 229376
    s_cmp_eq_u32 s16, s18
    s_cselect_b32 s16, s17, s16
    s_setprio 0
    s_lshl_b32 s21, s60, 23
    s_lshl_b32 s64, s73, 18
    s_add_u32 s21, s21, s64
    s_lshl_b32 s23, s69, 11
    s_add_u32 s21, s21, s23
    s_add_u32 s22, s21, 262144
    s_add_u32 s64, s57, 1
    s_and_b32 s64, s64, 15
    s_lshl_b32 s64, s64, 14
    s_add_u32 s20, s21, s64
    s_and_b32 s64, s3, 1
    s_lshl_b32 s64, s64, 12
    v_add_u32 v235, s64, v249
    v_lshrrev_b32 v253, 1, v251
    v_lshrrev_b32 v254, 2, v252
    v_lshl_add_u32 v253, v253, 2, v254
    v_mul_u32_u24 v253, 448, v253
    v_and_b32 v254, 1, v251
    v_mul_u32_u24 v254, 7200, v254
    v_add_u32 v253, v253, v254
    v_and_b32 v254, 3, v252
    v_lshl_add_u32 v253, v254, 3, v253
    v_add_u32 v253, 36736, v253
    s_lshr_b32 s64, s69, 1
    s_lshl_b32 s28, s64, 2
    s_add_u32 s28, s28, 8
    s_lshl_b32 s65, s28, 5
    v_add_u32 v236, s65, v253
    v_add_u32 v237, 57600, v236
    s_add_u32 s65, s64, 10
    s_lshl_b32 s65, s65, 5
    v_add_u32 v238, s65, v253
    v_add_u32 v239, 57600, v238
    s_mul_i32 s65, s64, 224
    s_and_b32 s64, s3, 1
    s_mul_i32 s64, s64, 14400
    s_add_u32 s65, s65, s64
    v_add_u32 v224, s65, v253
    v_mov_b32 v220, 0x3f803f80
    v_mov_b32 v221, 0x3f803f80
    v_mov_b32 v222, 0x3f803f80
    v_mov_b32 v223, 0x3f803f80
    s_mul_i32 s25, s73, 112
    s_mul_i32 s64, s74, 7
    s_add_u32 s25, s25, s64
    s_lshl_b32 s25, s25, 13
    s_lshl_b32 s64, s60, 24
    s_add_u32 s25, s25, s64
    s_add_u32 s25, s25, 20971520
    s_cmp_eq_u32 s75, 0
    s_cselect_b32 s27, s71, 7
    s_lshl_b32 s31, s75, 15
    s_lshl_b32 s66, s73, 9
    s_add_u32 s31, s31, s66
    s_add_u32 s31, s31, 75505664
    v_lshlrev_b32 v246, 5, v250
    s_waitcnt vmcnt(0)
    s_barrier
    ds_read_b128 v[144:147], v235 offset:0
    ds_read_b128 v[148:151], v235 offset:1024
    ds_read_b128 v[152:155], v235 offset:2048
    ds_read_b128 v[156:159], v235 offset:3072
    ds_read_b64_tr_b16 v[96:97], v236 offset:28800
    ds_read_b64_tr_b16 v[98:99], v236 offset:32384
    ds_read_b64_tr_b16 v[108:109], v236 offset:43200
    ds_read_b64_tr_b16 v[110:111], v236 offset:46784
    ds_read_b64_tr_b16 v[100:101], v236 offset:28832
    ds_read_b64_tr_b16 v[102:103], v236 offset:32416
    ds_read_b64_tr_b16 v[112:113], v236 offset:43232
    ds_read_b64_tr_b16 v[114:115], v236 offset:46816
    ds_read_b64_tr_b16 v[104:105], v238 offset:28800
    ds_read_b64_tr_b16 v[106:107], v238 offset:32384
    ds_read_b64_tr_b16 v[116:117], v238 offset:43200
    ds_read_b64_tr_b16 v[118:119], v238 offset:46784
    s_add_u32 m0, s19, 86400
    s_nop 0
    buffer_load_dwordx4 v228, s[8:11], s16 offen lds
    s_add_u32 m0, s19, 87424
    s_nop 0
    buffer_load_dwordx4 v229, s[8:11], s16 offen lds
    s_add_u32 m0, s19, 88448
    s_nop 0
    buffer_load_dwordx4 v230, s[8:11], s16 offen lds
    s_add_u32 m0, s19, 89472
    s_nop 0
    buffer_load_dwordx4 v231, s[8:11], s16 offen lds
    s_add_u32 m0, s19, 90496
    s_nop 0
    buffer_load_dwordx4 v232, s[8:11], s16 offen lds
    s_add_u32 m0, s19, 91520
    s_nop 0
    buffer_load_dwordx4 v233, s[8:11], s16 offen lds
    s_add_u32 m0, s19, 92544
    s_nop 0
    buffer_load_dwordx4 v234, s[8:11], s16 offen lds
    s_add_u32 s16, s16, 229376
    s_cmp_eq_u32 s16, s18
    s_cselect_b32 s16, s17, s16
    s_cmp_eq_u32 s27, 0
    s_cbranch_scc1 cs_38
cs_38_b:
    s_waitcnt lgkmcnt(0)
    s_barrier
    s_cmp_eq_u32 s27, 0
    s_cbranch_scc1 cs_39
cs_39_b:
    v_mfma_f32_16x16x32_bf16 v[0:3], v[96:99], v[144:147], 0
    ds_read_b128 v[160:163], v235 offset:8192
    ds_read_b128 v[164:167], v235 offset:9216
    v_mfma_f32_16x16x32_bf16 v[4:7], v[96:99], v[148:151], 0
    ds_read_b128 v[168:171], v235 offset:10240
    v_mfma_f32_16x16x32_bf16 v[8:11], v[96:99], v[152:155], 0
    ds_read_b128 v[172:175], v235 offset:11264
    ds_read_b64_tr_b16 v[120:121], v237 offset:0
    v_mfma_f32_16x16x32_bf16 v[12:15], v[96:99], v[156:159], 0
    ds_read_b64_tr_b16 v[122:123], v237 offset:3584
    v_mfma_f32_16x16x32_bf16 v[48:51], v[108:111], v[144:147], 0
    ds_read_b64_tr_b16 v[132:133], v237 offset:14400
    ds_read_b64_tr_b16 v[134:135], v237 offset:17984
    v_mfma_f32_16x16x32_bf16 v[52:55], v[108:111], v[148:151], 0
    ds_read_b64_tr_b16 v[124:125], v237 offset:32
    v_mfma_f32_16x16x32_bf16 v[56:59], v[108:111], v[152:155], 0
    ds_read_b64_tr_b16 v[126:127], v237 offset:3616
    ds_read_b64_tr_b16 v[136:137], v237 offset:14432
    v_mfma_f32_16x16x32_bf16 v[60:63], v[108:111], v[156:159], 0
    ds_read_b64_tr_b16 v[138:139], v237 offset:18016
    v_mfma_f32_16x16x32_bf16 v[16:19], v[100:103], v[144:147], 0
    ds_read_b64_tr_b16 v[128:129], v239 offset:0
    ds_read_b64_tr_b16 v[130:131], v239 offset:3584
    v_mfma_f32_16x16x32_bf16 v[20:23], v[100:103], v[148:151], 0
    ds_read_b64_tr_b16 v[140:141], v239 offset:14400
    v_mfma_f32_16x16x32_bf16 v[24:27], v[100:103], v[152:155], 0
    ds_read_b64_tr_b16 v[142:143], v239 offset:17984
    s_mov_b64 exec, 0xffff
pl_540:
    buffer_load_dwordx4 v[240:243], v246, s[80:83], s31 offen sc1
    s_sub_u32 s79, s79, 1
    s_cbranch_scc1 L_abort
    s_waitcnt vmcnt(0)
    v_and_b32 v240, v240, v241
    v_and_b32 v242, v242, v243
    v_and_b32 v240, v240, v242
    v_cmp_ne_u32 vcc, 1, v240
    s_cbranch_vccnz pl_540
    s_mov_b64 exec, -1
    s_cmp_lg_u32 s78, 0
    s_cbranch_scc1 pl_540_acq
pl_540_ok:
    s_add_u32 m0, s23, 16384
    s_nop 0
    buffer_load_dwordx4 v249, s[80:83], s20 offen sc1 lds
    s_add_u32 m0, s23, 16384
    s_nop 0
    buffer_load_dwordx4 v249, s[80:83], s20 offen offset:1024 sc1 lds
    s_add_u32 s20, s20, 8192
    s_cmp_eq_u32 s20, s22
    s_cselect_b32 s20, s21, s20
    v_mfma_f32_16x16x32_bf16 v[28:31], v[100:103], v[156:159], 0
    s_add_u32 m0, s23, 24576
    s_nop 0
    buffer_load_dwordx4 v249, s[80:83], s20 offen sc1 lds
    v_mfma_f32_16x16x32_bf16 v[64:67], v[112:115], v[144:147], 0
    v_mfma_f32_16x16x32_bf16 v[68:71], v[112:115], v[148:151], 0
    s_add_u32 m0, s23, 24576
    s_nop 0
    buffer_load_dwordx4 v249, s[80:83], s20 offen offset:1024 sc1 lds
    s_add_u32 s20, s20, 8192
    s_cmp_eq_u32 s20, s22
    s_cselect_b32 s20, s21, s20
    v_mfma_f32_16x16x32_bf16 v[72:75], v[112:115], v[152:155], 0
    v_mfma_f32_16x16x32_bf16 v[76:79], v[112:115], v[156:159], 0
    s_add_u32 m0, s19, 0
    s_nop 0
    buffer_load_dwordx4 v228, s[8:11], s16 offen lds
    v_mfma_f32_16x16x32_bf16 v[32:35], v[104:107], v[144:147], 0
    v_mfma_f32_16x16x32_bf16 v[36:39], v[104:107], v[148:151], 0
    v_mfma_f32_16x16x32_bf16 v[40:43], v[104:107], v[152:155], 0
    s_add_u32 m0, s19, 1024
    s_nop 0
    buffer_load_dwordx4 v229, s[8:11], s16 offen lds
    v_mfma_f32_16x16x32_bf16 v[44:47], v[104:107], v[156:159], 0
    v_mfma_f32_16x16x32_bf16 v[80:83], v[116:119], v[144:147], 0
    s_add_u32 m0, s19, 2048
    s_nop 0
    buffer_load_dwordx4 v230, s[8:11], s16 offen lds
    s_add_u32 s16, s16, 229376
    s_cmp_eq_u32 s16, s18
    s_cselect_b32 s16, s17, s16
    v_mfma_f32_16x16x32_bf16 v[84:87], v[116:119], v[148:151], 0
    v_mfma_f32_16x16x32_bf16 v[88:91], v[116:119], v[152:155], 0
    v_mfma_f32_16x16x32_bf16 v[92:95], v[116:119], v[156:159], 0
    s_waitcnt vmcnt(5) lgkmcnt(0)
    s_barrier
    s_cmp_eq_u32 s27, 1
    s_cbranch_scc1 cs_541
cs_541_b:
    v_mfma_f32_16x16x32_bf16 v[0:3], v[120:123], v[160:163], v[0:3]
    ds_read_b128 v[144:147], v235 offset:16384
    ds_read_b128 v[148:151], v235 offset:17408
    v_mfma_f32_16x16x32_bf16 v[4:7], v[120:123], v[164:167], v[4:7]
    ds_read_b128 v[152:155], v235 offset:18432
    v_mfma_f32_16x16x32_bf16 v[8:11], v[120:123], v[168:171], v[8:11]
    ds_read_b128 v[156:159], v235 offset:19456
    v_mfma_f32_16x16x32_bf16 v[12:15], v[120:123], v[172:175], v[12:15]
    s_add_u32 m0, s19, 28800
    s_nop 0
    buffer_load_dwordx4 v228, s[8:11], s16 offen lds
    v_mfma_f32_16x16x32_bf16 v[48:51], v[132:135], v[160:163], v[48:51]
    ds_read_b64_tr_b16 v[96:97], v237 offset:28800
    v_mfma_f32_16x16x32_bf16 v[52:55], v[132:135], v[164:167], v[52:55]
    ds_read_b64_tr_b16 v[98:99], v237 offset:32384
    v_mfma_f32_16x16x32_bf16 v[56:59], v[132:135], v[168:171], v[56:59]
    ds_read_b64_tr_b16 v[108:109], v237 offset:43200
    v_mfma_f32_16x16x32_bf16 v[60:63], v[132:135], v[172:175], v[60:63]
    s_add_u32 m0, s19, 29824
    s_nop 0
    buffer_load_dwordx4 v229, s[8:11], s16 offen lds
    v_mfma_f32_16x16x32_bf16 v[16:19], v[124:127], v[160:163], v[16:19]
    ds_read_b64_tr_b16 v[110:111], v237 offset:46784
    v_mfma_f32_16x16x32_bf16 v[20:23], v[124:127], v[164:167], v[20:23]
    ds_read_b64_tr_b16 v[100:101], v237 offset:28832
    v_mfma_f32_16x16x32_bf16 v[24:27], v[124:127], v[168:171], v[24:27]
    ds_read_b64_tr_b16 v[102:103], v237 offset:32416
    v_mfma_f32_16x16x32_bf16 v[28:31], v[124:127], v[172:175], v[28:31]
    s_add_u32 m0, s19, 30848
    s_nop 0
    buffer_load_dwordx4 v230, s[8:11], s16 offen lds
    s_add_u32 s16, s16, 229376
    s_cmp_eq_u32 s16, s18
    s_cselect_b32 s16, s17, s16
    v_mfma_f32_16x16x32_bf16 v[64:67], v[136:139], v[160:163], v[64:67]
    ds_read_b64_tr_b16 v[112:113], v237 offset:43232
    v_mfma_f32_16x16x32_bf16 v[68:71], v[136:139], v[164:167], v[68:71]
    ds_read_b64_tr_b16 v[114:115], v237 offset:46816
    v_mfma_f32_16x16x32_bf16 v[72:75], v[136:139], v[168:171], v[72:75]
    ds_read_b64_tr_b16 v[104:105], v239 offset:28800
    v_mfma_f32_16x16x32_bf16 v[76:79], v[136:139], v[172:175], v[76:79]
    s_add_u32 m0, s23, 0
    s_nop 0
    buffer_load_dwordx4 v249, s[80:83], s20 offen sc1 lds
    v_mfma_f32_16x16x32_bf16 v[32:35], v[128:131], v[160:163], v[32:35]
    ds_read_b64_tr_b16 v[106:107], v239 offset:32384
    v_mfma_f32_16x16x32_bf16 v[36:39], v[128:131], v[164:167], v[36:39]
    ds_read_b64_tr_b16 v[116:117], v239 offset:43200
    v_mfma_f32_16x16x32_bf16 v[40:43], v[128:131], v[168:171], v[40:43]
    ds_read_b64_tr_b16 v[118:119], v239 offset:46784
    v_mfma_f32_16x16x32_bf16 v[44:47], v[128:131], v[172:175], v[44:47]
    s_add_u32 m0, s23, 0
    s_nop 0
    buffer_load_dwordx4 v249, s[80:83], s20 offen offset:1024 sc1 lds
    s_add_u32 s20, s20, 8192
    s_cmp_eq_u32 s20, s22
    s_cselect_b32 s20, s21, s20
    v_mfma_f32_16x16x32_bf16 v[80:83], v[140:143], v[160:163], v[80:83]
    v_mfma_f32_16x16x32_bf16 v[84:87], v[140:143], v[164:167], v[84:87]
    v_mfma_f32_16x16x32_bf16 v[88:91], v[140:143], v[168:171], v[88:91]
    v_mfma_f32_16x16x32_bf16 v[92:95], v[140:143], v[172:175], v[92:95]
    s_waitcnt vmcnt(5) lgkmcnt(0)
    s_barrier
    s_cmp_eq_u32 s27, 1
    s_cbranch_scc1 cs_542
cs_542_b:
    v_mfma_f32_16x16x32_bf16 v[0:3], v[96:99], v[144:147], v[0:3]
    ds_read_b128 v[160:163], v235 offset:24576
    ds_read_b128 v[164:167], v235 offset:25600
    v_mfma_f32_16x16x32_bf16 v[4:7], v[96:99], v[148:151], v[4:7]
    ds_read_b128 v[168:171], v235 offset:26624
    v_mfma_f32_16x16x32_bf16 v[8:11], v[96:99], v[152:155], v[8:11]
    ds_read_b128 v[172:175], v235 offset:27648
    v_mfma_f32_16x16x32_bf16 v[12:15], v[96:99], v[156:159], v[12:15]
    s_add_u32 m0, s19, 57600
    s_nop 0
    buffer_load_dwordx4 v228, s[8:11], s16 offen lds
    v_mfma_f32_16x16x32_bf16 v[48:51], v[108:111], v[144:147], v[48:51]
    ds_read_b64_tr_b16 v[120:121], v236 offset:0
    v_mfma_f32_16x16x32_bf16 v[52:55], v[108:111], v[148:151], v[52:55]
    ds_read_b64_tr_b16 v[122:123], v236 offset:3584
    v_mfma_f32_16x16x32_bf16 v[56:59], v[108:111], v[152:155], v[56:59]
    ds_read_b64_tr_b16 v[132:133], v236 offset:14400
    v_mfma_f32_16x16x32_bf16 v[60:63], v[108:111], v[156:159], v[60:63]
    s_add_u32 m0, s19, 58624
    s_nop 0
    buffer_load_dwordx4 v229, s[8:11], s16 offen lds
    v_mfma_f32_16x16x32_bf16 v[16:19], v[100:103], v[144:147], v[16:19]
    ds_read_b64_tr_b16 v[134:135], v236 offset:17984
    v_mfma_f32_16x16x32_bf16 v[20:23], v[100:103], v[148:151], v[20:23]
    ds_read_b64_tr_b16 v[124:125], v236 offset:32
    v_mfma_f32_16x16x32_bf16 v[24:27], v[100:103], v[152:155], v[24:27]
    ds_read_b64_tr_b16 v[126:127], v236 offset:3616
    v_mfma_f32_16x16x32_bf16 v[28:31], v[100:103], v[156:159], v[28:31]
    s_add_u32 m0, s19, 59648
    s_nop 0
    buffer_load_dwordx4 v230, s[8:11], s16 offen lds
    s_add_u32 s16, s16, 229376
    s_cmp_eq_u32 s16, s18
    s_cselect_b32 s16, s17, s16
    v_mfma_f32_16x16x32_bf16 v[64:67], v[112:115], v[144:147], v[64:67]
    ds_read_b64_tr_b16 v[136:137], v236 offset:14432
    v_mfma_f32_16x16x32_bf16 v[68:71], v[112:115], v[148:151], v[68:71]
    ds_read_b64_tr_b16 v[138:139], v236 offset:18016
    v_mfma_f32_16x16x32_bf16 v[72:75], v[112:115], v[152:155], v[72:75]
    ds_read_b64_tr_b16 v[128:129], v238 offset:0
    v_mfma_f32_16x16x32_bf16 v[76:79], v[112:115], v[156:159], v[76:79]
    s_add_u32 m0, s23, 8192
    s_nop 0
    buffer_load_dwordx4 v249, s[80:83], s20 offen sc1 lds
    v_mfma_f32_16x16x32_bf16 v[32:35], v[104:107], v[144:147], v[32:35]
    ds_read_b64_tr_b16 v[130:131], v238 offset:3584
    v_mfma_f32_16x16x32_bf16 v[36:39], v[104:107], v[148:151], v[36:39]
    ds_read_b64_tr_b16 v[140:141], v238 offset:14400
    v_mfma_f32_16x16x32_bf16 v[40:43], v[104:107], v[152:155], v[40:43]
    ds_read_b64_tr_b16 v[142:143], v238 offset:17984
    v_mfma_f32_16x16x32_bf16 v[44:47], v[104:107], v[156:159], v[44:47]
    s_add_u32 m0, s23, 8192
    s_nop 0
    buffer_load_dwordx4 v249, s[80:83], s20 offen offset:1024 sc1 lds
    s_add_u32 s20, s20, 8192
    s_cmp_eq_u32 s20, s22
    s_cselect_b32 s20, s21, s20
    v_mfma_f32_16x16x32_bf16 v[80:83], v[116:119], v[144:147], v[80:83]
    v_mfma_f32_16x16x32_bf16 v[84:87], v[116:119], v[148:151], v[84:87]
    v_mfma_f32_16x16x32_bf16 v[88:91], v[116:119], v[152:155], v[88:91]
    v_mfma_f32_16x16x32_bf16 v[92:95], v[116:119], v[156:159], v[92:95]
    s_waitcnt vmcnt(5) lgkmcnt(0)
    s_barrier
    v_mfma_f32_16x16x32_bf16 v[0:3], v[120:123], v[160:163], v[0:3]
    ds_read_b128 v[144:147], v235 offset:0
    ds_read_b128 v[148:151], v235 offset:1024
    v_mfma_f32_16x16x32_bf16 v[4:7], v[120:123], v[164:167], v[4:7]
    ds_read_b128 v[152:155], v235 offset:2048
    v_mfma_f32_16x16x32_bf16 v[8:11], v[120:123], v[168:171], v[8:11]
    ds_read_b128 v[156:159], v235 offset:3072
    v_mfma_f32_16x16x32_bf16 v[12:15], v[120:123], v[172:175], v[12:15]
    s_add_u32 m0, s19, 86400
    s_nop 0
    buffer_load_dwordx4 v228, s[8:11], s16 offen lds
    v_mfma_f32_16x16x32_bf16 v[48:51], v[132:135], v[160:163], v[48:51]
    ds_read_b64_tr_b16 v[96:97], v236 offset:28800
    v_mfma_f32_16x16x32_bf16 v[52:55], v[132:135], v[164:167], v[52:55]
    ds_read_b64_tr_b16 v[98:99], v236 offset:32384
    v_mfma_f32_16x16x32_bf16 v[56:59], v[132:135], v[168:171], v[56:59]
    ds_read_b64_tr_b16 v[108:109], v236 offset:43200
    v_mfma_f32_16x16x32_bf16 v[60:63], v[132:135], v[172:175], v[60:63]
    s_add_u32 m0, s19, 87424
    s_nop 0
    buffer_load_dwordx4 v229, s[8:11], s16 offen lds
    v_mfma_f32_16x16x32_bf16 v[16:19], v[124:127], v[160:163], v[16:19]
    ds_read_b64_tr_b16 v[110:111], v236 offset:46784
    v_mfma_f32_16x16x32_bf16 v[20:23], v[124:127], v[164:167], v[20:23]
    ds_read_b64_tr_b16 v[100:101], v236 offset:28832
    v_mfma_f32_16x16x32_bf16 v[24:27], v[124:127], v[168:171], v[24:27]
    ds_read_b64_tr_b16 v[102:103], v236 offset:32416
    v_mfma_f32_16x16x32_bf16 v[28:31], v[124:127], v[172:175], v[28:31]
    s_add_u32 m0, s19, 88448
    s_nop 0
    buffer_load_dwordx4 v230, s[8:11], s16 offen lds
    s_add_u32 s16, s16, 229376
    s_cmp_eq_u32 s16, s18
    s_cselect_b32 s16, s17, s16
    v_mfma_f32_16x16x32_bf16 v[64:67], v[136:139], v[160:163], v[64:67]
    ds_read_b64_tr_b16 v[112:113], v236 offset:43232
    s_lshl_b32 s26, s73, 15
    v_mfma_f32_16x16x32_bf16 v[68:71], v[136:139], v[164:167], v[68:71]
    ds_read_b64_tr_b16 v[114:115], v236 offset:46816
    s_lshl_b32 s65, s75, 20
    v_mfma_f32_16x16x32_bf16 v[72:75], v[136:139], v[168:171], v[72:75]
    ds_read_b64_tr_b16 v[104:105], v238 offset:28800
    s_add_u32 s26, s26, s65
    v_mfma_f32_16x16x32_bf16 v[76:79], v[136:139], v[172:175], v[76:79]
    s_add_u32 m0, s23, 16384
    s_nop 0
    buffer_load_dwordx4 v249, s[80:83], s20 offen sc1 lds
    s_lshl_b32 s65, s69, 9
    v_mfma_f32_16x16x32_bf16 v[32:35], v[128:131], v[160:163], v[32:35]
    ds_read_b64_tr_b16 v[106:107], v238 offset:32384
    s_add_u32 s26, s26, s65
    v_mfma_f32_16x16x32_bf16 v[36:39], v[128:131], v[164:167], v[36:39]
    ds_read_b64_tr_b16 v[116:117], v238 offset:43200
    v_mfma_f32_16x16x32_bf16 v[40:43], v[128:131], v[168:171], v[40:43]
    ds_read_b64_tr_b16 v[118:119], v238 offset:46784
    s_add_u32 s26, s26, 71303168
    v_mfma_f32_16x16x32_bf16 v[44:47], v[128:131], v[172:175], v[44:47]
    s_add_u32 m0, s23, 16384
    s_nop 0
    buffer_load_dwordx4 v249, s[80:83], s20 offen offset:1024 sc1 lds
    s_add_u32 s20, s20, 8192
    s_cmp_eq_u32 s20, s22
    s_cselect_b32 s20, s21, s20
    v_and_b32 v225, 31, v250
    v_mfma_f32_16x16x32_bf16 v[80:83], v[140:143], v[160:163], v[80:83]
    v_lshlrev_b32 v225, 4, v225
    v_mfma_f32_16x16x32_bf16 v[84:87], v[140:143], v[164:167], v[84:87]
    v_lshrrev_b32 v253, 5, v250
    v_mfma_f32_16x16x32_bf16 v[88:91], v[140:143], v[168:171], v[88:91]
    v_lshl_add_u32 v225, v253, 14, v225
    v_mfma_f32_16x16x32_bf16 v[92:95], v[140:143], v[172:175], v[92:95]
    s_waitcnt vmcnt(5) lgkmcnt(0)
    s_barrier
    v_mfma_f32_16x16x32_bf16 v[0:3], v[96:99], v[144:147], v[0:3]
    ds_read_b128 v[160:163], v235 offset:8192
    ds_read_b128 v[164:167], v235 offset:9216
    v_mfma_f32_16x16x32_bf16 v[4:7], v[96:99], v[148:151], v[4:7]
    ds_read_b128 v[168:171], v235 offset:10240
    v_mfma_f32_16x16x32_bf16 v[8:11], v[96:99], v[152:155], v[8:11]
    ds_read_b128 v[172:175], v235 offset:11264
    v_mfma_f32_16x16x32_bf16 v[12:15], v[96:99], v[156:159], v[12:15]
    s_add_u32 m0, s19, 0
    s_nop 0
    buffer_load_dwordx4 v228, s[8:11], s16 offen lds
    v_mfma_f32_16x16x32_bf16 v[48:51], v[108:111], v[144:147], v[48:51]
    ds_read_b64_tr_b16 v[120:121], v237 offset:0
    v_mfma_f32_16x16x32_bf16 v[52:55], v[108:111], v[148:151], v[52:55]
    ds_read_b64_tr_b16 v[122:123], v237 offset:3584
    v_mfma_f32_16x16x32_bf16 v[56:59], v[108:111], v[152:155], v[56:59]
    ds_read_b64_tr_b16 v[132:133], v237 offset:14400
    v_mfma_f32_16x16x32_bf16 v[60:63], v[108:111], v[156:159], v[60:63]
    s_add_u32 m0, s19, 1024
    s_nop 0
    buffer_load_dwordx4 v229, s[8:11], s16 offen lds
    v_mfma_f32_16x16x32_bf16 v[16:19], v[100:103], v[144:147], v[16:19]
    ds_read_b64_tr_b16 v[134:135], v237 offset:17984
    v_mfma_f32_16x16x32_bf16 v[20:23], v[100:103], v[148:151], v[20:23]
    ds_read_b64_tr_b16 v[124:125], v237 offset:32
    v_mfma_f32_16x16x32_bf16 v[24:27], v[100:103], v[152:155], v[24:27]
    ds_read_b64_tr_b16 v[126:127], v237 offset:3616
    v_mfma_f32_16x16x32_bf16 v[28:31], v[100:103], v[156:159], v[28:31]
    s_add_u32 m0, s19, 2048
    s_nop 0
    buffer_load_dwordx4 v230, s[8:11], s16 offen lds
    s_add_u32 s16, s16, 229376
    s_cmp_eq_u32 s16, s18
    s_cselect_b32 s16, s17, s16
    v_mfma_f32_16x16x32_bf16 v[64:67], v[112:115], v[144:147], v[64:67]
    ds_read_b64_tr_b16 v[136:137], v237 offset:14432
    v_mfma_f32_16x16x32_bf16 v[68:71], v[112:115], v[148:151], v[68:71]
    ds_read_b64_tr_b16 v[138:139], v237 offset:18016
    v_mfma_f32_16x16x32_bf16 v[72:75], v[112:115], v[152:155], v[72:75]
    ds_read_b64_tr_b16 v[128:129], v239 offset:0
    v_mfma_f32_16x16x32_bf16 v[76:79], v[112:115], v[156:159], v[76:79]
    s_add_u32 m0, s23, 24576
    s_nop 0
    buffer_load_dwordx4 v249, s[80:83], s20 offen sc1 lds
    v_mfma_f32_16x16x32_bf16 v[32:35], v[104:107], v[144:147], v[32:35]
    ds_read_b64_tr_b16 v[130:131], v239 offset:3584
    v_mfma_f32_16x16x32_bf16 v[36:39], v[104:107], v[148:151], v[36:39]
    ds_read_b64_tr_b16 v[140:141], v239 offset:14400
    v_mfma_f32_16x16x32_bf16 v[40:43], v[104:107], v[152:155], v[40:43]
    ds_read_b64_tr_b16 v[142:143], v239 offset:17984
    v_mfma_f32_16x16x32_bf16 v[44:47], v[104:107], v[156:159], v[44:47]
    s_add_u32 m0, s23, 24576
    s_nop 0
    buffer_load_dwordx4 v249, s[80:83], s20 offen offset:1024 sc1 lds
    s_add_u32 s20, s20, 8192
    s_cmp_eq_u32 s20, s22
    s_cselect_b32 s20, s21, s20
    v_mfma_f32_16x16x32_bf16 v[80:83], v[116:119], v[144:147], v[80:83]
    buffer_load_dwordx4 v[176:179], v225, s[80:83], s26 offen offset:0 sc1
    v_mfma_f32_16x16x32_bf16 v[84:87], v[116:119], v[148:151], v[84:87]
    buffer_load_dwordx4 v[180:183], v225, s[80:83], s26 offen offset:2048 sc1
    s_add_u32 s26, s26, 4096
    v_mfma_f32_16x16x32_bf16 v[88:91], v[116:119], v[152:155], v[88:91]
    buffer_load_dwordx4 v[184:187], v225, s[80:83], s26 offen offset:0 sc1
    v_mfma_f32_16x16x32_bf16 v[92:95], v[116:119], v[156:159], v[92:95]
    buffer_load_dwordx4 v[188:191], v225, s[80:83], s26 offen offset:2048 sc1
    s_add_u32 s26, s26, 4096
    s_waitcnt vmcnt(9) lgkmcnt(0)
    s_barrier
    v_mfma_f32_16x16x32_bf16 v[0:3], v[120:123], v[160:163], v[0:3]
    ds_read_b128 v[144:147], v235 offset:16384
    ds_read_b128 v[148:151], v235 offset:17408
    v_mfma_f32_16x16x32_bf16 v[4:7], v[120:123], v[164:167], v[4:7]
    ds_read_b128 v[152:155], v235 offset:18432
    v_mfma_f32_16x16x32_bf16 v[8:11], v[120:123], v[168:171], v[8:11]
    ds_read_b128 v[156:159], v235 offset:19456
    v_mfma_f32_16x16x32_bf16 v[12:15], v[120:123], v[172:175], v[12:15]
    s_add_u32 m0, s19, 28800
    s_nop 0
    buffer_load_dwordx4 v228, s[8:11], s16 offen lds
    v_mfma_f32_16x16x32_bf16 v[48:51], v[132:135], v[160:163], v[48:51]
    ds_read_b64_tr_b16 v[96:97], v237 offset:28800
    v_mfma_f32_16x16x32_bf16 v[52:55], v[132:135], v[164:167], v[52:55]
    ds_read_b64_tr_b16 v[98:99], v237 offset:32384
    v_mfma_f32_16x16x32_bf16 v[56:59], v[132:135], v[168:171], v[56:59]
    ds_read_b64_tr_b16 v[108:109], v237 offset:43200
    v_mfma_f32_16x16x32_bf16 v[60:63], v[132:135], v[172:175], v[60:63]
    s_add_u32 m0, s19, 29824
    s_nop 0
    buffer_load_dwordx4 v229, s[8:11], s16 offen lds
    v_mfma_f32_16x16x32_bf16 v[16:19], v[124:127], v[160:163], v[16:19]
    ds_read_b64_tr_b16 v[110:111], v237 offset:46784
    v_mfma_f32_16x16x32_bf16 v[20:23], v[124:127], v[164:167], v[20:23]
    ds_read_b64_tr_b16 v[100:101], v237 offset:28832
    v_mfma_f32_16x16x32_bf16 v[24:27], v[124:127], v[168:171], v[24:27]
    ds_read_b64_tr_b16 v[102:103], v237 offset:32416
    v_mfma_f32_16x16x32_bf16 v[28:31], v[124:127], v[172:175], v[28:31]
    s_add_u32 m0, s19, 30848
    s_nop 0
    buffer_load_dwordx4 v230, s[8:11], s16 offen lds
    s_add_u32 s16, s16, 229376
    s_cmp_eq_u32 s16, s18
    s_cselect_b32 s16, s17, s16
    v_mfma_f32_16x16x32_bf16 v[64:67], v[136:139], v[160:163], v[64:67]
    ds_read_b64_tr_b16 v[112:113], v237 offset:43232
    v_mfma_f32_16x16x32_bf16 v[68:71], v[136:139], v[164:167], v[68:71]
    ds_read_b64_tr_b16 v[114:115], v237 offset:46816
    v_mfma_f32_16x16x32_bf16 v[72:75], v[136:139], v[168:171], v[72:75]
    ds_read_b64_tr_b16 v[104:105], v239 offset:28800
    v_mfma_f32_16x16x32_bf16 v[76:79], v[136:139], v[172:175], v[76:79]
    s_add_u32 m0, s23, 0
    s_nop 0
    buffer_load_dwordx4 v249, s[80:83], s20 offen sc1 lds
    v_mfma_f32_16x16x32_bf16 v[32:35], v[128:131], v[160:163], v[32:35]
    ds_read_b64_tr_b16 v[106:107], v239 offset:32384
    v_mfma_f32_16x16x32_bf16 v[36:39], v[128:131], v[164:167], v[36:39]
    ds_read_b64_tr_b16 v[116:117], v239 offset:43200
    v_mfma_f32_16x16x32_bf16 v[40:43], v[128:131], v[168:171], v[40:43]
    ds_read_b64_tr_b16 v[118:119], v239 offset:46784
    v_mfma_f32_16x16x32_bf16 v[44:47], v[128:131], v[172:175], v[44:47]
    s_add_u32 m0, s23, 0
    s_nop 0
    buffer_load_dwordx4 v249, s[80:83], s20 offen offset:1024 sc1 lds
    s_add_u32 s20, s20, 8192
    s_cmp_eq_u32 s20, s22
    s_cselect_b32 s20, s21, s20
    v_mfma_f32_16x16x32_bf16 v[80:83], v[140:143], v[160:163], v[80:83]
    buffer_load_dwordx4 v[192:195], v225, s[80:83], s26 offen offset:0 sc1
    v_mfma_f32_16x16x32_bf16 v[84:87], v[140:143], v[164:167], v[84:87]
    buffer_load_dwordx4 v[196:199], v225, s[80:83], s26 offen offset:2048 sc1
    s_add_u32 s26, s26, 4096
    v_mfma_f32_16x16x32_bf16 v[88:91], v[140:143], v[168:171], v[88:91]
    buffer_load_dwordx4 v[200:203], v225, s[80:83], s26 offen offset:0 sc1
    v_mfma_f32_16x16x32_bf16 v[92:95], v[140:143], v[172:175], v[92:95]
    buffer_load_dwordx4 v[204:207], v225, s[80:83], s26 offen offset:2048 sc1
    s_add_u32 s26, s26, 4096
    s_waitcnt vmcnt(13) lgkmcnt(0)
    s_barrier
    s_cmp_eq_u32 s75, 0
    s_cbranch_scc1 cf_1043
cf_1043_b:
    v_mfma_f32_16x16x32_bf16 v[0:3], v[96:99], v[144:147], v[0:3]
    ds_read_b128 v[160:163], v235 offset:24576
    ds_read_b128 v[164:167], v235 offset:25600
    v_mfma_f32_16x16x32_bf16 v[4:7], v[96:99], v[148:151], v[4:7]
    ds_read_b128 v[168:171], v235 offset:26624
    v_mfma_f32_16x16x32_bf16 v[8:11], v[96:99], v[152:155], v[8:11]
    ds_read_b128 v[172:175], v235 offset:27648
    v_mfma_f32_16x16x32_bf16 v[12:15], v[96:99], v[156:159], v[12:15]
    s_add_u32 m0, s19, 57600
    s_nop 0
    buffer_load_dwordx4 v228, s[8:11], s16 offen lds
    v_mfma_f32_16x16x32_bf16 v[48:51], v[108:111], v[144:147], v[48:51]
    ds_read_b64_tr_b16 v[120:121], v236 offset:0
    v_mfma_f32_16x16x32_bf16 v[52:55], v[108:111], v[148:151], v[52:55]
    ds_read_b64_tr_b16 v[122:123], v236 offset:3584
    v_mfma_f32_16x16x32_bf16 v[56:59], v[108:111], v[152:155], v[56:59]
    ds_read_b64_tr_b16 v[132:133], v236 offset:14400
    v_mfma_f32_16x16x32_bf16 v[60:63], v[108:111], v[156:159], v[60:63]
    s_add_u32 m0, s19, 58624
    s_nop 0
    buffer_load_dwordx4 v229, s[8:11], s16 offen lds
    v_mfma_f32_16x16x32_bf16 v[16:19], v[100:103], v[144:147], v[16:19]
    ds_read_b64_tr_b16 v[134:135], v236 offset:17984
    v_mfma_f32_16x16x32_bf16 v[20:23], v[100:103], v[148:151], v[20:23]
    ds_read_b64_tr_b16 v[124:125], v236 offset:32
    v_mfma_f32_16x16x32_bf16 v[24:27], v[100:103], v[152:155], v[24:27]
    ds_read_b64_tr_b16 v[126:127], v236 offset:3616
    v_mfma_f32_16x16x32_bf16 v[28:31], v[100:103], v[156:159], v[28:31]
    s_add_u32 m0, s19, 59648
    s_nop 0
    buffer_load_dwordx4 v230, s[8:11], s16 offen lds
    s_add_u32 s16, s16, 229376
    s_cmp_eq_u32 s16, s18
    s_cselect_b32 s16, s17, s16
    v_mfma_f32_16x16x32_bf16 v[64:67], v[112:115], v[144:147], v[64:67]
    ds_read_b64_tr_b16 v[136:137], v236 offset:14432
    v_mfma_f32_16x16x32_bf16 v[68:71], v[112:115], v[148:151], v[68:71]
    ds_read_b64_tr_b16 v[138:139], v236 offset:18016
    v_mfma_f32_16x16x32_bf16 v[72:75], v[112:115], v[152:155], v[72:75]
    ds_read_b64_tr_b16 v[128:129], v238 offset:0
    v_mfma_f32_16x16x32_bf16 v[76:79], v[112:115], v[156:159], v[76:79]
    s_add_u32 m0, s23, 8192
    s_nop 0
    buffer_load_dwordx4 v249, s[80:83], s20 offen sc1 lds
    v_mfma_f32_16x16x32_bf16 v[32:35], v[104:107], v[144:147], v[32:35]
    ds_read_b64_tr_b16 v[130:131], v238 offset:3584
    v_mfma_f32_16x16x32_bf16 v[36:39], v[104:107], v[148:151], v[36:39]
    ds_read_b64_tr_b16 v[140:141], v238 offset:14400
    v_mfma_f32_16x16x32_bf16 v[40:43], v[104:107], v[152:155], v[40:43]
    ds_read_b64_tr_b16 v[142:143], v238 offset:17984
    v_mfma_f32_16x16x32_bf16 v[44:47], v[104:107], v[156:159], v[44:47]
    s_add_u32 m0, s23, 8192
    s_nop 0
    buffer_load_dwordx4 v249, s[80:83], s20 offen offset:1024 sc1 lds
    s_add_u32 s20, s20, 8192
    s_cmp_eq_u32 s20, s22
    s_cselect_b32 s20, s21, s20
    v_mfma_f32_16x16x32_bf16 v[80:83], v[116:119], v[144:147], v[80:83]
    v_mfma_f32_16x16x32_bf16 v[84:87], v[116:119], v[148:151], v[84:87]
    v_mfma_f32_16x16x32_bf16 v[88:91], v[116:119], v[152:155], v[88:91]
    v_mfma_f32_16x16x32_bf16 v[92:95], v[116:119], v[156:159], v[92:95]
    s_waitcnt vmcnt(5) lgkmcnt(0)
    s_barrier
    v_mfma_f32_16x16x32_bf16 v[0:3], v[120:123], v[160:163], v[0:3]
    ds_read_b128 v[144:147], v235 offset:0
    ds_read_b128 v[148:151], v235 offset:1024
    v_pk_add_f32 v[176:177], v[176:177], v[192:193]
    v_pk_add_f32 v[178:179], v[178:179], v[194:195]
    v_mfma_f32_16x16x32_bf16 v[4:7], v[120:123], v[164:167], v[4:7]
    ds_read_b128 v[152:155], v235 offset:2048
    v_pk_add_f32 v[180:181], v[180:181], v[196:197]
    v_pk_add_f32 v[182:183], v[182:183], v[198:199]
    v_mfma_f32_16x16x32_bf16 v[8:11], v[120:123], v[168:171], v[8:11]
    ds_read_b128 v[156:159], v235 offset:3072
    v_pk_add_f32 v[184:185], v[184:185], v[200:201]
    v_pk_add_f32 v[186:187], v[186:187], v[202:203]
    v_mfma_f32_16x16x32_bf16 v[12:15], v[120:123], v[172:175], v[12:15]
    s_add_u32 m0, s19, 86400
    s_nop 0
    buffer_load_dwordx4 v228, s[8:11], s16 offen lds
    v_pk_add_f32 v[188:189], v[188:189], v[204:205]
    v_pk_add_f32 v[190:191], v[190:191], v[206:207]
    v_mfma_f32_16x16x32_bf16 v[48:51], v[132:135], v[160:163], v[48:51]
    ds_read_b64_tr_b16 v[96:97], v236 offset:28800
    v_pk_add_f32 v[176:177], v[176:177], v[184:185]
    v_pk_add_f32 v[178:179], v[178:179], v[186:187]
    v_mfma_f32_16x16x32_bf16 v[52:55], v[132:135], v[164:167], v[52:55]
    ds_read_b64_tr_b16 v[98:99], v236 offset:32384
    v_pk_add_f32 v[180:181], v[180:181], v[188:189]
    v_pk_add_f32 v[182:183], v[182:183], v[190:191]
    v_mfma_f32_16x16x32_bf16 v[56:59], v[132:135], v[168:171], v[56:59]
    ds_read_b64_tr_b16 v[108:109], v236 offset:43200
    v_pk_add_f32 v[176:177], v[176:177], v[180:181]
    v_pk_add_f32 v[178:179], v[178:179], v[182:183]
    v_mfma_f32_16x16x32_bf16 v[60:63], v[132:135], v[172:175], v[60:63]
    s_add_u32 m0, s19, 87424
    s_nop 0
    buffer_load_dwordx4 v229, s[8:11], s16 offen lds
    v_add_f32 v176, v176, v178
    v_add_f32 v177, v177, v179
    v_mfma_f32_16x16x32_bf16 v[16:19], v[124:127], v[160:163], v[16:19]
    ds_read_b64_tr_b16 v[110:111], v236 offset:46784
    v_mov_b32 v178, v176
    v_mov_b32 v179, v177
    v_mfma_f32_16x16x32_bf16 v[20:23], v[124:127], v[164:167], v[20:23]
    ds_read_b64_tr_b16 v[100:101], v236 offset:28832
    s_nop 1
    v_permlane32_swap_b32 v176, v178
    v_mfma_f32_16x16x32_bf16 v[24:27], v[124:127], v[168:171], v[24:27]
    ds_read_b64_tr_b16 v[102:103], v236 offset:32416
    v_permlane32_swap_b32 v177, v179
    v_add_f32 v176, v176, v178
    v_mfma_f32_16x16x32_bf16 v[28:31], v[124:127], v[172:175], v[28:31]
    s_add_u32 m0, s19, 88448
    s_nop 0
    buffer_load_dwordx4 v230, s[8:11], s16 offen lds
    s_add_u32 s16, s16, 229376
    s_cmp_eq_u32 s16, s18
    s_cselect_b32 s16, s17, s16
    v_add_f32 v177, v177, v179
    v_mfma_f32_16x16x32_bf16 v[64:67], v[136:139], v[160:163], v[64:67]
    ds_read_b64_tr_b16 v[112:113], v236 offset:43232
    v_mul_f32 v176, 0x3a800000, v176
    v_mul_f32 v177, 0x3a800000, v177
    v_mfma_f32_16x16x32_bf16 v[68:71], v[136:139], v[164:167], v[68:71]
    ds_read_b64_tr_b16 v[114:115], v236 offset:46816
    v_fma_f32 v177, -v176, v176, v177
    v_max_f32 v177, 0, v177
    v_mfma_f32_16x16x32_bf16 v[72:75], v[136:139], v[168:171], v[72:75]
    ds_read_b64_tr_b16 v[104:105], v238 offset:28800
    v_cvt_pk_bf16_f32 v176, v176, v176
    v_lshlrev_b32 v176, 16, v176
    v_mfma_f32_16x16x32_bf16 v[76:79], v[136:139], v[172:175], v[76:79]
    s_add_u32 m0, s23, 16384
    s_nop 0
    buffer_load_dwordx4 v249, s[80:83], s20 offen sc1 lds
    v_cvt_pk_bf16_f32 v177, v177, v177
    v_lshlrev_b32 v177, 16, v177
    v_mfma_f32_16x16x32_bf16 v[32:35], v[128:131], v[160:163], v[32:35]
    ds_read_b64_tr_b16 v[106:107], v238 offset:32384
    v_add_f32 v177, 0x3727c5ac, v177
    v_cvt_pk_bf16_f32 v177, v177, v177
    v_mfma_f32_16x16x32_bf16 v[36:39], v[128:131], v[164:167], v[36:39]
    ds_read_b64_tr_b16 v[116:117], v238 offset:43200
    v_lshlrev_b32 v177, 16, v177
    v_sqrt_f32 v177, v177
    v_mfma_f32_16x16x32_bf16 v[40:43], v[128:131], v[168:171], v[40:43]
    ds_read_b64_tr_b16 v[118:119], v238 offset:46784
    s_nop 0
    v_cvt_pk_bf16_f32 v177, v177, v177
    v_mfma_f32_16x16x32_bf16 v[44:47], v[128:131], v[172:175], v[44:47]
    s_add_u32 m0, s23, 16384
    s_nop 0
    buffer_load_dwordx4 v249, s[80:83], s20 offen offset:1024 sc1 lds
    s_add_u32 s20, s20, 8192
    s_cmp_eq_u32 s20, s22
    s_cselect_b32 s20, s21, s20
    v_lshlrev_b32 v177, 16, v177
    v_rcp_f32 v177, v177
    v_mfma_f32_16x16x32_bf16 v[80:83], v[140:143], v[160:163], v[80:83]
    s_nop 0
    v_and_b32 v225, 31, v250
    v_mfma_f32_16x16x32_bf16 v[84:87], v[140:143], v[164:167], v[84:87]
    s_lshl_b32 s64, s69, 8
    s_add_u32 s64, s64, 159744
    v_mfma_f32_16x16x32_bf16 v[88:91], v[140:143], v[168:171], v[88:91]
    v_lshlrev_b32 v225, 3, v225
    v_add_u32 v225, s64, v225
    v_mfma_f32_16x16x32_bf16 v[92:95], v[140:143], v[172:175], v[92:95]
    ds_write_b64 v225, v[176:177]
    s_mov_b32 s24, 5
    s_cmp_eq_u32 s75, 0
    s_cselect_b32 s27, 6, 0
g3c1_loop:
    s_waitcnt vmcnt(5) lgkmcnt(0)
    s_barrier
    s_bitcmp1_b32 s27, s24
    s_cbranch_scc1 g3c1_hook
g3c1_hb:
    v_mfma_f32_16x16x32_bf16 v[0:3], v[96:99], v[144:147], v[0:3]
    ds_read_b128 v[160:163], v235 offset:8192
    ds_read_b128 v[164:167], v235 offset:9216
    v_mfma_f32_16x16x32_bf16 v[4:7], v[96:99], v[148:151], v[4:7]
    ds_read_b128 v[168:171], v235 offset:10240
    v_mfma_f32_16x16x32_bf16 v[8:11], v[96:99], v[152:155], v[8:11]
    ds_read_b128 v[172:175], v235 offset:11264
    v_mfma_f32_16x16x32_bf16 v[12:15], v[96:99], v[156:159], v[12:15]
    s_add_u32 m0, s19, 0
    s_nop 0
    buffer_load_dwordx4 v228, s[8:11], s16 offen lds
    v_mfma_f32_16x16x32_bf16 v[48:51], v[108:111], v[144:147], v[48:51]
    ds_read_b64_tr_b16 v[120:121], v237 offset:0
    v_mfma_f32_16x16x32_bf16 v[52:55], v[108:111], v[148:151], v[52:55]
    ds_read_b64_tr_b16 v[122:123], v237 offset:3584
    v_mfma_f32_16x16x32_bf16 v[56:59], v[108:111], v[152:155], v[56:59]
    ds_read_b64_tr_b16 v[132:133], v237 offset:14400
    v_mfma_f32_16x16x32_bf16 v[60:63], v[108:111], v[156:159], v[60:63]
    s_add_u32 m0, s19, 1024
    s_nop 0
    buffer_load_dwordx4 v229, s[8:11], s16 offen lds
    v_mfma_f32_16x16x32_bf16 v[16:19], v[100:103], v[144:147], v[16:19]
    ds_read_b64_tr_b16 v[134:135], v237 offset:17984
    v_mfma_f32_16x16x32_bf16 v[20:23], v[100:103], v[148:151], v[20:23]
    ds_read_b64_tr_b16 v[124:125], v237 offset:32
    v_mfma_f32_16x16x32_bf16 v[24:27], v[100:103], v[152:155], v[24:27]
    ds_read_b64_tr_b16 v[126:127], v237 offset:3616
    v_mfma_f32_16x16x32_bf16 v[28:31], v[100:103], v[156:159], v[28:31]
    s_add_u32 m0, s19, 2048
    s_nop 0
    buffer_load_dwordx4 v230, s[8:11], s16 offen lds
    s_add_u32 s16, s16, 229376
    s_cmp_eq_u32 s16, s18
    s_cselect_b32 s16, s17, s16
    v_mfma_f32_16x16x32_bf16 v[64:67], v[112:115], v[144:147], v[64:67]
    ds_read_b64_tr_b16 v[136:137], v237 offset:14432
    v_mfma_f32_16x16x32_bf16 v[68:71], v[112:115], v[148:151], v[68:71]
    ds_read_b64_tr_b16 v[138:139], v237 offset:18016
    v_mfma_f32_16x16x32_bf16 v[72:75], v[112:115], v[152:155], v[72:75]
    ds_read_b64_tr_b16 v[128:129], v239 offset:0
    v_mfma_f32_16x16x32_bf16 v[76:79], v[112:115], v[156:159], v[76:79]
    s_add_u32 m0, s23, 24576
    s_nop 0
    buffer_load_dwordx4 v249, s[80:83], s20 offen sc1 lds
    v_mfma_f32_16x16x32_bf16 v[32:35], v[104:107], v[144:147], v[32:35]
    ds_read_b64_tr_b16 v[130:131], v239 offset:3584
    v_mfma_f32_16x16x32_bf16 v[36:39], v[104:107], v[148:151], v[36:39]
    ds_read_b64_tr_b16 v[140:141], v239 offset:14400
    v_mfma_f32_16x16x32_bf16 v[40:43], v[104:107], v[152:155], v[40:43]
    ds_read_b64_tr_b16 v[142:143], v239 offset:17984
    v_mfma_f32_16x16x32_bf16 v[44:47], v[104:107], v[156:159], v[44:47]
    s_add_u32 m0, s23, 24576
    s_nop 0
    buffer_load_dwordx4 v249, s[80:83], s20 offen offset:1024 sc1 lds
    s_add_u32 s20, s20, 8192
    s_cmp_eq_u32 s20, s22
    s_cselect_b32 s20, s21, s20
    v_mfma_f32_16x16x32_bf16 v[80:83], v[116:119], v[144:147], v[80:83]
    v_mfma_f32_16x16x32_bf16 v[84:87], v[116:119], v[148:151], v[84:87]
    v_mfma_f32_16x16x32_bf16 v[88:91], v[116:119], v[152:155], v[88:91]
    v_mfma_f32_16x16x32_bf16 v[92:95], v[116:119], v[156:159], v[92:95]
    s_waitcnt vmcnt(5) lgkmcnt(0)
    s_barrier
    v_mfma_f32_16x16x32_bf16 v[0:3], v[120:123], v[160:163], v[0:3]
    ds_read_b128 v[144:147], v235 offset:16384
    ds_read_b128 v[148:151], v235 offset:17408
    v_mfma_f32_16x16x32_bf16 v[4:7], v[120:123], v[164:167], v[4:7]
    ds_read_b128 v[152:155], v235 offset:18432
    v_mfma_f32_16x16x32_bf16 v[8:11], v[120:123], v[168:171], v[8:11]
    ds_read_b128 v[156:159], v235 offset:19456
    v_mfma_f32_16x16x32_bf16 v[12:15], v[120:123], v[172:175], v[12:15]
    s_add_u32 m0, s19, 28800
    s_nop 0
    buffer_load_dwordx4 v228, s[8:11], s16 offen lds
    v_mfma_f32_16x16x32_bf16 v[48:51], v[132:135], v[160:163], v[48:51]
    ds_read_b64_tr_b16 v[96:97], v237 offset:28800
    v_mfma_f32_16x16x32_bf16 v[52:55], v[132:135], v[164:167], v[52:55]
    ds_read_b64_tr_b16 v[98:99], v237 offset:32384
    v_mfma_f32_16x16x32_bf16 v[56:59], v[132:135], v[168:171], v[56:59]
    ds_read_b64_tr_b16 v[108:109], v237 offset:43200
    v_mfma_f32_16x16x32_bf16 v[60:63], v[132:135], v[172:175], v[60:63]
    s_add_u32 m0, s19, 29824
    s_nop 0
    buffer_load_dwordx4 v229, s[8:11], s16 offen lds
    v_mfma_f32_16x16x32_bf16 v[16:19], v[124:127], v[160:163], v[16:19]
    ds_read_b64_tr_b16 v[110:111], v237 offset:46784
    v_mfma_f32_16x16x32_bf16 v[20:23], v[124:127], v[164:167], v[20:23]
    ds_read_b64_tr_b16 v[100:101], v237 offset:28832
    v_mfma_f32_16x16x32_bf16 v[24:27], v[124:127], v[168:171], v[24:27]
    ds_read_b64_tr_b16 v[102:103], v237 offset:32416
    v_mfma_f32_16x16x32_bf16 v[28:31], v[124:127], v[172:175], v[28:31]
    s_add_u32 m0, s19, 30848
    s_nop 0
    buffer_load_dwordx4 v230, s[8:11], s16 offen lds
    s_add_u32 s16, s16, 229376
    s_cmp_eq_u32 s16, s18
    s_cselect_b32 s16, s17, s16
    v_mfma_f32_16x16x32_bf16 v[64:67], v[136:139], v[160:163], v[64:67]
    ds_read_b64_tr_b16 v[112:113], v237 offset:43232
    v_mfma_f32_16x16x32_bf16 v[68:71], v[136:139], v[164:167], v[68:71]
    ds_read_b64_tr_b16 v[114:115], v237 offset:46816
    v_mfma_f32_16x16x32_bf16 v[72:75], v[136:139], v[168:171], v[72:75]
    ds_read_b64_tr_b16 v[104:105], v239 offset:28800
    v_mfma_f32_16x16x32_bf16 v[76:79], v[136:139], v[172:175], v[76:79]
    s_add_u32 m0, s23, 0
    s_nop 0
    buffer_load_dwordx4 v249, s[80:83], s20 offen sc1 lds
    v_mfma_f32_16x16x32_bf16 v[32:35], v[128:131], v[160:163], v[32:35]
    ds_read_b64_tr_b16 v[106:107], v239 offset:32384
    v_mfma_f32_16x16x32_bf16 v[36:39], v[128:131], v[164:167], v[36:39]
    ds_read_b64_tr_b16 v[116:117], v239 offset:43200
    v_mfma_f32_16x16x32_bf16 v[40:43], v[128:131], v[168:171], v[40:43]
    ds_read_b64_tr_b16 v[118:119], v239 offset:46784
    v_mfma_f32_16x16x32_bf16 v[44:47], v[128:131], v[172:175], v[44:47]
    s_add_u32 m0, s23, 0
    s_nop 0
    buffer_load_dwordx4 v249, s[80:83], s20 offen offset:1024 sc1 lds
    s_add_u32 s20, s20, 8192
    s_cmp_eq_u32 s20, s22
    s_cselect_b32 s20, s21, s20
    v_mfma_f32_16x16x32_bf16 v[80:83], v[140:143], v[160:163], v[80:83]
    v_mfma_f32_16x16x32_bf16 v[84:87], v[140:143], v[164:167], v[84:87]
    v_mfma_f32_16x16x32_bf16 v[88:91], v[140:143], v[168:171], v[88:91]
    v_mfma_f32_16x16x32_bf16 v[92:95], v[140:143], v[172:175], v[92:95]
    s_waitcnt vmcnt(5) lgkmcnt(0)
    s_barrier
    v_mfma_f32_16x16x32_bf16 v[0:3], v[96:99], v[144:147], v[0:3]
    ds_read_b128 v[160:163], v235 offset:24576
    ds_read_b128 v[164:167], v235 offset:25600
    v_mfma_f32_16x16x32_bf16 v[4:7], v[96:99], v[148:151], v[4:7]
    ds_read_b128 v[168:171], v235 offset:26624
    v_mfma_f32_16x16x32_bf16 v[8:11], v[96:99], v[152:155], v[8:11]
    ds_read_b128 v[172:175], v235 offset:27648
    v_mfma_f32_16x16x32_bf16 v[12:15], v[96:99], v[156:159], v[12:15]
    s_add_u32 m0, s19, 57600
    s_nop 0
    buffer_load_dwordx4 v228, s[8:11], s16 offen lds
    v_mfma_f32_16x16x32_bf16 v[48:51], v[108:111], v[144:147], v[48:51]
    ds_read_b64_tr_b16 v[120:121], v236 offset:0
    v_mfma_f32_16x16x32_bf16 v[52:55], v[108:111], v[148:151], v[52:55]
    ds_read_b64_tr_b16 v[122:123], v236 offset:3584
    v_mfma_f32_16x16x32_bf16 v[56:59], v[108:111], v[152:155], v[56:59]
    ds_read_b64_tr_b16 v[132:133], v236 offset:14400
    v_mfma_f32_16x16x32_bf16 v[60:63], v[108:111], v[156:159], v[60:63]
    s_add_u32 m0, s19, 58624
    s_nop 0
    buffer_load_dwordx4 v229, s[8:11], s16 offen lds
    v_mfma_f32_16x16x32_bf16 v[16:19], v[100:103], v[144:147], v[16:19]
    ds_read_b64_tr_b16 v[134:135], v236 offset:17984
    v_mfma_f32_16x16x32_bf16 v[20:23], v[100:103], v[148:151], v[20:23]
    ds_read_b64_tr_b16 v[124:125], v236 offset:32
    v_mfma_f32_16x16x32_bf16 v[24:27], v[100:103], v[152:155], v[24:27]
    ds_read_b64_tr_b16 v[126:127], v236 offset:3616
    v_mfma_f32_16x16x32_bf16 v[28:31], v[100:103], v[156:159], v[28:31]
    s_add_u32 m0, s19, 59648
    s_nop 0
    buffer_load_dwordx4 v230, s[8:11], s16 offen lds
    s_add_u32 s16, s16, 229376
    s_cmp_eq_u32 s16, s18
    s_cselect_b32 s16, s17, s16
    v_mfma_f32_16x16x32_bf16 v[64:67], v[112:115], v[144:147], v[64:67]
    ds_read_b64_tr_b16 v[136:137], v236 offset:14432
    v_mfma_f32_16x16x32_bf16 v[68:71], v[112:115], v[148:151], v[68:71]
    ds_read_b64_tr_b16 v[138:139], v236 offset:18016
    v_mfma_f32_16x16x32_bf16 v[72:75], v[112:115], v[152:155], v[72:75]
    ds_read_b64_tr_b16 v[128:129], v238 offset:0
    v_mfma_f32_16x16x32_bf16 v[76:79], v[112:115], v[156:159], v[76:79]
    s_add_u32 m0, s23, 8192
    s_nop 0
    buffer_load_dwordx4 v249, s[80:83], s20 offen sc1 lds
    v_mfma_f32_16x16x32_bf16 v[32:35], v[104:107], v[144:147], v[32:35]
    ds_read_b64_tr_b16 v[130:131], v238 offset:3584
    v_mfma_f32_16x16x32_bf16 v[36:39], v[104:107], v[148:151], v[36:39]
    ds_read_b64_tr_b16 v[140:141], v238 offset:14400
    v_mfma_f32_16x16x32_bf16 v[40:43], v[104:107], v[152:155], v[40:43]
    ds_read_b64_tr_b16 v[142:143], v238 offset:17984
    v_mfma_f32_16x16x32_bf16 v[44:47], v[104:107], v[156:159], v[44:47]
    s_add_u32 m0, s23, 8192
    s_nop 0
    buffer_load_dwordx4 v249, s[80:83], s20 offen offset:1024 sc1 lds
    s_add_u32 s20, s20, 8192
    s_cmp_eq_u32 s20, s22
    s_cselect_b32 s20, s21, s20
    v_mfma_f32_16x16x32_bf16 v[80:83], v[116:119], v[144:147], v[80:83]
    v_mfma_f32_16x16x32_bf16 v[84:87], v[116:119], v[148:151], v[84:87]
    v_mfma_f32_16x16x32_bf16 v[88:91], v[116:119], v[152:155], v[88:91]
    v_mfma_f32_16x16x32_bf16 v[92:95], v[116:119], v[156:159], v[92:95]
    s_waitcnt vmcnt(5) lgkmcnt(0)
    s_barrier
    v_mfma_f32_16x16x32_bf16 v[0:3], v[120:123], v[160:163], v[0:3]
    ds_read_b128 v[144:147], v235 offset:0
    ds_read_b128 v[148:151], v235 offset:1024
    v_mfma_f32_16x16x32_bf16 v[4:7], v[120:123], v[164:167], v[4:7]
    ds_read_b128 v[152:155], v235 offset:2048
    v_mfma_f32_16x16x32_bf16 v[8:11], v[120:123], v[168:171], v[8:11]
    ds_read_b128 v[156:159], v235 offset:3072
    v_mfma_f32_16x16x32_bf16 v[12:15], v[120:123], v[172:175], v[12:15]
    s_add_u32 m0, s19, 86400
    s_nop 0
    buffer_load_dwordx4 v228, s[8:11], s16 offen lds
    v_mfma_f32_16x16x32_bf16 v[48:51], v[132:135], v[160:163], v[48:51]
    ds_read_b64_tr_b16 v[96:97], v236 offset:28800
    v_mfma_f32_16x16x32_bf16 v[52:55], v[132:135], v[164:167], v[52:55]
    ds_read_b64_tr_b16 v[98:99], v236 offset:32384
    v_mfma_f32_16x16x32_bf16 v[56:59], v[132:135], v[168:171], v[56:59]
    ds_read_b64_tr_b16 v[108:109], v236 offset:43200
    v_mfma_f32_16x16x32_bf16 v[60:63], v[132:135], v[172:175], v[60:63]
    s_add_u32 m0, s19, 87424
    s_nop 0
    buffer_load_dwordx4 v229, s[8:11], s16 offen lds
    v_mfma_f32_16x16x32_bf16 v[16:19], v[124:127], v[160:163], v[16:19]
    ds_read_b64_tr_b16 v[110:111], v236 offset:46784
    v_mfma_f32_16x16x32_bf16 v[20:23], v[124:127], v[164:167], v[20:23]
    ds_read_b64_tr_b16 v[100:101], v236 offset:28832
    v_mfma_f32_16x16x32_bf16 v[24:27], v[124:127], v[168:171], v[24:27]
    ds_read_b64_tr_b16 v[102:103], v236 offset:32416
    v_mfma_f32_16x16x32_bf16 v[28:31], v[124:127], v[172:175], v[28:31]
    s_add_u32 m0, s19, 88448
    s_nop 0
    buffer_load_dwordx4 v230, s[8:11], s16 offen lds
    s_add_u32 s16, s16, 229376
    s_cmp_eq_u32 s16, s18
    s_cselect_b32 s16, s17, s16
    v_mfma_f32_16x16x32_bf16 v[64:67], v[136:139], v[160:163], v[64:67]
    ds_read_b64_tr_b16 v[112:113], v236 offset:43232
    v_mfma_f32_16x16x32_bf16 v[68:71], v[136:139], v[164:167], v[68:71]
    ds_read_b64_tr_b16 v[114:115], v236 offset:46816
    v_mfma_f32_16x16x32_bf16 v[72:75], v[136:139], v[168:171], v[72:75]
    ds_read_b64_tr_b16 v[104:105], v238 offset:28800
    v_mfma_f32_16x16x32_bf16 v[76:79], v[136:139], v[172:175], v[76:79]
    s_add_u32 m0, s23, 16384
    s_nop 0
    buffer_load_dwordx4 v249, s[80:83], s20 offen sc1 lds
    v_mfma_f32_16x16x32_bf16 v[32:35], v[128:131], v[160:163], v[32:35]
    ds_read_b64_tr_b16 v[106:107], v238 offset:32384
    v_mfma_f32_16x16x32_bf16 v[36:39], v[128:131], v[164:167], v[36:39]
    ds_read_b64_tr_b16 v[116:117], v238 offset:43200
    v_mfma_f32_16x16x32_bf16 v[40:43], v[128:131], v[168:171], v[40:43]
    ds_read_b64_tr_b16 v[118:119], v238 offset:46784
    v_mfma_f32_16x16x32_bf16 v[44:47], v[128:131], v[172:175], v[44:47]
    s_add_u32 m0, s23, 16384
    s_nop 0
    buffer_load_dwordx4 v249, s[80:83], s20 offen offset:1024 sc1 lds
    s_add_u32 s20, s20, 8192
    s_cmp_eq_u32 s20, s22
    s_cselect_b32 s20, s21, s20
    v_mfma_f32_16x16x32_bf16 v[80:83], v[140:143], v[160:163], v[80:83]
    v_mfma_f32_16x16x32_bf16 v[84:87], v[140:143], v[164:167], v[84:87]
    v_mfma_f32_16x16x32_bf16 v[88:91], v[140:143], v[168:171], v[88:91]
    v_mfma_f32_16x16x32_bf16 v[92:95], v[140:143], v[172:175], v[92:95]
    s_sub_u32 s24, s24, 1
    s_cmp_lg_u32 s24, 0
    s_cbranch_scc1 g3c1_loop
    s_sub_u32 s27, s74, s58
    s_and_b32 s27, s27, 7
    s_cmp_lt_u32 s27, 4
    s_cselect_b32 s27, 14, 0
    s_waitcnt vmcnt(5) lgkmcnt(0)
    s_barrier
    v_mfma_f32_16x16x32_bf16 v[0:3], v[96:99], v[144:147], v[0:3]
    ds_read_b128 v[160:163], v235 offset:8192
    ds_read_b128 v[164:167], v235 offset:9216
    v_pk_add_f32 v[176:177], v[176:177], v[192:193]
    v_pk_add_f32 v[178:179], v[178:179], v[194:195]
    v_mfma_f32_16x16x32_bf16 v[4:7], v[96:99], v[148:151], v[4:7]
    ds_read_b128 v[168:171], v235 offset:10240
    v_pk_add_f32 v[180:181], v[180:181], v[196:197]
    v_mfma_f32_16x16x32_bf16 v[8:11], v[96:99], v[152:155], v[8:11]
    ds_read_b128 v[172:175], v235 offset:11264
    v_pk_add_f32 v[182:183], v[182:183], v[198:199]
    v_mfma_f32_16x16x32_bf16 v[12:15], v[96:99], v[156:159], v[12:15]
    s_add_u32 m0, s19, 0
    s_nop 0
    buffer_load_dwordx4 v228, s[8:11], s16 offen lds
    v_pk_add_f32 v[184:185], v[184:185], v[200:201]
    v_mfma_f32_16x16x32_bf16 v[48:51], v[108:111], v[144:147], v[48:51]
    ds_read_b64_tr_b16 v[120:121], v237 offset:0
    v_pk_add_f32 v[186:187], v[186:187], v[202:203]
    v_mfma_f32_16x16x32_bf16 v[52:55], v[108:111], v[148:151], v[52:55]
    ds_read_b64_tr_b16 v[122:123], v237 offset:3584
    v_pk_add_f32 v[188:189], v[188:189], v[204:205]
    v_mfma_f32_16x16x32_bf16 v[56:59], v[108:111], v[152:155], v[56:59]
    ds_read_b64_tr_b16 v[132:133], v237 offset:14400
    v_pk_add_f32 v[190:191], v[190:191], v[206:207]
    v_pk_add_f32 v[176:177], v[176:177], v[184:185]
    v_mfma_f32_16x16x32_bf16 v[60:63], v[108:111], v[156:159], v[60:63]
    s_add_u32 m0, s19, 1024
    s_nop 0
    buffer_load_dwordx4 v229, s[8:11], s16 offen lds
    v_pk_add_f32 v[178:179], v[178:179], v[186:187]
    v_mfma_f32_16x16x32_bf16 v[16:19], v[100:103], v[144:147], v[16:19]
    ds_read_b64_tr_b16 v[134:135], v237 offset:17984
    v_pk_add_f32 v[180:181], v[180:181], v[188:189]
    v_mfma_f32_16x16x32_bf16 v[20:23], v[100:103], v[148:151], v[20:23]
    ds_read_b64_tr_b16 v[124:125], v237 offset:32
    v_pk_add_f32 v[182:183], v[182:183], v[190:191]
    v_mfma_f32_16x16x32_bf16 v[24:27], v[100:103], v[152:155], v[24:27]
    ds_read_b64_tr_b16 v[126:127], v237 offset:3616
    v_pk_add_f32 v[176:177], v[176:177], v[180:181]
    v_mfma_f32_16x16x32_bf16 v[28:31], v[100:103], v[156:159], v[28:31]
    s_add_u32 m0, s19, 2048
    s_nop 0
    buffer_load_dwordx4 v230, s[8:11], s16 offen lds
    s_add_u32 s16, s16, 229376
    s_cmp_eq_u32 s16, s18
    s_cselect_b32 s16, s17, s16
    v_pk_add_f32 v[178:179], v[178:179], v[182:183]
    v_mfma_f32_16x16x32_bf16 v[64:67], v[112:115], v[144:147], v[64:67]
    ds_read_b64_tr_b16 v[136:137], v237 offset:14432
    v_mov_b32 v180, v176
    v_mov_b32 v181, v177
    v_mfma_f32_16x16x32_bf16 v[68:71], v[112:115], v[148:151], v[68:71]
    ds_read_b64_tr_b16 v[138:139], v237 offset:18016
    v_mov_b32 v182, v178
    v_mfma_f32_16x16x32_bf16 v[72:75], v[112:115], v[152:155], v[72:75]
    ds_read_b64_tr_b16 v[128:129], v239 offset:0
    v_mov_b32 v183, v179
    v_mfma_f32_16x16x32_bf16 v[76:79], v[112:115], v[156:159], v[76:79]
    s_add_u32 m0, s23, 24576
    s_nop 0
    buffer_load_dwordx4 v249, s[80:83], s20 offen sc1 lds
    s_nop 1
    v_mfma_f32_16x16x32_bf16 v[32:35], v[104:107], v[144:147], v[32:35]
    ds_read_b64_tr_b16 v[130:131], v239 offset:3584
    v_permlane32_swap_b32 v176, v180
    v_mfma_f32_16x16x32_bf16 v[36:39], v[104:107], v[148:151], v[36:39]
    ds_read_b64_tr_b16 v[140:141], v239 offset:14400
    v_permlane32_swap_b32 v177, v181
    v_mfma_f32_16x16x32_bf16 v[40:43], v[104:107], v[152:155], v[40:43]
    ds_read_b64_tr_b16 v[142:143], v239 offset:17984
    v_permlane32_swap_b32 v178, v182
    v_permlane32_swap_b32 v179, v183
    v_mfma_f32_16x16x32_bf16 v[44:47], v[104:107], v[156:159], v[44:47]
    s_add_u32 m0, s23, 24576
    s_nop 0
    buffer_load_dwordx4 v249, s[80:83], s20 offen offset:1024 sc1 lds
    s_add_u32 s20, s20, 8192
    s_cmp_eq_u32 s20, s22
    s_cselect_b32 s20, s21, s20
    v_add_f32 v176, v176, v180
    v_mfma_f32_16x16x32_bf16 v[80:83], v[116:119], v[144:147], v[80:83]
    v_add_f32 v177, v177, v181
    v_mfma_f32_16x16x32_bf16 v[84:87], v[116:119], v[148:151], v[84:87]
    v_add_f32 v178, v178, v182
    v_mfma_f32_16x16x32_bf16 v[88:91], v[116:119], v[152:155], v[88:91]
    v_add_f32 v179, v179, v183
    v_mfma_f32_16x16x32_bf16 v[92:95], v[116:119], v[156:159], v[92:95]
    s_and_b32 s64, s3, 1
    s_mul_i32 s64, s64, 896
    s_lshr_b32 s65, s69, 1
    s_mul_i32 s65, s65, 448
    s_add_u32 s64, s64, s65
    s_add_u32 s64, s64, 160896
    v_add_u32 v225, s64, v249
    s_cmp_lg_u32 s75, 0
    s_cbranch_scc1 g3c1_ncs
    s_mov_b64 exec, 0x0fffffff
    ds_write_b128 v225, v[176:179]
    s_mov_b64 exec, -1
g3c1_ncs:
    s_waitcnt vmcnt(5) lgkmcnt(0)
    s_barrier
    v_mfma_f32_16x16x32_bf16 v[0:3], v[120:123], v[160:163], v[0:3]
    ds_read_b128 v[144:147], v235 offset:16384
    s_mov_b32 s12, s96
    v_mfma_f32_16x16x32_bf16 v[4:7], v[120:123], v[164:167], v[4:7]
    ds_read_b128 v[148:151], v235 offset:17408
    s_mov_b32 s13, s97
    v_mfma_f32_16x16x32_bf16 v[8:11], v[120:123], v[168:171], v[8:11]
    ds_read_b128 v[152:155], v235 offset:18432
    s_mov_b32 s14, 7340032
    v_mfma_f32_16x16x32_bf16 v[12:15], v[120:123], v[172:175], v[12:15]
    ds_read_b128 v[156:159], v235 offset:19456
    s_mov_b32 s15, 0x00020000
    v_mfma_f32_16x16x32_bf16 v[48:51], v[132:135], v[160:163], v[48:51]
    s_and_b32 s64, s74, 8
    v_mfma_f32_16x16x32_bf16 v[52:55], v[132:135], v[164:167], v[52:55]
    ds_read_b64_tr_b16 v[96:97], v237 offset:28800
    v_xor_b32 v254, s64, v252
    v_mfma_f32_16x16x32_bf16 v[56:59], v[132:135], v[168:171], v[56:59]
    ds_read_b64_tr_b16 v[98:99], v237 offset:32384
    v_lshlrev_b32 v253, 14, v251
    v_lshlrev_b32 v247, 7, v250
    s_add_u32 s29, s3, 0
    s_lshl_b32 s30, s29, 12
    s_add_u32 s30, s30, s25
    s_cmp_lt_u32 s29, s27
    s_cselect_b32 s30, s30, 0x7f000000
    s_mov_b64 exec, 0xffffffff
    buffer_load_dword v248, v247, s[80:83], s30 offen sc1
    s_mov_b64 exec, -1
    v_mfma_f32_16x16x32_bf16 v[60:63], v[132:135], v[172:175], v[60:63]
    ds_read_b64_tr_b16 v[108:109], v237 offset:43200
    v_mfma_f32_16x16x32_bf16 v[16:19], v[124:127], v[160:163], v[16:19]
    ds_read_b64_tr_b16 v[110:111], v237 offset:46784
    v_and_b32 v254, 8, v254
    v_mfma_f32_16x16x32_bf16 v[20:23], v[124:127], v[164:167], v[20:23]
    v_lshl_add_u32 v253, v254, 7, v253
    v_mfma_f32_16x16x32_bf16 v[24:27], v[124:127], v[168:171], v[24:27]
    ds_read_b64_tr_b16 v[100:101], v237 offset:28832
    v_and_b32 v254, 7, v252
    v_mfma_f32_16x16x32_bf16 v[28:31], v[124:127], v[172:175], v[28:31]
    ds_read_b64_tr_b16 v[102:103], v237 offset:32416
    v_lshl_add_u32 v253, v254, 4, v253
    v_mfma_f32_16x16x32_bf16 v[64:67], v[136:139], v[160:163], v[64:67]
    ds_read_b64_tr_b16 v[112:113], v237 offset:43232
    s_lshl_b32 s64, s69, 12
    v_mfma_f32_16x16x32_bf16 v[68:71], v[136:139], v[164:167], v[68:71]
    ds_read_b64_tr_b16 v[114:115], v237 offset:46816
    v_add_u32 v244, s64, v253
    v_mfma_f32_16x16x32_bf16 v[72:75], v[136:139], v[168:171], v[72:75]
    v_add_u32 v245, 2048, v244
    v_mfma_f32_16x16x32_bf16 v[76:79], v[136:139], v[172:175], v[76:79]
    ds_read_b64_tr_b16 v[104:105], v239 offset:28800
    v_mfma_f32_16x16x32_bf16 v[32:35], v[128:131], v[160:163], v[32:35]
    ds_read_b64_tr_b16 v[106:107], v239 offset:32384
    s_mul_i32 s51, s69, 2112
    v_mfma_f32_16x16x32_bf16 v[36:39], v[128:131], v[164:167], v[36:39]
    ds_read_b64_tr_b16 v[116:117], v239 offset:43200
    s_lshr_b32 s64, s74, 3
    v_mfma_f32_16x16x32_bf16 v[40:43], v[128:131], v[168:171], v[40:43]
    ds_read_b64_tr_b16 v[118:119], v239 offset:46784
    s_mul_i32 s49, s64, 3670016
    v_mfma_f32_16x16x32_bf16 v[44:47], v[128:131], v[172:175], v[44:47]
    s_lshl_b32 s65, s61, 7
    v_mfma_f32_16x16x32_bf16 v[80:83], v[140:143], v[160:163], v[80:83]
    s_add_u32 s49, s49, s65
    v_lshlrev_b32 v247, 7, v250
    s_add_u32 s29, s3, 8
    s_lshl_b32 s30, s29, 12
    s_add_u32 s30, s30, s25
    s_cmp_lt_u32 s29, s27
    s_cselect_b32 s30, s30, 0x7f000000
    s_mov_b64 exec, 0xffffffff
    buffer_load_dword v248, v247, s[80:83], s30 offen sc1
    s_mov_b64 exec, -1
    v_mfma_f32_16x16x32_bf16 v[84:87], v[140:143], v[164:167], v[84:87]
    s_sub_u32 s50, s74, s58
    v_mfma_f32_16x16x32_bf16 v[88:91], v[140:143], v[168:171], v[88:91]
    s_and_b32 s50, s50, 7
    v_mfma_f32_16x16x32_bf16 v[92:95], v[140:143], v[172:175], v[92:95]
    s_waitcnt vmcnt(2) lgkmcnt(0)
    s_barrier
    s_setprio 1
    ds_read_b128 v[160:163], v235 offset:24576
    ds_read_b128 v[164:167], v235 offset:25600
    ds_read_b128 v[168:171], v235 offset:26624
    ds_read_b128 v[172:175], v235 offset:27648
    ds_read_b64_tr_b16 v[120:121], v236 offset:0
    ds_read_b64_tr_b16 v[122:123], v236 offset:3584
    ds_read_b64_tr_b16 v[132:133], v236 offset:14400
    ds_read_b64_tr_b16 v[134:135], v236 offset:17984
    ds_read_b64_tr_b16 v[124:125], v236 offset:32
    ds_read_b64_tr_b16 v[126:127], v236 offset:3616
    ds_read_b64_tr_b16 v[136:137], v236 offset:14432
    ds_read_b64_tr_b16 v[138:139], v236 offset:18016
    ds_read_b64_tr_b16 v[128:129], v238 offset:0
    ds_read_b64_tr_b16 v[130:131], v238 offset:3584
    ds_read_b64_tr_b16 v[140:141], v238 offset:14400
    ds_read_b64_tr_b16 v[142:143], v238 offset:17984
    s_waitcnt lgkmcnt(0)
    s_and_b32 s48, s74, 7
    s_mul_i32 s48, s48, 458752
    s_add_u32 s48, s48, s49
    s_add_u32 m0, s51, 107776
    s_nop 0
    buffer_load_dwordx4 v244, s[12:15], s48 offen lds
    s_add_u32 m0, s51, 108832
    s_nop 0
    buffer_load_dwordx4 v245, s[12:15], s48 offen lds
    s_add_u32 s48, s48, 65536
    s_barrier
    s_add_u32 m0, s51, 116224
    s_nop 0
    buffer_load_dwordx4 v244, s[12:15], s48 offen lds
    s_add_u32 m0, s51, 117280
    s_nop 0
    buffer_load_dwordx4 v245, s[12:15], s48 offen lds
    s_add_u32 s48, s48, 65536
    s_add_u32 m0, s51, 124672
    s_nop 0
    buffer_load_dwordx4 v244, s[12:15], s48 offen lds
    s_add_u32 m0, s51, 125728
    s_nop 0
    buffer_load_dwordx4 v245, s[12:15], s48 offen lds
    s_add_u32 s48, s48, 65536
    s_add_u32 m0, s51, 133120
    s_nop 0
    buffer_load_dwordx4 v244, s[12:15], s48 offen lds
    s_add_u32 m0, s51, 134176
    s_nop 0
    buffer_load_dwordx4 v245, s[12:15], s48 offen lds
    s_add_u32 s48, s48, 65536
    v_mfma_f32_16x16x32_bf16 v[0:3], v[96:99], v[144:147], v[0:3]
    s_add_u32 m0, s51, 141568
    s_nop 0
    buffer_load_dwordx4 v244, s[12:15], s48 offen lds
    v_mfma_f32_16x16x32_bf16 v[4:7], v[96:99], v[148:151], v[4:7]
    v_mfma_f32_16x16x32_bf16 v[8:11], v[96:99], v[152:155], v[8:11]
    v_mfma_f32_16x16x32_bf16 v[12:15], v[96:99], v[156:159], v[12:15]
    v_mfma_f32_16x16x32_bf16 v[48:51], v[108:111], v[144:147], v[48:51]
    s_add_u32 m0, s51, 142624
    s_nop 0
    buffer_load_dwordx4 v245, s[12:15], s48 offen lds
    s_add_u32 s48, s48, 65536
    v_mfma_f32_16x16x32_bf16 v[52:55], v[108:111], v[148:151], v[52:55]
    v_mfma_f32_16x16x32_bf16 v[56:59], v[108:111], v[152:155], v[56:59]
    v_mfma_f32_16x16x32_bf16 v[60:63], v[108:111], v[156:159], v[60:63]
    v_mfma_f32_16x16x32_bf16 v[16:19], v[100:103], v[144:147], v[16:19]
    s_add_u32 m0, s51, 65536
    s_nop 0
    buffer_load_dwordx4 v244, s[12:15], s48 offen lds
    v_mfma_f32_16x16x32_bf16 v[20:23], v[100:103], v[148:151], v[20:23]
    v_mfma_f32_16x16x32_bf16 v[24:27], v[100:103], v[152:155], v[24:27]
    v_mfma_f32_16x16x32_bf16 v[28:31], v[100:103], v[156:159], v[28:31]
    v_mfma_f32_16x16x32_bf16 v[64:67], v[112:115], v[144:147], v[64:67]
    s_add_u32 m0, s51, 66592
    s_nop 0
    buffer_load_dwordx4 v245, s[12:15], s48 offen lds
    s_add_u32 s48, s48, 65536
    v_mfma_f32_16x16x32_bf16 v[68:71], v[112:115], v[148:151], v[68:71]
    v_mfma_f32_16x16x32_bf16 v[72:75], v[112:115], v[152:155], v[72:75]
    v_mfma_f32_16x16x32_bf16 v[76:79], v[112:115], v[156:159], v[76:79]
    v_mfma_f32_16x16x32_bf16 v[32:35], v[104:107], v[144:147], v[32:35]
    s_add_u32 m0, s51, 73984
    s_nop 0
    buffer_load_dwordx4 v244, s[12:15], s48 offen lds
    v_mfma_f32_16x16x32_bf16 v[36:39], v[104:107], v[148:151], v[36:39]
    v_mfma_f32_16x16x32_bf16 v[40:43], v[104:107], v[152:155], v[40:43]
    v_mfma_f32_16x16x32_bf16 v[44:47], v[104:107], v[156:159], v[44:47]
    v_mfma_f32_16x16x32_bf16 v[80:83], v[116:119], v[144:147], v[80:83]
    s_add_u32 m0, s51, 75040
    s_nop 0
    buffer_load_dwordx4 v245, s[12:15], s48 offen lds
    s_add_u32 s48, s48, 65536
    v_mfma_f32_16x16x32_bf16 v[84:87], v[116:119], v[148:151], v[84:87]
    v_mfma_f32_16x16x32_bf16 v[88:91], v[116:119], v[152:155], v[88:91]
    v_mfma_f32_16x16x32_bf16 v[92:95], v[116:119], v[156:159], v[92:95]
    s_and_b32 s64, s3, 1
    s_lshl_b32 s64, s64, 9
    s_add_u32 s64, s64, 159744
    v_lshlrev_b32 v253, 3, v252
    v_add_u32 v253, s64, v253
    s_lshl_b32 s64, s28, 6
    s_add_u32 s64, s64, 160896
    v_lshlrev_b32 v254, 4, v251
    v_add_u32 v235, s64, v254
    s_lshr_b32 s64, s69, 1
    s_add_u32 s64, s64, 10
    s_lshl_b32 s64, s64, 6
    s_add_u32 s64, s64, 160896
    v_add_u32 v238, s64, v254
    v_mfma_f32_16x16x32_bf16 v[0:3], v[120:123], v[160:163], v[0:3]
    ds_read_b64 v[144:145], v253 offset:0
    s_cmp_le_u32 s50, 0
    s_addc_u32 s48, s58, 0
    s_and_b32 s48, s48, 7
    s_mul_i32 s48, s48, 458752
    s_add_u32 s48, s48, s49
    s_add_u32 m0, s51, 82432
    s_nop 0
    buffer_load_dwordx4 v244, s[12:15], s48 offen lds
    v_mfma_f32_16x16x32_bf16 v[4:7], v[120:123], v[164:167], v[4:7]
    ds_read_b64 v[146:147], v253 offset:128
    v_mfma_f32_16x16x32_bf16 v[8:11], v[120:123], v[168:171], v[8:11]
    ds_read_b64 v[148:149], v253 offset:256
    v_mfma_f32_16x16x32_bf16 v[12:15], v[120:123], v[172:175], v[12:15]
    ds_read_b64 v[150:151], v253 offset:384
    s_add_u32 m0, s51, 83488
    s_nop 0
    buffer_load_dwordx4 v245, s[12:15], s48 offen lds
    s_add_u32 s48, s48, 65536
    v_mfma_f32_16x16x32_bf16 v[48:51], v[132:135], v[160:163], v[48:51]
    v_mfma_f32_16x16x32_bf16 v[52:55], v[132:135], v[164:167], v[52:55]
    ds_read_b128 v[96:99], v235 offset:0
    v_mfma_f32_16x16x32_bf16 v[56:59], v[132:135], v[168:171], v[56:59]
    ds_read_b128 v[100:103], v235 offset:64
    v_mfma_f32_16x16x32_bf16 v[60:63], v[132:135], v[172:175], v[60:63]
    ds_read_b128 v[104:107], v238 offset:0
    s_add_u32 m0, s51, 90880
    s_nop 0
    buffer_load_dwordx4 v244, s[12:15], s48 offen lds
    v_mfma_f32_16x16x32_bf16 v[16:19], v[124:127], v[160:163], v[16:19]
    v_mfma_f32_16x16x32_bf16 v[20:23], v[124:127], v[164:167], v[20:23]
    ds_read_b128 v[108:111], v235 offset:896
    v_mfma_f32_16x16x32_bf16 v[24:27], v[124:127], v[168:171], v[24:27]
    ds_read_b128 v[112:115], v235 offset:960
    v_mfma_f32_16x16x32_bf16 v[28:31], v[124:127], v[172:175], v[28:31]
    ds_read_b128 v[116:119], v238 offset:896
    s_add_u32 m0, s51, 91936
    s_nop 0
    buffer_load_dwordx4 v245, s[12:15], s48 offen lds
    s_add_u32 s48, s48, 65536
    v_mfma_f32_16x16x32_bf16 v[64:67], v[136:139], v[160:163], v[64:67]
    v_mfma_f32_16x16x32_bf16 v[68:71], v[136:139], v[164:167], v[68:71]
    v_mfma_f32_16x16x32_bf16 v[72:75], v[136:139], v[168:171], v[72:75]
    v_mfma_f32_16x16x32_bf16 v[76:79], v[136:139], v[172:175], v[76:79]
    s_add_u32 m0, s51, 99328
    s_nop 0
    buffer_load_dwordx4 v244, s[12:15], s48 offen lds
    v_mfma_f32_16x16x32_bf16 v[32:35], v[128:131], v[160:163], v[32:35]
    v_mfma_f32_16x16x32_bf16 v[36:39], v[128:131], v[164:167], v[36:39]
    v_mfma_f32_16x16x32_bf16 v[40:43], v[128:131], v[168:171], v[40:43]
    v_mfma_f32_16x16x32_bf16 v[44:47], v[128:131], v[172:175], v[44:47]
    s_add_u32 m0, s51, 100384
    s_nop 0
    buffer_load_dwordx4 v245, s[12:15], s48 offen lds
    s_add_u32 s48, s48, 65536
    v_mfma_f32_16x16x32_bf16 v[80:83], v[140:143], v[160:163], v[80:83]
    v_mfma_f32_16x16x32_bf16 v[84:87], v[140:143], v[164:167], v[84:87]
    v_mfma_f32_16x16x32_bf16 v[88:91], v[140:143], v[168:171], v[88:91]
    v_mfma_f32_16x16x32_bf16 v[92:95], v[140:143], v[172:175], v[92:95]
    s_and_b32 s64, s3, 1
    s_lshl_b32 s64, s64, 12
    s_add_u32 s25, s25, s64
    s_lshr_b32 s64, s69, 1
    s_lshl_b32 s65, s64, 3
    s_add_u32 s26, s25, s65
    s_add_u32 s26, s26, 40960
    s_lshl_b32 s64, s64, 14
    s_add_u32 s25, s25, s64
    s_add_u32 s25, s25, 32768
    s_and_b32 s64, s3, 1
    s_lshl_b32 s64, s64, 12
    s_lshr_b32 s65, s69, 1
    s_lshl_b32 s66, s65, 3
    s_add_u32 s66, s66, s64
    s_add_u32 s66, s66, 32768
    v_add_u32 v237, s66, v249
    s_lshl_b32 s65, s65, 14
    s_add_u32 s64, s64, s65
    s_add_u32 s64, s64, 24576
    v_add_u32 v236, s64, v249
    s_waitcnt lgkmcnt(0)
    s_mov_b32 s64, 0xbfb8aa3b
    v_mul_f32 v136, v145, v145
    v_sub_f32 v120, 0, v144
    v_mul_f32 v128, s64, v145
    v_sub_f32 v121, 0, v144
    v_mul_f32 v129, s64, v145
    v_mul_f32 v138, v147, v147
    v_sub_f32 v122, 0, v146
    v_mul_f32 v130, s64, v147
    v_sub_f32 v123, 0, v146
    v_mul_f32 v131, s64, v147
    v_mul_f32 v140, v149, v149
    v_sub_f32 v124, 0, v148
    v_mul_f32 v132, s64, v149
    v_sub_f32 v125, 0, v148
    v_mul_f32 v133, s64, v149
    v_mul_f32 v142, v151, v151
    v_sub_f32 v126, 0, v150
    v_mul_f32 v134, s64, v151
    v_sub_f32 v127, 0, v150
    v_mul_f32 v135, s64, v151
    v_rcp_f32 v137, v136
    v_rcp_f32 v136, v136
    v_rcp_f32 v139, v138
    v_rcp_f32 v138, v138
    v_rcp_f32 v141, v140
    v_rcp_f32 v140, v140
    v_rcp_f32 v143, v142
    v_rcp_f32 v142, v142
    v_pk_fma_f32 v[0:1], v[120:121], v[96:97], v[0:1]
    v_pk_fma_f32 v[2:3], v[120:121], v[98:99], v[2:3]
    v_pk_mul_f32 v[164:165], v[128:129], v[0:1]
    v_pk_mul_f32 v[166:167], v[128:129], v[2:3]
    v_exp_f32 v164, v164
    v_exp_f32 v165, v165
    v_exp_f32 v166, v166
    v_exp_f32 v167, v167
    v_pk_fma_f32 v[48:49], v[120:121], v[108:109], v[48:49]
    v_pk_fma_f32 v[50:51], v[120:121], v[110:111], v[50:51]
    v_pk_fma_f32 v[164:165], v[164:165], v[136:137], v[136:137]
    v_pk_fma_f32 v[166:167], v[166:167], v[136:137], v[136:137]
    v_rcp_f32 v164, v164
    v_rcp_f32 v165, v165
    v_rcp_f32 v166, v166
    v_rcp_f32 v167, v167
    v_pk_mul_f32 v[0:1], v[0:1], v[48:49]
    v_pk_mul_f32 v[2:3], v[2:3], v[50:51]
    v_pk_mul_f32 v[0:1], v[0:1], v[164:165]
    v_pk_mul_f32 v[2:3], v[2:3], v[166:167]
    v_cvt_pk_bf16_f32 v168, v0, v1
    v_cvt_pk_bf16_f32 v169, v2, v3
    v_pk_fma_f32 v[16:17], v[120:121], v[100:101], v[16:17]
    v_pk_fma_f32 v[18:19], v[120:121], v[102:103], v[18:19]
    v_pk_mul_f32 v[164:165], v[128:129], v[16:17]
    v_pk_mul_f32 v[166:167], v[128:129], v[18:19]
    v_exp_f32 v164, v164
    v_exp_f32 v165, v165
    v_exp_f32 v166, v166
    v_exp_f32 v167, v167
    v_pk_fma_f32 v[64:65], v[120:121], v[112:113], v[64:65]
    v_pk_fma_f32 v[66:67], v[120:121], v[114:115], v[66:67]
    v_pk_fma_f32 v[164:165], v[164:165], v[136:137], v[136:137]
    v_pk_fma_f32 v[166:167], v[166:167], v[136:137], v[136:137]
    v_rcp_f32 v164, v164
    v_rcp_f32 v165, v165
    v_rcp_f32 v166, v166
    v_rcp_f32 v167, v167
    v_pk_mul_f32 v[16:17], v[16:17], v[64:65]
    v_pk_mul_f32 v[18:19], v[18:19], v[66:67]
    v_pk_mul_f32 v[16:17], v[16:17], v[164:165]
    v_pk_mul_f32 v[18:19], v[18:19], v[166:167]
    v_cvt_pk_bf16_f32 v170, v16, v17
    v_cvt_pk_bf16_f32 v171, v18, v19
    buffer_store_dwordx4 v[168:171], v249, s[80:83], s25 offen offset:0
    ds_write_b128 v236, v[168:171] offset:0
    v_pk_fma_f32 v[32:33], v[120:121], v[104:105], v[32:33]
    v_pk_fma_f32 v[34:35], v[120:121], v[106:107], v[34:35]
    v_pk_mul_f32 v[164:165], v[128:129], v[32:33]
    v_pk_mul_f32 v[166:167], v[128:129], v[34:35]
    v_exp_f32 v164, v164
    v_exp_f32 v165, v165
    v_exp_f32 v166, v166
    v_exp_f32 v167, v167
    v_pk_fma_f32 v[80:81], v[120:121], v[116:117], v[80:81]
    v_pk_fma_f32 v[82:83], v[120:121], v[118:119], v[82:83]
    v_pk_fma_f32 v[164:165], v[164:165], v[136:137], v[136:137]
    v_pk_fma_f32 v[166:167], v[166:167], v[136:137], v[136:137]
    v_rcp_f32 v164, v164
    v_rcp_f32 v165, v165
    v_rcp_f32 v166, v166
    v_rcp_f32 v167, v167
    v_pk_mul_f32 v[32:33], v[32:33], v[80:81]
    v_pk_mul_f32 v[34:35], v[34:35], v[82:83]
    v_pk_mul_f32 v[32:33], v[32:33], v[164:165]
    v_pk_mul_f32 v[34:35], v[34:35], v[166:167]
    v_cvt_pk_bf16_f32 v172, v32, v33
    v_cvt_pk_bf16_f32 v173, v34, v35
    buffer_store_dwordx2 v[172:173], v249, s[80:83], s26 offen offset:0
    ds_write_b64 v237, v[172:173] offset:0
    v_pk_fma_f32 v[4:5], v[122:123], v[96:97], v[4:5]
    v_pk_fma_f32 v[6:7], v[122:123], v[98:99], v[6:7]
    v_pk_mul_f32 v[164:165], v[130:131], v[4:5]
    v_pk_mul_f32 v[166:167], v[130:131], v[6:7]
    v_exp_f32 v164, v164
    v_exp_f32 v165, v165
    v_exp_f32 v166, v166
    v_exp_f32 v167, v167
    v_pk_fma_f32 v[52:53], v[122:123], v[108:109], v[52:53]
    v_pk_fma_f32 v[54:55], v[122:123], v[110:111], v[54:55]
    v_pk_fma_f32 v[164:165], v[164:165], v[138:139], v[138:139]
    v_pk_fma_f32 v[166:167], v[166:167], v[138:139], v[138:139]
    v_rcp_f32 v164, v164
    v_rcp_f32 v165, v165
    v_rcp_f32 v166, v166
    v_rcp_f32 v167, v167
    v_pk_mul_f32 v[4:5], v[4:5], v[52:53]
    v_pk_mul_f32 v[6:7], v[6:7], v[54:55]
    v_pk_mul_f32 v[4:5], v[4:5], v[164:165]
    v_pk_mul_f32 v[6:7], v[6:7], v[166:167]
    v_cvt_pk_bf16_f32 v168, v4, v5
    v_cvt_pk_bf16_f32 v169, v6, v7
    v_pk_fma_f32 v[20:21], v[122:123], v[100:101], v[20:21]
    v_pk_fma_f32 v[22:23], v[122:123], v[102:103], v[22:23]
    v_pk_mul_f32 v[164:165], v[130:131], v[20:21]
    v_pk_mul_f32 v[166:167], v[130:131], v[22:23]
    v_exp_f32 v164, v164
    v_exp_f32 v165, v165
    v_exp_f32 v166, v166
    v_exp_f32 v167, v167
    v_pk_fma_f32 v[68:69], v[122:123], v[112:113], v[68:69]
    v_pk_fma_f32 v[70:71], v[122:123], v[114:115], v[70:71]
    v_pk_fma_f32 v[164:165], v[164:165], v[138:139], v[138:139]
    v_pk_fma_f32 v[166:167], v[166:167], v[138:139], v[138:139]
    v_rcp_f32 v164, v164
    v_rcp_f32 v165, v165
    v_rcp_f32 v166, v166
    v_rcp_f32 v167, v167
    v_pk_mul_f32 v[20:21], v[20:21], v[68:69]
    v_pk_mul_f32 v[22:23], v[22:23], v[70:71]
    v_pk_mul_f32 v[20:21], v[20:21], v[164:165]
    v_pk_mul_f32 v[22:23], v[22:23], v[166:167]
    v_cvt_pk_bf16_f32 v170, v20, v21
    v_cvt_pk_bf16_f32 v171, v22, v23
    buffer_store_dwordx4 v[168:171], v249, s[80:83], s25 offen offset:1024
    ds_write_b128 v236, v[168:171] offset:1024
    v_pk_fma_f32 v[36:37], v[122:123], v[104:105], v[36:37]
    v_pk_fma_f32 v[38:39], v[122:123], v[106:107], v[38:39]
    v_pk_mul_f32 v[164:165], v[130:131], v[36:37]
    v_pk_mul_f32 v[166:167], v[130:131], v[38:39]
    v_exp_f32 v164, v164
    v_exp_f32 v165, v165
    v_exp_f32 v166, v166
    v_exp_f32 v167, v167
    v_pk_fma_f32 v[84:85], v[122:123], v[116:117], v[84:85]
    v_pk_fma_f32 v[86:87], v[122:123], v[118:119], v[86:87]
    v_pk_fma_f32 v[164:165], v[164:165], v[138:139], v[138:139]
    v_pk_fma_f32 v[166:167], v[166:167], v[138:139], v[138:139]
    v_rcp_f32 v164, v164
    v_rcp_f32 v165, v165
    v_rcp_f32 v166, v166
    v_rcp_f32 v167, v167
    v_pk_mul_f32 v[36:37], v[36:37], v[84:85]
    v_pk_mul_f32 v[38:39], v[38:39], v[86:87]
    v_pk_mul_f32 v[36:37], v[36:37], v[164:165]
    v_pk_mul_f32 v[38:39], v[38:39], v[166:167]
    v_cvt_pk_bf16_f32 v172, v36, v37
    v_cvt_pk_bf16_f32 v173, v38, v39
    buffer_store_dwordx2 v[172:173], v249, s[80:83], s26 offen offset:1024
    ds_write_b64 v237, v[172:173] offset:1024
    v_pk_fma_f32 v[8:9], v[124:125], v[96:97], v[8:9]
    v_pk_fma_f32 v[10:11], v[124:125], v[98:99], v[10:11]
    v_pk_mul_f32 v[164:165], v[132:133], v[8:9]
    v_pk_mul_f32 v[166:167], v[132:133], v[10:11]
    v_exp_f32 v164, v164
    v_exp_f32 v165, v165
    v_exp_f32 v166, v166
    v_exp_f32 v167, v167
    v_pk_fma_f32 v[56:57], v[124:125], v[108:109], v[56:57]
    v_pk_fma_f32 v[58:59], v[124:125], v[110:111], v[58:59]
    v_pk_fma_f32 v[164:165], v[164:165], v[140:141], v[140:141]
    v_pk_fma_f32 v[166:167], v[166:167], v[140:141], v[140:141]
    v_rcp_f32 v164, v164
    v_rcp_f32 v165, v165
    v_rcp_f32 v166, v166
    v_rcp_f32 v167, v167
    v_pk_mul_f32 v[8:9], v[8:9], v[56:57]
    v_pk_mul_f32 v[10:11], v[10:11], v[58:59]
    v_pk_mul_f32 v[8:9], v[8:9], v[164:165]
    v_pk_mul_f32 v[10:11], v[10:11], v[166:167]
    v_cvt_pk_bf16_f32 v168, v8, v9
    v_cvt_pk_bf16_f32 v169, v10, v11
    v_pk_fma_f32 v[24:25], v[124:125], v[100:101], v[24:25]
    v_pk_fma_f32 v[26:27], v[124:125], v[102:103], v[26:27]
    v_pk_mul_f32 v[164:165], v[132:133], v[24:25]
    v_pk_mul_f32 v[166:167], v[132:133], v[26:27]
    v_exp_f32 v164, v164
    v_exp_f32 v165, v165
    v_exp_f32 v166, v166
    v_exp_f32 v167, v167
    v_pk_fma_f32 v[72:73], v[124:125], v[112:113], v[72:73]
    v_pk_fma_f32 v[74:75], v[124:125], v[114:115], v[74:75]
    v_pk_fma_f32 v[164:165], v[164:165], v[140:141], v[140:141]
    v_pk_fma_f32 v[166:167], v[166:167], v[140:141], v[140:141]
    v_rcp_f32 v164, v164
    v_rcp_f32 v165, v165
    v_rcp_f32 v166, v166
    v_rcp_f32 v167, v167
    v_pk_mul_f32 v[24:25], v[24:25], v[72:73]
    v_pk_mul_f32 v[26:27], v[26:27], v[74:75]
    v_pk_mul_f32 v[24:25], v[24:25], v[164:165]
    v_pk_mul_f32 v[26:27], v[26:27], v[166:167]
    v_cvt_pk_bf16_f32 v170, v24, v25
    v_cvt_pk_bf16_f32 v171, v26, v27
    buffer_store_dwordx4 v[168:171], v249, s[80:83], s25 offen offset:2048
    ds_write_b128 v236, v[168:171] offset:2048
    v_pk_fma_f32 v[40:41], v[124:125], v[104:105], v[40:41]
    v_pk_fma_f32 v[42:43], v[124:125], v[106:107], v[42:43]
    v_pk_mul_f32 v[164:165], v[132:133], v[40:41]
    v_pk_mul_f32 v[166:167], v[132:133], v[42:43]
    v_exp_f32 v164, v164
    v_exp_f32 v165, v165
    v_exp_f32 v166, v166
    v_exp_f32 v167, v167
    v_pk_fma_f32 v[88:89], v[124:125], v[116:117], v[88:89]
    v_pk_fma_f32 v[90:91], v[124:125], v[118:119], v[90:91]
    v_pk_fma_f32 v[164:165], v[164:165], v[140:141], v[140:141]
    v_pk_fma_f32 v[166:167], v[166:167], v[140:141], v[140:141]
    v_rcp_f32 v164, v164
    v_rcp_f32 v165, v165
    v_rcp_f32 v166, v166
    v_rcp_f32 v167, v167
    v_pk_mul_f32 v[40:41], v[40:41], v[88:89]
    v_pk_mul_f32 v[42:43], v[42:43], v[90:91]
    v_pk_mul_f32 v[40:41], v[40:41], v[164:165]
    v_pk_mul_f32 v[42:43], v[42:43], v[166:167]
    v_cvt_pk_bf16_f32 v172, v40, v41
    v_cvt_pk_bf16_f32 v173, v42, v43
    buffer_store_dwordx2 v[172:173], v249, s[80:83], s26 offen offset:2048
    ds_write_b64 v237, v[172:173] offset:2048
    v_pk_fma_f32 v[12:13], v[126:127], v[96:97], v[12:13]
    v_pk_fma_f32 v[14:15], v[126:127], v[98:99], v[14:15]
    v_pk_mul_f32 v[164:165], v[134:135], v[12:13]
    v_pk_mul_f32 v[166:167], v[134:135], v[14:15]
    v_exp_f32 v164, v164
    v_exp_f32 v165, v165
    v_exp_f32 v166, v166
    v_exp_f32 v167, v167
    v_pk_fma_f32 v[60:61], v[126:127], v[108:109], v[60:61]
    v_pk_fma_f32 v[62:63], v[126:127], v[110:111], v[62:63]
    v_pk_fma_f32 v[164:165], v[164:165], v[142:143], v[142:143]
    v_pk_fma_f32 v[166:167], v[166:167], v[142:143], v[142:143]
    v_rcp_f32 v164, v164
    v_rcp_f32 v165, v165
    v_rcp_f32 v166, v166
    v_rcp_f32 v167, v167
    v_pk_mul_f32 v[12:13], v[12:13], v[60:61]
    v_pk_mul_f32 v[14:15], v[14:15], v[62:63]
    v_pk_mul_f32 v[12:13], v[12:13], v[164:165]
    v_pk_mul_f32 v[14:15], v[14:15], v[166:167]
    v_cvt_pk_bf16_f32 v168, v12, v13
    v_cvt_pk_bf16_f32 v169, v14, v15
    v_pk_fma_f32 v[28:29], v[126:127], v[100:101], v[28:29]
    v_pk_fma_f32 v[30:31], v[126:127], v[102:103], v[30:31]
    v_pk_mul_f32 v[164:165], v[134:135], v[28:29]
    v_pk_mul_f32 v[166:167], v[134:135], v[30:31]
    v_exp_f32 v164, v164
    v_exp_f32 v165, v165
    v_exp_f32 v166, v166
    v_exp_f32 v167, v167
    v_pk_fma_f32 v[76:77], v[126:127], v[112:113], v[76:77]
    v_pk_fma_f32 v[78:79], v[126:127], v[114:115], v[78:79]
    v_pk_fma_f32 v[164:165], v[164:165], v[142:143], v[142:143]
    v_pk_fma_f32 v[166:167], v[166:167], v[142:143], v[142:143]
    v_rcp_f32 v164, v164
    v_rcp_f32 v165, v165
    v_rcp_f32 v166, v166
    v_rcp_f32 v167, v167
    v_pk_mul_f32 v[28:29], v[28:29], v[76:77]
    v_pk_mul_f32 v[30:31], v[30:31], v[78:79]
    v_pk_mul_f32 v[28:29], v[28:29], v[164:165]
    v_pk_mul_f32 v[30:31], v[30:31], v[166:167]
    v_cvt_pk_bf16_f32 v170, v28, v29
    v_cvt_pk_bf16_f32 v171, v30, v31
    buffer_store_dwordx4 v[168:171], v249, s[80:83], s25 offen offset:3072
    ds_write_b128 v236, v[168:171] offset:3072
    v_pk_fma_f32 v[44:45], v[126:127], v[104:105], v[44:45]
    v_pk_fma_f32 v[46:47], v[126:127], v[106:107], v[46:47]
    v_pk_mul_f32 v[164:165], v[134:135], v[44:45]
    v_pk_mul_f32 v[166:167], v[134:135], v[46:47]
    v_exp_f32 v164, v164
    v_exp_f32 v165, v165
    v_exp_f32 v166, v166
    v_exp_f32 v167, v167
    v_pk_fma_f32 v[92:93], v[126:127], v[116:117], v[92:93]
    v_pk_fma_f32 v[94:95], v[126:127], v[118:119], v[94:95]
    v_pk_fma_f32 v[164:165], v[164:165], v[142:143], v[142:143]
    v_pk_fma_f32 v[166:167], v[166:167], v[142:143], v[142:143]
    v_rcp_f32 v164, v164
    v_rcp_f32 v165, v165
    v_rcp_f32 v166, v166
    v_rcp_f32 v167, v167
    v_pk_mul_f32 v[44:45], v[44:45], v[92:93]
    v_pk_mul_f32 v[46:47], v[46:47], v[94:95]
    v_pk_mul_f32 v[44:45], v[44:45], v[164:165]
    v_pk_mul_f32 v[46:47], v[46:47], v[166:167]
    v_cvt_pk_bf16_f32 v172, v44, v45
    v_cvt_pk_bf16_f32 v173, v46, v47
    buffer_store_dwordx2 v[172:173], v249, s[80:83], s26 offen offset:3072
    ds_write_b64 v237, v[172:173] offset:3072
    s_lshl_b32 s64, s75, 15
    s_lshl_b32 s66, s73, 9
    s_add_u32 s64, s64, s66
    s_add_u32 s64, s64, 75513856
    s_lshl_b32 s65, s72, 5
    s_add_u32 s64, s64, s65
    s_lshl_b32 s65, s3, 2
    s_add_u32 s64, s64, s65
    v_mov_b32 v144, 0
    v_mov_b32 v145, 1
    s_cmp_lg_u32 s78, 0
    s_cbranch_scc1 sg_3045_slow
    s_waitcnt vmcnt(0)
    s_mov_b64 exec, 1
    buffer_store_dword v145, v144, s[80:83], s64 offen
    s_mov_b64 exec, -1
sg_3045_done:
    s_setprio 3
    s_mov_b32 s8, s86
    s_mov_b32 s9, s87
    s_mov_b32 s10, 6291456
    s_mov_b32 s11, 0x00020000
    v_lshrrev_b32 v253, 3, v250
    v_lshlrev_b32 v253, 2, v253
    v_add_u32 v253, s69, v253
    v_mul_u32_u24 v253, 6144, v253
    v_and_b32 v254, 7, v250
    v_lshl_add_u32 v10, v254, 4, v253
    v_add_u32 v11, 2048, v10
    v_add_u32 v12, 4096, v10
    s_mul_i32 s19, s69, 3104
    s_lshl_b32 s17, s67, 7
    s_add_u32 s18, s17, 6291456
    s_lshl_b32 s64, s70, 1
    s_mul_i32 s64, s64, 393216
    s_add_u32 s16, s17, s64
    s_lshl_b32 s53, s60, 24
    s_mul_i32 s64, s73, 917504
    s_add_u32 s53, s53, s64
    s_lshr_b32 s64, s74, 3
    s_mul_i32 s64, s64, 458752
    s_add_u32 s53, s53, s64
    s_add_u32 s53, s53, 20971520
    s_lshl_b32 s55, s69, 11
    s_add_u32 s53, s53, s55
    s_lshl_b32 s56, s75, 15
    s_lshl_b32 s66, s73, 9
    s_add_u32 s56, s56, s66
    s_add_u32 s56, s56, 75513856
    v_lshlrev_b32 v246, 4, v250
    v_lshrrev_b32 v253, 1, v250
    s_lshl_b32 s65, s70, 1
    v_subrev_u32 v253, s65, v253
    v_xor_b32 v253, s74, v253
    v_and_b32 v253, 8, v253
    v_cmp_eq_u32 vcc, 0, v253
    s_mov_b32 s62, vcc_lo
    s_mov_b32 s63, 0
    s_lshr_b32 s40, s2, 3
    s_lshl_b32 s40, s40, 2
    s_add_u32 s40, s40, s69
    s_and_b32 s41, s40, 31
    s_lshl_b32 s41, s41, 11
    s_lshr_b32 s46, s40, 5
    s_and_b32 s46, s46, 1
    s_lshr_b32 s40, s40, 6
    s_mul_i32 s40, s40, 3670016
    s_add_u32 s40, s40, s41
    s_add_u32 s40, s96, s40
    s_addc_u32 s41, s97, 0
    s_mul_i32 s47, s58, 7
    s_add_u32 s46, s46, s47
    s_waitcnt lgkmcnt(0)
    s_barrier
    s_add_u32 s42, s46, 10
    s_cmp_ge_u32 s42, 56
    s_cselect_b32 s47, 56, 0
    s_sub_u32 s42, s42, s47
    s_lshl_b32 s42, s42, 16
    s_add_u32 s44, s40, s42
    s_addc_u32 s45, s41, 0
    s_load_dword s43, s[44:45], 384
    s_load_dword s43, s[44:45], 448
    s_load_dword s43, s[44:45], 1408
    s_load_dword s43, s[44:45], 1472
    s_barrier
    s_add_u32 s42, s46, 12
    s_cmp_ge_u32 s42, 56
    s_cselect_b32 s47, 56, 0
    s_sub_u32 s42, s42, s47
    s_lshl_b32 s42, s42, 16
    s_add_u32 s44, s40, s42
    s_addc_u32 s45, s41, 0
    s_load_dword s43, s[44:45], 384
    s_load_dword s43, s[44:45], 448
    s_load_dword s43, s[44:45], 1408
    s_load_dword s43, s[44:45], 1472
    s_add_u32 s42, s46, 14
    s_cmp_ge_u32 s42, 56
    s_cselect_b32 s47, 56, 0
    s_sub_u32 s42, s42, s47
    s_lshl_b32 s42, s42, 16
    s_add_u32 s44, s40, s42
    s_addc_u32 s45, s41, 0
    s_load_dword s43, s[44:45], 384
    s_load_dword s43, s[44:45], 448
    s_load_dword s43, s[44:45], 1408
    s_load_dword s43, s[44:45], 1472
    s_mov_b64 exec, s[62:63]
pl_3046:
    buffer_load_dwordx4 v[240:243], v246, s[80:83], s56 offen sc1
    s_sub_u32 s79, s79, 1
    s_cbranch_scc1 L_abort
    s_waitcnt vmcnt(0)
    v_and_b32 v240, v240, v241
    v_and_b32 v242, v242, v243
    v_and_b32 v240, v240, v242
    v_cmp_ne_u32 vcc, 1, v240
    s_cbranch_vccnz pl_3046
    s_mov_b64 exec, -1
    s_cmp_lg_u32 s78, 0
    s_cbranch_scc1 pl_3046_acq
pl_3046_ok:
    s_cmp_le_u32 s50, 0
    s_addc_u32 s52, s58, 0
    s_and_b32 s52, s52, 7
    s_mul_i32 s52, s52, 57344
    s_add_u32 s52, s52, s53
    s_add_u32 m0, s55, 49152
    s_nop 0
    buffer_load_dwordx4 v249, s[80:83], s52 offen offset:0 sc1 lds
    buffer_load_dwordx4 v249, s[80:83], s52 offen offset:1024 sc1 lds
    s_add_u32 s52, s52, 8192
    s_add_u32 m0, s55, 57344
    s_nop 0
    buffer_load_dwordx4 v249, s[80:83], s52 offen offset:0 sc1 lds
    buffer_load_dwordx4 v249, s[80:83], s52 offen offset:1024 sc1 lds
    s_add_u32 s52, s52, 8192
    s_add_u32 m0, s55, 0
    s_nop 0
    buffer_load_dwordx4 v249, s[80:83], s52 offen offset:0 sc1 lds
    buffer_load_dwordx4 v249, s[80:83], s52 offen offset:1024 sc1 lds
    s_add_u32 s52, s52, 8192
    s_add_u32 m0, s55, 8192
    s_nop 0
    buffer_load_dwordx4 v249, s[80:83], s52 offen offset:0 sc1 lds
    buffer_load_dwordx4 v249, s[80:83], s52 offen offset:1024 sc1 lds
    s_add_u32 s52, s52, 8192
    s_waitcnt vmcnt(4)
    s_barrier
    s_add_u32 s42, s46, 16
    s_cmp_ge_u32 s42, 56
    s_cselect_b32 s47, 56, 0
    s_sub_u32 s42, s42, s47
    s_lshl_b32 s42, s42, 16
    s_add_u32 s44, s40, s42
    s_addc_u32 s45, s41, 0
    s_load_dword s43, s[44:45], 384
    s_load_dword s43, s[44:45], 448
    s_load_dword s43, s[44:45], 1408
    s_load_dword s43, s[44:45], 1472
    s_add_u32 s42, s46, 18
    s_cmp_ge_u32 s42, 56
    s_cselect_b32 s47, 56, 0
    s_sub_u32 s42, s42, s47
    s_lshl_b32 s42, s42, 16
    s_add_u32 s44, s40, s42
    s_addc_u32 s45, s41, 0
    s_load_dword s43, s[44:45], 384
    s_load_dword s43, s[44:45], 448
    s_load_dword s43, s[44:45], 1408
    s_load_dword s43, s[44:45], 1472
    s_add_u32 m0, s51, 107776
    s_nop 0
    buffer_load_dwordx4 v244, s[12:15], s48 offen lds
    s_add_u32 m0, s51, 108832
    s_nop 0
    buffer_load_dwordx4 v245, s[12:15], s48 offen lds
    s_add_u32 s48, s48, 65536
    s_add_u32 m0, s55, 16384
    s_nop 0
    buffer_load_dwordx4 v249, s[80:83], s52 offen offset:0 sc1 lds
    buffer_load_dwordx4 v249, s[80:83], s52 offen offset:1024 sc1 lds
    s_add_u32 s52, s52, 8192
    s_add_u32 m0, s51, 116224
    s_nop 0
    buffer_load_dwordx4 v244, s[12:15], s48 offen lds
    s_add_u32 m0, s51, 117280
    s_nop 0
    buffer_load_dwordx4 v245, s[12:15], s48 offen lds
    s_add_u32 s48, s48, 65536
    s_add_u32 m0, s55, 24576
    s_nop 0
    buffer_load_dwordx4 v249, s[80:83], s52 offen offset:0 sc1 lds
    buffer_load_dwordx4 v249, s[80:83], s52 offen offset:1024 sc1 lds
    s_add_u32 s52, s52, 8192
    s_add_u32 m0, s51, 124672
    s_nop 0
    buffer_load_dwordx4 v244, s[12:15], s48 offen lds
    s_add_u32 m0, s51, 125728
    s_nop 0
    buffer_load_dwordx4 v245, s[12:15], s48 offen lds
    s_add_u32 s48, s48, 65536
    s_waitcnt vmcnt(8)
    s_barrier
    s_add_u32 s42, s46, 20
    s_cmp_ge_u32 s42, 56
    s_cselect_b32 s47, 56, 0
    s_sub_u32 s42, s42, s47
    s_lshl_b32 s42, s42, 16
    s_add_u32 s44, s40, s42
    s_addc_u32 s45, s41, 0
    s_load_dword s43, s[44:45], 384
    s_load_dword s43, s[44:45], 448
    s_load_dword s43, s[44:45], 1408
    s_load_dword s43, s[44:45], 1472
    s_add_u32 m0, s55, 32768
    s_nop 0
    buffer_load_dwordx4 v249, s[80:83], s52 offen offset:0 sc1 lds
    buffer_load_dwordx4 v249, s[80:83], s52 offen offset:1024 sc1 lds
    s_add_u32 s52, s52, 8192
    s_add_u32 m0, s51, 133120
    s_nop 0
    buffer_load_dwordx4 v244, s[12:15], s48 offen lds
    s_add_u32 m0, s51, 134176
    s_nop 0
    buffer_load_dwordx4 v245, s[12:15], s48 offen lds
    s_add_u32 s48, s48, 65536
    s_cmp_le_u32 s50, 1
    s_addc_u32 s52, s58, 1
    s_and_b32 s52, s52, 7
    s_mul_i32 s52, s52, 57344
    s_add_u32 s52, s52, s53
    s_add_u32 m0, s55, 40960
    s_nop 0
    buffer_load_dwordx4 v249, s[80:83], s52 offen offset:0 sc1 lds
    buffer_load_dwordx4 v249, s[80:83], s52 offen offset:1024 sc1 lds
    s_add_u32 s52, s52, 8192
    s_cmp_le_u32 s50, 1
    s_addc_u32 s48, s58, 1
    s_and_b32 s48, s48, 7
    s_mul_i32 s48, s48, 458752
    s_add_u32 s48, s48, s49
    s_add_u32 m0, s51, 141568
    s_nop 0
    buffer_load_dwordx4 v244, s[12:15], s48 offen lds
    s_add_u32 m0, s51, 142624
    s_nop 0
    buffer_load_dwordx4 v245, s[12:15], s48 offen lds
    s_add_u32 s48, s48, 65536
    s_add_u32 m0, s55, 49152
    s_nop 0
    buffer_load_dwordx4 v249, s[80:83], s52 offen offset:0 sc1 lds
    buffer_load_dwordx4 v249, s[80:83], s52 offen offset:1024 sc1 lds
    s_add_u32 s52, s52, 8192
    s_waitcnt vmcnt(10)
    s_barrier
    s_add_u32 s42, s46, 22
    s_cmp_ge_u32 s42, 56
    s_cselect_b32 s47, 56, 0
    s_sub_u32 s42, s42, s47
    s_lshl_b32 s42, s42, 16
    s_add_u32 s44, s40, s42
    s_addc_u32 s45, s41, 0
    s_load_dword s43, s[44:45], 384
    s_load_dword s43, s[44:45], 448
    s_load_dword s43, s[44:45], 1408
    s_load_dword s43, s[44:45], 1472
    s_add_u32 m0, s51, 65536
    s_nop 0
    buffer_load_dwordx4 v244, s[12:15], s48 offen lds
    s_add_u32 m0, s51, 66592
    s_nop 0
    buffer_load_dwordx4 v245, s[12:15], s48 offen lds
    s_add_u32 s48, s48, 65536
    s_add_u32 m0, s55, 57344
    s_nop 0
    buffer_load_dwordx4 v249, s[80:83], s52 offen offset:0 sc1 lds
    buffer_load_dwordx4 v249, s[80:83], s52 offen offset:1024 sc1 lds
    s_add_u32 s52, s52, 8192
    s_add_u32 m0, s51, 73984
    s_nop 0
    buffer_load_dwordx4 v244, s[12:15], s48 offen lds
    s_add_u32 m0, s51, 75040
    s_nop 0
    buffer_load_dwordx4 v245, s[12:15], s48 offen lds
    s_add_u32 s48, s48, 65536
    s_add_u32 m0, s55, 0
    s_nop 0
    buffer_load_dwordx4 v249, s[80:83], s52 offen offset:0 sc1 lds
    buffer_load_dwordx4 v249, s[80:83], s52 offen offset:1024 sc1 lds
    s_add_u32 s52, s52, 8192
    s_add_u32 m0, s51, 82432
    s_nop 0
    buffer_load_dwordx4 v244, s[12:15], s48 offen lds
    s_add_u32 m0, s51, 83488
    s_nop 0
    buffer_load_dwordx4 v245, s[12:15], s48 offen lds
    s_add_u32 s48, s48, 65536
    s_waitcnt vmcnt(12)
    s_barrier
    s_add_u32 s42, s46, 24
    s_cmp_ge_u32 s42, 56
    s_cselect_b32 s47, 56, 0
    s_sub_u32 s42, s42, s47
    s_lshl_b32 s42, s42, 16
    s_add_u32 s44, s40, s42
    s_addc_u32 s45, s41, 0
    s_load_dword s43, s[44:45], 384
    s_load_dword s43, s[44:45], 448
    s_load_dword s43, s[44:45], 1408
    s_load_dword s43, s[44:45], 1472
    s_add_u32 m0, s55, 8192
    s_nop 0
    buffer_load_dwordx4 v249, s[80:83], s52 offen offset:0 sc1 lds
    buffer_load_dwordx4 v249, s[80:83], s52 offen offset:1024 sc1 lds
    s_add_u32 s52, s52, 8192
    s_add_u32 m0, s51, 90880
    s_nop 0
    buffer_load_dwordx4 v244, s[12:15], s48 offen lds
    s_add_u32 m0, s51, 91936
    s_nop 0
    buffer_load_dwordx4 v245, s[12:15], s48 offen lds
    s_add_u32 s48, s48, 65536
    s_add_u32 m0, s55, 16384
    s_nop 0
    buffer_load_dwordx4 v249, s[80:83], s52 offen offset:0 sc1 lds
    buffer_load_dwordx4 v249, s[80:83], s52 offen offset:1024 sc1 lds
    s_add_u32 s52, s52, 8192
    s_add_u32 m0, s51, 99328
    s_nop 0
    buffer_load_dwordx4 v244, s[12:15], s48 offen lds
    s_add_u32 m0, s51, 100384
    s_nop 0
    buffer_load_dwordx4 v245, s[12:15], s48 offen lds
    s_add_u32 s48, s48, 65536
    s_waitcnt vmcnt(12)
    s_barrier
    s_add_u32 s42, s46, 26
    s_cmp_ge_u32 s42, 56
    s_cselect_b32 s47, 56, 0
    s_sub_u32 s42, s42, s47
    s_lshl_b32 s42, s42, 16
    s_add_u32 s44, s40, s42
    s_addc_u32 s45, s41, 0
    s_load_dword s43, s[44:45], 384
    s_load_dword s43, s[44:45], 448
    s_load_dword s43, s[44:45], 1408
    s_load_dword s43, s[44:45], 1472
    s_add_u32 m0, s55, 24576
    s_nop 0
    buffer_load_dwordx4 v249, s[80:83], s52 offen offset:0 sc1 lds
    buffer_load_dwordx4 v249, s[80:83], s52 offen offset:1024 sc1 lds
    s_add_u32 s52, s52, 8192
    s_add_u32 m0, s51, 107776
    s_nop 0
    buffer_load_dwordx4 v244, s[12:15], s48 offen lds
    s_add_u32 m0, s51, 108832
    s_nop 0
    buffer_load_dwordx4 v245, s[12:15], s48 offen lds
    s_add_u32 s48, s48, 65536
    s_cmp_le_u32 s50, 2
    s_addc_u32 s52, s58, 2
    s_and_b32 s52, s52, 7
    s_mul_i32 s52, s52, 57344
    s_add_u32 s52, s52, s53
    s_add_u32 m0, s55, 32768
    s_nop 0
    buffer_load_dwordx4 v249, s[80:83], s52 offen offset:0 sc1 lds
    buffer_load_dwordx4 v249, s[80:83], s52 offen offset:1024 sc1 lds
    s_add_u32 s52, s52, 8192
    s_cmp_le_u32 s50, 2
    s_addc_u32 s48, s58, 2
    s_and_b32 s48, s48, 7
    s_mul_i32 s48, s48, 458752
    s_add_u32 s48, s48, s49
    s_add_u32 m0, s51, 116224
    s_nop 0
    buffer_load_dwordx4 v244, s[12:15], s48 offen lds
    s_add_u32 m0, s51, 117280
    s_nop 0
    buffer_load_dwordx4 v245, s[12:15], s48 offen lds
    s_add_u32 s48, s48, 65536
    s_waitcnt vmcnt(12)
    s_barrier
    s_add_u32 s42, s46, 28
    s_cmp_ge_u32 s42, 56
    s_cselect_b32 s47, 56, 0
    s_sub_u32 s42, s42, s47
    s_lshl_b32 s42, s42, 16
    s_add_u32 s44, s40, s42
    s_addc_u32 s45, s41, 0
    s_load_dword s43, s[44:45], 384
    s_load_dword s43, s[44:45], 448
    s_load_dword s43, s[44:45], 1408
    s_load_dword s43, s[44:45], 1472
    s_add_u32 m0, s55, 40960
    s_nop 0
    buffer_load_dwordx4 v249, s[80:83], s52 offen offset:0 sc1 lds
    buffer_load_dwordx4 v249, s[80:83], s52 offen offset:1024 sc1 lds
    s_add_u32 s52, s52, 8192
    s_add_u32 m0, s51, 124672
    s_nop 0
    buffer_load_dwordx4 v244, s[12:15], s48 offen lds
    s_add_u32 m0, s51, 125728
    s_nop 0
    buffer_load_dwordx4 v245, s[12:15], s48 offen lds
    s_add_u32 s48, s48, 65536
    s_add_u32 m0, s55, 49152
    s_nop 0
    buffer_load_dwordx4 v249, s[80:83], s52 offen offset:0 sc1 lds
    buffer_load_dwordx4 v249, s[80:83], s52 offen offset:1024 sc1 lds
    s_add_u32 s52, s52, 8192
    s_add_u32 m0, s51, 133120
    s_nop 0
    buffer_load_dwordx4 v244, s[12:15], s48 offen lds
    s_add_u32 m0, s51, 134176
    s_nop 0
    buffer_load_dwordx4 v245, s[12:15], s48 offen lds
    s_add_u32 s48, s48, 65536
    s_waitcnt vmcnt(12)
    s_barrier
    s_add_u32 s42, s46, 30
    s_cmp_ge_u32 s42, 56
    s_cselect_b32 s47, 56, 0
    s_sub_u32 s42, s42, s47
    s_lshl_b32 s42, s42, 16
    s_add_u32 s44, s40, s42
    s_addc_u32 s45, s41, 0
    s_load_dword s43, s[44:45], 384
    s_load_dword s43, s[44:45], 448
    s_load_dword s43, s[44:45], 1408
    s_load_dword s43, s[44:45], 1472
    s_add_u32 m0, s55, 57344
    s_nop 0
    buffer_load_dwordx4 v249, s[80:83], s52 offen offset:0 sc1 lds
    buffer_load_dwordx4 v249, s[80:83], s52 offen offset:1024 sc1 lds
    s_add_u32 s52, s52, 8192
    s_add_u32 m0, s51, 141568
    s_nop 0
    buffer_load_dwordx4 v244, s[12:15], s48 offen lds
    s_add_u32 m0, s51, 142624
    s_nop 0
    buffer_load_dwordx4 v245, s[12:15], s48 offen lds
    s_add_u32 s48, s48, 65536
    s_add_u32 m0, s55, 0
    s_nop 0
    buffer_load_dwordx4 v249, s[80:83], s52 offen offset:0 sc1 lds
    buffer_load_dwordx4 v249, s[80:83], s52 offen offset:1024 sc1 lds
    s_add_u32 s52, s52, 8192
    s_add_u32 m0, s51, 65536
    s_nop 0
    buffer_load_dwordx4 v244, s[12:15], s48 offen lds
    s_add_u32 m0, s51, 66592
    s_nop 0
    buffer_load_dwordx4 v245, s[12:15], s48 offen lds
    s_add_u32 s48, s48, 65536
    s_waitcnt vmcnt(12)
    s_barrier
    s_add_u32 s42, s46, 32
    s_cmp_ge_u32 s42, 56
    s_cselect_b32 s47, 56, 0
    s_sub_u32 s42, s42, s47
    s_lshl_b32 s42, s42, 16
    s_add_u32 s44, s40, s42
    s_addc_u32 s45, s41, 0
    s_load_dword s43, s[44:45], 384
    s_load_dword s43, s[44:45], 448
    s_load_dword s43, s[44:45], 1408
    s_load_dword s43, s[44:45], 1472
    s_add_u32 m0, s55, 8192
    s_nop 0
    buffer_load_dwordx4 v249, s[80:83], s52 offen offset:0 sc1 lds
    buffer_load_dwordx4 v249, s[80:83], s52 offen offset:1024 sc1 lds
    s_add_u32 s52, s52, 8192
    s_add_u32 m0, s51, 73984
    s_nop 0
    buffer_load_dwordx4 v244, s[12:15], s48 offen lds
    s_add_u32 m0, s51, 75040
    s_nop 0
    buffer_load_dwordx4 v245, s[12:15], s48 offen lds
    s_add_u32 s48, s48, 65536
    s_add_u32 m0, s55, 16384
    s_nop 0
    buffer_load_dwordx4 v249, s[80:83], s52 offen offset:0 sc1 lds
    buffer_load_dwordx4 v249, s[80:83], s52 offen offset:1024 sc1 lds
    s_add_u32 s52, s52, 8192
    s_add_u32 m0, s51, 82432
    s_nop 0
    buffer_load_dwordx4 v244, s[12:15], s48 offen lds
    s_add_u32 m0, s51, 83488
    s_nop 0
    buffer_load_dwordx4 v245, s[12:15], s48 offen lds
    s_add_u32 s48, s48, 65536
    s_waitcnt vmcnt(12)
    s_barrier
    s_add_u32 s42, s46, 34
    s_cmp_ge_u32 s42, 56
    s_cselect_b32 s47, 56, 0
    s_sub_u32 s42, s42, s47
    s_lshl_b32 s42, s42, 16
    s_add_u32 s44, s40, s42
    s_addc_u32 s45, s41, 0
    s_load_dword s43, s[44:45], 384
    s_load_dword s43, s[44:45], 448
    s_load_dword s43, s[44:45], 1408
    s_load_dword s43, s[44:45], 1472
    s_cmp_le_u32 s50, 3
    s_addc_u32 s52, s58, 3
    s_and_b32 s52, s52, 7
    s_mul_i32 s52, s52, 57344
    s_add_u32 s52, s52, s53
    s_add_u32 m0, s55, 24576
    s_nop 0
    buffer_load_dwordx4 v249, s[80:83], s52 offen offset:0 sc1 lds
    buffer_load_dwordx4 v249, s[80:83], s52 offen offset:1024 sc1 lds
    s_add_u32 s52, s52, 8192
    s_cmp_le_u32 s50, 3
    s_addc_u32 s48, s58, 3
    s_and_b32 s48, s48, 7
    s_mul_i32 s48, s48, 458752
    s_add_u32 s48, s48, s49
    s_add_u32 m0, s51, 90880
    s_nop 0
    buffer_load_dwordx4 v244, s[12:15], s48 offen lds
    s_add_u32 m0, s51, 91936
    s_nop 0
    buffer_load_dwordx4 v245, s[12:15], s48 offen lds
    s_add_u32 s48, s48, 65536
    s_add_u32 m0, s55, 32768
    s_nop 0
    buffer_load_dwordx4 v249, s[80:83], s52 offen offset:0 sc1 lds
    buffer_load_dwordx4 v249, s[80:83], s52 offen offset:1024 sc1 lds
    s_add_u32 s52, s52, 8192
    s_add_u32 m0, s51, 99328
    s_nop 0
    buffer_load_dwordx4 v244, s[12:15], s48 offen lds
    s_add_u32 m0, s51, 100384
    s_nop 0
    buffer_load_dwordx4 v245, s[12:15], s48 offen lds
    s_add_u32 s48, s48, 65536
    s_waitcnt vmcnt(12)
    s_barrier
    s_add_u32 s42, s46, 36
    s_cmp_ge_u32 s42, 56
    s_cselect_b32 s47, 56, 0
    s_sub_u32 s42, s42, s47
    s_lshl_b32 s42, s42, 16
    s_add_u32 s44, s40, s42
    s_addc_u32 s45, s41, 0
    s_load_dword s43, s[44:45], 384
    s_load_dword s43, s[44:45], 448
    s_load_dword s43, s[44:45], 1408
    s_load_dword s43, s[44:45], 1472
    s_add_u32 m0, s55, 40960
    s_nop 0
    buffer_load_dwordx4 v249, s[80:83], s52 offen offset:0 sc1 lds
    buffer_load_dwordx4 v249, s[80:83], s52 offen offset:1024 sc1 lds
    s_add_u32 s52, s52, 8192
    s_add_u32 m0, s51, 107776
    s_nop 0
    buffer_load_dwordx4 v244, s[12:15], s48 offen lds
    s_add_u32 m0, s51, 108832
    s_nop 0
    buffer_load_dwordx4 v245, s[12:15], s48 offen lds
    s_add_u32 s48, s48, 65536
    s_add_u32 m0, s55, 49152
    s_nop 0
    buffer_load_dwordx4 v249, s[80:83], s52 offen offset:0 sc1 lds
    buffer_load_dwordx4 v249, s[80:83], s52 offen offset:1024 sc1 lds
    s_add_u32 s52, s52, 8192
    s_add_u32 m0, s51, 116224
    s_nop 0
    buffer_load_dwordx4 v244, s[12:15], s48 offen lds
    s_add_u32 m0, s51, 117280
    s_nop 0
    buffer_load_dwordx4 v245, s[12:15], s48 offen lds
    s_add_u32 s48, s48, 65536
    s_waitcnt vmcnt(12)
    s_barrier
    s_add_u32 s42, s46, 38
    s_cmp_ge_u32 s42, 56
    s_cselect_b32 s47, 56, 0
    s_sub_u32 s42, s42, s47
    s_lshl_b32 s42, s42, 16
    s_add_u32 s44, s40, s42
    s_addc_u32 s45, s41, 0
    s_load_dword s43, s[44:45], 384
    s_load_dword s43, s[44:45], 448
    s_load_dword s43, s[44:45], 1408
    s_load_dword s43, s[44:45], 1472
    s_add_u32 m0, s55, 57344
    s_nop 0
    buffer_load_dwordx4 v249, s[80:83], s52 offen offset:0 sc1 lds
    buffer_load_dwordx4 v249, s[80:83], s52 offen offset:1024 sc1 lds
    s_add_u32 s52, s52, 8192
    s_add_u32 m0, s51, 124672
    s_nop 0
    buffer_load_dwordx4 v244, s[12:15], s48 offen lds
    s_add_u32 m0, s51, 125728
    s_nop 0
    buffer_load_dwordx4 v245, s[12:15], s48 offen lds
    s_add_u32 s48, s48, 65536
    s_add_u32 m0, s55, 0
    s_nop 0
    buffer_load_dwordx4 v249, s[80:83], s52 offen offset:0 sc1 lds
    buffer_load_dwordx4 v249, s[80:83], s52 offen offset:1024 sc1 lds
    s_add_u32 s52, s52, 8192
    s_add_u32 m0, s51, 133120
    s_nop 0
    buffer_load_dwordx4 v244, s[12:15], s48 offen lds
    s_add_u32 m0, s51, 134176
    s_nop 0
    buffer_load_dwordx4 v245, s[12:15], s48 offen lds
    s_add_u32 s48, s48, 65536
    s_waitcnt vmcnt(12)
    s_barrier
    s_add_u32 s42, s46, 40
    s_cmp_ge_u32 s42, 56
    s_cselect_b32 s47, 56, 0
    s_sub_u32 s42, s42, s47
    s_lshl_b32 s42, s42, 16
    s_add_u32 s44, s40, s42
    s_addc_u32 s45, s41, 0
    s_load_dword s43, s[44:45], 384
    s_load_dword s43, s[44:45], 448
    s_load_dword s43, s[44:45], 1408
    s_load_dword s43, s[44:45], 1472
    s_add_u32 m0, s55, 8192
    s_nop 0
    buffer_load_dwordx4 v249, s[80:83], s52 offen offset:0 sc1 lds
    buffer_load_dwordx4 v249, s[80:83], s52 offen offset:1024 sc1 lds
    s_add_u32 s52, s52, 8192
    s_add_u32 m0, s51, 141568
    s_nop 0
    buffer_load_dwordx4 v244, s[12:15], s48 offen lds
    s_add_u32 m0, s51, 142624
    s_nop 0
    buffer_load_dwordx4 v245, s[12:15], s48 offen lds
    s_add_u32 s48, s48, 65536
    s_cmp_le_u32 s50, 4
    s_addc_u32 s52, s58, 4
    s_and_b32 s52, s52, 7
    s_mul_i32 s52, s52, 57344
    s_add_u32 s52, s52, s53
    s_add_u32 m0, s55, 16384
    s_nop 0
    buffer_load_dwordx4 v249, s[80:83], s52 offen offset:0 sc1 lds
    buffer_load_dwordx4 v249, s[80:83], s52 offen offset:1024 sc1 lds
    s_add_u32 s52, s52, 8192
    s_cmp_le_u32 s50, 4
    s_addc_u32 s48, s58, 4
    s_and_b32 s48, s48, 7
    s_mul_i32 s48, s48, 458752
    s_add_u32 s48, s48, s49
    s_add_u32 m0, s51, 65536
    s_nop 0
    buffer_load_dwordx4 v244, s[12:15], s48 offen lds
    s_add_u32 m0, s51, 66592
    s_nop 0
    buffer_load_dwordx4 v245, s[12:15], s48 offen lds
    s_add_u32 s48, s48, 65536
    s_waitcnt vmcnt(12)
    s_barrier
    s_add_u32 s42, s46, 42
    s_cmp_ge_u32 s42, 56
    s_cselect_b32 s47, 56, 0
    s_sub_u32 s42, s42, s47
    s_lshl_b32 s42, s42, 16
    s_add_u32 s44, s40, s42
    s_addc_u32 s45, s41, 0
    s_load_dword s43, s[44:45], 384
    s_load_dword s43, s[44:45], 448
    s_load_dword s43, s[44:45], 1408
    s_load_dword s43, s[44:45], 1472
    s_add_u32 m0, s55, 24576
    s_nop 0
    buffer_load_dwordx4 v249, s[80:83], s52 offen offset:0 sc1 lds
    buffer_load_dwordx4 v249, s[80:83], s52 offen offset:1024 sc1 lds
    s_add_u32 s52, s52, 8192
    s_add_u32 m0, s51, 73984
    s_nop 0
    buffer_load_dwordx4 v244, s[12:15], s48 offen lds
    s_add_u32 m0, s51, 75040
    s_nop 0
    buffer_load_dwordx4 v245, s[12:15], s48 offen lds
    s_add_u32 s48, s48, 65536
    s_add_u32 m0, s55, 32768
    s_nop 0
    buffer_load_dwordx4 v249, s[80:83], s52 offen offset:0 sc1 lds
    buffer_load_dwordx4 v249, s[80:83], s52 offen offset:1024 sc1 lds
    s_add_u32 s52, s52, 8192
    s_add_u32 m0, s51, 82432
    s_nop 0
    buffer_load_dwordx4 v244, s[12:15], s48 offen lds
    s_add_u32 m0, s51, 83488
    s_nop 0
    buffer_load_dwordx4 v245, s[12:15], s48 offen lds
    s_add_u32 s48, s48, 65536
    s_waitcnt vmcnt(12)
    s_barrier
    s_add_u32 s42, s46, 44
    s_cmp_ge_u32 s42, 56
    s_cselect_b32 s47, 56, 0
    s_sub_u32 s42, s42, s47
    s_lshl_b32 s42, s42, 16
    s_add_u32 s44, s40, s42
    s_addc_u32 s45, s41, 0
    s_load_dword s43, s[44:45], 384
    s_load_dword s43, s[44:45], 448
    s_load_dword s43, s[44:45], 1408
    s_load_dword s43, s[44:45], 1472
    s_add_u32 m0, s55, 40960
    s_nop 0
    buffer_load_dwordx4 v249, s[80:83], s52 offen offset:0 sc1 lds
    buffer_load_dwordx4 v249, s[80:83], s52 offen offset:1024 sc1 lds
    s_add_u32 s52, s52, 8192
    s_add_u32 m0, s51, 90880
    s_nop 0
    buffer_load_dwordx4 v244, s[12:15], s48 offen lds
    s_add_u32 m0, s51, 91936
    s_nop 0
    buffer_load_dwordx4 v245, s[12:15], s48 offen lds
    s_add_u32 s48, s48, 65536
    s_add_u32 m0, s55, 49152
    s_nop 0
    buffer_load_dwordx4 v249, s[80:83], s52 offen offset:0 sc1 lds
    buffer_load_dwordx4 v249, s[80:83], s52 offen offset:1024 sc1 lds
    s_add_u32 s52, s52, 8192
    s_add_u32 m0, s51, 99328
    s_nop 0
    buffer_load_dwordx4 v244, s[12:15], s48 offen lds
    s_add_u32 m0, s51, 100384
    s_nop 0
    buffer_load_dwordx4 v245, s[12:15], s48 offen lds
    s_add_u32 s48, s48, 65536
    s_waitcnt vmcnt(12)
    s_barrier
    s_add_u32 s42, s46, 46
    s_cmp_ge_u32 s42, 56
    s_cselect_b32 s47, 56, 0
    s_sub_u32 s42, s42, s47
    s_lshl_b32 s42, s42, 16
    s_add_u32 s44, s40, s42
    s_addc_u32 s45, s41, 0
    s_load_dword s43, s[44:45], 384
    s_load_dword s43, s[44:45], 448
    s_load_dword s43, s[44:45], 1408
    s_load_dword s43, s[44:45], 1472
    s_add_u32 m0, s55, 57344
    s_nop 0
    buffer_load_dwordx4 v249, s[80:83], s52 offen offset:0 sc1 lds
    buffer_load_dwordx4 v249, s[80:83], s52 offen offset:1024 sc1 lds
    s_add_u32 s52, s52, 8192
    s_add_u32 m0, s51, 107776
    s_nop 0
    buffer_load_dwordx4 v244, s[12:15], s48 offen lds
    s_add_u32 m0, s51, 108832
    s_nop 0
    buffer_load_dwordx4 v245, s[12:15], s48 offen lds
    s_add_u32 s48, s48, 65536
    s_add_u32 m0, s55, 0
    s_nop 0
    buffer_load_dwordx4 v249, s[80:83], s52 offen offset:0 sc1 lds
    buffer_load_dwordx4 v249, s[80:83], s52 offen offset:1024 sc1 lds
    s_add_u32 s52, s52, 8192
    s_add_u32 m0, s51, 116224
    s_nop 0
    buffer_load_dwordx4 v244, s[12:15], s48 offen lds
    s_add_u32 m0, s51, 117280
    s_nop 0
    buffer_load_dwordx4 v245, s[12:15], s48 offen lds
    s_add_u32 s48, s48, 65536
    s_waitcnt vmcnt(12)
    s_barrier
    s_add_u32 s42, s46, 48
    s_cmp_ge_u32 s42, 56
    s_cselect_b32 s47, 56, 0
    s_sub_u32 s42, s42, s47
    s_lshl_b32 s42, s42, 16
    s_add_u32 s44, s40, s42
    s_addc_u32 s45, s41, 0
    s_load_dword s43, s[44:45], 384
    s_load_dword s43, s[44:45], 448
    s_load_dword s43, s[44:45], 1408
    s_load_dword s43, s[44:45], 1472
    s_cmp_le_u32 s50, 5
    s_addc_u32 s52, s58, 5
    s_and_b32 s52, s52, 7
    s_mul_i32 s52, s52, 57344
    s_add_u32 s52, s52, s53
    s_add_u32 m0, s55, 8192
    s_nop 0
    buffer_load_dwordx4 v249, s[80:83], s52 offen offset:0 sc1 lds
    buffer_load_dwordx4 v249, s[80:83], s52 offen offset:1024 sc1 lds
    s_add_u32 s52, s52, 8192
    s_cmp_le_u32 s50, 5
    s_addc_u32 s48, s58, 5
    s_and_b32 s48, s48, 7
    s_mul_i32 s48, s48, 458752
    s_add_u32 s48, s48, s49
    s_add_u32 m0, s51, 124672
    s_nop 0
    buffer_load_dwordx4 v244, s[12:15], s48 offen lds
    s_add_u32 m0, s51, 125728
    s_nop 0
    buffer_load_dwordx4 v245, s[12:15], s48 offen lds
    s_add_u32 s48, s48, 65536
    s_add_u32 m0, s55, 16384
    s_nop 0
    buffer_load_dwordx4 v249, s[80:83], s52 offen offset:0 sc1 lds
    buffer_load_dwordx4 v249, s[80:83], s52 offen offset:1024 sc1 lds
    s_add_u32 s52, s52, 8192
    s_add_u32 m0, s51, 133120
    s_nop 0
    buffer_load_dwordx4 v244, s[12:15], s48 offen lds
    s_add_u32 m0, s51, 134176
    s_nop 0
    buffer_load_dwordx4 v245, s[12:15], s48 offen lds
    s_add_u32 s48, s48, 65536
    s_waitcnt vmcnt(12)
    s_barrier
    s_add_u32 s42, s46, 50
    s_cmp_ge_u32 s42, 56
    s_cselect_b32 s47, 56, 0
    s_sub_u32 s42, s42, s47
    s_lshl_b32 s42, s42, 16
    s_add_u32 s44, s40, s42
    s_addc_u32 s45, s41, 0
    s_load_dword s43, s[44:45], 384
    s_load_dword s43, s[44:45], 448
    s_load_dword s43, s[44:45], 1408
    s_load_dword s43, s[44:45], 1472
    s_add_u32 m0, s55, 24576
    s_nop 0
    buffer_load_dwordx4 v249, s[80:83], s52 offen offset:0 sc1 lds
    buffer_load_dwordx4 v249, s[80:83], s52 offen offset:1024 sc1 lds
    s_add_u32 s52, s52, 8192
    s_add_u32 m0, s51, 141568
    s_nop 0
    buffer_load_dwordx4 v244, s[12:15], s48 offen lds
    s_add_u32 m0, s51, 142624
    s_nop 0
    buffer_load_dwordx4 v245, s[12:15], s48 offen lds
    s_add_u32 s48, s48, 65536
    s_add_u32 m0, s55, 32768
    s_nop 0
    buffer_load_dwordx4 v249, s[80:83], s52 offen offset:0 sc1 lds
    buffer_load_dwordx4 v249, s[80:83], s52 offen offset:1024 sc1 lds
    s_add_u32 s52, s52, 8192
    s_add_u32 m0, s51, 65536
    s_nop 0
    buffer_load_dwordx4 v244, s[12:15], s48 offen lds
    s_add_u32 m0, s51, 66592
    s_nop 0
    buffer_load_dwordx4 v245, s[12:15], s48 offen lds
    s_add_u32 s48, s48, 65536
    s_waitcnt vmcnt(12)
    s_barrier
    s_add_u32 s42, s46, 52
    s_cmp_ge_u32 s42, 56
    s_cselect_b32 s47, 56, 0
    s_sub_u32 s42, s42, s47
    s_lshl_b32 s42, s42, 16
    s_add_u32 s44, s40, s42
    s_addc_u32 s45, s41, 0
    s_load_dword s43, s[44:45], 384
    s_load_dword s43, s[44:45], 448
    s_load_dword s43, s[44:45], 1408
    s_load_dword s43, s[44:45], 1472
    s_add_u32 m0, s55, 40960
    s_nop 0
    buffer_load_dwordx4 v249, s[80:83], s52 offen offset:0 sc1 lds
    buffer_load_dwordx4 v249, s[80:83], s52 offen offset:1024 sc1 lds
    s_add_u32 s52, s52, 8192
    s_add_u32 m0, s51, 73984
    s_nop 0
    buffer_load_dwordx4 v244, s[12:15], s48 offen lds
    s_add_u32 m0, s51, 75040
    s_nop 0
    buffer_load_dwordx4 v245, s[12:15], s48 offen lds
    s_add_u32 s48, s48, 65536
    s_add_u32 m0, s55, 49152
    s_nop 0
    buffer_load_dwordx4 v249, s[80:83], s52 offen offset:0 sc1 lds
    buffer_load_dwordx4 v249, s[80:83], s52 offen offset:1024 sc1 lds
    s_add_u32 s52, s52, 8192
    s_add_u32 m0, s51, 82432
    s_nop 0
    buffer_load_dwordx4 v244, s[12:15], s48 offen lds
    s_add_u32 m0, s51, 83488
    s_nop 0
    buffer_load_dwordx4 v245, s[12:15], s48 offen lds
    s_add_u32 s48, s48, 65536
    s_waitcnt vmcnt(12)
    s_barrier
    s_add_u32 s42, s46, 54
    s_cmp_ge_u32 s42, 56
    s_cselect_b32 s47, 56, 0
    s_sub_u32 s42, s42, s47
    s_lshl_b32 s42, s42, 16
    s_add_u32 s44, s40, s42
    s_addc_u32 s45, s41, 0
    s_load_dword s43, s[44:45], 384
    s_load_dword s43, s[44:45], 448
    s_load_dword s43, s[44:45], 1408
    s_load_dword s43, s[44:45], 1472
    s_add_u32 m0, s55, 57344
    s_nop 0
    buffer_load_dwordx4 v249, s[80:83], s52 offen offset:0 sc1 lds
    buffer_load_dwordx4 v249, s[80:83], s52 offen offset:1024 sc1 lds
    s_add_u32 s52, s52, 8192
    s_add_u32 m0, s51, 90880
    s_nop 0
    buffer_load_dwordx4 v244, s[12:15], s48 offen lds
    s_add_u32 m0, s51, 91936
    s_nop 0
    buffer_load_dwordx4 v245, s[12:15], s48 offen lds
    s_add_u32 s48, s48, 65536
    s_cmp_le_u32 s50, 6
    s_addc_u32 s52, s58, 6
    s_and_b32 s52, s52, 7
    s_mul_i32 s52, s52, 57344
    s_add_u32 s52, s52, s53
    s_add_u32 m0, s55, 0
    s_nop 0
    buffer_load_dwordx4 v249, s[80:83], s52 offen offset:0 sc1 lds
    buffer_load_dwordx4 v249, s[80:83], s52 offen offset:1024 sc1 lds
    s_add_u32 s52, s52, 8192
    s_cmp_le_u32 s50, 6
    s_addc_u32 s48, s58, 6
    s_and_b32 s48, s48, 7
    s_mul_i32 s48, s48, 458752
    s_add_u32 s48, s48, s49
    s_add_u32 m0, s51, 99328
    s_nop 0
    buffer_load_dwordx4 v244, s[12:15], s48 offen lds
    s_add_u32 m0, s51, 100384
    s_nop 0
    buffer_load_dwordx4 v245, s[12:15], s48 offen lds
    s_add_u32 s48, s48, 65536
    s_waitcnt vmcnt(12)
    s_barrier
    s_add_u32 m0, s55, 8192
    s_nop 0
    buffer_load_dwordx4 v249, s[80:83], s52 offen offset:0 sc1 lds
    buffer_load_dwordx4 v249, s[80:83], s52 offen offset:1024 sc1 lds
    s_add_u32 s52, s52, 8192
    s_add_u32 m0, s51, 107776
    s_nop 0
    buffer_load_dwordx4 v244, s[12:15], s48 offen lds
    s_add_u32 m0, s51, 108832
    s_nop 0
    buffer_load_dwordx4 v245, s[12:15], s48 offen lds
    s_add_u32 s48, s48, 65536
    s_add_u32 m0, s55, 16384
    s_nop 0
    buffer_load_dwordx4 v249, s[80:83], s52 offen offset:0 sc1 lds
    buffer_load_dwordx4 v249, s[80:83], s52 offen offset:1024 sc1 lds
    s_add_u32 s52, s52, 8192
    s_add_u32 m0, s51, 116224
    s_nop 0
    buffer_load_dwordx4 v244, s[12:15], s48 offen lds
    s_add_u32 m0, s51, 117280
    s_nop 0
    buffer_load_dwordx4 v245, s[12:15], s48 offen lds
    s_add_u32 s48, s48, 65536
    s_waitcnt vmcnt(12)
    s_barrier
    s_add_u32 m0, s55, 24576
    s_nop 0
    buffer_load_dwordx4 v249, s[80:83], s52 offen offset:0 sc1 lds
    buffer_load_dwordx4 v249, s[80:83], s52 offen offset:1024 sc1 lds
    s_add_u32 s52, s52, 8192
    s_add_u32 m0, s51, 124672
    s_nop 0
    buffer_load_dwordx4 v244, s[12:15], s48 offen lds
    s_add_u32 m0, s51, 125728
    s_nop 0
    buffer_load_dwordx4 v245, s[12:15], s48 offen lds
    s_add_u32 s48, s48, 65536
    s_add_u32 m0, s55, 32768
    s_nop 0
    buffer_load_dwordx4 v249, s[80:83], s52 offen offset:0 sc1 lds
    buffer_load_dwordx4 v249, s[80:83], s52 offen offset:1024 sc1 lds
    s_add_u32 s52, s52, 8192
    s_add_u32 m0, s51, 133120
    s_nop 0
    buffer_load_dwordx4 v244, s[12:15], s48 offen lds
    s_add_u32 m0, s51, 134176
    s_nop 0
    buffer_load_dwordx4 v245, s[12:15], s48 offen lds
    s_add_u32 s48, s48, 65536
    s_waitcnt vmcnt(12)
    s_barrier
    s_add_u32 m0, s55, 40960
    s_nop 0
    buffer_load_dwordx4 v249, s[80:83], s52 offen offset:0 sc1 lds
    buffer_load_dwordx4 v249, s[80:83], s52 offen offset:1024 sc1 lds
    s_add_u32 s52, s52, 8192
    s_add_u32 m0, s51, 141568
    s_nop 0
    buffer_load_dwordx4 v244, s[12:15], s48 offen lds
    s_add_u32 m0, s51, 142624
    s_nop 0
    buffer_load_dwordx4 v245, s[12:15], s48 offen lds
    s_add_u32 s48, s48, 65536
    s_add_u32 m0, s55, 49152
    s_nop 0
    buffer_load_dwordx4 v249, s[80:83], s52 offen offset:0 sc1 lds
    buffer_load_dwordx4 v249, s[80:83], s52 offen offset:1024 sc1 lds
    s_add_u32 s52, s52, 8192
    s_add_u32 m0, s51, 65536
    s_nop 0
    buffer_load_dwordx4 v244, s[12:15], s48 offen lds
    s_add_u32 m0, s51, 66592
    s_nop 0
    buffer_load_dwordx4 v245, s[12:15], s48 offen lds
    s_add_u32 s48, s48, 65536
    s_waitcnt vmcnt(12)
    s_barrier
    v_lshlrev_b32 v253, 7, v250
    s_lshl_b32 s64, s73, 4
    s_add_u32 s64, s64, s74
    s_lshl_b32 s64, s64, 2
    s_add_u32 s64, s64, s69
    s_lshl_b32 s64, s64, 13
    s_lshl_b32 s66, s60, 23
    s_add_u32 s64, s64, s66
    s_add_u32 s64, s64, 54525952
    buffer_load_dword v240, v253, s[80:83], s64 offen sc1
    s_lshl_b32 s64, s73, 4
    s_add_u32 s64, s64, s68
    s_lshl_b32 s64, s64, 14
    s_mul_i32 s66, s59, 4194304
    s_add_u32 s64, s64, s66
    s_lshl_b32 s65, s69, 12
    s_add_u32 s64, s64, s65
    s_lshl_b32 s65, s70, 1
    s_sub_u32 s65, s68, s65
    s_and_b32 s65, s65, 15
    s_cmp_lt_u32 s65, 16
    s_cselect_b32 s64, s64, 0x7f000000
    v_lshlrev_b32 v253, 7, v250
    s_mov_b64 exec, 0xffffffff
    buffer_load_dword v241, v253, s[80:83], s64 offen sc1
    s_mov_b64 exec, -1
    s_waitcnt vmcnt(2)
    s_barrier
    s_add_u32 m0, s19, 86400
    s_nop 0
    buffer_load_dwordx4 v10, s[8:11], s16 offen lds
    s_add_u32 m0, s19, 87424
    s_nop 0
    buffer_load_dwordx4 v11, s[8:11], s16 offen lds
    s_add_u32 m0, s19, 88448
    s_nop 0
    buffer_load_dwordx4 v12, s[8:11], s16 offen lds
    s_add_u32 s16, s16, 196608
    s_cmp_eq_u32 s16, s18
    s_cselect_b32 s16, s17, s16
    s_add_u32 m0, s19, 98816
    s_nop 0
    buffer_load_dwordx4 v10, s[8:11], s16 offen lds
    s_add_u32 m0, s19, 99840
    s_nop 0
    buffer_load_dwordx4 v11, s[8:11], s16 offen lds
    s_add_u32 m0, s19, 100864
    s_nop 0
    buffer_load_dwordx4 v12, s[8:11], s16 offen lds
    s_add_u32 s16, s16, 196608
    s_cmp_eq_u32 s16, s18
    s_cselect_b32 s16, s17, s16
    s_add_u32 m0, s19, 111232
    s_nop 0
    buffer_load_dwordx4 v10, s[8:11], s16 offen lds
    s_add_u32 m0, s19, 112256
    s_nop 0
    buffer_load_dwordx4 v11, s[8:11], s16 offen lds
    s_add_u32 m0, s19, 113280
    s_nop 0
    buffer_load_dwordx4 v12, s[8:11], s16 offen lds
    s_add_u32 s16, s16, 196608
    s_cmp_eq_u32 s16, s18
    s_cselect_b32 s16, s17, s16
    s_cmp_eq_u32 s75, 1
    s_cbranch_scc1 L_fin
    s_mov_b32 s75, 1
    s_mov_b32 s59, s78
    s_mul_i32 s60, s59, s75
    s_lshl_b32 s21, s73, 18
    s_lshl_b32 s64, s59, 22
    s_add_u32 s21, s21, s64
    s_lshl_b32 s64, s69, 11
    s_add_u32 s21, s21, s64
    s_lshl_b32 s23, s69, 12
    s_add_u32 s23, s23, 2048
    s_add_u32 s22, s21, 262144
    s_lshl_b32 s64, s70, 1
    s_lshl_b32 s65, s64, 14
    s_add_u32 s20, s21, s65
    s_sub_u32 s28, s73, 1
    s_and_b32 s28, s28, 15
    s_lshl_b32 s26, s28, 15
    s_add_u32 s26, s26, 73400320
    s_lshl_b32 s27, s64, 11
    s_lshl_b32 s64, s73, 9
    s_add_u32 s64, s64, 75522048
    v_lshlrev_b32 v246, 5, v250
    s_mov_b64 exec, 0xffff
pl_3047:
    buffer_load_dwordx4 v[240:243], v246, s[80:83], s64 offen sc1
    s_sub_u32 s79, s79, 1
    s_cbranch_scc1 L_abort
    s_waitcnt vmcnt(0)
    v_and_b32 v240, v240, v241
    v_and_b32 v242, v242, v243
    v_and_b32 v240, v240, v242
    v_cmp_ne_u32 vcc, 1, v240
    s_cbranch_vccnz pl_3047
    s_mov_b64 exec, -1
    s_cmp_lg_u32 s78, 0
    s_cbranch_scc1 pl_3047_acq
pl_3047_ok:
    s_lshl_b32 s64, s70, 1
    s_sub_u32 s64, s64, 1
    v_add_u32 v253, s64, v251
    v_and_b32 v253, 15, v253
    v_lshlrev_b32 v253, 9, v253
    v_lshl_add_u32 v246, v252, 5, v253
    s_mov_b32 s64, 75571200
    s_mov_b32 s62, -1
    s_mov_b32 s63, 0xffff
    s_mov_b64 exec, s[62:63]
pl_3048:
    buffer_load_dwordx2 v[240:241], v246, s[80:83], s64 offen sc1
    s_sub_u32 s79, s79, 1
    s_cbranch_scc1 L_abort
    s_waitcnt vmcnt(0)
    v_and_b32 v240, v240, v241
    v_cmp_ne_u32 vcc, 1, v240
    s_cbranch_vccnz pl_3048
    s_mov_b64 exec, -1
    s_cmp_lg_u32 s78, 0
    s_cbranch_scc1 pl_3048_acq
pl_3048_ok:
    s_lshr_b32 s40, s2, 3
    s_lshl_b32 s40, s40, 2
    s_add_u32 s40, s40, s69
    s_and_b32 s41, s40, 63
    s_mul_i32 s41, s41, 6144
    s_lshr_b32 s40, s40, 6
    s_lshl_b32 s40, s40, 10
    s_add_u32 s40, s40, s41
    s_add_u32 s40, s40, 384
    s_add_u32 s40, s86, s40
    s_addc_u32 s41, s87, 0
    s_cmp_lg_u32 s69, 0
    s_cbranch_scc1 nh_3049
    s_add_u32 s64, s27, 0
    s_and_b32 s64, s64, 0x7fff
    s_mov_b32 m0, 18432
    s_add_u32 s64, s64, s26
    buffer_load_dwordx4 v249, s[80:83], s64 offen sc1 lds
nh_3049:
    s_add_u32 m0, s23, 18432
    s_nop 0
    buffer_load_dwordx4 v249, s[80:83], s20 offen offset:0 sc1 lds
    s_add_u32 m0, s23, 19456
    s_nop 0
    buffer_load_dwordx4 v249, s[80:83], s20 offen offset:1024 sc1 lds
    s_add_u32 s20, s20, 8192
    s_cmp_eq_u32 s20, s22
    s_cselect_b32 s20, s21, s20
    s_cmp_lg_u32 s69, 1
    s_cbranch_scc1 nh_3050
    s_add_u32 s64, s27, 1024
    s_and_b32 s64, s64, 0x7fff
    s_mov_b32 m0, 19456
    s_add_u32 s64, s64, s26
    buffer_load_dwordx4 v249, s[80:83], s64 offen sc1 lds
nh_3050:
    s_add_u32 m0, s23, 19456
    s_nop 0
    buffer_load_dwordx4 v249, s[80:83], s20 offen offset:0 sc1 lds
    s_add_u32 m0, s23, 20480
    s_nop 0
    buffer_load_dwordx4 v249, s[80:83], s20 offen offset:1024 sc1 lds
    s_add_u32 s20, s20, 8192
    s_cmp_eq_u32 s20, s22
    s_cselect_b32 s20, s21, s20
    s_cmp_lg_u32 s69, 2
    s_cbranch_scc1 nh_3051
    s_add_u32 s64, s27, 2048
    s_and_b32 s64, s64, 0x7fff
    s_mov_b32 m0, 36864
    s_add_u32 s64, s64, s26
    buffer_load_dwordx4 v249, s[80:83], s64 offen sc1 lds
nh_3051:
    s_add_u32 m0, s23, 36864
    s_nop 0
    buffer_load_dwordx4 v249, s[80:83], s20 offen offset:0 sc1 lds
    s_add_u32 m0, s23, 37888
    s_nop 0
    buffer_load_dwordx4 v249, s[80:83], s20 offen offset:1024 sc1 lds
    s_add_u32 s20, s20, 8192
    s_cmp_eq_u32 s20, s22
    s_cselect_b32 s20, s21, s20
    s_waitcnt vmcnt(4)
    s_barrier
    s_cmp_lg_u32 s69, 3
    s_cbranch_scc1 nh_3052
    s_add_u32 s64, s27, 3072
    s_and_b32 s64, s64, 0x7fff
    s_mov_b32 m0, 37888
    s_add_u32 s64, s64, s26
    buffer_load_dwordx4 v249, s[80:83], s64 offen sc1 lds
nh_3052:
    s_add_u32 m0, s23, 37888
    s_nop 0
    buffer_load_dwordx4 v249, s[80:83], s20 offen offset:0 sc1 lds
    s_add_u32 m0, s23, 38912
    s_nop 0
    buffer_load_dwordx4 v249, s[80:83], s20 offen offset:1024 sc1 lds
    s_add_u32 s20, s20, 8192
    s_cmp_eq_u32 s20, s22
    s_cselect_b32 s20, s21, s20
    s_add_u32 m0, s19, 123648
    s_nop 0
    buffer_load_dwordx4 v10, s[8:11], s16 offen lds
    s_add_u32 m0, s19, 124672
    s_nop 0
    buffer_load_dwordx4 v11, s[8:11], s16 offen lds
    s_add_u32 m0, s19, 125696
    s_nop 0
    buffer_load_dwordx4 v12, s[8:11], s16 offen lds
    s_add_u32 s16, s16, 196608
    s_cmp_eq_u32 s16, s18
    s_cselect_b32 s16, s17, s16
    s_lshl_b32 s42, s70, 1
    s_add_u32 s42, s42, 2
    s_and_b32 s42, s42, 15
    s_mul_i32 s42, s42, 393216
    s_add_u32 s44, s40, s42
    s_addc_u32 s45, s41, 0
    s_load_dword s43, s[44:45], 0
    s_load_dword s43, s[44:45], 64
    s_load_dword s43, s[44:45], 2048
    s_load_dword s43, s[44:45], 2112
    s_load_dword s43, s[44:45], 4096
    s_load_dword s43, s[44:45], 4160
    s_lshl_b32 s42, s70, 1
    s_add_u32 s42, s42, 3
    s_and_b32 s42, s42, 15
    s_mul_i32 s42, s42, 393216
    s_add_u32 s44, s40, s42
    s_addc_u32 s45, s41, 0
    s_load_dword s43, s[44:45], 0
    s_load_dword s43, s[44:45], 64
    s_load_dword s43, s[44:45], 2048
    s_load_dword s43, s[44:45], 2112
    s_load_dword s43, s[44:45], 4096
    s_load_dword s43, s[44:45], 4160
    s_waitcnt vmcnt(5)
    s_barrier
    s_cmp_lg_u32 s69, 0
    s_cbranch_scc1 nh_3053
    s_add_u32 s64, s27, 4096
    s_and_b32 s64, s64, 0x7fff
    s_mov_b32 m0, 55296
    s_add_u32 s64, s64, s26
    buffer_load_dwordx4 v249, s[80:83], s64 offen sc1 lds
nh_3053:
    s_add_u32 m0, s23, 55296
    s_nop 0
    buffer_load_dwordx4 v249, s[80:83], s20 offen offset:0 sc1 lds
    s_add_u32 m0, s23, 56320
    s_nop 0
    buffer_load_dwordx4 v249, s[80:83], s20 offen offset:1024 sc1 lds
    s_add_u32 s20, s20, 8192
    s_cmp_eq_u32 s20, s22
    s_cselect_b32 s20, s21, s20
    s_add_u32 m0, s19, 136064
    s_nop 0
    buffer_load_dwordx4 v10, s[8:11], s16 offen lds
    s_add_u32 m0, s19, 137088
    s_nop 0
    buffer_load_dwordx4 v11, s[8:11], s16 offen lds
    s_add_u32 m0, s19, 138112
    s_nop 0
    buffer_load_dwordx4 v12, s[8:11], s16 offen lds
    s_add_u32 s16, s16, 196608
    s_cmp_eq_u32 s16, s18
    s_cselect_b32 s16, s17, s16
    s_cmp_lg_u32 s69, 1
    s_cbranch_scc1 nh_3054
    s_add_u32 s64, s27, 5120
    s_and_b32 s64, s64, 0x7fff
    s_mov_b32 m0, 56320
    s_add_u32 s64, s64, s26
    buffer_load_dwordx4 v249, s[80:83], s64 offen sc1 lds
nh_3054:
    s_add_u32 m0, s23, 56320
    s_nop 0
    buffer_load_dwordx4 v249, s[80:83], s20 offen offset:0 sc1 lds
    s_add_u32 m0, s23, 57344
    s_nop 0
    buffer_load_dwordx4 v249, s[80:83], s20 offen offset:1024 sc1 lds
    s_add_u32 s20, s20, 8192
    s_cmp_eq_u32 s20, s22
    s_cselect_b32 s20, s21, s20
    s_add_u32 m0, s19, 73984
    s_nop 0
    buffer_load_dwordx4 v10, s[8:11], s16 offen lds
    s_add_u32 m0, s19, 75008
    s_nop 0
    buffer_load_dwordx4 v11, s[8:11], s16 offen lds
    s_add_u32 m0, s19, 76032
    s_nop 0
    buffer_load_dwordx4 v12, s[8:11], s16 offen lds
    s_add_u32 s16, s16, 196608
    s_cmp_eq_u32 s16, s18
    s_cselect_b32 s16, s17, s16
    s_cmp_lg_u32 s69, 2
    s_cbranch_scc1 nh_3055
    s_add_u32 s64, s27, 6144
    s_and_b32 s64, s64, 0x7fff
    s_mov_b32 m0, 0
    s_add_u32 s64, s64, s26
    buffer_load_dwordx4 v249, s[80:83], s64 offen sc1 lds
nh_3055:
    s_add_u32 m0, s23, 0
    s_nop 0
    buffer_load_dwordx4 v249, s[80:83], s20 offen offset:0 sc1 lds
    s_add_u32 m0, s23, 1024
    s_nop 0
    buffer_load_dwordx4 v249, s[80:83], s20 offen offset:1024 sc1 lds
    s_add_u32 s20, s20, 8192
    s_cmp_eq_u32 s20, s22
    s_cselect_b32 s20, s21, s20
    s_lshl_b32 s42, s70, 1
    s_add_u32 s42, s42, 4
    s_and_b32 s42, s42, 15
    s_mul_i32 s42, s42, 393216
    s_add_u32 s44, s40, s42
    s_addc_u32 s45, s41, 0
    s_load_dword s43, s[44:45], 0
    s_load_dword s43, s[44:45], 64
    s_load_dword s43, s[44:45], 2048
    s_load_dword s43, s[44:45], 2112
    s_load_dword s43, s[44:45], 4096
    s_load_dword s43, s[44:45], 4160
    s_waitcnt vmcnt(7)
    s_barrier
    s_add_u32 m0, s19, 86400
    s_nop 0
    buffer_load_dwordx4 v10, s[8:11], s16 offen lds
    s_add_u32 m0, s19, 87424
    s_nop 0
    buffer_load_dwordx4 v11, s[8:11], s16 offen lds
    s_add_u32 m0, s19, 88448
    s_nop 0
    buffer_load_dwordx4 v12, s[8:11], s16 offen lds
    s_add_u32 s16, s16, 196608
    s_cmp_eq_u32 s16, s18
    s_cselect_b32 s16, s17, s16
    s_cmp_lg_u32 s69, 3
    s_cbranch_scc1 nh_3056
    s_add_u32 s64, s27, 7168
    s_and_b32 s64, s64, 0x7fff
    s_mov_b32 m0, 1024
    s_add_u32 s64, s64, s26
    buffer_load_dwordx4 v249, s[80:83], s64 offen sc1 lds
nh_3056:
    s_add_u32 m0, s23, 1024
    s_nop 0
    buffer_load_dwordx4 v249, s[80:83], s20 offen offset:0 sc1 lds
    s_add_u32 m0, s23, 2048
    s_nop 0
    buffer_load_dwordx4 v249, s[80:83], s20 offen offset:1024 sc1 lds
    s_add_u32 s20, s20, 8192
    s_cmp_eq_u32 s20, s22
    s_cselect_b32 s20, s21, s20
    s_add_u32 m0, s19, 98816
    s_nop 0
    buffer_load_dwordx4 v10, s[8:11], s16 offen lds
    s_add_u32 m0, s19, 99840
    s_nop 0
    buffer_load_dwordx4 v11, s[8:11], s16 offen lds
    s_add_u32 m0, s19, 100864
    s_nop 0
    buffer_load_dwordx4 v12, s[8:11], s16 offen lds
    s_add_u32 s16, s16, 196608
    s_cmp_eq_u32 s16, s18
    s_cselect_b32 s16, s17, s16
    s_cmp_lg_u32 s69, 0
    s_cbranch_scc1 nh_3057
    s_add_u32 s64, s27, 8192
    s_and_b32 s64, s64, 0x7fff
    s_mov_b32 m0, 18432
    s_add_u32 s64, s64, s26
    buffer_load_dwordx4 v249, s[80:83], s64 offen sc1 lds
nh_3057:
    s_add_u32 m0, s23, 18432
    s_nop 0
    buffer_load_dwordx4 v249, s[80:83], s20 offen offset:0 sc1 lds
    s_add_u32 m0, s23, 19456
    s_nop 0
    buffer_load_dwordx4 v249, s[80:83], s20 offen offset:1024 sc1 lds
    s_add_u32 s20, s20, 8192
    s_cmp_eq_u32 s20, s22
    s_cselect_b32 s20, s21, s20
    s_add_u32 m0, s19, 111232
    s_nop 0
    buffer_load_dwordx4 v10, s[8:11], s16 offen lds
    s_add_u32 m0, s19, 112256
    s_nop 0
    buffer_load_dwordx4 v11, s[8:11], s16 offen lds
    s_add_u32 m0, s19, 113280
    s_nop 0
    buffer_load_dwordx4 v12, s[8:11], s16 offen lds
    s_add_u32 s16, s16, 196608
    s_cmp_eq_u32 s16, s18
    s_cselect_b32 s16, s17, s16
    s_lshl_b32 s42, s70, 1
    s_add_u32 s42, s42, 5
    s_and_b32 s42, s42, 15
    s_mul_i32 s42, s42, 393216
    s_add_u32 s44, s40, s42
    s_addc_u32 s45, s41, 0
    s_load_dword s43, s[44:45], 0
    s_load_dword s43, s[44:45], 64
    s_load_dword s43, s[44:45], 2048
    s_load_dword s43, s[44:45], 2112
    s_load_dword s43, s[44:45], 4096
    s_load_dword s43, s[44:45], 4160
    s_waitcnt vmcnt(10)
    s_barrier
    s_cmp_lg_u32 s69, 1
    s_cbranch_scc1 nh_3058
    s_add_u32 s64, s27, 9216
    s_and_b32 s64, s64, 0x7fff
    s_mov_b32 m0, 19456
    s_add_u32 s64, s64, s26
    buffer_load_dwordx4 v249, s[80:83], s64 offen sc1 lds
nh_3058:
    s_add_u32 m0, s23, 19456
    s_nop 0
    buffer_load_dwordx4 v249, s[80:83], s20 offen offset:0 sc1 lds
    s_add_u32 m0, s23, 20480
    s_nop 0
    buffer_load_dwordx4 v249, s[80:83], s20 offen offset:1024 sc1 lds
    s_add_u32 s20, s20, 8192
    s_cmp_eq_u32 s20, s22
    s_cselect_b32 s20, s21, s20
    s_add_u32 m0, s19, 123648
    s_nop 0
    buffer_load_dwordx4 v10, s[8:11], s16 offen lds
    s_add_u32 m0, s19, 124672
    s_nop 0
    buffer_load_dwordx4 v11, s[8:11], s16 offen lds
    s_add_u32 m0, s19, 125696
    s_nop 0
    buffer_load_dwordx4 v12, s[8:11], s16 offen lds
    s_add_u32 s16, s16, 196608
    s_cmp_eq_u32 s16, s18
    s_cselect_b32 s16, s17, s16
    s_cmp_lg_u32 s69, 2
    s_cbranch_scc1 nh_3059
    s_add_u32 s64, s27, 10240
    s_and_b32 s64, s64, 0x7fff
    s_mov_b32 m0, 36864
    s_add_u32 s64, s64, s26
    buffer_load_dwordx4 v249, s[80:83], s64 offen sc1 lds
nh_3059:
    s_add_u32 m0, s23, 36864
    s_nop 0
    buffer_load_dwordx4 v249, s[80:83], s20 offen offset:0 sc1 lds
    s_add_u32 m0, s23, 37888
    s_nop 0
    buffer_load_dwordx4 v249, s[80:83], s20 offen offset:1024 sc1 lds
    s_add_u32 s20, s20, 8192
    s_cmp_eq_u32 s20, s22
    s_cselect_b32 s20, s21, s20
    s_add_u32 m0, s19, 136064
    s_nop 0
    buffer_load_dwordx4 v10, s[8:11], s16 offen lds
    s_add_u32 m0, s19, 137088
    s_nop 0
    buffer_load_dwordx4 v11, s[8:11], s16 offen lds
    s_add_u32 m0, s19, 138112
    s_nop 0
    buffer_load_dwordx4 v12, s[8:11], s16 offen lds
    s_add_u32 s16, s16, 196608
    s_cmp_eq_u32 s16, s18
    s_cselect_b32 s16, s17, s16
    s_cmp_lg_u32 s69, 3
    s_cbranch_scc1 nh_3060
    s_add_u32 s64, s27, 11264
    s_and_b32 s64, s64, 0x7fff
    s_mov_b32 m0, 37888
    s_add_u32 s64, s64, s26
    buffer_load_dwordx4 v249, s[80:83], s64 offen sc1 lds
nh_3060:
    s_add_u32 m0, s23, 37888
    s_nop 0
    buffer_load_dwordx4 v249, s[80:83], s20 offen offset:0 sc1 lds
    s_add_u32 m0, s23, 38912
    s_nop 0
    buffer_load_dwordx4 v249, s[80:83], s20 offen offset:1024 sc1 lds
    s_add_u32 s20, s20, 8192
    s_cmp_eq_u32 s20, s22
    s_cselect_b32 s20, s21, s20
    s_lshl_b32 s42, s70, 1
    s_add_u32 s42, s42, 6
    s_and_b32 s42, s42, 15
    s_mul_i32 s42, s42, 393216
    s_add_u32 s44, s40, s42
    s_addc_u32 s45, s41, 0
    s_load_dword s43, s[44:45], 0
    s_load_dword s43, s[44:45], 64
    s_load_dword s43, s[44:45], 2048
    s_load_dword s43, s[44:45], 2112
    s_load_dword s43, s[44:45], 4096
    s_load_dword s43, s[44:45], 4160
    s_waitcnt vmcnt(12)
    s_barrier
    s_add_u32 m0, s19, 73984
    s_nop 0
    buffer_load_dwordx4 v10, s[8:11], s16 offen lds
    s_add_u32 m0, s19, 75008
    s_nop 0
    buffer_load_dwordx4 v11, s[8:11], s16 offen lds
    s_add_u32 m0, s19, 76032
    s_nop 0
    buffer_load_dwordx4 v12, s[8:11], s16 offen lds
    s_add_u32 s16, s16, 196608
    s_cmp_eq_u32 s16, s18
    s_cselect_b32 s16, s17, s16
    s_cmp_lg_u32 s69, 0
    s_cbranch_scc1 nh_3061
    s_add_u32 s64, s27, 12288
    s_and_b32 s64, s64, 0x7fff
    s_mov_b32 m0, 55296
    s_add_u32 s64, s64, s26
    buffer_load_dwordx4 v249, s[80:83], s64 offen sc1 lds
nh_3061:
    s_add_u32 m0, s23, 55296
    s_nop 0
    buffer_load_dwordx4 v249, s[80:83], s20 offen offset:0 sc1 lds
    s_add_u32 m0, s23, 56320
    s_nop 0
    buffer_load_dwordx4 v249, s[80:83], s20 offen offset:1024 sc1 lds
    s_add_u32 s20, s20, 8192
    s_cmp_eq_u32 s20, s22
    s_cselect_b32 s20, s21, s20
    s_add_u32 m0, s19, 86400
    s_nop 0
    buffer_load_dwordx4 v10, s[8:11], s16 offen lds
    s_add_u32 m0, s19, 87424
    s_nop 0
    buffer_load_dwordx4 v11, s[8:11], s16 offen lds
    s_add_u32 m0, s19, 88448
    s_nop 0
    buffer_load_dwordx4 v12, s[8:11], s16 offen lds
    s_add_u32 s16, s16, 196608
    s_cmp_eq_u32 s16, s18
    s_cselect_b32 s16, s17, s16
    s_cmp_lg_u32 s69, 1
    s_cbranch_scc1 nh_3062
    s_add_u32 s64, s27, 13312
    s_and_b32 s64, s64, 0x7fff
    s_mov_b32 m0, 56320
    s_add_u32 s64, s64, s26
    buffer_load_dwordx4 v249, s[80:83], s64 offen sc1 lds
nh_3062:
    s_add_u32 m0, s23, 56320
    s_nop 0
    buffer_load_dwordx4 v249, s[80:83], s20 offen offset:0 sc1 lds
    s_add_u32 m0, s23, 57344
    s_nop 0
    buffer_load_dwordx4 v249, s[80:83], s20 offen offset:1024 sc1 lds
    s_add_u32 s20, s20, 8192
    s_cmp_eq_u32 s20, s22
    s_cselect_b32 s20, s21, s20
    s_lshl_b32 s42, s70, 1
    s_add_u32 s42, s42, 7
    s_and_b32 s42, s42, 15
    s_mul_i32 s42, s42, 393216
    s_add_u32 s44, s40, s42
    s_addc_u32 s45, s41, 0
    s_load_dword s43, s[44:45], 0
    s_load_dword s43, s[44:45], 64
    s_load_dword s43, s[44:45], 2048
    s_load_dword s43, s[44:45], 2112
    s_load_dword s43, s[44:45], 4096
    s_load_dword s43, s[44:45], 4160
    s_waitcnt vmcnt(12)
    s_barrier
    s_add_u32 m0, s19, 98816
    s_nop 0
    buffer_load_dwordx4 v10, s[8:11], s16 offen lds
    s_add_u32 m0, s19, 99840
    s_nop 0
    buffer_load_dwordx4 v11, s[8:11], s16 offen lds
    s_add_u32 m0, s19, 100864
    s_nop 0
    buffer_load_dwordx4 v12, s[8:11], s16 offen lds
    s_add_u32 s16, s16, 196608
    s_cmp_eq_u32 s16, s18
    s_cselect_b32 s16, s17, s16
    s_cmp_lg_u32 s69, 2
    s_cbranch_scc1 nh_3063
    s_add_u32 s64, s27, 14336
    s_and_b32 s64, s64, 0x7fff
    s_mov_b32 m0, 0
    s_add_u32 s64, s64, s26
    buffer_load_dwordx4 v249, s[80:83], s64 offen sc1 lds
nh_3063:
    s_add_u32 m0, s23, 0
    s_nop 0
    buffer_load_dwordx4 v249, s[80:83], s20 offen offset:0 sc1 lds
    s_add_u32 m0, s23, 1024
    s_nop 0
    buffer_load_dwordx4 v249, s[80:83], s20 offen offset:1024 sc1 lds
    s_add_u32 s20, s20, 8192
    s_cmp_eq_u32 s20, s22
    s_cselect_b32 s20, s21, s20
    s_add_u32 m0, s19, 111232
    s_nop 0
    buffer_load_dwordx4 v10, s[8:11], s16 offen lds
    s_add_u32 m0, s19, 112256
    s_nop 0
    buffer_load_dwordx4 v11, s[8:11], s16 offen lds
    s_add_u32 m0, s19, 113280
    s_nop 0
    buffer_load_dwordx4 v12, s[8:11], s16 offen lds
    s_add_u32 s16, s16, 196608
    s_cmp_eq_u32 s16, s18
    s_cselect_b32 s16, s17, s16
    s_cmp_lg_u32 s69, 3
    s_cbranch_scc1 nh_3064
    s_add_u32 s64, s27, 15360
    s_and_b32 s64, s64, 0x7fff
    s_mov_b32 m0, 1024
    s_add_u32 s64, s64, s26
    buffer_load_dwordx4 v249, s[80:83], s64 offen sc1 lds
nh_3064:
    s_add_u32 m0, s23, 1024
    s_nop 0
    buffer_load_dwordx4 v249, s[80:83], s20 offen offset:0 sc1 lds
    s_add_u32 m0, s23, 2048
    s_nop 0
    buffer_load_dwordx4 v249, s[80:83], s20 offen offset:1024 sc1 lds
    s_add_u32 s20, s20, 8192
    s_cmp_eq_u32 s20, s22
    s_cselect_b32 s20, s21, s20
    s_lshl_b32 s42, s70, 1
    s_add_u32 s42, s42, 8
    s_and_b32 s42, s42, 15
    s_mul_i32 s42, s42, 393216
    s_add_u32 s44, s40, s42
    s_addc_u32 s45, s41, 0
    s_load_dword s43, s[44:45], 0
    s_load_dword s43, s[44:45], 64
    s_load_dword s43, s[44:45], 2048
    s_load_dword s43, s[44:45], 2112
    s_load_dword s43, s[44:45], 4096
    s_load_dword s43, s[44:45], 4160
    s_lshl_b32 s64, s28, 12
    s_add_u32 s64, s64, 73924608
    v_lshlrev_b32 v81, 4, v252
    v_lshl_add_u32 v81, v251, 10, v81
    s_cmp_lg_u32 s69, 3
    s_cbranch_scc1 hs_3065
    buffer_load_dwordx4 v[64:67], v81, s[80:83], s64 offen offset:0 sc1
    buffer_load_dwordx4 v[68:71], v81, s[80:83], s64 offen offset:256 sc1
    buffer_load_dwordx4 v[72:75], v81, s[80:83], s64 offen offset:512 sc1
    buffer_load_dwordx4 v[76:79], v81, s[80:83], s64 offen offset:768 sc1
hs_3065:
    s_lshl_b32 s29, s73, 15
    s_lshl_b32 s65, s69, 9
    s_add_u32 s29, s29, s65
    s_add_u32 s29, s29, 71827456
    v_and_b32 v80, 31, v250
    v_lshlrev_b32 v80, 4, v80
    v_lshrrev_b32 v253, 5, v250
    v_lshl_add_u32 v80, v253, 14, v80
    s_waitcnt vmcnt(12)
    s_barrier
    s_add_u32 m0, s19, 123648
    s_nop 0
    buffer_load_dwordx4 v10, s[8:11], s16 offen lds
    s_add_u32 m0, s19, 124672
    s_nop 0
    buffer_load_dwordx4 v11, s[8:11], s16 offen lds
    s_add_u32 m0, s19, 125696
    s_nop 0
    buffer_load_dwordx4 v12, s[8:11], s16 offen lds
    s_add_u32 s16, s16, 196608
    s_cmp_eq_u32 s16, s18
    s_cselect_b32 s16, s17, s16
    s_cmp_lg_u32 s69, 0
    s_cbranch_scc1 nh_3066
    s_add_u32 s64, s27, 16384
    s_and_b32 s64, s64, 0x7fff
    s_mov_b32 m0, 18432
    s_add_u32 s64, s64, s26
    buffer_load_dwordx4 v249, s[80:83], s64 offen sc1 lds
nh_3066:
    s_add_u32 m0, s23, 18432
    s_nop 0
    buffer_load_dwordx4 v249, s[80:83], s20 offen offset:0 sc1 lds
    s_add_u32 m0, s23, 19456
    s_nop 0
    buffer_load_dwordx4 v249, s[80:83], s20 offen offset:1024 sc1 lds
    s_add_u32 s20, s20, 8192
    s_cmp_eq_u32 s20, s22
    s_cselect_b32 s20, s21, s20
    s_add_u32 m0, s19, 136064
    s_nop 0
    buffer_load_dwordx4 v10, s[8:11], s16 offen lds
    s_add_u32 m0, s19, 137088
    s_nop 0
    buffer_load_dwordx4 v11, s[8:11], s16 offen lds
    s_add_u32 m0, s19, 138112
    s_nop 0
    buffer_load_dwordx4 v12, s[8:11], s16 offen lds
    s_add_u32 s16, s16, 196608
    s_cmp_eq_u32 s16, s18
    s_cselect_b32 s16, s17, s16
    s_cmp_lg_u32 s69, 1
    s_cbranch_scc1 nh_3067
    s_add_u32 s64, s27, 17408
    s_and_b32 s64, s64, 0x7fff
    s_mov_b32 m0, 19456
    s_add_u32 s64, s64, s26
    buffer_load_dwordx4 v249, s[80:83], s64 offen sc1 lds
nh_3067:
    s_add_u32 m0, s23, 19456
    s_nop 0
    buffer_load_dwordx4 v249, s[80:83], s20 offen offset:0 sc1 lds
    s_add_u32 m0, s23, 20480
    s_nop 0
    buffer_load_dwordx4 v249, s[80:83], s20 offen offset:1024 sc1 lds
    s_add_u32 s20, s20, 8192
    s_cmp_eq_u32 s20, s22
    s_cselect_b32 s20, s21, s20
    s_lshl_b32 s42, s70, 1
    s_add_u32 s42, s42, 9
    s_and_b32 s42, s42, 15
    s_mul_i32 s42, s42, 393216
    s_add_u32 s44, s40, s42
    s_addc_u32 s45, s41, 0
    s_load_dword s43, s[44:45], 0
    s_load_dword s43, s[44:45], 64
    s_load_dword s43, s[44:45], 2048
    s_load_dword s43, s[44:45], 2112
    s_load_dword s43, s[44:45], 4096
    s_load_dword s43, s[44:45], 4160
    buffer_load_dwordx4 v[32:35], v80, s[80:83], s29 offen offset:0 sc1
    buffer_load_dwordx4 v[36:39], v80, s[80:83], s29 offen offset:2048 sc1
    s_add_u32 s29, s29, 4096
    s_waitcnt vmcnt(14)
    s_barrier
    s_add_u32 m0, s19, 73984
    s_nop 0
    buffer_load_dwordx4 v10, s[8:11], s16 offen lds
    s_add_u32 m0, s19, 75008
    s_nop 0
    buffer_load_dwordx4 v11, s[8:11], s16 offen lds
    s_add_u32 m0, s19, 76032
    s_nop 0
    buffer_load_dwordx4 v12, s[8:11], s16 offen lds
    s_add_u32 s16, s16, 196608
    s_cmp_eq_u32 s16, s18
    s_cselect_b32 s16, s17, s16
    s_cmp_lg_u32 s69, 2
    s_cbranch_scc1 nh_3068
    s_add_u32 s64, s27, 18432
    s_and_b32 s64, s64, 0x7fff
    s_mov_b32 m0, 36864
    s_add_u32 s64, s64, s26
    buffer_load_dwordx4 v249, s[80:83], s64 offen sc1 lds
nh_3068:
    s_add_u32 m0, s23, 36864
    s_nop 0
    buffer_load_dwordx4 v249, s[80:83], s20 offen offset:0 sc1 lds
    s_add_u32 m0, s23, 37888
    s_nop 0
    buffer_load_dwordx4 v249, s[80:83], s20 offen offset:1024 sc1 lds
    s_add_u32 s20, s20, 8192
    s_cmp_eq_u32 s20, s22
    s_cselect_b32 s20, s21, s20
    s_add_u32 m0, s19, 86400
    s_nop 0
    buffer_load_dwordx4 v10, s[8:11], s16 offen lds
    s_add_u32 m0, s19, 87424
    s_nop 0
    buffer_load_dwordx4 v11, s[8:11], s16 offen lds
    s_add_u32 m0, s19, 88448
    s_nop 0
    buffer_load_dwordx4 v12, s[8:11], s16 offen lds
    s_add_u32 s16, s16, 196608
    s_cmp_eq_u32 s16, s18
    s_cselect_b32 s16, s17, s16
    s_cmp_lg_u32 s69, 3
    s_cbranch_scc1 nh_3069
    s_add_u32 s64, s27, 19456
    s_and_b32 s64, s64, 0x7fff
    s_mov_b32 m0, 37888
    s_add_u32 s64, s64, s26
    buffer_load_dwordx4 v249, s[80:83], s64 offen sc1 lds
nh_3069:
    s_add_u32 m0, s23, 37888
    s_nop 0
    buffer_load_dwordx4 v249, s[80:83], s20 offen offset:0 sc1 lds
    s_add_u32 m0, s23, 38912
    s_nop 0
    buffer_load_dwordx4 v249, s[80:83], s20 offen offset:1024 sc1 lds
    s_add_u32 s20, s20, 8192
    s_cmp_eq_u32 s20, s22
    s_cselect_b32 s20, s21, s20
    s_lshl_b32 s42, s70, 1
    s_add_u32 s42, s42, 10
    s_and_b32 s42, s42, 15
    s_mul_i32 s42, s42, 393216
    s_add_u32 s44, s40, s42
    s_addc_u32 s45, s41, 0
    s_load_dword s43, s[44:45], 0
    s_load_dword s43, s[44:45], 64
    s_load_dword s43, s[44:45], 2048
    s_load_dword s43, s[44:45], 2112
    s_load_dword s43, s[44:45], 4096
    s_load_dword s43, s[44:45], 4160
    buffer_load_dwordx4 v[40:43], v80, s[80:83], s29 offen offset:0 sc1
    buffer_load_dwordx4 v[44:47], v80, s[80:83], s29 offen offset:2048 sc1
    s_add_u32 s29, s29, 4096
    s_waitcnt vmcnt(16)
    s_barrier
    s_add_u32 m0, s19, 98816
    s_nop 0
    buffer_load_dwordx4 v10, s[8:11], s16 offen lds
    s_add_u32 m0, s19, 99840
    s_nop 0
    buffer_load_dwordx4 v11, s[8:11], s16 offen lds
    s_add_u32 m0, s19, 100864
    s_nop 0
    buffer_load_dwordx4 v12, s[8:11], s16 offen lds
    s_add_u32 s16, s16, 196608
    s_cmp_eq_u32 s16, s18
    s_cselect_b32 s16, s17, s16
    s_cmp_lg_u32 s69, 0
    s_cbranch_scc1 nh_3070
    s_add_u32 s64, s27, 20480
    s_and_b32 s64, s64, 0x7fff
    s_mov_b32 m0, 55296
    s_add_u32 s64, s64, s26
    buffer_load_dwordx4 v249, s[80:83], s64 offen sc1 lds
nh_3070:
    s_add_u32 m0, s23, 55296
    s_nop 0
    buffer_load_dwordx4 v249, s[80:83], s20 offen offset:0 sc1 lds
    s_add_u32 m0, s23, 56320
    s_nop 0
    buffer_load_dwordx4 v249, s[80:83], s20 offen offset:1024 sc1 lds
    s_add_u32 s20, s20, 8192
    s_cmp_eq_u32 s20, s22
    s_cselect_b32 s20, s21, s20
    s_add_u32 m0, s19, 111232
    s_nop 0
    buffer_load_dwordx4 v10, s[8:11], s16 offen lds
    s_add_u32 m0, s19, 112256
    s_nop 0
    buffer_load_dwordx4 v11, s[8:11], s16 offen lds
    s_add_u32 m0, s19, 113280
    s_nop 0
    buffer_load_dwordx4 v12, s[8:11], s16 offen lds
    s_add_u32 s16, s16, 196608
    s_cmp_eq_u32 s16, s18
    s_cselect_b32 s16, s17, s16
    s_cmp_lg_u32 s69, 1
    s_cbranch_scc1 nh_3071
    s_add_u32 s64, s27, 21504
    s_and_b32 s64, s64, 0x7fff
    s_mov_b32 m0, 56320
    s_add_u32 s64, s64, s26
    buffer_load_dwordx4 v249, s[80:83], s64 offen sc1 lds
nh_3071:
    s_add_u32 m0, s23, 56320
    s_nop 0
    buffer_load_dwordx4 v249, s[80:83], s20 offen offset:0 sc1 lds
    s_add_u32 m0, s23, 57344
    s_nop 0
    buffer_load_dwordx4 v249, s[80:83], s20 offen offset:1024 sc1 lds
    s_add_u32 s20, s20, 8192
    s_cmp_eq_u32 s20, s22
    s_cselect_b32 s20, s21, s20
    s_lshl_b32 s42, s70, 1
    s_add_u32 s42, s42, 11
    s_and_b32 s42, s42, 15
    s_mul_i32 s42, s42, 393216
    s_add_u32 s44, s40, s42
    s_addc_u32 s45, s41, 0
    s_load_dword s43, s[44:45], 0
    s_load_dword s43, s[44:45], 64
    s_load_dword s43, s[44:45], 2048
    s_load_dword s43, s[44:45], 2112
    s_load_dword s43, s[44:45], 4096
    s_load_dword s43, s[44:45], 4160
    buffer_load_dwordx4 v[48:51], v80, s[80:83], s29 offen offset:0 sc1
    buffer_load_dwordx4 v[52:55], v80, s[80:83], s29 offen offset:2048 sc1
    s_add_u32 s29, s29, 4096
    s_waitcnt vmcnt(16)
    s_barrier
    s_add_u32 m0, s19, 123648
    s_nop 0
    buffer_load_dwordx4 v10, s[8:11], s16 offen lds
    s_add_u32 m0, s19, 124672
    s_nop 0
    buffer_load_dwordx4 v11, s[8:11], s16 offen lds
    s_add_u32 m0, s19, 125696
    s_nop 0
    buffer_load_dwordx4 v12, s[8:11], s16 offen lds
    s_add_u32 s16, s16, 196608
    s_cmp_eq_u32 s16, s18
    s_cselect_b32 s16, s17, s16
    s_cmp_lg_u32 s69, 2
    s_cbranch_scc1 nh_3072
    s_add_u32 s64, s27, 22528
    s_and_b32 s64, s64, 0x7fff
    s_mov_b32 m0, 0
    s_add_u32 s64, s64, s26
    buffer_load_dwordx4 v249, s[80:83], s64 offen sc1 lds
nh_3072:
    s_add_u32 m0, s23, 0
    s_nop 0
    buffer_load_dwordx4 v249, s[80:83], s20 offen offset:0 sc1 lds
    s_add_u32 m0, s23, 1024
    s_nop 0
    buffer_load_dwordx4 v249, s[80:83], s20 offen offset:1024 sc1 lds
    s_add_u32 s20, s20, 8192
    s_cmp_eq_u32 s20, s22
    s_cselect_b32 s20, s21, s20
    s_add_u32 m0, s19, 136064
    s_nop 0
    buffer_load_dwordx4 v10, s[8:11], s16 offen lds
    s_add_u32 m0, s19, 137088
    s_nop 0
    buffer_load_dwordx4 v11, s[8:11], s16 offen lds
    s_add_u32 m0, s19, 138112
    s_nop 0
    buffer_load_dwordx4 v12, s[8:11], s16 offen lds
    s_add_u32 s16, s16, 196608
    s_cmp_eq_u32 s16, s18
    s_cselect_b32 s16, s17, s16
    s_cmp_lg_u32 s69, 3
    s_cbranch_scc1 nh_3073
    s_add_u32 s64, s27, 23552
    s_and_b32 s64, s64, 0x7fff
    s_mov_b32 m0, 1024
    s_add_u32 s64, s64, s26
    buffer_load_dwordx4 v249, s[80:83], s64 offen sc1 lds
nh_3073:
    s_add_u32 m0, s23, 1024
    s_nop 0
    buffer_load_dwordx4 v249, s[80:83], s20 offen offset:0 sc1 lds
    s_add_u32 m0, s23, 2048
    s_nop 0
    buffer_load_dwordx4 v249, s[80:83], s20 offen offset:1024 sc1 lds
    s_add_u32 s20, s20, 8192
    s_cmp_eq_u32 s20, s22
    s_cselect_b32 s20, s21, s20
    s_lshl_b32 s42, s70, 1
    s_add_u32 s42, s42, 12
    s_and_b32 s42, s42, 15
    s_mul_i32 s42, s42, 393216
    s_add_u32 s44, s40, s42
    s_addc_u32 s45, s41, 0
    s_load_dword s43, s[44:45], 0
    s_load_dword s43, s[44:45], 64
    s_load_dword s43, s[44:45], 2048
    s_load_dword s43, s[44:45], 2112
    s_load_dword s43, s[44:45], 4096
    s_load_dword s43, s[44:45], 4160
    buffer_load_dwordx4 v[56:59], v80, s[80:83], s29 offen offset:0 sc1
    buffer_load_dwordx4 v[60:63], v80, s[80:83], s29 offen offset:2048 sc1
    s_add_u32 s29, s29, 4096
    s_waitcnt vmcnt(16)
    s_barrier
    s_add_u32 m0, s19, 73984
    s_nop 0
    buffer_load_dwordx4 v10, s[8:11], s16 offen lds
    s_add_u32 m0, s19, 75008
    s_nop 0
    buffer_load_dwordx4 v11, s[8:11], s16 offen lds
    s_add_u32 m0, s19, 76032
    s_nop 0
    buffer_load_dwordx4 v12, s[8:11], s16 offen lds
    s_add_u32 s16, s16, 196608
    s_cmp_eq_u32 s16, s18
    s_cselect_b32 s16, s17, s16
    s_cmp_lg_u32 s69, 0
    s_cbranch_scc1 nh_3074
    s_add_u32 s64, s27, 24576
    s_and_b32 s64, s64, 0x7fff
    s_mov_b32 m0, 18432
    s_add_u32 s64, s64, s26
    buffer_load_dwordx4 v249, s[80:83], s64 offen sc1 lds
nh_3074:
    s_add_u32 m0, s23, 18432
    s_nop 0
    buffer_load_dwordx4 v249, s[80:83], s20 offen offset:0 sc1 lds
    s_add_u32 m0, s23, 19456
    s_nop 0
    buffer_load_dwordx4 v249, s[80:83], s20 offen offset:1024 sc1 lds
    s_add_u32 s20, s20, 8192
    s_cmp_eq_u32 s20, s22
    s_cselect_b32 s20, s21, s20
    s_add_u32 m0, s19, 86400
    s_nop 0
    buffer_load_dwordx4 v10, s[8:11], s16 offen lds
    s_add_u32 m0, s19, 87424
    s_nop 0
    buffer_load_dwordx4 v11, s[8:11], s16 offen lds
    s_add_u32 m0, s19, 88448
    s_nop 0
    buffer_load_dwordx4 v12, s[8:11], s16 offen lds
    s_add_u32 s16, s16, 196608
    s_cmp_eq_u32 s16, s18
    s_cselect_b32 s16, s17, s16
    s_cmp_lg_u32 s69, 1
    s_cbranch_scc1 nh_3075
    s_add_u32 s64, s27, 25600
    s_and_b32 s64, s64, 0x7fff
    s_mov_b32 m0, 19456
    s_add_u32 s64, s64, s26
    buffer_load_dwordx4 v249, s[80:83], s64 offen sc1 lds
nh_3075:
    s_add_u32 m0, s23, 19456
    s_nop 0
    buffer_load_dwordx4 v249, s[80:83], s20 offen offset:0 sc1 lds
    s_add_u32 m0, s23, 20480
    s_nop 0
    buffer_load_dwordx4 v249, s[80:83], s20 offen offset:1024 sc1 lds
    s_add_u32 s20, s20, 8192
    s_cmp_eq_u32 s20, s22
    s_cselect_b32 s20, s21, s20
    s_lshl_b32 s42, s70, 1
    s_add_u32 s42, s42, 13
    s_and_b32 s42, s42, 15
    s_mul_i32 s42, s42, 393216
    s_add_u32 s44, s40, s42
    s_addc_u32 s45, s41, 0
    s_load_dword s43, s[44:45], 0
    s_load_dword s43, s[44:45], 64
    s_load_dword s43, s[44:45], 2048
    s_load_dword s43, s[44:45], 2112
    s_load_dword s43, s[44:45], 4096
    s_load_dword s43, s[44:45], 4160
    s_cmp_lg_u32 s69, 3
    s_cbranch_scc1 hf_3076
    v_pk_add_f32 v[64:65], v[64:65], v[72:73]
    v_pk_add_f32 v[66:67], v[66:67], v[74:75]
    v_pk_add_f32 v[68:69], v[68:69], v[76:77]
    v_pk_add_f32 v[70:71], v[70:71], v[78:79]
    v_pk_add_f32 v[64:65], v[64:65], v[68:69]
    v_pk_add_f32 v[66:67], v[66:67], v[70:71]
    v_add_f32 v64, v64, v66
    v_add_f32 v65, v65, v67
    v_mov_b32 v66, v64
    v_mov_b32 v67, v65
    s_nop 1
    v_permlane16_swap_b32 v64, v66
    v_permlane16_swap_b32 v65, v67
    v_add_f32 v64, v64, v66
    v_add_f32 v65, v65, v67
    v_mov_b32 v66, v64
    v_mov_b32 v67, v65
    s_nop 1
    v_permlane32_swap_b32 v64, v66
    v_permlane32_swap_b32 v65, v67
    v_add_f32 v64, v64, v66
    v_add_f32 v65, v65, v67
    v_mul_f32 v64, 0x3a800000, v64
    v_mul_f32 v65, 0x3a800000, v65
    v_fma_f32 v65, -v64, v64, v65
    v_max_f32 v65, 0, v65
    v_cvt_pk_bf16_f32 v64, v64, v64
    v_lshlrev_b32 v64, 16, v64
    v_cvt_pk_bf16_f32 v65, v65, v65
    v_lshlrev_b32 v65, 16, v65
    v_add_f32 v65, 0x3727c5ac, v65
    v_cvt_pk_bf16_f32 v65, v65, v65
    v_lshlrev_b32 v65, 16, v65
    v_sqrt_f32 v65, v65
    s_nop 0
    v_cvt_pk_bf16_f32 v65, v65, v65
    v_lshlrev_b32 v65, 16, v65
    v_rcp_f32 v65, v65
    s_nop 0
    v_lshlrev_b32 v81, 3, v252
    v_add_u32 v81, 159744, v81
    ds_write_b64 v81, v[64:65]
hf_3076:
    s_waitcnt vmcnt(14)
    s_barrier
    s_add_u32 m0, s19, 98816
    s_nop 0
    buffer_load_dwordx4 v10, s[8:11], s16 offen lds
    s_add_u32 m0, s19, 99840
    s_nop 0
    buffer_load_dwordx4 v11, s[8:11], s16 offen lds
    s_add_u32 m0, s19, 100864
    s_nop 0
    buffer_load_dwordx4 v12, s[8:11], s16 offen lds
    s_add_u32 s16, s16, 196608
    s_cmp_eq_u32 s16, s18
    s_cselect_b32 s16, s17, s16
    s_cmp_lg_u32 s69, 2
    s_cbranch_scc1 nh_3077
    s_add_u32 s64, s27, 26624
    s_and_b32 s64, s64, 0x7fff
    s_mov_b32 m0, 36864
    s_add_u32 s64, s64, s26
    buffer_load_dwordx4 v249, s[80:83], s64 offen sc1 lds
nh_3077:
    s_add_u32 m0, s23, 36864
    s_nop 0
    buffer_load_dwordx4 v249, s[80:83], s20 offen offset:0 sc1 lds
    s_add_u32 m0, s23, 37888
    s_nop 0
    buffer_load_dwordx4 v249, s[80:83], s20 offen offset:1024 sc1 lds
    s_add_u32 s20, s20, 8192
    s_cmp_eq_u32 s20, s22
    s_cselect_b32 s20, s21, s20
    s_add_u32 m0, s19, 111232
    s_nop 0
    buffer_load_dwordx4 v10, s[8:11], s16 offen lds
    s_add_u32 m0, s19, 112256
    s_nop 0
    buffer_load_dwordx4 v11, s[8:11], s16 offen lds
    s_add_u32 m0, s19, 113280
    s_nop 0
    buffer_load_dwordx4 v12, s[8:11], s16 offen lds
    s_add_u32 s16, s16, 196608
    s_cmp_eq_u32 s16, s18
    s_cselect_b32 s16, s17, s16
    s_cmp_lg_u32 s69, 3
    s_cbranch_scc1 nh_3078
    s_add_u32 s64, s27, 27648
    s_and_b32 s64, s64, 0x7fff
    s_mov_b32 m0, 37888
    s_add_u32 s64, s64, s26
    buffer_load_dwordx4 v249, s[80:83], s64 offen sc1 lds
nh_3078:
    s_add_u32 m0, s23, 37888
    s_nop 0
    buffer_load_dwordx4 v249, s[80:83], s20 offen offset:0 sc1 lds
    s_add_u32 m0, s23, 38912
    s_nop 0
    buffer_load_dwordx4 v249, s[80:83], s20 offen offset:1024 sc1 lds
    s_add_u32 s20, s20, 8192
    s_cmp_eq_u32 s20, s22
    s_cselect_b32 s20, s21, s20
    s_lshl_b32 s42, s70, 1
    s_add_u32 s42, s42, 14
    s_and_b32 s42, s42, 15
    s_mul_i32 s42, s42, 393216
    s_add_u32 s44, s40, s42
    s_addc_u32 s45, s41, 0
    s_load_dword s43, s[44:45], 0
    s_load_dword s43, s[44:45], 64
    s_load_dword s43, s[44:45], 2048
    s_load_dword s43, s[44:45], 2112
    s_load_dword s43, s[44:45], 4096
    s_load_dword s43, s[44:45], 4160
    s_waitcnt vmcnt(12)
    s_barrier
    s_add_u32 m0, s19, 123648
    s_nop 0
    buffer_load_dwordx4 v10, s[8:11], s16 offen lds
    s_add_u32 m0, s19, 124672
    s_nop 0
    buffer_load_dwordx4 v11, s[8:11], s16 offen lds
    s_add_u32 m0, s19, 125696
    s_nop 0
    buffer_load_dwordx4 v12, s[8:11], s16 offen lds
    s_add_u32 s16, s16, 196608
    s_cmp_eq_u32 s16, s18
    s_cselect_b32 s16, s17, s16
    s_cmp_lg_u32 s69, 0
    s_cbranch_scc1 nh_3079
    s_add_u32 s64, s27, 28672
    s_and_b32 s64, s64, 0x7fff
    s_mov_b32 m0, 55296
    s_add_u32 s64, s64, s26
    buffer_load_dwordx4 v249, s[80:83], s64 offen sc1 lds
nh_3079:
    s_add_u32 m0, s23, 55296
    s_nop 0
    buffer_load_dwordx4 v249, s[80:83], s20 offen offset:0 sc1 lds
    s_add_u32 m0, s23, 56320
    s_nop 0
    buffer_load_dwordx4 v249, s[80:83], s20 offen offset:1024 sc1 lds
    s_add_u32 s20, s20, 8192
    s_cmp_eq_u32 s20, s22
    s_cselect_b32 s20, s21, s20
    s_add_u32 m0, s19, 136064
    s_nop 0
    buffer_load_dwordx4 v10, s[8:11], s16 offen lds
    s_add_u32 m0, s19, 137088
    s_nop 0
    buffer_load_dwordx4 v11, s[8:11], s16 offen lds
    s_add_u32 m0, s19, 138112
    s_nop 0
    buffer_load_dwordx4 v12, s[8:11], s16 offen lds
    s_add_u32 s16, s16, 196608
    s_cmp_eq_u32 s16, s18
    s_cselect_b32 s16, s17, s16
    s_cmp_lg_u32 s69, 1
    s_cbranch_scc1 nh_3080
    s_add_u32 s64, s27, 29696
    s_and_b32 s64, s64, 0x7fff
    s_mov_b32 m0, 56320
    s_add_u32 s64, s64, s26
    buffer_load_dwordx4 v249, s[80:83], s64 offen sc1 lds
nh_3080:
    s_add_u32 m0, s23, 56320
    s_nop 0
    buffer_load_dwordx4 v249, s[80:83], s20 offen offset:0 sc1 lds
    s_add_u32 m0, s23, 57344
    s_nop 0
    buffer_load_dwordx4 v249, s[80:83], s20 offen offset:1024 sc1 lds
    s_add_u32 s20, s20, 8192
    s_cmp_eq_u32 s20, s22
    s_cselect_b32 s20, s21, s20
    s_lshl_b32 s42, s70, 1
    s_add_u32 s42, s42, 15
    s_and_b32 s42, s42, 15
    s_mul_i32 s42, s42, 393216
    s_add_u32 s44, s40, s42
    s_addc_u32 s45, s41, 0
    s_load_dword s43, s[44:45], 0
    s_load_dword s43, s[44:45], 64
    s_load_dword s43, s[44:45], 2048
    s_load_dword s43, s[44:45], 2112
    s_load_dword s43, s[44:45], 4096
    s_load_dword s43, s[44:45], 4160
    v_pk_add_f32 v[32:33], v[32:33], v[48:49]
    v_pk_add_f32 v[34:35], v[34:35], v[50:51]
    v_pk_add_f32 v[36:37], v[36:37], v[52:53]
    v_pk_add_f32 v[38:39], v[38:39], v[54:55]
    v_pk_add_f32 v[40:41], v[40:41], v[56:57]
    v_pk_add_f32 v[42:43], v[42:43], v[58:59]
    v_pk_add_f32 v[44:45], v[44:45], v[60:61]
    v_pk_add_f32 v[46:47], v[46:47], v[62:63]
    v_pk_add_f32 v[32:33], v[32:33], v[40:41]
    v_pk_add_f32 v[34:35], v[34:35], v[42:43]
    s_waitcnt vmcnt(12)
    s_barrier
    s_add_u32 m0, s19, 73984
    s_nop 0
    buffer_load_dwordx4 v10, s[8:11], s16 offen lds
    s_add_u32 m0, s19, 75008
    s_nop 0
    buffer_load_dwordx4 v11, s[8:11], s16 offen lds
    s_add_u32 m0, s19, 76032
    s_nop 0
    buffer_load_dwordx4 v12, s[8:11], s16 offen lds
    s_add_u32 s16, s16, 196608
    s_cmp_eq_u32 s16, s18
    s_cselect_b32 s16, s17, s16
    s_cmp_lg_u32 s69, 2
    s_cbranch_scc1 nh_3081
    s_add_u32 s64, s27, 30720
    s_and_b32 s64, s64, 0x7fff
    s_mov_b32 m0, 0
    s_add_u32 s64, s64, s26
    buffer_load_dwordx4 v249, s[80:83], s64 offen sc1 lds
nh_3081:
    s_add_u32 m0, s23, 0
    s_nop 0
    buffer_load_dwordx4 v249, s[80:83], s20 offen offset:0 sc1 lds
    s_add_u32 m0, s23, 1024
    s_nop 0
    buffer_load_dwordx4 v249, s[80:83], s20 offen offset:1024 sc1 lds
    s_add_u32 s20, s20, 8192
    s_cmp_eq_u32 s20, s22
    s_cselect_b32 s20, s21, s20
    s_add_u32 m0, s19, 86400
    s_nop 0
    buffer_load_dwordx4 v10, s[8:11], s16 offen lds
    s_add_u32 m0, s19, 87424
    s_nop 0
    buffer_load_dwordx4 v11, s[8:11], s16 offen lds
    s_add_u32 m0, s19, 88448
    s_nop 0
    buffer_load_dwordx4 v12, s[8:11], s16 offen lds
    s_add_u32 s16, s16, 196608
    s_cmp_eq_u32 s16, s18
    s_cselect_b32 s16, s17, s16
    s_cmp_lg_u32 s69, 3
    s_cbranch_scc1 nh_3082
    s_add_u32 s64, s27, 31744
    s_and_b32 s64, s64, 0x7fff
    s_mov_b32 m0, 1024
    s_add_u32 s64, s64, s26
    buffer_load_dwordx4 v249, s[80:83], s64 offen sc1 lds
nh_3082:
    s_add_u32 m0, s23, 1024
    s_nop 0
    buffer_load_dwordx4 v249, s[80:83], s20 offen offset:0 sc1 lds
    s_add_u32 m0, s23, 2048
    s_nop 0
    buffer_load_dwordx4 v249, s[80:83], s20 offen offset:1024 sc1 lds
    s_add_u32 s20, s20, 8192
    s_cmp_eq_u32 s20, s22
    s_cselect_b32 s20, s21, s20
    v_pk_add_f32 v[36:37], v[36:37], v[44:45]
    v_pk_add_f32 v[38:39], v[38:39], v[46:47]
    v_pk_add_f32 v[32:33], v[32:33], v[36:37]
    v_pk_add_f32 v[34:35], v[34:35], v[38:39]
    v_add_f32 v32, v32, v34
    v_add_f32 v33, v33, v35
    v_mov_b32 v34, v32
    v_mov_b32 v35, v33
    s_nop 1
    v_permlane32_swap_b32 v32, v34
    s_waitcnt vmcnt(12)
    s_barrier
    s_add_u32 m0, s19, 98816
    s_nop 0
    buffer_load_dwordx4 v10, s[8:11], s16 offen lds
    s_add_u32 m0, s19, 99840
    s_nop 0
    buffer_load_dwordx4 v11, s[8:11], s16 offen lds
    s_add_u32 m0, s19, 100864
    s_nop 0
    buffer_load_dwordx4 v12, s[8:11], s16 offen lds
    s_add_u32 s16, s16, 196608
    s_cmp_eq_u32 s16, s18
    s_cselect_b32 s16, s17, s16
    s_lshl_b32 s64, s73, 4
    s_add_u32 s64, s64, s67
    s_lshl_b32 s64, s64, 2
    s_add_u32 s64, s64, s69
    s_lshl_b32 s64, s64, 12
    s_lshl_b32 s65, s60, 22
    s_add_u32 s64, s64, s65
    s_add_u32 s64, s64, 12582912
    v_lshlrev_b32 v253, 7, v250
    s_mov_b64 exec, 0xffffffff
    buffer_load_dword v9, v253, s[80:83], s64 offen sc1
    s_mov_b64 exec, -1
    s_mov_b32 s12, s88
    s_mov_b32 s13, s89
    s_mov_b32 s14, 2097152
    s_mov_b32 s15, 0x00020000
    v_lshrrev_b32 v253, 3, v250
    v_lshlrev_b32 v253, 13, v253
    v_and_b32 v254, 7, v250
    v_lshl_add_u32 v253, v254, 4, v253
    s_lshl_b32 s64, s69, 11
    v_add_u32 v244, s64, v253
    s_mul_i32 s51, s69, 1056
    s_lshl_b32 s49, s72, 7
    s_lshl_b32 s64, s67, 17
    s_add_u32 s50, s49, 2097152
    s_add_u32 s48, s49, s64
    v_permlane32_swap_b32 v33, v35
    v_add_f32 v32, v32, v34
    v_add_f32 v33, v33, v35
    v_mul_f32 v32, 0x3a800000, v32
    v_mul_f32 v33, 0x3a800000, v33
    v_fma_f32 v33, -v32, v32, v33
    v_max_f32 v33, 0, v33
    v_cvt_pk_bf16_f32 v32, v32, v32
    v_lshlrev_b32 v32, 16, v32
    v_cvt_pk_bf16_f32 v33, v33, v33
    v_lshlrev_b32 v33, 16, v33
    v_add_f32 v33, 0x3727c5ac, v33
    v_cvt_pk_bf16_f32 v33, v33, v33
    v_lshlrev_b32 v33, 16, v33
    v_sqrt_f32 v33, v33
    s_nop 0
    s_add_u32 m0, s51, 116224
    s_nop 0
    buffer_load_dwordx4 v244, s[12:15], s48 offen lds
    s_add_u32 s48, s48, 65536
    s_cmp_eq_u32 s48, s50
    s_cselect_b32 s48, s49, s48
    s_waitcnt vmcnt(7)
    s_barrier
    v_cvt_pk_bf16_f32 v33, v33, v33
    v_lshlrev_b32 v33, 16, v33
    v_rcp_f32 v33, v33
    s_nop 0
    v_and_b32 v80, 31, v250
    s_lshl_b32 s29, s69, 8
    s_add_u32 s29, s29, 159872
    v_lshlrev_b32 v80, 3, v80
    v_add_u32 v80, s29, v80
    ds_write_b64 v80, v[32:33]
    s_add_u32 m0, s51, 120448
    s_nop 0
    buffer_load_dwordx4 v244, s[12:15], s48 offen lds
    s_add_u32 s48, s48, 65536
    s_cmp_eq_u32 s48, s50
    s_cselect_b32 s48, s49, s48
    s_add_u32 m0, s51, 124672
    s_nop 0
    buffer_load_dwordx4 v244, s[12:15], s48 offen lds
    s_add_u32 s48, s48, 65536
    s_cmp_eq_u32 s48, s50
    s_cselect_b32 s48, s49, s48
    s_add_u32 m0, s51, 128896
    s_nop 0
    buffer_load_dwordx4 v244, s[12:15], s48 offen lds
    s_add_u32 s48, s48, 65536
    s_cmp_eq_u32 s48, s50
    s_cselect_b32 s48, s49, s48
    s_add_u32 m0, s51, 133120
    s_nop 0
    buffer_load_dwordx4 v244, s[12:15], s48 offen lds
    s_add_u32 s48, s48, 65536
    s_cmp_eq_u32 s48, s50
    s_cselect_b32 s48, s49, s48
    s_add_u32 m0, s51, 137344
    s_nop 0
    buffer_load_dwordx4 v244, s[12:15], s48 offen lds
    s_add_u32 s48, s48, 65536
    s_cmp_eq_u32 s48, s50
    s_cselect_b32 s48, s49, s48
    s_add_u32 m0, s51, 141568
    s_nop 0
    buffer_load_dwordx4 v244, s[12:15], s48 offen lds
    s_add_u32 s48, s48, 65536
    s_cmp_eq_u32 s48, s50
    s_cselect_b32 s48, s49, s48
    s_add_u32 m0, s51, 145792
    s_nop 0
    buffer_load_dwordx4 v244, s[12:15], s48 offen lds
    s_add_u32 s48, s48, 65536
    s_cmp_eq_u32 s48, s50
    s_cselect_b32 s48, s49, s48
    s_add_u32 m0, s51, 150016
    s_nop 0
    buffer_load_dwordx4 v244, s[12:15], s48 offen lds
    s_add_u32 s48, s48, 65536
    s_cmp_eq_u32 s48, s50
    s_cselect_b32 s48, s49, s48
    s_waitcnt vmcnt(10)
    s_barrier
    s_add_u32 m0, s51, 154240
    s_nop 0
    buffer_load_dwordx4 v244, s[12:15], s48 offen lds
    s_add_u32 s48, s48, 65536
    s_cmp_eq_u32 s48, s50
    s_cselect_b32 s48, s49, s48
    s_add_u32 m0, s51, 65536
    s_nop 0
    buffer_load_dwordx4 v244, s[12:15], s48 offen lds
    s_add_u32 s48, s48, 65536
    s_cmp_eq_u32 s48, s50
    s_cselect_b32 s48, s49, s48
    s_add_u32 m0, s51, 69760
    s_nop 0
    buffer_load_dwordx4 v244, s[12:15], s48 offen lds
    s_add_u32 s48, s48, 65536
    s_cmp_eq_u32 s48, s50
    s_cselect_b32 s48, s49, s48
    s_add_u32 m0, s51, 73984
    s_nop 0
    buffer_load_dwordx4 v244, s[12:15], s48 offen lds
    s_add_u32 s48, s48, 65536
    s_cmp_eq_u32 s48, s50
    s_cselect_b32 s48, s49, s48
    s_add_u32 m0, s51, 78208
    s_nop 0
    buffer_load_dwordx4 v244, s[12:15], s48 offen lds
    s_add_u32 s48, s48, 65536
    s_cmp_eq_u32 s48, s50
    s_cselect_b32 s48, s49, s48
    s_add_u32 m0, s51, 82432
    s_nop 0
    buffer_load_dwordx4 v244, s[12:15], s48 offen lds
    s_add_u32 s48, s48, 65536
    s_cmp_eq_u32 s48, s50
    s_cselect_b32 s48, s49, s48
    s_add_u32 m0, s51, 86656
    s_nop 0
    buffer_load_dwordx4 v244, s[12:15], s48 offen lds
    s_add_u32 s48, s48, 65536
    s_cmp_eq_u32 s48, s50
    s_cselect_b32 s48, s49, s48
    s_add_u32 m0, s51, 90880
    s_nop 0
    buffer_load_dwordx4 v244, s[12:15], s48 offen lds
    s_add_u32 s48, s48, 65536
    s_cmp_eq_u32 s48, s50
    s_cselect_b32 s48, s49, s48
    s_waitcnt lgkmcnt(0)
    s_barrier
    s_add_u32 m0, s51, 95104
    s_nop 0
    buffer_load_dwordx4 v244, s[12:15], s48 offen lds
    s_add_u32 s48, s48, 65536
    s_cmp_eq_u32 s48, s50
    s_cselect_b32 s48, s49, s48
    s_add_u32 m0, s51, 99328
    s_nop 0
    buffer_load_dwordx4 v244, s[12:15], s48 offen lds
    s_add_u32 s48, s48, 65536
    s_cmp_eq_u32 s48, s50
    s_cselect_b32 s48, s49, s48
    s_add_u32 m0, s51, 103552
    s_nop 0
    buffer_load_dwordx4 v244, s[12:15], s48 offen lds
    s_add_u32 s48, s48, 65536
    s_cmp_eq_u32 s48, s50
    s_cselect_b32 s48, s49, s48
    s_add_u32 m0, s51, 107776
    s_nop 0
    buffer_load_dwordx4 v244, s[12:15], s48 offen lds
    s_add_u32 s48, s48, 65536
    s_cmp_eq_u32 s48, s50
    s_cselect_b32 s48, s49, s48
    s_add_u32 m0, s51, 112000
    s_nop 0
    buffer_load_dwordx4 v244, s[12:15], s48 offen lds
    s_add_u32 s48, s48, 65536
    s_cmp_eq_u32 s48, s50
    s_cselect_b32 s48, s49, s48
    s_branch L_g2
ar_19:
    v_mov_b32 v72, s32
    v_mov_b32 v73, 0
    s_mov_b64 exec, 1
    buffer_store_byte v72, v73, s[28:31], s2 offen sc0 sc1
    s_mov_b64 exec, -1
    s_branch ar_19_b
ar_21:
    v_mov_b32 v72, s32
    v_mov_b32 v73, 0
    s_mov_b64 exec, 1
    buffer_store_byte v72, v73, s[28:31], s2 offen sc0 sc1
    s_mov_b64 exec, -1
    s_branch ar_21_b
ar_23:
    v_mov_b32 v72, s32
    v_mov_b32 v73, 0
    s_mov_b64 exec, 1
    buffer_store_byte v72, v73, s[28:31], s2 offen sc0 sc1
    s_mov_b64 exec, -1
    s_branch ar_23_b
ar_25:
    v_mov_b32 v72, s32
    v_mov_b32 v73, 0
    s_mov_b64 exec, 1
    buffer_store_byte v72, v73, s[28:31], s2 offen sc0 sc1
    s_mov_b64 exec, -1
    s_branch ar_25_b
hs_34:
    buffer_load_dword v72, v71, s[28:31], 0 offen sc1
    s_sub_u32 s79, s79, 1
    s_cbranch_scc1 L_abort
    s_waitcnt vmcnt(0)
    v_and_b32 v73, 0x80808080, v72
    v_cmp_ne_u32 vcc, 0x80808080, v73
    s_cbranch_vccnz hs_34
    s_branch hs_34_b
pl_37_acq:
    buffer_inv sc1
    s_waitcnt vmcnt(0)
    s_branch pl_37_ok
cs_38:
    v_add_u32 v225, 28800, v224
    ds_read_b64_tr_b16 v[204:205], v225 offset:0
    ds_read_b64_tr_b16 v[206:207], v225 offset:3584
    ds_read_b64_tr_b16 v[208:209], v225 offset:32
    ds_read_b64_tr_b16 v[210:211], v225 offset:3616
    ds_read_b64_tr_b16 v[212:213], v225 offset:64
    ds_read_b64_tr_b16 v[214:215], v225 offset:3648
    ds_read_b64_tr_b16 v[216:217], v225 offset:96
    ds_read_b64_tr_b16 v[218:219], v225 offset:3680
    s_waitcnt lgkmcnt(0)
    v_mfma_f32_16x16x32_bf16 v[176:179], v[204:207], v[220:223], 0
    v_mfma_f32_16x16x32_bf16 v[180:183], v[208:211], v[220:223], 0
    v_mfma_f32_16x16x32_bf16 v[184:187], v[212:215], v[220:223], 0
    v_mfma_f32_16x16x32_bf16 v[188:191], v[216:219], v[220:223], 0
    s_nop 7
    ds_read_b64_tr_b16 v[204:205], v225 offset:128
    ds_read_b64_tr_b16 v[206:207], v225 offset:3712
    ds_read_b64_tr_b16 v[208:209], v225 offset:160
    ds_read_b64_tr_b16 v[210:211], v225 offset:3744
    ds_read_b64_tr_b16 v[212:213], v225 offset:192
    ds_read_b64_tr_b16 v[214:215], v225 offset:3776
    s_waitcnt lgkmcnt(0)
    v_mfma_f32_16x16x32_bf16 v[192:195], v[204:207], v[220:223], 0
    v_mfma_f32_16x16x32_bf16 v[196:199], v[208:211], v[220:223], 0
    v_mfma_f32_16x16x32_bf16 v[200:203], v[212:215], v[220:223], 0
    s_nop 7
    s_branch cs_38_b
cs_39:
    v_add_u32 v225, 57600, v224
    ds_read_b64_tr_b16 v[204:205], v225 offset:0
    ds_read_b64_tr_b16 v[206:207], v225 offset:3584
    ds_read_b64_tr_b16 v[208:209], v225 offset:32
    ds_read_b64_tr_b16 v[210:211], v225 offset:3616
    ds_read_b64_tr_b16 v[212:213], v225 offset:64
    ds_read_b64_tr_b16 v[214:215], v225 offset:3648
    ds_read_b64_tr_b16 v[216:217], v225 offset:96
    ds_read_b64_tr_b16 v[218:219], v225 offset:3680
    s_waitcnt lgkmcnt(0)
    v_mfma_f32_16x16x32_bf16 v[176:179], v[204:207], v[220:223], v[176:179]
    v_mfma_f32_16x16x32_bf16 v[180:183], v[208:211], v[220:223], v[180:183]
    v_mfma_f32_16x16x32_bf16 v[184:187], v[212:215], v[220:223], v[184:187]
    v_mfma_f32_16x16x32_bf16 v[188:191], v[216:219], v[220:223], v[188:191]
    s_nop 7
    ds_read_b64_tr_b16 v[204:205], v225 offset:128
    ds_read_b64_tr_b16 v[206:207], v225 offset:3712
    ds_read_b64_tr_b16 v[208:209], v225 offset:160
    ds_read_b64_tr_b16 v[210:211], v225 offset:3744
    ds_read_b64_tr_b16 v[212:213], v225 offset:192
    ds_read_b64_tr_b16 v[214:215], v225 offset:3776
    s_waitcnt lgkmcnt(0)
    v_mfma_f32_16x16x32_bf16 v[192:195], v[204:207], v[220:223], v[192:195]
    v_mfma_f32_16x16x32_bf16 v[196:199], v[208:211], v[220:223], v[196:199]
    v_mfma_f32_16x16x32_bf16 v[200:203], v[212:215], v[220:223], v[200:203]
    s_nop 7
    s_lshl_b32 s64, s73, 1
    s_and_b32 s65, s3, 1
    s_add_u32 s64, s64, s65
    s_mul_i32 s64, s64, 14336
    s_mul_i32 s65, s74, 896
    s_add_u32 s64, s64, s65
    s_lshr_b32 s65, s69, 1
    s_mul_i32 s65, s65, 448
    s_add_u32 s64, s64, s65
    s_add_u32 s64, s64, 74448896
    v_lshlrev_b32 v225, 4, v251
    s_mov_b32 exec_lo, 0x00010001
    s_mov_b32 exec_hi, 0x00010001
    buffer_store_dwordx4 v[176:179], v225, s[80:83], s64 offen offset:0 sc0 sc1
    buffer_store_dwordx4 v[180:183], v225, s[80:83], s64 offen offset:64 sc0 sc1
    buffer_store_dwordx4 v[184:187], v225, s[80:83], s64 offen offset:128 sc0 sc1
    buffer_store_dwordx4 v[188:191], v225, s[80:83], s64 offen offset:192 sc0 sc1
    buffer_store_dwordx4 v[192:195], v225, s[80:83], s64 offen offset:256 sc0 sc1
    buffer_store_dwordx4 v[196:199], v225, s[80:83], s64 offen offset:320 sc0 sc1
    buffer_store_dwordx4 v[200:203], v225, s[80:83], s64 offen offset:384 sc0 sc1
    s_mov_b64 exec, -1
    s_nop 3
    s_branch cs_39_b
pl_540_acq:
    buffer_inv sc1
    s_waitcnt vmcnt(0)
    s_branch pl_540_ok
cs_541:
    v_add_u32 v225, 86400, v224
    ds_read_b64_tr_b16 v[204:205], v225 offset:0
    ds_read_b64_tr_b16 v[206:207], v225 offset:3584
    ds_read_b64_tr_b16 v[208:209], v225 offset:32
    ds_read_b64_tr_b16 v[210:211], v225 offset:3616
    ds_read_b64_tr_b16 v[212:213], v225 offset:64
    ds_read_b64_tr_b16 v[214:215], v225 offset:3648
    ds_read_b64_tr_b16 v[216:217], v225 offset:96
    ds_read_b64_tr_b16 v[218:219], v225 offset:3680
    s_waitcnt lgkmcnt(0)
    v_mfma_f32_16x16x32_bf16 v[176:179], v[204:207], v[220:223], 0
    v_mfma_f32_16x16x32_bf16 v[180:183], v[208:211], v[220:223], 0
    v_mfma_f32_16x16x32_bf16 v[184:187], v[212:215], v[220:223], 0
    v_mfma_f32_16x16x32_bf16 v[188:191], v[216:219], v[220:223], 0
    s_nop 7
    ds_read_b64_tr_b16 v[204:205], v225 offset:128
    ds_read_b64_tr_b16 v[206:207], v225 offset:3712
    ds_read_b64_tr_b16 v[208:209], v225 offset:160
    ds_read_b64_tr_b16 v[210:211], v225 offset:3744
    ds_read_b64_tr_b16 v[212:213], v225 offset:192
    ds_read_b64_tr_b16 v[214:215], v225 offset:3776
    s_waitcnt lgkmcnt(0)
    v_mfma_f32_16x16x32_bf16 v[192:195], v[204:207], v[220:223], 0
    v_mfma_f32_16x16x32_bf16 v[196:199], v[208:211], v[220:223], 0
    v_mfma_f32_16x16x32_bf16 v[200:203], v[212:215], v[220:223], 0
    s_nop 7
    s_branch cs_541_b
cs_542:
    v_add_u32 v225, 0, v224
    ds_read_b64_tr_b16 v[204:205], v225 offset:0
    ds_read_b64_tr_b16 v[206:207], v225 offset:3584
    ds_read_b64_tr_b16 v[208:209], v225 offset:32
    ds_read_b64_tr_b16 v[210:211], v225 offset:3616
    ds_read_b64_tr_b16 v[212:213], v225 offset:64
    ds_read_b64_tr_b16 v[214:215], v225 offset:3648
    ds_read_b64_tr_b16 v[216:217], v225 offset:96
    ds_read_b64_tr_b16 v[218:219], v225 offset:3680
    s_waitcnt lgkmcnt(0)
    v_mfma_f32_16x16x32_bf16 v[176:179], v[204:207], v[220:223], v[176:179]
    v_mfma_f32_16x16x32_bf16 v[180:183], v[208:211], v[220:223], v[180:183]
    v_mfma_f32_16x16x32_bf16 v[184:187], v[212:215], v[220:223], v[184:187]
    v_mfma_f32_16x16x32_bf16 v[188:191], v[216:219], v[220:223], v[188:191]
    s_nop 7
    ds_read_b64_tr_b16 v[204:205], v225 offset:128
    ds_read_b64_tr_b16 v[206:207], v225 offset:3712
    ds_read_b64_tr_b16 v[208:209], v225 offset:160
    ds_read_b64_tr_b16 v[210:211], v225 offset:3744
    ds_read_b64_tr_b16 v[212:213], v225 offset:192
    ds_read_b64_tr_b16 v[214:215], v225 offset:3776
    s_waitcnt lgkmcnt(0)
    v_mfma_f32_16x16x32_bf16 v[192:195], v[204:207], v[220:223], v[192:195]
    v_mfma_f32_16x16x32_bf16 v[196:199], v[208:211], v[220:223], v[196:199]
    v_mfma_f32_16x16x32_bf16 v[200:203], v[212:215], v[220:223], v[200:203]
    s_nop 7
    s_lshl_b32 s64, s73, 1
    s_and_b32 s65, s3, 1
    s_add_u32 s64, s64, s65
    s_mul_i32 s64, s64, 14336
    s_mul_i32 s65, s74, 896
    s_add_u32 s64, s64, s65
    s_lshr_b32 s65, s69, 1
    s_mul_i32 s65, s65, 448
    s_add_u32 s64, s64, s65
    s_add_u32 s64, s64, 74448896
    v_lshlrev_b32 v225, 4, v251
    s_mov_b32 exec_lo, 0x00010001
    s_mov_b32 exec_hi, 0x00010001
    buffer_store_dwordx4 v[176:179], v225, s[80:83], s64 offen offset:0 sc0 sc1
    buffer_store_dwordx4 v[180:183], v225, s[80:83], s64 offen offset:64 sc0 sc1
    buffer_store_dwordx4 v[184:187], v225, s[80:83], s64 offen offset:128 sc0 sc1
    buffer_store_dwordx4 v[188:191], v225, s[80:83], s64 offen offset:192 sc0 sc1
    buffer_store_dwordx4 v[192:195], v225, s[80:83], s64 offen offset:256 sc0 sc1
    buffer_store_dwordx4 v[196:199], v225, s[80:83], s64 offen offset:320 sc0 sc1
    buffer_store_dwordx4 v[200:203], v225, s[80:83], s64 offen offset:384 sc0 sc1
    s_mov_b64 exec, -1
    s_nop 3
    s_branch cs_542_b
cf_1043:
    s_lshl_b32 s64, s74, 4
    s_add_u32 s64, s64, s73
    s_lshl_b32 s64, s64, 3
    s_add_u32 s64, s64, s69
    s_lshl_b32 s64, s64, 2
    s_add_u32 s64, s64, 75579392
    v_mov_b32 v216, 0
    v_mov_b32 v217, 1
    s_mov_b64 exec, 1
    buffer_store_dword v217, v216, s[80:83], s64 offen sc0 sc1
    s_mov_b64 exec, -1
    s_branch cf_1043_b
g3c1_hook:
    s_lshl_b32 s64, s74, 9
    s_add_u32 s64, s64, 75579392
    v_lshlrev_b32 v225, 5, v252
    s_cmp_eq_u32 s24, 1
    s_cbranch_scc1 g3c1_h1
    buffer_load_dwordx4 v[216:219], v225, s[80:83], s64 offen sc1
    s_branch g3c1_hb
g3c1_h1:
    v_and_b32 v216, v216, v217
    v_and_b32 v218, v218, v219
    v_and_b32 v216, v216, v218
    v_cmp_ne_u32 vcc, 1, v216
    s_cbranch_vccz g3c1_h1b
    s_mov_b64 exec, 0xffff
pl_2044:
    buffer_load_dwordx4 v[216:219], v225, s[80:83], s64 offen sc1
    s_sub_u32 s79, s79, 1
    s_cbranch_scc1 L_abort
    s_waitcnt vmcnt(0)
    v_and_b32 v216, v216, v217
    v_and_b32 v218, v218, v219
    v_and_b32 v216, v216, v218
    v_cmp_ne_u32 vcc, 1, v216
    s_cbranch_vccnz pl_2044
    s_mov_b64 exec, -1
g3c1_h1b:
    s_and_b32 s64, s3, 1
    s_mul_i32 s64, s64, 14336
    s_mul_i32 s65, s74, 896
    s_add_u32 s64, s64, s65
    s_lshr_b32 s65, s69, 1
    s_mul_i32 s65, s65, 448
    s_add_u32 s64, s64, s65
    s_add_u32 s64, s64, 74448896
    v_and_b32 v225, 31, v250
    v_lshlrev_b32 v225, 4, v225
    v_lshrrev_b32 v253, 5, v250
    v_mul_u32_u24 v253, 229376, v253
    v_add_u32 v225, v253, v225
    s_mov_b32 exec_lo, 0x0fffffff
    s_mov_b32 exec_hi, 0x0fffffff
    buffer_load_dwordx4 v[176:179], v225, s[80:83], s64 offen sc1
    s_add_u32 s64, s64, 28672
    buffer_load_dwordx4 v[180:183], v225, s[80:83], s64 offen sc1
    s_add_u32 s64, s64, 28672
    buffer_load_dwordx4 v[184:187], v225, s[80:83], s64 offen sc1
    s_add_u32 s64, s64, 28672
    buffer_load_dwordx4 v[188:191], v225, s[80:83], s64 offen sc1
    s_add_u32 s64, s64, 28672
    buffer_load_dwordx4 v[192:195], v225, s[80:83], s64 offen sc1
    s_add_u32 s64, s64, 28672
    buffer_load_dwordx4 v[196:199], v225, s[80:83], s64 offen sc1
    s_add_u32 s64, s64, 28672
    buffer_load_dwordx4 v[200:203], v225, s[80:83], s64 offen sc1
    s_add_u32 s64, s64, 28672
    buffer_load_dwordx4 v[204:207], v225, s[80:83], s64 offen sc1
    s_add_u32 s64, s64, 28672
    s_mov_b64 exec, -1
    s_branch g3c1_hb
sg_3045_slow:
    s_waitcnt vmcnt(0)
    buffer_wbl2 sc1
    s_waitcnt vmcnt(0)
    s_mov_b64 exec, 1
    buffer_store_dword v145, v144, s[80:83], s64 offen sc0 sc1
    s_mov_b64 exec, -1
    s_branch sg_3045_done
pl_3046_acq:
    buffer_inv sc1
    s_waitcnt vmcnt(0)
    s_branch pl_3046_ok
pl_3047_acq:
    buffer_inv sc1
    s_waitcnt vmcnt(0)
    s_branch pl_3047_ok
pl_3048_acq:
    buffer_inv sc1
    s_waitcnt vmcnt(0)
    s_branch pl_3048_ok
L_fin:
L_abort:
L_end:
    s_endpgm
.section .rodata,"a"
.p2align 6
.amdhsa_kernel interleave_layers__sliding_local_dilated__glu_gated_swiglu__prompt_kernel
  .amdhsa_next_free_vgpr 256
  .amdhsa_next_free_sgpr 102
  .amdhsa_accum_offset 256
  .amdhsa_group_segment_fixed_size 0
  .amdhsa_kernarg_size 80
  .amdhsa_user_sgpr_count 2
  .amdhsa_user_sgpr_kernarg_segment_ptr 1
  .amdhsa_system_sgpr_workgroup_id_x 1
.end_amdhsa_kernel
```

```asm
; @launch grid=(256,1,1) block=(512,1,1) lds=163840
.amdgcn_target "amdgcn-amd-amdhsa--gfx950"
.text
.globl interleave_layers__sliding_local_dilated__glu_gated_swiglu__prompt_kernel
.p2align 8
.type interleave_layers__sliding_local_dilated__glu_gated_swiglu__prompt_kernel,@function
interleave_layers__sliding_local_dilated__glu_gated_swiglu__prompt_kernel:
    s_cmp_ge_u32 s2, 256
    s_cbranch_scc1 L_end
    s_load_dwordx4 s[84:87], s[0:1], 0
    s_load_dwordx2 s[4:5], s[0:1], 72
    s_load_dwordx2 s[88:89], s[0:1], 16
    s_load_dwordx4 s[92:95], s[0:1], 32
    s_load_dwordx4 s[96:99], s[0:1], 48
    s_load_dwordx2 s[90:91], s[0:1], 64
    v_lshrrev_b32 v1, 6, v0
    v_and_b32 v250, 63, v0
    v_readfirstlane_b32 s3, v1
    v_lshrrev_b32 v251, 4, v250
    v_and_b32 v252, 15, v250
    v_lshlrev_b32 v249, 4, v250
    s_and_b32 s70, s2, 7
    s_lshr_b32 s72, s2, 4
    s_lshr_b32 s71, s2, 3
    s_and_b32 s71, s71, 1
    s_lshl_b32 s73, s70, 1
    s_add_u32 s67, s73, s72
    s_and_b32 s67, s67, 15
    s_add_u32 s73, s73, s71
    s_and_b32 s68, s72, 1
    s_and_b32 s64, s70, 1
    s_lshl_b32 s64, s64, 3
    s_lshr_b32 s74, s72, 1
    s_add_u32 s74, s74, s64
    s_and_b32 s58, s70, 6
    s_lshl_b32 s57, s58, 1
    s_sub_u32 s61, s74, s58
    s_add_u32 s61, s61, 3
    s_and_b32 s61, s61, 7
    s_mov_b32 s60, 0
    s_mov_b32 s59, 1
    s_and_b32 s69, s3, 3
    s_mov_b32 s75, 0
    s_mov_b32 s78, 1
    s_mov_b32 s79, 4194304
    s_waitcnt lgkmcnt(0)
    s_mov_b32 s80, s4
    s_mov_b32 s81, s5
    s_mov_b32 s82, 79691776
    s_mov_b32 s83, 0x00020000
    s_cmp_ge_u32 s3, 4
    s_cbranch_scc1 L_load
    s_mul_i32 s64, s3, 18432
    v_add_u32 v8, s64, v249
    v_mov_b32 v4, 0x3f803f80
    v_mov_b32 v5, 0x3f803f80
    v_mov_b32 v6, 0x3f803f80
    v_mov_b32 v7, 0x3f803f80
    s_mov_b64 exec, 0xff
    ds_write_b128 v8, v[4:7]
    s_mov_b64 exec, -1
    v_mov_b32 v0, 0
    s_cmp_lg_u32 s3, 3
    s_cbranch_scc1 L_noinit
    v_mov_b32 v1, 0
    v_mov_b32 v2, 0
    v_mov_b32 v3, 0
    v_lshrrev_b32 v8, 1, v250
    v_lshlrev_b32 v8, 13, v8
    v_and_b32 v9, 1, v250
    v_lshl_add_u32 v8, v9, 4, v8
    s_lshl_b32 s64, s73, 4
    s_add_u32 s64, s64, s72
    s_lshl_b32 s64, s64, 5
    s_add_u32 s65, s64, 75497472
    s_mov_b64 exec, 0xffff
    buffer_store_dwordx4 v[0:3], v8, s[80:83], s65 offen sc0 sc1
    v_lshrrev_b32 v8, 2, v250
    v_lshlrev_b32 v8, 17, v8
    v_and_b32 v9, 3, v250
    v_lshl_add_u32 v8, v9, 7, v8
    s_lshl_b32 s64, s2, 9
    s_add_u32 s65, s64, 75759616
    s_mov_b64 exec, 0xff
    buffer_store_dwordx4 v[0:3], v8, s[80:83], s65 offen sc0 sc1
    v_lshlrev_b32 v8, 12, v250
    s_lshl_b32 s64, s73, 1
    s_add_u32 s64, s64, s68
    s_lshl_b32 s64, s64, 7
    s_add_u32 s64, s64, 75563008
    s_cmp_lt_u32 s72, 2
    s_cselect_b32 s64, s64, 0x7f000000
    s_mov_b64 exec, 7
    buffer_store_dwordx4 v[0:3], v8, s[80:83], s64 offen sc0 sc1
    s_mov_b64 exec, 3
    s_add_u32 s65, s58, s71
    s_lshl_b32 s65, s65, 1
    s_add_u32 s65, s65, s68
    s_lshl_b32 s64, s74, 4
    s_add_u32 s64, s64, s65
    s_lshl_b32 s64, s64, 5
    s_add_u32 s65, s64, 75628544
    buffer_store_dwordx4 v[0:3], v249, s[80:83], s65 offen sc0 sc1
    s_mov_b64 exec, -1
L_noinit:
    s_mov_b32 s8, s84
    s_mov_b32 s9, s85
    s_mov_b32 s10, 4194304
    s_mov_b32 s11, 0x00020000
    s_lshl_b32 s16, s72, 2
    s_add_u32 s16, s16, s3
    s_lshl_b32 s16, s16, 1
    s_lshl_b32 s17, s73, 7
    s_add_u32 s18, s17, s16
    s_lshl_b32 s18, s18, 11
    s_add_u32 s19, s17, s72
    s_sub_u32 s19, s19, 16
    s_lshl_b32 s19, s19, 11
    s_cmp_eq_u32 s73, 0
    s_cselect_b32 s19, 0x7f000000, s19
    s_cmp_lg_u32 s3, 0
    s_cselect_b32 s19, 0x7f000000, s19
    buffer_load_dwordx4 v[16:19], v249, s[8:11], s18 offen offset:0
    buffer_load_dwordx4 v[20:23], v249, s[8:11], s18 offen offset:1024
    buffer_load_dwordx4 v[24:27], v249, s[8:11], s18 offen offset:2048
    buffer_load_dwordx4 v[28:31], v249, s[8:11], s18 offen offset:3072
    v_mov_b32 v32, 0
    v_mov_b32 v33, 0
    v_mov_b32 v34, 0
    v_mov_b32 v35, 0
    v_mov_b32 v36, 0
    v_mov_b32 v37, 0
    v_mov_b32 v38, 0
    v_mov_b32 v39, 0
    s_cbranch_scc1 xs_1
    buffer_load_dwordx4 v[32:35], v249, s[8:11], s19 offen offset:0
    buffer_load_dwordx4 v[36:39], v249, s[8:11], s19 offen offset:1024
xs_1:
    v_mov_b32 v56, 0x3f803f80
    s_waitcnt vmcnt(0)
    v_dot2_f32_bf16 v48, v16, v56, 0
    v_dot2_f32_bf16 v49, v16, v16, 0
    v_dot2_f32_bf16 v48, v17, v56, v48
    v_dot2_f32_bf16 v49, v17, v17, v49
    v_dot2_f32_bf16 v48, v18, v56, v48
    v_dot2_f32_bf16 v49, v18, v18, v49
    v_dot2_f32_bf16 v48, v19, v56, v48
    v_dot2_f32_bf16 v49, v19, v19, v49
    v_dot2_f32_bf16 v48, v20, v56, v48
    v_dot2_f32_bf16 v49, v20, v20, v49
    v_dot2_f32_bf16 v48, v21, v56, v48
    v_dot2_f32_bf16 v49, v21, v21, v49
    v_dot2_f32_bf16 v48, v22, v56, v48
    v_dot2_f32_bf16 v49, v22, v22, v49
    v_dot2_f32_bf16 v48, v23, v56, v48
    v_dot2_f32_bf16 v49, v23, v23, v49
    v_dot2_f32_bf16 v50, v24, v56, 0
    v_dot2_f32_bf16 v51, v24, v24, 0
    v_dot2_f32_bf16 v50, v25, v56, v50
    v_dot2_f32_bf16 v51, v25, v25, v51
    v_dot2_f32_bf16 v50, v26, v56, v50
    v_dot2_f32_bf16 v51, v26, v26, v51
    v_dot2_f32_bf16 v50, v27, v56, v50
    v_dot2_f32_bf16 v51, v27, v27, v51
    v_dot2_f32_bf16 v50, v28, v56, v50
    v_dot2_f32_bf16 v51, v28, v28, v51
    v_dot2_f32_bf16 v50, v29, v56, v50
    v_dot2_f32_bf16 v51, v29, v29, v51
    v_dot2_f32_bf16 v50, v30, v56, v50
    v_dot2_f32_bf16 v51, v30, v30, v51
    v_dot2_f32_bf16 v50, v31, v56, v50
    v_dot2_f32_bf16 v51, v31, v31, v51
    v_dot2_f32_bf16 v52, v32, v56, 0
    v_dot2_f32_bf16 v53, v32, v32, 0
    v_dot2_f32_bf16 v52, v33, v56, v52
    v_dot2_f32_bf16 v53, v33, v33, v53
    v_dot2_f32_bf16 v52, v34, v56, v52
    v_dot2_f32_bf16 v53, v34, v34, v53
    v_dot2_f32_bf16 v52, v35, v56, v52
    v_dot2_f32_bf16 v53, v35, v35, v53
    v_dot2_f32_bf16 v52, v36, v56, v52
    v_dot2_f32_bf16 v53, v36, v36, v53
    v_dot2_f32_bf16 v52, v37, v56, v52
    v_dot2_f32_bf16 v53, v37, v37, v53
    v_dot2_f32_bf16 v52, v38, v56, v52
    v_dot2_f32_bf16 v53, v38, v38, v53
    v_dot2_f32_bf16 v52, v39, v56, v52
    v_dot2_f32_bf16 v53, v39, v39, v53
    s_nop 2
    v_add_f32_dpp v48, v48, v48 quad_perm:[1,0,3,2] row_mask:0xf bank_mask:0xf
    v_add_f32_dpp v49, v49, v49 quad_perm:[1,0,3,2] row_mask:0xf bank_mask:0xf
    v_add_f32_dpp v50, v50, v50 quad_perm:[1,0,3,2] row_mask:0xf bank_mask:0xf
    v_add_f32_dpp v51, v51, v51 quad_perm:[1,0,3,2] row_mask:0xf bank_mask:0xf
    v_add_f32_dpp v52, v52, v52 quad_perm:[1,0,3,2] row_mask:0xf bank_mask:0xf
    v_add_f32_dpp v53, v53, v53 quad_perm:[1,0,3,2] row_mask:0xf bank_mask:0xf
    v_add_f32_dpp v48, v48, v48 quad_perm:[2,3,0,1] row_mask:0xf bank_mask:0xf
    v_add_f32_dpp v49, v49, v49 quad_perm:[2,3,0,1] row_mask:0xf bank_mask:0xf
    v_add_f32_dpp v50, v50, v50 quad_perm:[2,3,0,1] row_mask:0xf bank_mask:0xf
    v_add_f32_dpp v51, v51, v51 quad_perm:[2,3,0,1] row_mask:0xf bank_mask:0xf
    v_add_f32_dpp v52, v52, v52 quad_perm:[2,3,0,1] row_mask:0xf bank_mask:0xf
    v_add_f32_dpp v53, v53, v53 quad_perm:[2,3,0,1] row_mask:0xf bank_mask:0xf
    v_add_f32_dpp v48, v48, v48 row_half_mirror row_mask:0xf bank_mask:0xf
    v_add_f32_dpp v49, v49, v49 row_half_mirror row_mask:0xf bank_mask:0xf
    v_add_f32_dpp v50, v50, v50 row_half_mirror row_mask:0xf bank_mask:0xf
    v_add_f32_dpp v51, v51, v51 row_half_mirror row_mask:0xf bank_mask:0xf
    v_add_f32_dpp v52, v52, v52 row_half_mirror row_mask:0xf bank_mask:0xf
    v_add_f32_dpp v53, v53, v53 row_half_mirror row_mask:0xf bank_mask:0xf
    v_add_f32_dpp v48, v48, v48 row_mirror row_mask:0xf bank_mask:0xf
    v_add_f32_dpp v49, v49, v49 row_mirror row_mask:0xf bank_mask:0xf
    v_add_f32_dpp v50, v50, v50 row_mirror row_mask:0xf bank_mask:0xf
    v_add_f32_dpp v51, v51, v51 row_mirror row_mask:0xf bank_mask:0xf
    v_add_f32_dpp v52, v52, v52 row_mirror row_mask:0xf bank_mask:0xf
    v_add_f32_dpp v53, v53, v53 row_mirror row_mask:0xf bank_mask:0xf
    v_mov_b32 v16, v48
    v_mov_b32 v17, v49
    v_mov_b32 v18, v50
    v_mov_b32 v19, v51
    v_mov_b32 v20, v52
    v_mov_b32 v21, v53
    s_nop 1
    v_permlane16_swap_b32 v48, v16
    v_permlane16_swap_b32 v49, v17
    v_permlane16_swap_b32 v50, v18
    v_permlane16_swap_b32 v51, v19
    v_permlane16_swap_b32 v52, v20
    v_permlane16_swap_b32 v53, v21
    v_add_f32 v48, v48, v16
    v_add_f32 v49, v49, v17
    v_add_f32 v50, v50, v18
    v_add_f32 v51, v51, v19
    v_add_f32 v52, v52, v20
    v_add_f32 v53, v53, v21
    v_mov_b32 v16, v48
    v_mov_b32 v17, v49
    v_mov_b32 v18, v50
    v_mov_b32 v19, v51
    v_mov_b32 v20, v52
    v_mov_b32 v21, v53
    s_nop 1
    v_permlane32_swap_b32 v48, v16
    v_permlane32_swap_b32 v49, v17
    v_permlane32_swap_b32 v50, v18
    v_permlane32_swap_b32 v51, v19
    v_permlane32_swap_b32 v52, v20
    v_permlane32_swap_b32 v53, v21
    v_add_f32 v48, v48, v16
    v_add_f32 v49, v49, v17
    v_add_f32 v50, v50, v18
    v_add_f32 v51, v51, v19
    v_add_f32 v52, v52, v20
    v_add_f32 v53, v53, v21
    v_cmp_eq_u32 vcc, 1, v250
    s_nop 1
    v_cndmask_b32 v48, v48, v50, vcc
    v_cndmask_b32 v49, v49, v51, vcc
    v_cmp_eq_u32 vcc, 2, v250
    s_nop 1
    v_cndmask_b32 v48, v48, v52, vcc
    v_cndmask_b32 v49, v49, v53, vcc
    v_mul_f32 v48, 0x3a800000, v48
    v_mul_f32 v49, 0x3a800000, v49
    v_fma_f32 v49, -v48, v48, v49
    v_max_f32 v49, 0, v49
    v_cvt_pk_bf16_f32 v48, v48, v48
    v_lshlrev_b32 v48, 16, v48
    v_cvt_pk_bf16_f32 v49, v49, v49
    v_lshlrev_b32 v49, 16, v49
    v_add_f32 v49, 0x3727c5ac, v49
    v_cvt_pk_bf16_f32 v49, v49, v49
    v_lshlrev_b32 v49, 16, v49
    v_sqrt_f32 v49, v49
    s_nop 0
    v_cvt_pk_bf16_f32 v49, v49, v49
    v_lshlrev_b32 v49, 16, v49
    v_rcp_f32 v49, v49
    s_nop 0
    s_add_u32 s16, s16, 16
    v_add_u32 v16, s16, v250
    v_mov_b32 v17, s72
    v_cndmask_b32 v16, v16, v17, vcc
    v_lshlrev_b32 v16, 3, v16
    s_lshl_b32 s17, s73, 11
    s_add_u32 s17, s17, 74186752
    s_cmp_eq_u32 s3, 0
    s_cselect_b64 exec, 7, 3
    buffer_store_dwordx2 v[48:49], v16, s[80:83], s17 offen sc0 sc1
    s_mov_b64 exec, -1
    s_waitcnt lgkmcnt(0)
C_layer:
    s_and_b32 s19, s3, 1
    s_lshr_b32 s20, s3, 1
    s_cmp_lg_u32 s75, 0
    s_cbranch_scc1 ad_2_f
    v_lshlrev_b32 v253, 7, v252
    v_and_b32 v254, 6, v250
    v_xor_b32 v254, v254, v251
    v_lshl_add_u32 v204, v254, 4, v253
    v_xor_b32 v205, 64, v204
    s_branch ad_2_d
ad_2_f:
    v_mov_b32 v204, v249
    v_add_u32 v205, 1024, v249
ad_2_d:
    v_lshrrev_b32 v253, 2, v252
    v_mul_u32_u24 v253, 3104, v253
    v_lshl_add_u32 v253, v251, 7, v253
    v_and_b32 v254, 3, v252
    v_lshl_add_u32 v253, v254, 3, v253
    s_lshl_b32 s64, s19, 6
    s_add_u32 s64, s64, 73984
    v_add_u32 v208, s64, v253
    v_mov_b32 v209, v208
    s_mov_b32 s16, 0
    s_mov_b32 s17, 18432
    v_add_u32 v206, s17, v204
    v_add_u32 v207, s17, v205
    s_lshl_b32 s21, s73, 4
    s_add_u32 s21, s21, s67
    s_lshl_b32 s21, s21, 1
    s_add_u32 s21, s21, s19
    s_lshl_b32 s21, s21, 1
    s_add_u32 s21, s21, s20
    s_lshl_b32 s21, s21, 12
    s_lshl_b32 s64, s60, 22
    s_add_u32 s21, s21, s64
    s_add_u32 s21, s21, 12582912
    v_and_b32 v254, 1, v252
    v_cmp_eq_u32 s[28:29], 1, v254
    v_lshlrev_b32 v253, 2, v251
    v_sub_u32 v253, v252, v253
    v_sub_u32 v253, v253, v254
    v_lshlrev_b32 v254, 4, v254
    v_mov_b32 v210, 0xffff
    v_lshlrev_b32 v210, v254, v210
    v_cmp_le_i32 s[30:31], 0, v253
    v_cmp_le_i32 s[32:33], 2, v253
    s_or_b32 s22, s73, s20
    s_cmp_eq_u32 s22, 0
    s_cselect_b64 s[34:35], s[30:31], -1
    s_cselect_b64 s[36:37], s[32:33], -1
    v_cndmask_b32 v232, v210, 0, s[30:31]
    v_cndmask_b32 v234, 0, v210, s[30:31]
    v_cndmask_b32 v233, v210, 0, s[32:33]
    v_cndmask_b32 v235, 0, v210, s[32:33]
    s_mov_b32 s23, 0x3e8293ee
    s_mul_i32 s64, s19, 6144
    s_add_u32 s64, s64, 18432
    v_add_u32 v236, s64, v249
    s_mul_i32 s64, s19, 384
    s_add_u32 s64, s64, 162688
    v_lshlrev_b32 v237, 4, v251
    v_add_u32 v237, s64, v237
    v_lshlrev_b32 v238, 2, v252
    v_add_u32 v238, s64, v238
    s_lshl_b32 s64, s20, 9
    s_add_u32 s64, s64, 159744
    v_lshlrev_b32 v239, 3, v252
    v_add_u32 v239, s64, v239
    v_lshlrev_b32 v240, 5, v251
    v_add_u32 v240, s64, v240
    v_mov_b32 v241, 163456
    v_mov_b32 v212, 0
    v_mov_b32 v213, 0
    v_mov_b32 v214, 0
    v_mov_b32 v215, 0
    s_mov_b32 s18, 16
    s_nop 0
    v_mfma_f32_32x32x16_bf16 v[0:15], v[212:215], v[212:215], 0
    v_mfma_f32_32x32x16_bf16 v[16:31], v[212:215], v[212:215], 0
    v_mfma_f32_32x32x16_bf16 v[32:47], v[212:215], v[212:215], 0
    v_mfma_f32_32x32x16_bf16 v[48:63], v[212:215], v[212:215], 0
    v_mfma_f32_32x32x16_bf16 v[64:79], v[212:215], v[212:215], 0
    v_mfma_f32_32x32x16_bf16 v[80:95], v[212:215], v[212:215], 0
    v_mfma_f32_32x32x16_bf16 v[96:111], v[212:215], v[212:215], 0
    v_mfma_f32_32x32x16_bf16 v[112:127], v[212:215], v[212:215], 0
    s_nop 7
    s_nop 3
    s_cmp_eq_u32 s20, 1
    s_cbranch_scc1 g1c_r1
    s_barrier
    ds_read_b128 v[116:119], v206 offset:0
    ds_read_b64_tr_b16 v[164:165], v209 offset:13440
    ds_read_b64_tr_b16 v[166:167], v209 offset:13952
    ds_read_b128 v[120:123], v206 offset:2048
    ds_read_b64_tr_b16 v[168:169], v209 offset:13472
    ds_read_b64_tr_b16 v[170:171], v209 offset:13984
    ds_read_b128 v[124:127], v206 offset:4096
    ds_read_b64_tr_b16 v[172:173], v209 offset:14464
    ds_read_b64_tr_b16 v[174:175], v209 offset:14976
    ds_read_b128 v[128:131], v206 offset:6144
    ds_read_b64_tr_b16 v[176:177], v209 offset:14496
    ds_read_b64_tr_b16 v[178:179], v209 offset:15008
    ds_read_b128 v[132:135], v206 offset:8192
    ds_read_b64_tr_b16 v[156:157], v209 offset:12416
    ds_read_b64_tr_b16 v[158:159], v209 offset:12928
    ds_read_b64_tr_b16 v[160:161], v209 offset:12448
    ds_read_b64_tr_b16 v[162:163], v209 offset:12960
    s_add_u32 s16, s16, 24832
    s_cmp_eq_u32 s16, 74496
    s_cselect_b32 s16, 0, s16
    v_add_u32 v209, s16, v208
    s_waitcnt lgkmcnt(0)
g1c_loop0:
    s_barrier
    v_mfma_f32_16x16x32_bf16 v[112:115], v[156:159], v[116:119], v[112:115]
    ds_read_b128 v[136:139], v207 offset:0
    v_mfma_f32_16x16x32_bf16 v[32:35], v[164:167], v[116:119], v[32:35]
    ds_read_b64_tr_b16 v[188:189], v209 offset:1024
    v_mfma_f32_16x16x32_bf16 v[36:39], v[168:171], v[116:119], v[36:39]
    ds_read_b64_tr_b16 v[190:191], v209 offset:1536
    v_mfma_f32_16x16x32_bf16 v[40:43], v[164:167], v[120:123], v[40:43]
    ds_read_b128 v[140:143], v207 offset:2048
    v_mfma_f32_16x16x32_bf16 v[48:51], v[164:167], v[124:127], v[48:51]
    ds_read_b64_tr_b16 v[192:193], v209 offset:1056
    v_mfma_f32_16x16x32_bf16 v[56:59], v[164:167], v[128:131], v[56:59]
    ds_read_b64_tr_b16 v[194:195], v209 offset:1568
    v_mfma_f32_16x16x32_bf16 v[64:67], v[164:167], v[132:135], v[64:67]
    ds_read_b128 v[144:147], v207 offset:4096
    v_mfma_f32_16x16x32_bf16 v[44:47], v[168:171], v[120:123], v[44:47]
    ds_read_b64_tr_b16 v[196:197], v209 offset:2048
    v_mfma_f32_16x16x32_bf16 v[52:55], v[168:171], v[124:127], v[52:55]
    ds_read_b64_tr_b16 v[198:199], v209 offset:2560
    v_mfma_f32_16x16x32_bf16 v[60:63], v[168:171], v[128:131], v[60:63]
    ds_read_b128 v[148:151], v207 offset:6144
    v_mfma_f32_16x16x32_bf16 v[68:71], v[168:171], v[132:135], v[68:71]
    ds_read_b64_tr_b16 v[200:201], v209 offset:2080
    v_mfma_f32_16x16x32_bf16 v[80:83], v[120:123], v[172:175], v[80:83]
    ds_read_b64_tr_b16 v[202:203], v209 offset:2592
    v_mfma_f32_16x16x32_bf16 v[88:91], v[124:127], v[172:175], v[88:91]
    ds_read_b128 v[152:155], v207 offset:8192
    v_mfma_f32_16x16x32_bf16 v[96:99], v[128:131], v[172:175], v[96:99]
    ds_read_b64_tr_b16 v[180:181], v209 offset:0
    v_mfma_f32_16x16x32_bf16 v[104:107], v[132:135], v[172:175], v[104:107]
    ds_read_b64_tr_b16 v[182:183], v209 offset:512
    v_mfma_f32_16x16x32_bf16 v[84:87], v[120:123], v[176:179], v[84:87]
    ds_read_b64_tr_b16 v[184:185], v209 offset:32
    v_mfma_f32_16x16x32_bf16 v[92:95], v[124:127], v[176:179], v[92:95]
    ds_read_b64_tr_b16 v[186:187], v209 offset:544
    v_mfma_f32_16x16x32_bf16 v[100:103], v[128:131], v[176:179], v[100:103]
    v_mfma_f32_16x16x32_bf16 v[108:111], v[132:135], v[176:179], v[108:111]
    s_add_u32 s17, s17, 18432
    s_cmp_eq_u32 s17, 73728
    v_mfma_f32_16x16x32_bf16 v[0:3], v[156:159], v[120:123], v[0:3]
    v_mfma_f32_16x16x32_bf16 v[8:11], v[156:159], v[124:127], v[8:11]
    s_cselect_b32 s17, 0, s17
    v_mfma_f32_16x16x32_bf16 v[16:19], v[156:159], v[128:131], v[16:19]
    v_mfma_f32_16x16x32_bf16 v[24:27], v[156:159], v[132:135], v[24:27]
    v_add_u32 v206, s17, v204
    v_mfma_f32_16x16x32_bf16 v[4:7], v[160:163], v[120:123], v[4:7]
    v_mfma_f32_16x16x32_bf16 v[12:15], v[160:163], v[124:127], v[12:15]
    v_add_u32 v207, s17, v205
    v_mfma_f32_16x16x32_bf16 v[20:23], v[160:163], v[128:131], v[20:23]
    v_mfma_f32_16x16x32_bf16 v[28:31], v[160:163], v[132:135], v[28:31]
    s_waitcnt lgkmcnt(0)
    v_mfma_f32_16x16x32_bf16 v[112:115], v[180:183], v[136:139], v[112:115]
    ds_read_b128 v[116:119], v206 offset:0
    v_mfma_f32_16x16x32_bf16 v[32:35], v[188:191], v[136:139], v[32:35]
    ds_read_b64_tr_b16 v[164:165], v209 offset:13440
    v_mfma_f32_16x16x32_bf16 v[36:39], v[192:195], v[136:139], v[36:39]
    ds_read_b64_tr_b16 v[166:167], v209 offset:13952
    v_mfma_f32_16x16x32_bf16 v[40:43], v[188:191], v[140:143], v[40:43]
    ds_read_b128 v[120:123], v206 offset:2048
    v_mfma_f32_16x16x32_bf16 v[48:51], v[188:191], v[144:147], v[48:51]
    ds_read_b64_tr_b16 v[168:169], v209 offset:13472
    v_mfma_f32_16x16x32_bf16 v[56:59], v[188:191], v[148:151], v[56:59]
    ds_read_b64_tr_b16 v[170:171], v209 offset:13984
    v_mfma_f32_16x16x32_bf16 v[64:67], v[188:191], v[152:155], v[64:67]
    ds_read_b128 v[124:127], v206 offset:4096
    v_mfma_f32_16x16x32_bf16 v[44:47], v[192:195], v[140:143], v[44:47]
    ds_read_b64_tr_b16 v[172:173], v209 offset:14464
    v_mfma_f32_16x16x32_bf16 v[52:55], v[192:195], v[144:147], v[52:55]
    ds_read_b64_tr_b16 v[174:175], v209 offset:14976
    v_mfma_f32_16x16x32_bf16 v[60:63], v[192:195], v[148:151], v[60:63]
    ds_read_b128 v[128:131], v206 offset:6144
    v_mfma_f32_16x16x32_bf16 v[68:71], v[192:195], v[152:155], v[68:71]
    ds_read_b64_tr_b16 v[176:177], v209 offset:14496
    v_mfma_f32_16x16x32_bf16 v[80:83], v[140:143], v[196:199], v[80:83]
    ds_read_b64_tr_b16 v[178:179], v209 offset:15008
    v_mfma_f32_16x16x32_bf16 v[88:91], v[144:147], v[196:199], v[88:91]
    ds_read_b128 v[132:135], v206 offset:8192
    v_mfma_f32_16x16x32_bf16 v[96:99], v[148:151], v[196:199], v[96:99]
    ds_read_b64_tr_b16 v[156:157], v209 offset:12416
    v_mfma_f32_16x16x32_bf16 v[104:107], v[152:155], v[196:199], v[104:107]
    ds_read_b64_tr_b16 v[158:159], v209 offset:12928
    v_mfma_f32_16x16x32_bf16 v[84:87], v[140:143], v[200:203], v[84:87]
    ds_read_b64_tr_b16 v[160:161], v209 offset:12448
    v_mfma_f32_16x16x32_bf16 v[92:95], v[144:147], v[200:203], v[92:95]
    ds_read_b64_tr_b16 v[162:163], v209 offset:12960
    v_mfma_f32_16x16x32_bf16 v[100:103], v[148:151], v[200:203], v[100:103]
    v_mfma_f32_16x16x32_bf16 v[108:111], v[152:155], v[200:203], v[108:111]
    s_add_u32 s16, s16, 24832
    s_cmp_eq_u32 s16, 74496
    v_mfma_f32_16x16x32_bf16 v[0:3], v[180:183], v[140:143], v[0:3]
    v_mfma_f32_16x16x32_bf16 v[8:11], v[180:183], v[144:147], v[8:11]
    s_cselect_b32 s16, 0, s16
    v_mfma_f32_16x16x32_bf16 v[16:19], v[180:183], v[148:151], v[16:19]
    v_mfma_f32_16x16x32_bf16 v[24:27], v[180:183], v[152:155], v[24:27]
    v_add_u32 v209, s16, v208
    v_mfma_f32_16x16x32_bf16 v[4:7], v[184:187], v[140:143], v[4:7]
    v_mfma_f32_16x16x32_bf16 v[12:15], v[184:187], v[144:147], v[12:15]
    s_sub_u32 s18, s18, 1
    s_cmp_lg_u32 s18, 0
    v_mfma_f32_16x16x32_bf16 v[20:23], v[184:187], v[148:151], v[20:23]
    v_mfma_f32_16x16x32_bf16 v[28:31], v[184:187], v[152:155], v[28:31]
    s_waitcnt vmcnt(0) lgkmcnt(0)
    s_cbranch_scc1 g1c_loop0
    ds_write_b128 v236, v[64:67] offset:0
    ds_write_b128 v236, v[68:71] offset:1024
    ds_write_b128 v236, v[104:107] offset:2048
    ds_write_b128 v236, v[108:111] offset:3072
    s_mov_b32 exec_lo, 0x00010001
    s_mov_b32 exec_hi, 0x00010001
    ds_write_b128 v237, v[112:115]
    ds_write_b128 v237, v[32:35] offset:128
    ds_write_b128 v237, v[36:39] offset:192
    s_mov_b64 exec, -1
    s_waitcnt lgkmcnt(0)
    s_barrier
    ds_read_b128 v[116:119], v237 offset:0
    ds_read_b128 v[120:123], v237 offset:64
    ds_read_b128 v[124:127], v237 offset:128
    ds_read_b128 v[128:131], v237 offset:192
    ds_read2_b32 v[136:137], v239 offset0:32 offset1:32
    ds_read2_b32 v[138:139], v239 offset0:33 offset1:33
    ds_read2_b32 v[140:141], v239 offset0:64 offset1:64
    ds_read2_b32 v[142:143], v239 offset0:65 offset1:65
    ds_read2_b32 v[144:145], v239 offset0:96 offset1:96
    ds_read2_b32 v[146:147], v239 offset0:97 offset1:97
    ds_read2_b32 v[148:149], v239 offset0:128 offset1:128
    ds_read2_b32 v[150:151], v239 offset0:129 offset1:129
    ds_read2_b32 v[132:133], v239 offset0:0 offset1:0
    ds_read2_b32 v[134:135], v239 offset0:1 offset1:1
    s_waitcnt lgkmcnt(2)
    ds_read_b128 v[72:75], v236 offset:4096
    ds_read_b128 v[76:79], v236 offset:5120
    s_branch g1c_epi
g1c_r1:
    s_barrier
    ds_read_b128 v[116:119], v206 offset:0
    ds_read_b64_tr_b16 v[164:165], v209 offset:13440
    ds_read_b64_tr_b16 v[166:167], v209 offset:13952
    ds_read_b128 v[120:123], v206 offset:10240
    ds_read_b64_tr_b16 v[168:169], v209 offset:13472
    ds_read_b64_tr_b16 v[170:171], v209 offset:13984
    ds_read_b128 v[124:127], v206 offset:12288
    ds_read_b64_tr_b16 v[172:173], v209 offset:14464
    ds_read_b64_tr_b16 v[174:175], v209 offset:14976
    ds_read_b128 v[128:131], v206 offset:14336
    ds_read_b64_tr_b16 v[176:177], v209 offset:14496
    ds_read_b64_tr_b16 v[178:179], v209 offset:15008
    ds_read_b128 v[132:135], v206 offset:16384
    ds_read_b64_tr_b16 v[156:157], v209 offset:12416
    ds_read_b64_tr_b16 v[158:159], v209 offset:12928
    ds_read_b64_tr_b16 v[160:161], v209 offset:12448
    ds_read_b64_tr_b16 v[162:163], v209 offset:12960
    s_add_u32 s16, s16, 24832
    s_cmp_eq_u32 s16, 74496
    s_cselect_b32 s16, 0, s16
    v_add_u32 v209, s16, v208
    s_waitcnt lgkmcnt(0)
g1c_loop1:
    s_barrier
    v_mfma_f32_16x16x32_bf16 v[112:115], v[160:163], v[116:119], v[112:115]
    ds_read_b128 v[136:139], v207 offset:0
    v_mfma_f32_16x16x32_bf16 v[72:75], v[116:119], v[172:175], v[72:75]
    ds_read_b64_tr_b16 v[188:189], v209 offset:1024
    v_mfma_f32_16x16x32_bf16 v[76:79], v[116:119], v[176:179], v[76:79]
    ds_read_b64_tr_b16 v[190:191], v209 offset:1536
    v_mfma_f32_16x16x32_bf16 v[40:43], v[164:167], v[120:123], v[40:43]
    ds_read_b128 v[140:143], v207 offset:10240
    v_mfma_f32_16x16x32_bf16 v[48:51], v[164:167], v[124:127], v[48:51]
    ds_read_b64_tr_b16 v[192:193], v209 offset:1056
    v_mfma_f32_16x16x32_bf16 v[56:59], v[164:167], v[128:131], v[56:59]
    ds_read_b64_tr_b16 v[194:195], v209 offset:1568
    v_mfma_f32_16x16x32_bf16 v[64:67], v[164:167], v[132:135], v[64:67]
    ds_read_b128 v[144:147], v207 offset:12288
    v_mfma_f32_16x16x32_bf16 v[44:47], v[168:171], v[120:123], v[44:47]
    ds_read_b64_tr_b16 v[196:197], v209 offset:2048
    v_mfma_f32_16x16x32_bf16 v[52:55], v[168:171], v[124:127], v[52:55]
    ds_read_b64_tr_b16 v[198:199], v209 offset:2560
    v_mfma_f32_16x16x32_bf16 v[60:63], v[168:171], v[128:131], v[60:63]
    ds_read_b128 v[148:151], v207 offset:14336
    v_mfma_f32_16x16x32_bf16 v[68:71], v[168:171], v[132:135], v[68:71]
    ds_read_b64_tr_b16 v[200:201], v209 offset:2080
    v_mfma_f32_16x16x32_bf16 v[80:83], v[120:123], v[172:175], v[80:83]
    ds_read_b64_tr_b16 v[202:203], v209 offset:2592
    v_mfma_f32_16x16x32_bf16 v[88:91], v[124:127], v[172:175], v[88:91]
    ds_read_b128 v[152:155], v207 offset:16384
    v_mfma_f32_16x16x32_bf16 v[96:99], v[128:131], v[172:175], v[96:99]
    ds_read_b64_tr_b16 v[180:181], v209 offset:0
    v_mfma_f32_16x16x32_bf16 v[104:107], v[132:135], v[172:175], v[104:107]
    ds_read_b64_tr_b16 v[182:183], v209 offset:512
    v_mfma_f32_16x16x32_bf16 v[84:87], v[120:123], v[176:179], v[84:87]
    ds_read_b64_tr_b16 v[184:185], v209 offset:32
    v_mfma_f32_16x16x32_bf16 v[92:95], v[124:127], v[176:179], v[92:95]
    ds_read_b64_tr_b16 v[186:187], v209 offset:544
    v_mfma_f32_16x16x32_bf16 v[100:103], v[128:131], v[176:179], v[100:103]
    v_mfma_f32_16x16x32_bf16 v[108:111], v[132:135], v[176:179], v[108:111]
    s_add_u32 s17, s17, 18432
    s_cmp_eq_u32 s17, 73728
    v_mfma_f32_16x16x32_bf16 v[0:3], v[156:159], v[120:123], v[0:3]
    v_mfma_f32_16x16x32_bf16 v[8:11], v[156:159], v[124:127], v[8:11]
    s_cselect_b32 s17, 0, s17
    v_mfma_f32_16x16x32_bf16 v[16:19], v[156:159], v[128:131], v[16:19]
    v_mfma_f32_16x16x32_bf16 v[24:27], v[156:159], v[132:135], v[24:27]
    v_add_u32 v206, s17, v204
    v_mfma_f32_16x16x32_bf16 v[4:7], v[160:163], v[120:123], v[4:7]
    v_mfma_f32_16x16x32_bf16 v[12:15], v[160:163], v[124:127], v[12:15]
    v_add_u32 v207, s17, v205
    v_mfma_f32_16x16x32_bf16 v[20:23], v[160:163], v[128:131], v[20:23]
    v_mfma_f32_16x16x32_bf16 v[28:31], v[160:163], v[132:135], v[28:31]
    s_waitcnt lgkmcnt(0)
    v_mfma_f32_16x16x32_bf16 v[112:115], v[184:187], v[136:139], v[112:115]
    ds_read_b128 v[116:119], v206 offset:0
    v_mfma_f32_16x16x32_bf16 v[72:75], v[136:139], v[196:199], v[72:75]
    ds_read_b64_tr_b16 v[164:165], v209 offset:13440
    v_mfma_f32_16x16x32_bf16 v[76:79], v[136:139], v[200:203], v[76:79]
    ds_read_b64_tr_b16 v[166:167], v209 offset:13952
    v_mfma_f32_16x16x32_bf16 v[40:43], v[188:191], v[140:143], v[40:43]
    ds_read_b128 v[120:123], v206 offset:10240
    v_mfma_f32_16x16x32_bf16 v[48:51], v[188:191], v[144:147], v[48:51]
    ds_read_b64_tr_b16 v[168:169], v209 offset:13472
    v_mfma_f32_16x16x32_bf16 v[56:59], v[188:191], v[148:151], v[56:59]
    ds_read_b64_tr_b16 v[170:171], v209 offset:13984
    v_mfma_f32_16x16x32_bf16 v[64:67], v[188:191], v[152:155], v[64:67]
    ds_read_b128 v[124:127], v206 offset:12288
    v_mfma_f32_16x16x32_bf16 v[44:47], v[192:195], v[140:143], v[44:47]
    ds_read_b64_tr_b16 v[172:173], v209 offset:14464
    v_mfma_f32_16x16x32_bf16 v[52:55], v[192:195], v[144:147], v[52:55]
    ds_read_b64_tr_b16 v[174:175], v209 offset:14976
    v_mfma_f32_16x16x32_bf16 v[60:63], v[192:195], v[148:151], v[60:63]
    ds_read_b128 v[128:131], v206 offset:14336
    v_mfma_f32_16x16x32_bf16 v[68:71], v[192:195], v[152:155], v[68:71]
    ds_read_b64_tr_b16 v[176:177], v209 offset:14496
    v_mfma_f32_16x16x32_bf16 v[80:83], v[140:143], v[196:199], v[80:83]
    ds_read_b64_tr_b16 v[178:179], v209 offset:15008
    v_mfma_f32_16x16x32_bf16 v[88:91], v[144:147], v[196:199], v[88:91]
    ds_read_b128 v[132:135], v206 offset:16384
    v_mfma_f32_16x16x32_bf16 v[96:99], v[148:151], v[196:199], v[96:99]
    ds_read_b64_tr_b16 v[156:157], v209 offset:12416
    v_mfma_f32_16x16x32_bf16 v[104:107], v[152:155], v[196:199], v[104:107]
    ds_read_b64_tr_b16 v[158:159], v209 offset:12928
    v_mfma_f32_16x16x32_bf16 v[84:87], v[140:143], v[200:203], v[84:87]
    ds_read_b64_tr_b16 v[160:161], v209 offset:12448
    v_mfma_f32_16x16x32_bf16 v[92:95], v[144:147], v[200:203], v[92:95]
    ds_read_b64_tr_b16 v[162:163], v209 offset:12960
    v_mfma_f32_16x16x32_bf16 v[100:103], v[148:151], v[200:203], v[100:103]
    v_mfma_f32_16x16x32_bf16 v[108:111], v[152:155], v[200:203], v[108:111]
    s_add_u32 s16, s16, 24832
    s_cmp_eq_u32 s16, 74496
    v_mfma_f32_16x16x32_bf16 v[0:3], v[180:183], v[140:143], v[0:3]
    v_mfma_f32_16x16x32_bf16 v[8:11], v[180:183], v[144:147], v[8:11]
    s_cselect_b32 s16, 0, s16
    v_mfma_f32_16x16x32_bf16 v[16:19], v[180:183], v[148:151], v[16:19]
    v_mfma_f32_16x16x32_bf16 v[24:27], v[180:183], v[152:155], v[24:27]
    v_add_u32 v209, s16, v208
    v_mfma_f32_16x16x32_bf16 v[4:7], v[184:187], v[140:143], v[4:7]
    v_mfma_f32_16x16x32_bf16 v[12:15], v[184:187], v[144:147], v[12:15]
    s_sub_u32 s18, s18, 1
    s_cmp_lg_u32 s18, 0
    v_mfma_f32_16x16x32_bf16 v[20:23], v[184:187], v[148:151], v[20:23]
    v_mfma_f32_16x16x32_bf16 v[28:31], v[184:187], v[152:155], v[28:31]
    s_waitcnt vmcnt(0) lgkmcnt(0)
    s_cbranch_scc1 g1c_loop1
    ds_write_b128 v236, v[72:75] offset:4096
    ds_write_b128 v236, v[76:79] offset:5120
    s_mov_b32 exec_lo, 0x00010001
    s_mov_b32 exec_hi, 0x00010001
    ds_write_b128 v237, v[112:115] offset:64
    s_mov_b64 exec, 0xffff
    ds_write_b32 v238, v72 offset:256
    ds_write_b32 v238, v76 offset:320
    s_mov_b64 exec, -1
    s_waitcnt lgkmcnt(0)
    s_barrier
    ds_read_b128 v[116:119], v237 offset:0
    ds_read_b128 v[120:123], v237 offset:64
    ds_read_b128 v[124:127], v237 offset:128
    ds_read_b128 v[128:131], v237 offset:192
    ds_read2_b32 v[136:137], v239 offset0:32 offset1:32
    ds_read2_b32 v[138:139], v239 offset0:33 offset1:33
    ds_read2_b32 v[140:141], v239 offset0:64 offset1:64
    ds_read2_b32 v[142:143], v239 offset0:65 offset1:65
    ds_read2_b32 v[144:145], v239 offset0:96 offset1:96
    ds_read2_b32 v[146:147], v239 offset0:97 offset1:97
    ds_read2_b32 v[148:149], v239 offset0:128 offset1:128
    ds_read2_b32 v[150:151], v239 offset0:129 offset1:129
    ds_read2_b32 v[132:133], v239 offset0:0 offset1:0
    ds_read2_b32 v[134:135], v239 offset0:1 offset1:1
    s_waitcnt lgkmcnt(2)
    ds_read_b128 v[32:35], v236 offset:0
    ds_read_b128 v[36:39], v236 offset:1024
    ds_read_b128 v[72:75], v236 offset:2048
    ds_read_b128 v[76:79], v236 offset:3072
g1c_epi:
    ds_read_b32 v241, v241
    ds_read2_b32 v[196:197], v238 offset0:64 offset1:64
    ds_read2_b32 v[198:199], v238 offset0:80 offset1:80
    v_pk_fma_f32 v[0:1], v[136:137], v[116:117], v[0:1] neg_lo:[1,0,0] neg_hi:[1,0,0]
    v_pk_fma_f32 v[2:3], v[136:137], v[118:119], v[2:3] neg_lo:[1,0,0] neg_hi:[1,0,0]
    v_pk_fma_f32 v[4:5], v[136:137], v[120:121], v[4:5] neg_lo:[1,0,0] neg_hi:[1,0,0]
    v_pk_fma_f32 v[6:7], v[136:137], v[122:123], v[6:7] neg_lo:[1,0,0] neg_hi:[1,0,0]
    v_cvt_pk_bf16_f32 v0, v0, v1
    v_cvt_pk_bf16_f32 v1, v2, v3
    v_cvt_pk_bf16_f32 v2, v4, v5
    v_cvt_pk_bf16_f32 v3, v6, v7
    v_mul_f32 v200, s23, v138
    ds_read2_b32 v[164:165], v240 offset0:32 offset1:34
    ds_read2_b32 v[166:167], v240 offset0:36 offset1:38
    ds_read2_b32 v[168:169], v240 offset0:33 offset1:35
    ds_read2_b32 v[170:171], v240 offset0:37 offset1:39
    v_pk_fma_f32 v[40:41], v[136:137], v[124:125], v[40:41] neg_lo:[1,0,0] neg_hi:[1,0,0]
    v_pk_fma_f32 v[42:43], v[136:137], v[126:127], v[42:43] neg_lo:[1,0,0] neg_hi:[1,0,0]
    v_pk_fma_f32 v[44:45], v[136:137], v[128:129], v[44:45] neg_lo:[1,0,0] neg_hi:[1,0,0]
    v_pk_fma_f32 v[46:47], v[136:137], v[130:131], v[46:47] neg_lo:[1,0,0] neg_hi:[1,0,0]
    v_pk_mul_f32 v[40:41], v[138:139], v[40:41]
    v_pk_mul_f32 v[42:43], v[138:139], v[42:43]
    v_pk_mul_f32 v[44:45], v[138:139], v[44:45]
    v_pk_mul_f32 v[46:47], v[138:139], v[46:47]
    v_cvt_pk_bf16_f32 v40, v40, v41
    v_cvt_pk_bf16_f32 v41, v42, v43
    v_cvt_pk_bf16_f32 v42, v44, v45
    v_cvt_pk_bf16_f32 v43, v46, v47
    v_pk_fma_f32 v[8:9], v[140:141], v[116:117], v[8:9] neg_lo:[1,0,0] neg_hi:[1,0,0]
    v_pk_fma_f32 v[10:11], v[140:141], v[118:119], v[10:11] neg_lo:[1,0,0] neg_hi:[1,0,0]
    v_pk_fma_f32 v[12:13], v[140:141], v[120:121], v[12:13] neg_lo:[1,0,0] neg_hi:[1,0,0]
    v_pk_fma_f32 v[14:15], v[140:141], v[122:123], v[14:15] neg_lo:[1,0,0] neg_hi:[1,0,0]
    v_cvt_pk_bf16_f32 v8, v8, v9
    v_cvt_pk_bf16_f32 v9, v10, v11
    v_cvt_pk_bf16_f32 v10, v12, v13
    v_cvt_pk_bf16_f32 v11, v14, v15
    v_mul_f32 v201, s23, v142
    ds_read2_b32 v[172:173], v240 offset0:64 offset1:66
    ds_read2_b32 v[174:175], v240 offset0:68 offset1:70
    ds_read2_b32 v[176:177], v240 offset0:65 offset1:67
    ds_read2_b32 v[178:179], v240 offset0:69 offset1:71
    v_pk_fma_f32 v[48:49], v[140:141], v[124:125], v[48:49] neg_lo:[1,0,0] neg_hi:[1,0,0]
    v_pk_fma_f32 v[50:51], v[140:141], v[126:127], v[50:51] neg_lo:[1,0,0] neg_hi:[1,0,0]
    v_pk_fma_f32 v[52:53], v[140:141], v[128:129], v[52:53] neg_lo:[1,0,0] neg_hi:[1,0,0]
    v_pk_fma_f32 v[54:55], v[140:141], v[130:131], v[54:55] neg_lo:[1,0,0] neg_hi:[1,0,0]
    v_pk_mul_f32 v[48:49], v[142:143], v[48:49]
    v_pk_mul_f32 v[50:51], v[142:143], v[50:51]
    v_pk_mul_f32 v[52:53], v[142:143], v[52:53]
    v_pk_mul_f32 v[54:55], v[142:143], v[54:55]
    v_cvt_pk_bf16_f32 v48, v48, v49
    v_cvt_pk_bf16_f32 v49, v50, v51
    v_cvt_pk_bf16_f32 v50, v52, v53
    v_cvt_pk_bf16_f32 v51, v54, v55
    s_waitcnt lgkmcnt(4)
    v_pk_fma_f32 v[16:17], v[144:145], v[116:117], v[16:17] neg_lo:[1,0,0] neg_hi:[1,0,0]
    v_pk_fma_f32 v[18:19], v[144:145], v[118:119], v[18:19] neg_lo:[1,0,0] neg_hi:[1,0,0]
    v_pk_fma_f32 v[20:21], v[144:145], v[120:121], v[20:21] neg_lo:[1,0,0] neg_hi:[1,0,0]
    v_pk_fma_f32 v[22:23], v[144:145], v[122:123], v[22:23] neg_lo:[1,0,0] neg_hi:[1,0,0]
    v_cvt_pk_bf16_f32 v16, v16, v17
    v_cvt_pk_bf16_f32 v17, v18, v19
    v_cvt_pk_bf16_f32 v18, v20, v21
    v_cvt_pk_bf16_f32 v19, v22, v23
    v_mul_f32 v202, s23, v146
    ds_read2_b32 v[180:181], v240 offset0:96 offset1:98
    ds_read2_b32 v[182:183], v240 offset0:100 offset1:102
    ds_read2_b32 v[184:185], v240 offset0:97 offset1:99
    ds_read2_b32 v[186:187], v240 offset0:101 offset1:103
    v_pk_fma_f32 v[56:57], v[144:145], v[124:125], v[56:57] neg_lo:[1,0,0] neg_hi:[1,0,0]
    v_pk_fma_f32 v[58:59], v[144:145], v[126:127], v[58:59] neg_lo:[1,0,0] neg_hi:[1,0,0]
    v_pk_fma_f32 v[60:61], v[144:145], v[128:129], v[60:61] neg_lo:[1,0,0] neg_hi:[1,0,0]
    v_pk_fma_f32 v[62:63], v[144:145], v[130:131], v[62:63] neg_lo:[1,0,0] neg_hi:[1,0,0]
    v_pk_mul_f32 v[56:57], v[146:147], v[56:57]
    v_pk_mul_f32 v[58:59], v[146:147], v[58:59]
    v_pk_mul_f32 v[60:61], v[146:147], v[60:61]
    v_pk_mul_f32 v[62:63], v[146:147], v[62:63]
    v_cvt_pk_bf16_f32 v56, v56, v57
    v_cvt_pk_bf16_f32 v57, v58, v59
    v_cvt_pk_bf16_f32 v58, v60, v61
    v_cvt_pk_bf16_f32 v59, v62, v63
    v_pk_fma_f32 v[24:25], v[148:149], v[116:117], v[24:25] neg_lo:[1,0,0] neg_hi:[1,0,0]
    v_pk_fma_f32 v[26:27], v[148:149], v[118:119], v[26:27] neg_lo:[1,0,0] neg_hi:[1,0,0]
    v_pk_fma_f32 v[28:29], v[148:149], v[120:121], v[28:29] neg_lo:[1,0,0] neg_hi:[1,0,0]
    v_pk_fma_f32 v[30:31], v[148:149], v[122:123], v[30:31] neg_lo:[1,0,0] neg_hi:[1,0,0]
    v_cvt_pk_bf16_f32 v24, v24, v25
    v_cvt_pk_bf16_f32 v25, v26, v27
    v_cvt_pk_bf16_f32 v26, v28, v29
    v_cvt_pk_bf16_f32 v27, v30, v31
    v_mul_f32 v203, s23, v150
    ds_read2_b32 v[188:189], v240 offset0:128 offset1:130
    ds_read2_b32 v[190:191], v240 offset0:132 offset1:134
    ds_read2_b32 v[192:193], v240 offset0:129 offset1:131
    ds_read2_b32 v[194:195], v240 offset0:133 offset1:135
    v_pk_fma_f32 v[64:65], v[148:149], v[124:125], v[64:65] neg_lo:[1,0,0] neg_hi:[1,0,0]
    v_pk_fma_f32 v[66:67], v[148:149], v[126:127], v[66:67] neg_lo:[1,0,0] neg_hi:[1,0,0]
    v_pk_fma_f32 v[68:69], v[148:149], v[128:129], v[68:69] neg_lo:[1,0,0] neg_hi:[1,0,0]
    v_pk_fma_f32 v[70:71], v[148:149], v[130:131], v[70:71] neg_lo:[1,0,0] neg_hi:[1,0,0]
    v_pk_mul_f32 v[64:65], v[150:151], v[64:65]
    v_pk_mul_f32 v[66:67], v[150:151], v[66:67]
    v_pk_mul_f32 v[68:69], v[150:151], v[68:69]
    v_pk_mul_f32 v[70:71], v[150:151], v[70:71]
    v_cvt_pk_bf16_f32 v64, v64, v65
    v_cvt_pk_bf16_f32 v65, v66, v67
    v_cvt_pk_bf16_f32 v66, v68, v69
    v_cvt_pk_bf16_f32 v67, v70, v71
    ds_read2_b32 v[156:157], v240 offset0:0 offset1:2
    ds_read2_b32 v[158:159], v240 offset0:4 offset1:6
    ds_read2_b32 v[160:161], v240 offset0:1 offset1:3
    ds_read2_b32 v[162:163], v240 offset0:5 offset1:7
    s_waitcnt lgkmcnt(4)
    v_pk_fma_f32 v[32:33], v[132:133], v[124:125], v[32:33] neg_lo:[1,0,0] neg_hi:[1,0,0]
    v_pk_fma_f32 v[34:35], v[132:133], v[126:127], v[34:35] neg_lo:[1,0,0] neg_hi:[1,0,0]
    v_pk_fma_f32 v[36:37], v[132:133], v[128:129], v[36:37] neg_lo:[1,0,0] neg_hi:[1,0,0]
    v_pk_fma_f32 v[38:39], v[132:133], v[130:131], v[38:39] neg_lo:[1,0,0] neg_hi:[1,0,0]
    v_pk_mul_f32 v[32:33], v[134:135], v[32:33]
    v_pk_mul_f32 v[34:35], v[134:135], v[34:35]
    v_pk_mul_f32 v[36:37], v[134:135], v[36:37]
    v_pk_mul_f32 v[38:39], v[134:135], v[38:39]
    v_cvt_pk_bf16_f32 v32, v32, v33
    v_cvt_pk_bf16_f32 v33, v34, v35
    v_cvt_pk_bf16_f32 v34, v36, v37
    v_cvt_pk_bf16_f32 v35, v38, v39
    v_readfirstlane_b32 s78, v241
    s_mov_b32 s59, s78
    s_mul_i32 s60, s59, s75
    v_mfma_f32_16x16x32_bf16 v[116:119], v[40:43], v[0:3], 0
    v_mfma_f32_16x16x32_bf16 v[120:123], v[32:35], v[0:3], 0
    v_mfma_f32_16x16x32_bf16 v[124:127], v[48:51], v[8:11], 0
    v_mfma_f32_16x16x32_bf16 v[128:131], v[40:43], v[8:11], 0
    v_mfma_f32_16x16x32_bf16 v[132:135], v[56:59], v[16:19], 0
    v_mfma_f32_16x16x32_bf16 v[136:139], v[48:51], v[16:19], 0
    v_mfma_f32_16x16x32_bf16 v[140:143], v[64:67], v[24:27], 0
    v_mfma_f32_16x16x32_bf16 v[144:147], v[56:59], v[24:27], 0
    v_pk_fma_f32 v[80:81], v[164:165], v[196:197], v[80:81] neg_lo:[1,0,0] neg_hi:[1,0,0]
    v_pk_fma_f32 v[82:83], v[166:167], v[196:197], v[82:83] neg_lo:[1,0,0] neg_hi:[1,0,0]
    v_pk_mul_f32 v[80:81], v[168:169], v[80:81]
    v_pk_mul_f32 v[82:83], v[170:171], v[82:83]
    v_cvt_pk_bf16_f32 v214, v80, v81
    v_cvt_pk_bf16_f32 v215, v82, v83
    v_pk_fma_f32 v[84:85], v[164:165], v[198:199], v[84:85] neg_lo:[1,0,0] neg_hi:[1,0,0]
    v_pk_fma_f32 v[86:87], v[166:167], v[198:199], v[86:87] neg_lo:[1,0,0] neg_hi:[1,0,0]
    v_pk_mul_f32 v[84:85], v[168:169], v[84:85]
    v_pk_mul_f32 v[86:87], v[170:171], v[86:87]
    v_cvt_pk_bf16_f32 v224, v84, v85
    v_cvt_pk_bf16_f32 v225, v86, v87
    v_pk_fma_f32 v[88:89], v[172:173], v[196:197], v[88:89] neg_lo:[1,0,0] neg_hi:[1,0,0]
    v_pk_fma_f32 v[90:91], v[174:175], v[196:197], v[90:91] neg_lo:[1,0,0] neg_hi:[1,0,0]
    v_pk_mul_f32 v[88:89], v[176:177], v[88:89]
    v_pk_mul_f32 v[90:91], v[178:179], v[90:91]
    v_cvt_pk_bf16_f32 v216, v88, v89
    v_cvt_pk_bf16_f32 v217, v90, v91
    v_pk_fma_f32 v[92:93], v[172:173], v[198:199], v[92:93] neg_lo:[1,0,0] neg_hi:[1,0,0]
    v_pk_fma_f32 v[94:95], v[174:175], v[198:199], v[94:95] neg_lo:[1,0,0] neg_hi:[1,0,0]
    v_pk_mul_f32 v[92:93], v[176:177], v[92:93]
    v_pk_mul_f32 v[94:95], v[178:179], v[94:95]
    v_cvt_pk_bf16_f32 v226, v92, v93
    v_cvt_pk_bf16_f32 v227, v94, v95
    v_pk_fma_f32 v[96:97], v[180:181], v[196:197], v[96:97] neg_lo:[1,0,0] neg_hi:[1,0,0]
    v_pk_fma_f32 v[98:99], v[182:183], v[196:197], v[98:99] neg_lo:[1,0,0] neg_hi:[1,0,0]
    v_pk_mul_f32 v[96:97], v[184:185], v[96:97]
    v_pk_mul_f32 v[98:99], v[186:187], v[98:99]
    v_cvt_pk_bf16_f32 v218, v96, v97
    v_cvt_pk_bf16_f32 v219, v98, v99
    v_pk_fma_f32 v[100:101], v[180:181], v[198:199], v[100:101] neg_lo:[1,0,0] neg_hi:[1,0,0]
    v_pk_fma_f32 v[102:103], v[182:183], v[198:199], v[102:103] neg_lo:[1,0,0] neg_hi:[1,0,0]
    v_pk_mul_f32 v[100:101], v[184:185], v[100:101]
    v_pk_mul_f32 v[102:103], v[186:187], v[102:103]
    v_cvt_pk_bf16_f32 v228, v100, v101
    v_cvt_pk_bf16_f32 v229, v102, v103
    v_pk_fma_f32 v[104:105], v[188:189], v[196:197], v[104:105] neg_lo:[1,0,0] neg_hi:[1,0,0]
    v_pk_fma_f32 v[106:107], v[190:191], v[196:197], v[106:107] neg_lo:[1,0,0] neg_hi:[1,0,0]
    v_pk_mul_f32 v[104:105], v[192:193], v[104:105]
    v_pk_mul_f32 v[106:107], v[194:195], v[106:107]
    v_cvt_pk_bf16_f32 v220, v104, v105
    v_cvt_pk_bf16_f32 v221, v106, v107
    v_pk_fma_f32 v[108:109], v[188:189], v[198:199], v[108:109] neg_lo:[1,0,0] neg_hi:[1,0,0]
    v_pk_fma_f32 v[110:111], v[190:191], v[198:199], v[110:111] neg_lo:[1,0,0] neg_hi:[1,0,0]
    v_pk_mul_f32 v[108:109], v[192:193], v[108:109]
    v_pk_mul_f32 v[110:111], v[194:195], v[110:111]
    v_cvt_pk_bf16_f32 v230, v108, v109
    v_cvt_pk_bf16_f32 v231, v110, v111
    s_waitcnt lgkmcnt(0)
    v_pk_fma_f32 v[72:73], v[156:157], v[196:197], v[72:73] neg_lo:[1,0,0] neg_hi:[1,0,0]
    v_pk_fma_f32 v[74:75], v[158:159], v[196:197], v[74:75] neg_lo:[1,0,0] neg_hi:[1,0,0]
    v_pk_mul_f32 v[72:73], v[160:161], v[72:73]
    v_pk_mul_f32 v[74:75], v[162:163], v[74:75]
    v_cvt_pk_bf16_f32 v212, v72, v73
    v_cvt_pk_bf16_f32 v213, v74, v75
    v_pk_fma_f32 v[76:77], v[156:157], v[198:199], v[76:77] neg_lo:[1,0,0] neg_hi:[1,0,0]
    v_pk_fma_f32 v[78:79], v[158:159], v[198:199], v[78:79] neg_lo:[1,0,0] neg_hi:[1,0,0]
    v_pk_mul_f32 v[76:77], v[160:161], v[76:77]
    v_pk_mul_f32 v[78:79], v[162:163], v[78:79]
    v_cvt_pk_bf16_f32 v222, v76, v77
    v_cvt_pk_bf16_f32 v223, v78, v79
    s_mov_b64 vcc, s[28:29]
    v_mov_b32 v4, 0xf149f2ca
    v_cndmask_b32 v116, v116, v117, vcc
    v_cndmask_b32 v120, v120, v121, vcc
    v_cndmask_b32 v118, v118, v119, vcc
    v_cndmask_b32 v122, v122, v123, vcc
    v_cndmask_b32 v148, v120, v116, s[30:31]
    v_cndmask_b32 v149, v122, v118, s[32:33]
    v_cndmask_b32 v124, v124, v125, vcc
    v_cndmask_b32 v128, v128, v129, vcc
    v_cndmask_b32 v126, v126, v127, vcc
    v_cndmask_b32 v130, v130, v131, vcc
    v_cndmask_b32 v150, v128, v124, s[30:31]
    v_cndmask_b32 v151, v130, v126, s[32:33]
    v_cndmask_b32 v132, v132, v133, vcc
    v_cndmask_b32 v136, v136, v137, vcc
    v_cndmask_b32 v134, v134, v135, vcc
    v_cndmask_b32 v138, v138, v139, vcc
    v_cndmask_b32 v152, v136, v132, s[30:31]
    v_cndmask_b32 v153, v138, v134, s[32:33]
    v_cndmask_b32 v140, v140, v141, vcc
    v_cndmask_b32 v144, v144, v145, vcc
    v_cndmask_b32 v142, v142, v143, vcc
    v_cndmask_b32 v146, v146, v147, vcc
    v_cndmask_b32 v154, v144, v140, s[30:31]
    v_cndmask_b32 v155, v146, v142, s[32:33]
    v_cndmask_b32 v148, v4, v148, s[34:35]
    v_cndmask_b32 v149, v4, v149, s[36:37]
    v_max_f32 v0, v148, v149
    v_max_f32 v1, v150, v151
    v_max_f32 v2, v152, v153
    v_max_f32 v3, v154, v155
    s_nop 0
    v_permlane16_swap_b32 v0, v1
    v_permlane16_swap_b32 v2, v3
    v_max_f32 v0, v0, v1
    v_max_f32 v2, v2, v3
    s_nop 1
    v_permlane32_swap_b32 v0, v2
    v_max_f32 v0, v0, v2
    v_mov_b32 v2, v0
    s_nop 1
    v_permlane32_swap_b32 v0, v2
    v_mov_b32 v1, v0
    v_mov_b32 v3, v2
    s_nop 0
    v_permlane16_swap_b32 v0, v1
    v_permlane16_swap_b32 v2, v3
    v_sub_f32 v148, v148, v0
    v_sub_f32 v149, v149, v0
    v_sub_f32 v150, v150, v1
    v_sub_f32 v151, v151, v1
    v_sub_f32 v152, v152, v2
    v_sub_f32 v153, v153, v2
    v_sub_f32 v154, v154, v3
    v_sub_f32 v155, v155, v3
    v_mul_f32 v148, v200, v148
    v_mul_f32 v149, v200, v149
    v_mul_f32 v150, v201, v150
    v_mul_f32 v151, v201, v151
    v_mul_f32 v152, v202, v152
    v_mul_f32 v153, v202, v153
    v_mul_f32 v154, v203, v154
    v_mul_f32 v155, v203, v155
    v_exp_f32 v148, v148
    v_exp_f32 v149, v149
    v_exp_f32 v150, v150
    v_exp_f32 v151, v151
    v_exp_f32 v152, v152
    v_exp_f32 v153, v153
    v_exp_f32 v154, v154
    v_exp_f32 v155, v155
    v_add_f32 v0, v148, v149
    v_add_f32 v1, v150, v151
    v_add_f32 v2, v152, v153
    v_add_f32 v3, v154, v155
    s_nop 0
    v_permlane16_swap_b32 v0, v1
    v_permlane16_swap_b32 v2, v3
    v_add_f32 v0, v0, v1
    v_add_f32 v2, v2, v3
    s_nop 1
    v_permlane32_swap_b32 v0, v2
    v_add_f32 v0, v0, v2
    v_rcp_f32 v0, v0
    s_nop 0
    v_mov_b32 v2, v0
    s_nop 1
    v_permlane32_swap_b32 v0, v2
    v_mov_b32 v1, v0
    v_mov_b32 v3, v2
    s_nop 0
    v_permlane16_swap_b32 v0, v1
    v_permlane16_swap_b32 v2, v3
    v_mul_f32 v148, v148, v0
    v_mul_f32 v149, v149, v0
    v_cvt_pk_bf16_f32 v148, v148, v148
    v_cvt_pk_bf16_f32 v149, v149, v149
    v_and_b32 v8, v148, v232
    v_and_b32 v9, v149, v233
    v_and_b32 v10, v148, v234
    v_and_b32 v11, v149, v235
    v_mul_f32 v150, v150, v1
    v_mul_f32 v151, v151, v1
    v_cvt_pk_bf16_f32 v150, v150, v150
    v_cvt_pk_bf16_f32 v151, v151, v151
    v_and_b32 v12, v150, v232
    v_and_b32 v13, v151, v233
    v_and_b32 v14, v150, v234
    v_and_b32 v15, v151, v235
    v_mfma_f32_16x16x32_bf16 v[24:27], v[212:215], v[8:11], 0
    v_mfma_f32_16x16x32_bf16 v[28:31], v[222:225], v[8:11], 0
    v_mul_f32 v152, v152, v2
    v_mul_f32 v153, v153, v2
    v_cvt_pk_bf16_f32 v152, v152, v152
    v_cvt_pk_bf16_f32 v153, v153, v153
    v_and_b32 v16, v152, v232
    v_and_b32 v17, v153, v233
    v_and_b32 v18, v152, v234
    v_and_b32 v19, v153, v235
    v_mfma_f32_16x16x32_bf16 v[32:35], v[214:217], v[12:15], 0
    v_mfma_f32_16x16x32_bf16 v[36:39], v[224:227], v[12:15], 0
    v_mul_f32 v154, v154, v3
    v_mul_f32 v155, v155, v3
    v_cvt_pk_bf16_f32 v154, v154, v154
    v_cvt_pk_bf16_f32 v155, v155, v155
    v_and_b32 v20, v154, v232
    v_and_b32 v21, v155, v233
    v_and_b32 v22, v154, v234
    v_and_b32 v23, v155, v235
    v_mfma_f32_16x16x32_bf16 v[40:43], v[216:219], v[16:19], 0
    v_mfma_f32_16x16x32_bf16 v[44:47], v[226:229], v[16:19], 0
    v_mfma_f32_16x16x32_bf16 v[48:51], v[218:221], v[20:23], 0
    v_mfma_f32_16x16x32_bf16 v[52:55], v[228:231], v[20:23], 0
    v_cvt_pk_bf16_f32 v56, v24, v25
    v_cvt_pk_bf16_f32 v57, v26, v27
    v_cvt_pk_bf16_f32 v58, v28, v29
    v_cvt_pk_bf16_f32 v59, v30, v31
    buffer_store_dwordx4 v[56:59], v249, s[80:83], s21 offen offset:0
    v_cvt_pk_bf16_f32 v60, v32, v33
    v_cvt_pk_bf16_f32 v61, v34, v35
    v_cvt_pk_bf16_f32 v62, v36, v37
    v_cvt_pk_bf16_f32 v63, v38, v39
    buffer_store_dwordx4 v[60:63], v249, s[80:83], s21 offen offset:1024
    v_cvt_pk_bf16_f32 v64, v40, v41
    v_cvt_pk_bf16_f32 v65, v42, v43
    v_cvt_pk_bf16_f32 v66, v44, v45
    v_cvt_pk_bf16_f32 v67, v46, v47
    buffer_store_dwordx4 v[64:67], v249, s[80:83], s21 offen offset:2048
    v_cvt_pk_bf16_f32 v68, v48, v49
    v_cvt_pk_bf16_f32 v69, v50, v51
    v_cvt_pk_bf16_f32 v70, v52, v53
    v_cvt_pk_bf16_f32 v71, v54, v55
    buffer_store_dwordx4 v[68:71], v249, s[80:83], s21 offen offset:3072
    s_lshl_b32 s64, s75, 15
    s_lshl_b32 s66, s73, 9
    s_add_u32 s64, s64, s66
    s_add_u32 s64, s64, 75497472
    s_lshl_b32 s65, s72, 5
    s_add_u32 s64, s64, s65
    s_lshl_b32 s65, s3, 2
    s_add_u32 s64, s64, s65
    v_mov_b32 v108, 0
    v_mov_b32 v109, 1
    s_cmp_lg_u32 s78, 0
    s_cbranch_scc1 sg_3_slow
    s_waitcnt vmcnt(0)
    s_mov_b64 exec, 1
    buffer_store_dword v109, v108, s[80:83], s64 offen
    s_mov_b64 exec, -1
sg_3_done:
    s_lshr_b32 s64, s3, 1
    s_lshl_b32 s64, s64, 12
    v_add_u32 v240, s64, v249
    v_lshrrev_b32 v253, 2, v252
    v_mul_u32_u24 v253, 1056, v253
    v_lshl_add_u32 v253, v251, 7, v253
    v_and_b32 v254, 3, v252
    v_lshl_add_u32 v253, v254, 3, v253
    s_and_b32 s64, s3, 1
    s_lshl_b32 s64, s64, 6
    s_add_u32 s64, s64, 65536
    v_add_u32 v241, s64, v253
    s_mov_b32 s16, 50688
    v_add_u32 v242, s16, v241
    s_mov_b32 s25, s72
    s_lshl_b32 s18, s73, 4
    s_add_u32 s18, s18, s72
    s_lshl_b32 s18, s18, 14
    s_and_b32 s64, s3, 1
    s_lshl_b32 s64, s64, 13
    s_add_u32 s18, s18, s64
    s_lshr_b32 s64, s3, 1
    s_lshl_b32 s64, s64, 12
    s_add_u32 s18, s18, s64
    s_mov_b32 s20, s18
    s_lshl_b32 s66, s75, 23
    s_add_u32 s20, s20, s66
    s_add_u32 s18, s18, 4194304
    s_cmp_lg_u32 s75, 0
    s_cbranch_scc1 xo_4_f
    s_mov_b32 s8, s84
    s_mov_b32 s9, s85
    s_mov_b32 s10, 4194304
    s_mov_b32 s11, 0x00020000
    s_lshl_b32 s64, s73, 1
    s_lshr_b32 s65, s3, 1
    s_add_u32 s64, s64, s65
    s_lshl_b32 s64, s64, 17
    s_and_b32 s65, s3, 1
    s_lshl_b32 s65, s65, 6
    s_add_u32 s64, s64, s65
    s_lshl_b32 s65, s25, 7
    s_add_u32 s64, s64, s65
    v_lshlrev_b32 v243, 11, v252
    v_add_u32 v243, s64, v243
    v_lshl_add_u32 v243, v251, 3, v243
    s_mov_b32 s64, 0
    buffer_load_dwordx2 v[128:129], v243, s[8:11], s64 offen
    buffer_load_dwordx2 v[130:131], v243, s[8:11], s64 offen offset:32
    s_mov_b32 s64, 32768
    buffer_load_dwordx2 v[132:133], v243, s[8:11], s64 offen
    buffer_load_dwordx2 v[134:135], v243, s[8:11], s64 offen offset:32
    s_mov_b32 s64, 65536
    buffer_load_dwordx2 v[136:137], v243, s[8:11], s64 offen
    buffer_load_dwordx2 v[138:139], v243, s[8:11], s64 offen offset:32
    s_mov_b32 s64, 98304
    buffer_load_dwordx2 v[140:141], v243, s[8:11], s64 offen
    buffer_load_dwordx2 v[142:143], v243, s[8:11], s64 offen offset:32
    s_branch xo_4_d
xo_4_f:
    buffer_load_dwordx4 v[128:131], v249, s[80:83], s18 offen offset:0 sc1
    buffer_load_dwordx4 v[132:135], v249, s[80:83], s18 offen offset:1024 sc1
    buffer_load_dwordx4 v[136:139], v249, s[80:83], s18 offen offset:2048 sc1
    buffer_load_dwordx4 v[140:143], v249, s[80:83], s18 offen offset:3072 sc1
xo_4_d:
    s_lshl_b32 s24, s73, 4
    s_add_u32 s24, s24, s25
    s_lshl_b32 s24, s24, 11
    s_lshl_b32 s65, s75, 20
    s_add_u32 s24, s24, s65
    s_add_u32 s24, s24, 71303168
    s_lshr_b32 s65, s3, 1
    s_lshl_b32 s65, s65, 10
    s_add_u32 s24, s24, s65
    s_and_b32 s65, s3, 1
    s_lshl_b32 s65, s65, 3
    s_add_u32 s24, s24, s65
    v_mov_b32 v239, v249
    v_mov_b32 v208, 0
    v_mov_b32 v209, 0
    v_mov_b32 v210, 0
    v_mov_b32 v211, 0
    s_nop 1
    v_mfma_f32_32x32x16_bf16 v[0:15], v[208:211], v[208:211], 0
    v_mfma_f32_32x32x16_bf16 v[16:31], v[208:211], v[208:211], 0
    s_mov_b32 s17, 8
    s_waitcnt lgkmcnt(0)
    s_barrier
    ds_read_b128 v[32:35], v240 offset:0
    ds_read_b64_tr_b16 v[48:49], v242 offset:0
    ds_read_b64_tr_b16 v[50:51], v242 offset:512
    ds_read_b128 v[36:39], v240 offset:1024
    ds_read_b64_tr_b16 v[52:53], v242 offset:32
    ds_read_b64_tr_b16 v[54:55], v242 offset:544
    ds_read_b128 v[40:43], v240 offset:2048
    ds_read_b128 v[44:47], v240 offset:3072
    ds_read_b128 v[56:59], v240 offset:8192
    ds_read_b64_tr_b16 v[72:73], v242 offset:4224
    ds_read_b64_tr_b16 v[74:75], v242 offset:4736
    ds_read_b128 v[60:63], v240 offset:9216
    ds_read_b64_tr_b16 v[76:77], v242 offset:4256
    ds_read_b64_tr_b16 v[78:79], v242 offset:4768
    ds_read_b128 v[64:67], v240 offset:10240
    ds_read_b128 v[68:71], v240 offset:11264
    v_add_u16 v240, 0x4000, v240
    s_add_u32 s16, s16, 8448
    s_cmp_eq_u32 s16, 92928
    s_cselect_b32 s16, 0, s16
    v_add_u32 v242, s16, v241
    s_waitcnt lgkmcnt(0)
r1_loop:
    s_bitcmp1_b32 2, s17
    s_cbranch_scc1 r1_nb0
    s_barrier
r1_nb0:
    v_mfma_f32_16x16x32_bf16 v[0:3], v[48:51], v[32:35], v[0:3]
    ds_read_b128 v[80:83], v240 offset:0
    ds_read_b64_tr_b16 v[96:97], v242 offset:0
    v_mfma_f32_16x16x32_bf16 v[8:11], v[48:51], v[36:39], v[8:11]
    ds_read_b64_tr_b16 v[98:99], v242 offset:512
    v_mfma_f32_16x16x32_bf16 v[16:19], v[48:51], v[40:43], v[16:19]
    ds_read_b128 v[84:87], v240 offset:1024
    ds_read_b64_tr_b16 v[100:101], v242 offset:32
    v_mfma_f32_16x16x32_bf16 v[24:27], v[48:51], v[44:47], v[24:27]
    ds_read_b64_tr_b16 v[102:103], v242 offset:544
    v_mfma_f32_16x16x32_bf16 v[4:7], v[52:55], v[32:35], v[4:7]
    ds_read_b128 v[88:91], v240 offset:2048
    ds_read_b128 v[92:95], v240 offset:3072
    v_mfma_f32_16x16x32_bf16 v[12:15], v[52:55], v[36:39], v[12:15]
    ds_read_b128 v[104:107], v240 offset:8192
    v_mfma_f32_16x16x32_bf16 v[20:23], v[52:55], v[40:43], v[20:23]
    ds_read_b64_tr_b16 v[120:121], v242 offset:4224
    ds_read_b64_tr_b16 v[122:123], v242 offset:4736
    v_mfma_f32_16x16x32_bf16 v[28:31], v[52:55], v[44:47], v[28:31]
    ds_read_b128 v[108:111], v240 offset:9216
    v_mfma_f32_16x16x32_bf16 v[0:3], v[72:75], v[56:59], v[0:3]
    ds_read_b64_tr_b16 v[124:125], v242 offset:4256
    ds_read_b64_tr_b16 v[126:127], v242 offset:4768
    v_mfma_f32_16x16x32_bf16 v[8:11], v[72:75], v[60:63], v[8:11]
    ds_read_b128 v[112:115], v240 offset:10240
    v_mfma_f32_16x16x32_bf16 v[16:19], v[72:75], v[64:67], v[16:19]
    ds_read_b128 v[116:119], v240 offset:11264
    v_mfma_f32_16x16x32_bf16 v[24:27], v[72:75], v[68:71], v[24:27]
    v_add_u16 v240, 0x4000, v240
    v_mfma_f32_16x16x32_bf16 v[4:7], v[76:79], v[56:59], v[4:7]
    s_add_u32 s16, s16, 8448
    s_cmp_eq_u32 s16, 92928
    v_mfma_f32_16x16x32_bf16 v[12:15], v[76:79], v[60:63], v[12:15]
    s_cselect_b32 s16, 0, s16
    v_mfma_f32_16x16x32_bf16 v[20:23], v[76:79], v[64:67], v[20:23]
    v_add_u32 v242, s16, v241
    v_mfma_f32_16x16x32_bf16 v[28:31], v[76:79], v[68:71], v[28:31]
    s_waitcnt lgkmcnt(0)
    s_bitcmp1_b32 2, s17
    s_cbranch_scc1 r1_nb1
    s_barrier
r1_nb1:
    v_mfma_f32_16x16x32_bf16 v[0:3], v[96:99], v[80:83], v[0:3]
    ds_read_b128 v[32:35], v240 offset:0
    ds_read_b64_tr_b16 v[48:49], v242 offset:0
    v_mfma_f32_16x16x32_bf16 v[8:11], v[96:99], v[84:87], v[8:11]
    ds_read_b64_tr_b16 v[50:51], v242 offset:512
    v_mfma_f32_16x16x32_bf16 v[16:19], v[96:99], v[88:91], v[16:19]
    ds_read_b128 v[36:39], v240 offset:1024
    ds_read_b64_tr_b16 v[52:53], v242 offset:32
    v_mfma_f32_16x16x32_bf16 v[24:27], v[96:99], v[92:95], v[24:27]
    ds_read_b64_tr_b16 v[54:55], v242 offset:544
    v_mfma_f32_16x16x32_bf16 v[4:7], v[100:103], v[80:83], v[4:7]
    ds_read_b128 v[40:43], v240 offset:2048
    ds_read_b128 v[44:47], v240 offset:3072
    v_mfma_f32_16x16x32_bf16 v[12:15], v[100:103], v[84:87], v[12:15]
    ds_read_b128 v[56:59], v240 offset:8192
    v_mfma_f32_16x16x32_bf16 v[20:23], v[100:103], v[88:91], v[20:23]
    ds_read_b64_tr_b16 v[72:73], v242 offset:4224
    ds_read_b64_tr_b16 v[74:75], v242 offset:4736
    v_mfma_f32_16x16x32_bf16 v[28:31], v[100:103], v[92:95], v[28:31]
    ds_read_b128 v[60:63], v240 offset:9216
    v_mfma_f32_16x16x32_bf16 v[0:3], v[120:123], v[104:107], v[0:3]
    ds_read_b64_tr_b16 v[76:77], v242 offset:4256
    ds_read_b64_tr_b16 v[78:79], v242 offset:4768
    v_mfma_f32_16x16x32_bf16 v[8:11], v[120:123], v[108:111], v[8:11]
    ds_read_b128 v[64:67], v240 offset:10240
    v_mfma_f32_16x16x32_bf16 v[16:19], v[120:123], v[112:115], v[16:19]
    ds_read_b128 v[68:71], v240 offset:11264
    v_mfma_f32_16x16x32_bf16 v[24:27], v[120:123], v[116:119], v[24:27]
    v_add_u16 v240, 0x4000, v240
    s_add_u32 s16, s16, 8448
    s_cmp_eq_u32 s16, 92928
    v_mfma_f32_16x16x32_bf16 v[4:7], v[124:127], v[104:107], v[4:7]
    s_cselect_b32 s16, 0, s16
    v_mfma_f32_16x16x32_bf16 v[12:15], v[124:127], v[108:111], v[12:15]
    v_add_u32 v242, s16, v241
    v_mfma_f32_16x16x32_bf16 v[20:23], v[124:127], v[112:115], v[20:23]
    s_sub_u32 s17, s17, 1
    s_cmp_lg_u32 s17, 0
    v_mfma_f32_16x16x32_bf16 v[28:31], v[124:127], v[116:119], v[28:31]
    s_waitcnt lgkmcnt(0)
    s_cbranch_scc1 r1_loop
    s_barrier
    s_nop 3
    s_waitcnt vmcnt(0)
    v_lshlrev_b32 v144, 16, v128
    v_and_b32 v145, 0xffff0000, v128
    v_lshlrev_b32 v146, 16, v129
    v_and_b32 v147, 0xffff0000, v129
    v_lshlrev_b32 v148, 16, v130
    v_and_b32 v149, 0xffff0000, v130
    v_lshlrev_b32 v150, 16, v131
    v_and_b32 v151, 0xffff0000, v131
    v_lshlrev_b32 v152, 16, v132
    v_and_b32 v153, 0xffff0000, v132
    v_lshlrev_b32 v154, 16, v133
    v_and_b32 v155, 0xffff0000, v133
    v_lshlrev_b32 v156, 16, v134
    v_and_b32 v157, 0xffff0000, v134
    v_lshlrev_b32 v158, 16, v135
    v_and_b32 v159, 0xffff0000, v135
    v_lshlrev_b32 v160, 16, v136
    v_and_b32 v161, 0xffff0000, v136
    v_lshlrev_b32 v162, 16, v137
    v_and_b32 v163, 0xffff0000, v137
    v_lshlrev_b32 v164, 16, v138
    v_and_b32 v165, 0xffff0000, v138
    v_lshlrev_b32 v166, 16, v139
    v_and_b32 v167, 0xffff0000, v139
    v_lshlrev_b32 v168, 16, v140
    v_and_b32 v169, 0xffff0000, v140
    v_lshlrev_b32 v170, 16, v141
    v_and_b32 v171, 0xffff0000, v141
    v_lshlrev_b32 v172, 16, v142
    v_and_b32 v173, 0xffff0000, v142
    v_lshlrev_b32 v174, 16, v143
    v_and_b32 v175, 0xffff0000, v143
    v_mov_b32 v88, 0x3f803f80
    v_cvt_pk_bf16_f32 v208, v0, v1
    v_cvt_pk_bf16_f32 v209, v2, v3
    v_cvt_pk_bf16_f32 v210, v4, v5
    v_cvt_pk_bf16_f32 v211, v6, v7
    v_lshlrev_b32 v212, 16, v208
    v_and_b32 v213, 0xffff0000, v208
    v_lshlrev_b32 v214, 16, v209
    v_and_b32 v215, 0xffff0000, v209
    v_lshlrev_b32 v216, 16, v210
    v_and_b32 v217, 0xffff0000, v210
    v_lshlrev_b32 v218, 16, v211
    v_and_b32 v219, 0xffff0000, v211
    v_pk_add_f32 v[212:213], v[212:213], v[144:145]
    v_pk_add_f32 v[214:215], v[214:215], v[146:147]
    v_pk_add_f32 v[216:217], v[216:217], v[148:149]
    v_pk_add_f32 v[218:219], v[218:219], v[150:151]
    v_cvt_pk_bf16_f32 v64, v212, v213
    v_cvt_pk_bf16_f32 v65, v214, v215
    v_cvt_pk_bf16_f32 v66, v216, v217
    v_cvt_pk_bf16_f32 v67, v218, v219
    buffer_store_dwordx4 v[64:67], v249, s[80:83], s20 offen offset:0 sc0 sc1
    v_cvt_pk_bf16_f32 v208, v8, v9
    v_cvt_pk_bf16_f32 v209, v10, v11
    v_cvt_pk_bf16_f32 v210, v12, v13
    v_cvt_pk_bf16_f32 v211, v14, v15
    v_lshlrev_b32 v212, 16, v208
    v_and_b32 v213, 0xffff0000, v208
    v_lshlrev_b32 v214, 16, v209
    v_and_b32 v215, 0xffff0000, v209
    v_lshlrev_b32 v216, 16, v210
    v_and_b32 v217, 0xffff0000, v210
    v_lshlrev_b32 v218, 16, v211
    v_and_b32 v219, 0xffff0000, v211
    v_pk_add_f32 v[212:213], v[212:213], v[152:153]
    v_pk_add_f32 v[214:215], v[214:215], v[154:155]
    v_pk_add_f32 v[216:217], v[216:217], v[156:157]
    v_pk_add_f32 v[218:219], v[218:219], v[158:159]
    v_cvt_pk_bf16_f32 v68, v212, v213
    v_cvt_pk_bf16_f32 v69, v214, v215
    v_cvt_pk_bf16_f32 v70, v216, v217
    v_cvt_pk_bf16_f32 v71, v218, v219
    buffer_store_dwordx4 v[68:71], v249, s[80:83], s20 offen offset:1024 sc0 sc1
    v_cvt_pk_bf16_f32 v208, v16, v17
    v_cvt_pk_bf16_f32 v209, v18, v19
    v_cvt_pk_bf16_f32 v210, v20, v21
    v_cvt_pk_bf16_f32 v211, v22, v23
    v_lshlrev_b32 v212, 16, v208
    v_and_b32 v213, 0xffff0000, v208
    v_lshlrev_b32 v214, 16, v209
    v_and_b32 v215, 0xffff0000, v209
    v_lshlrev_b32 v216, 16, v210
    v_and_b32 v217, 0xffff0000, v210
    v_lshlrev_b32 v218, 16, v211
    v_and_b32 v219, 0xffff0000, v211
    v_pk_add_f32 v[212:213], v[212:213], v[160:161]
    v_pk_add_f32 v[214:215], v[214:215], v[162:163]
    v_pk_add_f32 v[216:217], v[216:217], v[164:165]
    v_pk_add_f32 v[218:219], v[218:219], v[166:167]
    v_cvt_pk_bf16_f32 v72, v212, v213
    v_cvt_pk_bf16_f32 v73, v214, v215
    v_cvt_pk_bf16_f32 v74, v216, v217
    v_cvt_pk_bf16_f32 v75, v218, v219
    buffer_store_dwordx4 v[72:75], v249, s[80:83], s20 offen offset:2048 sc0 sc1
    v_cvt_pk_bf16_f32 v208, v24, v25
    v_cvt_pk_bf16_f32 v209, v26, v27
    v_cvt_pk_bf16_f32 v210, v28, v29
    v_cvt_pk_bf16_f32 v211, v30, v31
    v_lshlrev_b32 v212, 16, v208
    v_and_b32 v213, 0xffff0000, v208
    v_lshlrev_b32 v214, 16, v209
    v_and_b32 v215, 0xffff0000, v209
    v_lshlrev_b32 v216, 16, v210
    v_and_b32 v217, 0xffff0000, v210
    v_lshlrev_b32 v218, 16, v211
    v_and_b32 v219, 0xffff0000, v211
    v_pk_add_f32 v[212:213], v[212:213], v[168:169]
    v_pk_add_f32 v[214:215], v[214:215], v[170:171]
    v_pk_add_f32 v[216:217], v[216:217], v[172:173]
    v_pk_add_f32 v[218:219], v[218:219], v[174:175]
    v_cvt_pk_bf16_f32 v76, v212, v213
    v_cvt_pk_bf16_f32 v77, v214, v215
    v_cvt_pk_bf16_f32 v78, v216, v217
    v_cvt_pk_bf16_f32 v79, v218, v219
    buffer_store_dwordx4 v[76:79], v249, s[80:83], s20 offen offset:3072 sc0 sc1
    v_dot2_f32_bf16 v80, v64, v88, 0
    v_dot2_f32_bf16 v84, v64, v64, 0
    v_dot2_f32_bf16 v80, v65, v88, v80
    v_dot2_f32_bf16 v84, v65, v65, v84
    v_dot2_f32_bf16 v80, v66, v88, v80
    v_dot2_f32_bf16 v84, v66, v66, v84
    v_dot2_f32_bf16 v80, v67, v88, v80
    v_dot2_f32_bf16 v84, v67, v67, v84
    v_dot2_f32_bf16 v81, v68, v88, 0
    v_dot2_f32_bf16 v85, v68, v68, 0
    v_dot2_f32_bf16 v81, v69, v88, v81
    v_dot2_f32_bf16 v85, v69, v69, v85
    v_dot2_f32_bf16 v81, v70, v88, v81
    v_dot2_f32_bf16 v85, v70, v70, v85
    v_dot2_f32_bf16 v81, v71, v88, v81
    v_dot2_f32_bf16 v85, v71, v71, v85
    v_dot2_f32_bf16 v82, v72, v88, 0
    v_dot2_f32_bf16 v86, v72, v72, 0
    v_dot2_f32_bf16 v82, v73, v88, v82
    v_dot2_f32_bf16 v86, v73, v73, v86
    v_dot2_f32_bf16 v82, v74, v88, v82
    v_dot2_f32_bf16 v86, v74, v74, v86
    v_dot2_f32_bf16 v82, v75, v88, v82
    v_dot2_f32_bf16 v86, v75, v75, v86
    v_dot2_f32_bf16 v83, v76, v88, 0
    v_dot2_f32_bf16 v87, v76, v76, 0
    v_dot2_f32_bf16 v83, v77, v88, v83
    v_dot2_f32_bf16 v87, v77, v77, v87
    v_dot2_f32_bf16 v83, v78, v88, v83
    v_dot2_f32_bf16 v87, v78, v78, v87
    v_dot2_f32_bf16 v83, v79, v88, v83
    v_dot2_f32_bf16 v87, v79, v79, v87
    s_nop 2
    v_permlane16_swap_b32 v80, v81
    v_permlane16_swap_b32 v82, v83
    v_permlane16_swap_b32 v84, v85
    v_permlane16_swap_b32 v86, v87
    v_add_f32 v80, v80, v81
    v_add_f32 v82, v82, v83
    v_add_f32 v84, v84, v85
    v_add_f32 v86, v86, v87
    s_nop 1
    v_permlane32_swap_b32 v80, v82
    v_permlane32_swap_b32 v84, v86
    v_add_f32 v80, v80, v82
    v_add_f32 v81, v84, v86
    buffer_store_dwordx2 v[80:81], v239, s[80:83], s24 offen sc0 sc1
    s_lshl_b32 s64, s75, 15
    s_lshl_b32 s66, s73, 9
    s_add_u32 s64, s64, s66
    s_add_u32 s64, s64, 75505664
    s_lshl_b32 s65, s72, 5
    s_add_u32 s64, s64, s65
    s_lshl_b32 s65, s3, 2
    s_add_u32 s64, s64, s65
    v_mov_b32 v208, 0
    v_mov_b32 v209, 1
    s_cmp_lg_u32 s78, 0
    s_cbranch_scc1 sg_6_slow
    s_waitcnt vmcnt(0)
    s_mov_b64 exec, 1
    buffer_store_dword v209, v208, s[80:83], s64 offen
    s_mov_b64 exec, -1
sg_6_done:
    s_and_b32 s64, s3, 1
    s_cmp_eq_u32 s64, 0
    s_cselect_b32 s8, s92, s94
    s_cselect_b32 s9, s93, s95
    s_mov_b32 s10, 7340032
    s_mov_b32 s11, 0x00020000
    s_mul_i32 s19, s64, 14400
    s_lshr_b32 s64, s69, 1
    s_mul_i32 s65, s64, 7200
    s_add_u32 s19, s19, s65
    s_add_u32 s19, s19, 36736
    s_mul_i32 s17, s64, 28672
    s_mul_i32 s65, s74, 448
    s_add_u32 s17, s17, s65
    s_add_u32 s18, s17, 7340032
    s_lshl_b32 s64, s57, 1
    s_add_u32 s64, s64, 3
    s_and_b32 s64, s64, 31
    s_mul_i32 s65, s64, 229376
    s_add_u32 s16, s17, s65
    s_mov_b32 s66, 2341
    v_add_u32 v253, 192, v250
    v_mul_lo_u32 v254, v253, s66
    v_lshrrev_b32 v254, 16, v254
    v_mul_u32_u24 v224, 28, v254
    v_sub_u32 v253, v253, v224
    v_and_b32 v224, 12, v254
    v_add_u32 v254, v254, v224
    v_mul_u32_u24 v254, 7168, v254
    v_lshl_add_u32 v224, v253, 4, v254
    v_add_u32 v253, 256, v250
    v_mul_lo_u32 v254, v253, s66
    v_lshrrev_b32 v254, 16, v254
    v_mul_u32_u24 v225, 28, v254
    v_sub_u32 v253, v253, v225
    v_and_b32 v225, 12, v254
    v_add_u32 v254, v254, v225
    v_mul_u32_u24 v254, 7168, v254
    v_lshl_add_u32 v225, v253, 4, v254
    v_add_u32 v253, 320, v250
    v_mul_lo_u32 v254, v253, s66
    v_lshrrev_b32 v254, 16, v254
    v_mul_u32_u24 v226, 28, v254
    v_sub_u32 v253, v253, v226
    v_and_b32 v226, 12, v254
    v_add_u32 v254, v254, v226
    v_mul_u32_u24 v254, 7168, v254
    v_lshl_add_u32 v226, v253, 4, v254
    v_add_u32 v253, 384, v250
    v_mul_lo_u32 v254, v253, s66
    v_lshrrev_b32 v254, 16, v254
    v_mul_u32_u24 v227, 28, v254
    v_sub_u32 v253, v253, v227
    v_and_b32 v227, 12, v254
    v_add_u32 v254, v254, v227
    v_mul_u32_u24 v254, 7168, v254
    v_lshl_add_u32 v227, v253, 4, v254
    s_and_b32 s64, s3, 1
    s_lshl_b32 s64, s64, 12
    v_add_u32 v231, s64, v249
    v_lshrrev_b32 v253, 1, v251
    v_lshrrev_b32 v254, 2, v252
    v_lshl_add_u32 v253, v253, 2, v254
    v_mul_u32_u24 v253, 448, v253
    v_and_b32 v254, 1, v251
    v_mul_u32_u24 v254, 7200, v254
    v_add_u32 v253, v253, v254
    v_and_b32 v254, 3, v252
    v_lshl_add_u32 v253, v254, 3, v253
    v_add_u32 v253, 36736, v253
    s_lshr_b32 s64, s69, 1
    s_lshl_b32 s28, s64, 2
    s_lshl_b32 s65, s28, 5
    v_add_u32 v232, s65, v253
    v_add_u32 v233, 57600, v232
    s_lshl_b32 s25, s73, 1
    s_add_u32 s25, s25, s68
    s_mul_i32 s25, s25, 458752
    s_lshl_b32 s66, s60, 24
    s_add_u32 s25, s25, s66
    s_add_u32 s25, s25, 20971520
    s_and_b32 s64, s74, 7
    s_mul_i32 s64, s64, 57344
    s_add_u32 s25, s25, s64
    v_mov_b32 v192, 0
    v_mov_b32 v193, 0
    v_mov_b32 v194, 0
    v_mov_b32 v195, 0
    s_nop 1
    v_mfma_f32_32x32x16_bf16 v[0:15], v[192:195], v[192:195], 0
    v_mfma_f32_32x32x16_bf16 v[16:31], v[192:195], v[192:195], 0
    v_mfma_f32_32x32x16_bf16 v[32:47], v[192:195], v[192:195], 0
    v_mfma_f32_32x32x16_bf16 v[48:63], v[192:195], v[192:195], 0
    v_mfma_f32_32x32x16_bf16 v[64:79], v[192:195], v[192:195], 0
    v_mfma_f32_32x32x16_bf16 v[80:95], v[192:195], v[192:195], 0
    v_mfma_f32_32x32x16_bf16 v[96:111], v[192:195], v[192:195], 0
    v_mfma_f32_32x32x16_bf16 v[112:127], v[192:195], v[192:195], 0
    s_barrier
    ds_read_b128 v[192:195], v231 offset:0
    ds_read_b128 v[196:199], v231 offset:1024
    ds_read_b128 v[200:203], v231 offset:2048
    ds_read_b128 v[204:207], v231 offset:3072
    ds_read_b64_tr_b16 v[128:129], v232 offset:28800
    ds_read_b64_tr_b16 v[130:131], v232 offset:32384
    ds_read_b64_tr_b16 v[144:145], v232 offset:43200
    ds_read_b64_tr_b16 v[146:147], v232 offset:46784
    ds_read_b64_tr_b16 v[132:133], v232 offset:28832
    ds_read_b64_tr_b16 v[134:135], v232 offset:32416
    ds_read_b64_tr_b16 v[148:149], v232 offset:43232
    ds_read_b64_tr_b16 v[150:151], v232 offset:46816
    ds_read_b64_tr_b16 v[136:137], v232 offset:28864
    ds_read_b64_tr_b16 v[138:139], v232 offset:32448
    ds_read_b64_tr_b16 v[152:153], v232 offset:43264
    ds_read_b64_tr_b16 v[154:155], v232 offset:46848
    ds_read_b64_tr_b16 v[140:141], v232 offset:28896
    ds_read_b64_tr_b16 v[142:143], v232 offset:32480
    ds_read_b64_tr_b16 v[156:157], v232 offset:43296
    ds_read_b64_tr_b16 v[158:159], v232 offset:46880
    s_mov_b32 s24, 7
g3c0_loop:
    s_waitcnt vmcnt(4) lgkmcnt(0)
    s_barrier
    v_mfma_f32_16x16x32_bf16 v[0:3], v[128:131], v[192:195], v[0:3]
    ds_read_b128 v[208:211], v231 offset:8192
    v_mfma_f32_16x16x32_bf16 v[4:7], v[128:131], v[196:199], v[4:7]
    ds_read_b128 v[212:215], v231 offset:9216
    v_mfma_f32_16x16x32_bf16 v[8:11], v[128:131], v[200:203], v[8:11]
    ds_read_b128 v[216:219], v231 offset:10240
    v_mfma_f32_16x16x32_bf16 v[12:15], v[128:131], v[204:207], v[12:15]
    ds_read_b128 v[220:223], v231 offset:11264
    v_mfma_f32_16x16x32_bf16 v[64:67], v[144:147], v[192:195], v[64:67]
    ds_read_b64_tr_b16 v[160:161], v233 offset:0
    v_mfma_f32_16x16x32_bf16 v[68:71], v[144:147], v[196:199], v[68:71]
    s_add_u32 m0, s19, 3072
    s_nop 0
    buffer_load_dwordx4 v224, s[8:11], s16 offen lds
    v_mfma_f32_16x16x32_bf16 v[72:75], v[144:147], v[200:203], v[72:75]
    ds_read_b64_tr_b16 v[162:163], v233 offset:3584
    v_mfma_f32_16x16x32_bf16 v[76:79], v[144:147], v[204:207], v[76:79]
    ds_read_b64_tr_b16 v[176:177], v233 offset:14400
    v_mfma_f32_16x16x32_bf16 v[16:19], v[132:135], v[192:195], v[16:19]
    ds_read_b64_tr_b16 v[178:179], v233 offset:17984
    v_mfma_f32_16x16x32_bf16 v[20:23], v[132:135], v[196:199], v[20:23]
    ds_read_b64_tr_b16 v[164:165], v233 offset:32
    v_mfma_f32_16x16x32_bf16 v[24:27], v[132:135], v[200:203], v[24:27]
    ds_read_b64_tr_b16 v[166:167], v233 offset:3616
    v_mfma_f32_16x16x32_bf16 v[28:31], v[132:135], v[204:207], v[28:31]
    s_add_u32 m0, s19, 4096
    s_nop 0
    buffer_load_dwordx4 v225, s[8:11], s16 offen lds
    v_mfma_f32_16x16x32_bf16 v[80:83], v[148:151], v[192:195], v[80:83]
    v_mfma_f32_16x16x32_bf16 v[84:87], v[148:151], v[196:199], v[84:87]
    ds_read_b64_tr_b16 v[180:181], v233 offset:14432
    v_mfma_f32_16x16x32_bf16 v[88:91], v[148:151], v[200:203], v[88:91]
    ds_read_b64_tr_b16 v[182:183], v233 offset:18016
    v_mfma_f32_16x16x32_bf16 v[92:95], v[148:151], v[204:207], v[92:95]
    ds_read_b64_tr_b16 v[168:169], v233 offset:64
    v_mfma_f32_16x16x32_bf16 v[32:35], v[136:139], v[192:195], v[32:35]
    ds_read_b64_tr_b16 v[170:171], v233 offset:3648
    v_mfma_f32_16x16x32_bf16 v[36:39], v[136:139], v[196:199], v[36:39]
    ds_read_b64_tr_b16 v[184:185], v233 offset:14464
    v_mfma_f32_16x16x32_bf16 v[40:43], v[136:139], v[200:203], v[40:43]
    s_add_u32 m0, s19, 5120
    s_nop 0
    buffer_load_dwordx4 v226, s[8:11], s16 offen lds
    v_mfma_f32_16x16x32_bf16 v[44:47], v[136:139], v[204:207], v[44:47]
    ds_read_b64_tr_b16 v[186:187], v233 offset:18048
    v_mfma_f32_16x16x32_bf16 v[96:99], v[152:155], v[192:195], v[96:99]
    ds_read_b64_tr_b16 v[172:173], v233 offset:96
    v_mfma_f32_16x16x32_bf16 v[100:103], v[152:155], v[196:199], v[100:103]
    ds_read_b64_tr_b16 v[174:175], v233 offset:3680
    v_mfma_f32_16x16x32_bf16 v[104:107], v[152:155], v[200:203], v[104:107]
    ds_read_b64_tr_b16 v[188:189], v233 offset:14496
    v_mfma_f32_16x16x32_bf16 v[108:111], v[152:155], v[204:207], v[108:111]
    ds_read_b64_tr_b16 v[190:191], v233 offset:18080
    v_mfma_f32_16x16x32_bf16 v[48:51], v[140:143], v[192:195], v[48:51]
    s_add_u32 m0, s19, 6144
    s_nop 0
    buffer_load_dwordx4 v227, s[8:11], s16 offen lds
    s_add_u32 s16, s16, 229376
    s_cmp_eq_u32 s16, s18
    s_cselect_b32 s16, s17, s16
    v_mfma_f32_16x16x32_bf16 v[52:55], v[140:143], v[196:199], v[52:55]
    v_mfma_f32_16x16x32_bf16 v[56:59], v[140:143], v[200:203], v[56:59]
    v_mfma_f32_16x16x32_bf16 v[60:63], v[140:143], v[204:207], v[60:63]
    v_mfma_f32_16x16x32_bf16 v[112:115], v[156:159], v[192:195], v[112:115]
    v_mfma_f32_16x16x32_bf16 v[116:119], v[156:159], v[196:199], v[116:119]
    v_mfma_f32_16x16x32_bf16 v[120:123], v[156:159], v[200:203], v[120:123]
    v_mfma_f32_16x16x32_bf16 v[124:127], v[156:159], v[204:207], v[124:127]
    s_waitcnt vmcnt(4) lgkmcnt(0)
    s_barrier
    v_mfma_f32_16x16x32_bf16 v[0:3], v[160:163], v[208:211], v[0:3]
    ds_read_b128 v[192:195], v231 offset:16384
    v_mfma_f32_16x16x32_bf16 v[4:7], v[160:163], v[212:215], v[4:7]
    ds_read_b128 v[196:199], v231 offset:17408
    v_mfma_f32_16x16x32_bf16 v[8:11], v[160:163], v[216:219], v[8:11]
    ds_read_b128 v[200:203], v231 offset:18432
    v_mfma_f32_16x16x32_bf16 v[12:15], v[160:163], v[220:223], v[12:15]
    ds_read_b128 v[204:207], v231 offset:19456
    v_mfma_f32_16x16x32_bf16 v[64:67], v[176:179], v[208:211], v[64:67]
    ds_read_b64_tr_b16 v[128:129], v233 offset:28800
    v_mfma_f32_16x16x32_bf16 v[68:71], v[176:179], v[212:215], v[68:71]
    s_add_u32 m0, s19, 31872
    s_nop 0
    buffer_load_dwordx4 v224, s[8:11], s16 offen lds
    v_mfma_f32_16x16x32_bf16 v[72:75], v[176:179], v[216:219], v[72:75]
    ds_read_b64_tr_b16 v[130:131], v233 offset:32384
    v_mfma_f32_16x16x32_bf16 v[76:79], v[176:179], v[220:223], v[76:79]
    ds_read_b64_tr_b16 v[144:145], v233 offset:43200
    v_mfma_f32_16x16x32_bf16 v[16:19], v[164:167], v[208:211], v[16:19]
    ds_read_b64_tr_b16 v[146:147], v233 offset:46784
    v_mfma_f32_16x16x32_bf16 v[20:23], v[164:167], v[212:215], v[20:23]
    ds_read_b64_tr_b16 v[132:133], v233 offset:28832
    v_mfma_f32_16x16x32_bf16 v[24:27], v[164:167], v[216:219], v[24:27]
    ds_read_b64_tr_b16 v[134:135], v233 offset:32416
    v_mfma_f32_16x16x32_bf16 v[28:31], v[164:167], v[220:223], v[28:31]
    s_add_u32 m0, s19, 32896
    s_nop 0
    buffer_load_dwordx4 v225, s[8:11], s16 offen lds
    v_mfma_f32_16x16x32_bf16 v[80:83], v[180:183], v[208:211], v[80:83]
    v_mfma_f32_16x16x32_bf16 v[84:87], v[180:183], v[212:215], v[84:87]
    ds_read_b64_tr_b16 v[148:149], v233 offset:43232
    v_mfma_f32_16x16x32_bf16 v[88:91], v[180:183], v[216:219], v[88:91]
    ds_read_b64_tr_b16 v[150:151], v233 offset:46816
    v_mfma_f32_16x16x32_bf16 v[92:95], v[180:183], v[220:223], v[92:95]
    ds_read_b64_tr_b16 v[136:137], v233 offset:28864
    v_mfma_f32_16x16x32_bf16 v[32:35], v[168:171], v[208:211], v[32:35]
    ds_read_b64_tr_b16 v[138:139], v233 offset:32448
    v_mfma_f32_16x16x32_bf16 v[36:39], v[168:171], v[212:215], v[36:39]
    ds_read_b64_tr_b16 v[152:153], v233 offset:43264
    v_mfma_f32_16x16x32_bf16 v[40:43], v[168:171], v[216:219], v[40:43]
    s_add_u32 m0, s19, 33920
    s_nop 0
    buffer_load_dwordx4 v226, s[8:11], s16 offen lds
    v_mfma_f32_16x16x32_bf16 v[44:47], v[168:171], v[220:223], v[44:47]
    ds_read_b64_tr_b16 v[154:155], v233 offset:46848
    v_mfma_f32_16x16x32_bf16 v[96:99], v[184:187], v[208:211], v[96:99]
    ds_read_b64_tr_b16 v[140:141], v233 offset:28896
    v_mfma_f32_16x16x32_bf16 v[100:103], v[184:187], v[212:215], v[100:103]
    ds_read_b64_tr_b16 v[142:143], v233 offset:32480
    v_mfma_f32_16x16x32_bf16 v[104:107], v[184:187], v[216:219], v[104:107]
    ds_read_b64_tr_b16 v[156:157], v233 offset:43296
    v_mfma_f32_16x16x32_bf16 v[108:111], v[184:187], v[220:223], v[108:111]
    ds_read_b64_tr_b16 v[158:159], v233 offset:46880
    v_mfma_f32_16x16x32_bf16 v[48:51], v[172:175], v[208:211], v[48:51]
    s_add_u32 m0, s19, 34944
    s_nop 0
    buffer_load_dwordx4 v227, s[8:11], s16 offen lds
    s_add_u32 s16, s16, 229376
    s_cmp_eq_u32 s16, s18
    s_cselect_b32 s16, s17, s16
    v_mfma_f32_16x16x32_bf16 v[52:55], v[172:175], v[212:215], v[52:55]
    v_mfma_f32_16x16x32_bf16 v[56:59], v[172:175], v[216:219], v[56:59]
    v_mfma_f32_16x16x32_bf16 v[60:63], v[172:175], v[220:223], v[60:63]
    v_mfma_f32_16x16x32_bf16 v[112:115], v[188:191], v[208:211], v[112:115]
    v_mfma_f32_16x16x32_bf16 v[116:119], v[188:191], v[212:215], v[116:119]
    v_mfma_f32_16x16x32_bf16 v[120:123], v[188:191], v[216:219], v[120:123]
    v_mfma_f32_16x16x32_bf16 v[124:127], v[188:191], v[220:223], v[124:127]
    s_waitcnt vmcnt(4) lgkmcnt(0)
    s_barrier
    v_mfma_f32_16x16x32_bf16 v[0:3], v[128:131], v[192:195], v[0:3]
    ds_read_b128 v[208:211], v231 offset:24576
    v_mfma_f32_16x16x32_bf16 v[4:7], v[128:131], v[196:199], v[4:7]
    ds_read_b128 v[212:215], v231 offset:25600
    v_mfma_f32_16x16x32_bf16 v[8:11], v[128:131], v[200:203], v[8:11]
    ds_read_b128 v[216:219], v231 offset:26624
    v_mfma_f32_16x16x32_bf16 v[12:15], v[128:131], v[204:207], v[12:15]
    ds_read_b128 v[220:223], v231 offset:27648
    v_mfma_f32_16x16x32_bf16 v[64:67], v[144:147], v[192:195], v[64:67]
    ds_read_b64_tr_b16 v[160:161], v232 offset:0
    v_mfma_f32_16x16x32_bf16 v[68:71], v[144:147], v[196:199], v[68:71]
    s_add_u32 m0, s19, 60672
    s_nop 0
    buffer_load_dwordx4 v224, s[8:11], s16 offen lds
    v_mfma_f32_16x16x32_bf16 v[72:75], v[144:147], v[200:203], v[72:75]
    ds_read_b64_tr_b16 v[162:163], v232 offset:3584
    v_mfma_f32_16x16x32_bf16 v[76:79], v[144:147], v[204:207], v[76:79]
    ds_read_b64_tr_b16 v[176:177], v232 offset:14400
    v_mfma_f32_16x16x32_bf16 v[16:19], v[132:135], v[192:195], v[16:19]
    ds_read_b64_tr_b16 v[178:179], v232 offset:17984
    v_mfma_f32_16x16x32_bf16 v[20:23], v[132:135], v[196:199], v[20:23]
    ds_read_b64_tr_b16 v[164:165], v232 offset:32
    v_mfma_f32_16x16x32_bf16 v[24:27], v[132:135], v[200:203], v[24:27]
    ds_read_b64_tr_b16 v[166:167], v232 offset:3616
    v_mfma_f32_16x16x32_bf16 v[28:31], v[132:135], v[204:207], v[28:31]
    s_add_u32 m0, s19, 61696
    s_nop 0
    buffer_load_dwordx4 v225, s[8:11], s16 offen lds
    v_mfma_f32_16x16x32_bf16 v[80:83], v[148:151], v[192:195], v[80:83]
    v_mfma_f32_16x16x32_bf16 v[84:87], v[148:151], v[196:199], v[84:87]
    ds_read_b64_tr_b16 v[180:181], v232 offset:14432
    v_mfma_f32_16x16x32_bf16 v[88:91], v[148:151], v[200:203], v[88:91]
    ds_read_b64_tr_b16 v[182:183], v232 offset:18016
    v_mfma_f32_16x16x32_bf16 v[92:95], v[148:151], v[204:207], v[92:95]
    ds_read_b64_tr_b16 v[168:169], v232 offset:64
    v_mfma_f32_16x16x32_bf16 v[32:35], v[136:139], v[192:195], v[32:35]
    ds_read_b64_tr_b16 v[170:171], v232 offset:3648
    v_mfma_f32_16x16x32_bf16 v[36:39], v[136:139], v[196:199], v[36:39]
    ds_read_b64_tr_b16 v[184:185], v232 offset:14464
    v_mfma_f32_16x16x32_bf16 v[40:43], v[136:139], v[200:203], v[40:43]
    s_add_u32 m0, s19, 62720
    s_nop 0
    buffer_load_dwordx4 v226, s[8:11], s16 offen lds
    v_mfma_f32_16x16x32_bf16 v[44:47], v[136:139], v[204:207], v[44:47]
    ds_read_b64_tr_b16 v[186:187], v232 offset:18048
    v_mfma_f32_16x16x32_bf16 v[96:99], v[152:155], v[192:195], v[96:99]
    ds_read_b64_tr_b16 v[172:173], v232 offset:96
    v_mfma_f32_16x16x32_bf16 v[100:103], v[152:155], v[196:199], v[100:103]
    ds_read_b64_tr_b16 v[174:175], v232 offset:3680
    v_mfma_f32_16x16x32_bf16 v[104:107], v[152:155], v[200:203], v[104:107]
    ds_read_b64_tr_b16 v[188:189], v232 offset:14496
    v_mfma_f32_16x16x32_bf16 v[108:111], v[152:155], v[204:207], v[108:111]
    ds_read_b64_tr_b16 v[190:191], v232 offset:18080
    v_mfma_f32_16x16x32_bf16 v[48:51], v[140:143], v[192:195], v[48:51]
    s_add_u32 m0, s19, 63744
    s_nop 0
    buffer_load_dwordx4 v227, s[8:11], s16 offen lds
    s_add_u32 s16, s16, 229376
    s_cmp_eq_u32 s16, s18
    s_cselect_b32 s16, s17, s16
    v_mfma_f32_16x16x32_bf16 v[52:55], v[140:143], v[196:199], v[52:55]
    v_mfma_f32_16x16x32_bf16 v[56:59], v[140:143], v[200:203], v[56:59]
    v_mfma_f32_16x16x32_bf16 v[60:63], v[140:143], v[204:207], v[60:63]
    v_mfma_f32_16x16x32_bf16 v[112:115], v[156:159], v[192:195], v[112:115]
    v_mfma_f32_16x16x32_bf16 v[116:119], v[156:159], v[196:199], v[116:119]
    v_mfma_f32_16x16x32_bf16 v[120:123], v[156:159], v[200:203], v[120:123]
    v_mfma_f32_16x16x32_bf16 v[124:127], v[156:159], v[204:207], v[124:127]
    s_waitcnt vmcnt(4) lgkmcnt(0)
    s_barrier
    v_mfma_f32_16x16x32_bf16 v[0:3], v[160:163], v[208:211], v[0:3]
    ds_read_b128 v[192:195], v231 offset:0
    v_mfma_f32_16x16x32_bf16 v[4:7], v[160:163], v[212:215], v[4:7]
    ds_read_b128 v[196:199], v231 offset:1024
    v_mfma_f32_16x16x32_bf16 v[8:11], v[160:163], v[216:219], v[8:11]
    ds_read_b128 v[200:203], v231 offset:2048
    v_mfma_f32_16x16x32_bf16 v[12:15], v[160:163], v[220:223], v[12:15]
    ds_read_b128 v[204:207], v231 offset:3072
    v_mfma_f32_16x16x32_bf16 v[64:67], v[176:179], v[208:211], v[64:67]
    ds_read_b64_tr_b16 v[128:129], v232 offset:28800
    v_mfma_f32_16x16x32_bf16 v[68:71], v[176:179], v[212:215], v[68:71]
    s_add_u32 m0, s19, 89472
    s_nop 0
    buffer_load_dwordx4 v224, s[8:11], s16 offen lds
    v_mfma_f32_16x16x32_bf16 v[72:75], v[176:179], v[216:219], v[72:75]
    ds_read_b64_tr_b16 v[130:131], v232 offset:32384
    v_mfma_f32_16x16x32_bf16 v[76:79], v[176:179], v[220:223], v[76:79]
    ds_read_b64_tr_b16 v[144:145], v232 offset:43200
    v_mfma_f32_16x16x32_bf16 v[16:19], v[164:167], v[208:211], v[16:19]
    ds_read_b64_tr_b16 v[146:147], v232 offset:46784
    v_mfma_f32_16x16x32_bf16 v[20:23], v[164:167], v[212:215], v[20:23]
    ds_read_b64_tr_b16 v[132:133], v232 offset:28832
    v_mfma_f32_16x16x32_bf16 v[24:27], v[164:167], v[216:219], v[24:27]
    ds_read_b64_tr_b16 v[134:135], v232 offset:32416
    v_mfma_f32_16x16x32_bf16 v[28:31], v[164:167], v[220:223], v[28:31]
    s_add_u32 m0, s19, 90496
    s_nop 0
    buffer_load_dwordx4 v225, s[8:11], s16 offen lds
    v_mfma_f32_16x16x32_bf16 v[80:83], v[180:183], v[208:211], v[80:83]
    v_mfma_f32_16x16x32_bf16 v[84:87], v[180:183], v[212:215], v[84:87]
    ds_read_b64_tr_b16 v[148:149], v232 offset:43232
    v_mfma_f32_16x16x32_bf16 v[88:91], v[180:183], v[216:219], v[88:91]
    ds_read_b64_tr_b16 v[150:151], v232 offset:46816
    v_mfma_f32_16x16x32_bf16 v[92:95], v[180:183], v[220:223], v[92:95]
    ds_read_b64_tr_b16 v[136:137], v232 offset:28864
    v_mfma_f32_16x16x32_bf16 v[32:35], v[168:171], v[208:211], v[32:35]
    ds_read_b64_tr_b16 v[138:139], v232 offset:32448
    v_mfma_f32_16x16x32_bf16 v[36:39], v[168:171], v[212:215], v[36:39]
    ds_read_b64_tr_b16 v[152:153], v232 offset:43264
    v_mfma_f32_16x16x32_bf16 v[40:43], v[168:171], v[216:219], v[40:43]
    s_add_u32 m0, s19, 91520
    s_nop 0
    buffer_load_dwordx4 v226, s[8:11], s16 offen lds
    v_mfma_f32_16x16x32_bf16 v[44:47], v[168:171], v[220:223], v[44:47]
    ds_read_b64_tr_b16 v[154:155], v232 offset:46848
    v_mfma_f32_16x16x32_bf16 v[96:99], v[184:187], v[208:211], v[96:99]
    ds_read_b64_tr_b16 v[140:141], v232 offset:28896
    v_mfma_f32_16x16x32_bf16 v[100:103], v[184:187], v[212:215], v[100:103]
    ds_read_b64_tr_b16 v[142:143], v232 offset:32480
    v_mfma_f32_16x16x32_bf16 v[104:107], v[184:187], v[216:219], v[104:107]
    ds_read_b64_tr_b16 v[156:157], v232 offset:43296
    v_mfma_f32_16x16x32_bf16 v[108:111], v[184:187], v[220:223], v[108:111]
    ds_read_b64_tr_b16 v[158:159], v232 offset:46880
    v_mfma_f32_16x16x32_bf16 v[48:51], v[172:175], v[208:211], v[48:51]
    s_add_u32 m0, s19, 92544
    s_nop 0
    buffer_load_dwordx4 v227, s[8:11], s16 offen lds
    s_add_u32 s16, s16, 229376
    s_cmp_eq_u32 s16, s18
    s_cselect_b32 s16, s17, s16
    v_mfma_f32_16x16x32_bf16 v[52:55], v[172:175], v[212:215], v[52:55]
    v_mfma_f32_16x16x32_bf16 v[56:59], v[172:175], v[216:219], v[56:59]
    v_mfma_f32_16x16x32_bf16 v[60:63], v[172:175], v[220:223], v[60:63]
    v_mfma_f32_16x16x32_bf16 v[112:115], v[188:191], v[208:211], v[112:115]
    v_mfma_f32_16x16x32_bf16 v[116:119], v[188:191], v[212:215], v[116:119]
    v_mfma_f32_16x16x32_bf16 v[120:123], v[188:191], v[216:219], v[120:123]
    v_mfma_f32_16x16x32_bf16 v[124:127], v[188:191], v[220:223], v[124:127]
    s_sub_u32 s24, s24, 1
    s_cmp_lg_u32 s24, 0
    s_cbranch_scc1 g3c0_loop
    s_sub_u32 s27, s74, s58
    s_and_b32 s27, s27, 7
    s_cmp_lt_u32 s27, 8
    s_cselect_b32 s27, 14, 0
    s_waitcnt vmcnt(4) lgkmcnt(0)
    s_barrier
    v_mfma_f32_16x16x32_bf16 v[0:3], v[128:131], v[192:195], v[0:3]
    ds_read_b128 v[208:211], v231 offset:8192
    v_mfma_f32_16x16x32_bf16 v[4:7], v[128:131], v[196:199], v[4:7]
    ds_read_b128 v[212:215], v231 offset:9216
    v_mfma_f32_16x16x32_bf16 v[8:11], v[128:131], v[200:203], v[8:11]
    ds_read_b128 v[216:219], v231 offset:10240
    v_mfma_f32_16x16x32_bf16 v[12:15], v[128:131], v[204:207], v[12:15]
    ds_read_b128 v[220:223], v231 offset:11264
    v_mfma_f32_16x16x32_bf16 v[64:67], v[144:147], v[192:195], v[64:67]
    ds_read_b64_tr_b16 v[160:161], v233 offset:0
    v_mfma_f32_16x16x32_bf16 v[68:71], v[144:147], v[196:199], v[68:71]
    s_add_u32 m0, s19, 3072
    s_nop 0
    buffer_load_dwordx4 v224, s[8:11], s16 offen lds
    v_mfma_f32_16x16x32_bf16 v[72:75], v[144:147], v[200:203], v[72:75]
    ds_read_b64_tr_b16 v[162:163], v233 offset:3584
    v_mfma_f32_16x16x32_bf16 v[76:79], v[144:147], v[204:207], v[76:79]
    ds_read_b64_tr_b16 v[176:177], v233 offset:14400
    v_mfma_f32_16x16x32_bf16 v[16:19], v[132:135], v[192:195], v[16:19]
    ds_read_b64_tr_b16 v[178:179], v233 offset:17984
    v_mfma_f32_16x16x32_bf16 v[20:23], v[132:135], v[196:199], v[20:23]
    ds_read_b64_tr_b16 v[164:165], v233 offset:32
    v_mfma_f32_16x16x32_bf16 v[24:27], v[132:135], v[200:203], v[24:27]
    ds_read_b64_tr_b16 v[166:167], v233 offset:3616
    v_mfma_f32_16x16x32_bf16 v[28:31], v[132:135], v[204:207], v[28:31]
    s_add_u32 m0, s19, 4096
    s_nop 0
    buffer_load_dwordx4 v225, s[8:11], s16 offen lds
    v_mfma_f32_16x16x32_bf16 v[80:83], v[148:151], v[192:195], v[80:83]
    v_mfma_f32_16x16x32_bf16 v[84:87], v[148:151], v[196:199], v[84:87]
    ds_read_b64_tr_b16 v[180:181], v233 offset:14432
    v_mfma_f32_16x16x32_bf16 v[88:91], v[148:151], v[200:203], v[88:91]
    ds_read_b64_tr_b16 v[182:183], v233 offset:18016
    v_mfma_f32_16x16x32_bf16 v[92:95], v[148:151], v[204:207], v[92:95]
    ds_read_b64_tr_b16 v[168:169], v233 offset:64
    v_mfma_f32_16x16x32_bf16 v[32:35], v[136:139], v[192:195], v[32:35]
    ds_read_b64_tr_b16 v[170:171], v233 offset:3648
    v_mfma_f32_16x16x32_bf16 v[36:39], v[136:139], v[196:199], v[36:39]
    ds_read_b64_tr_b16 v[184:185], v233 offset:14464
    v_mfma_f32_16x16x32_bf16 v[40:43], v[136:139], v[200:203], v[40:43]
    s_add_u32 m0, s19, 5120
    s_nop 0
    buffer_load_dwordx4 v226, s[8:11], s16 offen lds
    v_mfma_f32_16x16x32_bf16 v[44:47], v[136:139], v[204:207], v[44:47]
    ds_read_b64_tr_b16 v[186:187], v233 offset:18048
    v_mfma_f32_16x16x32_bf16 v[96:99], v[152:155], v[192:195], v[96:99]
    ds_read_b64_tr_b16 v[172:173], v233 offset:96
    v_mfma_f32_16x16x32_bf16 v[100:103], v[152:155], v[196:199], v[100:103]
    ds_read_b64_tr_b16 v[174:175], v233 offset:3680
    v_mfma_f32_16x16x32_bf16 v[104:107], v[152:155], v[200:203], v[104:107]
    ds_read_b64_tr_b16 v[188:189], v233 offset:14496
    v_mfma_f32_16x16x32_bf16 v[108:111], v[152:155], v[204:207], v[108:111]
    ds_read_b64_tr_b16 v[190:191], v233 offset:18080
    v_mfma_f32_16x16x32_bf16 v[48:51], v[140:143], v[192:195], v[48:51]
    s_add_u32 m0, s19, 6144
    s_nop 0
    buffer_load_dwordx4 v227, s[8:11], s16 offen lds
    s_add_u32 s16, s16, 229376
    s_cmp_eq_u32 s16, s18
    s_cselect_b32 s16, s17, s16
    v_mfma_f32_16x16x32_bf16 v[52:55], v[140:143], v[196:199], v[52:55]
    v_mfma_f32_16x16x32_bf16 v[56:59], v[140:143], v[200:203], v[56:59]
    v_mfma_f32_16x16x32_bf16 v[60:63], v[140:143], v[204:207], v[60:63]
    v_mfma_f32_16x16x32_bf16 v[112:115], v[156:159], v[192:195], v[112:115]
    v_mfma_f32_16x16x32_bf16 v[116:119], v[156:159], v[196:199], v[116:119]
    v_mfma_f32_16x16x32_bf16 v[120:123], v[156:159], v[200:203], v[120:123]
    v_mfma_f32_16x16x32_bf16 v[124:127], v[156:159], v[204:207], v[124:127]
    s_waitcnt vmcnt(4) lgkmcnt(0)
    s_barrier
    v_mfma_f32_16x16x32_bf16 v[0:3], v[160:163], v[208:211], v[0:3]
    ds_read_b128 v[192:195], v231 offset:16384
    v_mfma_f32_16x16x32_bf16 v[4:7], v[160:163], v[212:215], v[4:7]
    ds_read_b128 v[196:199], v231 offset:17408
    v_lshlrev_b32 v247, 7, v250
    s_add_u32 s29, s3, 0
    s_lshl_b32 s30, s29, 12
    s_add_u32 s30, s30, s25
    s_cmp_lt_u32 s29, s27
    s_cselect_b32 s30, s30, 0x7f000000
    s_mov_b64 exec, 0xffffffff
    buffer_load_dword v248, v247, s[80:83], s30 offen sc1
    s_mov_b64 exec, -1
    v_mfma_f32_16x16x32_bf16 v[8:11], v[160:163], v[216:219], v[8:11]
    ds_read_b128 v[200:203], v231 offset:18432
    v_mfma_f32_16x16x32_bf16 v[12:15], v[160:163], v[220:223], v[12:15]
    ds_read_b128 v[204:207], v231 offset:19456
    v_mfma_f32_16x16x32_bf16 v[64:67], v[176:179], v[208:211], v[64:67]
    v_mfma_f32_16x16x32_bf16 v[68:71], v[176:179], v[212:215], v[68:71]
    ds_read_b64_tr_b16 v[128:129], v233 offset:28800
    v_mfma_f32_16x16x32_bf16 v[72:75], v[176:179], v[216:219], v[72:75]
    ds_read_b64_tr_b16 v[130:131], v233 offset:32384
    v_mfma_f32_16x16x32_bf16 v[76:79], v[176:179], v[220:223], v[76:79]
    ds_read_b64_tr_b16 v[144:145], v233 offset:43200
    v_mfma_f32_16x16x32_bf16 v[16:19], v[164:167], v[208:211], v[16:19]
    v_mfma_f32_16x16x32_bf16 v[20:23], v[164:167], v[212:215], v[20:23]
    ds_read_b64_tr_b16 v[146:147], v233 offset:46784
    v_mfma_f32_16x16x32_bf16 v[24:27], v[164:167], v[216:219], v[24:27]
    ds_read_b64_tr_b16 v[132:133], v233 offset:28832
    v_mfma_f32_16x16x32_bf16 v[28:31], v[164:167], v[220:223], v[28:31]
    ds_read_b64_tr_b16 v[134:135], v233 offset:32416
    v_mfma_f32_16x16x32_bf16 v[80:83], v[180:183], v[208:211], v[80:83]
    v_mfma_f32_16x16x32_bf16 v[84:87], v[180:183], v[212:215], v[84:87]
    ds_read_b64_tr_b16 v[148:149], v233 offset:43232
    v_mfma_f32_16x16x32_bf16 v[88:91], v[180:183], v[216:219], v[88:91]
    ds_read_b64_tr_b16 v[150:151], v233 offset:46816
    v_mfma_f32_16x16x32_bf16 v[92:95], v[180:183], v[220:223], v[92:95]
    ds_read_b64_tr_b16 v[136:137], v233 offset:28864
    v_mfma_f32_16x16x32_bf16 v[32:35], v[168:171], v[208:211], v[32:35]
    ds_read_b64_tr_b16 v[138:139], v233 offset:32448
    v_mfma_f32_16x16x32_bf16 v[36:39], v[168:171], v[212:215], v[36:39]
    v_lshlrev_b32 v247, 7, v250
    s_add_u32 s29, s3, 8
    s_lshl_b32 s30, s29, 12
    s_add_u32 s30, s30, s25
    s_cmp_lt_u32 s29, s27
    s_cselect_b32 s30, s30, 0x7f000000
    s_mov_b64 exec, 0xffffffff
    buffer_load_dword v248, v247, s[80:83], s30 offen sc1
    s_mov_b64 exec, -1
    v_mfma_f32_16x16x32_bf16 v[40:43], v[168:171], v[216:219], v[40:43]
    ds_read_b64_tr_b16 v[152:153], v233 offset:43264
    v_mfma_f32_16x16x32_bf16 v[44:47], v[168:171], v[220:223], v[44:47]
    ds_read_b64_tr_b16 v[154:155], v233 offset:46848
    v_mfma_f32_16x16x32_bf16 v[96:99], v[184:187], v[208:211], v[96:99]
    ds_read_b64_tr_b16 v[140:141], v233 offset:28896
    v_mfma_f32_16x16x32_bf16 v[100:103], v[184:187], v[212:215], v[100:103]
    v_mfma_f32_16x16x32_bf16 v[104:107], v[184:187], v[216:219], v[104:107]
    ds_read_b64_tr_b16 v[142:143], v233 offset:32480
    v_mfma_f32_16x16x32_bf16 v[108:111], v[184:187], v[220:223], v[108:111]
    ds_read_b64_tr_b16 v[156:157], v233 offset:43296
    v_mfma_f32_16x16x32_bf16 v[48:51], v[172:175], v[208:211], v[48:51]
    ds_read_b64_tr_b16 v[158:159], v233 offset:46880
    v_mfma_f32_16x16x32_bf16 v[52:55], v[172:175], v[212:215], v[52:55]
    v_mfma_f32_16x16x32_bf16 v[56:59], v[172:175], v[216:219], v[56:59]
    v_mfma_f32_16x16x32_bf16 v[60:63], v[172:175], v[220:223], v[60:63]
    v_mfma_f32_16x16x32_bf16 v[112:115], v[188:191], v[208:211], v[112:115]
    v_mfma_f32_16x16x32_bf16 v[116:119], v[188:191], v[212:215], v[116:119]
    v_mfma_f32_16x16x32_bf16 v[120:123], v[188:191], v[216:219], v[120:123]
    v_mfma_f32_16x16x32_bf16 v[124:127], v[188:191], v[220:223], v[124:127]
    s_waitcnt vmcnt(2) lgkmcnt(0)
    s_barrier
    s_setprio 2
    v_mfma_f32_16x16x32_bf16 v[0:3], v[128:131], v[192:195], v[0:3]
    ds_read_b128 v[208:211], v231 offset:24576
    ds_read_b128 v[212:215], v231 offset:25600
    v_mfma_f32_16x16x32_bf16 v[4:7], v[128:131], v[196:199], v[4:7]
    ds_read_b128 v[216:219], v231 offset:26624
    v_mfma_f32_16x16x32_bf16 v[8:11], v[128:131], v[200:203], v[8:11]
    ds_read_b128 v[220:223], v231 offset:27648
    ds_read_b64_tr_b16 v[160:161], v232 offset:0
    v_mfma_f32_16x16x32_bf16 v[12:15], v[128:131], v[204:207], v[12:15]
    ds_read_b64_tr_b16 v[162:163], v232 offset:3584
    v_mfma_f32_16x16x32_bf16 v[64:67], v[144:147], v[192:195], v[64:67]
    ds_read_b64_tr_b16 v[176:177], v232 offset:14400
    ds_read_b64_tr_b16 v[178:179], v232 offset:17984
    v_mfma_f32_16x16x32_bf16 v[68:71], v[144:147], v[196:199], v[68:71]
    ds_read_b64_tr_b16 v[164:165], v232 offset:32
    v_mfma_f32_16x16x32_bf16 v[72:75], v[144:147], v[200:203], v[72:75]
    ds_read_b64_tr_b16 v[166:167], v232 offset:3616
    v_mfma_f32_16x16x32_bf16 v[76:79], v[144:147], v[204:207], v[76:79]
    ds_read_b64_tr_b16 v[180:181], v232 offset:14432
    ds_read_b64_tr_b16 v[182:183], v232 offset:18016
    v_mfma_f32_16x16x32_bf16 v[16:19], v[132:135], v[192:195], v[16:19]
    ds_read_b64_tr_b16 v[168:169], v232 offset:64
    v_mfma_f32_16x16x32_bf16 v[20:23], v[132:135], v[196:199], v[20:23]
    ds_read_b64_tr_b16 v[170:171], v232 offset:3648
    ds_read_b64_tr_b16 v[184:185], v232 offset:14464
    v_mfma_f32_16x16x32_bf16 v[24:27], v[132:135], v[200:203], v[24:27]
    ds_read_b64_tr_b16 v[186:187], v232 offset:18048
    v_mfma_f32_16x16x32_bf16 v[28:31], v[132:135], v[204:207], v[28:31]
    ds_read_b64_tr_b16 v[172:173], v232 offset:96
    ds_read_b64_tr_b16 v[174:175], v232 offset:3680
    v_mfma_f32_16x16x32_bf16 v[80:83], v[148:151], v[192:195], v[80:83]
    ds_read_b64_tr_b16 v[188:189], v232 offset:14496
    v_mfma_f32_16x16x32_bf16 v[84:87], v[148:151], v[196:199], v[84:87]
    ds_read_b64_tr_b16 v[190:191], v232 offset:18080
    v_mfma_f32_16x16x32_bf16 v[88:91], v[148:151], v[200:203], v[88:91]
    v_mfma_f32_16x16x32_bf16 v[92:95], v[148:151], v[204:207], v[92:95]
    v_mfma_f32_16x16x32_bf16 v[32:35], v[136:139], v[192:195], v[32:35]
    v_mfma_f32_16x16x32_bf16 v[36:39], v[136:139], v[196:199], v[36:39]
    v_mfma_f32_16x16x32_bf16 v[40:43], v[136:139], v[200:203], v[40:43]
    v_mfma_f32_16x16x32_bf16 v[44:47], v[136:139], v[204:207], v[44:47]
    v_mfma_f32_16x16x32_bf16 v[96:99], v[152:155], v[192:195], v[96:99]
    s_waitcnt lgkmcnt(0)
    s_barrier
    v_mfma_f32_16x16x32_bf16 v[100:103], v[152:155], v[196:199], v[100:103]
    v_mfma_f32_16x16x32_bf16 v[104:107], v[152:155], v[200:203], v[104:107]
    v_mfma_f32_16x16x32_bf16 v[108:111], v[152:155], v[204:207], v[108:111]
    v_mfma_f32_16x16x32_bf16 v[48:51], v[140:143], v[192:195], v[48:51]
    v_mfma_f32_16x16x32_bf16 v[52:55], v[140:143], v[196:199], v[52:55]
    v_mfma_f32_16x16x32_bf16 v[56:59], v[140:143], v[200:203], v[56:59]
    v_mfma_f32_16x16x32_bf16 v[60:63], v[140:143], v[204:207], v[60:63]
    v_mfma_f32_16x16x32_bf16 v[112:115], v[156:159], v[192:195], v[112:115]
    v_mfma_f32_16x16x32_bf16 v[116:119], v[156:159], v[196:199], v[116:119]
    v_mfma_f32_16x16x32_bf16 v[120:123], v[156:159], v[200:203], v[120:123]
    v_mfma_f32_16x16x32_bf16 v[124:127], v[156:159], v[204:207], v[124:127]
    s_and_b32 s64, s3, 1
    s_lshl_b32 s64, s64, 9
    s_add_u32 s64, s64, 159744
    v_lshlrev_b32 v253, 3, v252
    v_add_u32 v253, s64, v253
    s_lshl_b32 s64, s28, 6
    s_add_u32 s64, s64, 160896
    v_lshlrev_b32 v254, 4, v251
    v_add_u32 v231, s64, v254
    v_mfma_f32_16x16x32_bf16 v[0:3], v[160:163], v[208:211], v[0:3]
    ds_read_b64 v[192:193], v253 offset:0
    v_mfma_f32_16x16x32_bf16 v[4:7], v[160:163], v[212:215], v[4:7]
    ds_read_b64 v[194:195], v253 offset:128
    v_mfma_f32_16x16x32_bf16 v[8:11], v[160:163], v[216:219], v[8:11]
    ds_read_b64 v[196:197], v253 offset:256
    v_mfma_f32_16x16x32_bf16 v[12:15], v[160:163], v[220:223], v[12:15]
    v_mfma_f32_16x16x32_bf16 v[64:67], v[176:179], v[208:211], v[64:67]
    ds_read_b64 v[198:199], v253 offset:384
    v_mfma_f32_16x16x32_bf16 v[68:71], v[176:179], v[212:215], v[68:71]
    ds_read_b128 v[128:131], v231 offset:0
    v_mfma_f32_16x16x32_bf16 v[72:75], v[176:179], v[216:219], v[72:75]
    v_mfma_f32_16x16x32_bf16 v[76:79], v[176:179], v[220:223], v[76:79]
    ds_read_b128 v[132:135], v231 offset:64
    v_mfma_f32_16x16x32_bf16 v[16:19], v[164:167], v[208:211], v[16:19]
    ds_read_b128 v[136:139], v231 offset:128
    v_mfma_f32_16x16x32_bf16 v[20:23], v[164:167], v[212:215], v[20:23]
    ds_read_b128 v[140:143], v231 offset:192
    v_mfma_f32_16x16x32_bf16 v[24:27], v[164:167], v[216:219], v[24:27]
    v_mfma_f32_16x16x32_bf16 v[28:31], v[164:167], v[220:223], v[28:31]
    ds_read_b128 v[144:147], v231 offset:896
    v_mfma_f32_16x16x32_bf16 v[80:83], v[180:183], v[208:211], v[80:83]
    ds_read_b128 v[148:151], v231 offset:960
    v_mfma_f32_16x16x32_bf16 v[84:87], v[180:183], v[212:215], v[84:87]
    v_mfma_f32_16x16x32_bf16 v[88:91], v[180:183], v[216:219], v[88:91]
    ds_read_b128 v[152:155], v231 offset:1024
    v_mfma_f32_16x16x32_bf16 v[92:95], v[180:183], v[220:223], v[92:95]
    ds_read_b128 v[156:159], v231 offset:1088
    v_mfma_f32_16x16x32_bf16 v[32:35], v[168:171], v[208:211], v[32:35]
    v_mfma_f32_16x16x32_bf16 v[36:39], v[168:171], v[212:215], v[36:39]
    v_mfma_f32_16x16x32_bf16 v[40:43], v[168:171], v[216:219], v[40:43]
    v_mfma_f32_16x16x32_bf16 v[44:47], v[168:171], v[220:223], v[44:47]
    v_mfma_f32_16x16x32_bf16 v[96:99], v[184:187], v[208:211], v[96:99]
    v_mfma_f32_16x16x32_bf16 v[100:103], v[184:187], v[212:215], v[100:103]
    v_mfma_f32_16x16x32_bf16 v[104:107], v[184:187], v[216:219], v[104:107]
    v_mfma_f32_16x16x32_bf16 v[108:111], v[184:187], v[220:223], v[108:111]
    v_mfma_f32_16x16x32_bf16 v[48:51], v[172:175], v[208:211], v[48:51]
    v_mfma_f32_16x16x32_bf16 v[52:55], v[172:175], v[212:215], v[52:55]
    v_mfma_f32_16x16x32_bf16 v[56:59], v[172:175], v[216:219], v[56:59]
    v_mfma_f32_16x16x32_bf16 v[60:63], v[172:175], v[220:223], v[60:63]
    v_mfma_f32_16x16x32_bf16 v[112:115], v[188:191], v[208:211], v[112:115]
    v_mfma_f32_16x16x32_bf16 v[116:119], v[188:191], v[212:215], v[116:119]
    v_mfma_f32_16x16x32_bf16 v[120:123], v[188:191], v[216:219], v[120:123]
    v_mfma_f32_16x16x32_bf16 v[124:127], v[188:191], v[220:223], v[124:127]
    s_setprio 0
    s_and_b32 s64, s3, 1
    s_lshl_b32 s64, s64, 12
    s_add_u32 s25, s25, s64
    s_lshr_b32 s64, s69, 1
    s_lshl_b32 s64, s64, 14
    s_add_u32 s25, s25, s64
    s_add_u32 s26, s25, 8192
    s_and_b32 s64, s3, 1
    s_lshl_b32 s64, s64, 12
    s_lshr_b32 s65, s69, 1
    s_lshl_b32 s65, s65, 14
    s_add_u32 s64, s64, s65
    v_add_u32 v233, s64, v249
    v_add_u16 v232, 0xe000, v233
    s_waitcnt lgkmcnt(0)
    s_mov_b32 s64, 0xbfb8aa3b
    v_mul_f32 v176, v193, v193
    v_sub_f32 v160, 0, v192
    v_mul_f32 v168, s64, v193
    v_sub_f32 v161, 0, v192
    v_mul_f32 v169, s64, v193
    v_mul_f32 v178, v195, v195
    v_sub_f32 v162, 0, v194
    v_mul_f32 v170, s64, v195
    v_sub_f32 v163, 0, v194
    v_mul_f32 v171, s64, v195
    v_mul_f32 v180, v197, v197
    v_sub_f32 v164, 0, v196
    v_mul_f32 v172, s64, v197
    v_sub_f32 v165, 0, v196
    v_mul_f32 v173, s64, v197
    v_mul_f32 v182, v199, v199
    v_sub_f32 v166, 0, v198
    v_mul_f32 v174, s64, v199
    v_sub_f32 v167, 0, v198
    v_mul_f32 v175, s64, v199
    v_rcp_f32 v177, v176
    v_rcp_f32 v176, v176
    v_rcp_f32 v179, v178
    v_rcp_f32 v178, v178
    v_rcp_f32 v181, v180
    v_rcp_f32 v180, v180
    v_rcp_f32 v183, v182
    v_rcp_f32 v182, v182
    v_pk_fma_f32 v[0:1], v[160:161], v[128:129], v[0:1]
    v_pk_fma_f32 v[2:3], v[160:161], v[130:131], v[2:3]
    v_pk_mul_f32 v[212:213], v[168:169], v[0:1]
    v_pk_mul_f32 v[214:215], v[168:169], v[2:3]
    v_exp_f32 v212, v212
    v_exp_f32 v213, v213
    v_exp_f32 v214, v214
    v_exp_f32 v215, v215
    v_pk_fma_f32 v[64:65], v[160:161], v[144:145], v[64:65]
    v_pk_fma_f32 v[66:67], v[160:161], v[146:147], v[66:67]
    v_pk_fma_f32 v[212:213], v[212:213], v[176:177], v[176:177]
    v_pk_fma_f32 v[214:215], v[214:215], v[176:177], v[176:177]
    v_rcp_f32 v212, v212
    v_rcp_f32 v213, v213
    v_rcp_f32 v214, v214
    v_rcp_f32 v215, v215
    v_pk_mul_f32 v[0:1], v[0:1], v[64:65]
    v_pk_mul_f32 v[2:3], v[2:3], v[66:67]
    v_pk_mul_f32 v[0:1], v[0:1], v[212:213]
    v_pk_mul_f32 v[2:3], v[2:3], v[214:215]
    v_cvt_pk_bf16_f32 v216, v0, v1
    v_cvt_pk_bf16_f32 v217, v2, v3
    v_pk_fma_f32 v[16:17], v[160:161], v[132:133], v[16:17]
    v_pk_fma_f32 v[18:19], v[160:161], v[134:135], v[18:19]
    v_pk_mul_f32 v[212:213], v[168:169], v[16:17]
    v_pk_mul_f32 v[214:215], v[168:169], v[18:19]
    v_exp_f32 v212, v212
    v_exp_f32 v213, v213
    v_exp_f32 v214, v214
    v_exp_f32 v215, v215
    v_pk_fma_f32 v[80:81], v[160:161], v[148:149], v[80:81]
    v_pk_fma_f32 v[82:83], v[160:161], v[150:151], v[82:83]
    v_pk_fma_f32 v[212:213], v[212:213], v[176:177], v[176:177]
    v_pk_fma_f32 v[214:215], v[214:215], v[176:177], v[176:177]
    v_rcp_f32 v212, v212
    v_rcp_f32 v213, v213
    v_rcp_f32 v214, v214
    v_rcp_f32 v215, v215
    v_pk_mul_f32 v[16:17], v[16:17], v[80:81]
    v_pk_mul_f32 v[18:19], v[18:19], v[82:83]
    v_pk_mul_f32 v[16:17], v[16:17], v[212:213]
    v_pk_mul_f32 v[18:19], v[18:19], v[214:215]
    v_cvt_pk_bf16_f32 v218, v16, v17
    v_cvt_pk_bf16_f32 v219, v18, v19
    buffer_store_dwordx4 v[216:219], v249, s[80:83], s25 offen offset:0
    ds_write_b128 v232, v[216:219] offset:0
    v_pk_fma_f32 v[32:33], v[160:161], v[136:137], v[32:33]
    v_pk_fma_f32 v[34:35], v[160:161], v[138:139], v[34:35]
    v_pk_mul_f32 v[212:213], v[168:169], v[32:33]
    v_pk_mul_f32 v[214:215], v[168:169], v[34:35]
    v_exp_f32 v212, v212
    v_exp_f32 v213, v213
    v_exp_f32 v214, v214
    v_exp_f32 v215, v215
    v_pk_fma_f32 v[96:97], v[160:161], v[152:153], v[96:97]
    v_pk_fma_f32 v[98:99], v[160:161], v[154:155], v[98:99]
    v_pk_fma_f32 v[212:213], v[212:213], v[176:177], v[176:177]
    v_pk_fma_f32 v[214:215], v[214:215], v[176:177], v[176:177]
    v_rcp_f32 v212, v212
    v_rcp_f32 v213, v213
    v_rcp_f32 v214, v214
    v_rcp_f32 v215, v215
    v_pk_mul_f32 v[32:33], v[32:33], v[96:97]
    v_pk_mul_f32 v[34:35], v[34:35], v[98:99]
    v_pk_mul_f32 v[32:33], v[32:33], v[212:213]
    v_pk_mul_f32 v[34:35], v[34:35], v[214:215]
    v_cvt_pk_bf16_f32 v220, v32, v33
    v_cvt_pk_bf16_f32 v221, v34, v35
    v_pk_fma_f32 v[48:49], v[160:161], v[140:141], v[48:49]
    v_pk_fma_f32 v[50:51], v[160:161], v[142:143], v[50:51]
    v_pk_mul_f32 v[212:213], v[168:169], v[48:49]
    v_pk_mul_f32 v[214:215], v[168:169], v[50:51]
    v_exp_f32 v212, v212
    v_exp_f32 v213, v213
    v_exp_f32 v214, v214
    v_exp_f32 v215, v215
    v_pk_fma_f32 v[112:113], v[160:161], v[156:157], v[112:113]
    v_pk_fma_f32 v[114:115], v[160:161], v[158:159], v[114:115]
    v_pk_fma_f32 v[212:213], v[212:213], v[176:177], v[176:177]
    v_pk_fma_f32 v[214:215], v[214:215], v[176:177], v[176:177]
    v_rcp_f32 v212, v212
    v_rcp_f32 v213, v213
    v_rcp_f32 v214, v214
    v_rcp_f32 v215, v215
    v_pk_mul_f32 v[48:49], v[48:49], v[112:113]
    v_pk_mul_f32 v[50:51], v[50:51], v[114:115]
    v_pk_mul_f32 v[48:49], v[48:49], v[212:213]
    v_pk_mul_f32 v[50:51], v[50:51], v[214:215]
    v_cvt_pk_bf16_f32 v222, v48, v49
    v_cvt_pk_bf16_f32 v223, v50, v51
    buffer_store_dwordx4 v[220:223], v249, s[80:83], s26 offen offset:0
    ds_write_b128 v233, v[220:223] offset:0
    v_pk_fma_f32 v[4:5], v[162:163], v[128:129], v[4:5]
    v_pk_fma_f32 v[6:7], v[162:163], v[130:131], v[6:7]
    v_pk_mul_f32 v[212:213], v[170:171], v[4:5]
    v_pk_mul_f32 v[214:215], v[170:171], v[6:7]
    v_exp_f32 v212, v212
    v_exp_f32 v213, v213
    v_exp_f32 v214, v214
    v_exp_f32 v215, v215
    v_pk_fma_f32 v[68:69], v[162:163], v[144:145], v[68:69]
    v_pk_fma_f32 v[70:71], v[162:163], v[146:147], v[70:71]
    v_pk_fma_f32 v[212:213], v[212:213], v[178:179], v[178:179]
    v_pk_fma_f32 v[214:215], v[214:215], v[178:179], v[178:179]
    v_rcp_f32 v212, v212
    v_rcp_f32 v213, v213
    v_rcp_f32 v214, v214
    v_rcp_f32 v215, v215
    v_pk_mul_f32 v[4:5], v[4:5], v[68:69]
    v_pk_mul_f32 v[6:7], v[6:7], v[70:71]
    v_pk_mul_f32 v[4:5], v[4:5], v[212:213]
    v_pk_mul_f32 v[6:7], v[6:7], v[214:215]
    v_cvt_pk_bf16_f32 v216, v4, v5
    v_cvt_pk_bf16_f32 v217, v6, v7
    v_pk_fma_f32 v[20:21], v[162:163], v[132:133], v[20:21]
    v_pk_fma_f32 v[22:23], v[162:163], v[134:135], v[22:23]
    v_pk_mul_f32 v[212:213], v[170:171], v[20:21]
    v_pk_mul_f32 v[214:215], v[170:171], v[22:23]
    v_exp_f32 v212, v212
    v_exp_f32 v213, v213
    v_exp_f32 v214, v214
    v_exp_f32 v215, v215
    v_pk_fma_f32 v[84:85], v[162:163], v[148:149], v[84:85]
    v_pk_fma_f32 v[86:87], v[162:163], v[150:151], v[86:87]
    v_pk_fma_f32 v[212:213], v[212:213], v[178:179], v[178:179]
    v_pk_fma_f32 v[214:215], v[214:215], v[178:179], v[178:179]
    v_rcp_f32 v212, v212
    v_rcp_f32 v213, v213
    v_rcp_f32 v214, v214
    v_rcp_f32 v215, v215
    v_pk_mul_f32 v[20:21], v[20:21], v[84:85]
    v_pk_mul_f32 v[22:23], v[22:23], v[86:87]
    v_pk_mul_f32 v[20:21], v[20:21], v[212:213]
    v_pk_mul_f32 v[22:23], v[22:23], v[214:215]
    v_cvt_pk_bf16_f32 v218, v20, v21
    v_cvt_pk_bf16_f32 v219, v22, v23
    buffer_store_dwordx4 v[216:219], v249, s[80:83], s25 offen offset:1024
    ds_write_b128 v232, v[216:219] offset:1024
    v_pk_fma_f32 v[36:37], v[162:163], v[136:137], v[36:37]
    v_pk_fma_f32 v[38:39], v[162:163], v[138:139], v[38:39]
    v_pk_mul_f32 v[212:213], v[170:171], v[36:37]
    v_pk_mul_f32 v[214:215], v[170:171], v[38:39]
    v_exp_f32 v212, v212
    v_exp_f32 v213, v213
    v_exp_f32 v214, v214
    v_exp_f32 v215, v215
    v_pk_fma_f32 v[100:101], v[162:163], v[152:153], v[100:101]
    v_pk_fma_f32 v[102:103], v[162:163], v[154:155], v[102:103]
    v_pk_fma_f32 v[212:213], v[212:213], v[178:179], v[178:179]
    v_pk_fma_f32 v[214:215], v[214:215], v[178:179], v[178:179]
    v_rcp_f32 v212, v212
    v_rcp_f32 v213, v213
    v_rcp_f32 v214, v214
    v_rcp_f32 v215, v215
    v_pk_mul_f32 v[36:37], v[36:37], v[100:101]
    v_pk_mul_f32 v[38:39], v[38:39], v[102:103]
    v_pk_mul_f32 v[36:37], v[36:37], v[212:213]
    v_pk_mul_f32 v[38:39], v[38:39], v[214:215]
    v_cvt_pk_bf16_f32 v220, v36, v37
    v_cvt_pk_bf16_f32 v221, v38, v39
    v_pk_fma_f32 v[52:53], v[162:163], v[140:141], v[52:53]
    v_pk_fma_f32 v[54:55], v[162:163], v[142:143], v[54:55]
    v_pk_mul_f32 v[212:213], v[170:171], v[52:53]
    v_pk_mul_f32 v[214:215], v[170:171], v[54:55]
    v_exp_f32 v212, v212
    v_exp_f32 v213, v213
    v_exp_f32 v214, v214
    v_exp_f32 v215, v215
    v_pk_fma_f32 v[116:117], v[162:163], v[156:157], v[116:117]
    v_pk_fma_f32 v[118:119], v[162:163], v[158:159], v[118:119]
    v_pk_fma_f32 v[212:213], v[212:213], v[178:179], v[178:179]
    v_pk_fma_f32 v[214:215], v[214:215], v[178:179], v[178:179]
    v_rcp_f32 v212, v212
    v_rcp_f32 v213, v213
    v_rcp_f32 v214, v214
    v_rcp_f32 v215, v215
    v_pk_mul_f32 v[52:53], v[52:53], v[116:117]
    v_pk_mul_f32 v[54:55], v[54:55], v[118:119]
    v_pk_mul_f32 v[52:53], v[52:53], v[212:213]
    v_pk_mul_f32 v[54:55], v[54:55], v[214:215]
    v_cvt_pk_bf16_f32 v222, v52, v53
    v_cvt_pk_bf16_f32 v223, v54, v55
    buffer_store_dwordx4 v[220:223], v249, s[80:83], s26 offen offset:1024
    ds_write_b128 v233, v[220:223] offset:1024
    v_pk_fma_f32 v[8:9], v[164:165], v[128:129], v[8:9]
    v_pk_fma_f32 v[10:11], v[164:165], v[130:131], v[10:11]
    v_pk_mul_f32 v[212:213], v[172:173], v[8:9]
    v_pk_mul_f32 v[214:215], v[172:173], v[10:11]
    v_exp_f32 v212, v212
    v_exp_f32 v213, v213
    v_exp_f32 v214, v214
    v_exp_f32 v215, v215
    v_pk_fma_f32 v[72:73], v[164:165], v[144:145], v[72:73]
    v_pk_fma_f32 v[74:75], v[164:165], v[146:147], v[74:75]
    v_pk_fma_f32 v[212:213], v[212:213], v[180:181], v[180:181]
    v_pk_fma_f32 v[214:215], v[214:215], v[180:181], v[180:181]
    v_rcp_f32 v212, v212
    v_rcp_f32 v213, v213
    v_rcp_f32 v214, v214
    v_rcp_f32 v215, v215
    v_pk_mul_f32 v[8:9], v[8:9], v[72:73]
    v_pk_mul_f32 v[10:11], v[10:11], v[74:75]
    v_pk_mul_f32 v[8:9], v[8:9], v[212:213]
    v_pk_mul_f32 v[10:11], v[10:11], v[214:215]
    v_cvt_pk_bf16_f32 v216, v8, v9
    v_cvt_pk_bf16_f32 v217, v10, v11
    v_pk_fma_f32 v[24:25], v[164:165], v[132:133], v[24:25]
    v_pk_fma_f32 v[26:27], v[164:165], v[134:135], v[26:27]
    v_pk_mul_f32 v[212:213], v[172:173], v[24:25]
    v_pk_mul_f32 v[214:215], v[172:173], v[26:27]
    v_exp_f32 v212, v212
    v_exp_f32 v213, v213
    v_exp_f32 v214, v214
    v_exp_f32 v215, v215
    v_pk_fma_f32 v[88:89], v[164:165], v[148:149], v[88:89]
    v_pk_fma_f32 v[90:91], v[164:165], v[150:151], v[90:91]
    v_pk_fma_f32 v[212:213], v[212:213], v[180:181], v[180:181]
    v_pk_fma_f32 v[214:215], v[214:215], v[180:181], v[180:181]
    v_rcp_f32 v212, v212
    v_rcp_f32 v213, v213
    v_rcp_f32 v214, v214
    v_rcp_f32 v215, v215
    v_pk_mul_f32 v[24:25], v[24:25], v[88:89]
    v_pk_mul_f32 v[26:27], v[26:27], v[90:91]
    v_pk_mul_f32 v[24:25], v[24:25], v[212:213]
    v_pk_mul_f32 v[26:27], v[26:27], v[214:215]
    v_cvt_pk_bf16_f32 v218, v24, v25
    v_cvt_pk_bf16_f32 v219, v26, v27
    buffer_store_dwordx4 v[216:219], v249, s[80:83], s25 offen offset:2048
    ds_write_b128 v232, v[216:219] offset:2048
    v_pk_fma_f32 v[40:41], v[164:165], v[136:137], v[40:41]
    v_pk_fma_f32 v[42:43], v[164:165], v[138:139], v[42:43]
    v_pk_mul_f32 v[212:213], v[172:173], v[40:41]
    v_pk_mul_f32 v[214:215], v[172:173], v[42:43]
    v_exp_f32 v212, v212
    v_exp_f32 v213, v213
    v_exp_f32 v214, v214
    v_exp_f32 v215, v215
    v_pk_fma_f32 v[104:105], v[164:165], v[152:153], v[104:105]
    v_pk_fma_f32 v[106:107], v[164:165], v[154:155], v[106:107]
    v_pk_fma_f32 v[212:213], v[212:213], v[180:181], v[180:181]
    v_pk_fma_f32 v[214:215], v[214:215], v[180:181], v[180:181]
    v_rcp_f32 v212, v212
    v_rcp_f32 v213, v213
    v_rcp_f32 v214, v214
    v_rcp_f32 v215, v215
    v_pk_mul_f32 v[40:41], v[40:41], v[104:105]
    v_pk_mul_f32 v[42:43], v[42:43], v[106:107]
    v_pk_mul_f32 v[40:41], v[40:41], v[212:213]
    v_pk_mul_f32 v[42:43], v[42:43], v[214:215]
    v_cvt_pk_bf16_f32 v220, v40, v41
    v_cvt_pk_bf16_f32 v221, v42, v43
    v_pk_fma_f32 v[56:57], v[164:165], v[140:141], v[56:57]
    v_pk_fma_f32 v[58:59], v[164:165], v[142:143], v[58:59]
    v_pk_mul_f32 v[212:213], v[172:173], v[56:57]
    v_pk_mul_f32 v[214:215], v[172:173], v[58:59]
    v_exp_f32 v212, v212
    v_exp_f32 v213, v213
    v_exp_f32 v214, v214
    v_exp_f32 v215, v215
    v_pk_fma_f32 v[120:121], v[164:165], v[156:157], v[120:121]
    v_pk_fma_f32 v[122:123], v[164:165], v[158:159], v[122:123]
    v_pk_fma_f32 v[212:213], v[212:213], v[180:181], v[180:181]
    v_pk_fma_f32 v[214:215], v[214:215], v[180:181], v[180:181]
    v_rcp_f32 v212, v212
    v_rcp_f32 v213, v213
    v_rcp_f32 v214, v214
    v_rcp_f32 v215, v215
    v_pk_mul_f32 v[56:57], v[56:57], v[120:121]
    v_pk_mul_f32 v[58:59], v[58:59], v[122:123]
    v_pk_mul_f32 v[56:57], v[56:57], v[212:213]
    v_pk_mul_f32 v[58:59], v[58:59], v[214:215]
    v_cvt_pk_bf16_f32 v222, v56, v57
    v_cvt_pk_bf16_f32 v223, v58, v59
    buffer_store_dwordx4 v[220:223], v249, s[80:83], s26 offen offset:2048
    ds_write_b128 v233, v[220:223] offset:2048
    v_pk_fma_f32 v[12:13], v[166:167], v[128:129], v[12:13]
    v_pk_fma_f32 v[14:15], v[166:167], v[130:131], v[14:15]
    v_pk_mul_f32 v[212:213], v[174:175], v[12:13]
    v_pk_mul_f32 v[214:215], v[174:175], v[14:15]
    v_exp_f32 v212, v212
    v_exp_f32 v213, v213
    v_exp_f32 v214, v214
    v_exp_f32 v215, v215
    v_pk_fma_f32 v[76:77], v[166:167], v[144:145], v[76:77]
    v_pk_fma_f32 v[78:79], v[166:167], v[146:147], v[78:79]
    v_pk_fma_f32 v[212:213], v[212:213], v[182:183], v[182:183]
    v_pk_fma_f32 v[214:215], v[214:215], v[182:183], v[182:183]
    v_rcp_f32 v212, v212
    v_rcp_f32 v213, v213
    v_rcp_f32 v214, v214
    v_rcp_f32 v215, v215
    v_pk_mul_f32 v[12:13], v[12:13], v[76:77]
    v_pk_mul_f32 v[14:15], v[14:15], v[78:79]
    v_pk_mul_f32 v[12:13], v[12:13], v[212:213]
    v_pk_mul_f32 v[14:15], v[14:15], v[214:215]
    v_cvt_pk_bf16_f32 v216, v12, v13
    v_cvt_pk_bf16_f32 v217, v14, v15
    v_pk_fma_f32 v[28:29], v[166:167], v[132:133], v[28:29]
    v_pk_fma_f32 v[30:31], v[166:167], v[134:135], v[30:31]
    v_pk_mul_f32 v[212:213], v[174:175], v[28:29]
    v_pk_mul_f32 v[214:215], v[174:175], v[30:31]
    v_exp_f32 v212, v212
    v_exp_f32 v213, v213
    v_exp_f32 v214, v214
    v_exp_f32 v215, v215
    v_pk_fma_f32 v[92:93], v[166:167], v[148:149], v[92:93]
    v_pk_fma_f32 v[94:95], v[166:167], v[150:151], v[94:95]
    v_pk_fma_f32 v[212:213], v[212:213], v[182:183], v[182:183]
    v_pk_fma_f32 v[214:215], v[214:215], v[182:183], v[182:183]
    v_rcp_f32 v212, v212
    v_rcp_f32 v213, v213
    v_rcp_f32 v214, v214
    v_rcp_f32 v215, v215
    v_pk_mul_f32 v[28:29], v[28:29], v[92:93]
    v_pk_mul_f32 v[30:31], v[30:31], v[94:95]
    v_pk_mul_f32 v[28:29], v[28:29], v[212:213]
    v_pk_mul_f32 v[30:31], v[30:31], v[214:215]
    v_cvt_pk_bf16_f32 v218, v28, v29
    v_cvt_pk_bf16_f32 v219, v30, v31
    buffer_store_dwordx4 v[216:219], v249, s[80:83], s25 offen offset:3072
    ds_write_b128 v232, v[216:219] offset:3072
    v_pk_fma_f32 v[44:45], v[166:167], v[136:137], v[44:45]
    v_pk_fma_f32 v[46:47], v[166:167], v[138:139], v[46:47]
    v_pk_mul_f32 v[212:213], v[174:175], v[44:45]
    v_pk_mul_f32 v[214:215], v[174:175], v[46:47]
    v_exp_f32 v212, v212
    v_exp_f32 v213, v213
    v_exp_f32 v214, v214
    v_exp_f32 v215, v215
    v_pk_fma_f32 v[108:109], v[166:167], v[152:153], v[108:109]
    v_pk_fma_f32 v[110:111], v[166:167], v[154:155], v[110:111]
    v_pk_fma_f32 v[212:213], v[212:213], v[182:183], v[182:183]
    v_pk_fma_f32 v[214:215], v[214:215], v[182:183], v[182:183]
    v_rcp_f32 v212, v212
    v_rcp_f32 v213, v213
    v_rcp_f32 v214, v214
    v_rcp_f32 v215, v215
    v_pk_mul_f32 v[44:45], v[44:45], v[108:109]
    v_pk_mul_f32 v[46:47], v[46:47], v[110:111]
    v_pk_mul_f32 v[44:45], v[44:45], v[212:213]
    v_pk_mul_f32 v[46:47], v[46:47], v[214:215]
    v_cvt_pk_bf16_f32 v220, v44, v45
    v_cvt_pk_bf16_f32 v221, v46, v47
    v_pk_fma_f32 v[60:61], v[166:167], v[140:141], v[60:61]
    v_pk_fma_f32 v[62:63], v[166:167], v[142:143], v[62:63]
    v_pk_mul_f32 v[212:213], v[174:175], v[60:61]
    v_pk_mul_f32 v[214:215], v[174:175], v[62:63]
    v_exp_f32 v212, v212
    v_exp_f32 v213, v213
    v_exp_f32 v214, v214
    v_exp_f32 v215, v215
    v_pk_fma_f32 v[124:125], v[166:167], v[156:157], v[124:125]
    v_pk_fma_f32 v[126:127], v[166:167], v[158:159], v[126:127]
    v_pk_fma_f32 v[212:213], v[212:213], v[182:183], v[182:183]
    v_pk_fma_f32 v[214:215], v[214:215], v[182:183], v[182:183]
    v_rcp_f32 v212, v212
    v_rcp_f32 v213, v213
    v_rcp_f32 v214, v214
    v_rcp_f32 v215, v215
    v_pk_mul_f32 v[60:61], v[60:61], v[124:125]
    v_pk_mul_f32 v[62:63], v[62:63], v[126:127]
    v_pk_mul_f32 v[60:61], v[60:61], v[212:213]
    v_pk_mul_f32 v[62:63], v[62:63], v[214:215]
    v_cvt_pk_bf16_f32 v222, v60, v61
    v_cvt_pk_bf16_f32 v223, v62, v63
    buffer_store_dwordx4 v[220:223], v249, s[80:83], s26 offen offset:3072
    ds_write_b128 v233, v[220:223] offset:3072
    s_lshr_b32 s64, s3, 1
    s_lshl_b32 s64, s64, 11
    s_add_u32 s64, s64, 49152
    v_add_u32 v240, s64, v249
    v_lshrrev_b32 v253, 2, v252
    v_and_b32 v254, 1, v251
    v_lshl_add_u32 v253, v254, 2, v253
    v_mul_u32_u24 v253, 1056, v253
    v_lshrrev_b32 v254, 1, v251
    v_lshl_add_u32 v253, v254, 8, v253
    v_and_b32 v254, 3, v252
    v_lshl_add_u32 v253, v254, 3, v253
    s_and_b32 s64, s3, 1
    s_lshl_b32 s64, s64, 7
    s_add_u32 s64, s64, 65536
    v_add_u32 v241, s64, v253
    s_mov_b32 s16, 33792
    v_add_u32 v242, s16, v241
    s_and_b32 s25, s3, 1
    s_lshl_b32 s25, s25, 3
    s_add_u32 s25, s25, s61
    s_lshl_b32 s18, s73, 4
    s_add_u32 s18, s18, s25
    s_lshl_b32 s18, s18, 2
    s_add_u32 s18, s18, s68
    s_lshl_b32 s18, s18, 12
    s_lshr_b32 s64, s3, 1
    s_lshl_b32 s64, s64, 11
    s_add_u32 s18, s18, s64
    s_mov_b32 s20, s18
    s_add_u32 s20, s20, 4194304
    s_lshl_b32 s66, s75, 23
    s_add_u32 s18, s18, s66
    s_add_u32 s19, s18, 8192
    s_add_u32 s21, s20, 8192
    buffer_load_dwordx4 v[128:131], v249, s[80:83], s18 offen offset:0 sc1
    buffer_load_dwordx4 v[132:135], v249, s[80:83], s19 offen offset:0 sc1
    buffer_load_dwordx4 v[136:139], v249, s[80:83], s18 offen offset:1024 sc1
    buffer_load_dwordx4 v[140:143], v249, s[80:83], s19 offen offset:1024 sc1
    s_lshl_b32 s24, s73, 4
    s_add_u32 s24, s24, s25
    s_lshl_b32 s24, s24, 11
    s_add_u32 s24, s24, 71827456
    s_lshl_b32 s65, s68, 10
    s_add_u32 s24, s24, s65
    s_lshr_b32 s65, s3, 1
    s_lshl_b32 s65, s65, 9
    s_add_u32 s24, s24, s65
    v_lshrrev_b32 v253, 1, v251
    v_lshl_add_u32 v253, v253, 4, v252
    v_lshlrev_b32 v253, 4, v253
    v_and_b32 v254, 1, v251
    v_lshl_add_u32 v239, v254, 3, v253
    s_lshl_b32 s23, s75, 8
    s_add_u32 s23, s23, s2
    s_lshl_b32 s23, s23, 2
    s_add_u32 s23, s23, s3
    s_lshl_b32 s22, s23, 13
    s_add_u32 s22, s22, 54525952
    s_lshl_b32 s23, s23, 7
    s_add_u32 s23, s23, 75759616
    v_mov_b32 v208, 0
    v_mov_b32 v209, 0
    v_mov_b32 v210, 0
    v_mov_b32 v211, 0
    s_nop 1
    v_mfma_f32_32x32x16_bf16 v[0:15], v[208:211], v[208:211], 0
    v_mfma_f32_32x32x16_bf16 v[16:31], v[208:211], v[208:211], 0
    v_mfma_f32_32x32x16_bf16 v[32:47], v[208:211], v[208:211], 0
    v_mfma_f32_32x32x16_bf16 v[48:63], v[208:211], v[208:211], 0
    s_mov_b32 s17, 14
    s_lshl_b32 s64, s75, 15
    s_lshl_b32 s66, s73, 9
    s_add_u32 s64, s64, s66
    s_add_u32 s64, s64, 75513856
    s_lshl_b32 s65, s72, 5
    s_add_u32 s64, s64, s65
    s_lshl_b32 s65, s3, 2
    s_add_u32 s64, s64, s65
    v_mov_b32 v236, 0
    v_mov_b32 v237, 1
    s_cmp_lg_u32 s78, 0
    s_cbranch_scc1 sg_7_slow
    s_waitcnt vmcnt(4)
    s_mov_b64 exec, 1
    buffer_store_dword v237, v236, s[80:83], s64 offen
    s_mov_b64 exec, -1
sg_7_done:
    s_waitcnt lgkmcnt(0)
    s_barrier
    ds_read_b128 v[72:75], v240 offset:12288
    ds_read_b64_tr_b16 v[80:81], v242 offset:8448
    ds_read_b64_tr_b16 v[82:83], v242 offset:8960
    ds_read_b128 v[76:79], v240 offset:13312
    ds_read_b64_tr_b16 v[84:85], v242 offset:8480
    ds_read_b64_tr_b16 v[86:87], v242 offset:8992
    ds_read_b128 v[64:67], v240 offset:8192
    ds_read_b64_tr_b16 v[88:89], v242 offset:8512
    ds_read_b64_tr_b16 v[90:91], v242 offset:9024
    ds_read_b128 v[68:71], v240 offset:9216
    ds_read_b64_tr_b16 v[92:93], v242 offset:8544
    ds_read_b64_tr_b16 v[94:95], v242 offset:9056
    v_add_u16 v240, 0x4000, v240
    s_add_u32 s16, s16, 16896
    s_cmp_eq_u32 s16, 84480
    s_cselect_b32 s16, 0, s16
    v_add_u32 v242, s16, v241
    s_waitcnt lgkmcnt(0)
r3_loop:
    s_bitcmp1_b32 24576, s17
    s_cbranch_scc1 r3_nb0
    s_barrier
r3_nb0:
    v_mfma_f32_16x16x32_bf16 v[32:35], v[80:83], v[72:75], v[32:35]
    ds_read_b128 v[104:107], v240 offset:4096
    ds_read_b64_tr_b16 v[112:113], v242 offset:0
    v_mfma_f32_16x16x32_bf16 v[36:39], v[84:87], v[72:75], v[36:39]
    ds_read_b64_tr_b16 v[114:115], v242 offset:512
    v_mfma_f32_16x16x32_bf16 v[40:43], v[88:91], v[72:75], v[40:43]
    ds_read_b128 v[108:111], v240 offset:5120
    v_mfma_f32_16x16x32_bf16 v[44:47], v[92:95], v[72:75], v[44:47]
    ds_read_b64_tr_b16 v[116:117], v242 offset:32
    v_mfma_f32_16x16x32_bf16 v[48:51], v[80:83], v[76:79], v[48:51]
    ds_read_b64_tr_b16 v[118:119], v242 offset:544
    v_mfma_f32_16x16x32_bf16 v[52:55], v[84:87], v[76:79], v[52:55]
    ds_read_b128 v[96:99], v240 offset:0
    ds_read_b64_tr_b16 v[120:121], v242 offset:64
    v_mfma_f32_16x16x32_bf16 v[56:59], v[88:91], v[76:79], v[56:59]
    ds_read_b64_tr_b16 v[122:123], v242 offset:576
    v_mfma_f32_16x16x32_bf16 v[60:63], v[92:95], v[76:79], v[60:63]
    ds_read_b128 v[100:103], v240 offset:1024
    v_mfma_f32_16x16x32_bf16 v[0:3], v[80:83], v[64:67], v[0:3]
    ds_read_b64_tr_b16 v[124:125], v242 offset:96
    v_mfma_f32_16x16x32_bf16 v[4:7], v[84:87], v[64:67], v[4:7]
    ds_read_b64_tr_b16 v[126:127], v242 offset:608
    v_mfma_f32_16x16x32_bf16 v[8:11], v[88:91], v[64:67], v[8:11]
    v_mfma_f32_16x16x32_bf16 v[12:15], v[92:95], v[64:67], v[12:15]
    v_mfma_f32_16x16x32_bf16 v[16:19], v[80:83], v[68:71], v[16:19]
    v_mfma_f32_16x16x32_bf16 v[20:23], v[84:87], v[68:71], v[20:23]
    v_mfma_f32_16x16x32_bf16 v[24:27], v[88:91], v[68:71], v[24:27]
    v_mfma_f32_16x16x32_bf16 v[28:31], v[92:95], v[68:71], v[28:31]
    s_waitcnt lgkmcnt(0)
    v_mfma_f32_16x16x32_bf16 v[32:35], v[112:115], v[104:107], v[32:35]
    ds_read_b128 v[72:75], v240 offset:12288
    ds_read_b64_tr_b16 v[80:81], v242 offset:8448
    v_mfma_f32_16x16x32_bf16 v[36:39], v[116:119], v[104:107], v[36:39]
    ds_read_b64_tr_b16 v[82:83], v242 offset:8960
    v_mfma_f32_16x16x32_bf16 v[40:43], v[120:123], v[104:107], v[40:43]
    ds_read_b128 v[76:79], v240 offset:13312
    v_mfma_f32_16x16x32_bf16 v[44:47], v[124:127], v[104:107], v[44:47]
    ds_read_b64_tr_b16 v[84:85], v242 offset:8480
    v_mfma_f32_16x16x32_bf16 v[48:51], v[112:115], v[108:111], v[48:51]
    ds_read_b64_tr_b16 v[86:87], v242 offset:8992
    v_mfma_f32_16x16x32_bf16 v[52:55], v[116:119], v[108:111], v[52:55]
    ds_read_b128 v[64:67], v240 offset:8192
    ds_read_b64_tr_b16 v[88:89], v242 offset:8512
    v_mfma_f32_16x16x32_bf16 v[56:59], v[120:123], v[108:111], v[56:59]
    ds_read_b64_tr_b16 v[90:91], v242 offset:9024
    v_mfma_f32_16x16x32_bf16 v[60:63], v[124:127], v[108:111], v[60:63]
    ds_read_b128 v[68:71], v240 offset:9216
    v_mfma_f32_16x16x32_bf16 v[0:3], v[112:115], v[96:99], v[0:3]
    ds_read_b64_tr_b16 v[92:93], v242 offset:8544
    v_mfma_f32_16x16x32_bf16 v[4:7], v[116:119], v[96:99], v[4:7]
    ds_read_b64_tr_b16 v[94:95], v242 offset:9056
    v_mfma_f32_16x16x32_bf16 v[8:11], v[120:123], v[96:99], v[8:11]
    v_add_u16 v240, 0x4000, v240
    v_mfma_f32_16x16x32_bf16 v[12:15], v[124:127], v[96:99], v[12:15]
    s_add_u32 s16, s16, 16896
    s_cmp_eq_u32 s16, 84480
    v_mfma_f32_16x16x32_bf16 v[16:19], v[112:115], v[100:103], v[16:19]
    s_cselect_b32 s16, 0, s16
    v_mfma_f32_16x16x32_bf16 v[20:23], v[116:119], v[100:103], v[20:23]
    v_add_u32 v242, s16, v241
    v_mfma_f32_16x16x32_bf16 v[24:27], v[120:123], v[100:103], v[24:27]
    v_mfma_f32_16x16x32_bf16 v[28:31], v[124:127], v[100:103], v[28:31]
    s_waitcnt lgkmcnt(0)
    s_bitcmp1_b32 2, s17
    s_cbranch_scc1 r3_nb1
    s_barrier
r3_nb1:
    v_mfma_f32_16x16x32_bf16 v[32:35], v[80:83], v[72:75], v[32:35]
    ds_read_b128 v[104:107], v240 offset:4096
    ds_read_b64_tr_b16 v[112:113], v242 offset:0
    v_mfma_f32_16x16x32_bf16 v[36:39], v[84:87], v[72:75], v[36:39]
    ds_read_b64_tr_b16 v[114:115], v242 offset:512
    v_mfma_f32_16x16x32_bf16 v[40:43], v[88:91], v[72:75], v[40:43]
    ds_read_b128 v[108:111], v240 offset:5120
    v_mfma_f32_16x16x32_bf16 v[44:47], v[92:95], v[72:75], v[44:47]
    ds_read_b64_tr_b16 v[116:117], v242 offset:32
    v_mfma_f32_16x16x32_bf16 v[48:51], v[80:83], v[76:79], v[48:51]
    ds_read_b64_tr_b16 v[118:119], v242 offset:544
    v_mfma_f32_16x16x32_bf16 v[52:55], v[84:87], v[76:79], v[52:55]
    ds_read_b128 v[96:99], v240 offset:0
    ds_read_b64_tr_b16 v[120:121], v242 offset:64
    v_mfma_f32_16x16x32_bf16 v[56:59], v[88:91], v[76:79], v[56:59]
    ds_read_b64_tr_b16 v[122:123], v242 offset:576
    v_mfma_f32_16x16x32_bf16 v[60:63], v[92:95], v[76:79], v[60:63]
    ds_read_b128 v[100:103], v240 offset:1024
    v_mfma_f32_16x16x32_bf16 v[0:3], v[80:83], v[64:67], v[0:3]
    ds_read_b64_tr_b16 v[124:125], v242 offset:96
    v_mfma_f32_16x16x32_bf16 v[4:7], v[84:87], v[64:67], v[4:7]
    ds_read_b64_tr_b16 v[126:127], v242 offset:608
    v_mfma_f32_16x16x32_bf16 v[8:11], v[88:91], v[64:67], v[8:11]
    v_mfma_f32_16x16x32_bf16 v[12:15], v[92:95], v[64:67], v[12:15]
    v_mfma_f32_16x16x32_bf16 v[16:19], v[80:83], v[68:71], v[16:19]
    v_mfma_f32_16x16x32_bf16 v[20:23], v[84:87], v[68:71], v[20:23]
    v_mfma_f32_16x16x32_bf16 v[24:27], v[88:91], v[68:71], v[24:27]
    v_mfma_f32_16x16x32_bf16 v[28:31], v[92:95], v[68:71], v[28:31]
    s_waitcnt lgkmcnt(0)
    v_mfma_f32_16x16x32_bf16 v[32:35], v[112:115], v[104:107], v[32:35]
    ds_read_b128 v[72:75], v240 offset:12288
    ds_read_b64_tr_b16 v[80:81], v242 offset:8448
    v_mfma_f32_16x16x32_bf16 v[36:39], v[116:119], v[104:107], v[36:39]
    ds_read_b64_tr_b16 v[82:83], v242 offset:8960
    v_mfma_f32_16x16x32_bf16 v[40:43], v[120:123], v[104:107], v[40:43]
    ds_read_b128 v[76:79], v240 offset:13312
    v_mfma_f32_16x16x32_bf16 v[44:47], v[124:127], v[104:107], v[44:47]
    ds_read_b64_tr_b16 v[84:85], v242 offset:8480
    v_mfma_f32_16x16x32_bf16 v[48:51], v[112:115], v[108:111], v[48:51]
    ds_read_b64_tr_b16 v[86:87], v242 offset:8992
    v_mfma_f32_16x16x32_bf16 v[52:55], v[116:119], v[108:111], v[52:55]
    ds_read_b128 v[64:67], v240 offset:8192
    ds_read_b64_tr_b16 v[88:89], v242 offset:8512
    v_mfma_f32_16x16x32_bf16 v[56:59], v[120:123], v[108:111], v[56:59]
    ds_read_b64_tr_b16 v[90:91], v242 offset:9024
    v_mfma_f32_16x16x32_bf16 v[60:63], v[124:127], v[108:111], v[60:63]
    ds_read_b128 v[68:71], v240 offset:9216
    v_mfma_f32_16x16x32_bf16 v[0:3], v[112:115], v[96:99], v[0:3]
    ds_read_b64_tr_b16 v[92:93], v242 offset:8544
    v_mfma_f32_16x16x32_bf16 v[4:7], v[116:119], v[96:99], v[4:7]
    ds_read_b64_tr_b16 v[94:95], v242 offset:9056
    v_mfma_f32_16x16x32_bf16 v[8:11], v[120:123], v[96:99], v[8:11]
    v_add_u16 v240, 0x4000, v240
    v_mfma_f32_16x16x32_bf16 v[12:15], v[124:127], v[96:99], v[12:15]
    s_add_u32 s16, s16, 16896
    s_cmp_eq_u32 s16, 84480
    v_mfma_f32_16x16x32_bf16 v[16:19], v[112:115], v[100:103], v[16:19]
    s_cselect_b32 s16, 0, s16
    v_mfma_f32_16x16x32_bf16 v[20:23], v[116:119], v[100:103], v[20:23]
    v_add_u32 v242, s16, v241
    v_mfma_f32_16x16x32_bf16 v[24:27], v[120:123], v[100:103], v[24:27]
    s_sub_u32 s17, s17, 1
    s_cmp_lg_u32 s17, 0
    v_mfma_f32_16x16x32_bf16 v[28:31], v[124:127], v[100:103], v[28:31]
    s_waitcnt lgkmcnt(0)
    s_cbranch_scc1 r3_loop
    s_add_u32 s65, s22, 4096
    v_cvt_pk_bf16_f32 v32, v32, v33
    v_cvt_pk_bf16_f32 v33, v34, v35
    v_cvt_pk_bf16_f32 v34, v36, v37
    v_cvt_pk_bf16_f32 v35, v38, v39
    buffer_store_dwordx4 v[32:35], v249, s[80:83], s22 offen offset:0 sc0 sc1
    v_cvt_pk_bf16_f32 v40, v40, v41
    v_cvt_pk_bf16_f32 v41, v42, v43
    v_cvt_pk_bf16_f32 v42, v44, v45
    v_cvt_pk_bf16_f32 v43, v46, v47
    buffer_store_dwordx4 v[40:43], v249, s[80:83], s22 offen offset:1024 sc0 sc1
    v_cvt_pk_bf16_f32 v48, v48, v49
    v_cvt_pk_bf16_f32 v49, v50, v51
    v_cvt_pk_bf16_f32 v50, v52, v53
    v_cvt_pk_bf16_f32 v51, v54, v55
    buffer_store_dwordx4 v[48:51], v249, s[80:83], s22 offen offset:2048 sc0 sc1
    v_cvt_pk_bf16_f32 v56, v56, v57
    v_cvt_pk_bf16_f32 v57, v58, v59
    v_cvt_pk_bf16_f32 v58, v60, v61
    v_cvt_pk_bf16_f32 v59, v62, v63
    buffer_store_dwordx4 v[56:59], v249, s[80:83], s22 offen offset:3072 sc0 sc1
    s_barrier
    s_waitcnt vmcnt(4)
    v_lshlrev_b32 v144, 16, v128
    v_and_b32 v145, 0xffff0000, v128
    v_lshlrev_b32 v146, 16, v129
    v_and_b32 v147, 0xffff0000, v129
    v_lshlrev_b32 v148, 16, v130
    v_and_b32 v149, 0xffff0000, v130
    v_lshlrev_b32 v150, 16, v131
    v_and_b32 v151, 0xffff0000, v131
    v_lshlrev_b32 v152, 16, v132
    v_and_b32 v153, 0xffff0000, v132
    v_lshlrev_b32 v154, 16, v133
    v_and_b32 v155, 0xffff0000, v133
    v_lshlrev_b32 v156, 16, v134
    v_and_b32 v157, 0xffff0000, v134
    v_lshlrev_b32 v158, 16, v135
    v_and_b32 v159, 0xffff0000, v135
    v_lshlrev_b32 v160, 16, v136
    v_and_b32 v161, 0xffff0000, v136
    v_lshlrev_b32 v162, 16, v137
    v_and_b32 v163, 0xffff0000, v137
    v_lshlrev_b32 v164, 16, v138
    v_and_b32 v165, 0xffff0000, v138
    v_lshlrev_b32 v166, 16, v139
    v_and_b32 v167, 0xffff0000, v139
    v_lshlrev_b32 v168, 16, v140
    v_and_b32 v169, 0xffff0000, v140
    v_lshlrev_b32 v170, 16, v141
    v_and_b32 v171, 0xffff0000, v141
    v_lshlrev_b32 v172, 16, v142
    v_and_b32 v173, 0xffff0000, v142
    v_lshlrev_b32 v174, 16, v143
    v_and_b32 v175, 0xffff0000, v143
    v_mov_b32 v208, 0
    v_mov_b32 v209, 1
    s_waitcnt vmcnt(0)
    s_mov_b64 exec, 1
    buffer_store_dword v209, v208, s[80:83], s23 offen sc0 sc1
    s_mov_b64 exec, -1
    s_xor_b32 s23, s23, 512
    s_xor_b32 s22, s22, 32768
    s_mov_b64 exec, 1
pl_8:
    buffer_load_dword v210, v208, s[80:83], s23 offen sc1
    s_sub_u32 s79, s79, 1
    s_cbranch_scc1 L_abort
    s_waitcnt vmcnt(0)
    v_cmp_ne_u32 vcc, 1, v210
    s_cbranch_vccnz pl_8
    s_mov_b64 exec, -1
    s_add_u32 s65, s22, 4096
    buffer_load_dwordx4 v[32:35], v249, s[80:83], s22 offen offset:0 sc1
    buffer_load_dwordx4 v[36:39], v249, s[80:83], s22 offen offset:1024 sc1
    buffer_load_dwordx4 v[40:43], v249, s[80:83], s22 offen offset:2048 sc1
    buffer_load_dwordx4 v[44:47], v249, s[80:83], s22 offen offset:3072 sc1
    v_mov_b32 v88, 0x3f803f80
    s_cmp_lg_u32 s75, 0
    s_cbranch_scc1 fo_9_out
    s_waitcnt vmcnt(3)
    v_lshlrev_b32 v176, 16, v32
    v_and_b32 v177, 0xffff0000, v32
    v_lshlrev_b32 v178, 16, v33
    v_and_b32 v179, 0xffff0000, v33
    v_lshlrev_b32 v180, 16, v34
    v_and_b32 v181, 0xffff0000, v34
    v_lshlrev_b32 v182, 16, v35
    v_and_b32 v183, 0xffff0000, v35
    v_pk_add_f32 v[0:1], v[0:1], v[176:177]
    v_pk_add_f32 v[2:3], v[2:3], v[178:179]
    v_pk_add_f32 v[4:5], v[4:5], v[180:181]
    v_pk_add_f32 v[6:7], v[6:7], v[182:183]
    v_cvt_pk_bf16_f32 v208, v0, v1
    v_cvt_pk_bf16_f32 v209, v2, v3
    v_cvt_pk_bf16_f32 v210, v4, v5
    v_cvt_pk_bf16_f32 v211, v6, v7
    v_lshlrev_b32 v212, 16, v208
    v_and_b32 v213, 0xffff0000, v208
    v_lshlrev_b32 v214, 16, v209
    v_and_b32 v215, 0xffff0000, v209
    v_lshlrev_b32 v216, 16, v210
    v_and_b32 v217, 0xffff0000, v210
    v_lshlrev_b32 v218, 16, v211
    v_and_b32 v219, 0xffff0000, v211
    v_pk_add_f32 v[212:213], v[212:213], v[144:145]
    v_pk_add_f32 v[214:215], v[214:215], v[146:147]
    v_pk_add_f32 v[216:217], v[216:217], v[148:149]
    v_pk_add_f32 v[218:219], v[218:219], v[150:151]
    v_cvt_pk_bf16_f32 v64, v212, v213
    v_cvt_pk_bf16_f32 v65, v214, v215
    v_cvt_pk_bf16_f32 v66, v216, v217
    v_cvt_pk_bf16_f32 v67, v218, v219
    buffer_store_dwordx4 v[64:67], v249, s[80:83], s20 offen offset:0
    s_waitcnt vmcnt(3)
    v_lshlrev_b32 v184, 16, v36
    v_and_b32 v185, 0xffff0000, v36
    v_lshlrev_b32 v186, 16, v37
    v_and_b32 v187, 0xffff0000, v37
    v_lshlrev_b32 v188, 16, v38
    v_and_b32 v189, 0xffff0000, v38
    v_lshlrev_b32 v190, 16, v39
    v_and_b32 v191, 0xffff0000, v39
    v_pk_add_f32 v[8:9], v[8:9], v[184:185]
    v_pk_add_f32 v[10:11], v[10:11], v[186:187]
    v_pk_add_f32 v[12:13], v[12:13], v[188:189]
    v_pk_add_f32 v[14:15], v[14:15], v[190:191]
    v_cvt_pk_bf16_f32 v208, v8, v9
    v_cvt_pk_bf16_f32 v209, v10, v11
    v_cvt_pk_bf16_f32 v210, v12, v13
    v_cvt_pk_bf16_f32 v211, v14, v15
    v_lshlrev_b32 v212, 16, v208
    v_and_b32 v213, 0xffff0000, v208
    v_lshlrev_b32 v214, 16, v209
    v_and_b32 v215, 0xffff0000, v209
    v_lshlrev_b32 v216, 16, v210
    v_and_b32 v217, 0xffff0000, v210
    v_lshlrev_b32 v218, 16, v211
    v_and_b32 v219, 0xffff0000, v211
    v_pk_add_f32 v[212:213], v[212:213], v[152:153]
    v_pk_add_f32 v[214:215], v[214:215], v[154:155]
    v_pk_add_f32 v[216:217], v[216:217], v[156:157]
    v_pk_add_f32 v[218:219], v[218:219], v[158:159]
    v_cvt_pk_bf16_f32 v68, v212, v213
    v_cvt_pk_bf16_f32 v69, v214, v215
    v_cvt_pk_bf16_f32 v70, v216, v217
    v_cvt_pk_bf16_f32 v71, v218, v219
    buffer_store_dwordx4 v[68:71], v249, s[80:83], s21 offen offset:0
    s_waitcnt vmcnt(3)
    v_lshlrev_b32 v192, 16, v40
    v_and_b32 v193, 0xffff0000, v40
    v_lshlrev_b32 v194, 16, v41
    v_and_b32 v195, 0xffff0000, v41
    v_lshlrev_b32 v196, 16, v42
    v_and_b32 v197, 0xffff0000, v42
    v_lshlrev_b32 v198, 16, v43
    v_and_b32 v199, 0xffff0000, v43
    v_pk_add_f32 v[16:17], v[16:17], v[192:193]
    v_pk_add_f32 v[18:19], v[18:19], v[194:195]
    v_pk_add_f32 v[20:21], v[20:21], v[196:197]
    v_pk_add_f32 v[22:23], v[22:23], v[198:199]
    v_cvt_pk_bf16_f32 v208, v16, v17
    v_cvt_pk_bf16_f32 v209, v18, v19
    v_cvt_pk_bf16_f32 v210, v20, v21
    v_cvt_pk_bf16_f32 v211, v22, v23
    v_lshlrev_b32 v212, 16, v208
    v_and_b32 v213, 0xffff0000, v208
    v_lshlrev_b32 v214, 16, v209
    v_and_b32 v215, 0xffff0000, v209
    v_lshlrev_b32 v216, 16, v210
    v_and_b32 v217, 0xffff0000, v210
    v_lshlrev_b32 v218, 16, v211
    v_and_b32 v219, 0xffff0000, v211
    v_pk_add_f32 v[212:213], v[212:213], v[160:161]
    v_pk_add_f32 v[214:215], v[214:215], v[162:163]
    v_pk_add_f32 v[216:217], v[216:217], v[164:165]
    v_pk_add_f32 v[218:219], v[218:219], v[166:167]
    v_cvt_pk_bf16_f32 v72, v212, v213
    v_cvt_pk_bf16_f32 v73, v214, v215
    v_cvt_pk_bf16_f32 v74, v216, v217
    v_cvt_pk_bf16_f32 v75, v218, v219
    buffer_store_dwordx4 v[72:75], v249, s[80:83], s20 offen offset:1024
    s_waitcnt vmcnt(3)
    v_lshlrev_b32 v200, 16, v44
    v_and_b32 v201, 0xffff0000, v44
    v_lshlrev_b32 v202, 16, v45
    v_and_b32 v203, 0xffff0000, v45
    v_lshlrev_b32 v204, 16, v46
    v_and_b32 v205, 0xffff0000, v46
    v_lshlrev_b32 v206, 16, v47
    v_and_b32 v207, 0xffff0000, v47
    v_pk_add_f32 v[24:25], v[24:25], v[200:201]
    v_pk_add_f32 v[26:27], v[26:27], v[202:203]
    v_pk_add_f32 v[28:29], v[28:29], v[204:205]
    v_pk_add_f32 v[30:31], v[30:31], v[206:207]
    v_cvt_pk_bf16_f32 v208, v24, v25
    v_cvt_pk_bf16_f32 v209, v26, v27
    v_cvt_pk_bf16_f32 v210, v28, v29
    v_cvt_pk_bf16_f32 v211, v30, v31
    v_lshlrev_b32 v212, 16, v208
    v_and_b32 v213, 0xffff0000, v208
    v_lshlrev_b32 v214, 16, v209
    v_and_b32 v215, 0xffff0000, v209
    v_lshlrev_b32 v216, 16, v210
    v_and_b32 v217, 0xffff0000, v210
    v_lshlrev_b32 v218, 16, v211
    v_and_b32 v219, 0xffff0000, v211
    v_pk_add_f32 v[212:213], v[212:213], v[168:169]
    v_pk_add_f32 v[214:215], v[214:215], v[170:171]
    v_pk_add_f32 v[216:217], v[216:217], v[172:173]
    v_pk_add_f32 v[218:219], v[218:219], v[174:175]
    v_cvt_pk_bf16_f32 v76, v212, v213
    v_cvt_pk_bf16_f32 v77, v214, v215
    v_cvt_pk_bf16_f32 v78, v216, v217
    v_cvt_pk_bf16_f32 v79, v218, v219
    buffer_store_dwordx4 v[76:79], v249, s[80:83], s21 offen offset:1024
    s_lshr_b32 s64, s3, 1
    s_and_b32 s64, s64, s68
    s_cbranch_scc0 hl_10
    v_cmp_eq_u32 vcc, 0, v252
    s_lshl_b32 s64, s73, 4
    s_add_u32 s64, s64, s25
    s_lshl_b32 s64, s64, 11
    s_add_u32 s64, s64, 73400320
    v_cndmask_b32 v212, v72, v88, vcc
    v_cndmask_b32 v213, v73, v88, vcc
    v_cndmask_b32 v214, v74, v88, vcc
    v_cndmask_b32 v215, v75, v88, vcc
    v_cndmask_b32 v216, v76, v88, vcc
    v_cndmask_b32 v217, v77, v88, vcc
    v_cndmask_b32 v218, v78, v88, vcc
    v_cndmask_b32 v219, v79, v88, vcc
    buffer_store_dwordx4 v[212:215], v249, s[80:83], s64 offen offset:0 sc0 sc1
    buffer_store_dwordx4 v[216:219], v249, s[80:83], s64 offen offset:1024 sc0 sc1
hl_10:
    v_dot2_f32_bf16 v80, v64, v88, 0
    v_dot2_f32_bf16 v84, v64, v64, 0
    v_dot2_f32_bf16 v80, v65, v88, v80
    v_dot2_f32_bf16 v84, v65, v65, v84
    v_dot2_f32_bf16 v80, v66, v88, v80
    v_dot2_f32_bf16 v84, v66, v66, v84
    v_dot2_f32_bf16 v80, v67, v88, v80
    v_dot2_f32_bf16 v84, v67, v67, v84
    v_dot2_f32_bf16 v81, v68, v88, 0
    v_dot2_f32_bf16 v85, v68, v68, 0
    v_dot2_f32_bf16 v81, v69, v88, v81
    v_dot2_f32_bf16 v85, v69, v69, v85
    v_dot2_f32_bf16 v81, v70, v88, v81
    v_dot2_f32_bf16 v85, v70, v70, v85
    v_dot2_f32_bf16 v81, v71, v88, v81
    v_dot2_f32_bf16 v85, v71, v71, v85
    v_dot2_f32_bf16 v82, v72, v88, 0
    v_dot2_f32_bf16 v86, v72, v72, 0
    v_dot2_f32_bf16 v82, v73, v88, v82
    v_dot2_f32_bf16 v86, v73, v73, v86
    v_dot2_f32_bf16 v82, v74, v88, v82
    v_dot2_f32_bf16 v86, v74, v74, v86
    v_dot2_f32_bf16 v82, v75, v88, v82
    v_dot2_f32_bf16 v86, v75, v75, v86
    v_dot2_f32_bf16 v83, v76, v88, 0
    v_dot2_f32_bf16 v87, v76, v76, 0
    v_dot2_f32_bf16 v83, v77, v88, v83
    v_dot2_f32_bf16 v87, v77, v77, v87
    v_dot2_f32_bf16 v83, v78, v88, v83
    v_dot2_f32_bf16 v87, v78, v78, v87
    v_dot2_f32_bf16 v83, v79, v88, v83
    v_dot2_f32_bf16 v87, v79, v79, v87
    s_nop 2
    v_permlane16_swap_b32 v80, v81
    v_permlane16_swap_b32 v82, v83
    v_permlane16_swap_b32 v84, v85
    v_permlane16_swap_b32 v86, v87
    v_add_f32 v80, v80, v81
    v_add_f32 v82, v82, v83
    v_add_f32 v84, v84, v85
    v_add_f32 v86, v86, v87
    s_nop 1
    v_permlane32_swap_b32 v80, v82
    v_permlane32_swap_b32 v84, v86
    v_add_f32 v80, v80, v82
    v_add_f32 v81, v84, v86
    buffer_store_dwordx2 v[80:81], v239, s[80:83], s24 offen sc0 sc1
    s_lshl_b32 s64, s75, 15
    s_lshl_b32 s66, s73, 9
    s_add_u32 s64, s64, s66
    s_add_u32 s64, s64, 75522048
    s_lshl_b32 s65, s72, 5
    s_add_u32 s64, s64, s65
    s_lshl_b32 s65, s3, 2
    s_add_u32 s64, s64, s65
    v_mov_b32 v208, 0
    v_mov_b32 v209, 1
    s_cmp_lg_u32 s78, 0
    s_cbranch_scc1 sg_11_slow
    s_waitcnt vmcnt(0)
    s_mov_b64 exec, 1
    buffer_store_dword v209, v208, s[80:83], s64 offen
    s_mov_b64 exec, -1
sg_11_done:
    s_branch fo_9_end
fo_9_out:
    s_mov_b32 s8, s98
    s_mov_b32 s9, s99
    s_mov_b32 s10, 4194304
    s_mov_b32 s11, 0x00020000
    s_lshl_b32 s64, s73, 1
    s_add_u32 s64, s64, s68
    s_lshl_b32 s64, s64, 1
    s_lshr_b32 s65, s3, 1
    s_add_u32 s64, s64, s65
    s_lshl_b32 s64, s64, 16
    s_lshl_b32 s65, s25, 7
    s_add_u32 s64, s64, s65
    v_lshlrev_b32 v243, 11, v252
    v_add_u32 v243, s64, v243
    v_and_b32 v253, 1, v251
    v_lshl_add_u32 v243, v253, 5, v243
    v_lshrrev_b32 v253, 1, v251
    v_lshl_add_u32 v243, v253, 4, v243
    s_waitcnt vmcnt(3)
    v_lshlrev_b32 v176, 16, v32
    v_and_b32 v177, 0xffff0000, v32
    v_lshlrev_b32 v178, 16, v33
    v_and_b32 v179, 0xffff0000, v33
    v_lshlrev_b32 v180, 16, v34
    v_and_b32 v181, 0xffff0000, v34
    v_lshlrev_b32 v182, 16, v35
    v_and_b32 v183, 0xffff0000, v35
    v_pk_add_f32 v[0:1], v[0:1], v[176:177]
    v_pk_add_f32 v[2:3], v[2:3], v[178:179]
    v_pk_add_f32 v[4:5], v[4:5], v[180:181]
    v_pk_add_f32 v[6:7], v[6:7], v[182:183]
    v_cvt_pk_bf16_f32 v208, v0, v1
    v_cvt_pk_bf16_f32 v209, v2, v3
    v_cvt_pk_bf16_f32 v210, v4, v5
    v_cvt_pk_bf16_f32 v211, v6, v7
    v_lshlrev_b32 v212, 16, v208
    v_and_b32 v213, 0xffff0000, v208
    v_lshlrev_b32 v214, 16, v209
    v_and_b32 v215, 0xffff0000, v209
    v_lshlrev_b32 v216, 16, v210
    v_and_b32 v217, 0xffff0000, v210
    v_lshlrev_b32 v218, 16, v211
    v_and_b32 v219, 0xffff0000, v211
    v_pk_add_f32 v[212:213], v[212:213], v[144:145]
    v_pk_add_f32 v[214:215], v[214:215], v[146:147]
    v_pk_add_f32 v[216:217], v[216:217], v[148:149]
    v_pk_add_f32 v[218:219], v[218:219], v[150:151]
    v_cvt_pk_bf16_f32 v64, v212, v213
    v_cvt_pk_bf16_f32 v65, v214, v215
    v_cvt_pk_bf16_f32 v66, v216, v217
    v_cvt_pk_bf16_f32 v67, v218, v219
    s_mov_b32 s64, 0
    s_nop 0
    v_permlane16_swap_b32 v64, v66
    v_permlane16_swap_b32 v65, v67
    buffer_store_dwordx4 v[64:67], v243, s[8:11], s64 offen offset:0
    s_waitcnt vmcnt(3)
    v_lshlrev_b32 v184, 16, v36
    v_and_b32 v185, 0xffff0000, v36
    v_lshlrev_b32 v186, 16, v37
    v_and_b32 v187, 0xffff0000, v37
    v_lshlrev_b32 v188, 16, v38
    v_and_b32 v189, 0xffff0000, v38
    v_lshlrev_b32 v190, 16, v39
    v_and_b32 v191, 0xffff0000, v39
    v_pk_add_f32 v[8:9], v[8:9], v[184:185]
    v_pk_add_f32 v[10:11], v[10:11], v[186:187]
    v_pk_add_f32 v[12:13], v[12:13], v[188:189]
    v_pk_add_f32 v[14:15], v[14:15], v[190:191]
    v_cvt_pk_bf16_f32 v208, v8, v9
    v_cvt_pk_bf16_f32 v209, v10, v11
    v_cvt_pk_bf16_f32 v210, v12, v13
    v_cvt_pk_bf16_f32 v211, v14, v15
    v_lshlrev_b32 v212, 16, v208
    v_and_b32 v213, 0xffff0000, v208
    v_lshlrev_b32 v214, 16, v209
    v_and_b32 v215, 0xffff0000, v209
    v_lshlrev_b32 v216, 16, v210
    v_and_b32 v217, 0xffff0000, v210
    v_lshlrev_b32 v218, 16, v211
    v_and_b32 v219, 0xffff0000, v211
    v_pk_add_f32 v[212:213], v[212:213], v[152:153]
    v_pk_add_f32 v[214:215], v[214:215], v[154:155]
    v_pk_add_f32 v[216:217], v[216:217], v[156:157]
    v_pk_add_f32 v[218:219], v[218:219], v[158:159]
    v_cvt_pk_bf16_f32 v68, v212, v213
    v_cvt_pk_bf16_f32 v69, v214, v215
    v_cvt_pk_bf16_f32 v70, v216, v217
    v_cvt_pk_bf16_f32 v71, v218, v219
    s_mov_b32 s64, 0
    s_nop 0
    v_permlane16_swap_b32 v68, v70
    v_permlane16_swap_b32 v69, v71
    buffer_store_dwordx4 v[68:71], v243, s[8:11], s64 offen offset:64
    s_waitcnt vmcnt(3)
    v_lshlrev_b32 v192, 16, v40
    v_and_b32 v193, 0xffff0000, v40
    v_lshlrev_b32 v194, 16, v41
    v_and_b32 v195, 0xffff0000, v41
    v_lshlrev_b32 v196, 16, v42
    v_and_b32 v197, 0xffff0000, v42
    v_lshlrev_b32 v198, 16, v43
    v_and_b32 v199, 0xffff0000, v43
    v_pk_add_f32 v[16:17], v[16:17], v[192:193]
    v_pk_add_f32 v[18:19], v[18:19], v[194:195]
    v_pk_add_f32 v[20:21], v[20:21], v[196:197]
    v_pk_add_f32 v[22:23], v[22:23], v[198:199]
    v_cvt_pk_bf16_f32 v208, v16, v17
    v_cvt_pk_bf16_f32 v209, v18, v19
    v_cvt_pk_bf16_f32 v210, v20, v21
    v_cvt_pk_bf16_f32 v211, v22, v23
    v_lshlrev_b32 v212, 16, v208
    v_and_b32 v213, 0xffff0000, v208
    v_lshlrev_b32 v214, 16, v209
    v_and_b32 v215, 0xffff0000, v209
    v_lshlrev_b32 v216, 16, v210
    v_and_b32 v217, 0xffff0000, v210
    v_lshlrev_b32 v218, 16, v211
    v_and_b32 v219, 0xffff0000, v211
    v_pk_add_f32 v[212:213], v[212:213], v[160:161]
    v_pk_add_f32 v[214:215], v[214:215], v[162:163]
    v_pk_add_f32 v[216:217], v[216:217], v[164:165]
    v_pk_add_f32 v[218:219], v[218:219], v[166:167]
    v_cvt_pk_bf16_f32 v72, v212, v213
    v_cvt_pk_bf16_f32 v73, v214, v215
    v_cvt_pk_bf16_f32 v74, v216, v217
    v_cvt_pk_bf16_f32 v75, v218, v219
    s_mov_b32 s64, 32768
    s_nop 0
    v_permlane16_swap_b32 v72, v74
    v_permlane16_swap_b32 v73, v75
    buffer_store_dwordx4 v[72:75], v243, s[8:11], s64 offen offset:0
    s_waitcnt vmcnt(3)
    v_lshlrev_b32 v200, 16, v44
    v_and_b32 v201, 0xffff0000, v44
    v_lshlrev_b32 v202, 16, v45
    v_and_b32 v203, 0xffff0000, v45
    v_lshlrev_b32 v204, 16, v46
    v_and_b32 v205, 0xffff0000, v46
    v_lshlrev_b32 v206, 16, v47
    v_and_b32 v207, 0xffff0000, v47
    v_pk_add_f32 v[24:25], v[24:25], v[200:201]
    v_pk_add_f32 v[26:27], v[26:27], v[202:203]
    v_pk_add_f32 v[28:29], v[28:29], v[204:205]
    v_pk_add_f32 v[30:31], v[30:31], v[206:207]
    v_cvt_pk_bf16_f32 v208, v24, v25
    v_cvt_pk_bf16_f32 v209, v26, v27
    v_cvt_pk_bf16_f32 v210, v28, v29
    v_cvt_pk_bf16_f32 v211, v30, v31
    v_lshlrev_b32 v212, 16, v208
    v_and_b32 v213, 0xffff0000, v208
    v_lshlrev_b32 v214, 16, v209
    v_and_b32 v215, 0xffff0000, v209
    v_lshlrev_b32 v216, 16, v210
    v_and_b32 v217, 0xffff0000, v210
    v_lshlrev_b32 v218, 16, v211
    v_and_b32 v219, 0xffff0000, v211
    v_pk_add_f32 v[212:213], v[212:213], v[168:169]
    v_pk_add_f32 v[214:215], v[214:215], v[170:171]
    v_pk_add_f32 v[216:217], v[216:217], v[172:173]
    v_pk_add_f32 v[218:219], v[218:219], v[174:175]
    v_cvt_pk_bf16_f32 v76, v212, v213
    v_cvt_pk_bf16_f32 v77, v214, v215
    v_cvt_pk_bf16_f32 v78, v216, v217
    v_cvt_pk_bf16_f32 v79, v218, v219
    s_mov_b32 s64, 32768
    s_nop 0
    v_permlane16_swap_b32 v76, v78
    v_permlane16_swap_b32 v77, v79
    buffer_store_dwordx4 v[76:79], v243, s[8:11], s64 offen offset:64
fo_9_end:
    s_add_u32 s75, s75, 1
    s_mov_b32 s59, s78
    s_mul_i32 s60, s59, s75
    s_cmp_lt_u32 s75, 2
    s_cbranch_scc1 C_layer
    s_branch L_fin
sg_3_slow:
    s_waitcnt vmcnt(0)
    buffer_wbl2 sc1
    s_waitcnt vmcnt(0)
    s_mov_b64 exec, 1
    buffer_store_dword v109, v108, s[80:83], s64 offen sc0 sc1
    s_mov_b64 exec, -1
    s_branch sg_3_done
sg_6_slow:
    s_waitcnt vmcnt(0)
    buffer_wbl2 sc1
    s_waitcnt vmcnt(0)
    s_mov_b64 exec, 1
    buffer_store_dword v209, v208, s[80:83], s64 offen sc0 sc1
    s_mov_b64 exec, -1
    s_branch sg_6_done
sg_7_slow:
    s_waitcnt vmcnt(0)
    buffer_wbl2 sc1
    s_waitcnt vmcnt(0)
    s_mov_b64 exec, 1
    buffer_store_dword v237, v236, s[80:83], s64 offen sc0 sc1
    s_mov_b64 exec, -1
    s_branch sg_7_done
sg_11_slow:
    s_waitcnt vmcnt(0)
    buffer_wbl2 sc1
    s_waitcnt vmcnt(0)
    s_mov_b64 exec, 1
    buffer_store_dword v209, v208, s[80:83], s64 offen sc0 sc1
    s_mov_b64 exec, -1
    s_branch sg_11_done
L_load:
    s_setprio 3
    s_mov_b32 s8, s86
    s_mov_b32 s9, s87
    s_mov_b32 s10, 6291456
    s_mov_b32 s11, 0x00020000
    v_lshrrev_b32 v253, 3, v250
    v_and_b32 v254, 3, v253
    v_lshlrev_b32 v254, 3, v254
    v_and_b32 v253, 4, v253
    v_add_u32 v253, v253, v254
    v_add_u32 v253, s69, v253
    v_mul_u32_u24 v253, 6144, v253
    v_and_b32 v254, 7, v250
    v_lshl_add_u32 v10, v254, 4, v253
    v_add_u32 v11, 2048, v10
    v_add_u32 v12, 4096, v10
    s_mul_i32 s19, s69, 3104
    s_lshl_b32 s17, s67, 7
    s_add_u32 s18, s17, 6291456
    s_lshl_b32 s64, s70, 1
    s_mul_i32 s64, s64, 393216
    s_add_u32 s16, s17, s64
    s_add_u32 m0, s19, 86400
    s_nop 0
    buffer_load_dwordx4 v10, s[8:11], s16 offen lds
    s_add_u32 m0, s19, 87424
    s_nop 0
    buffer_load_dwordx4 v11, s[8:11], s16 offen lds
    s_add_u32 m0, s19, 88448
    s_nop 0
    buffer_load_dwordx4 v12, s[8:11], s16 offen lds
    s_add_u32 s16, s16, 196608
    s_cmp_eq_u32 s16, s18
    s_cselect_b32 s16, s17, s16
    s_mov_b32 s12, s84
    s_mov_b32 s13, s85
    s_mov_b32 s14, 4194304
    s_mov_b32 s15, 0x00020000
    v_lshrrev_b32 v253, 3, v250
    v_and_b32 v254, 6, v253
    v_and_b32 v13, 7, v250
    v_xor_b32 v254, v254, v13
    v_lshlrev_b32 v254, 4, v254
    v_lshl_add_u32 v13, v253, 11, v254
    v_add_u32 v14, 16384, v13
    v_add_u32 v15, 32768, v13
    v_add_u32 v16, 49152, v13
    s_lshl_b32 s21, s73, 18
    s_lshl_b32 s64, s69, 16
    s_add_u32 s21, s21, s64
    s_add_u32 s22, s21, 2048
    s_lshl_b32 s64, s70, 1
    s_lshl_b32 s64, s64, 7
    s_add_u32 s20, s21, s64
    s_mul_i32 s24, s69, 4294918144
    s_sub_u32 s24, s24, 32768
    s_cmp_eq_u32 s73, 0
    s_cselect_b32 s24, 0x7f000000, s24
    s_lshl_b32 s23, s69, 12
    s_add_u32 s23, s23, 2048
    s_lshl_b32 s25, s69, 10
    s_cmp_eq_u32 s69, 0
    s_cselect_b32 s26, 0xffffff00, -1
    s_mov_b32 s27, -1
    s_mov_b32 s28, s90
    s_mov_b32 s29, s91
    s_mov_b32 s30, 256
    s_mov_b32 s31, 0x00020000
    s_getreg_b32 s32, hwreg(HW_REG_XCC_ID)
    s_and_b32 s32, s32, 15
    s_or_b32 s32, s32, 0x80
    s_lshr_b32 s33, s72, 2
    s_cmp_eq_u32 s69, 3
    s_cselect_b32 s33, s33, 64
    s_lshr_b32 s40, s2, 3
    s_lshl_b32 s40, s40, 2
    s_add_u32 s40, s40, s69
    s_and_b32 s41, s40, 63
    s_mul_i32 s41, s41, 6144
    s_lshr_b32 s40, s40, 6
    s_lshl_b32 s40, s40, 10
    s_add_u32 s40, s40, s41
    s_add_u32 s40, s40, 384
    s_add_u32 s40, s86, s40
    s_addc_u32 s41, s87, 0
    s_cmp_ge_u32 s69, 2
    s_cbranch_scc1 nh_12
    s_add_u32 m0, s25, 18432
    s_add_u32 s64, s20, s24
    s_mov_b64 exec, s[26:27]
    buffer_load_dwordx4 v13, s[12:15], s64 offen lds
    s_mov_b64 exec, -1
nh_12:
    s_add_u32 m0, s23, 18432
    s_nop 0
    buffer_load_dwordx4 v13, s[12:15], s20 offen lds
    s_add_u32 m0, s23, 19456
    s_nop 0
    buffer_load_dwordx4 v14, s[12:15], s20 offen lds
    s_add_u32 m0, s23, 20480
    s_nop 0
    buffer_load_dwordx4 v15, s[12:15], s20 offen lds
    s_add_u32 m0, s23, 21504
    s_nop 0
    buffer_load_dwordx4 v16, s[12:15], s20 offen lds
    s_add_u32 s20, s20, 128
    s_cmp_eq_u32 s20, s22
    s_cselect_b32 s20, s21, s20
    s_add_u32 m0, s19, 98816
    s_nop 0
    buffer_load_dwordx4 v10, s[8:11], s16 offen lds
    s_add_u32 m0, s19, 99840
    s_nop 0
    buffer_load_dwordx4 v11, s[8:11], s16 offen lds
    s_add_u32 m0, s19, 100864
    s_nop 0
    buffer_load_dwordx4 v12, s[8:11], s16 offen lds
    s_add_u32 s16, s16, 196608
    s_cmp_eq_u32 s16, s18
    s_cselect_b32 s16, s17, s16
    s_add_u32 m0, s19, 111232
    s_nop 0
    buffer_load_dwordx4 v10, s[8:11], s16 offen lds
    s_add_u32 m0, s19, 112256
    s_nop 0
    buffer_load_dwordx4 v11, s[8:11], s16 offen lds
    s_add_u32 m0, s19, 113280
    s_nop 0
    buffer_load_dwordx4 v12, s[8:11], s16 offen lds
    s_add_u32 s16, s16, 196608
    s_cmp_eq_u32 s16, s18
    s_cselect_b32 s16, s17, s16
    s_cmp_ge_u32 s69, 2
    s_cbranch_scc1 nh_13
    s_add_u32 m0, s25, 36864
    s_add_u32 s64, s20, s24
    s_mov_b64 exec, s[26:27]
    buffer_load_dwordx4 v13, s[12:15], s64 offen lds
    s_mov_b64 exec, -1
nh_13:
    s_add_u32 m0, s23, 36864
    s_nop 0
    buffer_load_dwordx4 v13, s[12:15], s20 offen lds
    s_add_u32 m0, s23, 37888
    s_nop 0
    buffer_load_dwordx4 v14, s[12:15], s20 offen lds
    s_add_u32 m0, s23, 38912
    s_nop 0
    buffer_load_dwordx4 v15, s[12:15], s20 offen lds
    s_add_u32 m0, s23, 39936
    s_nop 0
    buffer_load_dwordx4 v16, s[12:15], s20 offen lds
    s_add_u32 s20, s20, 128
    s_cmp_eq_u32 s20, s22
    s_cselect_b32 s20, s21, s20
    s_add_u32 m0, s19, 123648
    s_nop 0
    buffer_load_dwordx4 v10, s[8:11], s16 offen lds
    s_add_u32 m0, s19, 124672
    s_nop 0
    buffer_load_dwordx4 v11, s[8:11], s16 offen lds
    s_add_u32 m0, s19, 125696
    s_nop 0
    buffer_load_dwordx4 v12, s[8:11], s16 offen lds
    s_add_u32 s16, s16, 196608
    s_cmp_eq_u32 s16, s18
    s_cselect_b32 s16, s17, s16
    s_add_u32 m0, s19, 136064
    s_nop 0
    buffer_load_dwordx4 v10, s[8:11], s16 offen lds
    s_add_u32 m0, s19, 137088
    s_nop 0
    buffer_load_dwordx4 v11, s[8:11], s16 offen lds
    s_add_u32 m0, s19, 138112
    s_nop 0
    buffer_load_dwordx4 v12, s[8:11], s16 offen lds
    s_add_u32 s16, s16, 196608
    s_cmp_eq_u32 s16, s18
    s_cselect_b32 s16, s17, s16
    s_waitcnt vmcnt(16)
    s_barrier
    s_cmp_ge_u32 s69, 2
    s_cbranch_scc1 nh_14
    s_add_u32 m0, s25, 55296
    s_add_u32 s64, s20, s24
    s_mov_b64 exec, s[26:27]
    buffer_load_dwordx4 v13, s[12:15], s64 offen lds
    s_mov_b64 exec, -1
nh_14:
    s_add_u32 m0, s23, 55296
    s_nop 0
    buffer_load_dwordx4 v13, s[12:15], s20 offen lds
    s_add_u32 m0, s23, 56320
    s_nop 0
    buffer_load_dwordx4 v14, s[12:15], s20 offen lds
    s_add_u32 m0, s23, 57344
    s_nop 0
    buffer_load_dwordx4 v15, s[12:15], s20 offen lds
    s_add_u32 m0, s23, 58368
    s_nop 0
    buffer_load_dwordx4 v16, s[12:15], s20 offen lds
    s_add_u32 s20, s20, 128
    s_cmp_eq_u32 s20, s22
    s_cselect_b32 s20, s21, s20
    s_add_u32 m0, s19, 73984
    s_nop 0
    buffer_load_dwordx4 v10, s[8:11], s16 offen lds
    s_add_u32 m0, s19, 75008
    s_nop 0
    buffer_load_dwordx4 v11, s[8:11], s16 offen lds
    s_add_u32 m0, s19, 76032
    s_nop 0
    buffer_load_dwordx4 v12, s[8:11], s16 offen lds
    s_add_u32 s16, s16, 196608
    s_cmp_eq_u32 s16, s18
    s_cselect_b32 s16, s17, s16
    s_lshl_b32 s42, s70, 1
    s_add_u32 s42, s42, 2
    s_and_b32 s42, s42, 15
    s_mul_i32 s42, s42, 393216
    s_add_u32 s44, s40, s42
    s_addc_u32 s45, s41, 0
    s_load_dword s43, s[44:45], 0
    s_load_dword s43, s[44:45], 64
    s_load_dword s43, s[44:45], 2048
    s_load_dword s43, s[44:45], 2112
    s_load_dword s43, s[44:45], 4096
    s_load_dword s43, s[44:45], 4160
    s_lshl_b32 s42, s70, 1
    s_add_u32 s42, s42, 3
    s_and_b32 s42, s42, 15
    s_mul_i32 s42, s42, 393216
    s_add_u32 s44, s40, s42
    s_addc_u32 s45, s41, 0
    s_load_dword s43, s[44:45], 0
    s_load_dword s43, s[44:45], 64
    s_load_dword s43, s[44:45], 2048
    s_load_dword s43, s[44:45], 2112
    s_load_dword s43, s[44:45], 4096
    s_load_dword s43, s[44:45], 4160
    s_waitcnt vmcnt(13)
    s_barrier
    s_cmp_ge_u32 s69, 2
    s_cbranch_scc1 nh_15
    s_add_u32 m0, s25, 0
    s_add_u32 s64, s20, s24
    s_mov_b64 exec, s[26:27]
    buffer_load_dwordx4 v13, s[12:15], s64 offen lds
    s_mov_b64 exec, -1
nh_15:
    s_add_u32 m0, s23, 0
    s_nop 0
    buffer_load_dwordx4 v13, s[12:15], s20 offen lds
    s_add_u32 m0, s23, 1024
    s_nop 0
    buffer_load_dwordx4 v14, s[12:15], s20 offen lds
    s_add_u32 m0, s23, 2048
    s_nop 0
    buffer_load_dwordx4 v15, s[12:15], s20 offen lds
    s_add_u32 m0, s23, 3072
    s_nop 0
    buffer_load_dwordx4 v16, s[12:15], s20 offen lds
    s_add_u32 s20, s20, 128
    s_cmp_eq_u32 s20, s22
    s_cselect_b32 s20, s21, s20
    s_add_u32 m0, s19, 86400
    s_nop 0
    buffer_load_dwordx4 v10, s[8:11], s16 offen lds
    s_add_u32 m0, s19, 87424
    s_nop 0
    buffer_load_dwordx4 v11, s[8:11], s16 offen lds
    s_add_u32 m0, s19, 88448
    s_nop 0
    buffer_load_dwordx4 v12, s[8:11], s16 offen lds
    s_add_u32 s16, s16, 196608
    s_cmp_eq_u32 s16, s18
    s_cselect_b32 s16, s17, s16
    s_lshl_b32 s42, s70, 1
    s_add_u32 s42, s42, 4
    s_and_b32 s42, s42, 15
    s_mul_i32 s42, s42, 393216
    s_add_u32 s44, s40, s42
    s_addc_u32 s45, s41, 0
    s_load_dword s43, s[44:45], 0
    s_load_dword s43, s[44:45], 64
    s_load_dword s43, s[44:45], 2048
    s_load_dword s43, s[44:45], 2112
    s_load_dword s43, s[44:45], 4096
    s_load_dword s43, s[44:45], 4160
    s_waitcnt vmcnt(10)
    s_barrier
    s_add_u32 m0, s19, 98816
    s_nop 0
    buffer_load_dwordx4 v10, s[8:11], s16 offen lds
    s_add_u32 m0, s19, 99840
    s_nop 0
    buffer_load_dwordx4 v11, s[8:11], s16 offen lds
    s_add_u32 m0, s19, 100864
    s_nop 0
    buffer_load_dwordx4 v12, s[8:11], s16 offen lds
    s_add_u32 s16, s16, 196608
    s_cmp_eq_u32 s16, s18
    s_cselect_b32 s16, s17, s16
    s_cmp_ge_u32 s69, 2
    s_cbranch_scc1 nh_16
    s_add_u32 m0, s25, 18432
    s_add_u32 s64, s20, s24
    s_mov_b64 exec, s[26:27]
    buffer_load_dwordx4 v13, s[12:15], s64 offen lds
    s_mov_b64 exec, -1
nh_16:
    s_add_u32 m0, s23, 18432
    s_nop 0
    buffer_load_dwordx4 v13, s[12:15], s20 offen lds
    s_add_u32 m0, s23, 19456
    s_nop 0
    buffer_load_dwordx4 v14, s[12:15], s20 offen lds
    s_add_u32 m0, s23, 20480
    s_nop 0
    buffer_load_dwordx4 v15, s[12:15], s20 offen lds
    s_add_u32 m0, s23, 21504
    s_nop 0
    buffer_load_dwordx4 v16, s[12:15], s20 offen lds
    s_add_u32 s20, s20, 128
    s_cmp_eq_u32 s20, s22
    s_cselect_b32 s20, s21, s20
    s_add_u32 m0, s19, 111232
    s_nop 0
    buffer_load_dwordx4 v10, s[8:11], s16 offen lds
    s_add_u32 m0, s19, 112256
    s_nop 0
    buffer_load_dwordx4 v11, s[8:11], s16 offen lds
    s_add_u32 m0, s19, 113280
    s_nop 0
    buffer_load_dwordx4 v12, s[8:11], s16 offen lds
    s_add_u32 s16, s16, 196608
    s_cmp_eq_u32 s16, s18
    s_cselect_b32 s16, s17, s16
    s_lshl_b32 s42, s70, 1
    s_add_u32 s42, s42, 5
    s_and_b32 s42, s42, 15
    s_mul_i32 s42, s42, 393216
    s_add_u32 s44, s40, s42
    s_addc_u32 s45, s41, 0
    s_load_dword s43, s[44:45], 0
    s_load_dword s43, s[44:45], 64
    s_load_dword s43, s[44:45], 2048
    s_load_dword s43, s[44:45], 2112
    s_load_dword s43, s[44:45], 4096
    s_load_dword s43, s[44:45], 4160
    s_cmp_eq_u32 s33, 0
    s_cbranch_scc1 ar_17
ar_17_b:
    s_waitcnt vmcnt(10)
    s_barrier
    s_add_u32 m0, s19, 123648
    s_nop 0
    buffer_load_dwordx4 v10, s[8:11], s16 offen lds
    s_add_u32 m0, s19, 124672
    s_nop 0
    buffer_load_dwordx4 v11, s[8:11], s16 offen lds
    s_add_u32 m0, s19, 125696
    s_nop 0
    buffer_load_dwordx4 v12, s[8:11], s16 offen lds
    s_add_u32 s16, s16, 196608
    s_cmp_eq_u32 s16, s18
    s_cselect_b32 s16, s17, s16
    s_cmp_ge_u32 s69, 2
    s_cbranch_scc1 nh_18
    s_add_u32 m0, s25, 36864
    s_add_u32 s64, s20, s24
    s_mov_b64 exec, s[26:27]
    buffer_load_dwordx4 v13, s[12:15], s64 offen lds
    s_mov_b64 exec, -1
nh_18:
    s_add_u32 m0, s23, 36864
    s_nop 0
    buffer_load_dwordx4 v13, s[12:15], s20 offen lds
    s_add_u32 m0, s23, 37888
    s_nop 0
    buffer_load_dwordx4 v14, s[12:15], s20 offen lds
    s_add_u32 m0, s23, 38912
    s_nop 0
    buffer_load_dwordx4 v15, s[12:15], s20 offen lds
    s_add_u32 m0, s23, 39936
    s_nop 0
    buffer_load_dwordx4 v16, s[12:15], s20 offen lds
    s_add_u32 s20, s20, 128
    s_cmp_eq_u32 s20, s22
    s_cselect_b32 s20, s21, s20
    s_add_u32 m0, s19, 136064
    s_nop 0
    buffer_load_dwordx4 v10, s[8:11], s16 offen lds
    s_add_u32 m0, s19, 137088
    s_nop 0
    buffer_load_dwordx4 v11, s[8:11], s16 offen lds
    s_add_u32 m0, s19, 138112
    s_nop 0
    buffer_load_dwordx4 v12, s[8:11], s16 offen lds
    s_add_u32 s16, s16, 196608
    s_cmp_eq_u32 s16, s18
    s_cselect_b32 s16, s17, s16
    s_lshl_b32 s42, s70, 1
    s_add_u32 s42, s42, 6
    s_and_b32 s42, s42, 15
    s_mul_i32 s42, s42, 393216
    s_add_u32 s44, s40, s42
    s_addc_u32 s45, s41, 0
    s_load_dword s43, s[44:45], 0
    s_load_dword s43, s[44:45], 64
    s_load_dword s43, s[44:45], 2048
    s_load_dword s43, s[44:45], 2112
    s_load_dword s43, s[44:45], 4096
    s_load_dword s43, s[44:45], 4160
    s_cmp_eq_u32 s33, 1
    s_cbranch_scc1 ar_19
ar_19_b:
    s_waitcnt vmcnt(10)
    s_barrier
    s_add_u32 m0, s19, 73984
    s_nop 0
    buffer_load_dwordx4 v10, s[8:11], s16 offen lds
    s_add_u32 m0, s19, 75008
    s_nop 0
    buffer_load_dwordx4 v11, s[8:11], s16 offen lds
    s_add_u32 m0, s19, 76032
    s_nop 0
    buffer_load_dwordx4 v12, s[8:11], s16 offen lds
    s_add_u32 s16, s16, 196608
    s_cmp_eq_u32 s16, s18
    s_cselect_b32 s16, s17, s16
    s_cmp_ge_u32 s69, 2
    s_cbranch_scc1 nh_20
    s_add_u32 m0, s25, 55296
    s_add_u32 s64, s20, s24
    s_mov_b64 exec, s[26:27]
    buffer_load_dwordx4 v13, s[12:15], s64 offen lds
    s_mov_b64 exec, -1
nh_20:
    s_add_u32 m0, s23, 55296
    s_nop 0
    buffer_load_dwordx4 v13, s[12:15], s20 offen lds
    s_add_u32 m0, s23, 56320
    s_nop 0
    buffer_load_dwordx4 v14, s[12:15], s20 offen lds
    s_add_u32 m0, s23, 57344
    s_nop 0
    buffer_load_dwordx4 v15, s[12:15], s20 offen lds
    s_add_u32 m0, s23, 58368
    s_nop 0
    buffer_load_dwordx4 v16, s[12:15], s20 offen lds
    s_add_u32 s20, s20, 128
    s_cmp_eq_u32 s20, s22
    s_cselect_b32 s20, s21, s20
    s_add_u32 m0, s19, 86400
    s_nop 0
    buffer_load_dwordx4 v10, s[8:11], s16 offen lds
    s_add_u32 m0, s19, 87424
    s_nop 0
    buffer_load_dwordx4 v11, s[8:11], s16 offen lds
    s_add_u32 m0, s19, 88448
    s_nop 0
    buffer_load_dwordx4 v12, s[8:11], s16 offen lds
    s_add_u32 s16, s16, 196608
    s_cmp_eq_u32 s16, s18
    s_cselect_b32 s16, s17, s16
    s_lshl_b32 s42, s70, 1
    s_add_u32 s42, s42, 7
    s_and_b32 s42, s42, 15
    s_mul_i32 s42, s42, 393216
    s_add_u32 s44, s40, s42
    s_addc_u32 s45, s41, 0
    s_load_dword s43, s[44:45], 0
    s_load_dword s43, s[44:45], 64
    s_load_dword s43, s[44:45], 2048
    s_load_dword s43, s[44:45], 2112
    s_load_dword s43, s[44:45], 4096
    s_load_dword s43, s[44:45], 4160
    s_cmp_eq_u32 s33, 2
    s_cbranch_scc1 ar_21
ar_21_b:
    s_waitcnt vmcnt(10)
    s_barrier
    s_add_u32 m0, s19, 98816
    s_nop 0
    buffer_load_dwordx4 v10, s[8:11], s16 offen lds
    s_add_u32 m0, s19, 99840
    s_nop 0
    buffer_load_dwordx4 v11, s[8:11], s16 offen lds
    s_add_u32 m0, s19, 100864
    s_nop 0
    buffer_load_dwordx4 v12, s[8:11], s16 offen lds
    s_add_u32 s16, s16, 196608
    s_cmp_eq_u32 s16, s18
    s_cselect_b32 s16, s17, s16
    s_cmp_ge_u32 s69, 2
    s_cbranch_scc1 nh_22
    s_add_u32 m0, s25, 0
    s_add_u32 s64, s20, s24
    s_mov_b64 exec, s[26:27]
    buffer_load_dwordx4 v13, s[12:15], s64 offen lds
    s_mov_b64 exec, -1
nh_22:
    s_add_u32 m0, s23, 0
    s_nop 0
    buffer_load_dwordx4 v13, s[12:15], s20 offen lds
    s_add_u32 m0, s23, 1024
    s_nop 0
    buffer_load_dwordx4 v14, s[12:15], s20 offen lds
    s_add_u32 m0, s23, 2048
    s_nop 0
    buffer_load_dwordx4 v15, s[12:15], s20 offen lds
    s_add_u32 m0, s23, 3072
    s_nop 0
    buffer_load_dwordx4 v16, s[12:15], s20 offen lds
    s_add_u32 s20, s20, 128
    s_cmp_eq_u32 s20, s22
    s_cselect_b32 s20, s21, s20
    s_add_u32 m0, s19, 111232
    s_nop 0
    buffer_load_dwordx4 v10, s[8:11], s16 offen lds
    s_add_u32 m0, s19, 112256
    s_nop 0
    buffer_load_dwordx4 v11, s[8:11], s16 offen lds
    s_add_u32 m0, s19, 113280
    s_nop 0
    buffer_load_dwordx4 v12, s[8:11], s16 offen lds
    s_add_u32 s16, s16, 196608
    s_cmp_eq_u32 s16, s18
    s_cselect_b32 s16, s17, s16
    s_lshl_b32 s42, s70, 1
    s_add_u32 s42, s42, 8
    s_and_b32 s42, s42, 15
    s_mul_i32 s42, s42, 393216
    s_add_u32 s44, s40, s42
    s_addc_u32 s45, s41, 0
    s_load_dword s43, s[44:45], 0
    s_load_dword s43, s[44:45], 64
    s_load_dword s43, s[44:45], 2048
    s_load_dword s43, s[44:45], 2112
    s_load_dword s43, s[44:45], 4096
    s_load_dword s43, s[44:45], 4160
    s_cmp_eq_u32 s33, 3
    s_cbranch_scc1 ar_23
ar_23_b:
    s_waitcnt vmcnt(10)
    s_barrier
    s_add_u32 m0, s19, 123648
    s_nop 0
    buffer_load_dwordx4 v10, s[8:11], s16 offen lds
    s_add_u32 m0, s19, 124672
    s_nop 0
    buffer_load_dwordx4 v11, s[8:11], s16 offen lds
    s_add_u32 m0, s19, 125696
    s_nop 0
    buffer_load_dwordx4 v12, s[8:11], s16 offen lds
    s_add_u32 s16, s16, 196608
    s_cmp_eq_u32 s16, s18
    s_cselect_b32 s16, s17, s16
    s_cmp_ge_u32 s69, 2
    s_cbranch_scc1 nh_24
    s_add_u32 m0, s25, 18432
    s_add_u32 s64, s20, s24
    s_mov_b64 exec, s[26:27]
    buffer_load_dwordx4 v13, s[12:15], s64 offen lds
    s_mov_b64 exec, -1
nh_24:
    s_add_u32 m0, s23, 18432
    s_nop 0
    buffer_load_dwordx4 v13, s[12:15], s20 offen lds
    s_add_u32 m0, s23, 19456
    s_nop 0
    buffer_load_dwordx4 v14, s[12:15], s20 offen lds
    s_add_u32 m0, s23, 20480
    s_nop 0
    buffer_load_dwordx4 v15, s[12:15], s20 offen lds
    s_add_u32 m0, s23, 21504
    s_nop 0
    buffer_load_dwordx4 v16, s[12:15], s20 offen lds
    s_add_u32 s20, s20, 128
    s_cmp_eq_u32 s20, s22
    s_cselect_b32 s20, s21, s20
    s_add_u32 m0, s19, 136064
    s_nop 0
    buffer_load_dwordx4 v10, s[8:11], s16 offen lds
    s_add_u32 m0, s19, 137088
    s_nop 0
    buffer_load_dwordx4 v11, s[8:11], s16 offen lds
    s_add_u32 m0, s19, 138112
    s_nop 0
    buffer_load_dwordx4 v12, s[8:11], s16 offen lds
    s_add_u32 s16, s16, 196608
    s_cmp_eq_u32 s16, s18
    s_cselect_b32 s16, s17, s16
    s_lshl_b32 s42, s70, 1
    s_add_u32 s42, s42, 9
    s_and_b32 s42, s42, 15
    s_mul_i32 s42, s42, 393216
    s_add_u32 s44, s40, s42
    s_addc_u32 s45, s41, 0
    s_load_dword s43, s[44:45], 0
    s_load_dword s43, s[44:45], 64
    s_load_dword s43, s[44:45], 2048
    s_load_dword s43, s[44:45], 2112
    s_load_dword s43, s[44:45], 4096
    s_load_dword s43, s[44:45], 4160
    s_waitcnt vmcnt(10)
    s_barrier
    s_add_u32 m0, s19, 73984
    s_nop 0
    buffer_load_dwordx4 v10, s[8:11], s16 offen lds
    s_add_u32 m0, s19, 75008
    s_nop 0
    buffer_load_dwordx4 v11, s[8:11], s16 offen lds
    s_add_u32 m0, s19, 76032
    s_nop 0
    buffer_load_dwordx4 v12, s[8:11], s16 offen lds
    s_add_u32 s16, s16, 196608
    s_cmp_eq_u32 s16, s18
    s_cselect_b32 s16, s17, s16
    s_cmp_ge_u32 s69, 2
    s_cbranch_scc1 nh_25
    s_add_u32 m0, s25, 36864
    s_add_u32 s64, s20, s24
    s_mov_b64 exec, s[26:27]
    buffer_load_dwordx4 v13, s[12:15], s64 offen lds
    s_mov_b64 exec, -1
nh_25:
    s_add_u32 m0, s23, 36864
    s_nop 0
    buffer_load_dwordx4 v13, s[12:15], s20 offen lds
    s_add_u32 m0, s23, 37888
    s_nop 0
    buffer_load_dwordx4 v14, s[12:15], s20 offen lds
    s_add_u32 m0, s23, 38912
    s_nop 0
    buffer_load_dwordx4 v15, s[12:15], s20 offen lds
    s_add_u32 m0, s23, 39936
    s_nop 0
    buffer_load_dwordx4 v16, s[12:15], s20 offen lds
    s_add_u32 s20, s20, 128
    s_cmp_eq_u32 s20, s22
    s_cselect_b32 s20, s21, s20
    s_add_u32 m0, s19, 86400
    s_nop 0
    buffer_load_dwordx4 v10, s[8:11], s16 offen lds
    s_add_u32 m0, s19, 87424
    s_nop 0
    buffer_load_dwordx4 v11, s[8:11], s16 offen lds
    s_add_u32 m0, s19, 88448
    s_nop 0
    buffer_load_dwordx4 v12, s[8:11], s16 offen lds
    s_add_u32 s16, s16, 196608
    s_cmp_eq_u32 s16, s18
    s_cselect_b32 s16, s17, s16
    s_lshl_b32 s42, s70, 1
    s_add_u32 s42, s42, 10
    s_and_b32 s42, s42, 15
    s_mul_i32 s42, s42, 393216
    s_add_u32 s44, s40, s42
    s_addc_u32 s45, s41, 0
    s_load_dword s43, s[44:45], 0
    s_load_dword s43, s[44:45], 64
    s_load_dword s43, s[44:45], 2048
    s_load_dword s43, s[44:45], 2112
    s_load_dword s43, s[44:45], 4096
    s_load_dword s43, s[44:45], 4160
    s_waitcnt vmcnt(10)
    s_barrier
    s_add_u32 m0, s19, 98816
    s_nop 0
    buffer_load_dwordx4 v10, s[8:11], s16 offen lds
    s_add_u32 m0, s19, 99840
    s_nop 0
    buffer_load_dwordx4 v11, s[8:11], s16 offen lds
    s_add_u32 m0, s19, 100864
    s_nop 0
    buffer_load_dwordx4 v12, s[8:11], s16 offen lds
    s_add_u32 s16, s16, 196608
    s_cmp_eq_u32 s16, s18
    s_cselect_b32 s16, s17, s16
    s_cmp_ge_u32 s69, 2
    s_cbranch_scc1 nh_26
    s_add_u32 m0, s25, 55296
    s_add_u32 s64, s20, s24
    s_mov_b64 exec, s[26:27]
    buffer_load_dwordx4 v13, s[12:15], s64 offen lds
    s_mov_b64 exec, -1
nh_26:
    s_add_u32 m0, s23, 55296
    s_nop 0
    buffer_load_dwordx4 v13, s[12:15], s20 offen lds
    s_add_u32 m0, s23, 56320
    s_nop 0
    buffer_load_dwordx4 v14, s[12:15], s20 offen lds
    s_add_u32 m0, s23, 57344
    s_nop 0
    buffer_load_dwordx4 v15, s[12:15], s20 offen lds
    s_add_u32 m0, s23, 58368
    s_nop 0
    buffer_load_dwordx4 v16, s[12:15], s20 offen lds
    s_add_u32 s20, s20, 128
    s_cmp_eq_u32 s20, s22
    s_cselect_b32 s20, s21, s20
    s_add_u32 m0, s19, 111232
    s_nop 0
    buffer_load_dwordx4 v10, s[8:11], s16 offen lds
    s_add_u32 m0, s19, 112256
    s_nop 0
    buffer_load_dwordx4 v11, s[8:11], s16 offen lds
    s_add_u32 m0, s19, 113280
    s_nop 0
    buffer_load_dwordx4 v12, s[8:11], s16 offen lds
    s_add_u32 s16, s16, 196608
    s_cmp_eq_u32 s16, s18
    s_cselect_b32 s16, s17, s16
    s_lshl_b32 s42, s70, 1
    s_add_u32 s42, s42, 11
    s_and_b32 s42, s42, 15
    s_mul_i32 s42, s42, 393216
    s_add_u32 s44, s40, s42
    s_addc_u32 s45, s41, 0
    s_load_dword s43, s[44:45], 0
    s_load_dword s43, s[44:45], 64
    s_load_dword s43, s[44:45], 2048
    s_load_dword s43, s[44:45], 2112
    s_load_dword s43, s[44:45], 4096
    s_load_dword s43, s[44:45], 4160
    s_waitcnt vmcnt(10)
    s_barrier
    s_add_u32 m0, s19, 123648
    s_nop 0
    buffer_load_dwordx4 v10, s[8:11], s16 offen lds
    s_add_u32 m0, s19, 124672
    s_nop 0
    buffer_load_dwordx4 v11, s[8:11], s16 offen lds
    s_add_u32 m0, s19, 125696
    s_nop 0
    buffer_load_dwordx4 v12, s[8:11], s16 offen lds
    s_add_u32 s16, s16, 196608
    s_cmp_eq_u32 s16, s18
    s_cselect_b32 s16, s17, s16
    s_cmp_ge_u32 s69, 2
    s_cbranch_scc1 nh_27
    s_add_u32 m0, s25, 0
    s_add_u32 s64, s20, s24
    s_mov_b64 exec, s[26:27]
    buffer_load_dwordx4 v13, s[12:15], s64 offen lds
    s_mov_b64 exec, -1
nh_27:
    s_add_u32 m0, s23, 0
    s_nop 0
    buffer_load_dwordx4 v13, s[12:15], s20 offen lds
    s_add_u32 m0, s23, 1024
    s_nop 0
    buffer_load_dwordx4 v14, s[12:15], s20 offen lds
    s_add_u32 m0, s23, 2048
    s_nop 0
    buffer_load_dwordx4 v15, s[12:15], s20 offen lds
    s_add_u32 m0, s23, 3072
    s_nop 0
    buffer_load_dwordx4 v16, s[12:15], s20 offen lds
    s_add_u32 s20, s20, 128
    s_cmp_eq_u32 s20, s22
    s_cselect_b32 s20, s21, s20
    s_add_u32 m0, s19, 136064
    s_nop 0
    buffer_load_dwordx4 v10, s[8:11], s16 offen lds
    s_add_u32 m0, s19, 137088
    s_nop 0
    buffer_load_dwordx4 v11, s[8:11], s16 offen lds
    s_add_u32 m0, s19, 138112
    s_nop 0
    buffer_load_dwordx4 v12, s[8:11], s16 offen lds
    s_add_u32 s16, s16, 196608
    s_cmp_eq_u32 s16, s18
    s_cselect_b32 s16, s17, s16
    s_lshl_b32 s42, s70, 1
    s_add_u32 s42, s42, 12
    s_and_b32 s42, s42, 15
    s_mul_i32 s42, s42, 393216
    s_add_u32 s44, s40, s42
    s_addc_u32 s45, s41, 0
    s_load_dword s43, s[44:45], 0
    s_load_dword s43, s[44:45], 64
    s_load_dword s43, s[44:45], 2048
    s_load_dword s43, s[44:45], 2112
    s_load_dword s43, s[44:45], 4096
    s_load_dword s43, s[44:45], 4160
    s_waitcnt vmcnt(10)
    s_barrier
    s_add_u32 m0, s19, 73984
    s_nop 0
    buffer_load_dwordx4 v10, s[8:11], s16 offen lds
    s_add_u32 m0, s19, 75008
    s_nop 0
    buffer_load_dwordx4 v11, s[8:11], s16 offen lds
    s_add_u32 m0, s19, 76032
    s_nop 0
    buffer_load_dwordx4 v12, s[8:11], s16 offen lds
    s_add_u32 s16, s16, 196608
    s_cmp_eq_u32 s16, s18
    s_cselect_b32 s16, s17, s16
    s_cmp_ge_u32 s69, 2
    s_cbranch_scc1 nh_28
    s_add_u32 m0, s25, 18432
    s_add_u32 s64, s20, s24
    s_mov_b64 exec, s[26:27]
    buffer_load_dwordx4 v13, s[12:15], s64 offen lds
    s_mov_b64 exec, -1
nh_28:
    s_add_u32 m0, s23, 18432
    s_nop 0
    buffer_load_dwordx4 v13, s[12:15], s20 offen lds
    s_add_u32 m0, s23, 19456
    s_nop 0
    buffer_load_dwordx4 v14, s[12:15], s20 offen lds
    s_add_u32 m0, s23, 20480
    s_nop 0
    buffer_load_dwordx4 v15, s[12:15], s20 offen lds
    s_add_u32 m0, s23, 21504
    s_nop 0
    buffer_load_dwordx4 v16, s[12:15], s20 offen lds
    s_add_u32 s20, s20, 128
    s_cmp_eq_u32 s20, s22
    s_cselect_b32 s20, s21, s20
    s_add_u32 m0, s19, 86400
    s_nop 0
    buffer_load_dwordx4 v10, s[8:11], s16 offen lds
    s_add_u32 m0, s19, 87424
    s_nop 0
    buffer_load_dwordx4 v11, s[8:11], s16 offen lds
    s_add_u32 m0, s19, 88448
    s_nop 0
    buffer_load_dwordx4 v12, s[8:11], s16 offen lds
    s_add_u32 s16, s16, 196608
    s_cmp_eq_u32 s16, s18
    s_cselect_b32 s16, s17, s16
    s_lshl_b32 s42, s70, 1
    s_add_u32 s42, s42, 13
    s_and_b32 s42, s42, 15
    s_mul_i32 s42, s42, 393216
    s_add_u32 s44, s40, s42
    s_addc_u32 s45, s41, 0
    s_load_dword s43, s[44:45], 0
    s_load_dword s43, s[44:45], 64
    s_load_dword s43, s[44:45], 2048
    s_load_dword s43, s[44:45], 2112
    s_load_dword s43, s[44:45], 4096
    s_load_dword s43, s[44:45], 4160
    s_waitcnt vmcnt(10)
    s_barrier
    s_add_u32 m0, s19, 98816
    s_nop 0
    buffer_load_dwordx4 v10, s[8:11], s16 offen lds
    s_add_u32 m0, s19, 99840
    s_nop 0
    buffer_load_dwordx4 v11, s[8:11], s16 offen lds
    s_add_u32 m0, s19, 100864
    s_nop 0
    buffer_load_dwordx4 v12, s[8:11], s16 offen lds
    s_add_u32 s16, s16, 196608
    s_cmp_eq_u32 s16, s18
    s_cselect_b32 s16, s17, s16
    s_cmp_ge_u32 s69, 2
    s_cbranch_scc1 nh_29
    s_add_u32 m0, s25, 36864
    s_add_u32 s64, s20, s24
    s_mov_b64 exec, s[26:27]
    buffer_load_dwordx4 v13, s[12:15], s64 offen lds
    s_mov_b64 exec, -1
nh_29:
    s_add_u32 m0, s23, 36864
    s_nop 0
    buffer_load_dwordx4 v13, s[12:15], s20 offen lds
    s_add_u32 m0, s23, 37888
    s_nop 0
    buffer_load_dwordx4 v14, s[12:15], s20 offen lds
    s_add_u32 m0, s23, 38912
    s_nop 0
    buffer_load_dwordx4 v15, s[12:15], s20 offen lds
    s_add_u32 m0, s23, 39936
    s_nop 0
    buffer_load_dwordx4 v16, s[12:15], s20 offen lds
    s_add_u32 s20, s20, 128
    s_cmp_eq_u32 s20, s22
    s_cselect_b32 s20, s21, s20
    s_add_u32 m0, s19, 111232
    s_nop 0
    buffer_load_dwordx4 v10, s[8:11], s16 offen lds
    s_add_u32 m0, s19, 112256
    s_nop 0
    buffer_load_dwordx4 v11, s[8:11], s16 offen lds
    s_add_u32 m0, s19, 113280
    s_nop 0
    buffer_load_dwordx4 v12, s[8:11], s16 offen lds
    s_add_u32 s16, s16, 196608
    s_cmp_eq_u32 s16, s18
    s_cselect_b32 s16, s17, s16
    s_lshl_b32 s42, s70, 1
    s_add_u32 s42, s42, 14
    s_and_b32 s42, s42, 15
    s_mul_i32 s42, s42, 393216
    s_add_u32 s44, s40, s42
    s_addc_u32 s45, s41, 0
    s_load_dword s43, s[44:45], 0
    s_load_dword s43, s[44:45], 64
    s_load_dword s43, s[44:45], 2048
    s_load_dword s43, s[44:45], 2112
    s_load_dword s43, s[44:45], 4096
    s_load_dword s43, s[44:45], 4160
    s_waitcnt vmcnt(10)
    s_barrier
    s_add_u32 m0, s19, 123648
    s_nop 0
    buffer_load_dwordx4 v10, s[8:11], s16 offen lds
    s_add_u32 m0, s19, 124672
    s_nop 0
    buffer_load_dwordx4 v11, s[8:11], s16 offen lds
    s_add_u32 m0, s19, 125696
    s_nop 0
    buffer_load_dwordx4 v12, s[8:11], s16 offen lds
    s_add_u32 s16, s16, 196608
    s_cmp_eq_u32 s16, s18
    s_cselect_b32 s16, s17, s16
    s_cmp_ge_u32 s69, 2
    s_cbranch_scc1 nh_30
    s_add_u32 m0, s25, 55296
    s_add_u32 s64, s20, s24
    s_mov_b64 exec, s[26:27]
    buffer_load_dwordx4 v13, s[12:15], s64 offen lds
    s_mov_b64 exec, -1
nh_30:
    s_add_u32 m0, s23, 55296
    s_nop 0
    buffer_load_dwordx4 v13, s[12:15], s20 offen lds
    s_add_u32 m0, s23, 56320
    s_nop 0
    buffer_load_dwordx4 v14, s[12:15], s20 offen lds
    s_add_u32 m0, s23, 57344
    s_nop 0
    buffer_load_dwordx4 v15, s[12:15], s20 offen lds
    s_add_u32 m0, s23, 58368
    s_nop 0
    buffer_load_dwordx4 v16, s[12:15], s20 offen lds
    s_add_u32 s20, s20, 128
    s_cmp_eq_u32 s20, s22
    s_cselect_b32 s20, s21, s20
    s_add_u32 m0, s19, 136064
    s_nop 0
    buffer_load_dwordx4 v10, s[8:11], s16 offen lds
    s_add_u32 m0, s19, 137088
    s_nop 0
    buffer_load_dwordx4 v11, s[8:11], s16 offen lds
    s_add_u32 m0, s19, 138112
    s_nop 0
    buffer_load_dwordx4 v12, s[8:11], s16 offen lds
    s_add_u32 s16, s16, 196608
    s_cmp_eq_u32 s16, s18
    s_cselect_b32 s16, s17, s16
    s_lshl_b32 s42, s70, 1
    s_add_u32 s42, s42, 15
    s_and_b32 s42, s42, 15
    s_mul_i32 s42, s42, 393216
    s_add_u32 s44, s40, s42
    s_addc_u32 s45, s41, 0
    s_load_dword s43, s[44:45], 0
    s_load_dword s43, s[44:45], 64
    s_load_dword s43, s[44:45], 2048
    s_load_dword s43, s[44:45], 2112
    s_load_dword s43, s[44:45], 4096
    s_load_dword s43, s[44:45], 4160
    v_lshlrev_b32 v71, 2, v250
    buffer_load_dword v72, v71, s[28:31], 0 offen sc1
    s_waitcnt vmcnt(11)
    s_barrier
    s_add_u32 m0, s19, 73984
    s_nop 0
    buffer_load_dwordx4 v10, s[8:11], s16 offen lds
    s_add_u32 m0, s19, 75008
    s_nop 0
    buffer_load_dwordx4 v11, s[8:11], s16 offen lds
    s_add_u32 m0, s19, 76032
    s_nop 0
    buffer_load_dwordx4 v12, s[8:11], s16 offen lds
    s_add_u32 s16, s16, 196608
    s_cmp_eq_u32 s16, s18
    s_cselect_b32 s16, s17, s16
    s_cmp_ge_u32 s69, 2
    s_cbranch_scc1 nh_31
    s_add_u32 m0, s25, 0
    s_add_u32 s64, s20, s24
    s_mov_b64 exec, s[26:27]
    buffer_load_dwordx4 v13, s[12:15], s64 offen lds
    s_mov_b64 exec, -1
nh_31:
    s_add_u32 m0, s23, 0
    s_nop 0
    buffer_load_dwordx4 v13, s[12:15], s20 offen lds
    s_add_u32 m0, s23, 1024
    s_nop 0
    buffer_load_dwordx4 v14, s[12:15], s20 offen lds
    s_add_u32 m0, s23, 2048
    s_nop 0
    buffer_load_dwordx4 v15, s[12:15], s20 offen lds
    s_add_u32 m0, s23, 3072
    s_nop 0
    buffer_load_dwordx4 v16, s[12:15], s20 offen lds
    s_add_u32 s20, s20, 128
    s_cmp_eq_u32 s20, s22
    s_cselect_b32 s20, s21, s20
    s_add_u32 m0, s19, 86400
    s_nop 0
    buffer_load_dwordx4 v10, s[8:11], s16 offen lds
    s_add_u32 m0, s19, 87424
    s_nop 0
    buffer_load_dwordx4 v11, s[8:11], s16 offen lds
    s_add_u32 m0, s19, 88448
    s_nop 0
    buffer_load_dwordx4 v12, s[8:11], s16 offen lds
    s_add_u32 s16, s16, 196608
    s_cmp_eq_u32 s16, s18
    s_cselect_b32 s16, s17, s16
    s_waitcnt vmcnt(11)
    s_barrier
    s_add_u32 m0, s19, 98816
    s_nop 0
    buffer_load_dwordx4 v10, s[8:11], s16 offen lds
    s_add_u32 m0, s19, 99840
    s_nop 0
    buffer_load_dwordx4 v11, s[8:11], s16 offen lds
    s_add_u32 m0, s19, 100864
    s_nop 0
    buffer_load_dwordx4 v12, s[8:11], s16 offen lds
    s_add_u32 s16, s16, 196608
    s_cmp_eq_u32 s16, s18
    s_cselect_b32 s16, s17, s16
    s_lshl_b32 s64, s73, 4
    s_add_u32 s64, s64, s67
    s_lshl_b32 s64, s64, 2
    s_add_u32 s64, s64, s69
    s_lshl_b32 s64, s64, 12
    s_lshl_b32 s65, s60, 22
    s_add_u32 s64, s64, s65
    s_add_u32 s64, s64, 12582912
    v_lshlrev_b32 v253, 7, v250
    s_mov_b64 exec, 0xffffffff
    buffer_load_dword v9, v253, s[80:83], s64 offen sc1
    s_mov_b64 exec, -1
    s_mov_b32 s12, s88
    s_mov_b32 s13, s89
    s_mov_b32 s14, 2097152
    s_mov_b32 s15, 0x00020000
    v_lshrrev_b32 v253, 3, v250
    v_lshlrev_b32 v253, 13, v253
    v_and_b32 v254, 7, v250
    v_lshl_add_u32 v253, v254, 4, v253
    s_lshl_b32 s64, s69, 11
    v_add_u32 v244, s64, v253
    s_mul_i32 s51, s69, 1056
    s_lshl_b32 s49, s72, 7
    s_lshl_b32 s64, s67, 17
    s_add_u32 s50, s49, 2097152
    s_add_u32 s48, s49, s64
    s_waitcnt vmcnt(14)
    v_and_b32 v73, 0x80808080, v72
    v_cmp_ne_u32 vcc, 0x80808080, v73
    s_cbranch_vccnz hs_32
hs_32_b:
    s_lshl_b32 s64, s73, 11
    s_mul_i32 s65, s69, 288
    s_add_u32 s64, s64, s65
    s_add_u32 s64, s64, 74186752
    s_mov_b64 exec, 0x3ffff
    buffer_load_dwordx4 v[76:79], v249, s[80:83], s64 offen sc0 sc1
    s_mov_b64 exec, -1
    s_add_u32 s65, s65, 159744
    v_add_u32 v75, s65, v249
    s_and_b32 s64, s70, 3
    s_lshl_b32 s64, s64, 3
    v_bfe_u32 v72, v72, s64, 8
    v_cmp_ne_u32 vcc, s32, v72
    s_lshr_b32 s64, s70, 2
    s_lshl_b32 s65, 0x55555555, s64
    s_or_b32 s64, vcc_lo, vcc_hi
    s_and_b32 s64, s64, s65
    s_cselect_b32 s78, 1, 0
    s_mov_b32 s59, s78
    s_mul_i32 s60, s59, s75
    s_add_u32 m0, s51, 116224
    s_nop 0
    buffer_load_dwordx4 v244, s[12:15], s48 offen lds
    s_add_u32 s48, s48, 65536
    s_cmp_eq_u32 s48, s50
    s_cselect_b32 s48, s49, s48
    s_waitcnt vmcnt(6)
    s_barrier
    s_add_u32 m0, s51, 120448
    s_nop 0
    buffer_load_dwordx4 v244, s[12:15], s48 offen lds
    s_add_u32 s48, s48, 65536
    s_cmp_eq_u32 s48, s50
    s_cselect_b32 s48, s49, s48
    s_add_u32 m0, s51, 124672
    s_nop 0
    buffer_load_dwordx4 v244, s[12:15], s48 offen lds
    s_add_u32 s48, s48, 65536
    s_cmp_eq_u32 s48, s50
    s_cselect_b32 s48, s49, s48
    s_add_u32 m0, s51, 128896
    s_nop 0
    buffer_load_dwordx4 v244, s[12:15], s48 offen lds
    s_add_u32 s48, s48, 65536
    s_cmp_eq_u32 s48, s50
    s_cselect_b32 s48, s49, s48
    s_add_u32 m0, s51, 133120
    s_nop 0
    buffer_load_dwordx4 v244, s[12:15], s48 offen lds
    s_add_u32 s48, s48, 65536
    s_cmp_eq_u32 s48, s50
    s_cselect_b32 s48, s49, s48
    s_add_u32 m0, s51, 137344
    s_nop 0
    buffer_load_dwordx4 v244, s[12:15], s48 offen lds
    s_add_u32 s48, s48, 65536
    s_cmp_eq_u32 s48, s50
    s_cselect_b32 s48, s49, s48
    s_add_u32 m0, s51, 141568
    s_nop 0
    buffer_load_dwordx4 v244, s[12:15], s48 offen lds
    s_add_u32 s48, s48, 65536
    s_cmp_eq_u32 s48, s50
    s_cselect_b32 s48, s49, s48
    s_add_u32 m0, s51, 145792
    s_nop 0
    buffer_load_dwordx4 v244, s[12:15], s48 offen lds
    s_add_u32 s48, s48, 65536
    s_cmp_eq_u32 s48, s50
    s_cselect_b32 s48, s49, s48
    s_add_u32 m0, s51, 150016
    s_nop 0
    buffer_load_dwordx4 v244, s[12:15], s48 offen lds
    s_add_u32 s48, s48, 65536
    s_cmp_eq_u32 s48, s50
    s_cselect_b32 s48, s49, s48
    s_waitcnt vmcnt(11)
    s_barrier
    s_waitcnt vmcnt(9)
    v_mov_b32 v72, s78
    v_mov_b32 v73, 163456
    s_mov_b64 exec, 0x3ffff
    ds_write_b128 v75, v[76:79]
    ds_write_b32 v73, v72
    s_mov_b64 exec, -1
    s_add_u32 m0, s51, 154240
    s_nop 0
    buffer_load_dwordx4 v244, s[12:15], s48 offen lds
    s_add_u32 s48, s48, 65536
    s_cmp_eq_u32 s48, s50
    s_cselect_b32 s48, s49, s48
    s_add_u32 m0, s51, 65536
    s_nop 0
    buffer_load_dwordx4 v244, s[12:15], s48 offen lds
    s_add_u32 s48, s48, 65536
    s_cmp_eq_u32 s48, s50
    s_cselect_b32 s48, s49, s48
    s_add_u32 m0, s51, 69760
    s_nop 0
    buffer_load_dwordx4 v244, s[12:15], s48 offen lds
    s_add_u32 s48, s48, 65536
    s_cmp_eq_u32 s48, s50
    s_cselect_b32 s48, s49, s48
    s_add_u32 m0, s51, 73984
    s_nop 0
    buffer_load_dwordx4 v244, s[12:15], s48 offen lds
    s_add_u32 s48, s48, 65536
    s_cmp_eq_u32 s48, s50
    s_cselect_b32 s48, s49, s48
    s_add_u32 m0, s51, 78208
    s_nop 0
    buffer_load_dwordx4 v244, s[12:15], s48 offen lds
    s_add_u32 s48, s48, 65536
    s_cmp_eq_u32 s48, s50
    s_cselect_b32 s48, s49, s48
    s_add_u32 m0, s51, 82432
    s_nop 0
    buffer_load_dwordx4 v244, s[12:15], s48 offen lds
    s_add_u32 s48, s48, 65536
    s_cmp_eq_u32 s48, s50
    s_cselect_b32 s48, s49, s48
    s_add_u32 m0, s51, 86656
    s_nop 0
    buffer_load_dwordx4 v244, s[12:15], s48 offen lds
    s_add_u32 s48, s48, 65536
    s_cmp_eq_u32 s48, s50
    s_cselect_b32 s48, s49, s48
    s_add_u32 m0, s51, 90880
    s_nop 0
    buffer_load_dwordx4 v244, s[12:15], s48 offen lds
    s_add_u32 s48, s48, 65536
    s_cmp_eq_u32 s48, s50
    s_cselect_b32 s48, s49, s48
    s_waitcnt lgkmcnt(0)
    s_barrier
    s_add_u32 m0, s51, 95104
    s_nop 0
    buffer_load_dwordx4 v244, s[12:15], s48 offen lds
    s_add_u32 s48, s48, 65536
    s_cmp_eq_u32 s48, s50
    s_cselect_b32 s48, s49, s48
    s_add_u32 m0, s51, 99328
    s_nop 0
    buffer_load_dwordx4 v244, s[12:15], s48 offen lds
    s_add_u32 s48, s48, 65536
    s_cmp_eq_u32 s48, s50
    s_cselect_b32 s48, s49, s48
    s_add_u32 m0, s51, 103552
    s_nop 0
    buffer_load_dwordx4 v244, s[12:15], s48 offen lds
    s_add_u32 s48, s48, 65536
    s_cmp_eq_u32 s48, s50
    s_cselect_b32 s48, s49, s48
    s_add_u32 m0, s51, 107776
    s_nop 0
    buffer_load_dwordx4 v244, s[12:15], s48 offen lds
    s_add_u32 s48, s48, 65536
    s_cmp_eq_u32 s48, s50
    s_cselect_b32 s48, s49, s48
    s_add_u32 m0, s51, 112000
    s_nop 0
    buffer_load_dwordx4 v244, s[12:15], s48 offen lds
    s_add_u32 s48, s48, 65536
    s_cmp_eq_u32 s48, s50
    s_cselect_b32 s48, s49, s48
L_g2:
    s_and_b32 s64, s3, 1
    s_cmp_eq_u32 s64, 0
    s_cselect_b32 s8, s92, s94
    s_cselect_b32 s9, s93, s95
    s_mov_b32 s10, 7340032
    s_mov_b32 s11, 0x00020000
    s_mul_i32 s19, s64, 14400
    s_lshr_b32 s64, s69, 1
    s_mul_i32 s65, s64, 7200
    s_add_u32 s19, s19, s65
    s_add_u32 s19, s19, 36736
    s_mul_i32 s17, s64, 28672
    s_mul_i32 s65, s74, 448
    s_add_u32 s17, s17, s65
    s_add_u32 s18, s17, 7340032
    s_lshl_b32 s64, s57, 1
    s_mul_i32 s65, s64, 229376
    s_add_u32 s16, s17, s65
    s_mov_b32 s66, 2341
    v_add_u32 v253, 0, v250
    v_mul_lo_u32 v254, v253, s66
    v_lshrrev_b32 v254, 16, v254
    v_mul_u32_u24 v228, 28, v254
    v_sub_u32 v253, v253, v228
    v_and_b32 v228, 12, v254
    v_add_u32 v254, v254, v228
    v_mul_u32_u24 v254, 7168, v254
    v_lshl_add_u32 v228, v253, 4, v254
    v_add_u32 v253, 64, v250
    v_mul_lo_u32 v254, v253, s66
    v_lshrrev_b32 v254, 16, v254
    v_mul_u32_u24 v229, 28, v254
    v_sub_u32 v253, v253, v229
    v_and_b32 v229, 12, v254
    v_add_u32 v254, v254, v229
    v_mul_u32_u24 v254, 7168, v254
    v_lshl_add_u32 v229, v253, 4, v254
    v_add_u32 v253, 128, v250
    v_mul_lo_u32 v254, v253, s66
    v_lshrrev_b32 v254, 16, v254
    v_mul_u32_u24 v230, 28, v254
    v_sub_u32 v253, v253, v230
    v_and_b32 v230, 12, v254
    v_add_u32 v254, v254, v230
    v_mul_u32_u24 v254, 7168, v254
    v_lshl_add_u32 v230, v253, 4, v254
    v_add_u32 v253, 192, v250
    v_mul_lo_u32 v254, v253, s66
    v_lshrrev_b32 v254, 16, v254
    v_mul_u32_u24 v231, 28, v254
    v_sub_u32 v253, v253, v231
    v_and_b32 v231, 12, v254
    v_add_u32 v254, v254, v231
    v_mul_u32_u24 v254, 7168, v254
    v_lshl_add_u32 v231, v253, 4, v254
    v_add_u32 v253, 256, v250
    v_mul_lo_u32 v254, v253, s66
    v_lshrrev_b32 v254, 16, v254
    v_mul_u32_u24 v232, 28, v254
    v_sub_u32 v253, v253, v232
    v_and_b32 v232, 12, v254
    v_add_u32 v254, v254, v232
    v_mul_u32_u24 v254, 7168, v254
    v_lshl_add_u32 v232, v253, 4, v254
    v_add_u32 v253, 320, v250
    v_mul_lo_u32 v254, v253, s66
    v_lshrrev_b32 v254, 16, v254
    v_mul_u32_u24 v233, 28, v254
    v_sub_u32 v253, v253, v233
    v_and_b32 v233, 12, v254
    v_add_u32 v254, v254, v233
    v_mul_u32_u24 v254, 7168, v254
    v_lshl_add_u32 v233, v253, 4, v254
    v_add_u32 v253, 384, v250
    v_mul_lo_u32 v254, v253, s66
    v_lshrrev_b32 v254, 16, v254
    v_mul_u32_u24 v234, 28, v254
    v_sub_u32 v253, v253, v234
    v_and_b32 v234, 12, v254
    v_add_u32 v254, v254, v234
    v_mul_u32_u24 v254, 7168, v254
    v_lshl_add_u32 v234, v253, 4, v254
    s_lshl_b32 s53, s60, 22
    s_lshl_b32 s64, s73, 18
    s_add_u32 s53, s53, s64
    s_add_u32 s53, s53, 12582912
    s_lshl_b32 s65, s67, 14
    s_lshl_b32 s55, s69, 11
    s_add_u32 s53, s53, s55
    s_add_u32 s54, s53, 262144
    s_add_u32 s52, s53, s65
    s_lshl_b32 s56, s75, 15
    s_lshl_b32 s66, s73, 9
    s_add_u32 s56, s56, s66
    s_add_u32 s56, s56, 75497472
    v_lshlrev_b32 v246, 5, v250
    s_mov_b64 exec, 0xffff
pl_33:
    buffer_load_dwordx4 v[240:243], v246, s[80:83], s56 offen sc1
    s_sub_u32 s79, s79, 1
    s_cbranch_scc1 L_abort
    s_waitcnt vmcnt(0)
    v_and_b32 v240, v240, v241
    v_and_b32 v242, v242, v243
    v_and_b32 v240, v240, v242
    v_cmp_ne_u32 vcc, 1, v240
    s_cbranch_vccnz pl_33
    s_mov_b64 exec, -1
    s_cmp_lg_u32 s78, 0
    s_cbranch_scc1 pl_33_acq
pl_33_ok:
    s_add_u32 m0, s55, 0
    s_nop 0
    buffer_load_dwordx4 v249, s[80:83], s52 offen offset:0 sc1 lds
    buffer_load_dwordx4 v249, s[80:83], s52 offen offset:1024 sc1 lds
    s_add_u32 s52, s52, 8192
    s_cmp_eq_u32 s52, s54
    s_cselect_b32 s52, s53, s52
    s_add_u32 m0, s55, 8192
    s_nop 0
    buffer_load_dwordx4 v249, s[80:83], s52 offen offset:0 sc1 lds
    buffer_load_dwordx4 v249, s[80:83], s52 offen offset:1024 sc1 lds
    s_add_u32 s52, s52, 8192
    s_cmp_eq_u32 s52, s54
    s_cselect_b32 s52, s53, s52
    s_add_u32 m0, s55, 16384
    s_nop 0
    buffer_load_dwordx4 v249, s[80:83], s52 offen offset:0 sc1 lds
    buffer_load_dwordx4 v249, s[80:83], s52 offen offset:1024 sc1 lds
    s_add_u32 s52, s52, 8192
    s_cmp_eq_u32 s52, s54
    s_cselect_b32 s52, s53, s52
    s_add_u32 m0, s55, 24576
    s_nop 0
    buffer_load_dwordx4 v249, s[80:83], s52 offen offset:0 sc1 lds
    buffer_load_dwordx4 v249, s[80:83], s52 offen offset:1024 sc1 lds
    s_add_u32 s52, s52, 8192
    s_cmp_eq_u32 s52, s54
    s_cselect_b32 s52, s53, s52
    s_waitcnt vmcnt(4) lgkmcnt(0)
    s_barrier
    s_add_u32 m0, s55, 32768
    s_nop 0
    buffer_load_dwordx4 v249, s[80:83], s52 offen offset:0 sc1 lds
    buffer_load_dwordx4 v249, s[80:83], s52 offen offset:1024 sc1 lds
    s_add_u32 s52, s52, 8192
    s_cmp_eq_u32 s52, s54
    s_cselect_b32 s52, s53, s52
    s_add_u32 m0, s55, 40960
    s_nop 0
    buffer_load_dwordx4 v249, s[80:83], s52 offen offset:0 sc1 lds
    buffer_load_dwordx4 v249, s[80:83], s52 offen offset:1024 sc1 lds
    s_add_u32 s52, s52, 8192
    s_cmp_eq_u32 s52, s54
    s_cselect_b32 s52, s53, s52
    s_add_u32 m0, s55, 49152
    s_nop 0
    buffer_load_dwordx4 v249, s[80:83], s52 offen offset:0 sc1 lds
    buffer_load_dwordx4 v249, s[80:83], s52 offen offset:1024 sc1 lds
    s_add_u32 s52, s52, 8192
    s_cmp_eq_u32 s52, s54
    s_cselect_b32 s52, s53, s52
    s_waitcnt vmcnt(6)
    s_barrier
    s_add_u32 m0, s55, 57344
    s_nop 0
    buffer_load_dwordx4 v249, s[80:83], s52 offen offset:0 sc1 lds
    buffer_load_dwordx4 v249, s[80:83], s52 offen offset:1024 sc1 lds
    s_add_u32 s52, s52, 8192
    s_cmp_eq_u32 s52, s54
    s_cselect_b32 s52, s53, s52
    s_add_u32 m0, s55, 0
    s_nop 0
    buffer_load_dwordx4 v249, s[80:83], s52 offen offset:0 sc1 lds
    buffer_load_dwordx4 v249, s[80:83], s52 offen offset:1024 sc1 lds
    s_add_u32 s52, s52, 8192
    s_cmp_eq_u32 s52, s54
    s_cselect_b32 s52, s53, s52
    s_add_u32 m0, s55, 8192
    s_nop 0
    buffer_load_dwordx4 v249, s[80:83], s52 offen offset:0 sc1 lds
    buffer_load_dwordx4 v249, s[80:83], s52 offen offset:1024 sc1 lds
    s_add_u32 s52, s52, 8192
    s_cmp_eq_u32 s52, s54
    s_cselect_b32 s52, s53, s52
    s_waitcnt vmcnt(8)
    s_barrier
    s_add_u32 m0, s55, 16384
    s_nop 0
    buffer_load_dwordx4 v249, s[80:83], s52 offen offset:0 sc1 lds
    buffer_load_dwordx4 v249, s[80:83], s52 offen offset:1024 sc1 lds
    s_add_u32 s52, s52, 8192
    s_cmp_eq_u32 s52, s54
    s_cselect_b32 s52, s53, s52
    s_add_u32 m0, s55, 24576
    s_nop 0
    buffer_load_dwordx4 v249, s[80:83], s52 offen offset:0 sc1 lds
    buffer_load_dwordx4 v249, s[80:83], s52 offen offset:1024 sc1 lds
    s_add_u32 s52, s52, 8192
    s_cmp_eq_u32 s52, s54
    s_cselect_b32 s52, s53, s52
    s_waitcnt vmcnt(8)
    s_barrier
    s_add_u32 m0, s55, 32768
    s_nop 0
    buffer_load_dwordx4 v249, s[80:83], s52 offen offset:0 sc1 lds
    buffer_load_dwordx4 v249, s[80:83], s52 offen offset:1024 sc1 lds
    s_add_u32 s52, s52, 8192
    s_cmp_eq_u32 s52, s54
    s_cselect_b32 s52, s53, s52
    s_add_u32 m0, s55, 40960
    s_nop 0
    buffer_load_dwordx4 v249, s[80:83], s52 offen offset:0 sc1 lds
    buffer_load_dwordx4 v249, s[80:83], s52 offen offset:1024 sc1 lds
    s_add_u32 s52, s52, 8192
    s_cmp_eq_u32 s52, s54
    s_cselect_b32 s52, s53, s52
    s_add_u32 m0, s51, 116224
    s_nop 0
    buffer_load_dwordx4 v244, s[12:15], s48 offen lds
    s_add_u32 s48, s48, 65536
    s_cmp_eq_u32 s48, s50
    s_cselect_b32 s48, s49, s48
    s_waitcnt vmcnt(9)
    s_barrier
    s_add_u32 m0, s55, 49152
    s_nop 0
    buffer_load_dwordx4 v249, s[80:83], s52 offen offset:0 sc1 lds
    buffer_load_dwordx4 v249, s[80:83], s52 offen offset:1024 sc1 lds
    s_add_u32 s52, s52, 8192
    s_cmp_eq_u32 s52, s54
    s_cselect_b32 s52, s53, s52
    s_add_u32 m0, s55, 57344
    s_nop 0
    buffer_load_dwordx4 v249, s[80:83], s52 offen offset:0 sc1 lds
    buffer_load_dwordx4 v249, s[80:83], s52 offen offset:1024 sc1 lds
    s_add_u32 s52, s52, 8192
    s_cmp_eq_u32 s52, s54
    s_cselect_b32 s52, s53, s52
    s_add_u32 m0, s51, 120448
    s_nop 0
    buffer_load_dwordx4 v244, s[12:15], s48 offen lds
    s_add_u32 s48, s48, 65536
    s_cmp_eq_u32 s48, s50
    s_cselect_b32 s48, s49, s48
    s_waitcnt vmcnt(10)
    s_barrier
    s_add_u32 m0, s55, 0
    s_nop 0
    buffer_load_dwordx4 v249, s[80:83], s52 offen offset:0 sc1 lds
    buffer_load_dwordx4 v249, s[80:83], s52 offen offset:1024 sc1 lds
    s_add_u32 s52, s52, 8192
    s_cmp_eq_u32 s52, s54
    s_cselect_b32 s52, s53, s52
    s_add_u32 m0, s55, 8192
    s_nop 0
    buffer_load_dwordx4 v249, s[80:83], s52 offen offset:0 sc1 lds
    buffer_load_dwordx4 v249, s[80:83], s52 offen offset:1024 sc1 lds
    s_add_u32 s52, s52, 8192
    s_cmp_eq_u32 s52, s54
    s_cselect_b32 s52, s53, s52
    s_add_u32 m0, s51, 124672
    s_nop 0
    buffer_load_dwordx4 v244, s[12:15], s48 offen lds
    s_add_u32 s48, s48, 65536
    s_cmp_eq_u32 s48, s50
    s_cselect_b32 s48, s49, s48
    s_waitcnt vmcnt(11)
    s_barrier
    s_add_u32 m0, s55, 16384
    s_nop 0
    buffer_load_dwordx4 v249, s[80:83], s52 offen offset:0 sc1 lds
    buffer_load_dwordx4 v249, s[80:83], s52 offen offset:1024 sc1 lds
    s_add_u32 s52, s52, 8192
    s_cmp_eq_u32 s52, s54
    s_cselect_b32 s52, s53, s52
    s_add_u32 m0, s55, 24576
    s_nop 0
    buffer_load_dwordx4 v249, s[80:83], s52 offen offset:0 sc1 lds
    buffer_load_dwordx4 v249, s[80:83], s52 offen offset:1024 sc1 lds
    s_add_u32 s52, s52, 8192
    s_cmp_eq_u32 s52, s54
    s_cselect_b32 s52, s53, s52
    s_add_u32 m0, s51, 128896
    s_nop 0
    buffer_load_dwordx4 v244, s[12:15], s48 offen lds
    s_add_u32 s48, s48, 65536
    s_cmp_eq_u32 s48, s50
    s_cselect_b32 s48, s49, s48
    s_waitcnt vmcnt(11)
    s_barrier
    s_add_u32 m0, s55, 32768
    s_nop 0
    buffer_load_dwordx4 v249, s[80:83], s52 offen offset:0 sc1 lds
    buffer_load_dwordx4 v249, s[80:83], s52 offen offset:1024 sc1 lds
    s_add_u32 s52, s52, 8192
    s_cmp_eq_u32 s52, s54
    s_cselect_b32 s52, s53, s52
    s_add_u32 m0, s55, 40960
    s_nop 0
    buffer_load_dwordx4 v249, s[80:83], s52 offen offset:0 sc1 lds
    buffer_load_dwordx4 v249, s[80:83], s52 offen offset:1024 sc1 lds
    s_add_u32 s52, s52, 8192
    s_cmp_eq_u32 s52, s54
    s_cselect_b32 s52, s53, s52
    s_add_u32 m0, s51, 133120
    s_nop 0
    buffer_load_dwordx4 v244, s[12:15], s48 offen lds
    s_add_u32 s48, s48, 65536
    s_cmp_eq_u32 s48, s50
    s_cselect_b32 s48, s49, s48
    s_waitcnt vmcnt(11)
    s_barrier
    s_add_u32 m0, s55, 49152
    s_nop 0
    buffer_load_dwordx4 v249, s[80:83], s52 offen offset:0 sc1 lds
    buffer_load_dwordx4 v249, s[80:83], s52 offen offset:1024 sc1 lds
    s_add_u32 s52, s52, 8192
    s_cmp_eq_u32 s52, s54
    s_cselect_b32 s52, s53, s52
    s_add_u32 m0, s55, 57344
    s_nop 0
    buffer_load_dwordx4 v249, s[80:83], s52 offen offset:0 sc1 lds
    buffer_load_dwordx4 v249, s[80:83], s52 offen offset:1024 sc1 lds
    s_add_u32 s52, s52, 8192
    s_cmp_eq_u32 s52, s54
    s_cselect_b32 s52, s53, s52
    s_add_u32 m0, s51, 137344
    s_nop 0
    buffer_load_dwordx4 v244, s[12:15], s48 offen lds
    s_add_u32 s48, s48, 65536
    s_cmp_eq_u32 s48, s50
    s_cselect_b32 s48, s49, s48
    s_waitcnt vmcnt(11)
    s_barrier
    s_add_u32 m0, s55, 0
    s_nop 0
    buffer_load_dwordx4 v249, s[80:83], s52 offen offset:0 sc1 lds
    buffer_load_dwordx4 v249, s[80:83], s52 offen offset:1024 sc1 lds
    s_add_u32 s52, s52, 8192
    s_cmp_eq_u32 s52, s54
    s_cselect_b32 s52, s53, s52
    s_add_u32 m0, s55, 8192
    s_nop 0
    buffer_load_dwordx4 v249, s[80:83], s52 offen offset:0 sc1 lds
    buffer_load_dwordx4 v249, s[80:83], s52 offen offset:1024 sc1 lds
    s_add_u32 s52, s52, 8192
    s_cmp_eq_u32 s52, s54
    s_cselect_b32 s52, s53, s52
    s_add_u32 m0, s51, 141568
    s_nop 0
    buffer_load_dwordx4 v244, s[12:15], s48 offen lds
    s_add_u32 s48, s48, 65536
    s_cmp_eq_u32 s48, s50
    s_cselect_b32 s48, s49, s48
    s_waitcnt vmcnt(11)
    s_barrier
    s_add_u32 m0, s55, 16384
    s_nop 0
    buffer_load_dwordx4 v249, s[80:83], s52 offen offset:0 sc1 lds
    buffer_load_dwordx4 v249, s[80:83], s52 offen offset:1024 sc1 lds
    s_add_u32 s52, s52, 8192
    s_cmp_eq_u32 s52, s54
    s_cselect_b32 s52, s53, s52
    s_add_u32 m0, s55, 24576
    s_nop 0
    buffer_load_dwordx4 v249, s[80:83], s52 offen offset:0 sc1 lds
    buffer_load_dwordx4 v249, s[80:83], s52 offen offset:1024 sc1 lds
    s_add_u32 s52, s52, 8192
    s_cmp_eq_u32 s52, s54
    s_cselect_b32 s52, s53, s52
    s_add_u32 m0, s51, 145792
    s_nop 0
    buffer_load_dwordx4 v244, s[12:15], s48 offen lds
    s_add_u32 s48, s48, 65536
    s_cmp_eq_u32 s48, s50
    s_cselect_b32 s48, s49, s48
    s_waitcnt vmcnt(11)
    s_barrier
    s_add_u32 m0, s55, 32768
    s_nop 0
    buffer_load_dwordx4 v249, s[80:83], s52 offen offset:0 sc1 lds
    buffer_load_dwordx4 v249, s[80:83], s52 offen offset:1024 sc1 lds
    s_add_u32 s52, s52, 8192
    s_cmp_eq_u32 s52, s54
    s_cselect_b32 s52, s53, s52
    s_add_u32 m0, s55, 40960
    s_nop 0
    buffer_load_dwordx4 v249, s[80:83], s52 offen offset:0 sc1 lds
    buffer_load_dwordx4 v249, s[80:83], s52 offen offset:1024 sc1 lds
    s_add_u32 s52, s52, 8192
    s_cmp_eq_u32 s52, s54
    s_cselect_b32 s52, s53, s52
    s_add_u32 m0, s51, 150016
    s_nop 0
    buffer_load_dwordx4 v244, s[12:15], s48 offen lds
    s_add_u32 s48, s48, 65536
    s_cmp_eq_u32 s48, s50
    s_cselect_b32 s48, s49, s48
    s_waitcnt vmcnt(11)
    s_barrier
    s_add_u32 m0, s55, 49152
    s_nop 0
    buffer_load_dwordx4 v249, s[80:83], s52 offen offset:0 sc1 lds
    buffer_load_dwordx4 v249, s[80:83], s52 offen offset:1024 sc1 lds
    s_add_u32 s52, s52, 8192
    s_cmp_eq_u32 s52, s54
    s_cselect_b32 s52, s53, s52
    s_add_u32 m0, s55, 57344
    s_nop 0
    buffer_load_dwordx4 v249, s[80:83], s52 offen offset:0 sc1 lds
    buffer_load_dwordx4 v249, s[80:83], s52 offen offset:1024 sc1 lds
    s_add_u32 s52, s52, 8192
    s_cmp_eq_u32 s52, s54
    s_cselect_b32 s52, s53, s52
    s_add_u32 m0, s51, 154240
    s_nop 0
    buffer_load_dwordx4 v244, s[12:15], s48 offen lds
    s_add_u32 s48, s48, 65536
    s_cmp_eq_u32 s48, s50
    s_cselect_b32 s48, s49, s48
    s_waitcnt vmcnt(11)
    s_barrier
    s_add_u32 m0, s19, 28800
    s_nop 0
    buffer_load_dwordx4 v228, s[8:11], s16 offen lds
    s_add_u32 m0, s19, 29824
    s_nop 0
    buffer_load_dwordx4 v229, s[8:11], s16 offen lds
    s_add_u32 m0, s19, 30848
    s_nop 0
    buffer_load_dwordx4 v230, s[8:11], s16 offen lds
    s_waitcnt vmcnt(3)
    s_barrier
    s_add_u32 m0, s19, 31872
    s_nop 0
    buffer_load_dwordx4 v231, s[8:11], s16 offen lds
    s_add_u32 m0, s19, 32896
    s_nop 0
    buffer_load_dwordx4 v232, s[8:11], s16 offen lds
    s_add_u32 m0, s19, 33920
    s_nop 0
    buffer_load_dwordx4 v233, s[8:11], s16 offen lds
    s_add_u32 m0, s19, 34944
    s_nop 0
    buffer_load_dwordx4 v234, s[8:11], s16 offen lds
    s_add_u32 s16, s16, 229376
    s_cmp_eq_u32 s16, s18
    s_cselect_b32 s16, s17, s16
    s_add_u32 m0, s19, 57600
    s_nop 0
    buffer_load_dwordx4 v228, s[8:11], s16 offen lds
    s_add_u32 m0, s19, 58624
    s_nop 0
    buffer_load_dwordx4 v229, s[8:11], s16 offen lds
    s_add_u32 m0, s19, 59648
    s_nop 0
    buffer_load_dwordx4 v230, s[8:11], s16 offen lds
    s_add_u32 m0, s19, 60672
    s_nop 0
    buffer_load_dwordx4 v231, s[8:11], s16 offen lds
    s_add_u32 m0, s19, 61696
    s_nop 0
    buffer_load_dwordx4 v232, s[8:11], s16 offen lds
    s_add_u32 m0, s19, 62720
    s_nop 0
    buffer_load_dwordx4 v233, s[8:11], s16 offen lds
    s_add_u32 m0, s19, 63744
    s_nop 0
    buffer_load_dwordx4 v234, s[8:11], s16 offen lds
    s_add_u32 s16, s16, 229376
    s_cmp_eq_u32 s16, s18
    s_cselect_b32 s16, s17, s16
    s_barrier
    s_setprio 0
    s_and_b32 s64, s69, 2
    s_xor_b32 s32, s73, s64
    s_lshl_b32 s21, s75, 23
    s_lshl_b32 s64, s32, 18
    s_add_u32 s21, s21, s64
    s_lshl_b32 s64, s68, 1
    s_and_b32 s65, s69, 1
    s_add_u32 s33, s64, s65
    s_lshl_b32 s64, s33, 11
    s_add_u32 s21, s21, s64
    s_lshl_b32 s23, s69, 11
    s_add_u32 s22, s21, 262144
    s_lshl_b32 s64, s57, 14
    s_add_u32 s20, s21, s64
    s_add_u32 s34, s58, s71
    s_lshl_b32 s34, s34, 1
    s_add_u32 s34, s34, s68
    s_and_b32 s64, s3, 1
    s_lshl_b32 s64, s64, 12
    v_add_u32 v235, s64, v249
    v_lshrrev_b32 v253, 1, v251
    v_lshrrev_b32 v254, 2, v252
    v_lshl_add_u32 v253, v253, 2, v254
    v_mul_u32_u24 v253, 448, v253
    v_and_b32 v254, 1, v251
    v_mul_u32_u24 v254, 7200, v254
    v_add_u32 v253, v253, v254
    v_and_b32 v254, 3, v252
    v_lshl_add_u32 v253, v254, 3, v253
    v_add_u32 v253, 36736, v253
    s_lshr_b32 s64, s69, 1
    s_lshl_b32 s28, s64, 2
    s_add_u32 s28, s28, 8
    s_lshl_b32 s65, s28, 5
    v_add_u32 v236, s65, v253
    v_add_u32 v237, 57600, v236
    s_add_u32 s65, s64, 10
    s_lshl_b32 s65, s65, 5
    v_add_u32 v238, s65, v253
    v_add_u32 v239, 57600, v238
    s_mul_i32 s65, s64, 224
    s_and_b32 s64, s3, 1
    s_mul_i32 s64, s64, 14400
    s_add_u32 s65, s65, s64
    v_add_u32 v224, s65, v253
    v_mov_b32 v220, 0x3f803f80
    v_mov_b32 v221, 0x3f803f80
    v_mov_b32 v222, 0x3f803f80
    v_mov_b32 v223, 0x3f803f80
    s_lshl_b32 s25, s73, 1
    s_add_u32 s25, s25, s68
    s_mul_i32 s25, s25, 458752
    s_lshl_b32 s66, s60, 24
    s_add_u32 s25, s25, s66
    s_add_u32 s25, s25, 20971520
    s_and_b32 s64, s74, 7
    s_mul_i32 s64, s64, 57344
    s_add_u32 s25, s25, s64
    s_cmp_eq_u32 s75, 0
    s_cselect_b32 s27, 0, 8
    s_and_b32 s64, s34, 3
    s_or_b32 s27, s27, s64
    s_lshl_b32 s35, s75, 15
    s_lshl_b32 s66, s73, 9
    s_add_u32 s35, s35, s66
    s_add_u32 s35, s35, 75505664
    s_lshl_b32 s65, s68, 3
    s_add_u32 s35, s35, s65
    v_lshlrev_b32 v246, 5, v250
    s_lshl_b32 s36, s75, 12
    s_add_u32 s36, s36, 75563008
    s_xor_b32 s37, s73, 2
    s_lshl_b32 s37, s37, 1
    s_add_u32 s37, s37, s68
    s_lshl_b32 s37, s37, 7
    s_add_u32 s37, s37, s36
    s_cmp_ge_u32 s69, 2
    s_cbranch_scc1 lr_34
    s_mov_b64 exec, 0xffff
pl_35:
    buffer_load_dwordx2 v[240:241], v246, s[80:83], s35 offen sc1
    s_sub_u32 s79, s79, 1
    s_cbranch_scc1 L_abort
    s_waitcnt vmcnt(0)
    v_and_b32 v240, v240, v241
    v_cmp_ne_u32 vcc, 1, v240
    s_cbranch_vccnz pl_35
    s_mov_b64 exec, -1
    s_cmp_lg_u32 s78, 0
    s_cbranch_scc1 pl_35_acq
pl_35_ok:
    s_lshr_b32 s64, s72, 1
    s_or_b32 s64, s64, s69
    s_cbranch_scc1 rl_36
    s_lshl_b32 s64, s73, 1
    s_add_u32 s64, s64, s68
    s_lshl_b32 s64, s64, 7
    s_add_u32 s64, s64, s36
    v_mov_b32 v242, 0
    v_mov_b32 v243, 1
    s_mov_b64 exec, 1
    buffer_store_dword v243, v242, s[80:83], s64 offen sc0 sc1
    s_mov_b64 exec, -1
rl_36:
    s_branch lr_34_d
lr_34:
    s_mov_b64 exec, 1
pl_37:
    buffer_load_dword v240, v246, s[80:83], s37 offen sc1
    s_sub_u32 s79, s79, 1
    s_cbranch_scc1 L_abort
    s_waitcnt vmcnt(0)
    v_cmp_ne_u32 vcc, 1, v240
    s_cbranch_vccnz pl_37
    s_mov_b64 exec, -1
    s_cmp_lg_u32 s78, 0
    s_cbranch_scc1 pl_37_acq
pl_37_ok:
lr_34_d:
    s_add_u32 m0, s23, 0
    s_nop 0
    buffer_load_dwordx4 v249, s[80:83], s20 offen sc1 lds
    s_add_u32 m0, s23, 0
    s_nop 0
    buffer_load_dwordx4 v249, s[80:83], s20 offen offset:1024 sc1 lds
    s_add_u32 s20, s20, 8192
    s_cmp_eq_u32 s20, s22
    s_cselect_b32 s20, s21, s20
    s_add_u32 m0, s23, 8192
    s_nop 0
    buffer_load_dwordx4 v249, s[80:83], s20 offen sc1 lds
    s_add_u32 m0, s23, 8192
    s_nop 0
    buffer_load_dwordx4 v249, s[80:83], s20 offen offset:1024 sc1 lds
    s_add_u32 s20, s20, 8192
    s_cmp_eq_u32 s20, s22
    s_cselect_b32 s20, s21, s20
    s_add_u32 m0, s19, 86400
    s_nop 0
    buffer_load_dwordx4 v228, s[8:11], s16 offen lds
    s_add_u32 m0, s19, 87424
    s_nop 0
    buffer_load_dwordx4 v229, s[8:11], s16 offen lds
    s_add_u32 m0, s19, 88448
    s_nop 0
    buffer_load_dwordx4 v230, s[8:11], s16 offen lds
    s_add_u32 m0, s19, 89472
    s_nop 0
    buffer_load_dwordx4 v231, s[8:11], s16 offen lds
    s_waitcnt vmcnt(6)
    s_barrier
    ds_read_b128 v[144:147], v235 offset:0
    ds_read_b128 v[148:151], v235 offset:1024
    ds_read_b128 v[152:155], v235 offset:2048
    ds_read_b128 v[156:159], v235 offset:3072
    ds_read_b64_tr_b16 v[96:97], v236 offset:28800
    ds_read_b64_tr_b16 v[98:99], v236 offset:32384
    ds_read_b64_tr_b16 v[108:109], v236 offset:43200
    ds_read_b64_tr_b16 v[110:111], v236 offset:46784
    ds_read_b64_tr_b16 v[100:101], v236 offset:28832
    ds_read_b64_tr_b16 v[102:103], v236 offset:32416
    ds_read_b64_tr_b16 v[112:113], v236 offset:43232
    ds_read_b64_tr_b16 v[114:115], v236 offset:46816
    ds_read_b64_tr_b16 v[104:105], v238 offset:28800
    ds_read_b64_tr_b16 v[106:107], v238 offset:32384
    ds_read_b64_tr_b16 v[116:117], v238 offset:43200
    ds_read_b64_tr_b16 v[118:119], v238 offset:46784
    s_add_u32 m0, s19, 90496
    s_nop 0
    buffer_load_dwordx4 v232, s[8:11], s16 offen lds
    s_add_u32 m0, s19, 91520
    s_nop 0
    buffer_load_dwordx4 v233, s[8:11], s16 offen lds
    s_add_u32 m0, s19, 92544
    s_nop 0
    buffer_load_dwordx4 v234, s[8:11], s16 offen lds
    s_add_u32 s16, s16, 229376
    s_cmp_eq_u32 s16, s18
    s_cselect_b32 s16, s17, s16
    s_add_u32 m0, s23, 16384
    s_nop 0
    buffer_load_dwordx4 v249, s[80:83], s20 offen sc1 lds
    s_add_u32 m0, s23, 16384
    s_nop 0
    buffer_load_dwordx4 v249, s[80:83], s20 offen offset:1024 sc1 lds
    s_add_u32 s20, s20, 8192
    s_cmp_eq_u32 s20, s22
    s_cselect_b32 s20, s21, s20
    s_cmp_eq_u32 s27, 0
    s_cbranch_scc1 cs_38
cs_38_b:
    s_waitcnt vmcnt(9) lgkmcnt(0)
    s_barrier
    s_cmp_eq_u32 s27, 0
    s_cbranch_scc1 cs_39
cs_39_b:
    v_mfma_f32_16x16x32_bf16 v[0:3], v[96:99], v[144:147], 0
    ds_read_b128 v[160:163], v235 offset:8192
    ds_read_b128 v[164:167], v235 offset:9216
    v_mfma_f32_16x16x32_bf16 v[4:7], v[96:99], v[148:151], 0
    ds_read_b128 v[168:171], v235 offset:10240
    v_mfma_f32_16x16x32_bf16 v[8:11], v[96:99], v[152:155], 0
    ds_read_b128 v[172:175], v235 offset:11264
    v_mfma_f32_16x16x32_bf16 v[12:15], v[96:99], v[156:159], 0
    s_add_u32 m0, s19, 0
    s_nop 0
    buffer_load_dwordx4 v228, s[8:11], s16 offen lds
    v_mfma_f32_16x16x32_bf16 v[48:51], v[108:111], v[144:147], 0
    ds_read_b64_tr_b16 v[120:121], v237 offset:0
    v_mfma_f32_16x16x32_bf16 v[52:55], v[108:111], v[148:151], 0
    ds_read_b64_tr_b16 v[122:123], v237 offset:3584
    v_mfma_f32_16x16x32_bf16 v[56:59], v[108:111], v[152:155], 0
    ds_read_b64_tr_b16 v[132:133], v237 offset:14400
    v_mfma_f32_16x16x32_bf16 v[60:63], v[108:111], v[156:159], 0
    s_add_u32 m0, s19, 1024
    s_nop 0
    buffer_load_dwordx4 v229, s[8:11], s16 offen lds
    v_mfma_f32_16x16x32_bf16 v[16:19], v[100:103], v[144:147], 0
    ds_read_b64_tr_b16 v[134:135], v237 offset:17984
    v_mfma_f32_16x16x32_bf16 v[20:23], v[100:103], v[148:151], 0
    ds_read_b64_tr_b16 v[124:125], v237 offset:32
    v_mfma_f32_16x16x32_bf16 v[24:27], v[100:103], v[152:155], 0
    ds_read_b64_tr_b16 v[126:127], v237 offset:3616
    v_mfma_f32_16x16x32_bf16 v[28:31], v[100:103], v[156:159], 0
    s_add_u32 m0, s19, 2048
    s_nop 0
    buffer_load_dwordx4 v230, s[8:11], s16 offen lds
    s_add_u32 s16, s16, 229376
    s_cmp_eq_u32 s16, s18
    s_cselect_b32 s16, s17, s16
    v_mfma_f32_16x16x32_bf16 v[64:67], v[112:115], v[144:147], 0
    ds_read_b64_tr_b16 v[136:137], v237 offset:14432
    v_mfma_f32_16x16x32_bf16 v[68:71], v[112:115], v[148:151], 0
    ds_read_b64_tr_b16 v[138:139], v237 offset:18016
    v_mfma_f32_16x16x32_bf16 v[72:75], v[112:115], v[152:155], 0
    ds_read_b64_tr_b16 v[128:129], v239 offset:0
    v_mfma_f32_16x16x32_bf16 v[76:79], v[112:115], v[156:159], 0
    s_add_u32 m0, s23, 24576
    s_nop 0
    buffer_load_dwordx4 v249, s[80:83], s20 offen sc1 lds
    v_mfma_f32_16x16x32_bf16 v[32:35], v[104:107], v[144:147], 0
    ds_read_b64_tr_b16 v[130:131], v239 offset:3584
    v_mfma_f32_16x16x32_bf16 v[36:39], v[104:107], v[148:151], 0
    ds_read_b64_tr_b16 v[140:141], v239 offset:14400
    v_mfma_f32_16x16x32_bf16 v[40:43], v[104:107], v[152:155], 0
    ds_read_b64_tr_b16 v[142:143], v239 offset:17984
    v_mfma_f32_16x16x32_bf16 v[44:47], v[104:107], v[156:159], 0
    s_add_u32 m0, s23, 24576
    s_nop 0
    buffer_load_dwordx4 v249, s[80:83], s20 offen offset:1024 sc1 lds
    s_add_u32 s20, s20, 8192
    s_cmp_eq_u32 s20, s22
    s_cselect_b32 s20, s21, s20
    v_mfma_f32_16x16x32_bf16 v[80:83], v[116:119], v[144:147], 0
    v_mfma_f32_16x16x32_bf16 v[84:87], v[116:119], v[148:151], 0
    v_mfma_f32_16x16x32_bf16 v[88:91], v[116:119], v[152:155], 0
    v_mfma_f32_16x16x32_bf16 v[92:95], v[116:119], v[156:159], 0
    s_waitcnt vmcnt(5) lgkmcnt(0)
    s_barrier
    s_cmp_eq_u32 s27, 1
    s_cbranch_scc1 cs_40
cs_40_b:
    v_mfma_f32_16x16x32_bf16 v[0:3], v[120:123], v[160:163], v[0:3]
    ds_read_b128 v[144:147], v235 offset:16384
    ds_read_b128 v[148:151], v235 offset:17408
    v_mfma_f32_16x16x32_bf16 v[4:7], v[120:123], v[164:167], v[4:7]
    ds_read_b128 v[152:155], v235 offset:18432
    v_mfma_f32_16x16x32_bf16 v[8:11], v[120:123], v[168:171], v[8:11]
    ds_read_b128 v[156:159], v235 offset:19456
    v_mfma_f32_16x16x32_bf16 v[12:15], v[120:123], v[172:175], v[12:15]
    s_add_u32 m0, s19, 28800
    s_nop 0
    buffer_load_dwordx4 v228, s[8:11], s16 offen lds
    v_mfma_f32_16x16x32_bf16 v[48:51], v[132:135], v[160:163], v[48:51]
    ds_read_b64_tr_b16 v[96:97], v237 offset:28800
    v_mfma_f32_16x16x32_bf16 v[52:55], v[132:135], v[164:167], v[52:55]
    ds_read_b64_tr_b16 v[98:99], v237 offset:32384
    v_mfma_f32_16x16x32_bf16 v[56:59], v[132:135], v[168:171], v[56:59]
    ds_read_b64_tr_b16 v[108:109], v237 offset:43200
    v_mfma_f32_16x16x32_bf16 v[60:63], v[132:135], v[172:175], v[60:63]
    s_add_u32 m0, s19, 29824
    s_nop 0
    buffer_load_dwordx4 v229, s[8:11], s16 offen lds
    v_mfma_f32_16x16x32_bf16 v[16:19], v[124:127], v[160:163], v[16:19]
    ds_read_b64_tr_b16 v[110:111], v237 offset:46784
    v_mfma_f32_16x16x32_bf16 v[20:23], v[124:127], v[164:167], v[20:23]
    ds_read_b64_tr_b16 v[100:101], v237 offset:28832
    v_mfma_f32_16x16x32_bf16 v[24:27], v[124:127], v[168:171], v[24:27]
    ds_read_b64_tr_b16 v[102:103], v237 offset:32416
    v_mfma_f32_16x16x32_bf16 v[28:31], v[124:127], v[172:175], v[28:31]
    s_add_u32 m0, s19, 30848
    s_nop 0
    buffer_load_dwordx4 v230, s[8:11], s16 offen lds
    s_add_u32 s16, s16, 229376
    s_cmp_eq_u32 s16, s18
    s_cselect_b32 s16, s17, s16
    v_mfma_f32_16x16x32_bf16 v[64:67], v[136:139], v[160:163], v[64:67]
    ds_read_b64_tr_b16 v[112:113], v237 offset:43232
    v_mfma_f32_16x16x32_bf16 v[68:71], v[136:139], v[164:167], v[68:71]
    ds_read_b64_tr_b16 v[114:115], v237 offset:46816
    v_mfma_f32_16x16x32_bf16 v[72:75], v[136:139], v[168:171], v[72:75]
    ds_read_b64_tr_b16 v[104:105], v239 offset:28800
    v_mfma_f32_16x16x32_bf16 v[76:79], v[136:139], v[172:175], v[76:79]
    s_add_u32 m0, s23, 0
    s_nop 0
    buffer_load_dwordx4 v249, s[80:83], s20 offen sc1 lds
    v_mfma_f32_16x16x32_bf16 v[32:35], v[128:131], v[160:163], v[32:35]
    ds_read_b64_tr_b16 v[106:107], v239 offset:32384
    v_mfma_f32_16x16x32_bf16 v[36:39], v[128:131], v[164:167], v[36:39]
    ds_read_b64_tr_b16 v[116:117], v239 offset:43200
    v_mfma_f32_16x16x32_bf16 v[40:43], v[128:131], v[168:171], v[40:43]
    ds_read_b64_tr_b16 v[118:119], v239 offset:46784
    v_mfma_f32_16x16x32_bf16 v[44:47], v[128:131], v[172:175], v[44:47]
    s_add_u32 m0, s23, 0
    s_nop 0
    buffer_load_dwordx4 v249, s[80:83], s20 offen offset:1024 sc1 lds
    s_add_u32 s20, s20, 8192
    s_cmp_eq_u32 s20, s22
    s_cselect_b32 s20, s21, s20
    v_mfma_f32_16x16x32_bf16 v[80:83], v[140:143], v[160:163], v[80:83]
    v_mfma_f32_16x16x32_bf16 v[84:87], v[140:143], v[164:167], v[84:87]
    v_mfma_f32_16x16x32_bf16 v[88:91], v[140:143], v[168:171], v[88:91]
    v_mfma_f32_16x16x32_bf16 v[92:95], v[140:143], v[172:175], v[92:95]
    s_waitcnt vmcnt(5) lgkmcnt(0)
    s_barrier
    s_cmp_eq_u32 s27, 1
    s_cbranch_scc1 cs_41
cs_41_b:
    v_mfma_f32_16x16x32_bf16 v[0:3], v[96:99], v[144:147], v[0:3]
    ds_read_b128 v[160:163], v235 offset:24576
    ds_read_b128 v[164:167], v235 offset:25600
    v_mfma_f32_16x16x32_bf16 v[4:7], v[96:99], v[148:151], v[4:7]
    ds_read_b128 v[168:171], v235 offset:26624
    v_mfma_f32_16x16x32_bf16 v[8:11], v[96:99], v[152:155], v[8:11]
    ds_read_b128 v[172:175], v235 offset:27648
    v_mfma_f32_16x16x32_bf16 v[12:15], v[96:99], v[156:159], v[12:15]
    s_add_u32 m0, s19, 57600
    s_nop 0
    buffer_load_dwordx4 v228, s[8:11], s16 offen lds
    v_mfma_f32_16x16x32_bf16 v[48:51], v[108:111], v[144:147], v[48:51]
    ds_read_b64_tr_b16 v[120:121], v236 offset:0
    v_mfma_f32_16x16x32_bf16 v[52:55], v[108:111], v[148:151], v[52:55]
    ds_read_b64_tr_b16 v[122:123], v236 offset:3584
    v_mfma_f32_16x16x32_bf16 v[56:59], v[108:111], v[152:155], v[56:59]
    ds_read_b64_tr_b16 v[132:133], v236 offset:14400
    v_mfma_f32_16x16x32_bf16 v[60:63], v[108:111], v[156:159], v[60:63]
    s_add_u32 m0, s19, 58624
    s_nop 0
    buffer_load_dwordx4 v229, s[8:11], s16 offen lds
    v_mfma_f32_16x16x32_bf16 v[16:19], v[100:103], v[144:147], v[16:19]
    ds_read_b64_tr_b16 v[134:135], v236 offset:17984
    v_mfma_f32_16x16x32_bf16 v[20:23], v[100:103], v[148:151], v[20:23]
    ds_read_b64_tr_b16 v[124:125], v236 offset:32
    v_mfma_f32_16x16x32_bf16 v[24:27], v[100:103], v[152:155], v[24:27]
    ds_read_b64_tr_b16 v[126:127], v236 offset:3616
    v_mfma_f32_16x16x32_bf16 v[28:31], v[100:103], v[156:159], v[28:31]
    s_add_u32 m0, s19, 59648
    s_nop 0
    buffer_load_dwordx4 v230, s[8:11], s16 offen lds
    s_add_u32 s16, s16, 229376
    s_cmp_eq_u32 s16, s18
    s_cselect_b32 s16, s17, s16
    v_mfma_f32_16x16x32_bf16 v[64:67], v[112:115], v[144:147], v[64:67]
    ds_read_b64_tr_b16 v[136:137], v236 offset:14432
    v_mfma_f32_16x16x32_bf16 v[68:71], v[112:115], v[148:151], v[68:71]
    ds_read_b64_tr_b16 v[138:139], v236 offset:18016
    v_mfma_f32_16x16x32_bf16 v[72:75], v[112:115], v[152:155], v[72:75]
    ds_read_b64_tr_b16 v[128:129], v238 offset:0
    v_mfma_f32_16x16x32_bf16 v[76:79], v[112:115], v[156:159], v[76:79]
    s_add_u32 m0, s23, 8192
    s_nop 0
    buffer_load_dwordx4 v249, s[80:83], s20 offen sc1 lds
    v_mfma_f32_16x16x32_bf16 v[32:35], v[104:107], v[144:147], v[32:35]
    ds_read_b64_tr_b16 v[130:131], v238 offset:3584
    v_mfma_f32_16x16x32_bf16 v[36:39], v[104:107], v[148:151], v[36:39]
    ds_read_b64_tr_b16 v[140:141], v238 offset:14400
    v_mfma_f32_16x16x32_bf16 v[40:43], v[104:107], v[152:155], v[40:43]
    ds_read_b64_tr_b16 v[142:143], v238 offset:17984
    v_mfma_f32_16x16x32_bf16 v[44:47], v[104:107], v[156:159], v[44:47]
    s_add_u32 m0, s23, 8192
    s_nop 0
    buffer_load_dwordx4 v249, s[80:83], s20 offen offset:1024 sc1 lds
    s_add_u32 s20, s20, 8192
    s_cmp_eq_u32 s20, s22
    s_cselect_b32 s20, s21, s20
    v_mfma_f32_16x16x32_bf16 v[80:83], v[116:119], v[144:147], v[80:83]
    v_mfma_f32_16x16x32_bf16 v[84:87], v[116:119], v[148:151], v[84:87]
    v_mfma_f32_16x16x32_bf16 v[88:91], v[116:119], v[152:155], v[88:91]
    v_mfma_f32_16x16x32_bf16 v[92:95], v[116:119], v[156:159], v[92:95]
    s_waitcnt vmcnt(5) lgkmcnt(0)
    s_barrier
    s_cmp_eq_u32 s27, 2
    s_cbranch_scc1 cs_42
cs_42_b:
    v_mfma_f32_16x16x32_bf16 v[0:3], v[120:123], v[160:163], v[0:3]
    ds_read_b128 v[144:147], v235 offset:0
    ds_read_b128 v[148:151], v235 offset:1024
    v_mfma_f32_16x16x32_bf16 v[4:7], v[120:123], v[164:167], v[4:7]
    ds_read_b128 v[152:155], v235 offset:2048
    v_mfma_f32_16x16x32_bf16 v[8:11], v[120:123], v[168:171], v[8:11]
    ds_read_b128 v[156:159], v235 offset:3072
    v_mfma_f32_16x16x32_bf16 v[12:15], v[120:123], v[172:175], v[12:15]
    s_add_u32 m0, s19, 86400
    s_nop 0
    buffer_load_dwordx4 v228, s[8:11], s16 offen lds
    v_mfma_f32_16x16x32_bf16 v[48:51], v[132:135], v[160:163], v[48:51]
    ds_read_b64_tr_b16 v[96:97], v236 offset:28800
    v_mfma_f32_16x16x32_bf16 v[52:55], v[132:135], v[164:167], v[52:55]
    ds_read_b64_tr_b16 v[98:99], v236 offset:32384
    v_mfma_f32_16x16x32_bf16 v[56:59], v[132:135], v[168:171], v[56:59]
    ds_read_b64_tr_b16 v[108:109], v236 offset:43200
    v_mfma_f32_16x16x32_bf16 v[60:63], v[132:135], v[172:175], v[60:63]
    s_add_u32 m0, s19, 87424
    s_nop 0
    buffer_load_dwordx4 v229, s[8:11], s16 offen lds
    v_mfma_f32_16x16x32_bf16 v[16:19], v[124:127], v[160:163], v[16:19]
    ds_read_b64_tr_b16 v[110:111], v236 offset:46784
    v_mfma_f32_16x16x32_bf16 v[20:23], v[124:127], v[164:167], v[20:23]
    ds_read_b64_tr_b16 v[100:101], v236 offset:28832
    v_mfma_f32_16x16x32_bf16 v[24:27], v[124:127], v[168:171], v[24:27]
    ds_read_b64_tr_b16 v[102:103], v236 offset:32416
    v_mfma_f32_16x16x32_bf16 v[28:31], v[124:127], v[172:175], v[28:31]
    s_add_u32 m0, s19, 88448
    s_nop 0
    buffer_load_dwordx4 v230, s[8:11], s16 offen lds
    s_add_u32 s16, s16, 229376
    s_cmp_eq_u32 s16, s18
    s_cselect_b32 s16, s17, s16
    v_mfma_f32_16x16x32_bf16 v[64:67], v[136:139], v[160:163], v[64:67]
    ds_read_b64_tr_b16 v[112:113], v236 offset:43232
    v_mfma_f32_16x16x32_bf16 v[68:71], v[136:139], v[164:167], v[68:71]
    ds_read_b64_tr_b16 v[114:115], v236 offset:46816
    v_mfma_f32_16x16x32_bf16 v[72:75], v[136:139], v[168:171], v[72:75]
    ds_read_b64_tr_b16 v[104:105], v238 offset:28800
    v_mfma_f32_16x16x32_bf16 v[76:79], v[136:139], v[172:175], v[76:79]
    s_add_u32 m0, s23, 16384
    s_nop 0
    buffer_load_dwordx4 v249, s[80:83], s20 offen sc1 lds
    v_mfma_f32_16x16x32_bf16 v[32:35], v[128:131], v[160:163], v[32:35]
    ds_read_b64_tr_b16 v[106:107], v238 offset:32384
    v_mfma_f32_16x16x32_bf16 v[36:39], v[128:131], v[164:167], v[36:39]
    ds_read_b64_tr_b16 v[116:117], v238 offset:43200
    v_mfma_f32_16x16x32_bf16 v[40:43], v[128:131], v[168:171], v[40:43]
    ds_read_b64_tr_b16 v[118:119], v238 offset:46784
    v_mfma_f32_16x16x32_bf16 v[44:47], v[128:131], v[172:175], v[44:47]
    s_add_u32 m0, s23, 16384
    s_nop 0
    buffer_load_dwordx4 v249, s[80:83], s20 offen offset:1024 sc1 lds
    s_add_u32 s20, s20, 8192
    s_cmp_eq_u32 s20, s22
    s_cselect_b32 s20, s21, s20
    v_mfma_f32_16x16x32_bf16 v[80:83], v[140:143], v[160:163], v[80:83]
    v_mfma_f32_16x16x32_bf16 v[84:87], v[140:143], v[164:167], v[84:87]
    v_mfma_f32_16x16x32_bf16 v[88:91], v[140:143], v[168:171], v[88:91]
    v_mfma_f32_16x16x32_bf16 v[92:95], v[140:143], v[172:175], v[92:95]
    s_waitcnt vmcnt(5) lgkmcnt(0)
    s_barrier
    s_cmp_eq_u32 s27, 2
    s_cbranch_scc1 cs_43
cs_43_b:
    v_mfma_f32_16x16x32_bf16 v[0:3], v[96:99], v[144:147], v[0:3]
    ds_read_b128 v[160:163], v235 offset:8192
    ds_read_b128 v[164:167], v235 offset:9216
    v_mfma_f32_16x16x32_bf16 v[4:7], v[96:99], v[148:151], v[4:7]
    ds_read_b128 v[168:171], v235 offset:10240
    v_mfma_f32_16x16x32_bf16 v[8:11], v[96:99], v[152:155], v[8:11]
    ds_read_b128 v[172:175], v235 offset:11264
    v_mfma_f32_16x16x32_bf16 v[12:15], v[96:99], v[156:159], v[12:15]
    s_add_u32 m0, s19, 0
    s_nop 0
    buffer_load_dwordx4 v228, s[8:11], s16 offen lds
    v_mfma_f32_16x16x32_bf16 v[48:51], v[108:111], v[144:147], v[48:51]
    ds_read_b64_tr_b16 v[120:121], v237 offset:0
    v_mfma_f32_16x16x32_bf16 v[52:55], v[108:111], v[148:151], v[52:55]
    ds_read_b64_tr_b16 v[122:123], v237 offset:3584
    v_mfma_f32_16x16x32_bf16 v[56:59], v[108:111], v[152:155], v[56:59]
    ds_read_b64_tr_b16 v[132:133], v237 offset:14400
    v_mfma_f32_16x16x32_bf16 v[60:63], v[108:111], v[156:159], v[60:63]
    s_add_u32 m0, s19, 1024
    s_nop 0
    buffer_load_dwordx4 v229, s[8:11], s16 offen lds
    v_mfma_f32_16x16x32_bf16 v[16:19], v[100:103], v[144:147], v[16:19]
    ds_read_b64_tr_b16 v[134:135], v237 offset:17984
    v_mfma_f32_16x16x32_bf16 v[20:23], v[100:103], v[148:151], v[20:23]
    ds_read_b64_tr_b16 v[124:125], v237 offset:32
    v_mfma_f32_16x16x32_bf16 v[24:27], v[100:103], v[152:155], v[24:27]
    ds_read_b64_tr_b16 v[126:127], v237 offset:3616
    v_mfma_f32_16x16x32_bf16 v[28:31], v[100:103], v[156:159], v[28:31]
    s_add_u32 m0, s19, 2048
    s_nop 0
    buffer_load_dwordx4 v230, s[8:11], s16 offen lds
    s_add_u32 s16, s16, 229376
    s_cmp_eq_u32 s16, s18
    s_cselect_b32 s16, s17, s16
    v_mfma_f32_16x16x32_bf16 v[64:67], v[112:115], v[144:147], v[64:67]
    ds_read_b64_tr_b16 v[136:137], v237 offset:14432
    v_mfma_f32_16x16x32_bf16 v[68:71], v[112:115], v[148:151], v[68:71]
    ds_read_b64_tr_b16 v[138:139], v237 offset:18016
    v_mfma_f32_16x16x32_bf16 v[72:75], v[112:115], v[152:155], v[72:75]
    ds_read_b64_tr_b16 v[128:129], v239 offset:0
    v_mfma_f32_16x16x32_bf16 v[76:79], v[112:115], v[156:159], v[76:79]
    s_add_u32 m0, s23, 24576
    s_nop 0
    buffer_load_dwordx4 v249, s[80:83], s20 offen sc1 lds
    v_mfma_f32_16x16x32_bf16 v[32:35], v[104:107], v[144:147], v[32:35]
    ds_read_b64_tr_b16 v[130:131], v239 offset:3584
    v_mfma_f32_16x16x32_bf16 v[36:39], v[104:107], v[148:151], v[36:39]
    ds_read_b64_tr_b16 v[140:141], v239 offset:14400
    v_mfma_f32_16x16x32_bf16 v[40:43], v[104:107], v[152:155], v[40:43]
    ds_read_b64_tr_b16 v[142:143], v239 offset:17984
    v_mfma_f32_16x16x32_bf16 v[44:47], v[104:107], v[156:159], v[44:47]
    s_add_u32 m0, s23, 24576
    s_nop 0
    buffer_load_dwordx4 v249, s[80:83], s20 offen offset:1024 sc1 lds
    s_add_u32 s20, s20, 8192
    s_cmp_eq_u32 s20, s22
    s_cselect_b32 s20, s21, s20
    v_mfma_f32_16x16x32_bf16 v[80:83], v[116:119], v[144:147], v[80:83]
    v_mfma_f32_16x16x32_bf16 v[84:87], v[116:119], v[148:151], v[84:87]
    v_mfma_f32_16x16x32_bf16 v[88:91], v[116:119], v[152:155], v[88:91]
    v_mfma_f32_16x16x32_bf16 v[92:95], v[116:119], v[156:159], v[92:95]
    s_waitcnt vmcnt(5) lgkmcnt(0)
    s_barrier
    s_cmp_eq_u32 s27, 3
    s_cbranch_scc1 cs_44
cs_44_b:
    v_mfma_f32_16x16x32_bf16 v[0:3], v[120:123], v[160:163], v[0:3]
    ds_read_b128 v[144:147], v235 offset:16384
    ds_read_b128 v[148:151], v235 offset:17408
    v_mfma_f32_16x16x32_bf16 v[4:7], v[120:123], v[164:167], v[4:7]
    ds_read_b128 v[152:155], v235 offset:18432
    v_mfma_f32_16x16x32_bf16 v[8:11], v[120:123], v[168:171], v[8:11]
    ds_read_b128 v[156:159], v235 offset:19456
    v_mfma_f32_16x16x32_bf16 v[12:15], v[120:123], v[172:175], v[12:15]
    s_add_u32 m0, s19, 28800
    s_nop 0
    buffer_load_dwordx4 v228, s[8:11], s16 offen lds
    v_mfma_f32_16x16x32_bf16 v[48:51], v[132:135], v[160:163], v[48:51]
    ds_read_b64_tr_b16 v[96:97], v237 offset:28800
    v_mfma_f32_16x16x32_bf16 v[52:55], v[132:135], v[164:167], v[52:55]
    ds_read_b64_tr_b16 v[98:99], v237 offset:32384
    v_mfma_f32_16x16x32_bf16 v[56:59], v[132:135], v[168:171], v[56:59]
    ds_read_b64_tr_b16 v[108:109], v237 offset:43200
    v_mfma_f32_16x16x32_bf16 v[60:63], v[132:135], v[172:175], v[60:63]
    s_add_u32 m0, s19, 29824
    s_nop 0
    buffer_load_dwordx4 v229, s[8:11], s16 offen lds
    v_mfma_f32_16x16x32_bf16 v[16:19], v[124:127], v[160:163], v[16:19]
    ds_read_b64_tr_b16 v[110:111], v237 offset:46784
    v_mfma_f32_16x16x32_bf16 v[20:23], v[124:127], v[164:167], v[20:23]
    ds_read_b64_tr_b16 v[100:101], v237 offset:28832
    v_mfma_f32_16x16x32_bf16 v[24:27], v[124:127], v[168:171], v[24:27]
    ds_read_b64_tr_b16 v[102:103], v237 offset:32416
    v_mfma_f32_16x16x32_bf16 v[28:31], v[124:127], v[172:175], v[28:31]
    s_add_u32 m0, s19, 30848
    s_nop 0
    buffer_load_dwordx4 v230, s[8:11], s16 offen lds
    s_add_u32 s16, s16, 229376
    s_cmp_eq_u32 s16, s18
    s_cselect_b32 s16, s17, s16
    v_mfma_f32_16x16x32_bf16 v[64:67], v[136:139], v[160:163], v[64:67]
    ds_read_b64_tr_b16 v[112:113], v237 offset:43232
    v_mfma_f32_16x16x32_bf16 v[68:71], v[136:139], v[164:167], v[68:71]
    ds_read_b64_tr_b16 v[114:115], v237 offset:46816
    v_mfma_f32_16x16x32_bf16 v[72:75], v[136:139], v[168:171], v[72:75]
    ds_read_b64_tr_b16 v[104:105], v239 offset:28800
    v_mfma_f32_16x16x32_bf16 v[76:79], v[136:139], v[172:175], v[76:79]
    s_add_u32 m0, s23, 0
    s_nop 0
    buffer_load_dwordx4 v249, s[80:83], s20 offen sc1 lds
    v_mfma_f32_16x16x32_bf16 v[32:35], v[128:131], v[160:163], v[32:35]
    ds_read_b64_tr_b16 v[106:107], v239 offset:32384
    v_mfma_f32_16x16x32_bf16 v[36:39], v[128:131], v[164:167], v[36:39]
    ds_read_b64_tr_b16 v[116:117], v239 offset:43200
    v_mfma_f32_16x16x32_bf16 v[40:43], v[128:131], v[168:171], v[40:43]
    ds_read_b64_tr_b16 v[118:119], v239 offset:46784
    v_mfma_f32_16x16x32_bf16 v[44:47], v[128:131], v[172:175], v[44:47]
    s_add_u32 m0, s23, 0
    s_nop 0
    buffer_load_dwordx4 v249, s[80:83], s20 offen offset:1024 sc1 lds
    s_add_u32 s20, s20, 8192
    s_cmp_eq_u32 s20, s22
    s_cselect_b32 s20, s21, s20
    v_mfma_f32_16x16x32_bf16 v[80:83], v[140:143], v[160:163], v[80:83]
    v_mfma_f32_16x16x32_bf16 v[84:87], v[140:143], v[164:167], v[84:87]
    v_mfma_f32_16x16x32_bf16 v[88:91], v[140:143], v[168:171], v[88:91]
    v_mfma_f32_16x16x32_bf16 v[92:95], v[140:143], v[172:175], v[92:95]
    s_waitcnt vmcnt(5) lgkmcnt(0)
    s_barrier
    s_cmp_eq_u32 s27, 3
    s_cbranch_scc1 cs_45
cs_45_b:
    v_mfma_f32_16x16x32_bf16 v[0:3], v[96:99], v[144:147], v[0:3]
    ds_read_b128 v[160:163], v235 offset:24576
    ds_read_b128 v[164:167], v235 offset:25600
    v_mfma_f32_16x16x32_bf16 v[4:7], v[96:99], v[148:151], v[4:7]
    ds_read_b128 v[168:171], v235 offset:26624
    v_mfma_f32_16x16x32_bf16 v[8:11], v[96:99], v[152:155], v[8:11]
    ds_read_b128 v[172:175], v235 offset:27648
    v_mfma_f32_16x16x32_bf16 v[12:15], v[96:99], v[156:159], v[12:15]
    s_add_u32 m0, s19, 57600
    s_nop 0
    buffer_load_dwordx4 v228, s[8:11], s16 offen lds
    v_mfma_f32_16x16x32_bf16 v[48:51], v[108:111], v[144:147], v[48:51]
    ds_read_b64_tr_b16 v[120:121], v236 offset:0
    v_mfma_f32_16x16x32_bf16 v[52:55], v[108:111], v[148:151], v[52:55]
    ds_read_b64_tr_b16 v[122:123], v236 offset:3584
    v_mfma_f32_16x16x32_bf16 v[56:59], v[108:111], v[152:155], v[56:59]
    ds_read_b64_tr_b16 v[132:133], v236 offset:14400
    v_mfma_f32_16x16x32_bf16 v[60:63], v[108:111], v[156:159], v[60:63]
    s_add_u32 m0, s19, 58624
    s_nop 0
    buffer_load_dwordx4 v229, s[8:11], s16 offen lds
    v_mfma_f32_16x16x32_bf16 v[16:19], v[100:103], v[144:147], v[16:19]
    ds_read_b64_tr_b16 v[134:135], v236 offset:17984
    v_mfma_f32_16x16x32_bf16 v[20:23], v[100:103], v[148:151], v[20:23]
    ds_read_b64_tr_b16 v[124:125], v236 offset:32
    v_mfma_f32_16x16x32_bf16 v[24:27], v[100:103], v[152:155], v[24:27]
    ds_read_b64_tr_b16 v[126:127], v236 offset:3616
    v_mfma_f32_16x16x32_bf16 v[28:31], v[100:103], v[156:159], v[28:31]
    s_add_u32 m0, s19, 59648
    s_nop 0
    buffer_load_dwordx4 v230, s[8:11], s16 offen lds
    s_add_u32 s16, s16, 229376
    s_cmp_eq_u32 s16, s18
    s_cselect_b32 s16, s17, s16
    v_mfma_f32_16x16x32_bf16 v[64:67], v[112:115], v[144:147], v[64:67]
    ds_read_b64_tr_b16 v[136:137], v236 offset:14432
    v_mfma_f32_16x16x32_bf16 v[68:71], v[112:115], v[148:151], v[68:71]
    ds_read_b64_tr_b16 v[138:139], v236 offset:18016
    v_mfma_f32_16x16x32_bf16 v[72:75], v[112:115], v[152:155], v[72:75]
    ds_read_b64_tr_b16 v[128:129], v238 offset:0
    v_mfma_f32_16x16x32_bf16 v[76:79], v[112:115], v[156:159], v[76:79]
    s_add_u32 m0, s23, 8192
    s_nop 0
    buffer_load_dwordx4 v249, s[80:83], s20 offen sc1 lds
    v_mfma_f32_16x16x32_bf16 v[32:35], v[104:107], v[144:147], v[32:35]
    ds_read_b64_tr_b16 v[130:131], v238 offset:3584
    v_mfma_f32_16x16x32_bf16 v[36:39], v[104:107], v[148:151], v[36:39]
    ds_read_b64_tr_b16 v[140:141], v238 offset:14400
    v_mfma_f32_16x16x32_bf16 v[40:43], v[104:107], v[152:155], v[40:43]
    ds_read_b64_tr_b16 v[142:143], v238 offset:17984
    v_mfma_f32_16x16x32_bf16 v[44:47], v[104:107], v[156:159], v[44:47]
    s_add_u32 m0, s23, 8192
    s_nop 0
    buffer_load_dwordx4 v249, s[80:83], s20 offen offset:1024 sc1 lds
    s_add_u32 s20, s20, 8192
    s_cmp_eq_u32 s20, s22
    s_cselect_b32 s20, s21, s20
    v_mfma_f32_16x16x32_bf16 v[80:83], v[116:119], v[144:147], v[80:83]
    v_mfma_f32_16x16x32_bf16 v[84:87], v[116:119], v[148:151], v[84:87]
    v_mfma_f32_16x16x32_bf16 v[88:91], v[116:119], v[152:155], v[88:91]
    v_mfma_f32_16x16x32_bf16 v[92:95], v[116:119], v[156:159], v[92:95]
    s_waitcnt vmcnt(5) lgkmcnt(0)
    s_barrier
    v_mfma_f32_16x16x32_bf16 v[0:3], v[120:123], v[160:163], v[0:3]
    ds_read_b128 v[144:147], v235 offset:0
    ds_read_b128 v[148:151], v235 offset:1024
    v_mfma_f32_16x16x32_bf16 v[4:7], v[120:123], v[164:167], v[4:7]
    ds_read_b128 v[152:155], v235 offset:2048
    v_mfma_f32_16x16x32_bf16 v[8:11], v[120:123], v[168:171], v[8:11]
    ds_read_b128 v[156:159], v235 offset:3072
    v_mfma_f32_16x16x32_bf16 v[12:15], v[120:123], v[172:175], v[12:15]
    s_add_u32 m0, s19, 86400
    s_nop 0
    buffer_load_dwordx4 v228, s[8:11], s16 offen lds
    v_mfma_f32_16x16x32_bf16 v[48:51], v[132:135], v[160:163], v[48:51]
    ds_read_b64_tr_b16 v[96:97], v236 offset:28800
    v_mfma_f32_16x16x32_bf16 v[52:55], v[132:135], v[164:167], v[52:55]
    ds_read_b64_tr_b16 v[98:99], v236 offset:32384
    v_mfma_f32_16x16x32_bf16 v[56:59], v[132:135], v[168:171], v[56:59]
    ds_read_b64_tr_b16 v[108:109], v236 offset:43200
    v_mfma_f32_16x16x32_bf16 v[60:63], v[132:135], v[172:175], v[60:63]
    s_add_u32 m0, s19, 87424
    s_nop 0
    buffer_load_dwordx4 v229, s[8:11], s16 offen lds
    v_mfma_f32_16x16x32_bf16 v[16:19], v[124:127], v[160:163], v[16:19]
    ds_read_b64_tr_b16 v[110:111], v236 offset:46784
    v_mfma_f32_16x16x32_bf16 v[20:23], v[124:127], v[164:167], v[20:23]
    ds_read_b64_tr_b16 v[100:101], v236 offset:28832
    v_mfma_f32_16x16x32_bf16 v[24:27], v[124:127], v[168:171], v[24:27]
    ds_read_b64_tr_b16 v[102:103], v236 offset:32416
    v_mfma_f32_16x16x32_bf16 v[28:31], v[124:127], v[172:175], v[28:31]
    s_add_u32 m0, s19, 88448
    s_nop 0
    buffer_load_dwordx4 v230, s[8:11], s16 offen lds
    s_add_u32 s16, s16, 229376
    s_cmp_eq_u32 s16, s18
    s_cselect_b32 s16, s17, s16
    v_mfma_f32_16x16x32_bf16 v[64:67], v[136:139], v[160:163], v[64:67]
    ds_read_b64_tr_b16 v[112:113], v236 offset:43232
    s_lshl_b32 s26, s32, 15
    v_mfma_f32_16x16x32_bf16 v[68:71], v[136:139], v[164:167], v[68:71]
    ds_read_b64_tr_b16 v[114:115], v236 offset:46816
    s_lshl_b32 s65, s75, 20
    v_mfma_f32_16x16x32_bf16 v[72:75], v[136:139], v[168:171], v[72:75]
    ds_read_b64_tr_b16 v[104:105], v238 offset:28800
    s_add_u32 s26, s26, s65
    v_mfma_f32_16x16x32_bf16 v[76:79], v[136:139], v[172:175], v[76:79]
    s_add_u32 m0, s23, 16384
    s_nop 0
    buffer_load_dwordx4 v249, s[80:83], s20 offen sc1 lds
    s_lshl_b32 s65, s33, 9
    v_mfma_f32_16x16x32_bf16 v[32:35], v[128:131], v[160:163], v[32:35]
    ds_read_b64_tr_b16 v[106:107], v238 offset:32384
    s_add_u32 s26, s26, s65
    v_mfma_f32_16x16x32_bf16 v[36:39], v[128:131], v[164:167], v[36:39]
    ds_read_b64_tr_b16 v[116:117], v238 offset:43200
    v_mfma_f32_16x16x32_bf16 v[40:43], v[128:131], v[168:171], v[40:43]
    ds_read_b64_tr_b16 v[118:119], v238 offset:46784
    s_add_u32 s26, s26, 71303168
    v_mfma_f32_16x16x32_bf16 v[44:47], v[128:131], v[172:175], v[44:47]
    s_add_u32 m0, s23, 16384
    s_nop 0
    buffer_load_dwordx4 v249, s[80:83], s20 offen offset:1024 sc1 lds
    s_add_u32 s20, s20, 8192
    s_cmp_eq_u32 s20, s22
    s_cselect_b32 s20, s21, s20
    v_and_b32 v225, 31, v250
    v_mfma_f32_16x16x32_bf16 v[80:83], v[140:143], v[160:163], v[80:83]
    v_lshlrev_b32 v225, 4, v225
    v_mfma_f32_16x16x32_bf16 v[84:87], v[140:143], v[164:167], v[84:87]
    v_lshrrev_b32 v253, 5, v250
    v_mfma_f32_16x16x32_bf16 v[88:91], v[140:143], v[168:171], v[88:91]
    v_lshl_add_u32 v225, v253, 14, v225
    v_mfma_f32_16x16x32_bf16 v[92:95], v[140:143], v[172:175], v[92:95]
    s_waitcnt vmcnt(5) lgkmcnt(0)
    s_barrier
    v_mfma_f32_16x16x32_bf16 v[0:3], v[96:99], v[144:147], v[0:3]
    ds_read_b128 v[160:163], v235 offset:8192
    ds_read_b128 v[164:167], v235 offset:9216
    v_mfma_f32_16x16x32_bf16 v[4:7], v[96:99], v[148:151], v[4:7]
    ds_read_b128 v[168:171], v235 offset:10240
    v_mfma_f32_16x16x32_bf16 v[8:11], v[96:99], v[152:155], v[8:11]
    ds_read_b128 v[172:175], v235 offset:11264
    v_mfma_f32_16x16x32_bf16 v[12:15], v[96:99], v[156:159], v[12:15]
    s_add_u32 m0, s19, 0
    s_nop 0
    buffer_load_dwordx4 v228, s[8:11], s16 offen lds
    v_mfma_f32_16x16x32_bf16 v[48:51], v[108:111], v[144:147], v[48:51]
    ds_read_b64_tr_b16 v[120:121], v237 offset:0
    v_mfma_f32_16x16x32_bf16 v[52:55], v[108:111], v[148:151], v[52:55]
    ds_read_b64_tr_b16 v[122:123], v237 offset:3584
    v_mfma_f32_16x16x32_bf16 v[56:59], v[108:111], v[152:155], v[56:59]
    ds_read_b64_tr_b16 v[132:133], v237 offset:14400
    v_mfma_f32_16x16x32_bf16 v[60:63], v[108:111], v[156:159], v[60:63]
    s_add_u32 m0, s19, 1024
    s_nop 0
    buffer_load_dwordx4 v229, s[8:11], s16 offen lds
    v_mfma_f32_16x16x32_bf16 v[16:19], v[100:103], v[144:147], v[16:19]
    ds_read_b64_tr_b16 v[134:135], v237 offset:17984
    v_mfma_f32_16x16x32_bf16 v[20:23], v[100:103], v[148:151], v[20:23]
    ds_read_b64_tr_b16 v[124:125], v237 offset:32
    v_mfma_f32_16x16x32_bf16 v[24:27], v[100:103], v[152:155], v[24:27]
    ds_read_b64_tr_b16 v[126:127], v237 offset:3616
    v_mfma_f32_16x16x32_bf16 v[28:31], v[100:103], v[156:159], v[28:31]
    s_add_u32 m0, s19, 2048
    s_nop 0
    buffer_load_dwordx4 v230, s[8:11], s16 offen lds
    s_add_u32 s16, s16, 229376
    s_cmp_eq_u32 s16, s18
    s_cselect_b32 s16, s17, s16
    v_mfma_f32_16x16x32_bf16 v[64:67], v[112:115], v[144:147], v[64:67]
    ds_read_b64_tr_b16 v[136:137], v237 offset:14432
    v_mfma_f32_16x16x32_bf16 v[68:71], v[112:115], v[148:151], v[68:71]
    ds_read_b64_tr_b16 v[138:139], v237 offset:18016
    v_mfma_f32_16x16x32_bf16 v[72:75], v[112:115], v[152:155], v[72:75]
    ds_read_b64_tr_b16 v[128:129], v239 offset:0
    v_mfma_f32_16x16x32_bf16 v[76:79], v[112:115], v[156:159], v[76:79]
    s_add_u32 m0, s23, 24576
    s_nop 0
    buffer_load_dwordx4 v249, s[80:83], s20 offen sc1 lds
    v_mfma_f32_16x16x32_bf16 v[32:35], v[104:107], v[144:147], v[32:35]
    ds_read_b64_tr_b16 v[130:131], v239 offset:3584
    v_mfma_f32_16x16x32_bf16 v[36:39], v[104:107], v[148:151], v[36:39]
    ds_read_b64_tr_b16 v[140:141], v239 offset:14400
    v_mfma_f32_16x16x32_bf16 v[40:43], v[104:107], v[152:155], v[40:43]
    ds_read_b64_tr_b16 v[142:143], v239 offset:17984
    v_mfma_f32_16x16x32_bf16 v[44:47], v[104:107], v[156:159], v[44:47]
    s_add_u32 m0, s23, 24576
    s_nop 0
    buffer_load_dwordx4 v249, s[80:83], s20 offen offset:1024 sc1 lds
    s_add_u32 s20, s20, 8192
    s_cmp_eq_u32 s20, s22
    s_cselect_b32 s20, s21, s20
    v_mfma_f32_16x16x32_bf16 v[80:83], v[116:119], v[144:147], v[80:83]
    buffer_load_dwordx4 v[176:179], v225, s[80:83], s26 offen offset:0 sc1
    v_mfma_f32_16x16x32_bf16 v[84:87], v[116:119], v[148:151], v[84:87]
    buffer_load_dwordx4 v[180:183], v225, s[80:83], s26 offen offset:2048 sc1
    s_add_u32 s26, s26, 4096
    v_mfma_f32_16x16x32_bf16 v[88:91], v[116:119], v[152:155], v[88:91]
    buffer_load_dwordx4 v[184:187], v225, s[80:83], s26 offen offset:0 sc1
    v_mfma_f32_16x16x32_bf16 v[92:95], v[116:119], v[156:159], v[92:95]
    buffer_load_dwordx4 v[188:191], v225, s[80:83], s26 offen offset:2048 sc1
    s_add_u32 s26, s26, 4096
    s_waitcnt vmcnt(9) lgkmcnt(0)
    s_barrier
    v_mfma_f32_16x16x32_bf16 v[0:3], v[120:123], v[160:163], v[0:3]
    ds_read_b128 v[144:147], v235 offset:16384
    ds_read_b128 v[148:151], v235 offset:17408
    v_mfma_f32_16x16x32_bf16 v[4:7], v[120:123], v[164:167], v[4:7]
    ds_read_b128 v[152:155], v235 offset:18432
    v_mfma_f32_16x16x32_bf16 v[8:11], v[120:123], v[168:171], v[8:11]
    ds_read_b128 v[156:159], v235 offset:19456
    v_mfma_f32_16x16x32_bf16 v[12:15], v[120:123], v[172:175], v[12:15]
    s_add_u32 m0, s19, 28800
    s_nop 0
    buffer_load_dwordx4 v228, s[8:11], s16 offen lds
    v_mfma_f32_16x16x32_bf16 v[48:51], v[132:135], v[160:163], v[48:51]
    ds_read_b64_tr_b16 v[96:97], v237 offset:28800
    v_mfma_f32_16x16x32_bf16 v[52:55], v[132:135], v[164:167], v[52:55]
    ds_read_b64_tr_b16 v[98:99], v237 offset:32384
    v_mfma_f32_16x16x32_bf16 v[56:59], v[132:135], v[168:171], v[56:59]
    ds_read_b64_tr_b16 v[108:109], v237 offset:43200
    v_mfma_f32_16x16x32_bf16 v[60:63], v[132:135], v[172:175], v[60:63]
    s_add_u32 m0, s19, 29824
    s_nop 0
    buffer_load_dwordx4 v229, s[8:11], s16 offen lds
    v_mfma_f32_16x16x32_bf16 v[16:19], v[124:127], v[160:163], v[16:19]
    ds_read_b64_tr_b16 v[110:111], v237 offset:46784
    v_mfma_f32_16x16x32_bf16 v[20:23], v[124:127], v[164:167], v[20:23]
    ds_read_b64_tr_b16 v[100:101], v237 offset:28832
    v_mfma_f32_16x16x32_bf16 v[24:27], v[124:127], v[168:171], v[24:27]
    ds_read_b64_tr_b16 v[102:103], v237 offset:32416
    v_mfma_f32_16x16x32_bf16 v[28:31], v[124:127], v[172:175], v[28:31]
    s_add_u32 m0, s19, 30848
    s_nop 0
    buffer_load_dwordx4 v230, s[8:11], s16 offen lds
    s_add_u32 s16, s16, 229376
    s_cmp_eq_u32 s16, s18
    s_cselect_b32 s16, s17, s16
    v_mfma_f32_16x16x32_bf16 v[64:67], v[136:139], v[160:163], v[64:67]
    ds_read_b64_tr_b16 v[112:113], v237 offset:43232
    v_mfma_f32_16x16x32_bf16 v[68:71], v[136:139], v[164:167], v[68:71]
    ds_read_b64_tr_b16 v[114:115], v237 offset:46816
    v_mfma_f32_16x16x32_bf16 v[72:75], v[136:139], v[168:171], v[72:75]
    ds_read_b64_tr_b16 v[104:105], v239 offset:28800
    v_mfma_f32_16x16x32_bf16 v[76:79], v[136:139], v[172:175], v[76:79]
    s_add_u32 m0, s23, 0
    s_nop 0
    buffer_load_dwordx4 v249, s[80:83], s20 offen sc1 lds
    v_mfma_f32_16x16x32_bf16 v[32:35], v[128:131], v[160:163], v[32:35]
    ds_read_b64_tr_b16 v[106:107], v239 offset:32384
    v_mfma_f32_16x16x32_bf16 v[36:39], v[128:131], v[164:167], v[36:39]
    ds_read_b64_tr_b16 v[116:117], v239 offset:43200
    v_mfma_f32_16x16x32_bf16 v[40:43], v[128:131], v[168:171], v[40:43]
    ds_read_b64_tr_b16 v[118:119], v239 offset:46784
    v_mfma_f32_16x16x32_bf16 v[44:47], v[128:131], v[172:175], v[44:47]
    s_add_u32 m0, s23, 0
    s_nop 0
    buffer_load_dwordx4 v249, s[80:83], s20 offen offset:1024 sc1 lds
    s_add_u32 s20, s20, 8192
    s_cmp_eq_u32 s20, s22
    s_cselect_b32 s20, s21, s20
    v_mfma_f32_16x16x32_bf16 v[80:83], v[140:143], v[160:163], v[80:83]
    buffer_load_dwordx4 v[192:195], v225, s[80:83], s26 offen offset:0 sc1
    v_mfma_f32_16x16x32_bf16 v[84:87], v[140:143], v[164:167], v[84:87]
    buffer_load_dwordx4 v[196:199], v225, s[80:83], s26 offen offset:2048 sc1
    s_add_u32 s26, s26, 4096
    v_mfma_f32_16x16x32_bf16 v[88:91], v[140:143], v[168:171], v[88:91]
    buffer_load_dwordx4 v[200:203], v225, s[80:83], s26 offen offset:0 sc1
    v_mfma_f32_16x16x32_bf16 v[92:95], v[140:143], v[172:175], v[92:95]
    buffer_load_dwordx4 v[204:207], v225, s[80:83], s26 offen offset:2048 sc1
    s_add_u32 s26, s26, 4096
    s_waitcnt vmcnt(13) lgkmcnt(0)
    s_barrier
    s_cmp_eq_u32 s75, 0
    s_cbranch_scc1 cf_546
cf_546_b:
    v_mfma_f32_16x16x32_bf16 v[0:3], v[96:99], v[144:147], v[0:3]
    ds_read_b128 v[160:163], v235 offset:24576
    ds_read_b128 v[164:167], v235 offset:25600
    v_mfma_f32_16x16x32_bf16 v[4:7], v[96:99], v[148:151], v[4:7]
    ds_read_b128 v[168:171], v235 offset:26624
    v_mfma_f32_16x16x32_bf16 v[8:11], v[96:99], v[152:155], v[8:11]
    ds_read_b128 v[172:175], v235 offset:27648
    v_mfma_f32_16x16x32_bf16 v[12:15], v[96:99], v[156:159], v[12:15]
    s_add_u32 m0, s19, 57600
    s_nop 0
    buffer_load_dwordx4 v228, s[8:11], s16 offen lds
    v_mfma_f32_16x16x32_bf16 v[48:51], v[108:111], v[144:147], v[48:51]
    ds_read_b64_tr_b16 v[120:121], v236 offset:0
    v_mfma_f32_16x16x32_bf16 v[52:55], v[108:111], v[148:151], v[52:55]
    ds_read_b64_tr_b16 v[122:123], v236 offset:3584
    v_mfma_f32_16x16x32_bf16 v[56:59], v[108:111], v[152:155], v[56:59]
    ds_read_b64_tr_b16 v[132:133], v236 offset:14400
    v_mfma_f32_16x16x32_bf16 v[60:63], v[108:111], v[156:159], v[60:63]
    s_add_u32 m0, s19, 58624
    s_nop 0
    buffer_load_dwordx4 v229, s[8:11], s16 offen lds
    v_mfma_f32_16x16x32_bf16 v[16:19], v[100:103], v[144:147], v[16:19]
    ds_read_b64_tr_b16 v[134:135], v236 offset:17984
    v_mfma_f32_16x16x32_bf16 v[20:23], v[100:103], v[148:151], v[20:23]
    ds_read_b64_tr_b16 v[124:125], v236 offset:32
    v_mfma_f32_16x16x32_bf16 v[24:27], v[100:103], v[152:155], v[24:27]
    ds_read_b64_tr_b16 v[126:127], v236 offset:3616
    v_mfma_f32_16x16x32_bf16 v[28:31], v[100:103], v[156:159], v[28:31]
    s_add_u32 m0, s19, 59648
    s_nop 0
    buffer_load_dwordx4 v230, s[8:11], s16 offen lds
    s_add_u32 s16, s16, 229376
    s_cmp_eq_u32 s16, s18
    s_cselect_b32 s16, s17, s16
    v_mfma_f32_16x16x32_bf16 v[64:67], v[112:115], v[144:147], v[64:67]
    ds_read_b64_tr_b16 v[136:137], v236 offset:14432
    v_mfma_f32_16x16x32_bf16 v[68:71], v[112:115], v[148:151], v[68:71]
    ds_read_b64_tr_b16 v[138:139], v236 offset:18016
    v_mfma_f32_16x16x32_bf16 v[72:75], v[112:115], v[152:155], v[72:75]
    ds_read_b64_tr_b16 v[128:129], v238 offset:0
    v_mfma_f32_16x16x32_bf16 v[76:79], v[112:115], v[156:159], v[76:79]
    s_add_u32 m0, s23, 8192
    s_nop 0
    buffer_load_dwordx4 v249, s[80:83], s20 offen sc1 lds
    v_mfma_f32_16x16x32_bf16 v[32:35], v[104:107], v[144:147], v[32:35]
    ds_read_b64_tr_b16 v[130:131], v238 offset:3584
    v_mfma_f32_16x16x32_bf16 v[36:39], v[104:107], v[148:151], v[36:39]
    ds_read_b64_tr_b16 v[140:141], v238 offset:14400
    v_mfma_f32_16x16x32_bf16 v[40:43], v[104:107], v[152:155], v[40:43]
    ds_read_b64_tr_b16 v[142:143], v238 offset:17984
    v_mfma_f32_16x16x32_bf16 v[44:47], v[104:107], v[156:159], v[44:47]
    s_add_u32 m0, s23, 8192
    s_nop 0
    buffer_load_dwordx4 v249, s[80:83], s20 offen offset:1024 sc1 lds
    s_add_u32 s20, s20, 8192
    s_cmp_eq_u32 s20, s22
    s_cselect_b32 s20, s21, s20
    v_mfma_f32_16x16x32_bf16 v[80:83], v[116:119], v[144:147], v[80:83]
    v_mfma_f32_16x16x32_bf16 v[84:87], v[116:119], v[148:151], v[84:87]
    v_mfma_f32_16x16x32_bf16 v[88:91], v[116:119], v[152:155], v[88:91]
    v_mfma_f32_16x16x32_bf16 v[92:95], v[116:119], v[156:159], v[92:95]
    s_waitcnt vmcnt(5) lgkmcnt(0)
    s_barrier
    v_mfma_f32_16x16x32_bf16 v[0:3], v[120:123], v[160:163], v[0:3]
    ds_read_b128 v[144:147], v235 offset:0
    ds_read_b128 v[148:151], v235 offset:1024
    v_pk_add_f32 v[176:177], v[176:177], v[192:193]
    v_pk_add_f32 v[178:179], v[178:179], v[194:195]
    v_mfma_f32_16x16x32_bf16 v[4:7], v[120:123], v[164:167], v[4:7]
    ds_read_b128 v[152:155], v235 offset:2048
    v_pk_add_f32 v[180:181], v[180:181], v[196:197]
    v_pk_add_f32 v[182:183], v[182:183], v[198:199]
    v_mfma_f32_16x16x32_bf16 v[8:11], v[120:123], v[168:171], v[8:11]
    ds_read_b128 v[156:159], v235 offset:3072
    v_pk_add_f32 v[184:185], v[184:185], v[200:201]
    v_pk_add_f32 v[186:187], v[186:187], v[202:203]
    v_mfma_f32_16x16x32_bf16 v[12:15], v[120:123], v[172:175], v[12:15]
    s_add_u32 m0, s19, 86400
    s_nop 0
    buffer_load_dwordx4 v228, s[8:11], s16 offen lds
    v_pk_add_f32 v[188:189], v[188:189], v[204:205]
    v_pk_add_f32 v[190:191], v[190:191], v[206:207]
    v_mfma_f32_16x16x32_bf16 v[48:51], v[132:135], v[160:163], v[48:51]
    ds_read_b64_tr_b16 v[96:97], v236 offset:28800
    v_pk_add_f32 v[176:177], v[176:177], v[184:185]
    v_pk_add_f32 v[178:179], v[178:179], v[186:187]
    v_mfma_f32_16x16x32_bf16 v[52:55], v[132:135], v[164:167], v[52:55]
    ds_read_b64_tr_b16 v[98:99], v236 offset:32384
    v_pk_add_f32 v[180:181], v[180:181], v[188:189]
    v_pk_add_f32 v[182:183], v[182:183], v[190:191]
    v_mfma_f32_16x16x32_bf16 v[56:59], v[132:135], v[168:171], v[56:59]
    ds_read_b64_tr_b16 v[108:109], v236 offset:43200
    v_pk_add_f32 v[176:177], v[176:177], v[180:181]
    v_pk_add_f32 v[178:179], v[178:179], v[182:183]
    v_mfma_f32_16x16x32_bf16 v[60:63], v[132:135], v[172:175], v[60:63]
    s_add_u32 m0, s19, 87424
    s_nop 0
    buffer_load_dwordx4 v229, s[8:11], s16 offen lds
    v_add_f32 v176, v176, v178
    v_add_f32 v177, v177, v179
    v_mfma_f32_16x16x32_bf16 v[16:19], v[124:127], v[160:163], v[16:19]
    ds_read_b64_tr_b16 v[110:111], v236 offset:46784
    v_mov_b32 v178, v176
    v_mov_b32 v179, v177
    v_mfma_f32_16x16x32_bf16 v[20:23], v[124:127], v[164:167], v[20:23]
    ds_read_b64_tr_b16 v[100:101], v236 offset:28832
    s_nop 1
    v_permlane32_swap_b32 v176, v178
    v_mfma_f32_16x16x32_bf16 v[24:27], v[124:127], v[168:171], v[24:27]
    ds_read_b64_tr_b16 v[102:103], v236 offset:32416
    v_permlane32_swap_b32 v177, v179
    v_add_f32 v176, v176, v178
    v_mfma_f32_16x16x32_bf16 v[28:31], v[124:127], v[172:175], v[28:31]
    s_add_u32 m0, s19, 88448
    s_nop 0
    buffer_load_dwordx4 v230, s[8:11], s16 offen lds
    s_add_u32 s16, s16, 229376
    s_cmp_eq_u32 s16, s18
    s_cselect_b32 s16, s17, s16
    v_add_f32 v177, v177, v179
    v_mfma_f32_16x16x32_bf16 v[64:67], v[136:139], v[160:163], v[64:67]
    ds_read_b64_tr_b16 v[112:113], v236 offset:43232
    v_mul_f32 v176, 0x3a800000, v176
    v_mul_f32 v177, 0x3a800000, v177
    v_mfma_f32_16x16x32_bf16 v[68:71], v[136:139], v[164:167], v[68:71]
    ds_read_b64_tr_b16 v[114:115], v236 offset:46816
    v_fma_f32 v177, -v176, v176, v177
    v_max_f32 v177, 0, v177
    v_mfma_f32_16x16x32_bf16 v[72:75], v[136:139], v[168:171], v[72:75]
    ds_read_b64_tr_b16 v[104:105], v238 offset:28800
    v_cvt_pk_bf16_f32 v176, v176, v176
    v_lshlrev_b32 v176, 16, v176
    v_mfma_f32_16x16x32_bf16 v[76:79], v[136:139], v[172:175], v[76:79]
    s_add_u32 m0, s23, 16384
    s_nop 0
    buffer_load_dwordx4 v249, s[80:83], s20 offen sc1 lds
    v_cvt_pk_bf16_f32 v177, v177, v177
    v_lshlrev_b32 v177, 16, v177
    v_mfma_f32_16x16x32_bf16 v[32:35], v[128:131], v[160:163], v[32:35]
    ds_read_b64_tr_b16 v[106:107], v238 offset:32384
    v_add_f32 v177, 0x3727c5ac, v177
    v_cvt_pk_bf16_f32 v177, v177, v177
    v_mfma_f32_16x16x32_bf16 v[36:39], v[128:131], v[164:167], v[36:39]
    ds_read_b64_tr_b16 v[116:117], v238 offset:43200
    v_lshlrev_b32 v177, 16, v177
    v_sqrt_f32 v177, v177
    v_mfma_f32_16x16x32_bf16 v[40:43], v[128:131], v[168:171], v[40:43]
    ds_read_b64_tr_b16 v[118:119], v238 offset:46784
    s_nop 0
    v_cvt_pk_bf16_f32 v177, v177, v177
    v_mfma_f32_16x16x32_bf16 v[44:47], v[128:131], v[172:175], v[44:47]
    s_add_u32 m0, s23, 16384
    s_nop 0
    buffer_load_dwordx4 v249, s[80:83], s20 offen offset:1024 sc1 lds
    s_add_u32 s20, s20, 8192
    s_cmp_eq_u32 s20, s22
    s_cselect_b32 s20, s21, s20
    v_lshlrev_b32 v177, 16, v177
    v_rcp_f32 v177, v177
    v_mfma_f32_16x16x32_bf16 v[80:83], v[140:143], v[160:163], v[80:83]
    s_nop 0
    v_and_b32 v225, 31, v250
    v_mfma_f32_16x16x32_bf16 v[84:87], v[140:143], v[164:167], v[84:87]
    s_lshl_b32 s64, s69, 8
    s_add_u32 s64, s64, 159744
    v_mfma_f32_16x16x32_bf16 v[88:91], v[140:143], v[168:171], v[88:91]
    v_lshlrev_b32 v225, 3, v225
    v_add_u32 v225, s64, v225
    v_mfma_f32_16x16x32_bf16 v[92:95], v[140:143], v[172:175], v[92:95]
    ds_write_b64 v225, v[176:177]
    s_mov_b32 s24, 4
    s_cmp_eq_u32 s75, 0
    s_cselect_b32 s27, 6, 0
    s_lshr_b32 s64, s69, 1
    s_lshl_b32 s64, 8, s64
    s_cmp_eq_u32 s75, 0
    s_cselect_b32 s64, s64, 0
    s_or_b32 s27, s27, s64
g3c1_loop:
    s_waitcnt vmcnt(5) lgkmcnt(0)
    s_barrier
    s_bitcmp1_b32 s27, s24
    s_cbranch_scc1 g3c1_hook
g3c1_hb:
    v_mfma_f32_16x16x32_bf16 v[0:3], v[96:99], v[144:147], v[0:3]
    ds_read_b128 v[160:163], v235 offset:8192
    ds_read_b128 v[164:167], v235 offset:9216
    v_mfma_f32_16x16x32_bf16 v[4:7], v[96:99], v[148:151], v[4:7]
    ds_read_b128 v[168:171], v235 offset:10240
    v_mfma_f32_16x16x32_bf16 v[8:11], v[96:99], v[152:155], v[8:11]
    ds_read_b128 v[172:175], v235 offset:11264
    v_mfma_f32_16x16x32_bf16 v[12:15], v[96:99], v[156:159], v[12:15]
    s_add_u32 m0, s19, 0
    s_nop 0
    buffer_load_dwordx4 v228, s[8:11], s16 offen lds
    v_mfma_f32_16x16x32_bf16 v[48:51], v[108:111], v[144:147], v[48:51]
    ds_read_b64_tr_b16 v[120:121], v237 offset:0
    v_mfma_f32_16x16x32_bf16 v[52:55], v[108:111], v[148:151], v[52:55]
    ds_read_b64_tr_b16 v[122:123], v237 offset:3584
    v_mfma_f32_16x16x32_bf16 v[56:59], v[108:111], v[152:155], v[56:59]
    ds_read_b64_tr_b16 v[132:133], v237 offset:14400
    v_mfma_f32_16x16x32_bf16 v[60:63], v[108:111], v[156:159], v[60:63]
    s_add_u32 m0, s19, 1024
    s_nop 0
    buffer_load_dwordx4 v229, s[8:11], s16 offen lds
    v_mfma_f32_16x16x32_bf16 v[16:19], v[100:103], v[144:147], v[16:19]
    ds_read_b64_tr_b16 v[134:135], v237 offset:17984
    v_mfma_f32_16x16x32_bf16 v[20:23], v[100:103], v[148:151], v[20:23]
    ds_read_b64_tr_b16 v[124:125], v237 offset:32
    v_mfma_f32_16x16x32_bf16 v[24:27], v[100:103], v[152:155], v[24:27]
    ds_read_b64_tr_b16 v[126:127], v237 offset:3616
    v_mfma_f32_16x16x32_bf16 v[28:31], v[100:103], v[156:159], v[28:31]
    s_add_u32 m0, s19, 2048
    s_nop 0
    buffer_load_dwordx4 v230, s[8:11], s16 offen lds
    s_add_u32 s16, s16, 229376
    s_cmp_eq_u32 s16, s18
    s_cselect_b32 s16, s17, s16
    v_mfma_f32_16x16x32_bf16 v[64:67], v[112:115], v[144:147], v[64:67]
    ds_read_b64_tr_b16 v[136:137], v237 offset:14432
    v_mfma_f32_16x16x32_bf16 v[68:71], v[112:115], v[148:151], v[68:71]
    ds_read_b64_tr_b16 v[138:139], v237 offset:18016
    v_mfma_f32_16x16x32_bf16 v[72:75], v[112:115], v[152:155], v[72:75]
    ds_read_b64_tr_b16 v[128:129], v239 offset:0
    v_mfma_f32_16x16x32_bf16 v[76:79], v[112:115], v[156:159], v[76:79]
    s_add_u32 m0, s23, 24576
    s_nop 0
    buffer_load_dwordx4 v249, s[80:83], s20 offen sc1 lds
    v_mfma_f32_16x16x32_bf16 v[32:35], v[104:107], v[144:147], v[32:35]
    ds_read_b64_tr_b16 v[130:131], v239 offset:3584
    v_mfma_f32_16x16x32_bf16 v[36:39], v[104:107], v[148:151], v[36:39]
    ds_read_b64_tr_b16 v[140:141], v239 offset:14400
    v_mfma_f32_16x16x32_bf16 v[40:43], v[104:107], v[152:155], v[40:43]
    ds_read_b64_tr_b16 v[142:143], v239 offset:17984
    v_mfma_f32_16x16x32_bf16 v[44:47], v[104:107], v[156:159], v[44:47]
    s_add_u32 m0, s23, 24576
    s_nop 0
    buffer_load_dwordx4 v249, s[80:83], s20 offen offset:1024 sc1 lds
    s_add_u32 s20, s20, 8192
    s_cmp_eq_u32 s20, s22
    s_cselect_b32 s20, s21, s20
    v_mfma_f32_16x16x32_bf16 v[80:83], v[116:119], v[144:147], v[80:83]
    v_mfma_f32_16x16x32_bf16 v[84:87], v[116:119], v[148:151], v[84:87]
    v_mfma_f32_16x16x32_bf16 v[88:91], v[116:119], v[152:155], v[88:91]
    v_mfma_f32_16x16x32_bf16 v[92:95], v[116:119], v[156:159], v[92:95]
    s_waitcnt vmcnt(5) lgkmcnt(0)
    s_barrier
    v_mfma_f32_16x16x32_bf16 v[0:3], v[120:123], v[160:163], v[0:3]
    ds_read_b128 v[144:147], v235 offset:16384
    ds_read_b128 v[148:151], v235 offset:17408
    v_mfma_f32_16x16x32_bf16 v[4:7], v[120:123], v[164:167], v[4:7]
    ds_read_b128 v[152:155], v235 offset:18432
    v_mfma_f32_16x16x32_bf16 v[8:11], v[120:123], v[168:171], v[8:11]
    ds_read_b128 v[156:159], v235 offset:19456
    v_mfma_f32_16x16x32_bf16 v[12:15], v[120:123], v[172:175], v[12:15]
    s_add_u32 m0, s19, 28800
    s_nop 0
    buffer_load_dwordx4 v228, s[8:11], s16 offen lds
    v_mfma_f32_16x16x32_bf16 v[48:51], v[132:135], v[160:163], v[48:51]
    ds_read_b64_tr_b16 v[96:97], v237 offset:28800
    v_mfma_f32_16x16x32_bf16 v[52:55], v[132:135], v[164:167], v[52:55]
    ds_read_b64_tr_b16 v[98:99], v237 offset:32384
    v_mfma_f32_16x16x32_bf16 v[56:59], v[132:135], v[168:171], v[56:59]
    ds_read_b64_tr_b16 v[108:109], v237 offset:43200
    v_mfma_f32_16x16x32_bf16 v[60:63], v[132:135], v[172:175], v[60:63]
    s_add_u32 m0, s19, 29824
    s_nop 0
    buffer_load_dwordx4 v229, s[8:11], s16 offen lds
    v_mfma_f32_16x16x32_bf16 v[16:19], v[124:127], v[160:163], v[16:19]
    ds_read_b64_tr_b16 v[110:111], v237 offset:46784
    v_mfma_f32_16x16x32_bf16 v[20:23], v[124:127], v[164:167], v[20:23]
    ds_read_b64_tr_b16 v[100:101], v237 offset:28832
    v_mfma_f32_16x16x32_bf16 v[24:27], v[124:127], v[168:171], v[24:27]
    ds_read_b64_tr_b16 v[102:103], v237 offset:32416
    v_mfma_f32_16x16x32_bf16 v[28:31], v[124:127], v[172:175], v[28:31]
    s_add_u32 m0, s19, 30848
    s_nop 0
    buffer_load_dwordx4 v230, s[8:11], s16 offen lds
    s_add_u32 s16, s16, 229376
    s_cmp_eq_u32 s16, s18
    s_cselect_b32 s16, s17, s16
    v_mfma_f32_16x16x32_bf16 v[64:67], v[136:139], v[160:163], v[64:67]
    ds_read_b64_tr_b16 v[112:113], v237 offset:43232
    v_mfma_f32_16x16x32_bf16 v[68:71], v[136:139], v[164:167], v[68:71]
    ds_read_b64_tr_b16 v[114:115], v237 offset:46816
    v_mfma_f32_16x16x32_bf16 v[72:75], v[136:139], v[168:171], v[72:75]
    ds_read_b64_tr_b16 v[104:105], v239 offset:28800
    v_mfma_f32_16x16x32_bf16 v[76:79], v[136:139], v[172:175], v[76:79]
    s_add_u32 m0, s23, 0
    s_nop 0
    buffer_load_dwordx4 v249, s[80:83], s20 offen sc1 lds
    v_mfma_f32_16x16x32_bf16 v[32:35], v[128:131], v[160:163], v[32:35]
    ds_read_b64_tr_b16 v[106:107], v239 offset:32384
    v_mfma_f32_16x16x32_bf16 v[36:39], v[128:131], v[164:167], v[36:39]
    ds_read_b64_tr_b16 v[116:117], v239 offset:43200
    v_mfma_f32_16x16x32_bf16 v[40:43], v[128:131], v[168:171], v[40:43]
    ds_read_b64_tr_b16 v[118:119], v239 offset:46784
    v_mfma_f32_16x16x32_bf16 v[44:47], v[128:131], v[172:175], v[44:47]
    s_add_u32 m0, s23, 0
    s_nop 0
    buffer_load_dwordx4 v249, s[80:83], s20 offen offset:1024 sc1 lds
    s_add_u32 s20, s20, 8192
    s_cmp_eq_u32 s20, s22
    s_cselect_b32 s20, s21, s20
    v_mfma_f32_16x16x32_bf16 v[80:83], v[140:143], v[160:163], v[80:83]
    v_mfma_f32_16x16x32_bf16 v[84:87], v[140:143], v[164:167], v[84:87]
    v_mfma_f32_16x16x32_bf16 v[88:91], v[140:143], v[168:171], v[88:91]
    v_mfma_f32_16x16x32_bf16 v[92:95], v[140:143], v[172:175], v[92:95]
    s_waitcnt vmcnt(5) lgkmcnt(0)
    s_barrier
    v_mfma_f32_16x16x32_bf16 v[0:3], v[96:99], v[144:147], v[0:3]
    ds_read_b128 v[160:163], v235 offset:24576
    ds_read_b128 v[164:167], v235 offset:25600
    v_mfma_f32_16x16x32_bf16 v[4:7], v[96:99], v[148:151], v[4:7]
    ds_read_b128 v[168:171], v235 offset:26624
    v_mfma_f32_16x16x32_bf16 v[8:11], v[96:99], v[152:155], v[8:11]
    ds_read_b128 v[172:175], v235 offset:27648
    v_mfma_f32_16x16x32_bf16 v[12:15], v[96:99], v[156:159], v[12:15]
    s_add_u32 m0, s19, 57600
    s_nop 0
    buffer_load_dwordx4 v228, s[8:11], s16 offen lds
    v_mfma_f32_16x16x32_bf16 v[48:51], v[108:111], v[144:147], v[48:51]
    ds_read_b64_tr_b16 v[120:121], v236 offset:0
    v_mfma_f32_16x16x32_bf16 v[52:55], v[108:111], v[148:151], v[52:55]
    ds_read_b64_tr_b16 v[122:123], v236 offset:3584
    v_mfma_f32_16x16x32_bf16 v[56:59], v[108:111], v[152:155], v[56:59]
    ds_read_b64_tr_b16 v[132:133], v236 offset:14400
    v_mfma_f32_16x16x32_bf16 v[60:63], v[108:111], v[156:159], v[60:63]
    s_add_u32 m0, s19, 58624
    s_nop 0
    buffer_load_dwordx4 v229, s[8:11], s16 offen lds
    v_mfma_f32_16x16x32_bf16 v[16:19], v[100:103], v[144:147], v[16:19]
    ds_read_b64_tr_b16 v[134:135], v236 offset:17984
    v_mfma_f32_16x16x32_bf16 v[20:23], v[100:103], v[148:151], v[20:23]
    ds_read_b64_tr_b16 v[124:125], v236 offset:32
    v_mfma_f32_16x16x32_bf16 v[24:27], v[100:103], v[152:155], v[24:27]
    ds_read_b64_tr_b16 v[126:127], v236 offset:3616
    v_mfma_f32_16x16x32_bf16 v[28:31], v[100:103], v[156:159], v[28:31]
    s_add_u32 m0, s19, 59648
    s_nop 0
    buffer_load_dwordx4 v230, s[8:11], s16 offen lds
    s_add_u32 s16, s16, 229376
    s_cmp_eq_u32 s16, s18
    s_cselect_b32 s16, s17, s16
    v_mfma_f32_16x16x32_bf16 v[64:67], v[112:115], v[144:147], v[64:67]
    ds_read_b64_tr_b16 v[136:137], v236 offset:14432
    v_mfma_f32_16x16x32_bf16 v[68:71], v[112:115], v[148:151], v[68:71]
    ds_read_b64_tr_b16 v[138:139], v236 offset:18016
    v_mfma_f32_16x16x32_bf16 v[72:75], v[112:115], v[152:155], v[72:75]
    ds_read_b64_tr_b16 v[128:129], v238 offset:0
    v_mfma_f32_16x16x32_bf16 v[76:79], v[112:115], v[156:159], v[76:79]
    s_add_u32 m0, s23, 8192
    s_nop 0
    buffer_load_dwordx4 v249, s[80:83], s20 offen sc1 lds
    v_mfma_f32_16x16x32_bf16 v[32:35], v[104:107], v[144:147], v[32:35]
    ds_read_b64_tr_b16 v[130:131], v238 offset:3584
    v_mfma_f32_16x16x32_bf16 v[36:39], v[104:107], v[148:151], v[36:39]
    ds_read_b64_tr_b16 v[140:141], v238 offset:14400
    v_mfma_f32_16x16x32_bf16 v[40:43], v[104:107], v[152:155], v[40:43]
    ds_read_b64_tr_b16 v[142:143], v238 offset:17984
    v_mfma_f32_16x16x32_bf16 v[44:47], v[104:107], v[156:159], v[44:47]
    s_add_u32 m0, s23, 8192
    s_nop 0
    buffer_load_dwordx4 v249, s[80:83], s20 offen offset:1024 sc1 lds
    s_add_u32 s20, s20, 8192
    s_cmp_eq_u32 s20, s22
    s_cselect_b32 s20, s21, s20
    v_mfma_f32_16x16x32_bf16 v[80:83], v[116:119], v[144:147], v[80:83]
    v_mfma_f32_16x16x32_bf16 v[84:87], v[116:119], v[148:151], v[84:87]
    v_mfma_f32_16x16x32_bf16 v[88:91], v[116:119], v[152:155], v[88:91]
    v_mfma_f32_16x16x32_bf16 v[92:95], v[116:119], v[156:159], v[92:95]
    s_waitcnt vmcnt(5) lgkmcnt(0)
    s_barrier
    v_mfma_f32_16x16x32_bf16 v[0:3], v[120:123], v[160:163], v[0:3]
    ds_read_b128 v[144:147], v235 offset:0
    ds_read_b128 v[148:151], v235 offset:1024
    v_mfma_f32_16x16x32_bf16 v[4:7], v[120:123], v[164:167], v[4:7]
    ds_read_b128 v[152:155], v235 offset:2048
    v_mfma_f32_16x16x32_bf16 v[8:11], v[120:123], v[168:171], v[8:11]
    ds_read_b128 v[156:159], v235 offset:3072
    v_mfma_f32_16x16x32_bf16 v[12:15], v[120:123], v[172:175], v[12:15]
    s_add_u32 m0, s19, 86400
    s_nop 0
    buffer_load_dwordx4 v228, s[8:11], s16 offen lds
    v_mfma_f32_16x16x32_bf16 v[48:51], v[132:135], v[160:163], v[48:51]
    ds_read_b64_tr_b16 v[96:97], v236 offset:28800
    v_mfma_f32_16x16x32_bf16 v[52:55], v[132:135], v[164:167], v[52:55]
    ds_read_b64_tr_b16 v[98:99], v236 offset:32384
    v_mfma_f32_16x16x32_bf16 v[56:59], v[132:135], v[168:171], v[56:59]
    ds_read_b64_tr_b16 v[108:109], v236 offset:43200
    v_mfma_f32_16x16x32_bf16 v[60:63], v[132:135], v[172:175], v[60:63]
    s_add_u32 m0, s19, 87424
    s_nop 0
    buffer_load_dwordx4 v229, s[8:11], s16 offen lds
    v_mfma_f32_16x16x32_bf16 v[16:19], v[124:127], v[160:163], v[16:19]
    ds_read_b64_tr_b16 v[110:111], v236 offset:46784
    v_mfma_f32_16x16x32_bf16 v[20:23], v[124:127], v[164:167], v[20:23]
    ds_read_b64_tr_b16 v[100:101], v236 offset:28832
    v_mfma_f32_16x16x32_bf16 v[24:27], v[124:127], v[168:171], v[24:27]
    ds_read_b64_tr_b16 v[102:103], v236 offset:32416
    v_mfma_f32_16x16x32_bf16 v[28:31], v[124:127], v[172:175], v[28:31]
    s_add_u32 m0, s19, 88448
    s_nop 0
    buffer_load_dwordx4 v230, s[8:11], s16 offen lds
    s_add_u32 s16, s16, 229376
    s_cmp_eq_u32 s16, s18
    s_cselect_b32 s16, s17, s16
    v_mfma_f32_16x16x32_bf16 v[64:67], v[136:139], v[160:163], v[64:67]
    ds_read_b64_tr_b16 v[112:113], v236 offset:43232
    v_mfma_f32_16x16x32_bf16 v[68:71], v[136:139], v[164:167], v[68:71]
    ds_read_b64_tr_b16 v[114:115], v236 offset:46816
    v_mfma_f32_16x16x32_bf16 v[72:75], v[136:139], v[168:171], v[72:75]
    ds_read_b64_tr_b16 v[104:105], v238 offset:28800
    v_mfma_f32_16x16x32_bf16 v[76:79], v[136:139], v[172:175], v[76:79]
    s_add_u32 m0, s23, 16384
    s_nop 0
    buffer_load_dwordx4 v249, s[80:83], s20 offen sc1 lds
    v_mfma_f32_16x16x32_bf16 v[32:35], v[128:131], v[160:163], v[32:35]
    ds_read_b64_tr_b16 v[106:107], v238 offset:32384
    v_mfma_f32_16x16x32_bf16 v[36:39], v[128:131], v[164:167], v[36:39]
    ds_read_b64_tr_b16 v[116:117], v238 offset:43200
    v_mfma_f32_16x16x32_bf16 v[40:43], v[128:131], v[168:171], v[40:43]
    ds_read_b64_tr_b16 v[118:119], v238 offset:46784
    v_mfma_f32_16x16x32_bf16 v[44:47], v[128:131], v[172:175], v[44:47]
    s_add_u32 m0, s23, 16384
    s_nop 0
    buffer_load_dwordx4 v249, s[80:83], s20 offen offset:1024 sc1 lds
    s_add_u32 s20, s20, 8192
    s_cmp_eq_u32 s20, s22
    s_cselect_b32 s20, s21, s20
    v_mfma_f32_16x16x32_bf16 v[80:83], v[140:143], v[160:163], v[80:83]
    v_mfma_f32_16x16x32_bf16 v[84:87], v[140:143], v[164:167], v[84:87]
    v_mfma_f32_16x16x32_bf16 v[88:91], v[140:143], v[168:171], v[88:91]
    v_mfma_f32_16x16x32_bf16 v[92:95], v[140:143], v[172:175], v[92:95]
    s_sub_u32 s24, s24, 1
    s_cmp_lg_u32 s24, 0
    s_cbranch_scc1 g3c1_loop
    s_sub_u32 s27, s74, s58
    s_and_b32 s27, s27, 7
    s_cmp_lt_u32 s27, 8
    s_cselect_b32 s27, 14, 0
    s_waitcnt vmcnt(5) lgkmcnt(0)
    s_barrier
    v_mfma_f32_16x16x32_bf16 v[0:3], v[96:99], v[144:147], v[0:3]
    ds_read_b128 v[160:163], v235 offset:8192
    ds_read_b128 v[164:167], v235 offset:9216
    v_pk_add_f32 v[176:177], v[176:177], v[192:193]
    v_pk_add_f32 v[178:179], v[178:179], v[194:195]
    v_mfma_f32_16x16x32_bf16 v[4:7], v[96:99], v[148:151], v[4:7]
    ds_read_b128 v[168:171], v235 offset:10240
    v_pk_add_f32 v[180:181], v[180:181], v[196:197]
    v_mfma_f32_16x16x32_bf16 v[8:11], v[96:99], v[152:155], v[8:11]
    ds_read_b128 v[172:175], v235 offset:11264
    v_pk_add_f32 v[182:183], v[182:183], v[198:199]
    v_mfma_f32_16x16x32_bf16 v[12:15], v[96:99], v[156:159], v[12:15]
    s_add_u32 m0, s19, 0
    s_nop 0
    buffer_load_dwordx4 v228, s[8:11], s16 offen lds
    v_pk_add_f32 v[184:185], v[184:185], v[200:201]
    v_mfma_f32_16x16x32_bf16 v[48:51], v[108:111], v[144:147], v[48:51]
    ds_read_b64_tr_b16 v[120:121], v237 offset:0
    v_pk_add_f32 v[186:187], v[186:187], v[202:203]
    v_mfma_f32_16x16x32_bf16 v[52:55], v[108:111], v[148:151], v[52:55]
    ds_read_b64_tr_b16 v[122:123], v237 offset:3584
    v_pk_add_f32 v[188:189], v[188:189], v[204:205]
    v_mfma_f32_16x16x32_bf16 v[56:59], v[108:111], v[152:155], v[56:59]
    ds_read_b64_tr_b16 v[132:133], v237 offset:14400
    v_pk_add_f32 v[190:191], v[190:191], v[206:207]
    v_pk_add_f32 v[176:177], v[176:177], v[184:185]
    v_mfma_f32_16x16x32_bf16 v[60:63], v[108:111], v[156:159], v[60:63]
    s_add_u32 m0, s19, 1024
    s_nop 0
    buffer_load_dwordx4 v229, s[8:11], s16 offen lds
    v_pk_add_f32 v[178:179], v[178:179], v[186:187]
    v_mfma_f32_16x16x32_bf16 v[16:19], v[100:103], v[144:147], v[16:19]
    ds_read_b64_tr_b16 v[134:135], v237 offset:17984
    v_pk_add_f32 v[180:181], v[180:181], v[188:189]
    v_mfma_f32_16x16x32_bf16 v[20:23], v[100:103], v[148:151], v[20:23]
    ds_read_b64_tr_b16 v[124:125], v237 offset:32
    v_pk_add_f32 v[182:183], v[182:183], v[190:191]
    v_mfma_f32_16x16x32_bf16 v[24:27], v[100:103], v[152:155], v[24:27]
    ds_read_b64_tr_b16 v[126:127], v237 offset:3616
    v_pk_add_f32 v[176:177], v[176:177], v[180:181]
    v_mfma_f32_16x16x32_bf16 v[28:31], v[100:103], v[156:159], v[28:31]
    s_add_u32 m0, s19, 2048
    s_nop 0
    buffer_load_dwordx4 v230, s[8:11], s16 offen lds
    s_add_u32 s16, s16, 229376
    s_cmp_eq_u32 s16, s18
    s_cselect_b32 s16, s17, s16
    v_pk_add_f32 v[178:179], v[178:179], v[182:183]
    v_mfma_f32_16x16x32_bf16 v[64:67], v[112:115], v[144:147], v[64:67]
    ds_read_b64_tr_b16 v[136:137], v237 offset:14432
    v_mov_b32 v180, v176
    v_mov_b32 v181, v177
    v_mfma_f32_16x16x32_bf16 v[68:71], v[112:115], v[148:151], v[68:71]
    ds_read_b64_tr_b16 v[138:139], v237 offset:18016
    v_mov_b32 v182, v178
    v_mfma_f32_16x16x32_bf16 v[72:75], v[112:115], v[152:155], v[72:75]
    ds_read_b64_tr_b16 v[128:129], v239 offset:0
    v_mov_b32 v183, v179
    v_mfma_f32_16x16x32_bf16 v[76:79], v[112:115], v[156:159], v[76:79]
    s_add_u32 m0, s23, 24576
    s_nop 0
    buffer_load_dwordx4 v249, s[80:83], s20 offen sc1 lds
    s_nop 1
    v_mfma_f32_16x16x32_bf16 v[32:35], v[104:107], v[144:147], v[32:35]
    ds_read_b64_tr_b16 v[130:131], v239 offset:3584
    v_permlane32_swap_b32 v176, v180
    v_mfma_f32_16x16x32_bf16 v[36:39], v[104:107], v[148:151], v[36:39]
    ds_read_b64_tr_b16 v[140:141], v239 offset:14400
    v_permlane32_swap_b32 v177, v181
    v_mfma_f32_16x16x32_bf16 v[40:43], v[104:107], v[152:155], v[40:43]
    ds_read_b64_tr_b16 v[142:143], v239 offset:17984
    v_permlane32_swap_b32 v178, v182
    v_permlane32_swap_b32 v179, v183
    v_mfma_f32_16x16x32_bf16 v[44:47], v[104:107], v[156:159], v[44:47]
    s_add_u32 m0, s23, 24576
    s_nop 0
    buffer_load_dwordx4 v249, s[80:83], s20 offen offset:1024 sc1 lds
    s_add_u32 s20, s20, 8192
    s_cmp_eq_u32 s20, s22
    s_cselect_b32 s20, s21, s20
    v_add_f32 v176, v176, v180
    v_mfma_f32_16x16x32_bf16 v[80:83], v[116:119], v[144:147], v[80:83]
    v_add_f32 v177, v177, v181
    v_mfma_f32_16x16x32_bf16 v[84:87], v[116:119], v[148:151], v[84:87]
    v_add_f32 v178, v178, v182
    v_mfma_f32_16x16x32_bf16 v[88:91], v[116:119], v[152:155], v[88:91]
    v_add_f32 v179, v179, v183
    v_mfma_f32_16x16x32_bf16 v[92:95], v[116:119], v[156:159], v[92:95]
    s_and_b32 s64, s3, 1
    s_mul_i32 s64, s64, 896
    s_lshr_b32 s65, s69, 1
    s_mul_i32 s65, s65, 448
    s_add_u32 s64, s64, s65
    s_add_u32 s64, s64, 160896
    v_add_u32 v225, s64, v249
    s_cmp_lg_u32 s75, 0
    s_cbranch_scc1 g3c1_ncs
    s_mov_b64 exec, 0x0fffffff
    ds_write_b128 v225, v[176:179]
    s_mov_b64 exec, -1
g3c1_ncs:
    s_waitcnt vmcnt(5) lgkmcnt(0)
    s_barrier
    v_mfma_f32_16x16x32_bf16 v[0:3], v[120:123], v[160:163], v[0:3]
    ds_read_b128 v[144:147], v235 offset:16384
    s_mov_b32 s12, s96
    v_mfma_f32_16x16x32_bf16 v[4:7], v[120:123], v[164:167], v[4:7]
    ds_read_b128 v[148:151], v235 offset:17408
    s_mov_b32 s13, s97
    v_mfma_f32_16x16x32_bf16 v[8:11], v[120:123], v[168:171], v[8:11]
    ds_read_b128 v[152:155], v235 offset:18432
    s_mov_b32 s14, 7340032
    v_mfma_f32_16x16x32_bf16 v[12:15], v[120:123], v[172:175], v[12:15]
    ds_read_b128 v[156:159], v235 offset:19456
    s_mov_b32 s15, 0x00020000
    v_mfma_f32_16x16x32_bf16 v[48:51], v[132:135], v[160:163], v[48:51]
    v_mfma_f32_16x16x32_bf16 v[52:55], v[132:135], v[164:167], v[52:55]
    ds_read_b64_tr_b16 v[96:97], v237 offset:28800
    v_lshlrev_b32 v253, 14, v251
    v_mfma_f32_16x16x32_bf16 v[56:59], v[132:135], v[168:171], v[56:59]
    ds_read_b64_tr_b16 v[98:99], v237 offset:32384
    v_and_b32 v254, 8, v252
    v_lshlrev_b32 v247, 7, v250
    s_add_u32 s29, s3, 0
    s_lshl_b32 s30, s29, 12
    s_add_u32 s30, s30, s25
    s_cmp_lt_u32 s29, s27
    s_cselect_b32 s30, s30, 0x7f000000
    s_mov_b64 exec, 0xffffffff
    buffer_load_dword v248, v247, s[80:83], s30 offen sc1
    s_mov_b64 exec, -1
    v_mfma_f32_16x16x32_bf16 v[60:63], v[132:135], v[172:175], v[60:63]
    ds_read_b64_tr_b16 v[108:109], v237 offset:43200
    v_lshl_add_u32 v253, v254, 7, v253
    v_mfma_f32_16x16x32_bf16 v[16:19], v[124:127], v[160:163], v[16:19]
    ds_read_b64_tr_b16 v[110:111], v237 offset:46784
    v_and_b32 v254, 7, v252
    v_mfma_f32_16x16x32_bf16 v[20:23], v[124:127], v[164:167], v[20:23]
    v_mfma_f32_16x16x32_bf16 v[24:27], v[124:127], v[168:171], v[24:27]
    ds_read_b64_tr_b16 v[100:101], v237 offset:28832
    v_lshl_add_u32 v253, v254, 4, v253
    v_mfma_f32_16x16x32_bf16 v[28:31], v[124:127], v[172:175], v[28:31]
    ds_read_b64_tr_b16 v[102:103], v237 offset:32416
    s_lshl_b32 s64, s69, 12
    v_mfma_f32_16x16x32_bf16 v[64:67], v[136:139], v[160:163], v[64:67]
    ds_read_b64_tr_b16 v[112:113], v237 offset:43232
    v_add_u32 v244, s64, v253
    v_mfma_f32_16x16x32_bf16 v[68:71], v[136:139], v[164:167], v[68:71]
    ds_read_b64_tr_b16 v[114:115], v237 offset:46816
    v_add_u32 v245, 2048, v244
    v_mfma_f32_16x16x32_bf16 v[72:75], v[136:139], v[168:171], v[72:75]
    v_mfma_f32_16x16x32_bf16 v[76:79], v[136:139], v[172:175], v[76:79]
    ds_read_b64_tr_b16 v[104:105], v239 offset:28800
    s_mul_i32 s51, s69, 2112
    v_mfma_f32_16x16x32_bf16 v[32:35], v[128:131], v[160:163], v[32:35]
    ds_read_b64_tr_b16 v[106:107], v239 offset:32384
    s_lshr_b32 s64, s74, 3
    v_mfma_f32_16x16x32_bf16 v[36:39], v[128:131], v[164:167], v[36:39]
    ds_read_b64_tr_b16 v[116:117], v239 offset:43200
    s_mul_i32 s49, s64, 3670016
    v_mfma_f32_16x16x32_bf16 v[40:43], v[128:131], v[168:171], v[40:43]
    ds_read_b64_tr_b16 v[118:119], v239 offset:46784
    s_lshl_b32 s65, s61, 7
    v_mfma_f32_16x16x32_bf16 v[44:47], v[128:131], v[172:175], v[44:47]
    v_mfma_f32_16x16x32_bf16 v[80:83], v[140:143], v[160:163], v[80:83]
    s_add_u32 s49, s49, s65
    v_lshlrev_b32 v247, 7, v250
    s_add_u32 s29, s3, 8
    s_lshl_b32 s30, s29, 12
    s_add_u32 s30, s30, s25
    s_cmp_lt_u32 s29, s27
    s_cselect_b32 s30, s30, 0x7f000000
    s_mov_b64 exec, 0xffffffff
    buffer_load_dword v248, v247, s[80:83], s30 offen sc1
    s_mov_b64 exec, -1
    v_mfma_f32_16x16x32_bf16 v[84:87], v[140:143], v[164:167], v[84:87]
    s_sub_u32 s50, s74, s58
    v_mfma_f32_16x16x32_bf16 v[88:91], v[140:143], v[168:171], v[88:91]
    s_and_b32 s50, s50, 7
    v_mfma_f32_16x16x32_bf16 v[92:95], v[140:143], v[172:175], v[92:95]
    s_waitcnt vmcnt(2) lgkmcnt(0)
    s_barrier
    s_setprio 1
    ds_read_b128 v[160:163], v235 offset:24576
    ds_read_b128 v[164:167], v235 offset:25600
    ds_read_b128 v[168:171], v235 offset:26624
    ds_read_b128 v[172:175], v235 offset:27648
    ds_read_b64_tr_b16 v[120:121], v236 offset:0
    ds_read_b64_tr_b16 v[122:123], v236 offset:3584
    ds_read_b64_tr_b16 v[132:133], v236 offset:14400
    ds_read_b64_tr_b16 v[134:135], v236 offset:17984
    ds_read_b64_tr_b16 v[124:125], v236 offset:32
    ds_read_b64_tr_b16 v[126:127], v236 offset:3616
    ds_read_b64_tr_b16 v[136:137], v236 offset:14432
    ds_read_b64_tr_b16 v[138:139], v236 offset:18016
    ds_read_b64_tr_b16 v[128:129], v238 offset:0
    ds_read_b64_tr_b16 v[130:131], v238 offset:3584
    ds_read_b64_tr_b16 v[140:141], v238 offset:14400
    ds_read_b64_tr_b16 v[142:143], v238 offset:17984
    s_waitcnt lgkmcnt(0)
    s_and_b32 s48, s74, 7
    s_mul_i32 s48, s48, 458752
    s_add_u32 s48, s48, s49
    s_add_u32 m0, s51, 107776
    s_nop 0
    buffer_load_dwordx4 v244, s[12:15], s48 offen lds
    s_add_u32 m0, s51, 108832
    s_nop 0
    buffer_load_dwordx4 v245, s[12:15], s48 offen lds
    s_add_u32 s48, s48, 65536
    s_barrier
    s_add_u32 m0, s51, 116224
    s_nop 0
    buffer_load_dwordx4 v244, s[12:15], s48 offen lds
    s_add_u32 m0, s51, 117280
    s_nop 0
    buffer_load_dwordx4 v245, s[12:15], s48 offen lds
    s_add_u32 s48, s48, 65536
    s_add_u32 m0, s51, 124672
    s_nop 0
    buffer_load_dwordx4 v244, s[12:15], s48 offen lds
    s_add_u32 m0, s51, 125728
    s_nop 0
    buffer_load_dwordx4 v245, s[12:15], s48 offen lds
    s_add_u32 s48, s48, 65536
    s_add_u32 m0, s51, 133120
    s_nop 0
    buffer_load_dwordx4 v244, s[12:15], s48 offen lds
    s_add_u32 m0, s51, 134176
    s_nop 0
    buffer_load_dwordx4 v245, s[12:15], s48 offen lds
    s_add_u32 s48, s48, 65536
    v_mfma_f32_16x16x32_bf16 v[0:3], v[96:99], v[144:147], v[0:3]
    s_add_u32 m0, s51, 141568
    s_nop 0
    buffer_load_dwordx4 v244, s[12:15], s48 offen lds
    v_mfma_f32_16x16x32_bf16 v[4:7], v[96:99], v[148:151], v[4:7]
    v_mfma_f32_16x16x32_bf16 v[8:11], v[96:99], v[152:155], v[8:11]
    v_mfma_f32_16x16x32_bf16 v[12:15], v[96:99], v[156:159], v[12:15]
    v_mfma_f32_16x16x32_bf16 v[48:51], v[108:111], v[144:147], v[48:51]
    s_add_u32 m0, s51, 142624
    s_nop 0
    buffer_load_dwordx4 v245, s[12:15], s48 offen lds
    s_add_u32 s48, s48, 65536
    v_mfma_f32_16x16x32_bf16 v[52:55], v[108:111], v[148:151], v[52:55]
    v_mfma_f32_16x16x32_bf16 v[56:59], v[108:111], v[152:155], v[56:59]
    v_mfma_f32_16x16x32_bf16 v[60:63], v[108:111], v[156:159], v[60:63]
    v_mfma_f32_16x16x32_bf16 v[16:19], v[100:103], v[144:147], v[16:19]
    s_add_u32 m0, s51, 65536
    s_nop 0
    buffer_load_dwordx4 v244, s[12:15], s48 offen lds
    v_mfma_f32_16x16x32_bf16 v[20:23], v[100:103], v[148:151], v[20:23]
    v_mfma_f32_16x16x32_bf16 v[24:27], v[100:103], v[152:155], v[24:27]
    v_mfma_f32_16x16x32_bf16 v[28:31], v[100:103], v[156:159], v[28:31]
    v_mfma_f32_16x16x32_bf16 v[64:67], v[112:115], v[144:147], v[64:67]
    s_add_u32 m0, s51, 66592
    s_nop 0
    buffer_load_dwordx4 v245, s[12:15], s48 offen lds
    s_add_u32 s48, s48, 65536
    v_mfma_f32_16x16x32_bf16 v[68:71], v[112:115], v[148:151], v[68:71]
    v_mfma_f32_16x16x32_bf16 v[72:75], v[112:115], v[152:155], v[72:75]
    v_mfma_f32_16x16x32_bf16 v[76:79], v[112:115], v[156:159], v[76:79]
    v_mfma_f32_16x16x32_bf16 v[32:35], v[104:107], v[144:147], v[32:35]
    s_add_u32 m0, s51, 73984
    s_nop 0
    buffer_load_dwordx4 v244, s[12:15], s48 offen lds
    v_mfma_f32_16x16x32_bf16 v[36:39], v[104:107], v[148:151], v[36:39]
    v_mfma_f32_16x16x32_bf16 v[40:43], v[104:107], v[152:155], v[40:43]
    v_mfma_f32_16x16x32_bf16 v[44:47], v[104:107], v[156:159], v[44:47]
    v_mfma_f32_16x16x32_bf16 v[80:83], v[116:119], v[144:147], v[80:83]
    s_add_u32 m0, s51, 75040
    s_nop 0
    buffer_load_dwordx4 v245, s[12:15], s48 offen lds
    s_add_u32 s48, s48, 65536
    v_mfma_f32_16x16x32_bf16 v[84:87], v[116:119], v[148:151], v[84:87]
    v_mfma_f32_16x16x32_bf16 v[88:91], v[116:119], v[152:155], v[88:91]
    v_mfma_f32_16x16x32_bf16 v[92:95], v[116:119], v[156:159], v[92:95]
    s_and_b32 s64, s3, 1
    s_lshl_b32 s64, s64, 9
    s_add_u32 s64, s64, 159744
    v_lshlrev_b32 v253, 3, v252
    v_add_u32 v253, s64, v253
    s_lshl_b32 s64, s28, 6
    s_add_u32 s64, s64, 160896
    v_lshlrev_b32 v254, 4, v251
    v_add_u32 v235, s64, v254
    s_lshr_b32 s64, s69, 1
    s_add_u32 s64, s64, 10
    s_lshl_b32 s64, s64, 6
    s_add_u32 s64, s64, 160896
    v_add_u32 v238, s64, v254
    v_mfma_f32_16x16x32_bf16 v[0:3], v[120:123], v[160:163], v[0:3]
    ds_read_b64 v[144:145], v253 offset:0
    s_cmp_le_u32 s50, 0
    s_addc_u32 s48, s58, 0
    s_and_b32 s48, s48, 7
    s_mul_i32 s48, s48, 458752
    s_add_u32 s48, s48, s49
    s_add_u32 m0, s51, 82432
    s_nop 0
    buffer_load_dwordx4 v244, s[12:15], s48 offen lds
    v_mfma_f32_16x16x32_bf16 v[4:7], v[120:123], v[164:167], v[4:7]
    ds_read_b64 v[146:147], v253 offset:128
    v_mfma_f32_16x16x32_bf16 v[8:11], v[120:123], v[168:171], v[8:11]
    ds_read_b64 v[148:149], v253 offset:256
    v_mfma_f32_16x16x32_bf16 v[12:15], v[120:123], v[172:175], v[12:15]
    ds_read_b64 v[150:151], v253 offset:384
    s_add_u32 m0, s51, 83488
    s_nop 0
    buffer_load_dwordx4 v245, s[12:15], s48 offen lds
    s_add_u32 s48, s48, 65536
    v_mfma_f32_16x16x32_bf16 v[48:51], v[132:135], v[160:163], v[48:51]
    v_mfma_f32_16x16x32_bf16 v[52:55], v[132:135], v[164:167], v[52:55]
    ds_read_b128 v[96:99], v235 offset:0
    v_mfma_f32_16x16x32_bf16 v[56:59], v[132:135], v[168:171], v[56:59]
    ds_read_b128 v[100:103], v235 offset:64
    v_mfma_f32_16x16x32_bf16 v[60:63], v[132:135], v[172:175], v[60:63]
    ds_read_b128 v[104:107], v238 offset:0
    s_add_u32 m0, s51, 90880
    s_nop 0
    buffer_load_dwordx4 v244, s[12:15], s48 offen lds
    v_mfma_f32_16x16x32_bf16 v[16:19], v[124:127], v[160:163], v[16:19]
    v_mfma_f32_16x16x32_bf16 v[20:23], v[124:127], v[164:167], v[20:23]
    ds_read_b128 v[108:111], v235 offset:896
    v_mfma_f32_16x16x32_bf16 v[24:27], v[124:127], v[168:171], v[24:27]
    ds_read_b128 v[112:115], v235 offset:960
    v_mfma_f32_16x16x32_bf16 v[28:31], v[124:127], v[172:175], v[28:31]
    ds_read_b128 v[116:119], v238 offset:896
    s_add_u32 m0, s51, 91936
    s_nop 0
    buffer_load_dwordx4 v245, s[12:15], s48 offen lds
    s_add_u32 s48, s48, 65536
    v_mfma_f32_16x16x32_bf16 v[64:67], v[136:139], v[160:163], v[64:67]
    v_mfma_f32_16x16x32_bf16 v[68:71], v[136:139], v[164:167], v[68:71]
    v_mfma_f32_16x16x32_bf16 v[72:75], v[136:139], v[168:171], v[72:75]
    v_mfma_f32_16x16x32_bf16 v[76:79], v[136:139], v[172:175], v[76:79]
    s_add_u32 m0, s51, 99328
    s_nop 0
    buffer_load_dwordx4 v244, s[12:15], s48 offen lds
    v_mfma_f32_16x16x32_bf16 v[32:35], v[128:131], v[160:163], v[32:35]
    v_mfma_f32_16x16x32_bf16 v[36:39], v[128:131], v[164:167], v[36:39]
    v_mfma_f32_16x16x32_bf16 v[40:43], v[128:131], v[168:171], v[40:43]
    v_mfma_f32_16x16x32_bf16 v[44:47], v[128:131], v[172:175], v[44:47]
    s_add_u32 m0, s51, 100384
    s_nop 0
    buffer_load_dwordx4 v245, s[12:15], s48 offen lds
    s_add_u32 s48, s48, 65536
    v_mfma_f32_16x16x32_bf16 v[80:83], v[140:143], v[160:163], v[80:83]
    v_mfma_f32_16x16x32_bf16 v[84:87], v[140:143], v[164:167], v[84:87]
    v_mfma_f32_16x16x32_bf16 v[88:91], v[140:143], v[168:171], v[88:91]
    v_mfma_f32_16x16x32_bf16 v[92:95], v[140:143], v[172:175], v[92:95]
    s_and_b32 s64, s3, 1
    s_lshl_b32 s64, s64, 12
    s_add_u32 s25, s25, s64
    s_lshr_b32 s64, s69, 1
    s_lshl_b32 s65, s64, 3
    s_add_u32 s26, s25, s65
    s_add_u32 s26, s26, 40960
    s_lshl_b32 s64, s64, 14
    s_add_u32 s25, s25, s64
    s_add_u32 s25, s25, 32768
    s_and_b32 s64, s3, 1
    s_lshl_b32 s64, s64, 12
    s_lshr_b32 s65, s69, 1
    s_lshl_b32 s66, s65, 3
    s_add_u32 s66, s66, s64
    s_add_u32 s66, s66, 32768
    v_add_u32 v237, s66, v249
    s_lshl_b32 s65, s65, 14
    s_add_u32 s64, s64, s65
    s_add_u32 s64, s64, 24576
    v_add_u32 v236, s64, v249
    s_waitcnt lgkmcnt(0)
    s_mov_b32 s64, 0xbfb8aa3b
    v_mul_f32 v136, v145, v145
    v_sub_f32 v120, 0, v144
    v_mul_f32 v128, s64, v145
    v_sub_f32 v121, 0, v144
    v_mul_f32 v129, s64, v145
    v_mul_f32 v138, v147, v147
    v_sub_f32 v122, 0, v146
    v_mul_f32 v130, s64, v147
    v_sub_f32 v123, 0, v146
    v_mul_f32 v131, s64, v147
    v_mul_f32 v140, v149, v149
    v_sub_f32 v124, 0, v148
    v_mul_f32 v132, s64, v149
    v_sub_f32 v125, 0, v148
    v_mul_f32 v133, s64, v149
    v_mul_f32 v142, v151, v151
    v_sub_f32 v126, 0, v150
    v_mul_f32 v134, s64, v151
    v_sub_f32 v127, 0, v150
    v_mul_f32 v135, s64, v151
    v_rcp_f32 v137, v136
    v_rcp_f32 v136, v136
    v_rcp_f32 v139, v138
    v_rcp_f32 v138, v138
    v_rcp_f32 v141, v140
    v_rcp_f32 v140, v140
    v_rcp_f32 v143, v142
    v_rcp_f32 v142, v142
    v_pk_fma_f32 v[0:1], v[120:121], v[96:97], v[0:1]
    v_pk_fma_f32 v[2:3], v[120:121], v[98:99], v[2:3]
    v_pk_mul_f32 v[164:165], v[128:129], v[0:1]
    v_pk_mul_f32 v[166:167], v[128:129], v[2:3]
    v_exp_f32 v164, v164
    v_exp_f32 v165, v165
    v_exp_f32 v166, v166
    v_exp_f32 v167, v167
    v_pk_fma_f32 v[48:49], v[120:121], v[108:109], v[48:49]
    v_pk_fma_f32 v[50:51], v[120:121], v[110:111], v[50:51]
    v_pk_fma_f32 v[164:165], v[164:165], v[136:137], v[136:137]
    v_pk_fma_f32 v[166:167], v[166:167], v[136:137], v[136:137]
    v_rcp_f32 v164, v164
    v_rcp_f32 v165, v165
    v_rcp_f32 v166, v166
    v_rcp_f32 v167, v167
    v_pk_mul_f32 v[0:1], v[0:1], v[48:49]
    v_pk_mul_f32 v[2:3], v[2:3], v[50:51]
    v_pk_mul_f32 v[0:1], v[0:1], v[164:165]
    v_pk_mul_f32 v[2:3], v[2:3], v[166:167]
    v_cvt_pk_bf16_f32 v168, v0, v1
    v_cvt_pk_bf16_f32 v169, v2, v3
    v_pk_fma_f32 v[16:17], v[120:121], v[100:101], v[16:17]
    v_pk_fma_f32 v[18:19], v[120:121], v[102:103], v[18:19]
    v_pk_mul_f32 v[164:165], v[128:129], v[16:17]
    v_pk_mul_f32 v[166:167], v[128:129], v[18:19]
    v_exp_f32 v164, v164
    v_exp_f32 v165, v165
    v_exp_f32 v166, v166
    v_exp_f32 v167, v167
    v_pk_fma_f32 v[64:65], v[120:121], v[112:113], v[64:65]
    v_pk_fma_f32 v[66:67], v[120:121], v[114:115], v[66:67]
    v_pk_fma_f32 v[164:165], v[164:165], v[136:137], v[136:137]
    v_pk_fma_f32 v[166:167], v[166:167], v[136:137], v[136:137]
    v_rcp_f32 v164, v164
    v_rcp_f32 v165, v165
    v_rcp_f32 v166, v166
    v_rcp_f32 v167, v167
    v_pk_mul_f32 v[16:17], v[16:17], v[64:65]
    v_pk_mul_f32 v[18:19], v[18:19], v[66:67]
    v_pk_mul_f32 v[16:17], v[16:17], v[164:165]
    v_pk_mul_f32 v[18:19], v[18:19], v[166:167]
    v_cvt_pk_bf16_f32 v170, v16, v17
    v_cvt_pk_bf16_f32 v171, v18, v19
    buffer_store_dwordx4 v[168:171], v249, s[80:83], s25 offen offset:0
    ds_write_b128 v236, v[168:171] offset:0
    v_pk_fma_f32 v[32:33], v[120:121], v[104:105], v[32:33]
    v_pk_fma_f32 v[34:35], v[120:121], v[106:107], v[34:35]
    v_pk_mul_f32 v[164:165], v[128:129], v[32:33]
    v_pk_mul_f32 v[166:167], v[128:129], v[34:35]
    v_exp_f32 v164, v164
    v_exp_f32 v165, v165
    v_exp_f32 v166, v166
    v_exp_f32 v167, v167
    v_pk_fma_f32 v[80:81], v[120:121], v[116:117], v[80:81]
    v_pk_fma_f32 v[82:83], v[120:121], v[118:119], v[82:83]
    v_pk_fma_f32 v[164:165], v[164:165], v[136:137], v[136:137]
    v_pk_fma_f32 v[166:167], v[166:167], v[136:137], v[136:137]
    v_rcp_f32 v164, v164
    v_rcp_f32 v165, v165
    v_rcp_f32 v166, v166
    v_rcp_f32 v167, v167
    v_pk_mul_f32 v[32:33], v[32:33], v[80:81]
    v_pk_mul_f32 v[34:35], v[34:35], v[82:83]
    v_pk_mul_f32 v[32:33], v[32:33], v[164:165]
    v_pk_mul_f32 v[34:35], v[34:35], v[166:167]
    v_cvt_pk_bf16_f32 v172, v32, v33
    v_cvt_pk_bf16_f32 v173, v34, v35
    buffer_store_dwordx2 v[172:173], v249, s[80:83], s26 offen offset:0
    ds_write_b64 v237, v[172:173] offset:0
    v_pk_fma_f32 v[4:5], v[122:123], v[96:97], v[4:5]
    v_pk_fma_f32 v[6:7], v[122:123], v[98:99], v[6:7]
    v_pk_mul_f32 v[164:165], v[130:131], v[4:5]
    v_pk_mul_f32 v[166:167], v[130:131], v[6:7]
    v_exp_f32 v164, v164
    v_exp_f32 v165, v165
    v_exp_f32 v166, v166
    v_exp_f32 v167, v167
    v_pk_fma_f32 v[52:53], v[122:123], v[108:109], v[52:53]
    v_pk_fma_f32 v[54:55], v[122:123], v[110:111], v[54:55]
    v_pk_fma_f32 v[164:165], v[164:165], v[138:139], v[138:139]
    v_pk_fma_f32 v[166:167], v[166:167], v[138:139], v[138:139]
    v_rcp_f32 v164, v164
    v_rcp_f32 v165, v165
    v_rcp_f32 v166, v166
    v_rcp_f32 v167, v167
    v_pk_mul_f32 v[4:5], v[4:5], v[52:53]
    v_pk_mul_f32 v[6:7], v[6:7], v[54:55]
    v_pk_mul_f32 v[4:5], v[4:5], v[164:165]
    v_pk_mul_f32 v[6:7], v[6:7], v[166:167]
    v_cvt_pk_bf16_f32 v168, v4, v5
    v_cvt_pk_bf16_f32 v169, v6, v7
    v_pk_fma_f32 v[20:21], v[122:123], v[100:101], v[20:21]
    v_pk_fma_f32 v[22:23], v[122:123], v[102:103], v[22:23]
    v_pk_mul_f32 v[164:165], v[130:131], v[20:21]
    v_pk_mul_f32 v[166:167], v[130:131], v[22:23]
    v_exp_f32 v164, v164
    v_exp_f32 v165, v165
    v_exp_f32 v166, v166
    v_exp_f32 v167, v167
    v_pk_fma_f32 v[68:69], v[122:123], v[112:113], v[68:69]
    v_pk_fma_f32 v[70:71], v[122:123], v[114:115], v[70:71]
    v_pk_fma_f32 v[164:165], v[164:165], v[138:139], v[138:139]
    v_pk_fma_f32 v[166:167], v[166:167], v[138:139], v[138:139]
    v_rcp_f32 v164, v164
    v_rcp_f32 v165, v165
    v_rcp_f32 v166, v166
    v_rcp_f32 v167, v167
    v_pk_mul_f32 v[20:21], v[20:21], v[68:69]
    v_pk_mul_f32 v[22:23], v[22:23], v[70:71]
    v_pk_mul_f32 v[20:21], v[20:21], v[164:165]
    v_pk_mul_f32 v[22:23], v[22:23], v[166:167]
    v_cvt_pk_bf16_f32 v170, v20, v21
    v_cvt_pk_bf16_f32 v171, v22, v23
    buffer_store_dwordx4 v[168:171], v249, s[80:83], s25 offen offset:1024
    ds_write_b128 v236, v[168:171] offset:1024
    v_pk_fma_f32 v[36:37], v[122:123], v[104:105], v[36:37]
    v_pk_fma_f32 v[38:39], v[122:123], v[106:107], v[38:39]
    v_pk_mul_f32 v[164:165], v[130:131], v[36:37]
    v_pk_mul_f32 v[166:167], v[130:131], v[38:39]
    v_exp_f32 v164, v164
    v_exp_f32 v165, v165
    v_exp_f32 v166, v166
    v_exp_f32 v167, v167
    v_pk_fma_f32 v[84:85], v[122:123], v[116:117], v[84:85]
    v_pk_fma_f32 v[86:87], v[122:123], v[118:119], v[86:87]
    v_pk_fma_f32 v[164:165], v[164:165], v[138:139], v[138:139]
    v_pk_fma_f32 v[166:167], v[166:167], v[138:139], v[138:139]
    v_rcp_f32 v164, v164
    v_rcp_f32 v165, v165
    v_rcp_f32 v166, v166
    v_rcp_f32 v167, v167
    v_pk_mul_f32 v[36:37], v[36:37], v[84:85]
    v_pk_mul_f32 v[38:39], v[38:39], v[86:87]
    v_pk_mul_f32 v[36:37], v[36:37], v[164:165]
    v_pk_mul_f32 v[38:39], v[38:39], v[166:167]
    v_cvt_pk_bf16_f32 v172, v36, v37
    v_cvt_pk_bf16_f32 v173, v38, v39
    buffer_store_dwordx2 v[172:173], v249, s[80:83], s26 offen offset:1024
    ds_write_b64 v237, v[172:173] offset:1024
    v_pk_fma_f32 v[8:9], v[124:125], v[96:97], v[8:9]
    v_pk_fma_f32 v[10:11], v[124:125], v[98:99], v[10:11]
    v_pk_mul_f32 v[164:165], v[132:133], v[8:9]
    v_pk_mul_f32 v[166:167], v[132:133], v[10:11]
    v_exp_f32 v164, v164
    v_exp_f32 v165, v165
    v_exp_f32 v166, v166
    v_exp_f32 v167, v167
    v_pk_fma_f32 v[56:57], v[124:125], v[108:109], v[56:57]
    v_pk_fma_f32 v[58:59], v[124:125], v[110:111], v[58:59]
    v_pk_fma_f32 v[164:165], v[164:165], v[140:141], v[140:141]
    v_pk_fma_f32 v[166:167], v[166:167], v[140:141], v[140:141]
    v_rcp_f32 v164, v164
    v_rcp_f32 v165, v165
    v_rcp_f32 v166, v166
    v_rcp_f32 v167, v167
    v_pk_mul_f32 v[8:9], v[8:9], v[56:57]
    v_pk_mul_f32 v[10:11], v[10:11], v[58:59]
    v_pk_mul_f32 v[8:9], v[8:9], v[164:165]
    v_pk_mul_f32 v[10:11], v[10:11], v[166:167]
    v_cvt_pk_bf16_f32 v168, v8, v9
    v_cvt_pk_bf16_f32 v169, v10, v11
    v_pk_fma_f32 v[24:25], v[124:125], v[100:101], v[24:25]
    v_pk_fma_f32 v[26:27], v[124:125], v[102:103], v[26:27]
    v_pk_mul_f32 v[164:165], v[132:133], v[24:25]
    v_pk_mul_f32 v[166:167], v[132:133], v[26:27]
    v_exp_f32 v164, v164
    v_exp_f32 v165, v165
    v_exp_f32 v166, v166
    v_exp_f32 v167, v167
    v_pk_fma_f32 v[72:73], v[124:125], v[112:113], v[72:73]
    v_pk_fma_f32 v[74:75], v[124:125], v[114:115], v[74:75]
    v_pk_fma_f32 v[164:165], v[164:165], v[140:141], v[140:141]
    v_pk_fma_f32 v[166:167], v[166:167], v[140:141], v[140:141]
    v_rcp_f32 v164, v164
    v_rcp_f32 v165, v165
    v_rcp_f32 v166, v166
    v_rcp_f32 v167, v167
    v_pk_mul_f32 v[24:25], v[24:25], v[72:73]
    v_pk_mul_f32 v[26:27], v[26:27], v[74:75]
    v_pk_mul_f32 v[24:25], v[24:25], v[164:165]
    v_pk_mul_f32 v[26:27], v[26:27], v[166:167]
    v_cvt_pk_bf16_f32 v170, v24, v25
    v_cvt_pk_bf16_f32 v171, v26, v27
    buffer_store_dwordx4 v[168:171], v249, s[80:83], s25 offen offset:2048
    ds_write_b128 v236, v[168:171] offset:2048
    v_pk_fma_f32 v[40:41], v[124:125], v[104:105], v[40:41]
    v_pk_fma_f32 v[42:43], v[124:125], v[106:107], v[42:43]
    v_pk_mul_f32 v[164:165], v[132:133], v[40:41]
    v_pk_mul_f32 v[166:167], v[132:133], v[42:43]
    v_exp_f32 v164, v164
    v_exp_f32 v165, v165
    v_exp_f32 v166, v166
    v_exp_f32 v167, v167
    v_pk_fma_f32 v[88:89], v[124:125], v[116:117], v[88:89]
    v_pk_fma_f32 v[90:91], v[124:125], v[118:119], v[90:91]
    v_pk_fma_f32 v[164:165], v[164:165], v[140:141], v[140:141]
    v_pk_fma_f32 v[166:167], v[166:167], v[140:141], v[140:141]
    v_rcp_f32 v164, v164
    v_rcp_f32 v165, v165
    v_rcp_f32 v166, v166
    v_rcp_f32 v167, v167
    v_pk_mul_f32 v[40:41], v[40:41], v[88:89]
    v_pk_mul_f32 v[42:43], v[42:43], v[90:91]
    v_pk_mul_f32 v[40:41], v[40:41], v[164:165]
    v_pk_mul_f32 v[42:43], v[42:43], v[166:167]
    v_cvt_pk_bf16_f32 v172, v40, v41
    v_cvt_pk_bf16_f32 v173, v42, v43
    buffer_store_dwordx2 v[172:173], v249, s[80:83], s26 offen offset:2048
    ds_write_b64 v237, v[172:173] offset:2048
    v_pk_fma_f32 v[12:13], v[126:127], v[96:97], v[12:13]
    v_pk_fma_f32 v[14:15], v[126:127], v[98:99], v[14:15]
    v_pk_mul_f32 v[164:165], v[134:135], v[12:13]
    v_pk_mul_f32 v[166:167], v[134:135], v[14:15]
    v_exp_f32 v164, v164
    v_exp_f32 v165, v165
    v_exp_f32 v166, v166
    v_exp_f32 v167, v167
    v_pk_fma_f32 v[60:61], v[126:127], v[108:109], v[60:61]
    v_pk_fma_f32 v[62:63], v[126:127], v[110:111], v[62:63]
    v_pk_fma_f32 v[164:165], v[164:165], v[142:143], v[142:143]
    v_pk_fma_f32 v[166:167], v[166:167], v[142:143], v[142:143]
    v_rcp_f32 v164, v164
    v_rcp_f32 v165, v165
    v_rcp_f32 v166, v166
    v_rcp_f32 v167, v167
    v_pk_mul_f32 v[12:13], v[12:13], v[60:61]
    v_pk_mul_f32 v[14:15], v[14:15], v[62:63]
    v_pk_mul_f32 v[12:13], v[12:13], v[164:165]
    v_pk_mul_f32 v[14:15], v[14:15], v[166:167]
    v_cvt_pk_bf16_f32 v168, v12, v13
    v_cvt_pk_bf16_f32 v169, v14, v15
    v_pk_fma_f32 v[28:29], v[126:127], v[100:101], v[28:29]
    v_pk_fma_f32 v[30:31], v[126:127], v[102:103], v[30:31]
    v_pk_mul_f32 v[164:165], v[134:135], v[28:29]
    v_pk_mul_f32 v[166:167], v[134:135], v[30:31]
    v_exp_f32 v164, v164
    v_exp_f32 v165, v165
    v_exp_f32 v166, v166
    v_exp_f32 v167, v167
    v_pk_fma_f32 v[76:77], v[126:127], v[112:113], v[76:77]
    v_pk_fma_f32 v[78:79], v[126:127], v[114:115], v[78:79]
    v_pk_fma_f32 v[164:165], v[164:165], v[142:143], v[142:143]
    v_pk_fma_f32 v[166:167], v[166:167], v[142:143], v[142:143]
    v_rcp_f32 v164, v164
    v_rcp_f32 v165, v165
    v_rcp_f32 v166, v166
    v_rcp_f32 v167, v167
    v_pk_mul_f32 v[28:29], v[28:29], v[76:77]
    v_pk_mul_f32 v[30:31], v[30:31], v[78:79]
    v_pk_mul_f32 v[28:29], v[28:29], v[164:165]
    v_pk_mul_f32 v[30:31], v[30:31], v[166:167]
    v_cvt_pk_bf16_f32 v170, v28, v29
    v_cvt_pk_bf16_f32 v171, v30, v31
    buffer_store_dwordx4 v[168:171], v249, s[80:83], s25 offen offset:3072
    ds_write_b128 v236, v[168:171] offset:3072
    v_pk_fma_f32 v[44:45], v[126:127], v[104:105], v[44:45]
    v_pk_fma_f32 v[46:47], v[126:127], v[106:107], v[46:47]
    v_pk_mul_f32 v[164:165], v[134:135], v[44:45]
    v_pk_mul_f32 v[166:167], v[134:135], v[46:47]
    v_exp_f32 v164, v164
    v_exp_f32 v165, v165
    v_exp_f32 v166, v166
    v_exp_f32 v167, v167
    v_pk_fma_f32 v[92:93], v[126:127], v[116:117], v[92:93]
    v_pk_fma_f32 v[94:95], v[126:127], v[118:119], v[94:95]
    v_pk_fma_f32 v[164:165], v[164:165], v[142:143], v[142:143]
    v_pk_fma_f32 v[166:167], v[166:167], v[142:143], v[142:143]
    v_rcp_f32 v164, v164
    v_rcp_f32 v165, v165
    v_rcp_f32 v166, v166
    v_rcp_f32 v167, v167
    v_pk_mul_f32 v[44:45], v[44:45], v[92:93]
    v_pk_mul_f32 v[46:47], v[46:47], v[94:95]
    v_pk_mul_f32 v[44:45], v[44:45], v[164:165]
    v_pk_mul_f32 v[46:47], v[46:47], v[166:167]
    v_cvt_pk_bf16_f32 v172, v44, v45
    v_cvt_pk_bf16_f32 v173, v46, v47
    buffer_store_dwordx2 v[172:173], v249, s[80:83], s26 offen offset:3072
    ds_write_b64 v237, v[172:173] offset:3072
    s_lshl_b32 s64, s75, 15
    s_lshl_b32 s66, s73, 9
    s_add_u32 s64, s64, s66
    s_add_u32 s64, s64, 75513856
    s_lshl_b32 s65, s72, 5
    s_add_u32 s64, s64, s65
    s_lshl_b32 s65, s3, 2
    s_add_u32 s64, s64, s65
    v_mov_b32 v144, 0
    v_mov_b32 v145, 1
    s_cmp_lg_u32 s78, 0
    s_cbranch_scc1 sg_2548_slow
    s_waitcnt vmcnt(0)
    s_mov_b64 exec, 1
    buffer_store_dword v145, v144, s[80:83], s64 offen
    s_mov_b64 exec, -1
sg_2548_done:
    s_setprio 3
    s_mov_b32 s8, s86
    s_mov_b32 s9, s87
    s_mov_b32 s10, 6291456
    s_mov_b32 s11, 0x00020000
    v_lshrrev_b32 v253, 3, v250
    v_lshlrev_b32 v253, 2, v253
    v_add_u32 v253, s69, v253
    v_mul_u32_u24 v253, 6144, v253
    v_and_b32 v254, 7, v250
    v_lshl_add_u32 v10, v254, 4, v253
    v_add_u32 v11, 2048, v10
    v_add_u32 v12, 4096, v10
    s_mul_i32 s19, s69, 3104
    s_lshl_b32 s17, s67, 7
    s_add_u32 s18, s17, 6291456
    s_lshl_b32 s64, s70, 1
    s_mul_i32 s64, s64, 393216
    s_add_u32 s16, s17, s64
    s_lshl_b32 s53, s73, 1
    s_add_u32 s53, s53, s68
    s_mul_i32 s53, s53, 458752
    s_lshl_b32 s66, s60, 24
    s_add_u32 s53, s53, s66
    s_add_u32 s53, s53, 20971520
    s_lshl_b32 s55, s69, 11
    s_add_u32 s53, s53, s55
    s_lshl_b32 s56, s75, 15
    s_lshl_b32 s66, s73, 9
    s_add_u32 s56, s56, s66
    s_add_u32 s56, s56, 75513856
    v_lshlrev_b32 v246, 4, v250
    s_lshl_b32 s64, s68, 1
    s_lshl_b32 s62, 0x33333333, s64
    s_mov_b32 s63, 0
    s_lshr_b32 s40, s2, 3
    s_lshl_b32 s40, s40, 2
    s_add_u32 s40, s40, s69
    s_and_b32 s41, s40, 31
    s_lshl_b32 s41, s41, 11
    s_lshr_b32 s46, s40, 5
    s_and_b32 s46, s46, 1
    s_lshr_b32 s40, s40, 6
    s_lshl_b32 s40, s40, 10
    s_add_u32 s40, s40, s41
    s_lshr_b32 s41, s74, 3
    s_mul_i32 s41, s41, 3670016
    s_add_u32 s40, s40, s41
    s_add_u32 s40, s96, s40
    s_addc_u32 s41, s97, 0
    s_mul_i32 s47, s58, 7
    s_add_u32 s46, s46, s47
    s_waitcnt lgkmcnt(0)
    s_barrier
    s_add_u32 s42, s46, 10
    s_cmp_ge_u32 s42, 56
    s_cselect_b32 s47, 56, 0
    s_sub_u32 s42, s42, s47
    s_lshl_b32 s42, s42, 16
    s_add_u32 s44, s40, s42
    s_addc_u32 s45, s41, 0
    s_load_dword s43, s[44:45], 384
    s_load_dword s43, s[44:45], 448
    s_barrier
    s_add_u32 s42, s46, 12
    s_cmp_ge_u32 s42, 56
    s_cselect_b32 s47, 56, 0
    s_sub_u32 s42, s42, s47
    s_lshl_b32 s42, s42, 16
    s_add_u32 s44, s40, s42
    s_addc_u32 s45, s41, 0
    s_load_dword s43, s[44:45], 384
    s_load_dword s43, s[44:45], 448
    s_add_u32 s42, s46, 14
    s_cmp_ge_u32 s42, 56
    s_cselect_b32 s47, 56, 0
    s_sub_u32 s42, s42, s47
    s_lshl_b32 s42, s42, 16
    s_add_u32 s44, s40, s42
    s_addc_u32 s45, s41, 0
    s_load_dword s43, s[44:45], 384
    s_load_dword s43, s[44:45], 448
    s_mov_b64 exec, s[62:63]
pl_2549:
    buffer_load_dwordx4 v[240:243], v246, s[80:83], s56 offen sc1
    s_sub_u32 s79, s79, 1
    s_cbranch_scc1 L_abort
    s_waitcnt vmcnt(0)
    v_and_b32 v240, v240, v241
    v_and_b32 v242, v242, v243
    v_and_b32 v240, v240, v242
    v_cmp_ne_u32 vcc, 1, v240
    s_cbranch_vccnz pl_2549
    s_mov_b64 exec, -1
    s_cmp_lg_u32 s78, 0
    s_cbranch_scc1 pl_2549_acq
pl_2549_ok:
    s_cmp_le_u32 s50, 0
    s_addc_u32 s52, s58, 0
    s_and_b32 s52, s52, 7
    s_mul_i32 s52, s52, 57344
    s_add_u32 s52, s52, s53
    s_add_u32 m0, s55, 49152
    s_nop 0
    buffer_load_dwordx4 v249, s[80:83], s52 offen offset:0 sc1 lds
    buffer_load_dwordx4 v249, s[80:83], s52 offen offset:1024 sc1 lds
    s_add_u32 s52, s52, 8192
    s_add_u32 m0, s55, 57344
    s_nop 0
    buffer_load_dwordx4 v249, s[80:83], s52 offen offset:0 sc1 lds
    buffer_load_dwordx4 v249, s[80:83], s52 offen offset:1024 sc1 lds
    s_add_u32 s52, s52, 8192
    s_add_u32 m0, s55, 0
    s_nop 0
    buffer_load_dwordx4 v249, s[80:83], s52 offen offset:0 sc1 lds
    buffer_load_dwordx4 v249, s[80:83], s52 offen offset:1024 sc1 lds
    s_add_u32 s52, s52, 8192
    s_add_u32 m0, s55, 8192
    s_nop 0
    buffer_load_dwordx4 v249, s[80:83], s52 offen offset:0 sc1 lds
    buffer_load_dwordx4 v249, s[80:83], s52 offen offset:1024 sc1 lds
    s_add_u32 s52, s52, 8192
    s_waitcnt vmcnt(4)
    s_barrier
    s_add_u32 s42, s46, 16
    s_cmp_ge_u32 s42, 56
    s_cselect_b32 s47, 56, 0
    s_sub_u32 s42, s42, s47
    s_lshl_b32 s42, s42, 16
    s_add_u32 s44, s40, s42
    s_addc_u32 s45, s41, 0
    s_load_dword s43, s[44:45], 384
    s_load_dword s43, s[44:45], 448
    s_add_u32 s42, s46, 18
    s_cmp_ge_u32 s42, 56
    s_cselect_b32 s47, 56, 0
    s_sub_u32 s42, s42, s47
    s_lshl_b32 s42, s42, 16
    s_add_u32 s44, s40, s42
    s_addc_u32 s45, s41, 0
    s_load_dword s43, s[44:45], 384
    s_load_dword s43, s[44:45], 448
    s_add_u32 m0, s51, 107776
    s_nop 0
    buffer_load_dwordx4 v244, s[12:15], s48 offen lds
    s_add_u32 m0, s51, 108832
    s_nop 0
    buffer_load_dwordx4 v245, s[12:15], s48 offen lds
    s_add_u32 s48, s48, 65536
    s_add_u32 m0, s55, 16384
    s_nop 0
    buffer_load_dwordx4 v249, s[80:83], s52 offen offset:0 sc1 lds
    buffer_load_dwordx4 v249, s[80:83], s52 offen offset:1024 sc1 lds
    s_add_u32 s52, s52, 8192
    s_add_u32 m0, s51, 116224
    s_nop 0
    buffer_load_dwordx4 v244, s[12:15], s48 offen lds
    s_add_u32 m0, s51, 117280
    s_nop 0
    buffer_load_dwordx4 v245, s[12:15], s48 offen lds
    s_add_u32 s48, s48, 65536
    s_add_u32 m0, s55, 24576
    s_nop 0
    buffer_load_dwordx4 v249, s[80:83], s52 offen offset:0 sc1 lds
    buffer_load_dwordx4 v249, s[80:83], s52 offen offset:1024 sc1 lds
    s_add_u32 s52, s52, 8192
    s_add_u32 m0, s51, 124672
    s_nop 0
    buffer_load_dwordx4 v244, s[12:15], s48 offen lds
    s_add_u32 m0, s51, 125728
    s_nop 0
    buffer_load_dwordx4 v245, s[12:15], s48 offen lds
    s_add_u32 s48, s48, 65536
    s_waitcnt vmcnt(8)
    s_barrier
    s_add_u32 s42, s46, 20
    s_cmp_ge_u32 s42, 56
    s_cselect_b32 s47, 56, 0
    s_sub_u32 s42, s42, s47
    s_lshl_b32 s42, s42, 16
    s_add_u32 s44, s40, s42
    s_addc_u32 s45, s41, 0
    s_load_dword s43, s[44:45], 384
    s_load_dword s43, s[44:45], 448
    s_add_u32 m0, s55, 32768
    s_nop 0
    buffer_load_dwordx4 v249, s[80:83], s52 offen offset:0 sc1 lds
    buffer_load_dwordx4 v249, s[80:83], s52 offen offset:1024 sc1 lds
    s_add_u32 s52, s52, 8192
    s_add_u32 m0, s51, 133120
    s_nop 0
    buffer_load_dwordx4 v244, s[12:15], s48 offen lds
    s_add_u32 m0, s51, 134176
    s_nop 0
    buffer_load_dwordx4 v245, s[12:15], s48 offen lds
    s_add_u32 s48, s48, 65536
    s_cmp_le_u32 s50, 1
    s_addc_u32 s52, s58, 1
    s_and_b32 s52, s52, 7
    s_mul_i32 s52, s52, 57344
    s_add_u32 s52, s52, s53
    s_add_u32 m0, s55, 40960
    s_nop 0
    buffer_load_dwordx4 v249, s[80:83], s52 offen offset:0 sc1 lds
    buffer_load_dwordx4 v249, s[80:83], s52 offen offset:1024 sc1 lds
    s_add_u32 s52, s52, 8192
    s_cmp_le_u32 s50, 1
    s_addc_u32 s48, s58, 1
    s_and_b32 s48, s48, 7
    s_mul_i32 s48, s48, 458752
    s_add_u32 s48, s48, s49
    s_add_u32 m0, s51, 141568
    s_nop 0
    buffer_load_dwordx4 v244, s[12:15], s48 offen lds
    s_add_u32 m0, s51, 142624
    s_nop 0
    buffer_load_dwordx4 v245, s[12:15], s48 offen lds
    s_add_u32 s48, s48, 65536
    s_add_u32 m0, s55, 49152
    s_nop 0
    buffer_load_dwordx4 v249, s[80:83], s52 offen offset:0 sc1 lds
    buffer_load_dwordx4 v249, s[80:83], s52 offen offset:1024 sc1 lds
    s_add_u32 s52, s52, 8192
    s_waitcnt vmcnt(10)
    s_barrier
    s_add_u32 s42, s46, 22
    s_cmp_ge_u32 s42, 56
    s_cselect_b32 s47, 56, 0
    s_sub_u32 s42, s42, s47
    s_lshl_b32 s42, s42, 16
    s_add_u32 s44, s40, s42
    s_addc_u32 s45, s41, 0
    s_load_dword s43, s[44:45], 384
    s_load_dword s43, s[44:45], 448
    s_add_u32 m0, s51, 65536
    s_nop 0
    buffer_load_dwordx4 v244, s[12:15], s48 offen lds
    s_add_u32 m0, s51, 66592
    s_nop 0
    buffer_load_dwordx4 v245, s[12:15], s48 offen lds
    s_add_u32 s48, s48, 65536
    s_add_u32 m0, s55, 57344
    s_nop 0
    buffer_load_dwordx4 v249, s[80:83], s52 offen offset:0 sc1 lds
    buffer_load_dwordx4 v249, s[80:83], s52 offen offset:1024 sc1 lds
    s_add_u32 s52, s52, 8192
    s_add_u32 m0, s51, 73984
    s_nop 0
    buffer_load_dwordx4 v244, s[12:15], s48 offen lds
    s_add_u32 m0, s51, 75040
    s_nop 0
    buffer_load_dwordx4 v245, s[12:15], s48 offen lds
    s_add_u32 s48, s48, 65536
    s_add_u32 m0, s55, 0
    s_nop 0
    buffer_load_dwordx4 v249, s[80:83], s52 offen offset:0 sc1 lds
    buffer_load_dwordx4 v249, s[80:83], s52 offen offset:1024 sc1 lds
    s_add_u32 s52, s52, 8192
    s_add_u32 m0, s51, 82432
    s_nop 0
    buffer_load_dwordx4 v244, s[12:15], s48 offen lds
    s_add_u32 m0, s51, 83488
    s_nop 0
    buffer_load_dwordx4 v245, s[12:15], s48 offen lds
    s_add_u32 s48, s48, 65536
    s_waitcnt vmcnt(12)
    s_barrier
    s_add_u32 s42, s46, 24
    s_cmp_ge_u32 s42, 56
    s_cselect_b32 s47, 56, 0
    s_sub_u32 s42, s42, s47
    s_lshl_b32 s42, s42, 16
    s_add_u32 s44, s40, s42
    s_addc_u32 s45, s41, 0
    s_load_dword s43, s[44:45], 384
    s_load_dword s43, s[44:45], 448
    s_add_u32 m0, s55, 8192
    s_nop 0
    buffer_load_dwordx4 v249, s[80:83], s52 offen offset:0 sc1 lds
    buffer_load_dwordx4 v249, s[80:83], s52 offen offset:1024 sc1 lds
    s_add_u32 s52, s52, 8192
    s_add_u32 m0, s51, 90880
    s_nop 0
    buffer_load_dwordx4 v244, s[12:15], s48 offen lds
    s_add_u32 m0, s51, 91936
    s_nop 0
    buffer_load_dwordx4 v245, s[12:15], s48 offen lds
    s_add_u32 s48, s48, 65536
    s_add_u32 m0, s55, 16384
    s_nop 0
    buffer_load_dwordx4 v249, s[80:83], s52 offen offset:0 sc1 lds
    buffer_load_dwordx4 v249, s[80:83], s52 offen offset:1024 sc1 lds
    s_add_u32 s52, s52, 8192
    s_add_u32 m0, s51, 99328
    s_nop 0
    buffer_load_dwordx4 v244, s[12:15], s48 offen lds
    s_add_u32 m0, s51, 100384
    s_nop 0
    buffer_load_dwordx4 v245, s[12:15], s48 offen lds
    s_add_u32 s48, s48, 65536
    s_waitcnt vmcnt(12)
    s_barrier
    s_add_u32 s42, s46, 26
    s_cmp_ge_u32 s42, 56
    s_cselect_b32 s47, 56, 0
    s_sub_u32 s42, s42, s47
    s_lshl_b32 s42, s42, 16
    s_add_u32 s44, s40, s42
    s_addc_u32 s45, s41, 0
    s_load_dword s43, s[44:45], 384
    s_load_dword s43, s[44:45], 448
    s_add_u32 m0, s55, 24576
    s_nop 0
    buffer_load_dwordx4 v249, s[80:83], s52 offen offset:0 sc1 lds
    buffer_load_dwordx4 v249, s[80:83], s52 offen offset:1024 sc1 lds
    s_add_u32 s52, s52, 8192
    s_add_u32 m0, s51, 107776
    s_nop 0
    buffer_load_dwordx4 v244, s[12:15], s48 offen lds
    s_add_u32 m0, s51, 108832
    s_nop 0
    buffer_load_dwordx4 v245, s[12:15], s48 offen lds
    s_add_u32 s48, s48, 65536
    s_cmp_le_u32 s50, 2
    s_addc_u32 s52, s58, 2
    s_and_b32 s52, s52, 7
    s_mul_i32 s52, s52, 57344
    s_add_u32 s52, s52, s53
    s_add_u32 m0, s55, 32768
    s_nop 0
    buffer_load_dwordx4 v249, s[80:83], s52 offen offset:0 sc1 lds
    buffer_load_dwordx4 v249, s[80:83], s52 offen offset:1024 sc1 lds
    s_add_u32 s52, s52, 8192
    s_cmp_le_u32 s50, 2
    s_addc_u32 s48, s58, 2
    s_and_b32 s48, s48, 7
    s_mul_i32 s48, s48, 458752
    s_add_u32 s48, s48, s49
    s_add_u32 m0, s51, 116224
    s_nop 0
    buffer_load_dwordx4 v244, s[12:15], s48 offen lds
    s_add_u32 m0, s51, 117280
    s_nop 0
    buffer_load_dwordx4 v245, s[12:15], s48 offen lds
    s_add_u32 s48, s48, 65536
    s_waitcnt vmcnt(12)
    s_barrier
    s_add_u32 s42, s46, 28
    s_cmp_ge_u32 s42, 56
    s_cselect_b32 s47, 56, 0
    s_sub_u32 s42, s42, s47
    s_lshl_b32 s42, s42, 16
    s_add_u32 s44, s40, s42
    s_addc_u32 s45, s41, 0
    s_load_dword s43, s[44:45], 384
    s_load_dword s43, s[44:45], 448
    s_add_u32 m0, s55, 40960
    s_nop 0
    buffer_load_dwordx4 v249, s[80:83], s52 offen offset:0 sc1 lds
    buffer_load_dwordx4 v249, s[80:83], s52 offen offset:1024 sc1 lds
    s_add_u32 s52, s52, 8192
    s_add_u32 m0, s51, 124672
    s_nop 0
    buffer_load_dwordx4 v244, s[12:15], s48 offen lds
    s_add_u32 m0, s51, 125728
    s_nop 0
    buffer_load_dwordx4 v245, s[12:15], s48 offen lds
    s_add_u32 s48, s48, 65536
    s_add_u32 m0, s55, 49152
    s_nop 0
    buffer_load_dwordx4 v249, s[80:83], s52 offen offset:0 sc1 lds
    buffer_load_dwordx4 v249, s[80:83], s52 offen offset:1024 sc1 lds
    s_add_u32 s52, s52, 8192
    s_add_u32 m0, s51, 133120
    s_nop 0
    buffer_load_dwordx4 v244, s[12:15], s48 offen lds
    s_add_u32 m0, s51, 134176
    s_nop 0
    buffer_load_dwordx4 v245, s[12:15], s48 offen lds
    s_add_u32 s48, s48, 65536
    s_waitcnt vmcnt(12)
    s_barrier
    s_add_u32 s42, s46, 30
    s_cmp_ge_u32 s42, 56
    s_cselect_b32 s47, 56, 0
    s_sub_u32 s42, s42, s47
    s_lshl_b32 s42, s42, 16
    s_add_u32 s44, s40, s42
    s_addc_u32 s45, s41, 0
    s_load_dword s43, s[44:45], 384
    s_load_dword s43, s[44:45], 448
    s_add_u32 m0, s55, 57344
    s_nop 0
    buffer_load_dwordx4 v249, s[80:83], s52 offen offset:0 sc1 lds
    buffer_load_dwordx4 v249, s[80:83], s52 offen offset:1024 sc1 lds
    s_add_u32 s52, s52, 8192
    s_add_u32 m0, s51, 141568
    s_nop 0
    buffer_load_dwordx4 v244, s[12:15], s48 offen lds
    s_add_u32 m0, s51, 142624
    s_nop 0
    buffer_load_dwordx4 v245, s[12:15], s48 offen lds
    s_add_u32 s48, s48, 65536
    s_add_u32 m0, s55, 0
    s_nop 0
    buffer_load_dwordx4 v249, s[80:83], s52 offen offset:0 sc1 lds
    buffer_load_dwordx4 v249, s[80:83], s52 offen offset:1024 sc1 lds
    s_add_u32 s52, s52, 8192
    s_add_u32 m0, s51, 65536
    s_nop 0
    buffer_load_dwordx4 v244, s[12:15], s48 offen lds
    s_add_u32 m0, s51, 66592
    s_nop 0
    buffer_load_dwordx4 v245, s[12:15], s48 offen lds
    s_add_u32 s48, s48, 65536
    s_waitcnt vmcnt(12)
    s_barrier
    s_add_u32 s42, s46, 32
    s_cmp_ge_u32 s42, 56
    s_cselect_b32 s47, 56, 0
    s_sub_u32 s42, s42, s47
    s_lshl_b32 s42, s42, 16
    s_add_u32 s44, s40, s42
    s_addc_u32 s45, s41, 0
    s_load_dword s43, s[44:45], 384
    s_load_dword s43, s[44:45], 448
    s_add_u32 m0, s55, 8192
    s_nop 0
    buffer_load_dwordx4 v249, s[80:83], s52 offen offset:0 sc1 lds
    buffer_load_dwordx4 v249, s[80:83], s52 offen offset:1024 sc1 lds
    s_add_u32 s52, s52, 8192
    s_add_u32 m0, s51, 73984
    s_nop 0
    buffer_load_dwordx4 v244, s[12:15], s48 offen lds
    s_add_u32 m0, s51, 75040
    s_nop 0
    buffer_load_dwordx4 v245, s[12:15], s48 offen lds
    s_add_u32 s48, s48, 65536
    s_add_u32 m0, s55, 16384
    s_nop 0
    buffer_load_dwordx4 v249, s[80:83], s52 offen offset:0 sc1 lds
    buffer_load_dwordx4 v249, s[80:83], s52 offen offset:1024 sc1 lds
    s_add_u32 s52, s52, 8192
    s_add_u32 m0, s51, 82432
    s_nop 0
    buffer_load_dwordx4 v244, s[12:15], s48 offen lds
    s_add_u32 m0, s51, 83488
    s_nop 0
    buffer_load_dwordx4 v245, s[12:15], s48 offen lds
    s_add_u32 s48, s48, 65536
    s_waitcnt vmcnt(12)
    s_barrier
    s_add_u32 s42, s46, 34
    s_cmp_ge_u32 s42, 56
    s_cselect_b32 s47, 56, 0
    s_sub_u32 s42, s42, s47
    s_lshl_b32 s42, s42, 16
    s_add_u32 s44, s40, s42
    s_addc_u32 s45, s41, 0
    s_load_dword s43, s[44:45], 384
    s_load_dword s43, s[44:45], 448
    s_cmp_le_u32 s50, 3
    s_addc_u32 s52, s58, 3
    s_and_b32 s52, s52, 7
    s_mul_i32 s52, s52, 57344
    s_add_u32 s52, s52, s53
    s_add_u32 m0, s55, 24576
    s_nop 0
    buffer_load_dwordx4 v249, s[80:83], s52 offen offset:0 sc1 lds
    buffer_load_dwordx4 v249, s[80:83], s52 offen offset:1024 sc1 lds
    s_add_u32 s52, s52, 8192
    s_cmp_le_u32 s50, 3
    s_addc_u32 s48, s58, 3
    s_and_b32 s48, s48, 7
    s_mul_i32 s48, s48, 458752
    s_add_u32 s48, s48, s49
    s_add_u32 m0, s51, 90880
    s_nop 0
    buffer_load_dwordx4 v244, s[12:15], s48 offen lds
    s_add_u32 m0, s51, 91936
    s_nop 0
    buffer_load_dwordx4 v245, s[12:15], s48 offen lds
    s_add_u32 s48, s48, 65536
    s_add_u32 m0, s55, 32768
    s_nop 0
    buffer_load_dwordx4 v249, s[80:83], s52 offen offset:0 sc1 lds
    buffer_load_dwordx4 v249, s[80:83], s52 offen offset:1024 sc1 lds
    s_add_u32 s52, s52, 8192
    s_add_u32 m0, s51, 99328
    s_nop 0
    buffer_load_dwordx4 v244, s[12:15], s48 offen lds
    s_add_u32 m0, s51, 100384
    s_nop 0
    buffer_load_dwordx4 v245, s[12:15], s48 offen lds
    s_add_u32 s48, s48, 65536
    s_waitcnt vmcnt(12)
    s_barrier
    s_add_u32 s42, s46, 36
    s_cmp_ge_u32 s42, 56
    s_cselect_b32 s47, 56, 0
    s_sub_u32 s42, s42, s47
    s_lshl_b32 s42, s42, 16
    s_add_u32 s44, s40, s42
    s_addc_u32 s45, s41, 0
    s_load_dword s43, s[44:45], 384
    s_load_dword s43, s[44:45], 448
    s_add_u32 m0, s55, 40960
    s_nop 0
    buffer_load_dwordx4 v249, s[80:83], s52 offen offset:0 sc1 lds
    buffer_load_dwordx4 v249, s[80:83], s52 offen offset:1024 sc1 lds
    s_add_u32 s52, s52, 8192
    s_add_u32 m0, s51, 107776
    s_nop 0
    buffer_load_dwordx4 v244, s[12:15], s48 offen lds
    s_add_u32 m0, s51, 108832
    s_nop 0
    buffer_load_dwordx4 v245, s[12:15], s48 offen lds
    s_add_u32 s48, s48, 65536
    s_add_u32 m0, s55, 49152
    s_nop 0
    buffer_load_dwordx4 v249, s[80:83], s52 offen offset:0 sc1 lds
    buffer_load_dwordx4 v249, s[80:83], s52 offen offset:1024 sc1 lds
    s_add_u32 s52, s52, 8192
    s_add_u32 m0, s51, 116224
    s_nop 0
    buffer_load_dwordx4 v244, s[12:15], s48 offen lds
    s_add_u32 m0, s51, 117280
    s_nop 0
    buffer_load_dwordx4 v245, s[12:15], s48 offen lds
    s_add_u32 s48, s48, 65536
    s_waitcnt vmcnt(12)
    s_barrier
    s_add_u32 s42, s46, 38
    s_cmp_ge_u32 s42, 56
    s_cselect_b32 s47, 56, 0
    s_sub_u32 s42, s42, s47
    s_lshl_b32 s42, s42, 16
    s_add_u32 s44, s40, s42
    s_addc_u32 s45, s41, 0
    s_load_dword s43, s[44:45], 384
    s_load_dword s43, s[44:45], 448
    s_add_u32 m0, s55, 57344
    s_nop 0
    buffer_load_dwordx4 v249, s[80:83], s52 offen offset:0 sc1 lds
    buffer_load_dwordx4 v249, s[80:83], s52 offen offset:1024 sc1 lds
    s_add_u32 s52, s52, 8192
    s_add_u32 m0, s51, 124672
    s_nop 0
    buffer_load_dwordx4 v244, s[12:15], s48 offen lds
    s_add_u32 m0, s51, 125728
    s_nop 0
    buffer_load_dwordx4 v245, s[12:15], s48 offen lds
    s_add_u32 s48, s48, 65536
    s_add_u32 m0, s55, 0
    s_nop 0
    buffer_load_dwordx4 v249, s[80:83], s52 offen offset:0 sc1 lds
    buffer_load_dwordx4 v249, s[80:83], s52 offen offset:1024 sc1 lds
    s_add_u32 s52, s52, 8192
    s_add_u32 m0, s51, 133120
    s_nop 0
    buffer_load_dwordx4 v244, s[12:15], s48 offen lds
    s_add_u32 m0, s51, 134176
    s_nop 0
    buffer_load_dwordx4 v245, s[12:15], s48 offen lds
    s_add_u32 s48, s48, 65536
    s_waitcnt vmcnt(12)
    s_barrier
    s_add_u32 s42, s46, 40
    s_cmp_ge_u32 s42, 56
    s_cselect_b32 s47, 56, 0
    s_sub_u32 s42, s42, s47
    s_lshl_b32 s42, s42, 16
    s_add_u32 s44, s40, s42
    s_addc_u32 s45, s41, 0
    s_load_dword s43, s[44:45], 384
    s_load_dword s43, s[44:45], 448
    s_add_u32 m0, s55, 8192
    s_nop 0
    buffer_load_dwordx4 v249, s[80:83], s52 offen offset:0 sc1 lds
    buffer_load_dwordx4 v249, s[80:83], s52 offen offset:1024 sc1 lds
    s_add_u32 s52, s52, 8192
    s_add_u32 m0, s51, 141568
    s_nop 0
    buffer_load_dwordx4 v244, s[12:15], s48 offen lds
    s_add_u32 m0, s51, 142624
    s_nop 0
    buffer_load_dwordx4 v245, s[12:15], s48 offen lds
    s_add_u32 s48, s48, 65536
    s_cmp_le_u32 s50, 4
    s_addc_u32 s52, s58, 4
    s_and_b32 s52, s52, 7
    s_mul_i32 s52, s52, 57344
    s_add_u32 s52, s52, s53
    s_add_u32 m0, s55, 16384
    s_nop 0
    buffer_load_dwordx4 v249, s[80:83], s52 offen offset:0 sc1 lds
    buffer_load_dwordx4 v249, s[80:83], s52 offen offset:1024 sc1 lds
    s_add_u32 s52, s52, 8192
    s_cmp_le_u32 s50, 4
    s_addc_u32 s48, s58, 4
    s_and_b32 s48, s48, 7
    s_mul_i32 s48, s48, 458752
    s_add_u32 s48, s48, s49
    s_add_u32 m0, s51, 65536
    s_nop 0
    buffer_load_dwordx4 v244, s[12:15], s48 offen lds
    s_add_u32 m0, s51, 66592
    s_nop 0
    buffer_load_dwordx4 v245, s[12:15], s48 offen lds
    s_add_u32 s48, s48, 65536
    s_waitcnt vmcnt(12)
    s_barrier
    s_add_u32 s42, s46, 42
    s_cmp_ge_u32 s42, 56
    s_cselect_b32 s47, 56, 0
    s_sub_u32 s42, s42, s47
    s_lshl_b32 s42, s42, 16
    s_add_u32 s44, s40, s42
    s_addc_u32 s45, s41, 0
    s_load_dword s43, s[44:45], 384
    s_load_dword s43, s[44:45], 448
    s_add_u32 m0, s55, 24576
    s_nop 0
    buffer_load_dwordx4 v249, s[80:83], s52 offen offset:0 sc1 lds
    buffer_load_dwordx4 v249, s[80:83], s52 offen offset:1024 sc1 lds
    s_add_u32 s52, s52, 8192
    s_add_u32 m0, s51, 73984
    s_nop 0
    buffer_load_dwordx4 v244, s[12:15], s48 offen lds
    s_add_u32 m0, s51, 75040
    s_nop 0
    buffer_load_dwordx4 v245, s[12:15], s48 offen lds
    s_add_u32 s48, s48, 65536
    s_add_u32 m0, s55, 32768
    s_nop 0
    buffer_load_dwordx4 v249, s[80:83], s52 offen offset:0 sc1 lds
    buffer_load_dwordx4 v249, s[80:83], s52 offen offset:1024 sc1 lds
    s_add_u32 s52, s52, 8192
    s_add_u32 m0, s51, 82432
    s_nop 0
    buffer_load_dwordx4 v244, s[12:15], s48 offen lds
    s_add_u32 m0, s51, 83488
    s_nop 0
    buffer_load_dwordx4 v245, s[12:15], s48 offen lds
    s_add_u32 s48, s48, 65536
    s_waitcnt vmcnt(12)
    s_barrier
    s_add_u32 s42, s46, 44
    s_cmp_ge_u32 s42, 56
    s_cselect_b32 s47, 56, 0
    s_sub_u32 s42, s42, s47
    s_lshl_b32 s42, s42, 16
    s_add_u32 s44, s40, s42
    s_addc_u32 s45, s41, 0
    s_load_dword s43, s[44:45], 384
    s_load_dword s43, s[44:45], 448
    s_add_u32 m0, s55, 40960
    s_nop 0
    buffer_load_dwordx4 v249, s[80:83], s52 offen offset:0 sc1 lds
    buffer_load_dwordx4 v249, s[80:83], s52 offen offset:1024 sc1 lds
    s_add_u32 s52, s52, 8192
    s_add_u32 m0, s51, 90880
    s_nop 0
    buffer_load_dwordx4 v244, s[12:15], s48 offen lds
    s_add_u32 m0, s51, 91936
    s_nop 0
    buffer_load_dwordx4 v245, s[12:15], s48 offen lds
    s_add_u32 s48, s48, 65536
    s_add_u32 m0, s55, 49152
    s_nop 0
    buffer_load_dwordx4 v249, s[80:83], s52 offen offset:0 sc1 lds
    buffer_load_dwordx4 v249, s[80:83], s52 offen offset:1024 sc1 lds
    s_add_u32 s52, s52, 8192
    s_add_u32 m0, s51, 99328
    s_nop 0
    buffer_load_dwordx4 v244, s[12:15], s48 offen lds
    s_add_u32 m0, s51, 100384
    s_nop 0
    buffer_load_dwordx4 v245, s[12:15], s48 offen lds
    s_add_u32 s48, s48, 65536
    s_waitcnt vmcnt(12)
    s_barrier
    s_add_u32 s42, s46, 46
    s_cmp_ge_u32 s42, 56
    s_cselect_b32 s47, 56, 0
    s_sub_u32 s42, s42, s47
    s_lshl_b32 s42, s42, 16
    s_add_u32 s44, s40, s42
    s_addc_u32 s45, s41, 0
    s_load_dword s43, s[44:45], 384
    s_load_dword s43, s[44:45], 448
    s_add_u32 m0, s55, 57344
    s_nop 0
    buffer_load_dwordx4 v249, s[80:83], s52 offen offset:0 sc1 lds
    buffer_load_dwordx4 v249, s[80:83], s52 offen offset:1024 sc1 lds
    s_add_u32 s52, s52, 8192
    s_add_u32 m0, s51, 107776
    s_nop 0
    buffer_load_dwordx4 v244, s[12:15], s48 offen lds
    s_add_u32 m0, s51, 108832
    s_nop 0
    buffer_load_dwordx4 v245, s[12:15], s48 offen lds
    s_add_u32 s48, s48, 65536
    s_add_u32 m0, s55, 0
    s_nop 0
    buffer_load_dwordx4 v249, s[80:83], s52 offen offset:0 sc1 lds
    buffer_load_dwordx4 v249, s[80:83], s52 offen offset:1024 sc1 lds
    s_add_u32 s52, s52, 8192
    s_add_u32 m0, s51, 116224
    s_nop 0
    buffer_load_dwordx4 v244, s[12:15], s48 offen lds
    s_add_u32 m0, s51, 117280
    s_nop 0
    buffer_load_dwordx4 v245, s[12:15], s48 offen lds
    s_add_u32 s48, s48, 65536
    s_waitcnt vmcnt(12)
    s_barrier
    s_add_u32 s42, s46, 48
    s_cmp_ge_u32 s42, 56
    s_cselect_b32 s47, 56, 0
    s_sub_u32 s42, s42, s47
    s_lshl_b32 s42, s42, 16
    s_add_u32 s44, s40, s42
    s_addc_u32 s45, s41, 0
    s_load_dword s43, s[44:45], 384
    s_load_dword s43, s[44:45], 448
    s_cmp_le_u32 s50, 5
    s_addc_u32 s52, s58, 5
    s_and_b32 s52, s52, 7
    s_mul_i32 s52, s52, 57344
    s_add_u32 s52, s52, s53
    s_add_u32 m0, s55, 8192
    s_nop 0
    buffer_load_dwordx4 v249, s[80:83], s52 offen offset:0 sc1 lds
    buffer_load_dwordx4 v249, s[80:83], s52 offen offset:1024 sc1 lds
    s_add_u32 s52, s52, 8192
    s_cmp_le_u32 s50, 5
    s_addc_u32 s48, s58, 5
    s_and_b32 s48, s48, 7
    s_mul_i32 s48, s48, 458752
    s_add_u32 s48, s48, s49
    s_add_u32 m0, s51, 124672
    s_nop 0
    buffer_load_dwordx4 v244, s[12:15], s48 offen lds
    s_add_u32 m0, s51, 125728
    s_nop 0
    buffer_load_dwordx4 v245, s[12:15], s48 offen lds
    s_add_u32 s48, s48, 65536
    s_add_u32 m0, s55, 16384
    s_nop 0
    buffer_load_dwordx4 v249, s[80:83], s52 offen offset:0 sc1 lds
    buffer_load_dwordx4 v249, s[80:83], s52 offen offset:1024 sc1 lds
    s_add_u32 s52, s52, 8192
    s_add_u32 m0, s51, 133120
    s_nop 0
    buffer_load_dwordx4 v244, s[12:15], s48 offen lds
    s_add_u32 m0, s51, 134176
    s_nop 0
    buffer_load_dwordx4 v245, s[12:15], s48 offen lds
    s_add_u32 s48, s48, 65536
    s_waitcnt vmcnt(12)
    s_barrier
    s_add_u32 s42, s46, 50
    s_cmp_ge_u32 s42, 56
    s_cselect_b32 s47, 56, 0
    s_sub_u32 s42, s42, s47
    s_lshl_b32 s42, s42, 16
    s_add_u32 s44, s40, s42
    s_addc_u32 s45, s41, 0
    s_load_dword s43, s[44:45], 384
    s_load_dword s43, s[44:45], 448
    s_add_u32 m0, s55, 24576
    s_nop 0
    buffer_load_dwordx4 v249, s[80:83], s52 offen offset:0 sc1 lds
    buffer_load_dwordx4 v249, s[80:83], s52 offen offset:1024 sc1 lds
    s_add_u32 s52, s52, 8192
    s_add_u32 m0, s51, 141568
    s_nop 0
    buffer_load_dwordx4 v244, s[12:15], s48 offen lds
    s_add_u32 m0, s51, 142624
    s_nop 0
    buffer_load_dwordx4 v245, s[12:15], s48 offen lds
    s_add_u32 s48, s48, 65536
    s_add_u32 m0, s55, 32768
    s_nop 0
    buffer_load_dwordx4 v249, s[80:83], s52 offen offset:0 sc1 lds
    buffer_load_dwordx4 v249, s[80:83], s52 offen offset:1024 sc1 lds
    s_add_u32 s52, s52, 8192
    s_add_u32 m0, s51, 65536
    s_nop 0
    buffer_load_dwordx4 v244, s[12:15], s48 offen lds
    s_add_u32 m0, s51, 66592
    s_nop 0
    buffer_load_dwordx4 v245, s[12:15], s48 offen lds
    s_add_u32 s48, s48, 65536
    s_waitcnt vmcnt(12)
    s_barrier
    s_add_u32 s42, s46, 52
    s_cmp_ge_u32 s42, 56
    s_cselect_b32 s47, 56, 0
    s_sub_u32 s42, s42, s47
    s_lshl_b32 s42, s42, 16
    s_add_u32 s44, s40, s42
    s_addc_u32 s45, s41, 0
    s_load_dword s43, s[44:45], 384
    s_load_dword s43, s[44:45], 448
    s_add_u32 m0, s55, 40960
    s_nop 0
    buffer_load_dwordx4 v249, s[80:83], s52 offen offset:0 sc1 lds
    buffer_load_dwordx4 v249, s[80:83], s52 offen offset:1024 sc1 lds
    s_add_u32 s52, s52, 8192
    s_add_u32 m0, s51, 73984
    s_nop 0
    buffer_load_dwordx4 v244, s[12:15], s48 offen lds
    s_add_u32 m0, s51, 75040
    s_nop 0
    buffer_load_dwordx4 v245, s[12:15], s48 offen lds
    s_add_u32 s48, s48, 65536
    s_add_u32 m0, s55, 49152
    s_nop 0
    buffer_load_dwordx4 v249, s[80:83], s52 offen offset:0 sc1 lds
    buffer_load_dwordx4 v249, s[80:83], s52 offen offset:1024 sc1 lds
    s_add_u32 s52, s52, 8192
    s_add_u32 m0, s51, 82432
    s_nop 0
    buffer_load_dwordx4 v244, s[12:15], s48 offen lds
    s_add_u32 m0, s51, 83488
    s_nop 0
    buffer_load_dwordx4 v245, s[12:15], s48 offen lds
    s_add_u32 s48, s48, 65536
    s_waitcnt vmcnt(12)
    s_barrier
    s_add_u32 s42, s46, 54
    s_cmp_ge_u32 s42, 56
    s_cselect_b32 s47, 56, 0
    s_sub_u32 s42, s42, s47
    s_lshl_b32 s42, s42, 16
    s_add_u32 s44, s40, s42
    s_addc_u32 s45, s41, 0
    s_load_dword s43, s[44:45], 384
    s_load_dword s43, s[44:45], 448
    s_add_u32 m0, s55, 57344
    s_nop 0
    buffer_load_dwordx4 v249, s[80:83], s52 offen offset:0 sc1 lds
    buffer_load_dwordx4 v249, s[80:83], s52 offen offset:1024 sc1 lds
    s_add_u32 s52, s52, 8192
    s_add_u32 m0, s51, 90880
    s_nop 0
    buffer_load_dwordx4 v244, s[12:15], s48 offen lds
    s_add_u32 m0, s51, 91936
    s_nop 0
    buffer_load_dwordx4 v245, s[12:15], s48 offen lds
    s_add_u32 s48, s48, 65536
    s_cmp_le_u32 s50, 6
    s_addc_u32 s52, s58, 6
    s_and_b32 s52, s52, 7
    s_mul_i32 s52, s52, 57344
    s_add_u32 s52, s52, s53
    s_add_u32 m0, s55, 0
    s_nop 0
    buffer_load_dwordx4 v249, s[80:83], s52 offen offset:0 sc1 lds
    buffer_load_dwordx4 v249, s[80:83], s52 offen offset:1024 sc1 lds
    s_add_u32 s52, s52, 8192
    s_cmp_le_u32 s50, 6
    s_addc_u32 s48, s58, 6
    s_and_b32 s48, s48, 7
    s_mul_i32 s48, s48, 458752
    s_add_u32 s48, s48, s49
    s_add_u32 m0, s51, 99328
    s_nop 0
    buffer_load_dwordx4 v244, s[12:15], s48 offen lds
    s_add_u32 m0, s51, 100384
    s_nop 0
    buffer_load_dwordx4 v245, s[12:15], s48 offen lds
    s_add_u32 s48, s48, 65536
    s_waitcnt vmcnt(12)
    s_barrier
    s_add_u32 m0, s55, 8192
    s_nop 0
    buffer_load_dwordx4 v249, s[80:83], s52 offen offset:0 sc1 lds
    buffer_load_dwordx4 v249, s[80:83], s52 offen offset:1024 sc1 lds
    s_add_u32 s52, s52, 8192
    s_add_u32 m0, s51, 107776
    s_nop 0
    buffer_load_dwordx4 v244, s[12:15], s48 offen lds
    s_add_u32 m0, s51, 108832
    s_nop 0
    buffer_load_dwordx4 v245, s[12:15], s48 offen lds
    s_add_u32 s48, s48, 65536
    s_add_u32 m0, s55, 16384
    s_nop 0
    buffer_load_dwordx4 v249, s[80:83], s52 offen offset:0 sc1 lds
    buffer_load_dwordx4 v249, s[80:83], s52 offen offset:1024 sc1 lds
    s_add_u32 s52, s52, 8192
    s_add_u32 m0, s51, 116224
    s_nop 0
    buffer_load_dwordx4 v244, s[12:15], s48 offen lds
    s_add_u32 m0, s51, 117280
    s_nop 0
    buffer_load_dwordx4 v245, s[12:15], s48 offen lds
    s_add_u32 s48, s48, 65536
    s_waitcnt vmcnt(12)
    s_barrier
    s_add_u32 m0, s55, 24576
    s_nop 0
    buffer_load_dwordx4 v249, s[80:83], s52 offen offset:0 sc1 lds
    buffer_load_dwordx4 v249, s[80:83], s52 offen offset:1024 sc1 lds
    s_add_u32 s52, s52, 8192
    s_add_u32 m0, s51, 124672
    s_nop 0
    buffer_load_dwordx4 v244, s[12:15], s48 offen lds
    s_add_u32 m0, s51, 125728
    s_nop 0
    buffer_load_dwordx4 v245, s[12:15], s48 offen lds
    s_add_u32 s48, s48, 65536
    s_add_u32 m0, s55, 32768
    s_nop 0
    buffer_load_dwordx4 v249, s[80:83], s52 offen offset:0 sc1 lds
    buffer_load_dwordx4 v249, s[80:83], s52 offen offset:1024 sc1 lds
    s_add_u32 s52, s52, 8192
    s_add_u32 m0, s51, 133120
    s_nop 0
    buffer_load_dwordx4 v244, s[12:15], s48 offen lds
    s_add_u32 m0, s51, 134176
    s_nop 0
    buffer_load_dwordx4 v245, s[12:15], s48 offen lds
    s_add_u32 s48, s48, 65536
    s_waitcnt vmcnt(12)
    s_barrier
    s_add_u32 m0, s55, 40960
    s_nop 0
    buffer_load_dwordx4 v249, s[80:83], s52 offen offset:0 sc1 lds
    buffer_load_dwordx4 v249, s[80:83], s52 offen offset:1024 sc1 lds
    s_add_u32 s52, s52, 8192
    s_add_u32 m0, s51, 141568
    s_nop 0
    buffer_load_dwordx4 v244, s[12:15], s48 offen lds
    s_add_u32 m0, s51, 142624
    s_nop 0
    buffer_load_dwordx4 v245, s[12:15], s48 offen lds
    s_add_u32 s48, s48, 65536
    s_add_u32 m0, s55, 49152
    s_nop 0
    buffer_load_dwordx4 v249, s[80:83], s52 offen offset:0 sc1 lds
    buffer_load_dwordx4 v249, s[80:83], s52 offen offset:1024 sc1 lds
    s_add_u32 s52, s52, 8192
    s_add_u32 m0, s51, 65536
    s_nop 0
    buffer_load_dwordx4 v244, s[12:15], s48 offen lds
    s_add_u32 m0, s51, 66592
    s_nop 0
    buffer_load_dwordx4 v245, s[12:15], s48 offen lds
    s_add_u32 s48, s48, 65536
    s_waitcnt vmcnt(12)
    s_barrier
    s_lshr_b32 s65, s69, 1
    s_lshl_b32 s65, s65, 3
    s_add_u32 s65, s65, s61
    s_lshl_b32 s64, s73, 4
    s_add_u32 s64, s64, s65
    s_lshl_b32 s64, s64, 2
    s_add_u32 s64, s64, s68
    s_lshl_b32 s64, s64, 12
    s_add_u32 s64, s64, 4194304
    s_and_b32 s65, s69, 1
    s_lshl_b32 s65, s65, 13
    s_add_u32 s64, s64, s65
    v_lshlrev_b32 v253, 7, v250
    s_mov_b64 exec, 0xffffffff
    buffer_load_dword v241, v253, s[80:83], s64 offen sc1
    s_mov_b64 exec, -1
    s_add_u32 m0, s19, 86400
    s_nop 0
    buffer_load_dwordx4 v10, s[8:11], s16 offen lds
    s_add_u32 m0, s19, 87424
    s_nop 0
    buffer_load_dwordx4 v11, s[8:11], s16 offen lds
    s_add_u32 m0, s19, 88448
    s_nop 0
    buffer_load_dwordx4 v12, s[8:11], s16 offen lds
    s_add_u32 s16, s16, 196608
    s_cmp_eq_u32 s16, s18
    s_cselect_b32 s16, s17, s16
    s_add_u32 m0, s19, 98816
    s_nop 0
    buffer_load_dwordx4 v10, s[8:11], s16 offen lds
    s_add_u32 m0, s19, 99840
    s_nop 0
    buffer_load_dwordx4 v11, s[8:11], s16 offen lds
    s_add_u32 m0, s19, 100864
    s_nop 0
    buffer_load_dwordx4 v12, s[8:11], s16 offen lds
    s_add_u32 s16, s16, 196608
    s_cmp_eq_u32 s16, s18
    s_cselect_b32 s16, s17, s16
    s_waitcnt vmcnt(7)
    s_barrier
    s_add_u32 m0, s19, 111232
    s_nop 0
    buffer_load_dwordx4 v10, s[8:11], s16 offen lds
    s_add_u32 m0, s19, 112256
    s_nop 0
    buffer_load_dwordx4 v11, s[8:11], s16 offen lds
    s_add_u32 m0, s19, 113280
    s_nop 0
    buffer_load_dwordx4 v12, s[8:11], s16 offen lds
    s_add_u32 s16, s16, 196608
    s_cmp_eq_u32 s16, s18
    s_cselect_b32 s16, s17, s16
    s_barrier
    s_cmp_eq_u32 s75, 1
    s_cbranch_scc1 L_fin
    s_mov_b32 s75, 1
    s_mov_b32 s59, s78
    s_mul_i32 s60, s59, s75
    s_lshl_b32 s21, s73, 18
    s_add_u32 s21, s21, 4194304
    s_lshl_b32 s64, s69, 11
    s_add_u32 s21, s21, s64
    s_lshl_b32 s23, s69, 12
    s_add_u32 s23, s23, 2048
    s_add_u32 s22, s21, 262144
    s_lshl_b32 s64, s70, 1
    s_lshl_b32 s65, s64, 14
    s_add_u32 s20, s21, s65
    s_sub_u32 s28, s73, 1
    s_and_b32 s28, s28, 15
    s_lshl_b32 s26, s28, 15
    s_add_u32 s26, s26, 73400320
    s_lshl_b32 s27, s64, 11
    v_lshlrev_b32 v246, 5, v250
    s_lshl_b32 s35, s70, 10
    s_add_u32 s35, s35, 75522048
    s_lshl_b32 s37, s70, 1
    s_sub_u32 s37, s37, 1
    s_and_b32 s37, s37, 15
    s_lshl_b32 s37, s37, 8
    s_add_u32 s37, s37, 75571328
    s_mov_b64 exec, 0xffffffff
pl_2550:
    buffer_load_dwordx4 v[240:243], v246, s[80:83], s35 offen sc1
    s_sub_u32 s79, s79, 1
    s_cbranch_scc1 L_abort
    s_waitcnt vmcnt(0)
    v_and_b32 v240, v240, v241
    v_and_b32 v242, v242, v243
    v_and_b32 v240, v240, v242
    v_cmp_ne_u32 vcc, 1, v240
    s_cbranch_vccnz pl_2550
    s_mov_b64 exec, -1
    s_cmp_lg_u32 s78, 0
    s_cbranch_scc1 pl_2550_acq
pl_2550_ok:
    s_lshr_b32 s64, s72, 1
    s_or_b32 s64, s64, s69
    s_cbranch_scc1 rl_2551
    s_lshl_b32 s64, s73, 1
    s_add_u32 s64, s64, s68
    s_lshl_b32 s64, s64, 7
    s_add_u32 s64, s64, 75571200
    v_mov_b32 v242, 0
    v_mov_b32 v243, 1
    s_mov_b64 exec, 1
    buffer_store_dword v243, v242, s[80:83], s64 offen sc0 sc1
    s_mov_b64 exec, -1
rl_2551:
    s_mov_b64 exec, 1
pl_2552:
    buffer_load_dword v240, v246, s[80:83], s37 offen sc1
    s_sub_u32 s79, s79, 1
    s_cbranch_scc1 L_abort
    s_waitcnt vmcnt(0)
    v_cmp_ne_u32 vcc, 1, v240
    s_cbranch_vccnz pl_2552
    s_mov_b64 exec, -1
    s_cmp_lg_u32 s78, 0
    s_cbranch_scc1 pl_2552_acq
pl_2552_ok:
    s_lshr_b32 s40, s2, 3
    s_lshl_b32 s40, s40, 2
    s_add_u32 s40, s40, s69
    s_and_b32 s41, s40, 63
    s_mul_i32 s41, s41, 6144
    s_lshr_b32 s40, s40, 6
    s_lshl_b32 s40, s40, 10
    s_add_u32 s40, s40, s41
    s_add_u32 s40, s40, 384
    s_add_u32 s40, s86, s40
    s_addc_u32 s41, s87, 0
    s_cmp_lg_u32 s69, 0
    s_cbranch_scc1 nh_2553
    s_add_u32 s64, s27, 0
    s_and_b32 s64, s64, 0x7fff
    s_mov_b32 m0, 18432
    s_add_u32 s64, s64, s26
    buffer_load_dwordx4 v249, s[80:83], s64 offen sc1 lds
nh_2553:
    s_add_u32 m0, s23, 18432
    s_nop 0
    buffer_load_dwordx4 v249, s[80:83], s20 offen offset:0 sc1 lds
    s_add_u32 m0, s23, 19456
    s_nop 0
    buffer_load_dwordx4 v249, s[80:83], s20 offen offset:1024 sc1 lds
    s_add_u32 s20, s20, 8192
    s_cmp_eq_u32 s20, s22
    s_cselect_b32 s20, s21, s20
    s_cmp_lg_u32 s69, 1
    s_cbranch_scc1 nh_2554
    s_add_u32 s64, s27, 1024
    s_and_b32 s64, s64, 0x7fff
    s_mov_b32 m0, 19456
    s_add_u32 s64, s64, s26
    buffer_load_dwordx4 v249, s[80:83], s64 offen sc1 lds
nh_2554:
    s_add_u32 m0, s23, 19456
    s_nop 0
    buffer_load_dwordx4 v249, s[80:83], s20 offen offset:0 sc1 lds
    s_add_u32 m0, s23, 20480
    s_nop 0
    buffer_load_dwordx4 v249, s[80:83], s20 offen offset:1024 sc1 lds
    s_add_u32 s20, s20, 8192
    s_cmp_eq_u32 s20, s22
    s_cselect_b32 s20, s21, s20
    s_cmp_lg_u32 s69, 2
    s_cbranch_scc1 nh_2555
    s_add_u32 s64, s27, 2048
    s_and_b32 s64, s64, 0x7fff
    s_mov_b32 m0, 36864
    s_add_u32 s64, s64, s26
    buffer_load_dwordx4 v249, s[80:83], s64 offen sc1 lds
nh_2555:
    s_add_u32 m0, s23, 36864
    s_nop 0
    buffer_load_dwordx4 v249, s[80:83], s20 offen offset:0 sc1 lds
    s_add_u32 m0, s23, 37888
    s_nop 0
    buffer_load_dwordx4 v249, s[80:83], s20 offen offset:1024 sc1 lds
    s_add_u32 s20, s20, 8192
    s_cmp_eq_u32 s20, s22
    s_cselect_b32 s20, s21, s20
    s_waitcnt vmcnt(4)
    s_barrier
    s_cmp_lg_u32 s69, 3
    s_cbranch_scc1 nh_2556
    s_add_u32 s64, s27, 3072
    s_and_b32 s64, s64, 0x7fff
    s_mov_b32 m0, 37888
    s_add_u32 s64, s64, s26
    buffer_load_dwordx4 v249, s[80:83], s64 offen sc1 lds
nh_2556:
    s_add_u32 m0, s23, 37888
    s_nop 0
    buffer_load_dwordx4 v249, s[80:83], s20 offen offset:0 sc1 lds
    s_add_u32 m0, s23, 38912
    s_nop 0
    buffer_load_dwordx4 v249, s[80:83], s20 offen offset:1024 sc1 lds
    s_add_u32 s20, s20, 8192
    s_cmp_eq_u32 s20, s22
    s_cselect_b32 s20, s21, s20
    s_add_u32 m0, s19, 123648
    s_nop 0
    buffer_load_dwordx4 v10, s[8:11], s16 offen lds
    s_add_u32 m0, s19, 124672
    s_nop 0
    buffer_load_dwordx4 v11, s[8:11], s16 offen lds
    s_add_u32 m0, s19, 125696
    s_nop 0
    buffer_load_dwordx4 v12, s[8:11], s16 offen lds
    s_add_u32 s16, s16, 196608
    s_cmp_eq_u32 s16, s18
    s_cselect_b32 s16, s17, s16
    s_lshl_b32 s42, s70, 1
    s_add_u32 s42, s42, 2
    s_and_b32 s42, s42, 15
    s_mul_i32 s42, s42, 393216
    s_add_u32 s44, s40, s42
    s_addc_u32 s45, s41, 0
    s_load_dword s43, s[44:45], 0
    s_load_dword s43, s[44:45], 64
    s_load_dword s43, s[44:45], 2048
    s_load_dword s43, s[44:45], 2112
    s_load_dword s43, s[44:45], 4096
    s_load_dword s43, s[44:45], 4160
    s_lshl_b32 s42, s70, 1
    s_add_u32 s42, s42, 3
    s_and_b32 s42, s42, 15
    s_mul_i32 s42, s42, 393216
    s_add_u32 s44, s40, s42
    s_addc_u32 s45, s41, 0
    s_load_dword s43, s[44:45], 0
    s_load_dword s43, s[44:45], 64
    s_load_dword s43, s[44:45], 2048
    s_load_dword s43, s[44:45], 2112
    s_load_dword s43, s[44:45], 4096
    s_load_dword s43, s[44:45], 4160
    s_waitcnt vmcnt(5)
    s_barrier
    s_cmp_lg_u32 s69, 0
    s_cbranch_scc1 nh_2557
    s_add_u32 s64, s27, 4096
    s_and_b32 s64, s64, 0x7fff
    s_mov_b32 m0, 55296
    s_add_u32 s64, s64, s26
    buffer_load_dwordx4 v249, s[80:83], s64 offen sc1 lds
nh_2557:
    s_add_u32 m0, s23, 55296
    s_nop 0
    buffer_load_dwordx4 v249, s[80:83], s20 offen offset:0 sc1 lds
    s_add_u32 m0, s23, 56320
    s_nop 0
    buffer_load_dwordx4 v249, s[80:83], s20 offen offset:1024 sc1 lds
    s_add_u32 s20, s20, 8192
    s_cmp_eq_u32 s20, s22
    s_cselect_b32 s20, s21, s20
    s_add_u32 m0, s19, 136064
    s_nop 0
    buffer_load_dwordx4 v10, s[8:11], s16 offen lds
    s_add_u32 m0, s19, 137088
    s_nop 0
    buffer_load_dwordx4 v11, s[8:11], s16 offen lds
    s_add_u32 m0, s19, 138112
    s_nop 0
    buffer_load_dwordx4 v12, s[8:11], s16 offen lds
    s_add_u32 s16, s16, 196608
    s_cmp_eq_u32 s16, s18
    s_cselect_b32 s16, s17, s16
    s_cmp_lg_u32 s69, 1
    s_cbranch_scc1 nh_2558
    s_add_u32 s64, s27, 5120
    s_and_b32 s64, s64, 0x7fff
    s_mov_b32 m0, 56320
    s_add_u32 s64, s64, s26
    buffer_load_dwordx4 v249, s[80:83], s64 offen sc1 lds
nh_2558:
    s_add_u32 m0, s23, 56320
    s_nop 0
    buffer_load_dwordx4 v249, s[80:83], s20 offen offset:0 sc1 lds
    s_add_u32 m0, s23, 57344
    s_nop 0
    buffer_load_dwordx4 v249, s[80:83], s20 offen offset:1024 sc1 lds
    s_add_u32 s20, s20, 8192
    s_cmp_eq_u32 s20, s22
    s_cselect_b32 s20, s21, s20
    s_add_u32 m0, s19, 73984
    s_nop 0
    buffer_load_dwordx4 v10, s[8:11], s16 offen lds
    s_add_u32 m0, s19, 75008
    s_nop 0
    buffer_load_dwordx4 v11, s[8:11], s16 offen lds
    s_add_u32 m0, s19, 76032
    s_nop 0
    buffer_load_dwordx4 v12, s[8:11], s16 offen lds
    s_add_u32 s16, s16, 196608
    s_cmp_eq_u32 s16, s18
    s_cselect_b32 s16, s17, s16
    s_cmp_lg_u32 s69, 2
    s_cbranch_scc1 nh_2559
    s_add_u32 s64, s27, 6144
    s_and_b32 s64, s64, 0x7fff
    s_mov_b32 m0, 0
    s_add_u32 s64, s64, s26
    buffer_load_dwordx4 v249, s[80:83], s64 offen sc1 lds
nh_2559:
    s_add_u32 m0, s23, 0
    s_nop 0
    buffer_load_dwordx4 v249, s[80:83], s20 offen offset:0 sc1 lds
    s_add_u32 m0, s23, 1024
    s_nop 0
    buffer_load_dwordx4 v249, s[80:83], s20 offen offset:1024 sc1 lds
    s_add_u32 s20, s20, 8192
    s_cmp_eq_u32 s20, s22
    s_cselect_b32 s20, s21, s20
    s_lshl_b32 s42, s70, 1
    s_add_u32 s42, s42, 4
    s_and_b32 s42, s42, 15
    s_mul_i32 s42, s42, 393216
    s_add_u32 s44, s40, s42
    s_addc_u32 s45, s41, 0
    s_load_dword s43, s[44:45], 0
    s_load_dword s43, s[44:45], 64
    s_load_dword s43, s[44:45], 2048
    s_load_dword s43, s[44:45], 2112
    s_load_dword s43, s[44:45], 4096
    s_load_dword s43, s[44:45], 4160
    s_waitcnt vmcnt(7)
    s_barrier
    s_add_u32 m0, s19, 86400
    s_nop 0
    buffer_load_dwordx4 v10, s[8:11], s16 offen lds
    s_add_u32 m0, s19, 87424
    s_nop 0
    buffer_load_dwordx4 v11, s[8:11], s16 offen lds
    s_add_u32 m0, s19, 88448
    s_nop 0
    buffer_load_dwordx4 v12, s[8:11], s16 offen lds
    s_add_u32 s16, s16, 196608
    s_cmp_eq_u32 s16, s18
    s_cselect_b32 s16, s17, s16
    s_cmp_lg_u32 s69, 3
    s_cbranch_scc1 nh_2560
    s_add_u32 s64, s27, 7168
    s_and_b32 s64, s64, 0x7fff
    s_mov_b32 m0, 1024
    s_add_u32 s64, s64, s26
    buffer_load_dwordx4 v249, s[80:83], s64 offen sc1 lds
nh_2560:
    s_add_u32 m0, s23, 1024
    s_nop 0
    buffer_load_dwordx4 v249, s[80:83], s20 offen offset:0 sc1 lds
    s_add_u32 m0, s23, 2048
    s_nop 0
    buffer_load_dwordx4 v249, s[80:83], s20 offen offset:1024 sc1 lds
    s_add_u32 s20, s20, 8192
    s_cmp_eq_u32 s20, s22
    s_cselect_b32 s20, s21, s20
    s_add_u32 m0, s19, 98816
    s_nop 0
    buffer_load_dwordx4 v10, s[8:11], s16 offen lds
    s_add_u32 m0, s19, 99840
    s_nop 0
    buffer_load_dwordx4 v11, s[8:11], s16 offen lds
    s_add_u32 m0, s19, 100864
    s_nop 0
    buffer_load_dwordx4 v12, s[8:11], s16 offen lds
    s_add_u32 s16, s16, 196608
    s_cmp_eq_u32 s16, s18
    s_cselect_b32 s16, s17, s16
    s_cmp_lg_u32 s69, 0
    s_cbranch_scc1 nh_2561
    s_add_u32 s64, s27, 8192
    s_and_b32 s64, s64, 0x7fff
    s_mov_b32 m0, 18432
    s_add_u32 s64, s64, s26
    buffer_load_dwordx4 v249, s[80:83], s64 offen sc1 lds
nh_2561:
    s_add_u32 m0, s23, 18432
    s_nop 0
    buffer_load_dwordx4 v249, s[80:83], s20 offen offset:0 sc1 lds
    s_add_u32 m0, s23, 19456
    s_nop 0
    buffer_load_dwordx4 v249, s[80:83], s20 offen offset:1024 sc1 lds
    s_add_u32 s20, s20, 8192
    s_cmp_eq_u32 s20, s22
    s_cselect_b32 s20, s21, s20
    s_add_u32 m0, s19, 111232
    s_nop 0
    buffer_load_dwordx4 v10, s[8:11], s16 offen lds
    s_add_u32 m0, s19, 112256
    s_nop 0
    buffer_load_dwordx4 v11, s[8:11], s16 offen lds
    s_add_u32 m0, s19, 113280
    s_nop 0
    buffer_load_dwordx4 v12, s[8:11], s16 offen lds
    s_add_u32 s16, s16, 196608
    s_cmp_eq_u32 s16, s18
    s_cselect_b32 s16, s17, s16
    s_lshl_b32 s42, s70, 1
    s_add_u32 s42, s42, 5
    s_and_b32 s42, s42, 15
    s_mul_i32 s42, s42, 393216
    s_add_u32 s44, s40, s42
    s_addc_u32 s45, s41, 0
    s_load_dword s43, s[44:45], 0
    s_load_dword s43, s[44:45], 64
    s_load_dword s43, s[44:45], 2048
    s_load_dword s43, s[44:45], 2112
    s_load_dword s43, s[44:45], 4096
    s_load_dword s43, s[44:45], 4160
    s_waitcnt vmcnt(10)
    s_barrier
    s_cmp_lg_u32 s69, 1
    s_cbranch_scc1 nh_2562
    s_add_u32 s64, s27, 9216
    s_and_b32 s64, s64, 0x7fff
    s_mov_b32 m0, 19456
    s_add_u32 s64, s64, s26
    buffer_load_dwordx4 v249, s[80:83], s64 offen sc1 lds
nh_2562:
    s_add_u32 m0, s23, 19456
    s_nop 0
    buffer_load_dwordx4 v249, s[80:83], s20 offen offset:0 sc1 lds
    s_add_u32 m0, s23, 20480
    s_nop 0
    buffer_load_dwordx4 v249, s[80:83], s20 offen offset:1024 sc1 lds
    s_add_u32 s20, s20, 8192
    s_cmp_eq_u32 s20, s22
    s_cselect_b32 s20, s21, s20
    s_add_u32 m0, s19, 123648
    s_nop 0
    buffer_load_dwordx4 v10, s[8:11], s16 offen lds
    s_add_u32 m0, s19, 124672
    s_nop 0
    buffer_load_dwordx4 v11, s[8:11], s16 offen lds
    s_add_u32 m0, s19, 125696
    s_nop 0
    buffer_load_dwordx4 v12, s[8:11], s16 offen lds
    s_add_u32 s16, s16, 196608
    s_cmp_eq_u32 s16, s18
    s_cselect_b32 s16, s17, s16
    s_cmp_lg_u32 s69, 2
    s_cbranch_scc1 nh_2563
    s_add_u32 s64, s27, 10240
    s_and_b32 s64, s64, 0x7fff
    s_mov_b32 m0, 36864
    s_add_u32 s64, s64, s26
    buffer_load_dwordx4 v249, s[80:83], s64 offen sc1 lds
nh_2563:
    s_add_u32 m0, s23, 36864
    s_nop 0
    buffer_load_dwordx4 v249, s[80:83], s20 offen offset:0 sc1 lds
    s_add_u32 m0, s23, 37888
    s_nop 0
    buffer_load_dwordx4 v249, s[80:83], s20 offen offset:1024 sc1 lds
    s_add_u32 s20, s20, 8192
    s_cmp_eq_u32 s20, s22
    s_cselect_b32 s20, s21, s20
    s_add_u32 m0, s19, 136064
    s_nop 0
    buffer_load_dwordx4 v10, s[8:11], s16 offen lds
    s_add_u32 m0, s19, 137088
    s_nop 0
    buffer_load_dwordx4 v11, s[8:11], s16 offen lds
    s_add_u32 m0, s19, 138112
    s_nop 0
    buffer_load_dwordx4 v12, s[8:11], s16 offen lds
    s_add_u32 s16, s16, 196608
    s_cmp_eq_u32 s16, s18
    s_cselect_b32 s16, s17, s16
    s_cmp_lg_u32 s69, 3
    s_cbranch_scc1 nh_2564
    s_add_u32 s64, s27, 11264
    s_and_b32 s64, s64, 0x7fff
    s_mov_b32 m0, 37888
    s_add_u32 s64, s64, s26
    buffer_load_dwordx4 v249, s[80:83], s64 offen sc1 lds
nh_2564:
    s_add_u32 m0, s23, 37888
    s_nop 0
    buffer_load_dwordx4 v249, s[80:83], s20 offen offset:0 sc1 lds
    s_add_u32 m0, s23, 38912
    s_nop 0
    buffer_load_dwordx4 v249, s[80:83], s20 offen offset:1024 sc1 lds
    s_add_u32 s20, s20, 8192
    s_cmp_eq_u32 s20, s22
    s_cselect_b32 s20, s21, s20
    s_lshl_b32 s42, s70, 1
    s_add_u32 s42, s42, 6
    s_and_b32 s42, s42, 15
    s_mul_i32 s42, s42, 393216
    s_add_u32 s44, s40, s42
    s_addc_u32 s45, s41, 0
    s_load_dword s43, s[44:45], 0
    s_load_dword s43, s[44:45], 64
    s_load_dword s43, s[44:45], 2048
    s_load_dword s43, s[44:45], 2112
    s_load_dword s43, s[44:45], 4096
    s_load_dword s43, s[44:45], 4160
    s_waitcnt vmcnt(12)
    s_barrier
    s_add_u32 m0, s19, 73984
    s_nop 0
    buffer_load_dwordx4 v10, s[8:11], s16 offen lds
    s_add_u32 m0, s19, 75008
    s_nop 0
    buffer_load_dwordx4 v11, s[8:11], s16 offen lds
    s_add_u32 m0, s19, 76032
    s_nop 0
    buffer_load_dwordx4 v12, s[8:11], s16 offen lds
    s_add_u32 s16, s16, 196608
    s_cmp_eq_u32 s16, s18
    s_cselect_b32 s16, s17, s16
    s_cmp_lg_u32 s69, 0
    s_cbranch_scc1 nh_2565
    s_add_u32 s64, s27, 12288
    s_and_b32 s64, s64, 0x7fff
    s_mov_b32 m0, 55296
    s_add_u32 s64, s64, s26
    buffer_load_dwordx4 v249, s[80:83], s64 offen sc1 lds
nh_2565:
    s_add_u32 m0, s23, 55296
    s_nop 0
    buffer_load_dwordx4 v249, s[80:83], s20 offen offset:0 sc1 lds
    s_add_u32 m0, s23, 56320
    s_nop 0
    buffer_load_dwordx4 v249, s[80:83], s20 offen offset:1024 sc1 lds
    s_add_u32 s20, s20, 8192
    s_cmp_eq_u32 s20, s22
    s_cselect_b32 s20, s21, s20
    s_add_u32 m0, s19, 86400
    s_nop 0
    buffer_load_dwordx4 v10, s[8:11], s16 offen lds
    s_add_u32 m0, s19, 87424
    s_nop 0
    buffer_load_dwordx4 v11, s[8:11], s16 offen lds
    s_add_u32 m0, s19, 88448
    s_nop 0
    buffer_load_dwordx4 v12, s[8:11], s16 offen lds
    s_add_u32 s16, s16, 196608
    s_cmp_eq_u32 s16, s18
    s_cselect_b32 s16, s17, s16
    s_cmp_lg_u32 s69, 1
    s_cbranch_scc1 nh_2566
    s_add_u32 s64, s27, 13312
    s_and_b32 s64, s64, 0x7fff
    s_mov_b32 m0, 56320
    s_add_u32 s64, s64, s26
    buffer_load_dwordx4 v249, s[80:83], s64 offen sc1 lds
nh_2566:
    s_add_u32 m0, s23, 56320
    s_nop 0
    buffer_load_dwordx4 v249, s[80:83], s20 offen offset:0 sc1 lds
    s_add_u32 m0, s23, 57344
    s_nop 0
    buffer_load_dwordx4 v249, s[80:83], s20 offen offset:1024 sc1 lds
    s_add_u32 s20, s20, 8192
    s_cmp_eq_u32 s20, s22
    s_cselect_b32 s20, s21, s20
    s_lshl_b32 s42, s70, 1
    s_add_u32 s42, s42, 7
    s_and_b32 s42, s42, 15
    s_mul_i32 s42, s42, 393216
    s_add_u32 s44, s40, s42
    s_addc_u32 s45, s41, 0
    s_load_dword s43, s[44:45], 0
    s_load_dword s43, s[44:45], 64
    s_load_dword s43, s[44:45], 2048
    s_load_dword s43, s[44:45], 2112
    s_load_dword s43, s[44:45], 4096
    s_load_dword s43, s[44:45], 4160
    s_waitcnt vmcnt(12)
    s_barrier
    s_add_u32 m0, s19, 98816
    s_nop 0
    buffer_load_dwordx4 v10, s[8:11], s16 offen lds
    s_add_u32 m0, s19, 99840
    s_nop 0
    buffer_load_dwordx4 v11, s[8:11], s16 offen lds
    s_add_u32 m0, s19, 100864
    s_nop 0
    buffer_load_dwordx4 v12, s[8:11], s16 offen lds
    s_add_u32 s16, s16, 196608
    s_cmp_eq_u32 s16, s18
    s_cselect_b32 s16, s17, s16
    s_cmp_lg_u32 s69, 2
    s_cbranch_scc1 nh_2567
    s_add_u32 s64, s27, 14336
    s_and_b32 s64, s64, 0x7fff
    s_mov_b32 m0, 0
    s_add_u32 s64, s64, s26
    buffer_load_dwordx4 v249, s[80:83], s64 offen sc1 lds
nh_2567:
    s_add_u32 m0, s23, 0
    s_nop 0
    buffer_load_dwordx4 v249, s[80:83], s20 offen offset:0 sc1 lds
    s_add_u32 m0, s23, 1024
    s_nop 0
    buffer_load_dwordx4 v249, s[80:83], s20 offen offset:1024 sc1 lds
    s_add_u32 s20, s20, 8192
    s_cmp_eq_u32 s20, s22
    s_cselect_b32 s20, s21, s20
    s_add_u32 m0, s19, 111232
    s_nop 0
    buffer_load_dwordx4 v10, s[8:11], s16 offen lds
    s_add_u32 m0, s19, 112256
    s_nop 0
    buffer_load_dwordx4 v11, s[8:11], s16 offen lds
    s_add_u32 m0, s19, 113280
    s_nop 0
    buffer_load_dwordx4 v12, s[8:11], s16 offen lds
    s_add_u32 s16, s16, 196608
    s_cmp_eq_u32 s16, s18
    s_cselect_b32 s16, s17, s16
    s_cmp_lg_u32 s69, 3
    s_cbranch_scc1 nh_2568
    s_add_u32 s64, s27, 15360
    s_and_b32 s64, s64, 0x7fff
    s_mov_b32 m0, 1024
    s_add_u32 s64, s64, s26
    buffer_load_dwordx4 v249, s[80:83], s64 offen sc1 lds
nh_2568:
    s_add_u32 m0, s23, 1024
    s_nop 0
    buffer_load_dwordx4 v249, s[80:83], s20 offen offset:0 sc1 lds
    s_add_u32 m0, s23, 2048
    s_nop 0
    buffer_load_dwordx4 v249, s[80:83], s20 offen offset:1024 sc1 lds
    s_add_u32 s20, s20, 8192
    s_cmp_eq_u32 s20, s22
    s_cselect_b32 s20, s21, s20
    s_lshl_b32 s42, s70, 1
    s_add_u32 s42, s42, 8
    s_and_b32 s42, s42, 15
    s_mul_i32 s42, s42, 393216
    s_add_u32 s44, s40, s42
    s_addc_u32 s45, s41, 0
    s_load_dword s43, s[44:45], 0
    s_load_dword s43, s[44:45], 64
    s_load_dword s43, s[44:45], 2048
    s_load_dword s43, s[44:45], 2112
    s_load_dword s43, s[44:45], 4096
    s_load_dword s43, s[44:45], 4160
    s_lshl_b32 s64, s28, 15
    s_add_u32 s64, s64, 71829248
    v_lshlrev_b32 v81, 4, v252
    v_lshl_add_u32 v81, v251, 13, v81
    s_cmp_lg_u32 s69, 3
    s_cbranch_scc1 hs_2569
    buffer_load_dwordx4 v[64:67], v81, s[80:83], s64 offen offset:0 sc1
    buffer_load_dwordx4 v[68:71], v81, s[80:83], s64 offen offset:2048 sc1
    s_add_u32 s64, s64, 4096
    buffer_load_dwordx4 v[72:75], v81, s[80:83], s64 offen offset:0 sc1
    buffer_load_dwordx4 v[76:79], v81, s[80:83], s64 offen offset:2048 sc1
hs_2569:
    s_lshl_b32 s29, s73, 15
    s_lshl_b32 s65, s69, 9
    s_add_u32 s29, s29, s65
    s_add_u32 s29, s29, 71827456
    v_and_b32 v80, 31, v250
    v_lshlrev_b32 v80, 4, v80
    v_lshrrev_b32 v253, 5, v250
    v_lshl_add_u32 v80, v253, 14, v80
    s_waitcnt vmcnt(12)
    s_barrier
    s_add_u32 m0, s19, 123648
    s_nop 0
    buffer_load_dwordx4 v10, s[8:11], s16 offen lds
    s_add_u32 m0, s19, 124672
    s_nop 0
    buffer_load_dwordx4 v11, s[8:11], s16 offen lds
    s_add_u32 m0, s19, 125696
    s_nop 0
    buffer_load_dwordx4 v12, s[8:11], s16 offen lds
    s_add_u32 s16, s16, 196608
    s_cmp_eq_u32 s16, s18
    s_cselect_b32 s16, s17, s16
    s_cmp_lg_u32 s69, 0
    s_cbranch_scc1 nh_2570
    s_add_u32 s64, s27, 16384
    s_and_b32 s64, s64, 0x7fff
    s_mov_b32 m0, 18432
    s_add_u32 s64, s64, s26
    buffer_load_dwordx4 v249, s[80:83], s64 offen sc1 lds
nh_2570:
    s_add_u32 m0, s23, 18432
    s_nop 0
    buffer_load_dwordx4 v249, s[80:83], s20 offen offset:0 sc1 lds
    s_add_u32 m0, s23, 19456
    s_nop 0
    buffer_load_dwordx4 v249, s[80:83], s20 offen offset:1024 sc1 lds
    s_add_u32 s20, s20, 8192
    s_cmp_eq_u32 s20, s22
    s_cselect_b32 s20, s21, s20
    s_add_u32 m0, s19, 136064
    s_nop 0
    buffer_load_dwordx4 v10, s[8:11], s16 offen lds
    s_add_u32 m0, s19, 137088
    s_nop 0
    buffer_load_dwordx4 v11, s[8:11], s16 offen lds
    s_add_u32 m0, s19, 138112
    s_nop 0
    buffer_load_dwordx4 v12, s[8:11], s16 offen lds
    s_add_u32 s16, s16, 196608
    s_cmp_eq_u32 s16, s18
    s_cselect_b32 s16, s17, s16
    s_cmp_lg_u32 s69, 1
    s_cbranch_scc1 nh_2571
    s_add_u32 s64, s27, 17408
    s_and_b32 s64, s64, 0x7fff
    s_mov_b32 m0, 19456
    s_add_u32 s64, s64, s26
    buffer_load_dwordx4 v249, s[80:83], s64 offen sc1 lds
nh_2571:
    s_add_u32 m0, s23, 19456
    s_nop 0
    buffer_load_dwordx4 v249, s[80:83], s20 offen offset:0 sc1 lds
    s_add_u32 m0, s23, 20480
    s_nop 0
    buffer_load_dwordx4 v249, s[80:83], s20 offen offset:1024 sc1 lds
    s_add_u32 s20, s20, 8192
    s_cmp_eq_u32 s20, s22
    s_cselect_b32 s20, s21, s20
    s_lshl_b32 s42, s70, 1
    s_add_u32 s42, s42, 9
    s_and_b32 s42, s42, 15
    s_mul_i32 s42, s42, 393216
    s_add_u32 s44, s40, s42
    s_addc_u32 s45, s41, 0
    s_load_dword s43, s[44:45], 0
    s_load_dword s43, s[44:45], 64
    s_load_dword s43, s[44:45], 2048
    s_load_dword s43, s[44:45], 2112
    s_load_dword s43, s[44:45], 4096
    s_load_dword s43, s[44:45], 4160
    buffer_load_dwordx4 v[32:35], v80, s[80:83], s29 offen offset:0 sc1
    buffer_load_dwordx4 v[36:39], v80, s[80:83], s29 offen offset:2048 sc1
    s_add_u32 s29, s29, 4096
    s_waitcnt vmcnt(14)
    s_barrier
    s_add_u32 m0, s19, 73984
    s_nop 0
    buffer_load_dwordx4 v10, s[8:11], s16 offen lds
    s_add_u32 m0, s19, 75008
    s_nop 0
    buffer_load_dwordx4 v11, s[8:11], s16 offen lds
    s_add_u32 m0, s19, 76032
    s_nop 0
    buffer_load_dwordx4 v12, s[8:11], s16 offen lds
    s_add_u32 s16, s16, 196608
    s_cmp_eq_u32 s16, s18
    s_cselect_b32 s16, s17, s16
    s_cmp_lg_u32 s69, 2
    s_cbranch_scc1 nh_2572
    s_add_u32 s64, s27, 18432
    s_and_b32 s64, s64, 0x7fff
    s_mov_b32 m0, 36864
    s_add_u32 s64, s64, s26
    buffer_load_dwordx4 v249, s[80:83], s64 offen sc1 lds
nh_2572:
    s_add_u32 m0, s23, 36864
    s_nop 0
    buffer_load_dwordx4 v249, s[80:83], s20 offen offset:0 sc1 lds
    s_add_u32 m0, s23, 37888
    s_nop 0
    buffer_load_dwordx4 v249, s[80:83], s20 offen offset:1024 sc1 lds
    s_add_u32 s20, s20, 8192
    s_cmp_eq_u32 s20, s22
    s_cselect_b32 s20, s21, s20
    s_add_u32 m0, s19, 86400
    s_nop 0
    buffer_load_dwordx4 v10, s[8:11], s16 offen lds
    s_add_u32 m0, s19, 87424
    s_nop 0
    buffer_load_dwordx4 v11, s[8:11], s16 offen lds
    s_add_u32 m0, s19, 88448
    s_nop 0
    buffer_load_dwordx4 v12, s[8:11], s16 offen lds
    s_add_u32 s16, s16, 196608
    s_cmp_eq_u32 s16, s18
    s_cselect_b32 s16, s17, s16
    s_cmp_lg_u32 s69, 3
    s_cbranch_scc1 nh_2573
    s_add_u32 s64, s27, 19456
    s_and_b32 s64, s64, 0x7fff
    s_mov_b32 m0, 37888
    s_add_u32 s64, s64, s26
    buffer_load_dwordx4 v249, s[80:83], s64 offen sc1 lds
nh_2573:
    s_add_u32 m0, s23, 37888
    s_nop 0
    buffer_load_dwordx4 v249, s[80:83], s20 offen offset:0 sc1 lds
    s_add_u32 m0, s23, 38912
    s_nop 0
    buffer_load_dwordx4 v249, s[80:83], s20 offen offset:1024 sc1 lds
    s_add_u32 s20, s20, 8192
    s_cmp_eq_u32 s20, s22
    s_cselect_b32 s20, s21, s20
    s_lshl_b32 s42, s70, 1
    s_add_u32 s42, s42, 10
    s_and_b32 s42, s42, 15
    s_mul_i32 s42, s42, 393216
    s_add_u32 s44, s40, s42
    s_addc_u32 s45, s41, 0
    s_load_dword s43, s[44:45], 0
    s_load_dword s43, s[44:45], 64
    s_load_dword s43, s[44:45], 2048
    s_load_dword s43, s[44:45], 2112
    s_load_dword s43, s[44:45], 4096
    s_load_dword s43, s[44:45], 4160
    buffer_load_dwordx4 v[40:43], v80, s[80:83], s29 offen offset:0 sc1
    buffer_load_dwordx4 v[44:47], v80, s[80:83], s29 offen offset:2048 sc1
    s_add_u32 s29, s29, 4096
    s_waitcnt vmcnt(16)
    s_barrier
    s_add_u32 m0, s19, 98816
    s_nop 0
    buffer_load_dwordx4 v10, s[8:11], s16 offen lds
    s_add_u32 m0, s19, 99840
    s_nop 0
    buffer_load_dwordx4 v11, s[8:11], s16 offen lds
    s_add_u32 m0, s19, 100864
    s_nop 0
    buffer_load_dwordx4 v12, s[8:11], s16 offen lds
    s_add_u32 s16, s16, 196608
    s_cmp_eq_u32 s16, s18
    s_cselect_b32 s16, s17, s16
    s_cmp_lg_u32 s69, 0
    s_cbranch_scc1 nh_2574
    s_add_u32 s64, s27, 20480
    s_and_b32 s64, s64, 0x7fff
    s_mov_b32 m0, 55296
    s_add_u32 s64, s64, s26
    buffer_load_dwordx4 v249, s[80:83], s64 offen sc1 lds
nh_2574:
    s_add_u32 m0, s23, 55296
    s_nop 0
    buffer_load_dwordx4 v249, s[80:83], s20 offen offset:0 sc1 lds
    s_add_u32 m0, s23, 56320
    s_nop 0
    buffer_load_dwordx4 v249, s[80:83], s20 offen offset:1024 sc1 lds
    s_add_u32 s20, s20, 8192
    s_cmp_eq_u32 s20, s22
    s_cselect_b32 s20, s21, s20
    s_add_u32 m0, s19, 111232
    s_nop 0
    buffer_load_dwordx4 v10, s[8:11], s16 offen lds
    s_add_u32 m0, s19, 112256
    s_nop 0
    buffer_load_dwordx4 v11, s[8:11], s16 offen lds
    s_add_u32 m0, s19, 113280
    s_nop 0
    buffer_load_dwordx4 v12, s[8:11], s16 offen lds
    s_add_u32 s16, s16, 196608
    s_cmp_eq_u32 s16, s18
    s_cselect_b32 s16, s17, s16
    s_cmp_lg_u32 s69, 1
    s_cbranch_scc1 nh_2575
    s_add_u32 s64, s27, 21504
    s_and_b32 s64, s64, 0x7fff
    s_mov_b32 m0, 56320
    s_add_u32 s64, s64, s26
    buffer_load_dwordx4 v249, s[80:83], s64 offen sc1 lds
nh_2575:
    s_add_u32 m0, s23, 56320
    s_nop 0
    buffer_load_dwordx4 v249, s[80:83], s20 offen offset:0 sc1 lds
    s_add_u32 m0, s23, 57344
    s_nop 0
    buffer_load_dwordx4 v249, s[80:83], s20 offen offset:1024 sc1 lds
    s_add_u32 s20, s20, 8192
    s_cmp_eq_u32 s20, s22
    s_cselect_b32 s20, s21, s20
    s_lshl_b32 s42, s70, 1
    s_add_u32 s42, s42, 11
    s_and_b32 s42, s42, 15
    s_mul_i32 s42, s42, 393216
    s_add_u32 s44, s40, s42
    s_addc_u32 s45, s41, 0
    s_load_dword s43, s[44:45], 0
    s_load_dword s43, s[44:45], 64
    s_load_dword s43, s[44:45], 2048
    s_load_dword s43, s[44:45], 2112
    s_load_dword s43, s[44:45], 4096
    s_load_dword s43, s[44:45], 4160
    buffer_load_dwordx4 v[48:51], v80, s[80:83], s29 offen offset:0 sc1
    buffer_load_dwordx4 v[52:55], v80, s[80:83], s29 offen offset:2048 sc1
    s_add_u32 s29, s29, 4096
    s_waitcnt vmcnt(16)
    s_barrier
    s_add_u32 m0, s19, 123648
    s_nop 0
    buffer_load_dwordx4 v10, s[8:11], s16 offen lds
    s_add_u32 m0, s19, 124672
    s_nop 0
    buffer_load_dwordx4 v11, s[8:11], s16 offen lds
    s_add_u32 m0, s19, 125696
    s_nop 0
    buffer_load_dwordx4 v12, s[8:11], s16 offen lds
    s_add_u32 s16, s16, 196608
    s_cmp_eq_u32 s16, s18
    s_cselect_b32 s16, s17, s16
    s_cmp_lg_u32 s69, 2
    s_cbranch_scc1 nh_2576
    s_add_u32 s64, s27, 22528
    s_and_b32 s64, s64, 0x7fff
    s_mov_b32 m0, 0
    s_add_u32 s64, s64, s26
    buffer_load_dwordx4 v249, s[80:83], s64 offen sc1 lds
nh_2576:
    s_add_u32 m0, s23, 0
    s_nop 0
    buffer_load_dwordx4 v249, s[80:83], s20 offen offset:0 sc1 lds
    s_add_u32 m0, s23, 1024
    s_nop 0
    buffer_load_dwordx4 v249, s[80:83], s20 offen offset:1024 sc1 lds
    s_add_u32 s20, s20, 8192
    s_cmp_eq_u32 s20, s22
    s_cselect_b32 s20, s21, s20
    s_add_u32 m0, s19, 136064
    s_nop 0
    buffer_load_dwordx4 v10, s[8:11], s16 offen lds
    s_add_u32 m0, s19, 137088
    s_nop 0
    buffer_load_dwordx4 v11, s[8:11], s16 offen lds
    s_add_u32 m0, s19, 138112
    s_nop 0
    buffer_load_dwordx4 v12, s[8:11], s16 offen lds
    s_add_u32 s16, s16, 196608
    s_cmp_eq_u32 s16, s18
    s_cselect_b32 s16, s17, s16
    s_cmp_lg_u32 s69, 3
    s_cbranch_scc1 nh_2577
    s_add_u32 s64, s27, 23552
    s_and_b32 s64, s64, 0x7fff
    s_mov_b32 m0, 1024
    s_add_u32 s64, s64, s26
    buffer_load_dwordx4 v249, s[80:83], s64 offen sc1 lds
nh_2577:
    s_add_u32 m0, s23, 1024
    s_nop 0
    buffer_load_dwordx4 v249, s[80:83], s20 offen offset:0 sc1 lds
    s_add_u32 m0, s23, 2048
    s_nop 0
    buffer_load_dwordx4 v249, s[80:83], s20 offen offset:1024 sc1 lds
    s_add_u32 s20, s20, 8192
    s_cmp_eq_u32 s20, s22
    s_cselect_b32 s20, s21, s20
    s_lshl_b32 s42, s70, 1
    s_add_u32 s42, s42, 12
    s_and_b32 s42, s42, 15
    s_mul_i32 s42, s42, 393216
    s_add_u32 s44, s40, s42
    s_addc_u32 s45, s41, 0
    s_load_dword s43, s[44:45], 0
    s_load_dword s43, s[44:45], 64
    s_load_dword s43, s[44:45], 2048
    s_load_dword s43, s[44:45], 2112
    s_load_dword s43, s[44:45], 4096
    s_load_dword s43, s[44:45], 4160
    buffer_load_dwordx4 v[56:59], v80, s[80:83], s29 offen offset:0 sc1
    buffer_load_dwordx4 v[60:63], v80, s[80:83], s29 offen offset:2048 sc1
    s_add_u32 s29, s29, 4096
    s_waitcnt vmcnt(16)
    s_barrier
    s_add_u32 m0, s19, 73984
    s_nop 0
    buffer_load_dwordx4 v10, s[8:11], s16 offen lds
    s_add_u32 m0, s19, 75008
    s_nop 0
    buffer_load_dwordx4 v11, s[8:11], s16 offen lds
    s_add_u32 m0, s19, 76032
    s_nop 0
    buffer_load_dwordx4 v12, s[8:11], s16 offen lds
    s_add_u32 s16, s16, 196608
    s_cmp_eq_u32 s16, s18
    s_cselect_b32 s16, s17, s16
    s_cmp_lg_u32 s69, 0
    s_cbranch_scc1 nh_2578
    s_add_u32 s64, s27, 24576
    s_and_b32 s64, s64, 0x7fff
    s_mov_b32 m0, 18432
    s_add_u32 s64, s64, s26
    buffer_load_dwordx4 v249, s[80:83], s64 offen sc1 lds
nh_2578:
    s_add_u32 m0, s23, 18432
    s_nop 0
    buffer_load_dwordx4 v249, s[80:83], s20 offen offset:0 sc1 lds
    s_add_u32 m0, s23, 19456
    s_nop 0
    buffer_load_dwordx4 v249, s[80:83], s20 offen offset:1024 sc1 lds
    s_add_u32 s20, s20, 8192
    s_cmp_eq_u32 s20, s22
    s_cselect_b32 s20, s21, s20
    s_add_u32 m0, s19, 86400
    s_nop 0
    buffer_load_dwordx4 v10, s[8:11], s16 offen lds
    s_add_u32 m0, s19, 87424
    s_nop 0
    buffer_load_dwordx4 v11, s[8:11], s16 offen lds
    s_add_u32 m0, s19, 88448
    s_nop 0
    buffer_load_dwordx4 v12, s[8:11], s16 offen lds
    s_add_u32 s16, s16, 196608
    s_cmp_eq_u32 s16, s18
    s_cselect_b32 s16, s17, s16
    s_cmp_lg_u32 s69, 1
    s_cbranch_scc1 nh_2579
    s_add_u32 s64, s27, 25600
    s_and_b32 s64, s64, 0x7fff
    s_mov_b32 m0, 19456
    s_add_u32 s64, s64, s26
    buffer_load_dwordx4 v249, s[80:83], s64 offen sc1 lds
nh_2579:
    s_add_u32 m0, s23, 19456
    s_nop 0
    buffer_load_dwordx4 v249, s[80:83], s20 offen offset:0 sc1 lds
    s_add_u32 m0, s23, 20480
    s_nop 0
    buffer_load_dwordx4 v249, s[80:83], s20 offen offset:1024 sc1 lds
    s_add_u32 s20, s20, 8192
    s_cmp_eq_u32 s20, s22
    s_cselect_b32 s20, s21, s20
    s_lshl_b32 s42, s70, 1
    s_add_u32 s42, s42, 13
    s_and_b32 s42, s42, 15
    s_mul_i32 s42, s42, 393216
    s_add_u32 s44, s40, s42
    s_addc_u32 s45, s41, 0
    s_load_dword s43, s[44:45], 0
    s_load_dword s43, s[44:45], 64
    s_load_dword s43, s[44:45], 2048
    s_load_dword s43, s[44:45], 2112
    s_load_dword s43, s[44:45], 4096
    s_load_dword s43, s[44:45], 4160
    s_cmp_lg_u32 s69, 3
    s_cbranch_scc1 hf_2580
    v_pk_add_f32 v[64:65], v[64:65], v[72:73]
    v_pk_add_f32 v[66:67], v[66:67], v[74:75]
    v_pk_add_f32 v[68:69], v[68:69], v[76:77]
    v_pk_add_f32 v[70:71], v[70:71], v[78:79]
    v_pk_add_f32 v[64:65], v[64:65], v[68:69]
    v_pk_add_f32 v[66:67], v[66:67], v[70:71]
    v_add_f32 v64, v64, v66
    v_add_f32 v65, v65, v67
    v_mov_b32 v66, v64
    v_mov_b32 v67, v65
    s_nop 1
    v_permlane16_swap_b32 v64, v66
    v_permlane16_swap_b32 v65, v67
    v_add_f32 v64, v64, v66
    v_add_f32 v65, v65, v67
    v_mov_b32 v66, v64
    v_mov_b32 v67, v65
    s_nop 1
    v_permlane32_swap_b32 v64, v66
    v_permlane32_swap_b32 v65, v67
    v_add_f32 v64, v64, v66
    v_add_f32 v65, v65, v67
    v_mul_f32 v64, 0x3a800000, v64
    v_mul_f32 v65, 0x3a800000, v65
    v_fma_f32 v65, -v64, v64, v65
    v_max_f32 v65, 0, v65
    v_cvt_pk_bf16_f32 v64, v64, v64
    v_lshlrev_b32 v64, 16, v64
    v_cvt_pk_bf16_f32 v65, v65, v65
    v_lshlrev_b32 v65, 16, v65
    v_add_f32 v65, 0x3727c5ac, v65
    v_cvt_pk_bf16_f32 v65, v65, v65
    v_lshlrev_b32 v65, 16, v65
    v_sqrt_f32 v65, v65
    s_nop 0
    v_cvt_pk_bf16_f32 v65, v65, v65
    v_lshlrev_b32 v65, 16, v65
    v_rcp_f32 v65, v65
    s_nop 0
    v_lshlrev_b32 v81, 3, v252
    v_add_u32 v81, 159744, v81
    ds_write_b64 v81, v[64:65]
hf_2580:
    s_waitcnt vmcnt(14)
    s_barrier
    s_add_u32 m0, s19, 98816
    s_nop 0
    buffer_load_dwordx4 v10, s[8:11], s16 offen lds
    s_add_u32 m0, s19, 99840
    s_nop 0
    buffer_load_dwordx4 v11, s[8:11], s16 offen lds
    s_add_u32 m0, s19, 100864
    s_nop 0
    buffer_load_dwordx4 v12, s[8:11], s16 offen lds
    s_add_u32 s16, s16, 196608
    s_cmp_eq_u32 s16, s18
    s_cselect_b32 s16, s17, s16
    s_cmp_lg_u32 s69, 2
    s_cbranch_scc1 nh_2581
    s_add_u32 s64, s27, 26624
    s_and_b32 s64, s64, 0x7fff
    s_mov_b32 m0, 36864
    s_add_u32 s64, s64, s26
    buffer_load_dwordx4 v249, s[80:83], s64 offen sc1 lds
nh_2581:
    s_add_u32 m0, s23, 36864
    s_nop 0
    buffer_load_dwordx4 v249, s[80:83], s20 offen offset:0 sc1 lds
    s_add_u32 m0, s23, 37888
    s_nop 0
    buffer_load_dwordx4 v249, s[80:83], s20 offen offset:1024 sc1 lds
    s_add_u32 s20, s20, 8192
    s_cmp_eq_u32 s20, s22
    s_cselect_b32 s20, s21, s20
    s_add_u32 m0, s19, 111232
    s_nop 0
    buffer_load_dwordx4 v10, s[8:11], s16 offen lds
    s_add_u32 m0, s19, 112256
    s_nop 0
    buffer_load_dwordx4 v11, s[8:11], s16 offen lds
    s_add_u32 m0, s19, 113280
    s_nop 0
    buffer_load_dwordx4 v12, s[8:11], s16 offen lds
    s_add_u32 s16, s16, 196608
    s_cmp_eq_u32 s16, s18
    s_cselect_b32 s16, s17, s16
    s_cmp_lg_u32 s69, 3
    s_cbranch_scc1 nh_2582
    s_add_u32 s64, s27, 27648
    s_and_b32 s64, s64, 0x7fff
    s_mov_b32 m0, 37888
    s_add_u32 s64, s64, s26
    buffer_load_dwordx4 v249, s[80:83], s64 offen sc1 lds
nh_2582:
    s_add_u32 m0, s23, 37888
    s_nop 0
    buffer_load_dwordx4 v249, s[80:83], s20 offen offset:0 sc1 lds
    s_add_u32 m0, s23, 38912
    s_nop 0
    buffer_load_dwordx4 v249, s[80:83], s20 offen offset:1024 sc1 lds
    s_add_u32 s20, s20, 8192
    s_cmp_eq_u32 s20, s22
    s_cselect_b32 s20, s21, s20
    s_lshl_b32 s42, s70, 1
    s_add_u32 s42, s42, 14
    s_and_b32 s42, s42, 15
    s_mul_i32 s42, s42, 393216
    s_add_u32 s44, s40, s42
    s_addc_u32 s45, s41, 0
    s_load_dword s43, s[44:45], 0
    s_load_dword s43, s[44:45], 64
    s_load_dword s43, s[44:45], 2048
    s_load_dword s43, s[44:45], 2112
    s_load_dword s43, s[44:45], 4096
    s_load_dword s43, s[44:45], 4160
    s_waitcnt vmcnt(12)
    s_barrier
    s_add_u32 m0, s19, 123648
    s_nop 0
    buffer_load_dwordx4 v10, s[8:11], s16 offen lds
    s_add_u32 m0, s19, 124672
    s_nop 0
    buffer_load_dwordx4 v11, s[8:11], s16 offen lds
    s_add_u32 m0, s19, 125696
    s_nop 0
    buffer_load_dwordx4 v12, s[8:11], s16 offen lds
    s_add_u32 s16, s16, 196608
    s_cmp_eq_u32 s16, s18
    s_cselect_b32 s16, s17, s16
    s_cmp_lg_u32 s69, 0
    s_cbranch_scc1 nh_2583
    s_add_u32 s64, s27, 28672
    s_and_b32 s64, s64, 0x7fff
    s_mov_b32 m0, 55296
    s_add_u32 s64, s64, s26
    buffer_load_dwordx4 v249, s[80:83], s64 offen sc1 lds
nh_2583:
    s_add_u32 m0, s23, 55296
    s_nop 0
    buffer_load_dwordx4 v249, s[80:83], s20 offen offset:0 sc1 lds
    s_add_u32 m0, s23, 56320
    s_nop 0
    buffer_load_dwordx4 v249, s[80:83], s20 offen offset:1024 sc1 lds
    s_add_u32 s20, s20, 8192
    s_cmp_eq_u32 s20, s22
    s_cselect_b32 s20, s21, s20
    s_add_u32 m0, s19, 136064
    s_nop 0
    buffer_load_dwordx4 v10, s[8:11], s16 offen lds
    s_add_u32 m0, s19, 137088
    s_nop 0
    buffer_load_dwordx4 v11, s[8:11], s16 offen lds
    s_add_u32 m0, s19, 138112
    s_nop 0
    buffer_load_dwordx4 v12, s[8:11], s16 offen lds
    s_add_u32 s16, s16, 196608
    s_cmp_eq_u32 s16, s18
    s_cselect_b32 s16, s17, s16
    s_cmp_lg_u32 s69, 1
    s_cbranch_scc1 nh_2584
    s_add_u32 s64, s27, 29696
    s_and_b32 s64, s64, 0x7fff
    s_mov_b32 m0, 56320
    s_add_u32 s64, s64, s26
    buffer_load_dwordx4 v249, s[80:83], s64 offen sc1 lds
nh_2584:
    s_add_u32 m0, s23, 56320
    s_nop 0
    buffer_load_dwordx4 v249, s[80:83], s20 offen offset:0 sc1 lds
    s_add_u32 m0, s23, 57344
    s_nop 0
    buffer_load_dwordx4 v249, s[80:83], s20 offen offset:1024 sc1 lds
    s_add_u32 s20, s20, 8192
    s_cmp_eq_u32 s20, s22
    s_cselect_b32 s20, s21, s20
    s_lshl_b32 s42, s70, 1
    s_add_u32 s42, s42, 15
    s_and_b32 s42, s42, 15
    s_mul_i32 s42, s42, 393216
    s_add_u32 s44, s40, s42
    s_addc_u32 s45, s41, 0
    s_load_dword s43, s[44:45], 0
    s_load_dword s43, s[44:45], 64
    s_load_dword s43, s[44:45], 2048
    s_load_dword s43, s[44:45], 2112
    s_load_dword s43, s[44:45], 4096
    s_load_dword s43, s[44:45], 4160
    v_pk_add_f32 v[32:33], v[32:33], v[48:49]
    v_pk_add_f32 v[34:35], v[34:35], v[50:51]
    v_pk_add_f32 v[36:37], v[36:37], v[52:53]
    v_pk_add_f32 v[38:39], v[38:39], v[54:55]
    v_pk_add_f32 v[40:41], v[40:41], v[56:57]
    v_pk_add_f32 v[42:43], v[42:43], v[58:59]
    v_pk_add_f32 v[44:45], v[44:45], v[60:61]
    v_pk_add_f32 v[46:47], v[46:47], v[62:63]
    v_pk_add_f32 v[32:33], v[32:33], v[40:41]
    v_pk_add_f32 v[34:35], v[34:35], v[42:43]
    s_waitcnt vmcnt(12)
    s_barrier
    s_add_u32 m0, s19, 73984
    s_nop 0
    buffer_load_dwordx4 v10, s[8:11], s16 offen lds
    s_add_u32 m0, s19, 75008
    s_nop 0
    buffer_load_dwordx4 v11, s[8:11], s16 offen lds
    s_add_u32 m0, s19, 76032
    s_nop 0
    buffer_load_dwordx4 v12, s[8:11], s16 offen lds
    s_add_u32 s16, s16, 196608
    s_cmp_eq_u32 s16, s18
    s_cselect_b32 s16, s17, s16
    s_cmp_lg_u32 s69, 2
    s_cbranch_scc1 nh_2585
    s_add_u32 s64, s27, 30720
    s_and_b32 s64, s64, 0x7fff
    s_mov_b32 m0, 0
    s_add_u32 s64, s64, s26
    buffer_load_dwordx4 v249, s[80:83], s64 offen sc1 lds
nh_2585:
    s_add_u32 m0, s23, 0
    s_nop 0
    buffer_load_dwordx4 v249, s[80:83], s20 offen offset:0 sc1 lds
    s_add_u32 m0, s23, 1024
    s_nop 0
    buffer_load_dwordx4 v249, s[80:83], s20 offen offset:1024 sc1 lds
    s_add_u32 s20, s20, 8192
    s_cmp_eq_u32 s20, s22
    s_cselect_b32 s20, s21, s20
    s_add_u32 m0, s19, 86400
    s_nop 0
    buffer_load_dwordx4 v10, s[8:11], s16 offen lds
    s_add_u32 m0, s19, 87424
    s_nop 0
    buffer_load_dwordx4 v11, s[8:11], s16 offen lds
    s_add_u32 m0, s19, 88448
    s_nop 0
    buffer_load_dwordx4 v12, s[8:11], s16 offen lds
    s_add_u32 s16, s16, 196608
    s_cmp_eq_u32 s16, s18
    s_cselect_b32 s16, s17, s16
    s_cmp_lg_u32 s69, 3
    s_cbranch_scc1 nh_2586
    s_add_u32 s64, s27, 31744
    s_and_b32 s64, s64, 0x7fff
    s_mov_b32 m0, 1024
    s_add_u32 s64, s64, s26
    buffer_load_dwordx4 v249, s[80:83], s64 offen sc1 lds
nh_2586:
    s_add_u32 m0, s23, 1024
    s_nop 0
    buffer_load_dwordx4 v249, s[80:83], s20 offen offset:0 sc1 lds
    s_add_u32 m0, s23, 2048
    s_nop 0
    buffer_load_dwordx4 v249, s[80:83], s20 offen offset:1024 sc1 lds
    s_add_u32 s20, s20, 8192
    s_cmp_eq_u32 s20, s22
    s_cselect_b32 s20, s21, s20
    v_pk_add_f32 v[36:37], v[36:37], v[44:45]
    v_pk_add_f32 v[38:39], v[38:39], v[46:47]
    v_pk_add_f32 v[32:33], v[32:33], v[36:37]
    v_pk_add_f32 v[34:35], v[34:35], v[38:39]
    v_add_f32 v32, v32, v34
    v_add_f32 v33, v33, v35
    v_mov_b32 v34, v32
    v_mov_b32 v35, v33
    s_nop 1
    v_permlane32_swap_b32 v32, v34
    s_waitcnt vmcnt(12)
    s_barrier
    s_add_u32 m0, s19, 98816
    s_nop 0
    buffer_load_dwordx4 v10, s[8:11], s16 offen lds
    s_add_u32 m0, s19, 99840
    s_nop 0
    buffer_load_dwordx4 v11, s[8:11], s16 offen lds
    s_add_u32 m0, s19, 100864
    s_nop 0
    buffer_load_dwordx4 v12, s[8:11], s16 offen lds
    s_add_u32 s16, s16, 196608
    s_cmp_eq_u32 s16, s18
    s_cselect_b32 s16, s17, s16
    s_lshl_b32 s64, s73, 4
    s_add_u32 s64, s64, s67
    s_lshl_b32 s64, s64, 2
    s_add_u32 s64, s64, s69
    s_lshl_b32 s64, s64, 12
    s_lshl_b32 s65, s60, 22
    s_add_u32 s64, s64, s65
    s_add_u32 s64, s64, 12582912
    v_lshlrev_b32 v253, 7, v250
    s_mov_b64 exec, 0xffffffff
    buffer_load_dword v9, v253, s[80:83], s64 offen sc1
    s_mov_b64 exec, -1
    s_mov_b32 s12, s88
    s_mov_b32 s13, s89
    s_mov_b32 s14, 2097152
    s_mov_b32 s15, 0x00020000
    v_lshrrev_b32 v253, 3, v250
    v_lshlrev_b32 v253, 13, v253
    v_and_b32 v254, 7, v250
    v_lshl_add_u32 v253, v254, 4, v253
    s_lshl_b32 s64, s69, 11
    v_add_u32 v244, s64, v253
    s_mul_i32 s51, s69, 1056
    s_lshl_b32 s49, s72, 7
    s_lshl_b32 s64, s67, 17
    s_add_u32 s50, s49, 2097152
    s_add_u32 s48, s49, s64
    v_permlane32_swap_b32 v33, v35
    v_add_f32 v32, v32, v34
    v_add_f32 v33, v33, v35
    v_mul_f32 v32, 0x3a800000, v32
    v_mul_f32 v33, 0x3a800000, v33
    v_fma_f32 v33, -v32, v32, v33
    v_max_f32 v33, 0, v33
    v_cvt_pk_bf16_f32 v32, v32, v32
    v_lshlrev_b32 v32, 16, v32
    v_cvt_pk_bf16_f32 v33, v33, v33
    v_lshlrev_b32 v33, 16, v33
    v_add_f32 v33, 0x3727c5ac, v33
    v_cvt_pk_bf16_f32 v33, v33, v33
    v_lshlrev_b32 v33, 16, v33
    v_sqrt_f32 v33, v33
    s_nop 0
    s_add_u32 m0, s51, 116224
    s_nop 0
    buffer_load_dwordx4 v244, s[12:15], s48 offen lds
    s_add_u32 s48, s48, 65536
    s_cmp_eq_u32 s48, s50
    s_cselect_b32 s48, s49, s48
    s_waitcnt vmcnt(7)
    s_barrier
    v_cvt_pk_bf16_f32 v33, v33, v33
    v_lshlrev_b32 v33, 16, v33
    v_rcp_f32 v33, v33
    s_nop 0
    v_and_b32 v80, 31, v250
    s_lshl_b32 s29, s69, 8
    s_add_u32 s29, s29, 159872
    v_lshlrev_b32 v80, 3, v80
    v_add_u32 v80, s29, v80
    ds_write_b64 v80, v[32:33]
    s_add_u32 m0, s51, 120448
    s_nop 0
    buffer_load_dwordx4 v244, s[12:15], s48 offen lds
    s_add_u32 s48, s48, 65536
    s_cmp_eq_u32 s48, s50
    s_cselect_b32 s48, s49, s48
    s_add_u32 m0, s51, 124672
    s_nop 0
    buffer_load_dwordx4 v244, s[12:15], s48 offen lds
    s_add_u32 s48, s48, 65536
    s_cmp_eq_u32 s48, s50
    s_cselect_b32 s48, s49, s48
    s_add_u32 m0, s51, 128896
    s_nop 0
    buffer_load_dwordx4 v244, s[12:15], s48 offen lds
    s_add_u32 s48, s48, 65536
    s_cmp_eq_u32 s48, s50
    s_cselect_b32 s48, s49, s48
    s_add_u32 m0, s51, 133120
    s_nop 0
    buffer_load_dwordx4 v244, s[12:15], s48 offen lds
    s_add_u32 s48, s48, 65536
    s_cmp_eq_u32 s48, s50
    s_cselect_b32 s48, s49, s48
    s_add_u32 m0, s51, 137344
    s_nop 0
    buffer_load_dwordx4 v244, s[12:15], s48 offen lds
    s_add_u32 s48, s48, 65536
    s_cmp_eq_u32 s48, s50
    s_cselect_b32 s48, s49, s48
    s_add_u32 m0, s51, 141568
    s_nop 0
    buffer_load_dwordx4 v244, s[12:15], s48 offen lds
    s_add_u32 s48, s48, 65536
    s_cmp_eq_u32 s48, s50
    s_cselect_b32 s48, s49, s48
    s_add_u32 m0, s51, 145792
    s_nop 0
    buffer_load_dwordx4 v244, s[12:15], s48 offen lds
    s_add_u32 s48, s48, 65536
    s_cmp_eq_u32 s48, s50
    s_cselect_b32 s48, s49, s48
    s_add_u32 m0, s51, 150016
    s_nop 0
    buffer_load_dwordx4 v244, s[12:15], s48 offen lds
    s_add_u32 s48, s48, 65536
    s_cmp_eq_u32 s48, s50
    s_cselect_b32 s48, s49, s48
    s_waitcnt vmcnt(10)
    s_barrier
    s_add_u32 m0, s51, 154240
    s_nop 0
    buffer_load_dwordx4 v244, s[12:15], s48 offen lds
    s_add_u32 s48, s48, 65536
    s_cmp_eq_u32 s48, s50
    s_cselect_b32 s48, s49, s48
    s_add_u32 m0, s51, 65536
    s_nop 0
    buffer_load_dwordx4 v244, s[12:15], s48 offen lds
    s_add_u32 s48, s48, 65536
    s_cmp_eq_u32 s48, s50
    s_cselect_b32 s48, s49, s48
    s_add_u32 m0, s51, 69760
    s_nop 0
    buffer_load_dwordx4 v244, s[12:15], s48 offen lds
    s_add_u32 s48, s48, 65536
    s_cmp_eq_u32 s48, s50
    s_cselect_b32 s48, s49, s48
    s_add_u32 m0, s51, 73984
    s_nop 0
    buffer_load_dwordx4 v244, s[12:15], s48 offen lds
    s_add_u32 s48, s48, 65536
    s_cmp_eq_u32 s48, s50
    s_cselect_b32 s48, s49, s48
    s_add_u32 m0, s51, 78208
    s_nop 0
    buffer_load_dwordx4 v244, s[12:15], s48 offen lds
    s_add_u32 s48, s48, 65536
    s_cmp_eq_u32 s48, s50
    s_cselect_b32 s48, s49, s48
    s_add_u32 m0, s51, 82432
    s_nop 0
    buffer_load_dwordx4 v244, s[12:15], s48 offen lds
    s_add_u32 s48, s48, 65536
    s_cmp_eq_u32 s48, s50
    s_cselect_b32 s48, s49, s48
    s_add_u32 m0, s51, 86656
    s_nop 0
    buffer_load_dwordx4 v244, s[12:15], s48 offen lds
    s_add_u32 s48, s48, 65536
    s_cmp_eq_u32 s48, s50
    s_cselect_b32 s48, s49, s48
    s_add_u32 m0, s51, 90880
    s_nop 0
    buffer_load_dwordx4 v244, s[12:15], s48 offen lds
    s_add_u32 s48, s48, 65536
    s_cmp_eq_u32 s48, s50
    s_cselect_b32 s48, s49, s48
    s_waitcnt lgkmcnt(0)
    s_barrier
    s_add_u32 m0, s51, 95104
    s_nop 0
    buffer_load_dwordx4 v244, s[12:15], s48 offen lds
    s_add_u32 s48, s48, 65536
    s_cmp_eq_u32 s48, s50
    s_cselect_b32 s48, s49, s48
    s_add_u32 m0, s51, 99328
    s_nop 0
    buffer_load_dwordx4 v244, s[12:15], s48 offen lds
    s_add_u32 s48, s48, 65536
    s_cmp_eq_u32 s48, s50
    s_cselect_b32 s48, s49, s48
    s_add_u32 m0, s51, 103552
    s_nop 0
    buffer_load_dwordx4 v244, s[12:15], s48 offen lds
    s_add_u32 s48, s48, 65536
    s_cmp_eq_u32 s48, s50
    s_cselect_b32 s48, s49, s48
    s_add_u32 m0, s51, 107776
    s_nop 0
    buffer_load_dwordx4 v244, s[12:15], s48 offen lds
    s_add_u32 s48, s48, 65536
    s_cmp_eq_u32 s48, s50
    s_cselect_b32 s48, s49, s48
    s_add_u32 m0, s51, 112000
    s_nop 0
    buffer_load_dwordx4 v244, s[12:15], s48 offen lds
    s_add_u32 s48, s48, 65536
    s_cmp_eq_u32 s48, s50
    s_cselect_b32 s48, s49, s48
    s_branch L_g2
ar_17:
    v_mov_b32 v72, s32
    v_mov_b32 v73, 0
    s_mov_b64 exec, 1
    buffer_store_byte v72, v73, s[28:31], s2 offen sc0 sc1
    s_mov_b64 exec, -1
    s_branch ar_17_b
ar_19:
    v_mov_b32 v72, s32
    v_mov_b32 v73, 0
    s_mov_b64 exec, 1
    buffer_store_byte v72, v73, s[28:31], s2 offen sc0 sc1
    s_mov_b64 exec, -1
    s_branch ar_19_b
ar_21:
    v_mov_b32 v72, s32
    v_mov_b32 v73, 0
    s_mov_b64 exec, 1
    buffer_store_byte v72, v73, s[28:31], s2 offen sc0 sc1
    s_mov_b64 exec, -1
    s_branch ar_21_b
ar_23:
    v_mov_b32 v72, s32
    v_mov_b32 v73, 0
    s_mov_b64 exec, 1
    buffer_store_byte v72, v73, s[28:31], s2 offen sc0 sc1
    s_mov_b64 exec, -1
    s_branch ar_23_b
hs_32:
    buffer_load_dword v72, v71, s[28:31], 0 offen sc1
    s_sub_u32 s79, s79, 1
    s_cbranch_scc1 L_abort
    s_waitcnt vmcnt(0)
    v_and_b32 v73, 0x80808080, v72
    v_cmp_ne_u32 vcc, 0x80808080, v73
    s_cbranch_vccnz hs_32
    s_branch hs_32_b
pl_33_acq:
    buffer_inv sc1
    s_waitcnt vmcnt(0)
    s_branch pl_33_ok
pl_35_acq:
    buffer_inv sc1
    s_waitcnt vmcnt(0)
    s_branch pl_35_ok
pl_37_acq:
    buffer_inv sc1
    s_waitcnt vmcnt(0)
    s_branch pl_37_ok
cs_38:
    v_add_u32 v225, 28800, v224
    ds_read_b64_tr_b16 v[204:205], v225 offset:0
    ds_read_b64_tr_b16 v[206:207], v225 offset:3584
    ds_read_b64_tr_b16 v[208:209], v225 offset:32
    ds_read_b64_tr_b16 v[210:211], v225 offset:3616
    ds_read_b64_tr_b16 v[212:213], v225 offset:64
    ds_read_b64_tr_b16 v[214:215], v225 offset:3648
    ds_read_b64_tr_b16 v[216:217], v225 offset:96
    ds_read_b64_tr_b16 v[218:219], v225 offset:3680
    s_waitcnt lgkmcnt(0)
    v_mfma_f32_16x16x32_bf16 v[176:179], v[204:207], v[220:223], 0
    v_mfma_f32_16x16x32_bf16 v[180:183], v[208:211], v[220:223], 0
    v_mfma_f32_16x16x32_bf16 v[184:187], v[212:215], v[220:223], 0
    v_mfma_f32_16x16x32_bf16 v[188:191], v[216:219], v[220:223], 0
    s_nop 7
    ds_read_b64_tr_b16 v[204:205], v225 offset:128
    ds_read_b64_tr_b16 v[206:207], v225 offset:3712
    ds_read_b64_tr_b16 v[208:209], v225 offset:160
    ds_read_b64_tr_b16 v[210:211], v225 offset:3744
    ds_read_b64_tr_b16 v[212:213], v225 offset:192
    ds_read_b64_tr_b16 v[214:215], v225 offset:3776
    s_waitcnt lgkmcnt(0)
    v_mfma_f32_16x16x32_bf16 v[192:195], v[204:207], v[220:223], 0
    v_mfma_f32_16x16x32_bf16 v[196:199], v[208:211], v[220:223], 0
    v_mfma_f32_16x16x32_bf16 v[200:203], v[212:215], v[220:223], 0
    s_nop 7
    s_branch cs_38_b
cs_39:
    v_add_u32 v225, 57600, v224
    ds_read_b64_tr_b16 v[204:205], v225 offset:0
    ds_read_b64_tr_b16 v[206:207], v225 offset:3584
    ds_read_b64_tr_b16 v[208:209], v225 offset:32
    ds_read_b64_tr_b16 v[210:211], v225 offset:3616
    ds_read_b64_tr_b16 v[212:213], v225 offset:64
    ds_read_b64_tr_b16 v[214:215], v225 offset:3648
    ds_read_b64_tr_b16 v[216:217], v225 offset:96
    ds_read_b64_tr_b16 v[218:219], v225 offset:3680
    s_waitcnt lgkmcnt(0)
    v_mfma_f32_16x16x32_bf16 v[176:179], v[204:207], v[220:223], v[176:179]
    v_mfma_f32_16x16x32_bf16 v[180:183], v[208:211], v[220:223], v[180:183]
    v_mfma_f32_16x16x32_bf16 v[184:187], v[212:215], v[220:223], v[184:187]
    v_mfma_f32_16x16x32_bf16 v[188:191], v[216:219], v[220:223], v[188:191]
    s_nop 7
    ds_read_b64_tr_b16 v[204:205], v225 offset:128
    ds_read_b64_tr_b16 v[206:207], v225 offset:3712
    ds_read_b64_tr_b16 v[208:209], v225 offset:160
    ds_read_b64_tr_b16 v[210:211], v225 offset:3744
    ds_read_b64_tr_b16 v[212:213], v225 offset:192
    ds_read_b64_tr_b16 v[214:215], v225 offset:3776
    s_waitcnt lgkmcnt(0)
    v_mfma_f32_16x16x32_bf16 v[192:195], v[204:207], v[220:223], v[192:195]
    v_mfma_f32_16x16x32_bf16 v[196:199], v[208:211], v[220:223], v[196:199]
    v_mfma_f32_16x16x32_bf16 v[200:203], v[212:215], v[220:223], v[200:203]
    s_nop 7
    s_lshl_b32 s64, s34, 1
    s_and_b32 s65, s3, 1
    s_add_u32 s64, s64, s65
    s_mul_i32 s64, s64, 14336
    s_mul_i32 s65, s74, 896
    s_add_u32 s64, s64, s65
    s_lshr_b32 s65, s69, 1
    s_mul_i32 s65, s65, 448
    s_add_u32 s64, s64, s65
    s_add_u32 s64, s64, 74448896
    v_lshlrev_b32 v225, 4, v251
    s_mov_b32 exec_lo, 0x00010001
    s_mov_b32 exec_hi, 0x00010001
    buffer_store_dwordx4 v[176:179], v225, s[80:83], s64 offen offset:0 sc0 sc1
    buffer_store_dwordx4 v[180:183], v225, s[80:83], s64 offen offset:64 sc0 sc1
    buffer_store_dwordx4 v[184:187], v225, s[80:83], s64 offen offset:128 sc0 sc1
    buffer_store_dwordx4 v[188:191], v225, s[80:83], s64 offen offset:192 sc0 sc1
    buffer_store_dwordx4 v[192:195], v225, s[80:83], s64 offen offset:256 sc0 sc1
    buffer_store_dwordx4 v[196:199], v225, s[80:83], s64 offen offset:320 sc0 sc1
    buffer_store_dwordx4 v[200:203], v225, s[80:83], s64 offen offset:384 sc0 sc1
    s_mov_b64 exec, -1
    s_nop 3
    s_branch cs_39_b
cs_40:
    v_add_u32 v225, 86400, v224
    ds_read_b64_tr_b16 v[204:205], v225 offset:0
    ds_read_b64_tr_b16 v[206:207], v225 offset:3584
    ds_read_b64_tr_b16 v[208:209], v225 offset:32
    ds_read_b64_tr_b16 v[210:211], v225 offset:3616
    ds_read_b64_tr_b16 v[212:213], v225 offset:64
    ds_read_b64_tr_b16 v[214:215], v225 offset:3648
    ds_read_b64_tr_b16 v[216:217], v225 offset:96
    ds_read_b64_tr_b16 v[218:219], v225 offset:3680
    s_waitcnt lgkmcnt(0)
    v_mfma_f32_16x16x32_bf16 v[176:179], v[204:207], v[220:223], 0
    v_mfma_f32_16x16x32_bf16 v[180:183], v[208:211], v[220:223], 0
    v_mfma_f32_16x16x32_bf16 v[184:187], v[212:215], v[220:223], 0
    v_mfma_f32_16x16x32_bf16 v[188:191], v[216:219], v[220:223], 0
    s_nop 7
    ds_read_b64_tr_b16 v[204:205], v225 offset:128
    ds_read_b64_tr_b16 v[206:207], v225 offset:3712
    ds_read_b64_tr_b16 v[208:209], v225 offset:160
    ds_read_b64_tr_b16 v[210:211], v225 offset:3744
    ds_read_b64_tr_b16 v[212:213], v225 offset:192
    ds_read_b64_tr_b16 v[214:215], v225 offset:3776
    s_waitcnt lgkmcnt(0)
    v_mfma_f32_16x16x32_bf16 v[192:195], v[204:207], v[220:223], 0
    v_mfma_f32_16x16x32_bf16 v[196:199], v[208:211], v[220:223], 0
    v_mfma_f32_16x16x32_bf16 v[200:203], v[212:215], v[220:223], 0
    s_nop 7
    s_branch cs_40_b
cs_41:
    v_add_u32 v225, 0, v224
    ds_read_b64_tr_b16 v[204:205], v225 offset:0
    ds_read_b64_tr_b16 v[206:207], v225 offset:3584
    ds_read_b64_tr_b16 v[208:209], v225 offset:32
    ds_read_b64_tr_b16 v[210:211], v225 offset:3616
    ds_read_b64_tr_b16 v[212:213], v225 offset:64
    ds_read_b64_tr_b16 v[214:215], v225 offset:3648
    ds_read_b64_tr_b16 v[216:217], v225 offset:96
    ds_read_b64_tr_b16 v[218:219], v225 offset:3680
    s_waitcnt lgkmcnt(0)
    v_mfma_f32_16x16x32_bf16 v[176:179], v[204:207], v[220:223], v[176:179]
    v_mfma_f32_16x16x32_bf16 v[180:183], v[208:211], v[220:223], v[180:183]
    v_mfma_f32_16x16x32_bf16 v[184:187], v[212:215], v[220:223], v[184:187]
    v_mfma_f32_16x16x32_bf16 v[188:191], v[216:219], v[220:223], v[188:191]
    s_nop 7
    ds_read_b64_tr_b16 v[204:205], v225 offset:128
    ds_read_b64_tr_b16 v[206:207], v225 offset:3712
    ds_read_b64_tr_b16 v[208:209], v225 offset:160
    ds_read_b64_tr_b16 v[210:211], v225 offset:3744
    ds_read_b64_tr_b16 v[212:213], v225 offset:192
    ds_read_b64_tr_b16 v[214:215], v225 offset:3776
    s_waitcnt lgkmcnt(0)
    v_mfma_f32_16x16x32_bf16 v[192:195], v[204:207], v[220:223], v[192:195]
    v_mfma_f32_16x16x32_bf16 v[196:199], v[208:211], v[220:223], v[196:199]
    v_mfma_f32_16x16x32_bf16 v[200:203], v[212:215], v[220:223], v[200:203]
    s_nop 7
    s_lshl_b32 s64, s34, 1
    s_and_b32 s65, s3, 1
    s_add_u32 s64, s64, s65
    s_mul_i32 s64, s64, 14336
    s_mul_i32 s65, s74, 896
    s_add_u32 s64, s64, s65
    s_lshr_b32 s65, s69, 1
    s_mul_i32 s65, s65, 448
    s_add_u32 s64, s64, s65
    s_add_u32 s64, s64, 74448896
    v_lshlrev_b32 v225, 4, v251
    s_mov_b32 exec_lo, 0x00010001
    s_mov_b32 exec_hi, 0x00010001
    buffer_store_dwordx4 v[176:179], v225, s[80:83], s64 offen offset:0 sc0 sc1
    buffer_store_dwordx4 v[180:183], v225, s[80:83], s64 offen offset:64 sc0 sc1
    buffer_store_dwordx4 v[184:187], v225, s[80:83], s64 offen offset:128 sc0 sc1
    buffer_store_dwordx4 v[188:191], v225, s[80:83], s64 offen offset:192 sc0 sc1
    buffer_store_dwordx4 v[192:195], v225, s[80:83], s64 offen offset:256 sc0 sc1
    buffer_store_dwordx4 v[196:199], v225, s[80:83], s64 offen offset:320 sc0 sc1
    buffer_store_dwordx4 v[200:203], v225, s[80:83], s64 offen offset:384 sc0 sc1
    s_mov_b64 exec, -1
    s_nop 3
    s_branch cs_41_b
cs_42:
    v_add_u32 v225, 28800, v224
    ds_read_b64_tr_b16 v[204:205], v225 offset:0
    ds_read_b64_tr_b16 v[206:207], v225 offset:3584
    ds_read_b64_tr_b16 v[208:209], v225 offset:32
    ds_read_b64_tr_b16 v[210:211], v225 offset:3616
    ds_read_b64_tr_b16 v[212:213], v225 offset:64
    ds_read_b64_tr_b16 v[214:215], v225 offset:3648
    ds_read_b64_tr_b16 v[216:217], v225 offset:96
    ds_read_b64_tr_b16 v[218:219], v225 offset:3680
    s_waitcnt lgkmcnt(0)
    v_mfma_f32_16x16x32_bf16 v[176:179], v[204:207], v[220:223], 0
    v_mfma_f32_16x16x32_bf16 v[180:183], v[208:211], v[220:223], 0
    v_mfma_f32_16x16x32_bf16 v[184:187], v[212:215], v[220:223], 0
    v_mfma_f32_16x16x32_bf16 v[188:191], v[216:219], v[220:223], 0
    s_nop 7
    ds_read_b64_tr_b16 v[204:205], v225 offset:128
    ds_read_b64_tr_b16 v[206:207], v225 offset:3712
    ds_read_b64_tr_b16 v[208:209], v225 offset:160
    ds_read_b64_tr_b16 v[210:211], v225 offset:3744
    ds_read_b64_tr_b16 v[212:213], v225 offset:192
    ds_read_b64_tr_b16 v[214:215], v225 offset:3776
    s_waitcnt lgkmcnt(0)
    v_mfma_f32_16x16x32_bf16 v[192:195], v[204:207], v[220:223], 0
    v_mfma_f32_16x16x32_bf16 v[196:199], v[208:211], v[220:223], 0
    v_mfma_f32_16x16x32_bf16 v[200:203], v[212:215], v[220:223], 0
    s_nop 7
    s_branch cs_42_b
cs_43:
    v_add_u32 v225, 57600, v224
    ds_read_b64_tr_b16 v[204:205], v225 offset:0
    ds_read_b64_tr_b16 v[206:207], v225 offset:3584
    ds_read_b64_tr_b16 v[208:209], v225 offset:32
    ds_read_b64_tr_b16 v[210:211], v225 offset:3616
    ds_read_b64_tr_b16 v[212:213], v225 offset:64
    ds_read_b64_tr_b16 v[214:215], v225 offset:3648
    ds_read_b64_tr_b16 v[216:217], v225 offset:96
    ds_read_b64_tr_b16 v[218:219], v225 offset:3680
    s_waitcnt lgkmcnt(0)
    v_mfma_f32_16x16x32_bf16 v[176:179], v[204:207], v[220:223], v[176:179]
    v_mfma_f32_16x16x32_bf16 v[180:183], v[208:211], v[220:223], v[180:183]
    v_mfma_f32_16x16x32_bf16 v[184:187], v[212:215], v[220:223], v[184:187]
    v_mfma_f32_16x16x32_bf16 v[188:191], v[216:219], v[220:223], v[188:191]
    s_nop 7
    ds_read_b64_tr_b16 v[204:205], v225 offset:128
    ds_read_b64_tr_b16 v[206:207], v225 offset:3712
    ds_read_b64_tr_b16 v[208:209], v225 offset:160
    ds_read_b64_tr_b16 v[210:211], v225 offset:3744
    ds_read_b64_tr_b16 v[212:213], v225 offset:192
    ds_read_b64_tr_b16 v[214:215], v225 offset:3776
    s_waitcnt lgkmcnt(0)
    v_mfma_f32_16x16x32_bf16 v[192:195], v[204:207], v[220:223], v[192:195]
    v_mfma_f32_16x16x32_bf16 v[196:199], v[208:211], v[220:223], v[196:199]
    v_mfma_f32_16x16x32_bf16 v[200:203], v[212:215], v[220:223], v[200:203]
    s_nop 7
    s_lshl_b32 s64, s34, 1
    s_and_b32 s65, s3, 1
    s_add_u32 s64, s64, s65
    s_mul_i32 s64, s64, 14336
    s_mul_i32 s65, s74, 896
    s_add_u32 s64, s64, s65
    s_lshr_b32 s65, s69, 1
    s_mul_i32 s65, s65, 448
    s_add_u32 s64, s64, s65
    s_add_u32 s64, s64, 74448896
    v_lshlrev_b32 v225, 4, v251
    s_mov_b32 exec_lo, 0x00010001
    s_mov_b32 exec_hi, 0x00010001
    buffer_store_dwordx4 v[176:179], v225, s[80:83], s64 offen offset:0 sc0 sc1
    buffer_store_dwordx4 v[180:183], v225, s[80:83], s64 offen offset:64 sc0 sc1
    buffer_store_dwordx4 v[184:187], v225, s[80:83], s64 offen offset:128 sc0 sc1
    buffer_store_dwordx4 v[188:191], v225, s[80:83], s64 offen offset:192 sc0 sc1
    buffer_store_dwordx4 v[192:195], v225, s[80:83], s64 offen offset:256 sc0 sc1
    buffer_store_dwordx4 v[196:199], v225, s[80:83], s64 offen offset:320 sc0 sc1
    buffer_store_dwordx4 v[200:203], v225, s[80:83], s64 offen offset:384 sc0 sc1
    s_mov_b64 exec, -1
    s_nop 3
    s_branch cs_43_b
cs_44:
    v_add_u32 v225, 86400, v224
    ds_read_b64_tr_b16 v[204:205], v225 offset:0
    ds_read_b64_tr_b16 v[206:207], v225 offset:3584
    ds_read_b64_tr_b16 v[208:209], v225 offset:32
    ds_read_b64_tr_b16 v[210:211], v225 offset:3616
    ds_read_b64_tr_b16 v[212:213], v225 offset:64
    ds_read_b64_tr_b16 v[214:215], v225 offset:3648
    ds_read_b64_tr_b16 v[216:217], v225 offset:96
    ds_read_b64_tr_b16 v[218:219], v225 offset:3680
    s_waitcnt lgkmcnt(0)
    v_mfma_f32_16x16x32_bf16 v[176:179], v[204:207], v[220:223], 0
    v_mfma_f32_16x16x32_bf16 v[180:183], v[208:211], v[220:223], 0
    v_mfma_f32_16x16x32_bf16 v[184:187], v[212:215], v[220:223], 0
    v_mfma_f32_16x16x32_bf16 v[188:191], v[216:219], v[220:223], 0
    s_nop 7
    ds_read_b64_tr_b16 v[204:205], v225 offset:128
    ds_read_b64_tr_b16 v[206:207], v225 offset:3712
    ds_read_b64_tr_b16 v[208:209], v225 offset:160
    ds_read_b64_tr_b16 v[210:211], v225 offset:3744
    ds_read_b64_tr_b16 v[212:213], v225 offset:192
    ds_read_b64_tr_b16 v[214:215], v225 offset:3776
    s_waitcnt lgkmcnt(0)
    v_mfma_f32_16x16x32_bf16 v[192:195], v[204:207], v[220:223], 0
    v_mfma_f32_16x16x32_bf16 v[196:199], v[208:211], v[220:223], 0
    v_mfma_f32_16x16x32_bf16 v[200:203], v[212:215], v[220:223], 0
    s_nop 7
    s_branch cs_44_b
cs_45:
    v_add_u32 v225, 0, v224
    ds_read_b64_tr_b16 v[204:205], v225 offset:0
    ds_read_b64_tr_b16 v[206:207], v225 offset:3584
    ds_read_b64_tr_b16 v[208:209], v225 offset:32
    ds_read_b64_tr_b16 v[210:211], v225 offset:3616
    ds_read_b64_tr_b16 v[212:213], v225 offset:64
    ds_read_b64_tr_b16 v[214:215], v225 offset:3648
    ds_read_b64_tr_b16 v[216:217], v225 offset:96
    ds_read_b64_tr_b16 v[218:219], v225 offset:3680
    s_waitcnt lgkmcnt(0)
    v_mfma_f32_16x16x32_bf16 v[176:179], v[204:207], v[220:223], v[176:179]
    v_mfma_f32_16x16x32_bf16 v[180:183], v[208:211], v[220:223], v[180:183]
    v_mfma_f32_16x16x32_bf16 v[184:187], v[212:215], v[220:223], v[184:187]
    v_mfma_f32_16x16x32_bf16 v[188:191], v[216:219], v[220:223], v[188:191]
    s_nop 7
    ds_read_b64_tr_b16 v[204:205], v225 offset:128
    ds_read_b64_tr_b16 v[206:207], v225 offset:3712
    ds_read_b64_tr_b16 v[208:209], v225 offset:160
    ds_read_b64_tr_b16 v[210:211], v225 offset:3744
    ds_read_b64_tr_b16 v[212:213], v225 offset:192
    ds_read_b64_tr_b16 v[214:215], v225 offset:3776
    s_waitcnt lgkmcnt(0)
    v_mfma_f32_16x16x32_bf16 v[192:195], v[204:207], v[220:223], v[192:195]
    v_mfma_f32_16x16x32_bf16 v[196:199], v[208:211], v[220:223], v[196:199]
    v_mfma_f32_16x16x32_bf16 v[200:203], v[212:215], v[220:223], v[200:203]
    s_nop 7
    s_lshl_b32 s64, s34, 1
    s_and_b32 s65, s3, 1
    s_add_u32 s64, s64, s65
    s_mul_i32 s64, s64, 14336
    s_mul_i32 s65, s74, 896
    s_add_u32 s64, s64, s65
    s_lshr_b32 s65, s69, 1
    s_mul_i32 s65, s65, 448
    s_add_u32 s64, s64, s65
    s_add_u32 s64, s64, 74448896
    v_lshlrev_b32 v225, 4, v251
    s_mov_b32 exec_lo, 0x00010001
    s_mov_b32 exec_hi, 0x00010001
    buffer_store_dwordx4 v[176:179], v225, s[80:83], s64 offen offset:0 sc0 sc1
    buffer_store_dwordx4 v[180:183], v225, s[80:83], s64 offen offset:64 sc0 sc1
    buffer_store_dwordx4 v[184:187], v225, s[80:83], s64 offen offset:128 sc0 sc1
    buffer_store_dwordx4 v[188:191], v225, s[80:83], s64 offen offset:192 sc0 sc1
    buffer_store_dwordx4 v[192:195], v225, s[80:83], s64 offen offset:256 sc0 sc1
    buffer_store_dwordx4 v[196:199], v225, s[80:83], s64 offen offset:320 sc0 sc1
    buffer_store_dwordx4 v[200:203], v225, s[80:83], s64 offen offset:384 sc0 sc1
    s_mov_b64 exec, -1
    s_nop 3
    s_branch cs_45_b
cf_546:
    s_lshl_b32 s64, s74, 4
    s_add_u32 s64, s64, s34
    s_lshl_b32 s64, s64, 3
    s_add_u32 s64, s64, s69
    s_lshl_b32 s64, s64, 2
    s_add_u32 s64, s64, 75628544
    v_mov_b32 v216, 0
    v_mov_b32 v217, 1
    s_mov_b64 exec, 1
    buffer_store_dword v217, v216, s[80:83], s64 offen sc0 sc1
    s_mov_b64 exec, -1
    s_branch cf_546_b
g3c1_hook:
    s_cmp_lt_u32 s24, 3
    s_cbranch_scc1 g3c1_h2
    s_mov_b32 s12, s96
    s_mov_b32 s13, s97
    s_mov_b32 s14, 7340032
    s_mov_b32 s15, 0x00020000
    s_lshl_b32 s64, s2, 2
    s_add_u32 s64, s64, s69
    s_mul_i32 s64, s64, 7168
    v_lshlrev_b32 v247, 7, v250
    s_mov_b32 exec_hi, 0x00ffffff
    buffer_load_dword v248, v247, s[12:15], s64 offen
    s_mov_b64 exec, -1
    s_branch g3c1_hb
g3c1_h2:
    s_lshl_b32 s64, s74, 9
    s_add_u32 s64, s64, 75628544
    v_lshlrev_b32 v225, 5, v252
    s_cmp_eq_u32 s24, 1
    s_cbranch_scc1 g3c1_h1
    buffer_load_dwordx4 v[216:219], v225, s[80:83], s64 offen sc1
    s_branch g3c1_hb
g3c1_h1:
    v_and_b32 v216, v216, v217
    v_and_b32 v218, v218, v219
    v_and_b32 v216, v216, v218
    v_cmp_ne_u32 vcc, 1, v216
    s_cbranch_vccz g3c1_h1b
    s_mov_b64 exec, 0xffff
pl_1547:
    buffer_load_dwordx4 v[216:219], v225, s[80:83], s64 offen sc1
    s_sub_u32 s79, s79, 1
    s_cbranch_scc1 L_abort
    s_waitcnt vmcnt(0)
    v_and_b32 v216, v216, v217
    v_and_b32 v218, v218, v219
    v_and_b32 v216, v216, v218
    v_cmp_ne_u32 vcc, 1, v216
    s_cbranch_vccnz pl_1547
    s_mov_b64 exec, -1
g3c1_h1b:
    s_and_b32 s64, s3, 1
    s_mul_i32 s64, s64, 14336
    s_mul_i32 s65, s74, 896
    s_add_u32 s64, s64, s65
    s_lshr_b32 s65, s69, 1
    s_mul_i32 s65, s65, 448
    s_add_u32 s64, s64, s65
    s_add_u32 s64, s64, 74448896
    v_and_b32 v225, 31, v250
    v_lshlrev_b32 v225, 4, v225
    v_lshrrev_b32 v253, 5, v250
    v_mul_u32_u24 v253, 229376, v253
    v_add_u32 v225, v253, v225
    s_mov_b32 exec_lo, 0x0fffffff
    s_mov_b32 exec_hi, 0x0fffffff
    buffer_load_dwordx4 v[176:179], v225, s[80:83], s64 offen sc1
    s_add_u32 s64, s64, 28672
    buffer_load_dwordx4 v[180:183], v225, s[80:83], s64 offen sc1
    s_add_u32 s64, s64, 28672
    buffer_load_dwordx4 v[184:187], v225, s[80:83], s64 offen sc1
    s_add_u32 s64, s64, 28672
    buffer_load_dwordx4 v[188:191], v225, s[80:83], s64 offen sc1
    s_add_u32 s64, s64, 28672
    buffer_load_dwordx4 v[192:195], v225, s[80:83], s64 offen sc1
    s_add_u32 s64, s64, 28672
    buffer_load_dwordx4 v[196:199], v225, s[80:83], s64 offen sc1
    s_add_u32 s64, s64, 28672
    buffer_load_dwordx4 v[200:203], v225, s[80:83], s64 offen sc1
    s_add_u32 s64, s64, 28672
    buffer_load_dwordx4 v[204:207], v225, s[80:83], s64 offen sc1
    s_add_u32 s64, s64, 28672
    s_mov_b64 exec, -1
    s_branch g3c1_hb
sg_2548_slow:
    s_waitcnt vmcnt(0)
    buffer_wbl2 sc1
    s_waitcnt vmcnt(0)
    s_mov_b64 exec, 1
    buffer_store_dword v145, v144, s[80:83], s64 offen sc0 sc1
    s_mov_b64 exec, -1
    s_branch sg_2548_done
pl_2549_acq:
    buffer_inv sc1
    s_waitcnt vmcnt(0)
    s_branch pl_2549_ok
pl_2550_acq:
    buffer_inv sc1
    s_waitcnt vmcnt(0)
    s_branch pl_2550_ok
pl_2552_acq:
    buffer_inv sc1
    s_waitcnt vmcnt(0)
    s_branch pl_2552_ok
L_fin:
L_abort:
L_end:
    s_endpgm
.section .rodata,"a"
.p2align 6
.amdhsa_kernel interleave_layers__sliding_local_dilated__glu_gated_swiglu__prompt_kernel
  .amdhsa_next_free_vgpr 256
  .amdhsa_next_free_sgpr 102
  .amdhsa_accum_offset 256
  .amdhsa_group_segment_fixed_size 0
  .amdhsa_kernarg_size 80
  .amdhsa_user_sgpr_count 2
  .amdhsa_user_sgpr_kernarg_segment_ptr 1
  .amdhsa_system_sgpr_workgroup_id_x 1
.end_amdhsa_kernel
```

```asm
; @launch grid=(256,1,1) block=(512,1,1) lds=163840
.amdgcn_target "amdgcn-amd-amdhsa--gfx950"
.text
.globl interleave_layers__sliding_local_dilated__glu_gated_swiglu__prompt_kernel
.p2align 8
.type interleave_layers__sliding_local_dilated__glu_gated_swiglu__prompt_kernel,@function
interleave_layers__sliding_local_dilated__glu_gated_swiglu__prompt_kernel:
    s_cmp_ge_u32 s2, 256
    s_cbranch_scc1 L_end
    s_load_dwordx4 s[84:87], s[0:1], 0
    s_load_dwordx2 s[4:5], s[0:1], 72
    s_load_dwordx2 s[88:89], s[0:1], 16
    s_load_dwordx4 s[92:95], s[0:1], 32
    s_load_dwordx4 s[96:99], s[0:1], 48
    s_load_dwordx2 s[90:91], s[0:1], 64
    v_lshrrev_b32 v1, 6, v0
    v_and_b32 v250, 63, v0
    v_readfirstlane_b32 s3, v1
    v_lshrrev_b32 v251, 4, v250
    v_and_b32 v252, 15, v250
    v_lshlrev_b32 v249, 4, v250
    s_and_b32 s70, s2, 7
    s_lshr_b32 s72, s2, 4
    s_lshr_b32 s71, s2, 3
    s_and_b32 s71, s71, 1
    s_lshl_b32 s73, s70, 1
    s_add_u32 s73, s73, s71
    s_and_b32 s68, s72, 1
    s_lshl_b32 s67, s68, 1
    s_xor_b32 s67, s67, s73
    s_and_b32 s64, s70, 1
    s_lshl_b32 s64, s64, 3
    s_lshr_b32 s74, s72, 1
    s_add_u32 s74, s74, s64
    s_and_b32 s58, s70, 6
    s_lshl_b32 s57, s58, 1
    s_sub_u32 s61, s74, s58
    s_add_u32 s61, s61, 3
    s_and_b32 s61, s61, 7
    s_mov_b32 s60, 0
    s_mov_b32 s59, 1
    s_and_b32 s69, s3, 3
    s_mov_b32 s75, 0
    s_mov_b32 s78, 1
    s_mov_b32 s79, 4194304
    s_waitcnt lgkmcnt(0)
    s_mov_b32 s80, s4
    s_mov_b32 s81, s5
    s_mov_b32 s82, 79691776
    s_mov_b32 s83, 0x00020000
    s_cmp_ge_u32 s3, 4
    s_cbranch_scc1 L_load
    s_mul_i32 s64, s3, 18432
    v_add_u32 v8, s64, v249
    v_mov_b32 v4, 0x3f803f80
    v_mov_b32 v5, 0x3f803f80
    v_mov_b32 v6, 0x3f803f80
    v_mov_b32 v7, 0x3f803f80
    s_mov_b64 exec, 0xff
    ds_write_b128 v8, v[4:7]
    s_mov_b64 exec, -1
    v_mov_b32 v0, 0
    s_cmp_lg_u32 s3, 3
    s_cbranch_scc1 L_noinit
    v_mov_b32 v1, 0
    v_mov_b32 v2, 0
    v_mov_b32 v3, 0
    v_lshrrev_b32 v8, 1, v250
    v_lshlrev_b32 v8, 13, v8
    v_and_b32 v9, 1, v250
    v_lshl_add_u32 v8, v9, 4, v8
    s_lshl_b32 s64, s73, 4
    s_add_u32 s64, s64, s72
    s_lshl_b32 s64, s64, 5
    s_add_u32 s65, s64, 75497472
    s_mov_b64 exec, 0xffff
    buffer_store_dwordx4 v[0:3], v8, s[80:83], s65 offen sc0 sc1
    v_lshrrev_b32 v8, 2, v250
    v_lshlrev_b32 v8, 17, v8
    v_and_b32 v9, 3, v250
    v_lshl_add_u32 v8, v9, 7, v8
    s_lshl_b32 s64, s2, 9
    s_add_u32 s65, s64, 75759616
    s_mov_b64 exec, 0xff
    buffer_store_dwordx4 v[0:3], v8, s[80:83], s65 offen sc0 sc1
    v_lshlrev_b32 v8, 12, v250
    s_lshl_b32 s64, s73, 1
    s_add_u32 s64, s64, s68
    s_lshl_b32 s64, s64, 7
    s_add_u32 s64, s64, 75563008
    s_cmp_lt_u32 s72, 2
    s_cselect_b32 s64, s64, 0x7f000000
    s_mov_b64 exec, 31
    buffer_store_dwordx4 v[0:3], v8, s[80:83], s64 offen sc0 sc1
    s_mov_b64 exec, 3
    s_add_u32 s65, s58, s71
    s_lshl_b32 s65, s65, 1
    s_add_u32 s65, s65, s68
    s_lshl_b32 s64, s74, 4
    s_add_u32 s64, s64, s65
    s_lshl_b32 s64, s64, 5
    s_add_u32 s65, s64, 75628544
    buffer_store_dwordx4 v[0:3], v249, s[80:83], s65 offen sc0 sc1
    s_mov_b64 exec, -1
L_noinit:
    s_mov_b32 s8, s84
    s_mov_b32 s9, s85
    s_mov_b32 s10, 4194304
    s_mov_b32 s11, 0x00020000
    s_lshl_b32 s16, s72, 2
    s_add_u32 s16, s16, s3
    s_lshl_b32 s16, s16, 1
    s_lshl_b32 s17, s73, 7
    s_add_u32 s18, s17, s16
    s_lshl_b32 s18, s18, 11
    s_add_u32 s19, s17, s72
    s_sub_u32 s19, s19, 16
    s_lshl_b32 s19, s19, 11
    s_cmp_eq_u32 s73, 0
    s_cselect_b32 s19, 0x7f000000, s19
    s_cmp_lg_u32 s3, 0
    s_cselect_b32 s19, 0x7f000000, s19
    buffer_load_dwordx4 v[16:19], v249, s[8:11], s18 offen offset:0
    buffer_load_dwordx4 v[20:23], v249, s[8:11], s18 offen offset:1024
    buffer_load_dwordx4 v[24:27], v249, s[8:11], s18 offen offset:2048
    buffer_load_dwordx4 v[28:31], v249, s[8:11], s18 offen offset:3072
    v_mov_b32 v32, 0
    v_mov_b32 v33, 0
    v_mov_b32 v34, 0
    v_mov_b32 v35, 0
    v_mov_b32 v36, 0
    v_mov_b32 v37, 0
    v_mov_b32 v38, 0
    v_mov_b32 v39, 0
    s_cbranch_scc1 xs_1
    buffer_load_dwordx4 v[32:35], v249, s[8:11], s19 offen offset:0
    buffer_load_dwordx4 v[36:39], v249, s[8:11], s19 offen offset:1024
xs_1:
    v_mov_b32 v56, 0x3f803f80
    s_waitcnt vmcnt(0)
    v_dot2_f32_bf16 v48, v16, v56, 0
    v_dot2_f32_bf16 v49, v16, v16, 0
    v_dot2_f32_bf16 v48, v17, v56, v48
    v_dot2_f32_bf16 v49, v17, v17, v49
    v_dot2_f32_bf16 v48, v18, v56, v48
    v_dot2_f32_bf16 v49, v18, v18, v49
    v_dot2_f32_bf16 v48, v19, v56, v48
    v_dot2_f32_bf16 v49, v19, v19, v49
    v_dot2_f32_bf16 v48, v20, v56, v48
    v_dot2_f32_bf16 v49, v20, v20, v49
    v_dot2_f32_bf16 v48, v21, v56, v48
    v_dot2_f32_bf16 v49, v21, v21, v49
    v_dot2_f32_bf16 v48, v22, v56, v48
    v_dot2_f32_bf16 v49, v22, v22, v49
    v_dot2_f32_bf16 v48, v23, v56, v48
    v_dot2_f32_bf16 v49, v23, v23, v49
    v_dot2_f32_bf16 v50, v24, v56, 0
    v_dot2_f32_bf16 v51, v24, v24, 0
    v_dot2_f32_bf16 v50, v25, v56, v50
    v_dot2_f32_bf16 v51, v25, v25, v51
    v_dot2_f32_bf16 v50, v26, v56, v50
    v_dot2_f32_bf16 v51, v26, v26, v51
    v_dot2_f32_bf16 v50, v27, v56, v50
    v_dot2_f32_bf16 v51, v27, v27, v51
    v_dot2_f32_bf16 v50, v28, v56, v50
    v_dot2_f32_bf16 v51, v28, v28, v51
    v_dot2_f32_bf16 v50, v29, v56, v50
    v_dot2_f32_bf16 v51, v29, v29, v51
    v_dot2_f32_bf16 v50, v30, v56, v50
    v_dot2_f32_bf16 v51, v30, v30, v51
    v_dot2_f32_bf16 v50, v31, v56, v50
    v_dot2_f32_bf16 v51, v31, v31, v51
    v_dot2_f32_bf16 v52, v32, v56, 0
    v_dot2_f32_bf16 v53, v32, v32, 0
    v_dot2_f32_bf16 v52, v33, v56, v52
    v_dot2_f32_bf16 v53, v33, v33, v53
    v_dot2_f32_bf16 v52, v34, v56, v52
    v_dot2_f32_bf16 v53, v34, v34, v53
    v_dot2_f32_bf16 v52, v35, v56, v52
    v_dot2_f32_bf16 v53, v35, v35, v53
    v_dot2_f32_bf16 v52, v36, v56, v52
    v_dot2_f32_bf16 v53, v36, v36, v53
    v_dot2_f32_bf16 v52, v37, v56, v52
    v_dot2_f32_bf16 v53, v37, v37, v53
    v_dot2_f32_bf16 v52, v38, v56, v52
    v_dot2_f32_bf16 v53, v38, v38, v53
    v_dot2_f32_bf16 v52, v39, v56, v52
    v_dot2_f32_bf16 v53, v39, v39, v53
    s_nop 2
    v_add_f32_dpp v48, v48, v48 quad_perm:[1,0,3,2] row_mask:0xf bank_mask:0xf
    v_add_f32_dpp v49, v49, v49 quad_perm:[1,0,3,2] row_mask:0xf bank_mask:0xf
    v_add_f32_dpp v50, v50, v50 quad_perm:[1,0,3,2] row_mask:0xf bank_mask:0xf
    v_add_f32_dpp v51, v51, v51 quad_perm:[1,0,3,2] row_mask:0xf bank_mask:0xf
    v_add_f32_dpp v52, v52, v52 quad_perm:[1,0,3,2] row_mask:0xf bank_mask:0xf
    v_add_f32_dpp v53, v53, v53 quad_perm:[1,0,3,2] row_mask:0xf bank_mask:0xf
    v_add_f32_dpp v48, v48, v48 quad_perm:[2,3,0,1] row_mask:0xf bank_mask:0xf
    v_add_f32_dpp v49, v49, v49 quad_perm:[2,3,0,1] row_mask:0xf bank_mask:0xf
    v_add_f32_dpp v50, v50, v50 quad_perm:[2,3,0,1] row_mask:0xf bank_mask:0xf
    v_add_f32_dpp v51, v51, v51 quad_perm:[2,3,0,1] row_mask:0xf bank_mask:0xf
    v_add_f32_dpp v52, v52, v52 quad_perm:[2,3,0,1] row_mask:0xf bank_mask:0xf
    v_add_f32_dpp v53, v53, v53 quad_perm:[2,3,0,1] row_mask:0xf bank_mask:0xf
    v_add_f32_dpp v48, v48, v48 row_half_mirror row_mask:0xf bank_mask:0xf
    v_add_f32_dpp v49, v49, v49 row_half_mirror row_mask:0xf bank_mask:0xf
    v_add_f32_dpp v50, v50, v50 row_half_mirror row_mask:0xf bank_mask:0xf
    v_add_f32_dpp v51, v51, v51 row_half_mirror row_mask:0xf bank_mask:0xf
    v_add_f32_dpp v52, v52, v52 row_half_mirror row_mask:0xf bank_mask:0xf
    v_add_f32_dpp v53, v53, v53 row_half_mirror row_mask:0xf bank_mask:0xf
    v_add_f32_dpp v48, v48, v48 row_mirror row_mask:0xf bank_mask:0xf
    v_add_f32_dpp v49, v49, v49 row_mirror row_mask:0xf bank_mask:0xf
    v_add_f32_dpp v50, v50, v50 row_mirror row_mask:0xf bank_mask:0xf
    v_add_f32_dpp v51, v51, v51 row_mirror row_mask:0xf bank_mask:0xf
    v_add_f32_dpp v52, v52, v52 row_mirror row_mask:0xf bank_mask:0xf
    v_add_f32_dpp v53, v53, v53 row_mirror row_mask:0xf bank_mask:0xf
    v_mov_b32 v16, v48
    v_mov_b32 v17, v49
    v_mov_b32 v18, v50
    v_mov_b32 v19, v51
    v_mov_b32 v20, v52
    v_mov_b32 v21, v53
    s_nop 1
    v_permlane16_swap_b32 v48, v16
    v_permlane16_swap_b32 v49, v17
    v_permlane16_swap_b32 v50, v18
    v_permlane16_swap_b32 v51, v19
    v_permlane16_swap_b32 v52, v20
    v_permlane16_swap_b32 v53, v21
    v_add_f32 v48, v48, v16
    v_add_f32 v49, v49, v17
    v_add_f32 v50, v50, v18
    v_add_f32 v51, v51, v19
    v_add_f32 v52, v52, v20
    v_add_f32 v53, v53, v21
    v_mov_b32 v16, v48
    v_mov_b32 v17, v49
    v_mov_b32 v18, v50
    v_mov_b32 v19, v51
    v_mov_b32 v20, v52
    v_mov_b32 v21, v53
    s_nop 1
    v_permlane32_swap_b32 v48, v16
    v_permlane32_swap_b32 v49, v17
    v_permlane32_swap_b32 v50, v18
    v_permlane32_swap_b32 v51, v19
    v_permlane32_swap_b32 v52, v20
    v_permlane32_swap_b32 v53, v21
    v_add_f32 v48, v48, v16
    v_add_f32 v49, v49, v17
    v_add_f32 v50, v50, v18
    v_add_f32 v51, v51, v19
    v_add_f32 v52, v52, v20
    v_add_f32 v53, v53, v21
    v_cmp_eq_u32 vcc, 1, v250
    s_nop 1
    v_cndmask_b32 v48, v48, v50, vcc
    v_cndmask_b32 v49, v49, v51, vcc
    v_cmp_eq_u32 vcc, 2, v250
    s_nop 1
    v_cndmask_b32 v48, v48, v52, vcc
    v_cndmask_b32 v49, v49, v53, vcc
    v_mul_f32 v48, 0x3a800000, v48
    v_mul_f32 v49, 0x3a800000, v49
    v_fma_f32 v49, -v48, v48, v49
    v_max_f32 v49, 0, v49
    v_cvt_pk_bf16_f32 v48, v48, v48
    v_lshlrev_b32 v48, 16, v48
    v_cvt_pk_bf16_f32 v49, v49, v49
    v_lshlrev_b32 v49, 16, v49
    v_add_f32 v49, 0x3727c5ac, v49
    v_cvt_pk_bf16_f32 v49, v49, v49
    v_lshlrev_b32 v49, 16, v49
    v_sqrt_f32 v49, v49
    s_nop 0
    v_cvt_pk_bf16_f32 v49, v49, v49
    v_lshlrev_b32 v49, 16, v49
    v_rcp_f32 v49, v49
    s_nop 0
    s_add_u32 s16, s16, 16
    v_add_u32 v16, s16, v250
    v_mov_b32 v17, s72
    v_cndmask_b32 v16, v16, v17, vcc
    v_lshlrev_b32 v16, 3, v16
    s_lshl_b32 s17, s73, 11
    s_add_u32 s17, s17, 74186752
    s_cmp_eq_u32 s3, 0
    s_cselect_b64 exec, 7, 3
    buffer_store_dwordx2 v[48:49], v16, s[80:83], s17 offen sc0 sc1
    s_mov_b64 exec, -1
    s_waitcnt lgkmcnt(0)
C_layer:
    s_and_b32 s19, s3, 1
    s_lshr_b32 s20, s3, 1
    s_cmp_lg_u32 s75, 0
    s_cbranch_scc1 ad_2_f
    v_lshlrev_b32 v253, 7, v252
    v_and_b32 v254, 6, v250
    v_xor_b32 v254, v254, v251
    v_lshl_add_u32 v204, v254, 4, v253
    v_xor_b32 v205, 64, v204
    s_branch ad_2_d
ad_2_f:
    v_mov_b32 v204, v249
    v_add_u32 v205, 1024, v249
ad_2_d:
    v_lshrrev_b32 v253, 2, v252
    v_mul_u32_u24 v253, 3104, v253
    v_lshl_add_u32 v253, v251, 7, v253
    v_and_b32 v254, 3, v252
    v_lshl_add_u32 v253, v254, 3, v253
    s_lshl_b32 s64, s19, 6
    s_add_u32 s64, s64, 73984
    v_add_u32 v208, s64, v253
    v_mov_b32 v209, v208
    s_mov_b32 s16, 0
    s_mov_b32 s17, 18432
    v_add_u32 v206, s17, v204
    v_add_u32 v207, s17, v205
    s_lshl_b32 s21, s67, 4
    s_add_u32 s21, s21, s74
    s_lshl_b32 s21, s21, 1
    s_add_u32 s21, s21, s19
    s_lshl_b32 s21, s21, 1
    s_add_u32 s21, s21, s20
    s_lshl_b32 s21, s21, 12
    s_lshl_b32 s64, s75, 22
    s_add_u32 s21, s21, s64
    s_add_u32 s21, s21, 12582912
    v_and_b32 v254, 1, v252
    v_cmp_eq_u32 s[28:29], 1, v254
    v_lshlrev_b32 v253, 2, v251
    v_sub_u32 v253, v252, v253
    v_sub_u32 v253, v253, v254
    v_lshlrev_b32 v254, 4, v254
    v_mov_b32 v210, 0xffff
    v_lshlrev_b32 v210, v254, v210
    v_cmp_le_i32 s[30:31], 0, v253
    v_cmp_le_i32 s[32:33], 2, v253
    s_or_b32 s22, s67, s20
    s_cmp_eq_u32 s22, 0
    s_cselect_b64 s[34:35], s[30:31], -1
    s_cselect_b64 s[36:37], s[32:33], -1
    v_cndmask_b32 v232, v210, 0, s[30:31]
    v_cndmask_b32 v234, 0, v210, s[30:31]
    v_cndmask_b32 v233, v210, 0, s[32:33]
    v_cndmask_b32 v235, 0, v210, s[32:33]
    s_mov_b32 s23, 0x3e8293ee
    s_mul_i32 s64, s19, 6144
    s_add_u32 s64, s64, 18432
    v_add_u32 v236, s64, v249
    s_mul_i32 s64, s19, 384
    s_add_u32 s64, s64, 162688
    v_lshlrev_b32 v237, 4, v251
    v_add_u32 v237, s64, v237
    v_lshlrev_b32 v238, 2, v252
    v_add_u32 v238, s64, v238
    s_lshl_b32 s64, s20, 9
    s_add_u32 s64, s64, 159744
    v_lshlrev_b32 v239, 3, v252
    v_add_u32 v239, s64, v239
    v_lshlrev_b32 v240, 5, v251
    v_add_u32 v240, s64, v240
    v_mov_b32 v241, 163456
    v_mov_b32 v212, 0
    v_mov_b32 v213, 0
    v_mov_b32 v214, 0
    v_mov_b32 v215, 0
    s_mov_b32 s18, 16
    s_nop 0
    v_mfma_f32_32x32x16_bf16 v[0:15], v[212:215], v[212:215], 0
    v_mfma_f32_32x32x16_bf16 v[16:31], v[212:215], v[212:215], 0
    v_mfma_f32_32x32x16_bf16 v[32:47], v[212:215], v[212:215], 0
    v_mfma_f32_32x32x16_bf16 v[48:63], v[212:215], v[212:215], 0
    v_mfma_f32_32x32x16_bf16 v[64:79], v[212:215], v[212:215], 0
    v_mfma_f32_32x32x16_bf16 v[80:95], v[212:215], v[212:215], 0
    v_mfma_f32_32x32x16_bf16 v[96:111], v[212:215], v[212:215], 0
    v_mfma_f32_32x32x16_bf16 v[112:127], v[212:215], v[212:215], 0
    s_nop 7
    s_nop 3
    s_cmp_eq_u32 s20, 1
    s_cbranch_scc1 g1c_r1
    s_barrier
    ds_read_b128 v[116:119], v206 offset:0
    ds_read_b64_tr_b16 v[164:165], v209 offset:13440
    ds_read_b64_tr_b16 v[166:167], v209 offset:13952
    ds_read_b128 v[120:123], v206 offset:2048
    ds_read_b64_tr_b16 v[168:169], v209 offset:13472
    ds_read_b64_tr_b16 v[170:171], v209 offset:13984
    ds_read_b128 v[124:127], v206 offset:4096
    ds_read_b64_tr_b16 v[172:173], v209 offset:14464
    ds_read_b64_tr_b16 v[174:175], v209 offset:14976
    ds_read_b128 v[128:131], v206 offset:6144
    ds_read_b64_tr_b16 v[176:177], v209 offset:14496
    ds_read_b64_tr_b16 v[178:179], v209 offset:15008
    ds_read_b128 v[132:135], v206 offset:8192
    ds_read_b64_tr_b16 v[156:157], v209 offset:12416
    ds_read_b64_tr_b16 v[158:159], v209 offset:12928
    ds_read_b64_tr_b16 v[160:161], v209 offset:12448
    ds_read_b64_tr_b16 v[162:163], v209 offset:12960
    s_add_u32 s16, s16, 24832
    s_cmp_eq_u32 s16, 74496
    s_cselect_b32 s16, 0, s16
    v_add_u32 v209, s16, v208
    s_waitcnt lgkmcnt(0)
g1c_loop0:
    s_barrier
    v_mfma_f32_16x16x32_bf16 v[112:115], v[156:159], v[116:119], v[112:115]
    ds_read_b128 v[136:139], v207 offset:0
    v_mfma_f32_16x16x32_bf16 v[32:35], v[164:167], v[116:119], v[32:35]
    ds_read_b64_tr_b16 v[188:189], v209 offset:1024
    v_mfma_f32_16x16x32_bf16 v[36:39], v[168:171], v[116:119], v[36:39]
    ds_read_b64_tr_b16 v[190:191], v209 offset:1536
    v_mfma_f32_16x16x32_bf16 v[40:43], v[164:167], v[120:123], v[40:43]
    ds_read_b128 v[140:143], v207 offset:2048
    v_mfma_f32_16x16x32_bf16 v[48:51], v[164:167], v[124:127], v[48:51]
    ds_read_b64_tr_b16 v[192:193], v209 offset:1056
    v_mfma_f32_16x16x32_bf16 v[56:59], v[164:167], v[128:131], v[56:59]
    ds_read_b64_tr_b16 v[194:195], v209 offset:1568
    v_mfma_f32_16x16x32_bf16 v[64:67], v[164:167], v[132:135], v[64:67]
    ds_read_b128 v[144:147], v207 offset:4096
    v_mfma_f32_16x16x32_bf16 v[44:47], v[168:171], v[120:123], v[44:47]
    ds_read_b64_tr_b16 v[196:197], v209 offset:2048
    v_mfma_f32_16x16x32_bf16 v[52:55], v[168:171], v[124:127], v[52:55]
    ds_read_b64_tr_b16 v[198:199], v209 offset:2560
    v_mfma_f32_16x16x32_bf16 v[60:63], v[168:171], v[128:131], v[60:63]
    ds_read_b128 v[148:151], v207 offset:6144
    v_mfma_f32_16x16x32_bf16 v[68:71], v[168:171], v[132:135], v[68:71]
    ds_read_b64_tr_b16 v[200:201], v209 offset:2080
    v_mfma_f32_16x16x32_bf16 v[80:83], v[120:123], v[172:175], v[80:83]
    ds_read_b64_tr_b16 v[202:203], v209 offset:2592
    v_mfma_f32_16x16x32_bf16 v[88:91], v[124:127], v[172:175], v[88:91]
    ds_read_b128 v[152:155], v207 offset:8192
    v_mfma_f32_16x16x32_bf16 v[96:99], v[128:131], v[172:175], v[96:99]
    ds_read_b64_tr_b16 v[180:181], v209 offset:0
    v_mfma_f32_16x16x32_bf16 v[104:107], v[132:135], v[172:175], v[104:107]
    ds_read_b64_tr_b16 v[182:183], v209 offset:512
    v_mfma_f32_16x16x32_bf16 v[84:87], v[120:123], v[176:179], v[84:87]
    ds_read_b64_tr_b16 v[184:185], v209 offset:32
    v_mfma_f32_16x16x32_bf16 v[92:95], v[124:127], v[176:179], v[92:95]
    ds_read_b64_tr_b16 v[186:187], v209 offset:544
    v_mfma_f32_16x16x32_bf16 v[100:103], v[128:131], v[176:179], v[100:103]
    v_mfma_f32_16x16x32_bf16 v[108:111], v[132:135], v[176:179], v[108:111]
    s_add_u32 s17, s17, 18432
    s_cmp_eq_u32 s17, 73728
    v_mfma_f32_16x16x32_bf16 v[0:3], v[156:159], v[120:123], v[0:3]
    v_mfma_f32_16x16x32_bf16 v[8:11], v[156:159], v[124:127], v[8:11]
    s_cselect_b32 s17, 0, s17
    v_mfma_f32_16x16x32_bf16 v[16:19], v[156:159], v[128:131], v[16:19]
    v_mfma_f32_16x16x32_bf16 v[24:27], v[156:159], v[132:135], v[24:27]
    v_add_u32 v206, s17, v204
    v_mfma_f32_16x16x32_bf16 v[4:7], v[160:163], v[120:123], v[4:7]
    v_mfma_f32_16x16x32_bf16 v[12:15], v[160:163], v[124:127], v[12:15]
    v_add_u32 v207, s17, v205
    v_mfma_f32_16x16x32_bf16 v[20:23], v[160:163], v[128:131], v[20:23]
    v_mfma_f32_16x16x32_bf16 v[28:31], v[160:163], v[132:135], v[28:31]
    s_waitcnt lgkmcnt(0)
    v_mfma_f32_16x16x32_bf16 v[112:115], v[180:183], v[136:139], v[112:115]
    ds_read_b128 v[116:119], v206 offset:0
    v_mfma_f32_16x16x32_bf16 v[32:35], v[188:191], v[136:139], v[32:35]
    ds_read_b64_tr_b16 v[164:165], v209 offset:13440
    v_mfma_f32_16x16x32_bf16 v[36:39], v[192:195], v[136:139], v[36:39]
    ds_read_b64_tr_b16 v[166:167], v209 offset:13952
    v_mfma_f32_16x16x32_bf16 v[40:43], v[188:191], v[140:143], v[40:43]
    ds_read_b128 v[120:123], v206 offset:2048
    v_mfma_f32_16x16x32_bf16 v[48:51], v[188:191], v[144:147], v[48:51]
    ds_read_b64_tr_b16 v[168:169], v209 offset:13472
    v_mfma_f32_16x16x32_bf16 v[56:59], v[188:191], v[148:151], v[56:59]
    ds_read_b64_tr_b16 v[170:171], v209 offset:13984
    v_mfma_f32_16x16x32_bf16 v[64:67], v[188:191], v[152:155], v[64:67]
    ds_read_b128 v[124:127], v206 offset:4096
    v_mfma_f32_16x16x32_bf16 v[44:47], v[192:195], v[140:143], v[44:47]
    ds_read_b64_tr_b16 v[172:173], v209 offset:14464
    v_mfma_f32_16x16x32_bf16 v[52:55], v[192:195], v[144:147], v[52:55]
    ds_read_b64_tr_b16 v[174:175], v209 offset:14976
    v_mfma_f32_16x16x32_bf16 v[60:63], v[192:195], v[148:151], v[60:63]
    ds_read_b128 v[128:131], v206 offset:6144
    v_mfma_f32_16x16x32_bf16 v[68:71], v[192:195], v[152:155], v[68:71]
    ds_read_b64_tr_b16 v[176:177], v209 offset:14496
    v_mfma_f32_16x16x32_bf16 v[80:83], v[140:143], v[196:199], v[80:83]
    ds_read_b64_tr_b16 v[178:179], v209 offset:15008
    v_mfma_f32_16x16x32_bf16 v[88:91], v[144:147], v[196:199], v[88:91]
    ds_read_b128 v[132:135], v206 offset:8192
    v_mfma_f32_16x16x32_bf16 v[96:99], v[148:151], v[196:199], v[96:99]
    ds_read_b64_tr_b16 v[156:157], v209 offset:12416
    v_mfma_f32_16x16x32_bf16 v[104:107], v[152:155], v[196:199], v[104:107]
    ds_read_b64_tr_b16 v[158:159], v209 offset:12928
    v_mfma_f32_16x16x32_bf16 v[84:87], v[140:143], v[200:203], v[84:87]
    ds_read_b64_tr_b16 v[160:161], v209 offset:12448
    v_mfma_f32_16x16x32_bf16 v[92:95], v[144:147], v[200:203], v[92:95]
    ds_read_b64_tr_b16 v[162:163], v209 offset:12960
    v_mfma_f32_16x16x32_bf16 v[100:103], v[148:151], v[200:203], v[100:103]
    v_mfma_f32_16x16x32_bf16 v[108:111], v[152:155], v[200:203], v[108:111]
    s_add_u32 s16, s16, 24832
    s_cmp_eq_u32 s16, 74496
    v_mfma_f32_16x16x32_bf16 v[0:3], v[180:183], v[140:143], v[0:3]
    v_mfma_f32_16x16x32_bf16 v[8:11], v[180:183], v[144:147], v[8:11]
    s_cselect_b32 s16, 0, s16
    v_mfma_f32_16x16x32_bf16 v[16:19], v[180:183], v[148:151], v[16:19]
    v_mfma_f32_16x16x32_bf16 v[24:27], v[180:183], v[152:155], v[24:27]
    v_add_u32 v209, s16, v208
    v_mfma_f32_16x16x32_bf16 v[4:7], v[184:187], v[140:143], v[4:7]
    v_mfma_f32_16x16x32_bf16 v[12:15], v[184:187], v[144:147], v[12:15]
    s_sub_u32 s18, s18, 1
    s_cmp_lg_u32 s18, 0
    v_mfma_f32_16x16x32_bf16 v[20:23], v[184:187], v[148:151], v[20:23]
    v_mfma_f32_16x16x32_bf16 v[28:31], v[184:187], v[152:155], v[28:31]
    s_waitcnt vmcnt(0) lgkmcnt(0)
    s_cbranch_scc1 g1c_loop0
    ds_write_b128 v236, v[64:67] offset:0
    ds_write_b128 v236, v[68:71] offset:1024
    ds_write_b128 v236, v[104:107] offset:2048
    ds_write_b128 v236, v[108:111] offset:3072
    s_mov_b32 exec_lo, 0x00010001
    s_mov_b32 exec_hi, 0x00010001
    ds_write_b128 v237, v[112:115]
    ds_write_b128 v237, v[32:35] offset:128
    ds_write_b128 v237, v[36:39] offset:192
    s_mov_b64 exec, -1
    s_waitcnt lgkmcnt(0)
    s_barrier
    ds_read_b128 v[116:119], v237 offset:0
    ds_read_b128 v[120:123], v237 offset:64
    ds_read_b128 v[124:127], v237 offset:128
    ds_read_b128 v[128:131], v237 offset:192
    ds_read2_b32 v[136:137], v239 offset0:32 offset1:32
    ds_read2_b32 v[138:139], v239 offset0:33 offset1:33
    ds_read2_b32 v[140:141], v239 offset0:64 offset1:64
    ds_read2_b32 v[142:143], v239 offset0:65 offset1:65
    ds_read2_b32 v[144:145], v239 offset0:96 offset1:96
    ds_read2_b32 v[146:147], v239 offset0:97 offset1:97
    ds_read2_b32 v[148:149], v239 offset0:128 offset1:128
    ds_read2_b32 v[150:151], v239 offset0:129 offset1:129
    ds_read2_b32 v[132:133], v239 offset0:0 offset1:0
    ds_read2_b32 v[134:135], v239 offset0:1 offset1:1
    s_waitcnt lgkmcnt(2)
    ds_read_b128 v[72:75], v236 offset:4096
    ds_read_b128 v[76:79], v236 offset:5120
    s_branch g1c_epi
g1c_r1:
    s_barrier
    ds_read_b128 v[116:119], v206 offset:0
    ds_read_b64_tr_b16 v[164:165], v209 offset:13440
    ds_read_b64_tr_b16 v[166:167], v209 offset:13952
    ds_read_b128 v[120:123], v206 offset:10240
    ds_read_b64_tr_b16 v[168:169], v209 offset:13472
    ds_read_b64_tr_b16 v[170:171], v209 offset:13984
    ds_read_b128 v[124:127], v206 offset:12288
    ds_read_b64_tr_b16 v[172:173], v209 offset:14464
    ds_read_b64_tr_b16 v[174:175], v209 offset:14976
    ds_read_b128 v[128:131], v206 offset:14336
    ds_read_b64_tr_b16 v[176:177], v209 offset:14496
    ds_read_b64_tr_b16 v[178:179], v209 offset:15008
    ds_read_b128 v[132:135], v206 offset:16384
    ds_read_b64_tr_b16 v[156:157], v209 offset:12416
    ds_read_b64_tr_b16 v[158:159], v209 offset:12928
    ds_read_b64_tr_b16 v[160:161], v209 offset:12448
    ds_read_b64_tr_b16 v[162:163], v209 offset:12960
    s_add_u32 s16, s16, 24832
    s_cmp_eq_u32 s16, 74496
    s_cselect_b32 s16, 0, s16
    v_add_u32 v209, s16, v208
    s_waitcnt lgkmcnt(0)
g1c_loop1:
    s_barrier
    v_mfma_f32_16x16x32_bf16 v[112:115], v[160:163], v[116:119], v[112:115]
    ds_read_b128 v[136:139], v207 offset:0
    v_mfma_f32_16x16x32_bf16 v[72:75], v[116:119], v[172:175], v[72:75]
    ds_read_b64_tr_b16 v[188:189], v209 offset:1024
    v_mfma_f32_16x16x32_bf16 v[76:79], v[116:119], v[176:179], v[76:79]
    ds_read_b64_tr_b16 v[190:191], v209 offset:1536
    v_mfma_f32_16x16x32_bf16 v[40:43], v[164:167], v[120:123], v[40:43]
    ds_read_b128 v[140:143], v207 offset:10240
    v_mfma_f32_16x16x32_bf16 v[48:51], v[164:167], v[124:127], v[48:51]
    ds_read_b64_tr_b16 v[192:193], v209 offset:1056
    v_mfma_f32_16x16x32_bf16 v[56:59], v[164:167], v[128:131], v[56:59]
    ds_read_b64_tr_b16 v[194:195], v209 offset:1568
    v_mfma_f32_16x16x32_bf16 v[64:67], v[164:167], v[132:135], v[64:67]
    ds_read_b128 v[144:147], v207 offset:12288
    v_mfma_f32_16x16x32_bf16 v[44:47], v[168:171], v[120:123], v[44:47]
    ds_read_b64_tr_b16 v[196:197], v209 offset:2048
    v_mfma_f32_16x16x32_bf16 v[52:55], v[168:171], v[124:127], v[52:55]
    ds_read_b64_tr_b16 v[198:199], v209 offset:2560
    v_mfma_f32_16x16x32_bf16 v[60:63], v[168:171], v[128:131], v[60:63]
    ds_read_b128 v[148:151], v207 offset:14336
    v_mfma_f32_16x16x32_bf16 v[68:71], v[168:171], v[132:135], v[68:71]
    ds_read_b64_tr_b16 v[200:201], v209 offset:2080
    v_mfma_f32_16x16x32_bf16 v[80:83], v[120:123], v[172:175], v[80:83]
    ds_read_b64_tr_b16 v[202:203], v209 offset:2592
    v_mfma_f32_16x16x32_bf16 v[88:91], v[124:127], v[172:175], v[88:91]
    ds_read_b128 v[152:155], v207 offset:16384
    v_mfma_f32_16x16x32_bf16 v[96:99], v[128:131], v[172:175], v[96:99]
    ds_read_b64_tr_b16 v[180:181], v209 offset:0
    v_mfma_f32_16x16x32_bf16 v[104:107], v[132:135], v[172:175], v[104:107]
    ds_read_b64_tr_b16 v[182:183], v209 offset:512
    v_mfma_f32_16x16x32_bf16 v[84:87], v[120:123], v[176:179], v[84:87]
    ds_read_b64_tr_b16 v[184:185], v209 offset:32
    v_mfma_f32_16x16x32_bf16 v[92:95], v[124:127], v[176:179], v[92:95]
    ds_read_b64_tr_b16 v[186:187], v209 offset:544
    v_mfma_f32_16x16x32_bf16 v[100:103], v[128:131], v[176:179], v[100:103]
    v_mfma_f32_16x16x32_bf16 v[108:111], v[132:135], v[176:179], v[108:111]
    s_add_u32 s17, s17, 18432
    s_cmp_eq_u32 s17, 73728
    v_mfma_f32_16x16x32_bf16 v[0:3], v[156:159], v[120:123], v[0:3]
    v_mfma_f32_16x16x32_bf16 v[8:11], v[156:159], v[124:127], v[8:11]
    s_cselect_b32 s17, 0, s17
    v_mfma_f32_16x16x32_bf16 v[16:19], v[156:159], v[128:131], v[16:19]
    v_mfma_f32_16x16x32_bf16 v[24:27], v[156:159], v[132:135], v[24:27]
    v_add_u32 v206, s17, v204
    v_mfma_f32_16x16x32_bf16 v[4:7], v[160:163], v[120:123], v[4:7]
    v_mfma_f32_16x16x32_bf16 v[12:15], v[160:163], v[124:127], v[12:15]
    v_add_u32 v207, s17, v205
    v_mfma_f32_16x16x32_bf16 v[20:23], v[160:163], v[128:131], v[20:23]
    v_mfma_f32_16x16x32_bf16 v[28:31], v[160:163], v[132:135], v[28:31]
    s_waitcnt lgkmcnt(0)
    v_mfma_f32_16x16x32_bf16 v[112:115], v[184:187], v[136:139], v[112:115]
    ds_read_b128 v[116:119], v206 offset:0
    v_mfma_f32_16x16x32_bf16 v[72:75], v[136:139], v[196:199], v[72:75]
    ds_read_b64_tr_b16 v[164:165], v209 offset:13440
    v_mfma_f32_16x16x32_bf16 v[76:79], v[136:139], v[200:203], v[76:79]
    ds_read_b64_tr_b16 v[166:167], v209 offset:13952
    v_mfma_f32_16x16x32_bf16 v[40:43], v[188:191], v[140:143], v[40:43]
    ds_read_b128 v[120:123], v206 offset:10240
    v_mfma_f32_16x16x32_bf16 v[48:51], v[188:191], v[144:147], v[48:51]
    ds_read_b64_tr_b16 v[168:169], v209 offset:13472
    v_mfma_f32_16x16x32_bf16 v[56:59], v[188:191], v[148:151], v[56:59]
    ds_read_b64_tr_b16 v[170:171], v209 offset:13984
    v_mfma_f32_16x16x32_bf16 v[64:67], v[188:191], v[152:155], v[64:67]
    ds_read_b128 v[124:127], v206 offset:12288
    v_mfma_f32_16x16x32_bf16 v[44:47], v[192:195], v[140:143], v[44:47]
    ds_read_b64_tr_b16 v[172:173], v209 offset:14464
    v_mfma_f32_16x16x32_bf16 v[52:55], v[192:195], v[144:147], v[52:55]
    ds_read_b64_tr_b16 v[174:175], v209 offset:14976
    v_mfma_f32_16x16x32_bf16 v[60:63], v[192:195], v[148:151], v[60:63]
    ds_read_b128 v[128:131], v206 offset:14336
    v_mfma_f32_16x16x32_bf16 v[68:71], v[192:195], v[152:155], v[68:71]
    ds_read_b64_tr_b16 v[176:177], v209 offset:14496
    v_mfma_f32_16x16x32_bf16 v[80:83], v[140:143], v[196:199], v[80:83]
    ds_read_b64_tr_b16 v[178:179], v209 offset:15008
    v_mfma_f32_16x16x32_bf16 v[88:91], v[144:147], v[196:199], v[88:91]
    ds_read_b128 v[132:135], v206 offset:16384
    v_mfma_f32_16x16x32_bf16 v[96:99], v[148:151], v[196:199], v[96:99]
    ds_read_b64_tr_b16 v[156:157], v209 offset:12416
    v_mfma_f32_16x16x32_bf16 v[104:107], v[152:155], v[196:199], v[104:107]
    ds_read_b64_tr_b16 v[158:159], v209 offset:12928
    v_mfma_f32_16x16x32_bf16 v[84:87], v[140:143], v[200:203], v[84:87]
    ds_read_b64_tr_b16 v[160:161], v209 offset:12448
    v_mfma_f32_16x16x32_bf16 v[92:95], v[144:147], v[200:203], v[92:95]
    ds_read_b64_tr_b16 v[162:163], v209 offset:12960
    v_mfma_f32_16x16x32_bf16 v[100:103], v[148:151], v[200:203], v[100:103]
    v_mfma_f32_16x16x32_bf16 v[108:111], v[152:155], v[200:203], v[108:111]
    s_add_u32 s16, s16, 24832
    s_cmp_eq_u32 s16, 74496
    v_mfma_f32_16x16x32_bf16 v[0:3], v[180:183], v[140:143], v[0:3]
    v_mfma_f32_16x16x32_bf16 v[8:11], v[180:183], v[144:147], v[8:11]
    s_cselect_b32 s16, 0, s16
    v_mfma_f32_16x16x32_bf16 v[16:19], v[180:183], v[148:151], v[16:19]
    v_mfma_f32_16x16x32_bf16 v[24:27], v[180:183], v[152:155], v[24:27]
    v_add_u32 v209, s16, v208
    v_mfma_f32_16x16x32_bf16 v[4:7], v[184:187], v[140:143], v[4:7]
    v_mfma_f32_16x16x32_bf16 v[12:15], v[184:187], v[144:147], v[12:15]
    s_sub_u32 s18, s18, 1
    s_cmp_lg_u32 s18, 0
    v_mfma_f32_16x16x32_bf16 v[20:23], v[184:187], v[148:151], v[20:23]
    v_mfma_f32_16x16x32_bf16 v[28:31], v[184:187], v[152:155], v[28:31]
    s_waitcnt vmcnt(0) lgkmcnt(0)
    s_cbranch_scc1 g1c_loop1
    ds_write_b128 v236, v[72:75] offset:4096
    ds_write_b128 v236, v[76:79] offset:5120
    s_mov_b32 exec_lo, 0x00010001
    s_mov_b32 exec_hi, 0x00010001
    ds_write_b128 v237, v[112:115] offset:64
    s_mov_b64 exec, 0xffff
    ds_write_b32 v238, v72 offset:256
    ds_write_b32 v238, v76 offset:320
    s_mov_b64 exec, -1
    s_waitcnt lgkmcnt(0)
    s_barrier
    ds_read_b128 v[116:119], v237 offset:0
    ds_read_b128 v[120:123], v237 offset:64
    ds_read_b128 v[124:127], v237 offset:128
    ds_read_b128 v[128:131], v237 offset:192
    ds_read2_b32 v[136:137], v239 offset0:32 offset1:32
    ds_read2_b32 v[138:139], v239 offset0:33 offset1:33
    ds_read2_b32 v[140:141], v239 offset0:64 offset1:64
    ds_read2_b32 v[142:143], v239 offset0:65 offset1:65
    ds_read2_b32 v[144:145], v239 offset0:96 offset1:96
    ds_read2_b32 v[146:147], v239 offset0:97 offset1:97
    ds_read2_b32 v[148:149], v239 offset0:128 offset1:128
    ds_read2_b32 v[150:151], v239 offset0:129 offset1:129
    ds_read2_b32 v[132:133], v239 offset0:0 offset1:0
    ds_read2_b32 v[134:135], v239 offset0:1 offset1:1
    s_waitcnt lgkmcnt(2)
    ds_read_b128 v[32:35], v236 offset:0
    ds_read_b128 v[36:39], v236 offset:1024
    ds_read_b128 v[72:75], v236 offset:2048
    ds_read_b128 v[76:79], v236 offset:3072
g1c_epi:
    ds_read_b32 v241, v241
    ds_read2_b32 v[196:197], v238 offset0:64 offset1:64
    ds_read2_b32 v[198:199], v238 offset0:80 offset1:80
    v_pk_fma_f32 v[0:1], v[136:137], v[116:117], v[0:1] neg_lo:[1,0,0] neg_hi:[1,0,0]
    v_pk_fma_f32 v[2:3], v[136:137], v[118:119], v[2:3] neg_lo:[1,0,0] neg_hi:[1,0,0]
    v_pk_fma_f32 v[4:5], v[136:137], v[120:121], v[4:5] neg_lo:[1,0,0] neg_hi:[1,0,0]
    v_pk_fma_f32 v[6:7], v[136:137], v[122:123], v[6:7] neg_lo:[1,0,0] neg_hi:[1,0,0]
    v_cvt_pk_bf16_f32 v0, v0, v1
    v_cvt_pk_bf16_f32 v1, v2, v3
    v_cvt_pk_bf16_f32 v2, v4, v5
    v_cvt_pk_bf16_f32 v3, v6, v7
    v_mul_f32 v200, s23, v138
    ds_read2_b32 v[164:165], v240 offset0:32 offset1:34
    ds_read2_b32 v[166:167], v240 offset0:36 offset1:38
    ds_read2_b32 v[168:169], v240 offset0:33 offset1:35
    ds_read2_b32 v[170:171], v240 offset0:37 offset1:39
    v_pk_fma_f32 v[40:41], v[136:137], v[124:125], v[40:41] neg_lo:[1,0,0] neg_hi:[1,0,0]
    v_pk_fma_f32 v[42:43], v[136:137], v[126:127], v[42:43] neg_lo:[1,0,0] neg_hi:[1,0,0]
    v_pk_fma_f32 v[44:45], v[136:137], v[128:129], v[44:45] neg_lo:[1,0,0] neg_hi:[1,0,0]
    v_pk_fma_f32 v[46:47], v[136:137], v[130:131], v[46:47] neg_lo:[1,0,0] neg_hi:[1,0,0]
    v_pk_mul_f32 v[40:41], v[138:139], v[40:41]
    v_pk_mul_f32 v[42:43], v[138:139], v[42:43]
    v_pk_mul_f32 v[44:45], v[138:139], v[44:45]
    v_pk_mul_f32 v[46:47], v[138:139], v[46:47]
    v_cvt_pk_bf16_f32 v40, v40, v41
    v_cvt_pk_bf16_f32 v41, v42, v43
    v_cvt_pk_bf16_f32 v42, v44, v45
    v_cvt_pk_bf16_f32 v43, v46, v47
    v_pk_fma_f32 v[8:9], v[140:141], v[116:117], v[8:9] neg_lo:[1,0,0] neg_hi:[1,0,0]
    v_pk_fma_f32 v[10:11], v[140:141], v[118:119], v[10:11] neg_lo:[1,0,0] neg_hi:[1,0,0]
    v_pk_fma_f32 v[12:13], v[140:141], v[120:121], v[12:13] neg_lo:[1,0,0] neg_hi:[1,0,0]
    v_pk_fma_f32 v[14:15], v[140:141], v[122:123], v[14:15] neg_lo:[1,0,0] neg_hi:[1,0,0]
    v_cvt_pk_bf16_f32 v8, v8, v9
    v_cvt_pk_bf16_f32 v9, v10, v11
    v_cvt_pk_bf16_f32 v10, v12, v13
    v_cvt_pk_bf16_f32 v11, v14, v15
    v_mul_f32 v201, s23, v142
    ds_read2_b32 v[172:173], v240 offset0:64 offset1:66
    ds_read2_b32 v[174:175], v240 offset0:68 offset1:70
    ds_read2_b32 v[176:177], v240 offset0:65 offset1:67
    ds_read2_b32 v[178:179], v240 offset0:69 offset1:71
    v_pk_fma_f32 v[48:49], v[140:141], v[124:125], v[48:49] neg_lo:[1,0,0] neg_hi:[1,0,0]
    v_pk_fma_f32 v[50:51], v[140:141], v[126:127], v[50:51] neg_lo:[1,0,0] neg_hi:[1,0,0]
    v_pk_fma_f32 v[52:53], v[140:141], v[128:129], v[52:53] neg_lo:[1,0,0] neg_hi:[1,0,0]
    v_pk_fma_f32 v[54:55], v[140:141], v[130:131], v[54:55] neg_lo:[1,0,0] neg_hi:[1,0,0]
    v_pk_mul_f32 v[48:49], v[142:143], v[48:49]
    v_pk_mul_f32 v[50:51], v[142:143], v[50:51]
    v_pk_mul_f32 v[52:53], v[142:143], v[52:53]
    v_pk_mul_f32 v[54:55], v[142:143], v[54:55]
    v_cvt_pk_bf16_f32 v48, v48, v49
    v_cvt_pk_bf16_f32 v49, v50, v51
    v_cvt_pk_bf16_f32 v50, v52, v53
    v_cvt_pk_bf16_f32 v51, v54, v55
    s_waitcnt lgkmcnt(4)
    v_pk_fma_f32 v[16:17], v[144:145], v[116:117], v[16:17] neg_lo:[1,0,0] neg_hi:[1,0,0]
    v_pk_fma_f32 v[18:19], v[144:145], v[118:119], v[18:19] neg_lo:[1,0,0] neg_hi:[1,0,0]
    v_pk_fma_f32 v[20:21], v[144:145], v[120:121], v[20:21] neg_lo:[1,0,0] neg_hi:[1,0,0]
    v_pk_fma_f32 v[22:23], v[144:145], v[122:123], v[22:23] neg_lo:[1,0,0] neg_hi:[1,0,0]
    v_cvt_pk_bf16_f32 v16, v16, v17
    v_cvt_pk_bf16_f32 v17, v18, v19
    v_cvt_pk_bf16_f32 v18, v20, v21
    v_cvt_pk_bf16_f32 v19, v22, v23
    v_mul_f32 v202, s23, v146
    ds_read2_b32 v[180:181], v240 offset0:96 offset1:98
    ds_read2_b32 v[182:183], v240 offset0:100 offset1:102
    ds_read2_b32 v[184:185], v240 offset0:97 offset1:99
    ds_read2_b32 v[186:187], v240 offset0:101 offset1:103
    v_pk_fma_f32 v[56:57], v[144:145], v[124:125], v[56:57] neg_lo:[1,0,0] neg_hi:[1,0,0]
    v_pk_fma_f32 v[58:59], v[144:145], v[126:127], v[58:59] neg_lo:[1,0,0] neg_hi:[1,0,0]
    v_pk_fma_f32 v[60:61], v[144:145], v[128:129], v[60:61] neg_lo:[1,0,0] neg_hi:[1,0,0]
    v_pk_fma_f32 v[62:63], v[144:145], v[130:131], v[62:63] neg_lo:[1,0,0] neg_hi:[1,0,0]
    v_pk_mul_f32 v[56:57], v[146:147], v[56:57]
    v_pk_mul_f32 v[58:59], v[146:147], v[58:59]
    v_pk_mul_f32 v[60:61], v[146:147], v[60:61]
    v_pk_mul_f32 v[62:63], v[146:147], v[62:63]
    v_cvt_pk_bf16_f32 v56, v56, v57
    v_cvt_pk_bf16_f32 v57, v58, v59
    v_cvt_pk_bf16_f32 v58, v60, v61
    v_cvt_pk_bf16_f32 v59, v62, v63
    v_pk_fma_f32 v[24:25], v[148:149], v[116:117], v[24:25] neg_lo:[1,0,0] neg_hi:[1,0,0]
    v_pk_fma_f32 v[26:27], v[148:149], v[118:119], v[26:27] neg_lo:[1,0,0] neg_hi:[1,0,0]
    v_pk_fma_f32 v[28:29], v[148:149], v[120:121], v[28:29] neg_lo:[1,0,0] neg_hi:[1,0,0]
    v_pk_fma_f32 v[30:31], v[148:149], v[122:123], v[30:31] neg_lo:[1,0,0] neg_hi:[1,0,0]
    v_cvt_pk_bf16_f32 v24, v24, v25
    v_cvt_pk_bf16_f32 v25, v26, v27
    v_cvt_pk_bf16_f32 v26, v28, v29
    v_cvt_pk_bf16_f32 v27, v30, v31
    v_mul_f32 v203, s23, v150
    ds_read2_b32 v[188:189], v240 offset0:128 offset1:130
    ds_read2_b32 v[190:191], v240 offset0:132 offset1:134
    ds_read2_b32 v[192:193], v240 offset0:129 offset1:131
    ds_read2_b32 v[194:195], v240 offset0:133 offset1:135
    v_pk_fma_f32 v[64:65], v[148:149], v[124:125], v[64:65] neg_lo:[1,0,0] neg_hi:[1,0,0]
    v_pk_fma_f32 v[66:67], v[148:149], v[126:127], v[66:67] neg_lo:[1,0,0] neg_hi:[1,0,0]
    v_pk_fma_f32 v[68:69], v[148:149], v[128:129], v[68:69] neg_lo:[1,0,0] neg_hi:[1,0,0]
    v_pk_fma_f32 v[70:71], v[148:149], v[130:131], v[70:71] neg_lo:[1,0,0] neg_hi:[1,0,0]
    v_pk_mul_f32 v[64:65], v[150:151], v[64:65]
    v_pk_mul_f32 v[66:67], v[150:151], v[66:67]
    v_pk_mul_f32 v[68:69], v[150:151], v[68:69]
    v_pk_mul_f32 v[70:71], v[150:151], v[70:71]
    v_cvt_pk_bf16_f32 v64, v64, v65
    v_cvt_pk_bf16_f32 v65, v66, v67
    v_cvt_pk_bf16_f32 v66, v68, v69
    v_cvt_pk_bf16_f32 v67, v70, v71
    ds_read2_b32 v[156:157], v240 offset0:0 offset1:2
    ds_read2_b32 v[158:159], v240 offset0:4 offset1:6
    ds_read2_b32 v[160:161], v240 offset0:1 offset1:3
    ds_read2_b32 v[162:163], v240 offset0:5 offset1:7
    s_waitcnt lgkmcnt(4)
    v_pk_fma_f32 v[32:33], v[132:133], v[124:125], v[32:33] neg_lo:[1,0,0] neg_hi:[1,0,0]
    v_pk_fma_f32 v[34:35], v[132:133], v[126:127], v[34:35] neg_lo:[1,0,0] neg_hi:[1,0,0]
    v_pk_fma_f32 v[36:37], v[132:133], v[128:129], v[36:37] neg_lo:[1,0,0] neg_hi:[1,0,0]
    v_pk_fma_f32 v[38:39], v[132:133], v[130:131], v[38:39] neg_lo:[1,0,0] neg_hi:[1,0,0]
    v_pk_mul_f32 v[32:33], v[134:135], v[32:33]
    v_pk_mul_f32 v[34:35], v[134:135], v[34:35]
    v_pk_mul_f32 v[36:37], v[134:135], v[36:37]
    v_pk_mul_f32 v[38:39], v[134:135], v[38:39]
    v_cvt_pk_bf16_f32 v32, v32, v33
    v_cvt_pk_bf16_f32 v33, v34, v35
    v_cvt_pk_bf16_f32 v34, v36, v37
    v_cvt_pk_bf16_f32 v35, v38, v39
    v_readfirstlane_b32 s78, v241
    s_mov_b32 s59, s78
    s_mul_i32 s60, s59, s75
    v_mfma_f32_16x16x32_bf16 v[116:119], v[40:43], v[0:3], 0
    v_mfma_f32_16x16x32_bf16 v[120:123], v[32:35], v[0:3], 0
    v_mfma_f32_16x16x32_bf16 v[124:127], v[48:51], v[8:11], 0
    v_mfma_f32_16x16x32_bf16 v[128:131], v[40:43], v[8:11], 0
    v_mfma_f32_16x16x32_bf16 v[132:135], v[56:59], v[16:19], 0
    v_mfma_f32_16x16x32_bf16 v[136:139], v[48:51], v[16:19], 0
    v_mfma_f32_16x16x32_bf16 v[140:143], v[64:67], v[24:27], 0
    v_mfma_f32_16x16x32_bf16 v[144:147], v[56:59], v[24:27], 0
    v_pk_fma_f32 v[80:81], v[164:165], v[196:197], v[80:81] neg_lo:[1,0,0] neg_hi:[1,0,0]
    v_pk_fma_f32 v[82:83], v[166:167], v[196:197], v[82:83] neg_lo:[1,0,0] neg_hi:[1,0,0]
    v_pk_mul_f32 v[80:81], v[168:169], v[80:81]
    v_pk_mul_f32 v[82:83], v[170:171], v[82:83]
    v_cvt_pk_bf16_f32 v214, v80, v81
    v_cvt_pk_bf16_f32 v215, v82, v83
    v_pk_fma_f32 v[84:85], v[164:165], v[198:199], v[84:85] neg_lo:[1,0,0] neg_hi:[1,0,0]
    v_pk_fma_f32 v[86:87], v[166:167], v[198:199], v[86:87] neg_lo:[1,0,0] neg_hi:[1,0,0]
    v_pk_mul_f32 v[84:85], v[168:169], v[84:85]
    v_pk_mul_f32 v[86:87], v[170:171], v[86:87]
    v_cvt_pk_bf16_f32 v224, v84, v85
    v_cvt_pk_bf16_f32 v225, v86, v87
    v_pk_fma_f32 v[88:89], v[172:173], v[196:197], v[88:89] neg_lo:[1,0,0] neg_hi:[1,0,0]
    v_pk_fma_f32 v[90:91], v[174:175], v[196:197], v[90:91] neg_lo:[1,0,0] neg_hi:[1,0,0]
    v_pk_mul_f32 v[88:89], v[176:177], v[88:89]
    v_pk_mul_f32 v[90:91], v[178:179], v[90:91]
    v_cvt_pk_bf16_f32 v216, v88, v89
    v_cvt_pk_bf16_f32 v217, v90, v91
    v_pk_fma_f32 v[92:93], v[172:173], v[198:199], v[92:93] neg_lo:[1,0,0] neg_hi:[1,0,0]
    v_pk_fma_f32 v[94:95], v[174:175], v[198:199], v[94:95] neg_lo:[1,0,0] neg_hi:[1,0,0]
    v_pk_mul_f32 v[92:93], v[176:177], v[92:93]
    v_pk_mul_f32 v[94:95], v[178:179], v[94:95]
    v_cvt_pk_bf16_f32 v226, v92, v93
    v_cvt_pk_bf16_f32 v227, v94, v95
    v_pk_fma_f32 v[96:97], v[180:181], v[196:197], v[96:97] neg_lo:[1,0,0] neg_hi:[1,0,0]
    v_pk_fma_f32 v[98:99], v[182:183], v[196:197], v[98:99] neg_lo:[1,0,0] neg_hi:[1,0,0]
    v_pk_mul_f32 v[96:97], v[184:185], v[96:97]
    v_pk_mul_f32 v[98:99], v[186:187], v[98:99]
    v_cvt_pk_bf16_f32 v218, v96, v97
    v_cvt_pk_bf16_f32 v219, v98, v99
    v_pk_fma_f32 v[100:101], v[180:181], v[198:199], v[100:101] neg_lo:[1,0,0] neg_hi:[1,0,0]
    v_pk_fma_f32 v[102:103], v[182:183], v[198:199], v[102:103] neg_lo:[1,0,0] neg_hi:[1,0,0]
    v_pk_mul_f32 v[100:101], v[184:185], v[100:101]
    v_pk_mul_f32 v[102:103], v[186:187], v[102:103]
    v_cvt_pk_bf16_f32 v228, v100, v101
    v_cvt_pk_bf16_f32 v229, v102, v103
    v_pk_fma_f32 v[104:105], v[188:189], v[196:197], v[104:105] neg_lo:[1,0,0] neg_hi:[1,0,0]
    v_pk_fma_f32 v[106:107], v[190:191], v[196:197], v[106:107] neg_lo:[1,0,0] neg_hi:[1,0,0]
    v_pk_mul_f32 v[104:105], v[192:193], v[104:105]
    v_pk_mul_f32 v[106:107], v[194:195], v[106:107]
    v_cvt_pk_bf16_f32 v220, v104, v105
    v_cvt_pk_bf16_f32 v221, v106, v107
    v_pk_fma_f32 v[108:109], v[188:189], v[198:199], v[108:109] neg_lo:[1,0,0] neg_hi:[1,0,0]
    v_pk_fma_f32 v[110:111], v[190:191], v[198:199], v[110:111] neg_lo:[1,0,0] neg_hi:[1,0,0]
    v_pk_mul_f32 v[108:109], v[192:193], v[108:109]
    v_pk_mul_f32 v[110:111], v[194:195], v[110:111]
    v_cvt_pk_bf16_f32 v230, v108, v109
    v_cvt_pk_bf16_f32 v231, v110, v111
    s_waitcnt lgkmcnt(0)
    v_pk_fma_f32 v[72:73], v[156:157], v[196:197], v[72:73] neg_lo:[1,0,0] neg_hi:[1,0,0]
    v_pk_fma_f32 v[74:75], v[158:159], v[196:197], v[74:75] neg_lo:[1,0,0] neg_hi:[1,0,0]
    v_pk_mul_f32 v[72:73], v[160:161], v[72:73]
    v_pk_mul_f32 v[74:75], v[162:163], v[74:75]
    v_cvt_pk_bf16_f32 v212, v72, v73
    v_cvt_pk_bf16_f32 v213, v74, v75
    v_pk_fma_f32 v[76:77], v[156:157], v[198:199], v[76:77] neg_lo:[1,0,0] neg_hi:[1,0,0]
    v_pk_fma_f32 v[78:79], v[158:159], v[198:199], v[78:79] neg_lo:[1,0,0] neg_hi:[1,0,0]
    v_pk_mul_f32 v[76:77], v[160:161], v[76:77]
    v_pk_mul_f32 v[78:79], v[162:163], v[78:79]
    v_cvt_pk_bf16_f32 v222, v76, v77
    v_cvt_pk_bf16_f32 v223, v78, v79
    s_mov_b64 vcc, s[28:29]
    v_mov_b32 v4, 0xf149f2ca
    v_cndmask_b32 v116, v116, v117, vcc
    v_cndmask_b32 v120, v120, v121, vcc
    v_cndmask_b32 v118, v118, v119, vcc
    v_cndmask_b32 v122, v122, v123, vcc
    v_cndmask_b32 v148, v120, v116, s[30:31]
    v_cndmask_b32 v149, v122, v118, s[32:33]
    v_cndmask_b32 v124, v124, v125, vcc
    v_cndmask_b32 v128, v128, v129, vcc
    v_cndmask_b32 v126, v126, v127, vcc
    v_cndmask_b32 v130, v130, v131, vcc
    v_cndmask_b32 v150, v128, v124, s[30:31]
    v_cndmask_b32 v151, v130, v126, s[32:33]
    v_cndmask_b32 v132, v132, v133, vcc
    v_cndmask_b32 v136, v136, v137, vcc
    v_cndmask_b32 v134, v134, v135, vcc
    v_cndmask_b32 v138, v138, v139, vcc
    v_cndmask_b32 v152, v136, v132, s[30:31]
    v_cndmask_b32 v153, v138, v134, s[32:33]
    v_cndmask_b32 v140, v140, v141, vcc
    v_cndmask_b32 v144, v144, v145, vcc
    v_cndmask_b32 v142, v142, v143, vcc
    v_cndmask_b32 v146, v146, v147, vcc
    v_cndmask_b32 v154, v144, v140, s[30:31]
    v_cndmask_b32 v155, v146, v142, s[32:33]
    v_cndmask_b32 v148, v4, v148, s[34:35]
    v_cndmask_b32 v149, v4, v149, s[36:37]
    v_max_f32 v0, v148, v149
    v_max_f32 v1, v150, v151
    v_max_f32 v2, v152, v153
    v_max_f32 v3, v154, v155
    s_nop 0
    v_permlane16_swap_b32 v0, v1
    v_permlane16_swap_b32 v2, v3
    v_max_f32 v0, v0, v1
    v_max_f32 v2, v2, v3
    s_nop 1
    v_permlane32_swap_b32 v0, v2
    v_max_f32 v0, v0, v2
    v_mov_b32 v2, v0
    s_nop 1
    v_permlane32_swap_b32 v0, v2
    v_mov_b32 v1, v0
    v_mov_b32 v3, v2
    s_nop 0
    v_permlane16_swap_b32 v0, v1
    v_permlane16_swap_b32 v2, v3
    v_sub_f32 v148, v148, v0
    v_sub_f32 v149, v149, v0
    v_sub_f32 v150, v150, v1
    v_sub_f32 v151, v151, v1
    v_sub_f32 v152, v152, v2
    v_sub_f32 v153, v153, v2
    v_sub_f32 v154, v154, v3
    v_sub_f32 v155, v155, v3
    v_mul_f32 v148, v200, v148
    v_mul_f32 v149, v200, v149
    v_mul_f32 v150, v201, v150
    v_mul_f32 v151, v201, v151
    v_mul_f32 v152, v202, v152
    v_mul_f32 v153, v202, v153
    v_mul_f32 v154, v203, v154
    v_mul_f32 v155, v203, v155
    v_exp_f32 v148, v148
    v_exp_f32 v149, v149
    v_exp_f32 v150, v150
    v_exp_f32 v151, v151
    v_exp_f32 v152, v152
    v_exp_f32 v153, v153
    v_exp_f32 v154, v154
    v_exp_f32 v155, v155
    v_add_f32 v0, v148, v149
    v_add_f32 v1, v150, v151
    v_add_f32 v2, v152, v153
    v_add_f32 v3, v154, v155
    s_nop 0
    v_permlane16_swap_b32 v0, v1
    v_permlane16_swap_b32 v2, v3
    v_add_f32 v0, v0, v1
    v_add_f32 v2, v2, v3
    s_nop 1
    v_permlane32_swap_b32 v0, v2
    v_add_f32 v0, v0, v2
    v_rcp_f32 v0, v0
    s_nop 0
    v_mov_b32 v2, v0
    s_nop 1
    v_permlane32_swap_b32 v0, v2
    v_mov_b32 v1, v0
    v_mov_b32 v3, v2
    s_nop 0
    v_permlane16_swap_b32 v0, v1
    v_permlane16_swap_b32 v2, v3
    v_mul_f32 v148, v148, v0
    v_mul_f32 v149, v149, v0
    v_cvt_pk_bf16_f32 v148, v148, v148
    v_cvt_pk_bf16_f32 v149, v149, v149
    v_and_b32 v8, v148, v232
    v_and_b32 v9, v149, v233
    v_and_b32 v10, v148, v234
    v_and_b32 v11, v149, v235
    v_mul_f32 v150, v150, v1
    v_mul_f32 v151, v151, v1
    v_cvt_pk_bf16_f32 v150, v150, v150
    v_cvt_pk_bf16_f32 v151, v151, v151
    v_and_b32 v12, v150, v232
    v_and_b32 v13, v151, v233
    v_and_b32 v14, v150, v234
    v_and_b32 v15, v151, v235
    v_mfma_f32_16x16x32_bf16 v[24:27], v[212:215], v[8:11], 0
    v_mfma_f32_16x16x32_bf16 v[28:31], v[222:225], v[8:11], 0
    v_mul_f32 v152, v152, v2
    v_mul_f32 v153, v153, v2
    v_cvt_pk_bf16_f32 v152, v152, v152
    v_cvt_pk_bf16_f32 v153, v153, v153
    v_and_b32 v16, v152, v232
    v_and_b32 v17, v153, v233
    v_and_b32 v18, v152, v234
    v_and_b32 v19, v153, v235
    v_mfma_f32_16x16x32_bf16 v[32:35], v[214:217], v[12:15], 0
    v_mfma_f32_16x16x32_bf16 v[36:39], v[224:227], v[12:15], 0
    v_mul_f32 v154, v154, v3
    v_mul_f32 v155, v155, v3
    v_cvt_pk_bf16_f32 v154, v154, v154
    v_cvt_pk_bf16_f32 v155, v155, v155
    v_and_b32 v20, v154, v232
    v_and_b32 v21, v155, v233
    v_and_b32 v22, v154, v234
    v_and_b32 v23, v155, v235
    v_mfma_f32_16x16x32_bf16 v[40:43], v[216:219], v[16:19], 0
    v_mfma_f32_16x16x32_bf16 v[44:47], v[226:229], v[16:19], 0
    v_mfma_f32_16x16x32_bf16 v[48:51], v[218:221], v[20:23], 0
    v_mfma_f32_16x16x32_bf16 v[52:55], v[228:231], v[20:23], 0
    s_cmp_lg_u32 s68, 0
    s_cbranch_scc1 g1c_rem
    v_cvt_pk_bf16_f32 v56, v24, v25
    v_cvt_pk_bf16_f32 v57, v26, v27
    v_cvt_pk_bf16_f32 v58, v28, v29
    v_cvt_pk_bf16_f32 v59, v30, v31
    buffer_store_dwordx4 v[56:59], v249, s[80:83], s21 offen offset:0
    v_cvt_pk_bf16_f32 v60, v32, v33
    v_cvt_pk_bf16_f32 v61, v34, v35
    v_cvt_pk_bf16_f32 v62, v36, v37
    v_cvt_pk_bf16_f32 v63, v38, v39
    buffer_store_dwordx4 v[60:63], v249, s[80:83], s21 offen offset:1024
    v_cvt_pk_bf16_f32 v64, v40, v41
    v_cvt_pk_bf16_f32 v65, v42, v43
    v_cvt_pk_bf16_f32 v66, v44, v45
    v_cvt_pk_bf16_f32 v67, v46, v47
    buffer_store_dwordx4 v[64:67], v249, s[80:83], s21 offen offset:2048
    v_cvt_pk_bf16_f32 v68, v48, v49
    v_cvt_pk_bf16_f32 v69, v50, v51
    v_cvt_pk_bf16_f32 v70, v52, v53
    v_cvt_pk_bf16_f32 v71, v54, v55
    buffer_store_dwordx4 v[68:71], v249, s[80:83], s21 offen offset:3072
g1c_remb:
    s_lshl_b32 s64, s75, 15
    s_lshl_b32 s66, s73, 9
    s_add_u32 s64, s64, s66
    s_add_u32 s64, s64, 75497472
    s_lshl_b32 s65, s72, 5
    s_add_u32 s64, s64, s65
    s_lshl_b32 s65, s3, 2
    s_add_u32 s64, s64, s65
    v_mov_b32 v108, 0
    v_mov_b32 v109, 1
    s_cmp_lg_u32 s78, 0
    s_cbranch_scc1 sg_3_slow
    s_waitcnt vmcnt(0)
    s_mov_b64 exec, 1
    buffer_store_dword v109, v108, s[80:83], s64 offen
    s_mov_b64 exec, -1
sg_3_done:
    s_lshr_b32 s64, s3, 1
    s_lshl_b32 s64, s64, 12
    v_add_u32 v240, s64, v249
    v_lshrrev_b32 v253, 2, v252
    v_mul_u32_u24 v253, 1056, v253
    v_lshl_add_u32 v253, v251, 7, v253
    v_and_b32 v254, 3, v252
    v_lshl_add_u32 v253, v254, 3, v253
    s_and_b32 s64, s3, 1
    s_lshl_b32 s64, s64, 6
    s_add_u32 s64, s64, 65536
    v_add_u32 v241, s64, v253
    s_mov_b32 s16, 50688
    v_add_u32 v242, s16, v241
    s_mov_b32 s25, s72
    s_lshl_b32 s18, s73, 4
    s_add_u32 s18, s18, s72
    s_lshl_b32 s18, s18, 14
    s_and_b32 s64, s3, 1
    s_lshl_b32 s64, s64, 13
    s_add_u32 s18, s18, s64
    s_lshr_b32 s64, s3, 1
    s_lshl_b32 s64, s64, 12
    s_add_u32 s18, s18, s64
    s_mov_b32 s20, s18
    s_lshl_b32 s66, s75, 23
    s_add_u32 s20, s20, s66
    s_add_u32 s18, s18, 4194304
    s_cmp_lg_u32 s75, 0
    s_cbranch_scc1 xo_4_f
    s_mov_b32 s8, s84
    s_mov_b32 s9, s85
    s_mov_b32 s10, 4194304
    s_mov_b32 s11, 0x00020000
    s_lshl_b32 s64, s73, 1
    s_lshr_b32 s65, s3, 1
    s_add_u32 s64, s64, s65
    s_lshl_b32 s64, s64, 17
    s_and_b32 s65, s3, 1
    s_lshl_b32 s65, s65, 6
    s_add_u32 s64, s64, s65
    s_lshl_b32 s65, s25, 7
    s_add_u32 s64, s64, s65
    v_lshlrev_b32 v243, 11, v252
    v_add_u32 v243, s64, v243
    v_lshl_add_u32 v243, v251, 3, v243
    s_mov_b32 s64, 0
    buffer_load_dwordx2 v[128:129], v243, s[8:11], s64 offen
    buffer_load_dwordx2 v[130:131], v243, s[8:11], s64 offen offset:32
    s_mov_b32 s64, 32768
    buffer_load_dwordx2 v[132:133], v243, s[8:11], s64 offen
    buffer_load_dwordx2 v[134:135], v243, s[8:11], s64 offen offset:32
    s_mov_b32 s64, 65536
    buffer_load_dwordx2 v[136:137], v243, s[8:11], s64 offen
    buffer_load_dwordx2 v[138:139], v243, s[8:11], s64 offen offset:32
    s_mov_b32 s64, 98304
    buffer_load_dwordx2 v[140:141], v243, s[8:11], s64 offen
    buffer_load_dwordx2 v[142:143], v243, s[8:11], s64 offen offset:32
    s_branch xo_4_d
xo_4_f:
    buffer_load_dwordx4 v[128:131], v249, s[80:83], s18 offen offset:0 sc1
    buffer_load_dwordx4 v[132:135], v249, s[80:83], s18 offen offset:1024 sc1
    buffer_load_dwordx4 v[136:139], v249, s[80:83], s18 offen offset:2048 sc1
    buffer_load_dwordx4 v[140:143], v249, s[80:83], s18 offen offset:3072 sc1
xo_4_d:
    s_lshl_b32 s24, s73, 4
    s_add_u32 s24, s24, s25
    s_lshl_b32 s24, s24, 11
    s_lshl_b32 s65, s75, 20
    s_add_u32 s24, s24, s65
    s_add_u32 s24, s24, 71303168
    s_lshr_b32 s65, s3, 1
    s_lshl_b32 s65, s65, 9
    s_add_u32 s24, s24, s65
    s_and_b32 s65, s3, 1
    s_lshl_b32 s65, s65, 10
    s_add_u32 s24, s24, s65
    v_lshlrev_b32 v239, 3, v250
    v_mov_b32 v208, 0
    v_mov_b32 v209, 0
    v_mov_b32 v210, 0
    v_mov_b32 v211, 0
    s_nop 1
    v_mfma_f32_32x32x16_bf16 v[0:15], v[208:211], v[208:211], 0
    v_mfma_f32_32x32x16_bf16 v[16:31], v[208:211], v[208:211], 0
    s_mov_b32 s17, 8
    s_waitcnt lgkmcnt(0)
    s_barrier
    ds_read_b128 v[32:35], v240 offset:0
    ds_read_b64_tr_b16 v[48:49], v242 offset:0
    ds_read_b64_tr_b16 v[50:51], v242 offset:512
    ds_read_b128 v[36:39], v240 offset:1024
    ds_read_b64_tr_b16 v[52:53], v242 offset:32
    ds_read_b64_tr_b16 v[54:55], v242 offset:544
    ds_read_b128 v[40:43], v240 offset:2048
    ds_read_b128 v[44:47], v240 offset:3072
    ds_read_b128 v[56:59], v240 offset:8192
    ds_read_b64_tr_b16 v[72:73], v242 offset:4224
    ds_read_b64_tr_b16 v[74:75], v242 offset:4736
    ds_read_b128 v[60:63], v240 offset:9216
    ds_read_b64_tr_b16 v[76:77], v242 offset:4256
    ds_read_b64_tr_b16 v[78:79], v242 offset:4768
    ds_read_b128 v[64:67], v240 offset:10240
    ds_read_b128 v[68:71], v240 offset:11264
    v_add_u16 v240, 0x4000, v240
    s_add_u32 s16, s16, 8448
    s_cmp_eq_u32 s16, 92928
    s_cselect_b32 s16, 0, s16
    v_add_u32 v242, s16, v241
    s_waitcnt lgkmcnt(0)
r1_loop:
    s_bitcmp1_b32 2, s17
    s_cbranch_scc1 r1_nb0
    s_barrier
r1_nb0:
    v_mfma_f32_16x16x32_bf16 v[0:3], v[48:51], v[32:35], v[0:3]
    ds_read_b128 v[80:83], v240 offset:0
    ds_read_b64_tr_b16 v[96:97], v242 offset:0
    v_mfma_f32_16x16x32_bf16 v[8:11], v[48:51], v[36:39], v[8:11]
    ds_read_b64_tr_b16 v[98:99], v242 offset:512
    v_mfma_f32_16x16x32_bf16 v[16:19], v[48:51], v[40:43], v[16:19]
    ds_read_b128 v[84:87], v240 offset:1024
    ds_read_b64_tr_b16 v[100:101], v242 offset:32
    v_mfma_f32_16x16x32_bf16 v[24:27], v[48:51], v[44:47], v[24:27]
    ds_read_b64_tr_b16 v[102:103], v242 offset:544
    v_mfma_f32_16x16x32_bf16 v[4:7], v[52:55], v[32:35], v[4:7]
    ds_read_b128 v[88:91], v240 offset:2048
    ds_read_b128 v[92:95], v240 offset:3072
    v_mfma_f32_16x16x32_bf16 v[12:15], v[52:55], v[36:39], v[12:15]
    ds_read_b128 v[104:107], v240 offset:8192
    v_mfma_f32_16x16x32_bf16 v[20:23], v[52:55], v[40:43], v[20:23]
    ds_read_b64_tr_b16 v[120:121], v242 offset:4224
    ds_read_b64_tr_b16 v[122:123], v242 offset:4736
    v_mfma_f32_16x16x32_bf16 v[28:31], v[52:55], v[44:47], v[28:31]
    ds_read_b128 v[108:111], v240 offset:9216
    v_mfma_f32_16x16x32_bf16 v[0:3], v[72:75], v[56:59], v[0:3]
    ds_read_b64_tr_b16 v[124:125], v242 offset:4256
    ds_read_b64_tr_b16 v[126:127], v242 offset:4768
    v_mfma_f32_16x16x32_bf16 v[8:11], v[72:75], v[60:63], v[8:11]
    ds_read_b128 v[112:115], v240 offset:10240
    v_mfma_f32_16x16x32_bf16 v[16:19], v[72:75], v[64:67], v[16:19]
    ds_read_b128 v[116:119], v240 offset:11264
    v_mfma_f32_16x16x32_bf16 v[24:27], v[72:75], v[68:71], v[24:27]
    v_add_u16 v240, 0x4000, v240
    v_mfma_f32_16x16x32_bf16 v[4:7], v[76:79], v[56:59], v[4:7]
    s_add_u32 s16, s16, 8448
    s_cmp_eq_u32 s16, 92928
    v_mfma_f32_16x16x32_bf16 v[12:15], v[76:79], v[60:63], v[12:15]
    s_cselect_b32 s16, 0, s16
    v_mfma_f32_16x16x32_bf16 v[20:23], v[76:79], v[64:67], v[20:23]
    v_add_u32 v242, s16, v241
    v_mfma_f32_16x16x32_bf16 v[28:31], v[76:79], v[68:71], v[28:31]
    s_waitcnt lgkmcnt(0)
    s_bitcmp1_b32 2, s17
    s_cbranch_scc1 r1_nb1
    s_barrier
r1_nb1:
    v_mfma_f32_16x16x32_bf16 v[0:3], v[96:99], v[80:83], v[0:3]
    ds_read_b128 v[32:35], v240 offset:0
    ds_read_b64_tr_b16 v[48:49], v242 offset:0
    v_mfma_f32_16x16x32_bf16 v[8:11], v[96:99], v[84:87], v[8:11]
    ds_read_b64_tr_b16 v[50:51], v242 offset:512
    v_mfma_f32_16x16x32_bf16 v[16:19], v[96:99], v[88:91], v[16:19]
    ds_read_b128 v[36:39], v240 offset:1024
    ds_read_b64_tr_b16 v[52:53], v242 offset:32
    v_mfma_f32_16x16x32_bf16 v[24:27], v[96:99], v[92:95], v[24:27]
    ds_read_b64_tr_b16 v[54:55], v242 offset:544
    v_mfma_f32_16x16x32_bf16 v[4:7], v[100:103], v[80:83], v[4:7]
    ds_read_b128 v[40:43], v240 offset:2048
    ds_read_b128 v[44:47], v240 offset:3072
    v_mfma_f32_16x16x32_bf16 v[12:15], v[100:103], v[84:87], v[12:15]
    ds_read_b128 v[56:59], v240 offset:8192
    v_mfma_f32_16x16x32_bf16 v[20:23], v[100:103], v[88:91], v[20:23]
    ds_read_b64_tr_b16 v[72:73], v242 offset:4224
    ds_read_b64_tr_b16 v[74:75], v242 offset:4736
    v_mfma_f32_16x16x32_bf16 v[28:31], v[100:103], v[92:95], v[28:31]
    ds_read_b128 v[60:63], v240 offset:9216
    v_mfma_f32_16x16x32_bf16 v[0:3], v[120:123], v[104:107], v[0:3]
    ds_read_b64_tr_b16 v[76:77], v242 offset:4256
    ds_read_b64_tr_b16 v[78:79], v242 offset:4768
    v_mfma_f32_16x16x32_bf16 v[8:11], v[120:123], v[108:111], v[8:11]
    ds_read_b128 v[64:67], v240 offset:10240
    v_mfma_f32_16x16x32_bf16 v[16:19], v[120:123], v[112:115], v[16:19]
    ds_read_b128 v[68:71], v240 offset:11264
    v_mfma_f32_16x16x32_bf16 v[24:27], v[120:123], v[116:119], v[24:27]
    v_add_u16 v240, 0x4000, v240
    s_add_u32 s16, s16, 8448
    s_cmp_eq_u32 s16, 92928
    v_mfma_f32_16x16x32_bf16 v[4:7], v[124:127], v[104:107], v[4:7]
    s_cselect_b32 s16, 0, s16
    v_mfma_f32_16x16x32_bf16 v[12:15], v[124:127], v[108:111], v[12:15]
    v_add_u32 v242, s16, v241
    v_mfma_f32_16x16x32_bf16 v[20:23], v[124:127], v[112:115], v[20:23]
    s_sub_u32 s17, s17, 1
    s_cmp_lg_u32 s17, 0
    v_mfma_f32_16x16x32_bf16 v[28:31], v[124:127], v[116:119], v[28:31]
    s_waitcnt lgkmcnt(0)
    s_cbranch_scc1 r1_loop
    s_barrier
    s_nop 3
    s_waitcnt vmcnt(0)
    v_lshlrev_b32 v144, 16, v128
    v_and_b32 v145, 0xffff0000, v128
    v_lshlrev_b32 v146, 16, v129
    v_and_b32 v147, 0xffff0000, v129
    v_lshlrev_b32 v148, 16, v130
    v_and_b32 v149, 0xffff0000, v130
    v_lshlrev_b32 v150, 16, v131
    v_and_b32 v151, 0xffff0000, v131
    v_lshlrev_b32 v152, 16, v132
    v_and_b32 v153, 0xffff0000, v132
    v_lshlrev_b32 v154, 16, v133
    v_and_b32 v155, 0xffff0000, v133
    v_lshlrev_b32 v156, 16, v134
    v_and_b32 v157, 0xffff0000, v134
    v_lshlrev_b32 v158, 16, v135
    v_and_b32 v159, 0xffff0000, v135
    v_lshlrev_b32 v160, 16, v136
    v_and_b32 v161, 0xffff0000, v136
    v_lshlrev_b32 v162, 16, v137
    v_and_b32 v163, 0xffff0000, v137
    v_lshlrev_b32 v164, 16, v138
    v_and_b32 v165, 0xffff0000, v138
    v_lshlrev_b32 v166, 16, v139
    v_and_b32 v167, 0xffff0000, v139
    v_lshlrev_b32 v168, 16, v140
    v_and_b32 v169, 0xffff0000, v140
    v_lshlrev_b32 v170, 16, v141
    v_and_b32 v171, 0xffff0000, v141
    v_lshlrev_b32 v172, 16, v142
    v_and_b32 v173, 0xffff0000, v142
    v_lshlrev_b32 v174, 16, v143
    v_and_b32 v175, 0xffff0000, v143
    v_mov_b32 v88, 0x3f803f80
    v_cvt_pk_bf16_f32 v208, v0, v1
    v_cvt_pk_bf16_f32 v209, v2, v3
    v_cvt_pk_bf16_f32 v210, v4, v5
    v_cvt_pk_bf16_f32 v211, v6, v7
    v_lshlrev_b32 v212, 16, v208
    v_and_b32 v213, 0xffff0000, v208
    v_lshlrev_b32 v214, 16, v209
    v_and_b32 v215, 0xffff0000, v209
    v_lshlrev_b32 v216, 16, v210
    v_and_b32 v217, 0xffff0000, v210
    v_lshlrev_b32 v218, 16, v211
    v_and_b32 v219, 0xffff0000, v211
    v_pk_add_f32 v[212:213], v[212:213], v[144:145]
    v_pk_add_f32 v[214:215], v[214:215], v[146:147]
    v_pk_add_f32 v[216:217], v[216:217], v[148:149]
    v_pk_add_f32 v[218:219], v[218:219], v[150:151]
    v_cvt_pk_bf16_f32 v64, v212, v213
    v_cvt_pk_bf16_f32 v65, v214, v215
    v_cvt_pk_bf16_f32 v66, v216, v217
    v_cvt_pk_bf16_f32 v67, v218, v219
    buffer_store_dwordx4 v[64:67], v249, s[80:83], s20 offen offset:0 sc0 sc1
    v_cvt_pk_bf16_f32 v208, v8, v9
    v_cvt_pk_bf16_f32 v209, v10, v11
    v_cvt_pk_bf16_f32 v210, v12, v13
    v_cvt_pk_bf16_f32 v211, v14, v15
    v_lshlrev_b32 v212, 16, v208
    v_and_b32 v213, 0xffff0000, v208
    v_lshlrev_b32 v214, 16, v209
    v_and_b32 v215, 0xffff0000, v209
    v_lshlrev_b32 v216, 16, v210
    v_and_b32 v217, 0xffff0000, v210
    v_lshlrev_b32 v218, 16, v211
    v_and_b32 v219, 0xffff0000, v211
    v_pk_add_f32 v[212:213], v[212:213], v[152:153]
    v_pk_add_f32 v[214:215], v[214:215], v[154:155]
    v_pk_add_f32 v[216:217], v[216:217], v[156:157]
    v_pk_add_f32 v[218:219], v[218:219], v[158:159]
    v_cvt_pk_bf16_f32 v68, v212, v213
    v_cvt_pk_bf16_f32 v69, v214, v215
    v_cvt_pk_bf16_f32 v70, v216, v217
    v_cvt_pk_bf16_f32 v71, v218, v219
    buffer_store_dwordx4 v[68:71], v249, s[80:83], s20 offen offset:1024 sc0 sc1
    v_cvt_pk_bf16_f32 v208, v16, v17
    v_cvt_pk_bf16_f32 v209, v18, v19
    v_cvt_pk_bf16_f32 v210, v20, v21
    v_cvt_pk_bf16_f32 v211, v22, v23
    v_lshlrev_b32 v212, 16, v208
    v_and_b32 v213, 0xffff0000, v208
    v_lshlrev_b32 v214, 16, v209
    v_and_b32 v215, 0xffff0000, v209
    v_lshlrev_b32 v216, 16, v210
    v_and_b32 v217, 0xffff0000, v210
    v_lshlrev_b32 v218, 16, v211
    v_and_b32 v219, 0xffff0000, v211
    v_pk_add_f32 v[212:213], v[212:213], v[160:161]
    v_pk_add_f32 v[214:215], v[214:215], v[162:163]
    v_pk_add_f32 v[216:217], v[216:217], v[164:165]
    v_pk_add_f32 v[218:219], v[218:219], v[166:167]
    v_cvt_pk_bf16_f32 v72, v212, v213
    v_cvt_pk_bf16_f32 v73, v214, v215
    v_cvt_pk_bf16_f32 v74, v216, v217
    v_cvt_pk_bf16_f32 v75, v218, v219
    buffer_store_dwordx4 v[72:75], v249, s[80:83], s20 offen offset:2048 sc0 sc1
    v_cvt_pk_bf16_f32 v208, v24, v25
    v_cvt_pk_bf16_f32 v209, v26, v27
    v_cvt_pk_bf16_f32 v210, v28, v29
    v_cvt_pk_bf16_f32 v211, v30, v31
    v_lshlrev_b32 v212, 16, v208
    v_and_b32 v213, 0xffff0000, v208
    v_lshlrev_b32 v214, 16, v209
    v_and_b32 v215, 0xffff0000, v209
    v_lshlrev_b32 v216, 16, v210
    v_and_b32 v217, 0xffff0000, v210
    v_lshlrev_b32 v218, 16, v211
    v_and_b32 v219, 0xffff0000, v211
    v_pk_add_f32 v[212:213], v[212:213], v[168:169]
    v_pk_add_f32 v[214:215], v[214:215], v[170:171]
    v_pk_add_f32 v[216:217], v[216:217], v[172:173]
    v_pk_add_f32 v[218:219], v[218:219], v[174:175]
    v_cvt_pk_bf16_f32 v76, v212, v213
    v_cvt_pk_bf16_f32 v77, v214, v215
    v_cvt_pk_bf16_f32 v78, v216, v217
    v_cvt_pk_bf16_f32 v79, v218, v219
    buffer_store_dwordx4 v[76:79], v249, s[80:83], s20 offen offset:3072 sc0 sc1
    v_dot2_f32_bf16 v80, v64, v88, 0
    v_dot2_f32_bf16 v84, v64, v64, 0
    v_dot2_f32_bf16 v80, v65, v88, v80
    v_dot2_f32_bf16 v84, v65, v65, v84
    v_dot2_f32_bf16 v80, v66, v88, v80
    v_dot2_f32_bf16 v84, v66, v66, v84
    v_dot2_f32_bf16 v80, v67, v88, v80
    v_dot2_f32_bf16 v84, v67, v67, v84
    v_dot2_f32_bf16 v81, v68, v88, 0
    v_dot2_f32_bf16 v85, v68, v68, 0
    v_dot2_f32_bf16 v81, v69, v88, v81
    v_dot2_f32_bf16 v85, v69, v69, v85
    v_dot2_f32_bf16 v81, v70, v88, v81
    v_dot2_f32_bf16 v85, v70, v70, v85
    v_dot2_f32_bf16 v81, v71, v88, v81
    v_dot2_f32_bf16 v85, v71, v71, v85
    v_dot2_f32_bf16 v82, v72, v88, 0
    v_dot2_f32_bf16 v86, v72, v72, 0
    v_dot2_f32_bf16 v82, v73, v88, v82
    v_dot2_f32_bf16 v86, v73, v73, v86
    v_dot2_f32_bf16 v82, v74, v88, v82
    v_dot2_f32_bf16 v86, v74, v74, v86
    v_dot2_f32_bf16 v82, v75, v88, v82
    v_dot2_f32_bf16 v86, v75, v75, v86
    v_dot2_f32_bf16 v83, v76, v88, 0
    v_dot2_f32_bf16 v87, v76, v76, 0
    v_dot2_f32_bf16 v83, v77, v88, v83
    v_dot2_f32_bf16 v87, v77, v77, v87
    v_dot2_f32_bf16 v83, v78, v88, v83
    v_dot2_f32_bf16 v87, v78, v78, v87
    v_dot2_f32_bf16 v83, v79, v88, v83
    v_dot2_f32_bf16 v87, v79, v79, v87
    s_nop 2
    v_permlane16_swap_b32 v80, v81
    v_permlane16_swap_b32 v82, v83
    v_permlane16_swap_b32 v84, v85
    v_permlane16_swap_b32 v86, v87
    v_add_f32 v80, v80, v81
    v_add_f32 v82, v82, v83
    v_add_f32 v84, v84, v85
    v_add_f32 v86, v86, v87
    s_nop 1
    v_permlane32_swap_b32 v80, v82
    v_permlane32_swap_b32 v84, v86
    v_add_f32 v80, v80, v82
    v_add_f32 v81, v84, v86
    buffer_store_dwordx2 v[80:81], v239, s[80:83], s24 offen sc0 sc1
    s_lshl_b32 s64, s75, 15
    s_lshl_b32 s66, s73, 9
    s_add_u32 s64, s64, s66
    s_add_u32 s64, s64, 75505664
    s_lshl_b32 s65, s72, 5
    s_add_u32 s64, s64, s65
    s_lshl_b32 s65, s3, 2
    s_add_u32 s64, s64, s65
    v_mov_b32 v208, 0
    v_mov_b32 v209, 1
    s_cmp_lg_u32 s78, 0
    s_cbranch_scc1 sg_6_slow
    s_waitcnt vmcnt(0)
    s_mov_b64 exec, 1
    buffer_store_dword v209, v208, s[80:83], s64 offen
    s_mov_b64 exec, -1
sg_6_done:
    s_and_b32 s64, s3, 1
    s_cmp_eq_u32 s64, 0
    s_cselect_b32 s8, s92, s94
    s_cselect_b32 s9, s93, s95
    s_mov_b32 s10, 7340032
    s_mov_b32 s11, 0x00020000
    s_mul_i32 s19, s64, 14400
    s_lshr_b32 s64, s69, 1
    s_mul_i32 s65, s64, 7200
    s_add_u32 s19, s19, s65
    s_add_u32 s19, s19, 36736
    s_mul_i32 s17, s64, 28672
    s_mul_i32 s65, s74, 448
    s_add_u32 s17, s17, s65
    s_add_u32 s18, s17, 7340032
    s_lshl_b32 s64, s57, 1
    s_add_u32 s64, s64, 3
    s_and_b32 s64, s64, 31
    s_mul_i32 s65, s64, 229376
    s_add_u32 s16, s17, s65
    s_mov_b32 s66, 2341
    v_add_u32 v253, 192, v250
    v_mul_lo_u32 v254, v253, s66
    v_lshrrev_b32 v254, 16, v254
    v_mul_u32_u24 v224, 28, v254
    v_sub_u32 v253, v253, v224
    v_and_b32 v224, 12, v254
    v_add_u32 v254, v254, v224
    v_mul_u32_u24 v254, 7168, v254
    v_lshl_add_u32 v224, v253, 4, v254
    v_add_u32 v253, 256, v250
    v_mul_lo_u32 v254, v253, s66
    v_lshrrev_b32 v254, 16, v254
    v_mul_u32_u24 v225, 28, v254
    v_sub_u32 v253, v253, v225
    v_and_b32 v225, 12, v254
    v_add_u32 v254, v254, v225
    v_mul_u32_u24 v254, 7168, v254
    v_lshl_add_u32 v225, v253, 4, v254
    v_add_u32 v253, 320, v250
    v_mul_lo_u32 v254, v253, s66
    v_lshrrev_b32 v254, 16, v254
    v_mul_u32_u24 v226, 28, v254
    v_sub_u32 v253, v253, v226
    v_and_b32 v226, 12, v254
    v_add_u32 v254, v254, v226
    v_mul_u32_u24 v254, 7168, v254
    v_lshl_add_u32 v226, v253, 4, v254
    v_add_u32 v253, 384, v250
    v_mul_lo_u32 v254, v253, s66
    v_lshrrev_b32 v254, 16, v254
    v_mul_u32_u24 v227, 28, v254
    v_sub_u32 v253, v253, v227
    v_and_b32 v227, 12, v254
    v_add_u32 v254, v254, v227
    v_mul_u32_u24 v254, 7168, v254
    v_lshl_add_u32 v227, v253, 4, v254
    s_and_b32 s64, s3, 1
    s_lshl_b32 s64, s64, 12
    v_add_u32 v231, s64, v249
    v_lshrrev_b32 v253, 1, v251
    v_lshrrev_b32 v254, 2, v252
    v_lshl_add_u32 v253, v253, 2, v254
    v_mul_u32_u24 v253, 448, v253
    v_and_b32 v254, 1, v251
    v_mul_u32_u24 v254, 7200, v254
    v_add_u32 v253, v253, v254
    v_and_b32 v254, 3, v252
    v_lshl_add_u32 v253, v254, 3, v253
    v_add_u32 v253, 36736, v253
    s_lshr_b32 s64, s69, 1
    s_lshl_b32 s28, s64, 2
    s_lshl_b32 s65, s28, 5
    v_add_u32 v232, s65, v253
    v_add_u32 v233, 57600, v232
    s_lshl_b32 s25, s73, 1
    s_add_u32 s25, s25, s68
    s_mul_i32 s25, s25, 458752
    s_lshl_b32 s66, s60, 24
    s_add_u32 s25, s25, s66
    s_add_u32 s25, s25, 20971520
    s_and_b32 s64, s74, 7
    s_mul_i32 s64, s64, 57344
    s_add_u32 s25, s25, s64
    v_mov_b32 v192, 0
    v_mov_b32 v193, 0
    v_mov_b32 v194, 0
    v_mov_b32 v195, 0
    s_nop 1
    v_mfma_f32_32x32x16_bf16 v[0:15], v[192:195], v[192:195], 0
    v_mfma_f32_32x32x16_bf16 v[16:31], v[192:195], v[192:195], 0
    v_mfma_f32_32x32x16_bf16 v[32:47], v[192:195], v[192:195], 0
    v_mfma_f32_32x32x16_bf16 v[48:63], v[192:195], v[192:195], 0
    v_mfma_f32_32x32x16_bf16 v[64:79], v[192:195], v[192:195], 0
    v_mfma_f32_32x32x16_bf16 v[80:95], v[192:195], v[192:195], 0
    v_mfma_f32_32x32x16_bf16 v[96:111], v[192:195], v[192:195], 0
    v_mfma_f32_32x32x16_bf16 v[112:127], v[192:195], v[192:195], 0
    s_barrier
    ds_read_b128 v[192:195], v231 offset:0
    ds_read_b128 v[196:199], v231 offset:1024
    ds_read_b128 v[200:203], v231 offset:2048
    ds_read_b128 v[204:207], v231 offset:3072
    ds_read_b64_tr_b16 v[128:129], v232 offset:28800
    ds_read_b64_tr_b16 v[130:131], v232 offset:32384
    ds_read_b64_tr_b16 v[144:145], v232 offset:43200
    ds_read_b64_tr_b16 v[146:147], v232 offset:46784
    ds_read_b64_tr_b16 v[132:133], v232 offset:28832
    ds_read_b64_tr_b16 v[134:135], v232 offset:32416
    ds_read_b64_tr_b16 v[148:149], v232 offset:43232
    ds_read_b64_tr_b16 v[150:151], v232 offset:46816
    ds_read_b64_tr_b16 v[136:137], v232 offset:28864
    ds_read_b64_tr_b16 v[138:139], v232 offset:32448
    ds_read_b64_tr_b16 v[152:153], v232 offset:43264
    ds_read_b64_tr_b16 v[154:155], v232 offset:46848
    ds_read_b64_tr_b16 v[140:141], v232 offset:28896
    ds_read_b64_tr_b16 v[142:143], v232 offset:32480
    ds_read_b64_tr_b16 v[156:157], v232 offset:43296
    ds_read_b64_tr_b16 v[158:159], v232 offset:46880
    s_mov_b32 s24, 7
g3c0_loop:
    s_waitcnt vmcnt(4) lgkmcnt(0)
    s_barrier
    v_mfma_f32_16x16x32_bf16 v[0:3], v[128:131], v[192:195], v[0:3]
    ds_read_b128 v[208:211], v231 offset:8192
    v_mfma_f32_16x16x32_bf16 v[4:7], v[128:131], v[196:199], v[4:7]
    ds_read_b128 v[212:215], v231 offset:9216
    v_mfma_f32_16x16x32_bf16 v[8:11], v[128:131], v[200:203], v[8:11]
    ds_read_b128 v[216:219], v231 offset:10240
    v_mfma_f32_16x16x32_bf16 v[12:15], v[128:131], v[204:207], v[12:15]
    ds_read_b128 v[220:223], v231 offset:11264
    v_mfma_f32_16x16x32_bf16 v[64:67], v[144:147], v[192:195], v[64:67]
    ds_read_b64_tr_b16 v[160:161], v233 offset:0
    v_mfma_f32_16x16x32_bf16 v[68:71], v[144:147], v[196:199], v[68:71]
    s_add_u32 m0, s19, 3072
    s_nop 0
    buffer_load_dwordx4 v224, s[8:11], s16 offen lds
    v_mfma_f32_16x16x32_bf16 v[72:75], v[144:147], v[200:203], v[72:75]
    ds_read_b64_tr_b16 v[162:163], v233 offset:3584
    v_mfma_f32_16x16x32_bf16 v[76:79], v[144:147], v[204:207], v[76:79]
    ds_read_b64_tr_b16 v[176:177], v233 offset:14400
    v_mfma_f32_16x16x32_bf16 v[16:19], v[132:135], v[192:195], v[16:19]
    ds_read_b64_tr_b16 v[178:179], v233 offset:17984
    v_mfma_f32_16x16x32_bf16 v[20:23], v[132:135], v[196:199], v[20:23]
    ds_read_b64_tr_b16 v[164:165], v233 offset:32
    v_mfma_f32_16x16x32_bf16 v[24:27], v[132:135], v[200:203], v[24:27]
    ds_read_b64_tr_b16 v[166:167], v233 offset:3616
    v_mfma_f32_16x16x32_bf16 v[28:31], v[132:135], v[204:207], v[28:31]
    s_add_u32 m0, s19, 4096
    s_nop 0
    buffer_load_dwordx4 v225, s[8:11], s16 offen lds
    v_mfma_f32_16x16x32_bf16 v[80:83], v[148:151], v[192:195], v[80:83]
    v_mfma_f32_16x16x32_bf16 v[84:87], v[148:151], v[196:199], v[84:87]
    ds_read_b64_tr_b16 v[180:181], v233 offset:14432
    v_mfma_f32_16x16x32_bf16 v[88:91], v[148:151], v[200:203], v[88:91]
    ds_read_b64_tr_b16 v[182:183], v233 offset:18016
    v_mfma_f32_16x16x32_bf16 v[92:95], v[148:151], v[204:207], v[92:95]
    ds_read_b64_tr_b16 v[168:169], v233 offset:64
    v_mfma_f32_16x16x32_bf16 v[32:35], v[136:139], v[192:195], v[32:35]
    ds_read_b64_tr_b16 v[170:171], v233 offset:3648
    v_mfma_f32_16x16x32_bf16 v[36:39], v[136:139], v[196:199], v[36:39]
    ds_read_b64_tr_b16 v[184:185], v233 offset:14464
    v_mfma_f32_16x16x32_bf16 v[40:43], v[136:139], v[200:203], v[40:43]
    s_add_u32 m0, s19, 5120
    s_nop 0
    buffer_load_dwordx4 v226, s[8:11], s16 offen lds
    v_mfma_f32_16x16x32_bf16 v[44:47], v[136:139], v[204:207], v[44:47]
    ds_read_b64_tr_b16 v[186:187], v233 offset:18048
    v_mfma_f32_16x16x32_bf16 v[96:99], v[152:155], v[192:195], v[96:99]
    ds_read_b64_tr_b16 v[172:173], v233 offset:96
    v_mfma_f32_16x16x32_bf16 v[100:103], v[152:155], v[196:199], v[100:103]
    ds_read_b64_tr_b16 v[174:175], v233 offset:3680
    v_mfma_f32_16x16x32_bf16 v[104:107], v[152:155], v[200:203], v[104:107]
    ds_read_b64_tr_b16 v[188:189], v233 offset:14496
    v_mfma_f32_16x16x32_bf16 v[108:111], v[152:155], v[204:207], v[108:111]
    ds_read_b64_tr_b16 v[190:191], v233 offset:18080
    v_mfma_f32_16x16x32_bf16 v[48:51], v[140:143], v[192:195], v[48:51]
    s_add_u32 m0, s19, 6144
    s_nop 0
    buffer_load_dwordx4 v227, s[8:11], s16 offen lds
    s_add_u32 s16, s16, 229376
    s_cmp_eq_u32 s16, s18
    s_cselect_b32 s16, s17, s16
    v_mfma_f32_16x16x32_bf16 v[52:55], v[140:143], v[196:199], v[52:55]
    v_mfma_f32_16x16x32_bf16 v[56:59], v[140:143], v[200:203], v[56:59]
    v_mfma_f32_16x16x32_bf16 v[60:63], v[140:143], v[204:207], v[60:63]
    v_mfma_f32_16x16x32_bf16 v[112:115], v[156:159], v[192:195], v[112:115]
    v_mfma_f32_16x16x32_bf16 v[116:119], v[156:159], v[196:199], v[116:119]
    v_mfma_f32_16x16x32_bf16 v[120:123], v[156:159], v[200:203], v[120:123]
    v_mfma_f32_16x16x32_bf16 v[124:127], v[156:159], v[204:207], v[124:127]
    s_waitcnt vmcnt(4) lgkmcnt(0)
    s_barrier
    v_mfma_f32_16x16x32_bf16 v[0:3], v[160:163], v[208:211], v[0:3]
    ds_read_b128 v[192:195], v231 offset:16384
    v_mfma_f32_16x16x32_bf16 v[4:7], v[160:163], v[212:215], v[4:7]
    ds_read_b128 v[196:199], v231 offset:17408
    v_mfma_f32_16x16x32_bf16 v[8:11], v[160:163], v[216:219], v[8:11]
    ds_read_b128 v[200:203], v231 offset:18432
    v_mfma_f32_16x16x32_bf16 v[12:15], v[160:163], v[220:223], v[12:15]
    ds_read_b128 v[204:207], v231 offset:19456
    v_mfma_f32_16x16x32_bf16 v[64:67], v[176:179], v[208:211], v[64:67]
    ds_read_b64_tr_b16 v[128:129], v233 offset:28800
    v_mfma_f32_16x16x32_bf16 v[68:71], v[176:179], v[212:215], v[68:71]
    s_add_u32 m0, s19, 31872
    s_nop 0
    buffer_load_dwordx4 v224, s[8:11], s16 offen lds
    v_mfma_f32_16x16x32_bf16 v[72:75], v[176:179], v[216:219], v[72:75]
    ds_read_b64_tr_b16 v[130:131], v233 offset:32384
    v_mfma_f32_16x16x32_bf16 v[76:79], v[176:179], v[220:223], v[76:79]
    ds_read_b64_tr_b16 v[144:145], v233 offset:43200
    v_mfma_f32_16x16x32_bf16 v[16:19], v[164:167], v[208:211], v[16:19]
    ds_read_b64_tr_b16 v[146:147], v233 offset:46784
    v_mfma_f32_16x16x32_bf16 v[20:23], v[164:167], v[212:215], v[20:23]
    ds_read_b64_tr_b16 v[132:133], v233 offset:28832
    v_mfma_f32_16x16x32_bf16 v[24:27], v[164:167], v[216:219], v[24:27]
    ds_read_b64_tr_b16 v[134:135], v233 offset:32416
    v_mfma_f32_16x16x32_bf16 v[28:31], v[164:167], v[220:223], v[28:31]
    s_add_u32 m0, s19, 32896
    s_nop 0
    buffer_load_dwordx4 v225, s[8:11], s16 offen lds
    v_mfma_f32_16x16x32_bf16 v[80:83], v[180:183], v[208:211], v[80:83]
    v_mfma_f32_16x16x32_bf16 v[84:87], v[180:183], v[212:215], v[84:87]
    ds_read_b64_tr_b16 v[148:149], v233 offset:43232
    v_mfma_f32_16x16x32_bf16 v[88:91], v[180:183], v[216:219], v[88:91]
    ds_read_b64_tr_b16 v[150:151], v233 offset:46816
    v_mfma_f32_16x16x32_bf16 v[92:95], v[180:183], v[220:223], v[92:95]
    ds_read_b64_tr_b16 v[136:137], v233 offset:28864
    v_mfma_f32_16x16x32_bf16 v[32:35], v[168:171], v[208:211], v[32:35]
    ds_read_b64_tr_b16 v[138:139], v233 offset:32448
    v_mfma_f32_16x16x32_bf16 v[36:39], v[168:171], v[212:215], v[36:39]
    ds_read_b64_tr_b16 v[152:153], v233 offset:43264
    v_mfma_f32_16x16x32_bf16 v[40:43], v[168:171], v[216:219], v[40:43]
    s_add_u32 m0, s19, 33920
    s_nop 0
    buffer_load_dwordx4 v226, s[8:11], s16 offen lds
    v_mfma_f32_16x16x32_bf16 v[44:47], v[168:171], v[220:223], v[44:47]
    ds_read_b64_tr_b16 v[154:155], v233 offset:46848
    v_mfma_f32_16x16x32_bf16 v[96:99], v[184:187], v[208:211], v[96:99]
    ds_read_b64_tr_b16 v[140:141], v233 offset:28896
    v_mfma_f32_16x16x32_bf16 v[100:103], v[184:187], v[212:215], v[100:103]
    ds_read_b64_tr_b16 v[142:143], v233 offset:32480
    v_mfma_f32_16x16x32_bf16 v[104:107], v[184:187], v[216:219], v[104:107]
    ds_read_b64_tr_b16 v[156:157], v233 offset:43296
    v_mfma_f32_16x16x32_bf16 v[108:111], v[184:187], v[220:223], v[108:111]
    ds_read_b64_tr_b16 v[158:159], v233 offset:46880
    v_mfma_f32_16x16x32_bf16 v[48:51], v[172:175], v[208:211], v[48:51]
    s_add_u32 m0, s19, 34944
    s_nop 0
    buffer_load_dwordx4 v227, s[8:11], s16 offen lds
    s_add_u32 s16, s16, 229376
    s_cmp_eq_u32 s16, s18
    s_cselect_b32 s16, s17, s16
    v_mfma_f32_16x16x32_bf16 v[52:55], v[172:175], v[212:215], v[52:55]
    v_mfma_f32_16x16x32_bf16 v[56:59], v[172:175], v[216:219], v[56:59]
    v_mfma_f32_16x16x32_bf16 v[60:63], v[172:175], v[220:223], v[60:63]
    v_mfma_f32_16x16x32_bf16 v[112:115], v[188:191], v[208:211], v[112:115]
    v_mfma_f32_16x16x32_bf16 v[116:119], v[188:191], v[212:215], v[116:119]
    v_mfma_f32_16x16x32_bf16 v[120:123], v[188:191], v[216:219], v[120:123]
    v_mfma_f32_16x16x32_bf16 v[124:127], v[188:191], v[220:223], v[124:127]
    s_waitcnt vmcnt(4) lgkmcnt(0)
    s_barrier
    v_mfma_f32_16x16x32_bf16 v[0:3], v[128:131], v[192:195], v[0:3]
    ds_read_b128 v[208:211], v231 offset:24576
    v_mfma_f32_16x16x32_bf16 v[4:7], v[128:131], v[196:199], v[4:7]
    ds_read_b128 v[212:215], v231 offset:25600
    v_mfma_f32_16x16x32_bf16 v[8:11], v[128:131], v[200:203], v[8:11]
    ds_read_b128 v[216:219], v231 offset:26624
    v_mfma_f32_16x16x32_bf16 v[12:15], v[128:131], v[204:207], v[12:15]
    ds_read_b128 v[220:223], v231 offset:27648
    v_mfma_f32_16x16x32_bf16 v[64:67], v[144:147], v[192:195], v[64:67]
    ds_read_b64_tr_b16 v[160:161], v232 offset:0
    v_mfma_f32_16x16x32_bf16 v[68:71], v[144:147], v[196:199], v[68:71]
    s_add_u32 m0, s19, 60672
    s_nop 0
    buffer_load_dwordx4 v224, s[8:11], s16 offen lds
    v_mfma_f32_16x16x32_bf16 v[72:75], v[144:147], v[200:203], v[72:75]
    ds_read_b64_tr_b16 v[162:163], v232 offset:3584
    v_mfma_f32_16x16x32_bf16 v[76:79], v[144:147], v[204:207], v[76:79]
    ds_read_b64_tr_b16 v[176:177], v232 offset:14400
    v_mfma_f32_16x16x32_bf16 v[16:19], v[132:135], v[192:195], v[16:19]
    ds_read_b64_tr_b16 v[178:179], v232 offset:17984
    v_mfma_f32_16x16x32_bf16 v[20:23], v[132:135], v[196:199], v[20:23]
    ds_read_b64_tr_b16 v[164:165], v232 offset:32
    v_mfma_f32_16x16x32_bf16 v[24:27], v[132:135], v[200:203], v[24:27]
    ds_read_b64_tr_b16 v[166:167], v232 offset:3616
    v_mfma_f32_16x16x32_bf16 v[28:31], v[132:135], v[204:207], v[28:31]
    s_add_u32 m0, s19, 61696
    s_nop 0
    buffer_load_dwordx4 v225, s[8:11], s16 offen lds
    v_mfma_f32_16x16x32_bf16 v[80:83], v[148:151], v[192:195], v[80:83]
    v_mfma_f32_16x16x32_bf16 v[84:87], v[148:151], v[196:199], v[84:87]
    ds_read_b64_tr_b16 v[180:181], v232 offset:14432
    v_mfma_f32_16x16x32_bf16 v[88:91], v[148:151], v[200:203], v[88:91]
    ds_read_b64_tr_b16 v[182:183], v232 offset:18016
    v_mfma_f32_16x16x32_bf16 v[92:95], v[148:151], v[204:207], v[92:95]
    ds_read_b64_tr_b16 v[168:169], v232 offset:64
    v_mfma_f32_16x16x32_bf16 v[32:35], v[136:139], v[192:195], v[32:35]
    ds_read_b64_tr_b16 v[170:171], v232 offset:3648
    v_mfma_f32_16x16x32_bf16 v[36:39], v[136:139], v[196:199], v[36:39]
    ds_read_b64_tr_b16 v[184:185], v232 offset:14464
    v_mfma_f32_16x16x32_bf16 v[40:43], v[136:139], v[200:203], v[40:43]
    s_add_u32 m0, s19, 62720
    s_nop 0
    buffer_load_dwordx4 v226, s[8:11], s16 offen lds
    v_mfma_f32_16x16x32_bf16 v[44:47], v[136:139], v[204:207], v[44:47]
    ds_read_b64_tr_b16 v[186:187], v232 offset:18048
    v_mfma_f32_16x16x32_bf16 v[96:99], v[152:155], v[192:195], v[96:99]
    ds_read_b64_tr_b16 v[172:173], v232 offset:96
    v_mfma_f32_16x16x32_bf16 v[100:103], v[152:155], v[196:199], v[100:103]
    ds_read_b64_tr_b16 v[174:175], v232 offset:3680
    v_mfma_f32_16x16x32_bf16 v[104:107], v[152:155], v[200:203], v[104:107]
    ds_read_b64_tr_b16 v[188:189], v232 offset:14496
    v_mfma_f32_16x16x32_bf16 v[108:111], v[152:155], v[204:207], v[108:111]
    ds_read_b64_tr_b16 v[190:191], v232 offset:18080
    v_mfma_f32_16x16x32_bf16 v[48:51], v[140:143], v[192:195], v[48:51]
    s_add_u32 m0, s19, 63744
    s_nop 0
    buffer_load_dwordx4 v227, s[8:11], s16 offen lds
    s_add_u32 s16, s16, 229376
    s_cmp_eq_u32 s16, s18
    s_cselect_b32 s16, s17, s16
    v_mfma_f32_16x16x32_bf16 v[52:55], v[140:143], v[196:199], v[52:55]
    v_mfma_f32_16x16x32_bf16 v[56:59], v[140:143], v[200:203], v[56:59]
    v_mfma_f32_16x16x32_bf16 v[60:63], v[140:143], v[204:207], v[60:63]
    v_mfma_f32_16x16x32_bf16 v[112:115], v[156:159], v[192:195], v[112:115]
    v_mfma_f32_16x16x32_bf16 v[116:119], v[156:159], v[196:199], v[116:119]
    v_mfma_f32_16x16x32_bf16 v[120:123], v[156:159], v[200:203], v[120:123]
    v_mfma_f32_16x16x32_bf16 v[124:127], v[156:159], v[204:207], v[124:127]
    s_waitcnt vmcnt(4) lgkmcnt(0)
    s_barrier
    v_mfma_f32_16x16x32_bf16 v[0:3], v[160:163], v[208:211], v[0:3]
    ds_read_b128 v[192:195], v231 offset:0
    v_mfma_f32_16x16x32_bf16 v[4:7], v[160:163], v[212:215], v[4:7]
    ds_read_b128 v[196:199], v231 offset:1024
    v_mfma_f32_16x16x32_bf16 v[8:11], v[160:163], v[216:219], v[8:11]
    ds_read_b128 v[200:203], v231 offset:2048
    v_mfma_f32_16x16x32_bf16 v[12:15], v[160:163], v[220:223], v[12:15]
    ds_read_b128 v[204:207], v231 offset:3072
    v_mfma_f32_16x16x32_bf16 v[64:67], v[176:179], v[208:211], v[64:67]
    ds_read_b64_tr_b16 v[128:129], v232 offset:28800
    v_mfma_f32_16x16x32_bf16 v[68:71], v[176:179], v[212:215], v[68:71]
    s_add_u32 m0, s19, 89472
    s_nop 0
    buffer_load_dwordx4 v224, s[8:11], s16 offen lds
    v_mfma_f32_16x16x32_bf16 v[72:75], v[176:179], v[216:219], v[72:75]
    ds_read_b64_tr_b16 v[130:131], v232 offset:32384
    v_mfma_f32_16x16x32_bf16 v[76:79], v[176:179], v[220:223], v[76:79]
    ds_read_b64_tr_b16 v[144:145], v232 offset:43200
    v_mfma_f32_16x16x32_bf16 v[16:19], v[164:167], v[208:211], v[16:19]
    ds_read_b64_tr_b16 v[146:147], v232 offset:46784
    v_mfma_f32_16x16x32_bf16 v[20:23], v[164:167], v[212:215], v[20:23]
    ds_read_b64_tr_b16 v[132:133], v232 offset:28832
    v_mfma_f32_16x16x32_bf16 v[24:27], v[164:167], v[216:219], v[24:27]
    ds_read_b64_tr_b16 v[134:135], v232 offset:32416
    v_mfma_f32_16x16x32_bf16 v[28:31], v[164:167], v[220:223], v[28:31]
    s_add_u32 m0, s19, 90496
    s_nop 0
    buffer_load_dwordx4 v225, s[8:11], s16 offen lds
    v_mfma_f32_16x16x32_bf16 v[80:83], v[180:183], v[208:211], v[80:83]
    v_mfma_f32_16x16x32_bf16 v[84:87], v[180:183], v[212:215], v[84:87]
    ds_read_b64_tr_b16 v[148:149], v232 offset:43232
    v_mfma_f32_16x16x32_bf16 v[88:91], v[180:183], v[216:219], v[88:91]
    ds_read_b64_tr_b16 v[150:151], v232 offset:46816
    v_mfma_f32_16x16x32_bf16 v[92:95], v[180:183], v[220:223], v[92:95]
    ds_read_b64_tr_b16 v[136:137], v232 offset:28864
    v_mfma_f32_16x16x32_bf16 v[32:35], v[168:171], v[208:211], v[32:35]
    ds_read_b64_tr_b16 v[138:139], v232 offset:32448
    v_mfma_f32_16x16x32_bf16 v[36:39], v[168:171], v[212:215], v[36:39]
    ds_read_b64_tr_b16 v[152:153], v232 offset:43264
    v_mfma_f32_16x16x32_bf16 v[40:43], v[168:171], v[216:219], v[40:43]
    s_add_u32 m0, s19, 91520
    s_nop 0
    buffer_load_dwordx4 v226, s[8:11], s16 offen lds
    v_mfma_f32_16x16x32_bf16 v[44:47], v[168:171], v[220:223], v[44:47]
    ds_read_b64_tr_b16 v[154:155], v232 offset:46848
    v_mfma_f32_16x16x32_bf16 v[96:99], v[184:187], v[208:211], v[96:99]
    ds_read_b64_tr_b16 v[140:141], v232 offset:28896
    v_mfma_f32_16x16x32_bf16 v[100:103], v[184:187], v[212:215], v[100:103]
    ds_read_b64_tr_b16 v[142:143], v232 offset:32480
    v_mfma_f32_16x16x32_bf16 v[104:107], v[184:187], v[216:219], v[104:107]
    ds_read_b64_tr_b16 v[156:157], v232 offset:43296
    v_mfma_f32_16x16x32_bf16 v[108:111], v[184:187], v[220:223], v[108:111]
    ds_read_b64_tr_b16 v[158:159], v232 offset:46880
    v_mfma_f32_16x16x32_bf16 v[48:51], v[172:175], v[208:211], v[48:51]
    s_add_u32 m0, s19, 92544
    s_nop 0
    buffer_load_dwordx4 v227, s[8:11], s16 offen lds
    s_add_u32 s16, s16, 229376
    s_cmp_eq_u32 s16, s18
    s_cselect_b32 s16, s17, s16
    v_mfma_f32_16x16x32_bf16 v[52:55], v[172:175], v[212:215], v[52:55]
    v_mfma_f32_16x16x32_bf16 v[56:59], v[172:175], v[216:219], v[56:59]
    v_mfma_f32_16x16x32_bf16 v[60:63], v[172:175], v[220:223], v[60:63]
    v_mfma_f32_16x16x32_bf16 v[112:115], v[188:191], v[208:211], v[112:115]
    v_mfma_f32_16x16x32_bf16 v[116:119], v[188:191], v[212:215], v[116:119]
    v_mfma_f32_16x16x32_bf16 v[120:123], v[188:191], v[216:219], v[120:123]
    v_mfma_f32_16x16x32_bf16 v[124:127], v[188:191], v[220:223], v[124:127]
    s_sub_u32 s24, s24, 1
    s_cmp_lg_u32 s24, 0
    s_cbranch_scc1 g3c0_loop
    s_sub_u32 s27, s74, s58
    s_and_b32 s27, s27, 7
    s_cmp_lt_u32 s27, 4
    s_cselect_b32 s27, 14, 0
    s_waitcnt vmcnt(4) lgkmcnt(0)
    s_barrier
    v_mfma_f32_16x16x32_bf16 v[0:3], v[128:131], v[192:195], v[0:3]
    ds_read_b128 v[208:211], v231 offset:8192
    v_mfma_f32_16x16x32_bf16 v[4:7], v[128:131], v[196:199], v[4:7]
    ds_read_b128 v[212:215], v231 offset:9216
    v_mfma_f32_16x16x32_bf16 v[8:11], v[128:131], v[200:203], v[8:11]
    ds_read_b128 v[216:219], v231 offset:10240
    v_mfma_f32_16x16x32_bf16 v[12:15], v[128:131], v[204:207], v[12:15]
    ds_read_b128 v[220:223], v231 offset:11264
    v_mfma_f32_16x16x32_bf16 v[64:67], v[144:147], v[192:195], v[64:67]
    ds_read_b64_tr_b16 v[160:161], v233 offset:0
    v_mfma_f32_16x16x32_bf16 v[68:71], v[144:147], v[196:199], v[68:71]
    s_add_u32 m0, s19, 3072
    s_nop 0
    buffer_load_dwordx4 v224, s[8:11], s16 offen lds
    v_mfma_f32_16x16x32_bf16 v[72:75], v[144:147], v[200:203], v[72:75]
    ds_read_b64_tr_b16 v[162:163], v233 offset:3584
    v_mfma_f32_16x16x32_bf16 v[76:79], v[144:147], v[204:207], v[76:79]
    ds_read_b64_tr_b16 v[176:177], v233 offset:14400
    v_mfma_f32_16x16x32_bf16 v[16:19], v[132:135], v[192:195], v[16:19]
    ds_read_b64_tr_b16 v[178:179], v233 offset:17984
    v_mfma_f32_16x16x32_bf16 v[20:23], v[132:135], v[196:199], v[20:23]
    ds_read_b64_tr_b16 v[164:165], v233 offset:32
    v_mfma_f32_16x16x32_bf16 v[24:27], v[132:135], v[200:203], v[24:27]
    ds_read_b64_tr_b16 v[166:167], v233 offset:3616
    v_mfma_f32_16x16x32_bf16 v[28:31], v[132:135], v[204:207], v[28:31]
    s_add_u32 m0, s19, 4096
    s_nop 0
    buffer_load_dwordx4 v225, s[8:11], s16 offen lds
    v_mfma_f32_16x16x32_bf16 v[80:83], v[148:151], v[192:195], v[80:83]
    v_mfma_f32_16x16x32_bf16 v[84:87], v[148:151], v[196:199], v[84:87]
    ds_read_b64_tr_b16 v[180:181], v233 offset:14432
    v_mfma_f32_16x16x32_bf16 v[88:91], v[148:151], v[200:203], v[88:91]
    ds_read_b64_tr_b16 v[182:183], v233 offset:18016
    v_mfma_f32_16x16x32_bf16 v[92:95], v[148:151], v[204:207], v[92:95]
    ds_read_b64_tr_b16 v[168:169], v233 offset:64
    v_mfma_f32_16x16x32_bf16 v[32:35], v[136:139], v[192:195], v[32:35]
    ds_read_b64_tr_b16 v[170:171], v233 offset:3648
    v_mfma_f32_16x16x32_bf16 v[36:39], v[136:139], v[196:199], v[36:39]
    ds_read_b64_tr_b16 v[184:185], v233 offset:14464
    v_mfma_f32_16x16x32_bf16 v[40:43], v[136:139], v[200:203], v[40:43]
    s_add_u32 m0, s19, 5120
    s_nop 0
    buffer_load_dwordx4 v226, s[8:11], s16 offen lds
    v_mfma_f32_16x16x32_bf16 v[44:47], v[136:139], v[204:207], v[44:47]
    ds_read_b64_tr_b16 v[186:187], v233 offset:18048
    v_mfma_f32_16x16x32_bf16 v[96:99], v[152:155], v[192:195], v[96:99]
    ds_read_b64_tr_b16 v[172:173], v233 offset:96
    v_mfma_f32_16x16x32_bf16 v[100:103], v[152:155], v[196:199], v[100:103]
    ds_read_b64_tr_b16 v[174:175], v233 offset:3680
    v_mfma_f32_16x16x32_bf16 v[104:107], v[152:155], v[200:203], v[104:107]
    ds_read_b64_tr_b16 v[188:189], v233 offset:14496
    v_mfma_f32_16x16x32_bf16 v[108:111], v[152:155], v[204:207], v[108:111]
    ds_read_b64_tr_b16 v[190:191], v233 offset:18080
    v_mfma_f32_16x16x32_bf16 v[48:51], v[140:143], v[192:195], v[48:51]
    s_add_u32 m0, s19, 6144
    s_nop 0
    buffer_load_dwordx4 v227, s[8:11], s16 offen lds
    s_add_u32 s16, s16, 229376
    s_cmp_eq_u32 s16, s18
    s_cselect_b32 s16, s17, s16
    v_mfma_f32_16x16x32_bf16 v[52:55], v[140:143], v[196:199], v[52:55]
    v_mfma_f32_16x16x32_bf16 v[56:59], v[140:143], v[200:203], v[56:59]
    v_mfma_f32_16x16x32_bf16 v[60:63], v[140:143], v[204:207], v[60:63]
    v_mfma_f32_16x16x32_bf16 v[112:115], v[156:159], v[192:195], v[112:115]
    v_mfma_f32_16x16x32_bf16 v[116:119], v[156:159], v[196:199], v[116:119]
    v_mfma_f32_16x16x32_bf16 v[120:123], v[156:159], v[200:203], v[120:123]
    v_mfma_f32_16x16x32_bf16 v[124:127], v[156:159], v[204:207], v[124:127]
    s_waitcnt vmcnt(4) lgkmcnt(0)
    s_barrier
    v_mfma_f32_16x16x32_bf16 v[0:3], v[160:163], v[208:211], v[0:3]
    ds_read_b128 v[192:195], v231 offset:16384
    v_mfma_f32_16x16x32_bf16 v[4:7], v[160:163], v[212:215], v[4:7]
    ds_read_b128 v[196:199], v231 offset:17408
    v_lshlrev_b32 v247, 7, v250
    s_add_u32 s29, s3, 0
    s_lshl_b32 s30, s29, 12
    s_add_u32 s30, s30, s25
    s_cmp_lt_u32 s29, s27
    s_cselect_b32 s30, s30, 0x7f000000
    s_mov_b64 exec, 0xffffffff
    buffer_load_dword v248, v247, s[80:83], s30 offen sc1
    s_mov_b64 exec, -1
    v_mfma_f32_16x16x32_bf16 v[8:11], v[160:163], v[216:219], v[8:11]
    ds_read_b128 v[200:203], v231 offset:18432
    v_mfma_f32_16x16x32_bf16 v[12:15], v[160:163], v[220:223], v[12:15]
    ds_read_b128 v[204:207], v231 offset:19456
    v_mfma_f32_16x16x32_bf16 v[64:67], v[176:179], v[208:211], v[64:67]
    v_mfma_f32_16x16x32_bf16 v[68:71], v[176:179], v[212:215], v[68:71]
    ds_read_b64_tr_b16 v[128:129], v233 offset:28800
    v_mfma_f32_16x16x32_bf16 v[72:75], v[176:179], v[216:219], v[72:75]
    ds_read_b64_tr_b16 v[130:131], v233 offset:32384
    v_mfma_f32_16x16x32_bf16 v[76:79], v[176:179], v[220:223], v[76:79]
    ds_read_b64_tr_b16 v[144:145], v233 offset:43200
    v_mfma_f32_16x16x32_bf16 v[16:19], v[164:167], v[208:211], v[16:19]
    v_mfma_f32_16x16x32_bf16 v[20:23], v[164:167], v[212:215], v[20:23]
    ds_read_b64_tr_b16 v[146:147], v233 offset:46784
    v_mfma_f32_16x16x32_bf16 v[24:27], v[164:167], v[216:219], v[24:27]
    ds_read_b64_tr_b16 v[132:133], v233 offset:28832
    v_mfma_f32_16x16x32_bf16 v[28:31], v[164:167], v[220:223], v[28:31]
    ds_read_b64_tr_b16 v[134:135], v233 offset:32416
    v_mfma_f32_16x16x32_bf16 v[80:83], v[180:183], v[208:211], v[80:83]
    v_mfma_f32_16x16x32_bf16 v[84:87], v[180:183], v[212:215], v[84:87]
    ds_read_b64_tr_b16 v[148:149], v233 offset:43232
    v_mfma_f32_16x16x32_bf16 v[88:91], v[180:183], v[216:219], v[88:91]
    ds_read_b64_tr_b16 v[150:151], v233 offset:46816
    v_mfma_f32_16x16x32_bf16 v[92:95], v[180:183], v[220:223], v[92:95]
    ds_read_b64_tr_b16 v[136:137], v233 offset:28864
    v_mfma_f32_16x16x32_bf16 v[32:35], v[168:171], v[208:211], v[32:35]
    ds_read_b64_tr_b16 v[138:139], v233 offset:32448
    v_mfma_f32_16x16x32_bf16 v[36:39], v[168:171], v[212:215], v[36:39]
    v_lshlrev_b32 v247, 7, v250
    s_add_u32 s29, s3, 8
    s_lshl_b32 s30, s29, 12
    s_add_u32 s30, s30, s25
    s_cmp_lt_u32 s29, s27
    s_cselect_b32 s30, s30, 0x7f000000
    s_mov_b64 exec, 0xffffffff
    buffer_load_dword v248, v247, s[80:83], s30 offen sc1
    s_mov_b64 exec, -1
    v_mfma_f32_16x16x32_bf16 v[40:43], v[168:171], v[216:219], v[40:43]
    ds_read_b64_tr_b16 v[152:153], v233 offset:43264
    v_mfma_f32_16x16x32_bf16 v[44:47], v[168:171], v[220:223], v[44:47]
    ds_read_b64_tr_b16 v[154:155], v233 offset:46848
    v_mfma_f32_16x16x32_bf16 v[96:99], v[184:187], v[208:211], v[96:99]
    ds_read_b64_tr_b16 v[140:141], v233 offset:28896
    v_mfma_f32_16x16x32_bf16 v[100:103], v[184:187], v[212:215], v[100:103]
    v_mfma_f32_16x16x32_bf16 v[104:107], v[184:187], v[216:219], v[104:107]
    ds_read_b64_tr_b16 v[142:143], v233 offset:32480
    v_mfma_f32_16x16x32_bf16 v[108:111], v[184:187], v[220:223], v[108:111]
    ds_read_b64_tr_b16 v[156:157], v233 offset:43296
    v_mfma_f32_16x16x32_bf16 v[48:51], v[172:175], v[208:211], v[48:51]
    ds_read_b64_tr_b16 v[158:159], v233 offset:46880
    v_mfma_f32_16x16x32_bf16 v[52:55], v[172:175], v[212:215], v[52:55]
    v_mfma_f32_16x16x32_bf16 v[56:59], v[172:175], v[216:219], v[56:59]
    v_mfma_f32_16x16x32_bf16 v[60:63], v[172:175], v[220:223], v[60:63]
    v_mfma_f32_16x16x32_bf16 v[112:115], v[188:191], v[208:211], v[112:115]
    v_mfma_f32_16x16x32_bf16 v[116:119], v[188:191], v[212:215], v[116:119]
    v_mfma_f32_16x16x32_bf16 v[120:123], v[188:191], v[216:219], v[120:123]
    v_mfma_f32_16x16x32_bf16 v[124:127], v[188:191], v[220:223], v[124:127]
    s_waitcnt vmcnt(2) lgkmcnt(0)
    s_barrier
    s_setprio 2
    v_mfma_f32_16x16x32_bf16 v[0:3], v[128:131], v[192:195], v[0:3]
    ds_read_b128 v[208:211], v231 offset:24576
    ds_read_b128 v[212:215], v231 offset:25600
    v_mfma_f32_16x16x32_bf16 v[4:7], v[128:131], v[196:199], v[4:7]
    ds_read_b128 v[216:219], v231 offset:26624
    v_mfma_f32_16x16x32_bf16 v[8:11], v[128:131], v[200:203], v[8:11]
    ds_read_b128 v[220:223], v231 offset:27648
    ds_read_b64_tr_b16 v[160:161], v232 offset:0
    v_mfma_f32_16x16x32_bf16 v[12:15], v[128:131], v[204:207], v[12:15]
    ds_read_b64_tr_b16 v[162:163], v232 offset:3584
    v_mfma_f32_16x16x32_bf16 v[64:67], v[144:147], v[192:195], v[64:67]
    ds_read_b64_tr_b16 v[176:177], v232 offset:14400
    ds_read_b64_tr_b16 v[178:179], v232 offset:17984
    v_mfma_f32_16x16x32_bf16 v[68:71], v[144:147], v[196:199], v[68:71]
    ds_read_b64_tr_b16 v[164:165], v232 offset:32
    v_mfma_f32_16x16x32_bf16 v[72:75], v[144:147], v[200:203], v[72:75]
    ds_read_b64_tr_b16 v[166:167], v232 offset:3616
    v_mfma_f32_16x16x32_bf16 v[76:79], v[144:147], v[204:207], v[76:79]
    ds_read_b64_tr_b16 v[180:181], v232 offset:14432
    ds_read_b64_tr_b16 v[182:183], v232 offset:18016
    v_mfma_f32_16x16x32_bf16 v[16:19], v[132:135], v[192:195], v[16:19]
    ds_read_b64_tr_b16 v[168:169], v232 offset:64
    v_mfma_f32_16x16x32_bf16 v[20:23], v[132:135], v[196:199], v[20:23]
    ds_read_b64_tr_b16 v[170:171], v232 offset:3648
    ds_read_b64_tr_b16 v[184:185], v232 offset:14464
    v_mfma_f32_16x16x32_bf16 v[24:27], v[132:135], v[200:203], v[24:27]
    ds_read_b64_tr_b16 v[186:187], v232 offset:18048
    v_mfma_f32_16x16x32_bf16 v[28:31], v[132:135], v[204:207], v[28:31]
    ds_read_b64_tr_b16 v[172:173], v232 offset:96
    ds_read_b64_tr_b16 v[174:175], v232 offset:3680
    v_mfma_f32_16x16x32_bf16 v[80:83], v[148:151], v[192:195], v[80:83]
    ds_read_b64_tr_b16 v[188:189], v232 offset:14496
    v_mfma_f32_16x16x32_bf16 v[84:87], v[148:151], v[196:199], v[84:87]
    ds_read_b64_tr_b16 v[190:191], v232 offset:18080
    v_mfma_f32_16x16x32_bf16 v[88:91], v[148:151], v[200:203], v[88:91]
    v_mfma_f32_16x16x32_bf16 v[92:95], v[148:151], v[204:207], v[92:95]
    v_mfma_f32_16x16x32_bf16 v[32:35], v[136:139], v[192:195], v[32:35]
    v_mfma_f32_16x16x32_bf16 v[36:39], v[136:139], v[196:199], v[36:39]
    v_mfma_f32_16x16x32_bf16 v[40:43], v[136:139], v[200:203], v[40:43]
    v_mfma_f32_16x16x32_bf16 v[44:47], v[136:139], v[204:207], v[44:47]
    v_mfma_f32_16x16x32_bf16 v[96:99], v[152:155], v[192:195], v[96:99]
    s_waitcnt lgkmcnt(0)
    s_barrier
    v_mfma_f32_16x16x32_bf16 v[100:103], v[152:155], v[196:199], v[100:103]
    v_mfma_f32_16x16x32_bf16 v[104:107], v[152:155], v[200:203], v[104:107]
    v_mfma_f32_16x16x32_bf16 v[108:111], v[152:155], v[204:207], v[108:111]
    v_mfma_f32_16x16x32_bf16 v[48:51], v[140:143], v[192:195], v[48:51]
    v_mfma_f32_16x16x32_bf16 v[52:55], v[140:143], v[196:199], v[52:55]
    v_mfma_f32_16x16x32_bf16 v[56:59], v[140:143], v[200:203], v[56:59]
    v_mfma_f32_16x16x32_bf16 v[60:63], v[140:143], v[204:207], v[60:63]
    v_mfma_f32_16x16x32_bf16 v[112:115], v[156:159], v[192:195], v[112:115]
    v_mfma_f32_16x16x32_bf16 v[116:119], v[156:159], v[196:199], v[116:119]
    v_mfma_f32_16x16x32_bf16 v[120:123], v[156:159], v[200:203], v[120:123]
    v_mfma_f32_16x16x32_bf16 v[124:127], v[156:159], v[204:207], v[124:127]
    s_and_b32 s64, s3, 1
    s_lshl_b32 s64, s64, 9
    s_add_u32 s64, s64, 159744
    v_lshlrev_b32 v253, 3, v252
    v_add_u32 v253, s64, v253
    s_lshl_b32 s64, s28, 6
    s_add_u32 s64, s64, 160896
    v_lshlrev_b32 v254, 4, v251
    v_add_u32 v231, s64, v254
    v_mfma_f32_16x16x32_bf16 v[0:3], v[160:163], v[208:211], v[0:3]
    ds_read_b64 v[192:193], v253 offset:0
    v_mfma_f32_16x16x32_bf16 v[4:7], v[160:163], v[212:215], v[4:7]
    ds_read_b64 v[194:195], v253 offset:128
    v_mfma_f32_16x16x32_bf16 v[8:11], v[160:163], v[216:219], v[8:11]
    ds_read_b64 v[196:197], v253 offset:256
    v_mfma_f32_16x16x32_bf16 v[12:15], v[160:163], v[220:223], v[12:15]
    v_mfma_f32_16x16x32_bf16 v[64:67], v[176:179], v[208:211], v[64:67]
    ds_read_b64 v[198:199], v253 offset:384
    v_mfma_f32_16x16x32_bf16 v[68:71], v[176:179], v[212:215], v[68:71]
    ds_read_b128 v[128:131], v231 offset:0
    v_mfma_f32_16x16x32_bf16 v[72:75], v[176:179], v[216:219], v[72:75]
    v_mfma_f32_16x16x32_bf16 v[76:79], v[176:179], v[220:223], v[76:79]
    ds_read_b128 v[132:135], v231 offset:64
    v_mfma_f32_16x16x32_bf16 v[16:19], v[164:167], v[208:211], v[16:19]
    ds_read_b128 v[136:139], v231 offset:128
    v_mfma_f32_16x16x32_bf16 v[20:23], v[164:167], v[212:215], v[20:23]
    ds_read_b128 v[140:143], v231 offset:192
    v_mfma_f32_16x16x32_bf16 v[24:27], v[164:167], v[216:219], v[24:27]
    v_mfma_f32_16x16x32_bf16 v[28:31], v[164:167], v[220:223], v[28:31]
    ds_read_b128 v[144:147], v231 offset:896
    v_mfma_f32_16x16x32_bf16 v[80:83], v[180:183], v[208:211], v[80:83]
    ds_read_b128 v[148:151], v231 offset:960
    v_mfma_f32_16x16x32_bf16 v[84:87], v[180:183], v[212:215], v[84:87]
    v_mfma_f32_16x16x32_bf16 v[88:91], v[180:183], v[216:219], v[88:91]
    ds_read_b128 v[152:155], v231 offset:1024
    v_mfma_f32_16x16x32_bf16 v[92:95], v[180:183], v[220:223], v[92:95]
    ds_read_b128 v[156:159], v231 offset:1088
    v_mfma_f32_16x16x32_bf16 v[32:35], v[168:171], v[208:211], v[32:35]
    v_mfma_f32_16x16x32_bf16 v[36:39], v[168:171], v[212:215], v[36:39]
    v_mfma_f32_16x16x32_bf16 v[40:43], v[168:171], v[216:219], v[40:43]
    v_mfma_f32_16x16x32_bf16 v[44:47], v[168:171], v[220:223], v[44:47]
    v_mfma_f32_16x16x32_bf16 v[96:99], v[184:187], v[208:211], v[96:99]
    v_mfma_f32_16x16x32_bf16 v[100:103], v[184:187], v[212:215], v[100:103]
    v_mfma_f32_16x16x32_bf16 v[104:107], v[184:187], v[216:219], v[104:107]
    v_mfma_f32_16x16x32_bf16 v[108:111], v[184:187], v[220:223], v[108:111]
    v_mfma_f32_16x16x32_bf16 v[48:51], v[172:175], v[208:211], v[48:51]
    v_mfma_f32_16x16x32_bf16 v[52:55], v[172:175], v[212:215], v[52:55]
    v_mfma_f32_16x16x32_bf16 v[56:59], v[172:175], v[216:219], v[56:59]
    v_mfma_f32_16x16x32_bf16 v[60:63], v[172:175], v[220:223], v[60:63]
    v_mfma_f32_16x16x32_bf16 v[112:115], v[188:191], v[208:211], v[112:115]
    v_mfma_f32_16x16x32_bf16 v[116:119], v[188:191], v[212:215], v[116:119]
    v_mfma_f32_16x16x32_bf16 v[120:123], v[188:191], v[216:219], v[120:123]
    v_mfma_f32_16x16x32_bf16 v[124:127], v[188:191], v[220:223], v[124:127]
    s_setprio 0
    s_and_b32 s64, s3, 1
    s_lshl_b32 s64, s64, 12
    s_add_u32 s25, s25, s64
    s_lshr_b32 s64, s69, 1
    s_lshl_b32 s64, s64, 14
    s_add_u32 s25, s25, s64
    s_add_u32 s26, s25, 8192
    s_and_b32 s64, s3, 1
    s_lshl_b32 s64, s64, 12
    s_lshr_b32 s65, s69, 1
    s_lshl_b32 s65, s65, 14
    s_add_u32 s64, s64, s65
    v_add_u32 v233, s64, v249
    v_add_u16 v232, 0xe000, v233
    s_waitcnt lgkmcnt(0)
    s_mov_b32 s64, 0xbfb8aa3b
    v_mul_f32 v176, v193, v193
    v_sub_f32 v160, 0, v192
    v_mul_f32 v168, s64, v193
    v_sub_f32 v161, 0, v192
    v_mul_f32 v169, s64, v193
    v_mul_f32 v178, v195, v195
    v_sub_f32 v162, 0, v194
    v_mul_f32 v170, s64, v195
    v_sub_f32 v163, 0, v194
    v_mul_f32 v171, s64, v195
    v_mul_f32 v180, v197, v197
    v_sub_f32 v164, 0, v196
    v_mul_f32 v172, s64, v197
    v_sub_f32 v165, 0, v196
    v_mul_f32 v173, s64, v197
    v_mul_f32 v182, v199, v199
    v_sub_f32 v166, 0, v198
    v_mul_f32 v174, s64, v199
    v_sub_f32 v167, 0, v198
    v_mul_f32 v175, s64, v199
    v_rcp_f32 v177, v176
    v_rcp_f32 v176, v176
    v_rcp_f32 v179, v178
    v_rcp_f32 v178, v178
    v_rcp_f32 v181, v180
    v_rcp_f32 v180, v180
    v_rcp_f32 v183, v182
    v_rcp_f32 v182, v182
    v_pk_fma_f32 v[0:1], v[160:161], v[128:129], v[0:1]
    v_pk_fma_f32 v[2:3], v[160:161], v[130:131], v[2:3]
    v_pk_mul_f32 v[212:213], v[168:169], v[0:1]
    v_pk_mul_f32 v[214:215], v[168:169], v[2:3]
    v_exp_f32 v212, v212
    v_exp_f32 v213, v213
    v_exp_f32 v214, v214
    v_exp_f32 v215, v215
    v_pk_fma_f32 v[64:65], v[160:161], v[144:145], v[64:65]
    v_pk_fma_f32 v[66:67], v[160:161], v[146:147], v[66:67]
    v_pk_fma_f32 v[212:213], v[212:213], v[176:177], v[176:177]
    v_pk_fma_f32 v[214:215], v[214:215], v[176:177], v[176:177]
    v_rcp_f32 v212, v212
    v_rcp_f32 v213, v213
    v_rcp_f32 v214, v214
    v_rcp_f32 v215, v215
    v_pk_mul_f32 v[0:1], v[0:1], v[64:65]
    v_pk_mul_f32 v[2:3], v[2:3], v[66:67]
    v_pk_mul_f32 v[0:1], v[0:1], v[212:213]
    v_pk_mul_f32 v[2:3], v[2:3], v[214:215]
    v_cvt_pk_bf16_f32 v216, v0, v1
    v_cvt_pk_bf16_f32 v217, v2, v3
    v_pk_fma_f32 v[16:17], v[160:161], v[132:133], v[16:17]
    v_pk_fma_f32 v[18:19], v[160:161], v[134:135], v[18:19]
    v_pk_mul_f32 v[212:213], v[168:169], v[16:17]
    v_pk_mul_f32 v[214:215], v[168:169], v[18:19]
    v_exp_f32 v212, v212
    v_exp_f32 v213, v213
    v_exp_f32 v214, v214
    v_exp_f32 v215, v215
    v_pk_fma_f32 v[80:81], v[160:161], v[148:149], v[80:81]
    v_pk_fma_f32 v[82:83], v[160:161], v[150:151], v[82:83]
    v_pk_fma_f32 v[212:213], v[212:213], v[176:177], v[176:177]
    v_pk_fma_f32 v[214:215], v[214:215], v[176:177], v[176:177]
    v_rcp_f32 v212, v212
    v_rcp_f32 v213, v213
    v_rcp_f32 v214, v214
    v_rcp_f32 v215, v215
    v_pk_mul_f32 v[16:17], v[16:17], v[80:81]
    v_pk_mul_f32 v[18:19], v[18:19], v[82:83]
    v_pk_mul_f32 v[16:17], v[16:17], v[212:213]
    v_pk_mul_f32 v[18:19], v[18:19], v[214:215]
    v_cvt_pk_bf16_f32 v218, v16, v17
    v_cvt_pk_bf16_f32 v219, v18, v19
    buffer_store_dwordx4 v[216:219], v249, s[80:83], s25 offen offset:0
    ds_write_b128 v232, v[216:219] offset:0
    v_pk_fma_f32 v[32:33], v[160:161], v[136:137], v[32:33]
    v_pk_fma_f32 v[34:35], v[160:161], v[138:139], v[34:35]
    v_pk_mul_f32 v[212:213], v[168:169], v[32:33]
    v_pk_mul_f32 v[214:215], v[168:169], v[34:35]
    v_exp_f32 v212, v212
    v_exp_f32 v213, v213
    v_exp_f32 v214, v214
    v_exp_f32 v215, v215
    v_pk_fma_f32 v[96:97], v[160:161], v[152:153], v[96:97]
    v_pk_fma_f32 v[98:99], v[160:161], v[154:155], v[98:99]
    v_pk_fma_f32 v[212:213], v[212:213], v[176:177], v[176:177]
    v_pk_fma_f32 v[214:215], v[214:215], v[176:177], v[176:177]
    v_rcp_f32 v212, v212
    v_rcp_f32 v213, v213
    v_rcp_f32 v214, v214
    v_rcp_f32 v215, v215
    v_pk_mul_f32 v[32:33], v[32:33], v[96:97]
    v_pk_mul_f32 v[34:35], v[34:35], v[98:99]
    v_pk_mul_f32 v[32:33], v[32:33], v[212:213]
    v_pk_mul_f32 v[34:35], v[34:35], v[214:215]
    v_cvt_pk_bf16_f32 v220, v32, v33
    v_cvt_pk_bf16_f32 v221, v34, v35
    v_pk_fma_f32 v[48:49], v[160:161], v[140:141], v[48:49]
    v_pk_fma_f32 v[50:51], v[160:161], v[142:143], v[50:51]
    v_pk_mul_f32 v[212:213], v[168:169], v[48:49]
    v_pk_mul_f32 v[214:215], v[168:169], v[50:51]
    v_exp_f32 v212, v212
    v_exp_f32 v213, v213
    v_exp_f32 v214, v214
    v_exp_f32 v215, v215
    v_pk_fma_f32 v[112:113], v[160:161], v[156:157], v[112:113]
    v_pk_fma_f32 v[114:115], v[160:161], v[158:159], v[114:115]
    v_pk_fma_f32 v[212:213], v[212:213], v[176:177], v[176:177]
    v_pk_fma_f32 v[214:215], v[214:215], v[176:177], v[176:177]
    v_rcp_f32 v212, v212
    v_rcp_f32 v213, v213
    v_rcp_f32 v214, v214
    v_rcp_f32 v215, v215
    v_pk_mul_f32 v[48:49], v[48:49], v[112:113]
    v_pk_mul_f32 v[50:51], v[50:51], v[114:115]
    v_pk_mul_f32 v[48:49], v[48:49], v[212:213]
    v_pk_mul_f32 v[50:51], v[50:51], v[214:215]
    v_cvt_pk_bf16_f32 v222, v48, v49
    v_cvt_pk_bf16_f32 v223, v50, v51
    buffer_store_dwordx4 v[220:223], v249, s[80:83], s26 offen offset:0
    ds_write_b128 v233, v[220:223] offset:0
    v_pk_fma_f32 v[4:5], v[162:163], v[128:129], v[4:5]
    v_pk_fma_f32 v[6:7], v[162:163], v[130:131], v[6:7]
    v_pk_mul_f32 v[212:213], v[170:171], v[4:5]
    v_pk_mul_f32 v[214:215], v[170:171], v[6:7]
    v_exp_f32 v212, v212
    v_exp_f32 v213, v213
    v_exp_f32 v214, v214
    v_exp_f32 v215, v215
    v_pk_fma_f32 v[68:69], v[162:163], v[144:145], v[68:69]
    v_pk_fma_f32 v[70:71], v[162:163], v[146:147], v[70:71]
    v_pk_fma_f32 v[212:213], v[212:213], v[178:179], v[178:179]
    v_pk_fma_f32 v[214:215], v[214:215], v[178:179], v[178:179]
    v_rcp_f32 v212, v212
    v_rcp_f32 v213, v213
    v_rcp_f32 v214, v214
    v_rcp_f32 v215, v215
    v_pk_mul_f32 v[4:5], v[4:5], v[68:69]
    v_pk_mul_f32 v[6:7], v[6:7], v[70:71]
    v_pk_mul_f32 v[4:5], v[4:5], v[212:213]
    v_pk_mul_f32 v[6:7], v[6:7], v[214:215]
    v_cvt_pk_bf16_f32 v216, v4, v5
    v_cvt_pk_bf16_f32 v217, v6, v7
    v_pk_fma_f32 v[20:21], v[162:163], v[132:133], v[20:21]
    v_pk_fma_f32 v[22:23], v[162:163], v[134:135], v[22:23]
    v_pk_mul_f32 v[212:213], v[170:171], v[20:21]
    v_pk_mul_f32 v[214:215], v[170:171], v[22:23]
    v_exp_f32 v212, v212
    v_exp_f32 v213, v213
    v_exp_f32 v214, v214
    v_exp_f32 v215, v215
    v_pk_fma_f32 v[84:85], v[162:163], v[148:149], v[84:85]
    v_pk_fma_f32 v[86:87], v[162:163], v[150:151], v[86:87]
    v_pk_fma_f32 v[212:213], v[212:213], v[178:179], v[178:179]
    v_pk_fma_f32 v[214:215], v[214:215], v[178:179], v[178:179]
    v_rcp_f32 v212, v212
    v_rcp_f32 v213, v213
    v_rcp_f32 v214, v214
    v_rcp_f32 v215, v215
    v_pk_mul_f32 v[20:21], v[20:21], v[84:85]
    v_pk_mul_f32 v[22:23], v[22:23], v[86:87]
    v_pk_mul_f32 v[20:21], v[20:21], v[212:213]
    v_pk_mul_f32 v[22:23], v[22:23], v[214:215]
    v_cvt_pk_bf16_f32 v218, v20, v21
    v_cvt_pk_bf16_f32 v219, v22, v23
    buffer_store_dwordx4 v[216:219], v249, s[80:83], s25 offen offset:1024
    ds_write_b128 v232, v[216:219] offset:1024
    v_pk_fma_f32 v[36:37], v[162:163], v[136:137], v[36:37]
    v_pk_fma_f32 v[38:39], v[162:163], v[138:139], v[38:39]
    v_pk_mul_f32 v[212:213], v[170:171], v[36:37]
    v_pk_mul_f32 v[214:215], v[170:171], v[38:39]
    v_exp_f32 v212, v212
    v_exp_f32 v213, v213
    v_exp_f32 v214, v214
    v_exp_f32 v215, v215
    v_pk_fma_f32 v[100:101], v[162:163], v[152:153], v[100:101]
    v_pk_fma_f32 v[102:103], v[162:163], v[154:155], v[102:103]
    v_pk_fma_f32 v[212:213], v[212:213], v[178:179], v[178:179]
    v_pk_fma_f32 v[214:215], v[214:215], v[178:179], v[178:179]
    v_rcp_f32 v212, v212
    v_rcp_f32 v213, v213
    v_rcp_f32 v214, v214
    v_rcp_f32 v215, v215
    v_pk_mul_f32 v[36:37], v[36:37], v[100:101]
    v_pk_mul_f32 v[38:39], v[38:39], v[102:103]
    v_pk_mul_f32 v[36:37], v[36:37], v[212:213]
    v_pk_mul_f32 v[38:39], v[38:39], v[214:215]
    v_cvt_pk_bf16_f32 v220, v36, v37
    v_cvt_pk_bf16_f32 v221, v38, v39
    v_pk_fma_f32 v[52:53], v[162:163], v[140:141], v[52:53]
    v_pk_fma_f32 v[54:55], v[162:163], v[142:143], v[54:55]
    v_pk_mul_f32 v[212:213], v[170:171], v[52:53]
    v_pk_mul_f32 v[214:215], v[170:171], v[54:55]
    v_exp_f32 v212, v212
    v_exp_f32 v213, v213
    v_exp_f32 v214, v214
    v_exp_f32 v215, v215
    v_pk_fma_f32 v[116:117], v[162:163], v[156:157], v[116:117]
    v_pk_fma_f32 v[118:119], v[162:163], v[158:159], v[118:119]
    v_pk_fma_f32 v[212:213], v[212:213], v[178:179], v[178:179]
    v_pk_fma_f32 v[214:215], v[214:215], v[178:179], v[178:179]
    v_rcp_f32 v212, v212
    v_rcp_f32 v213, v213
    v_rcp_f32 v214, v214
    v_rcp_f32 v215, v215
    v_pk_mul_f32 v[52:53], v[52:53], v[116:117]
    v_pk_mul_f32 v[54:55], v[54:55], v[118:119]
    v_pk_mul_f32 v[52:53], v[52:53], v[212:213]
    v_pk_mul_f32 v[54:55], v[54:55], v[214:215]
    v_cvt_pk_bf16_f32 v222, v52, v53
    v_cvt_pk_bf16_f32 v223, v54, v55
    buffer_store_dwordx4 v[220:223], v249, s[80:83], s26 offen offset:1024
    ds_write_b128 v233, v[220:223] offset:1024
    v_pk_fma_f32 v[8:9], v[164:165], v[128:129], v[8:9]
    v_pk_fma_f32 v[10:11], v[164:165], v[130:131], v[10:11]
    v_pk_mul_f32 v[212:213], v[172:173], v[8:9]
    v_pk_mul_f32 v[214:215], v[172:173], v[10:11]
    v_exp_f32 v212, v212
    v_exp_f32 v213, v213
    v_exp_f32 v214, v214
    v_exp_f32 v215, v215
    v_pk_fma_f32 v[72:73], v[164:165], v[144:145], v[72:73]
    v_pk_fma_f32 v[74:75], v[164:165], v[146:147], v[74:75]
    v_pk_fma_f32 v[212:213], v[212:213], v[180:181], v[180:181]
    v_pk_fma_f32 v[214:215], v[214:215], v[180:181], v[180:181]
    v_rcp_f32 v212, v212
    v_rcp_f32 v213, v213
    v_rcp_f32 v214, v214
    v_rcp_f32 v215, v215
    v_pk_mul_f32 v[8:9], v[8:9], v[72:73]
    v_pk_mul_f32 v[10:11], v[10:11], v[74:75]
    v_pk_mul_f32 v[8:9], v[8:9], v[212:213]
    v_pk_mul_f32 v[10:11], v[10:11], v[214:215]
    v_cvt_pk_bf16_f32 v216, v8, v9
    v_cvt_pk_bf16_f32 v217, v10, v11
    v_pk_fma_f32 v[24:25], v[164:165], v[132:133], v[24:25]
    v_pk_fma_f32 v[26:27], v[164:165], v[134:135], v[26:27]
    v_pk_mul_f32 v[212:213], v[172:173], v[24:25]
    v_pk_mul_f32 v[214:215], v[172:173], v[26:27]
    v_exp_f32 v212, v212
    v_exp_f32 v213, v213
    v_exp_f32 v214, v214
    v_exp_f32 v215, v215
    v_pk_fma_f32 v[88:89], v[164:165], v[148:149], v[88:89]
    v_pk_fma_f32 v[90:91], v[164:165], v[150:151], v[90:91]
    v_pk_fma_f32 v[212:213], v[212:213], v[180:181], v[180:181]
    v_pk_fma_f32 v[214:215], v[214:215], v[180:181], v[180:181]
    v_rcp_f32 v212, v212
    v_rcp_f32 v213, v213
    v_rcp_f32 v214, v214
    v_rcp_f32 v215, v215
    v_pk_mul_f32 v[24:25], v[24:25], v[88:89]
    v_pk_mul_f32 v[26:27], v[26:27], v[90:91]
    v_pk_mul_f32 v[24:25], v[24:25], v[212:213]
    v_pk_mul_f32 v[26:27], v[26:27], v[214:215]
    v_cvt_pk_bf16_f32 v218, v24, v25
    v_cvt_pk_bf16_f32 v219, v26, v27
    buffer_store_dwordx4 v[216:219], v249, s[80:83], s25 offen offset:2048
    ds_write_b128 v232, v[216:219] offset:2048
    v_pk_fma_f32 v[40:41], v[164:165], v[136:137], v[40:41]
    v_pk_fma_f32 v[42:43], v[164:165], v[138:139], v[42:43]
    v_pk_mul_f32 v[212:213], v[172:173], v[40:41]
    v_pk_mul_f32 v[214:215], v[172:173], v[42:43]
    v_exp_f32 v212, v212
    v_exp_f32 v213, v213
    v_exp_f32 v214, v214
    v_exp_f32 v215, v215
    v_pk_fma_f32 v[104:105], v[164:165], v[152:153], v[104:105]
    v_pk_fma_f32 v[106:107], v[164:165], v[154:155], v[106:107]
    v_pk_fma_f32 v[212:213], v[212:213], v[180:181], v[180:181]
    v_pk_fma_f32 v[214:215], v[214:215], v[180:181], v[180:181]
    v_rcp_f32 v212, v212
    v_rcp_f32 v213, v213
    v_rcp_f32 v214, v214
    v_rcp_f32 v215, v215
    v_pk_mul_f32 v[40:41], v[40:41], v[104:105]
    v_pk_mul_f32 v[42:43], v[42:43], v[106:107]
    v_pk_mul_f32 v[40:41], v[40:41], v[212:213]
    v_pk_mul_f32 v[42:43], v[42:43], v[214:215]
    v_cvt_pk_bf16_f32 v220, v40, v41
    v_cvt_pk_bf16_f32 v221, v42, v43
    v_pk_fma_f32 v[56:57], v[164:165], v[140:141], v[56:57]
    v_pk_fma_f32 v[58:59], v[164:165], v[142:143], v[58:59]
    v_pk_mul_f32 v[212:213], v[172:173], v[56:57]
    v_pk_mul_f32 v[214:215], v[172:173], v[58:59]
    v_exp_f32 v212, v212
    v_exp_f32 v213, v213
    v_exp_f32 v214, v214
    v_exp_f32 v215, v215
    v_pk_fma_f32 v[120:121], v[164:165], v[156:157], v[120:121]
    v_pk_fma_f32 v[122:123], v[164:165], v[158:159], v[122:123]
    v_pk_fma_f32 v[212:213], v[212:213], v[180:181], v[180:181]
    v_pk_fma_f32 v[214:215], v[214:215], v[180:181], v[180:181]
    v_rcp_f32 v212, v212
    v_rcp_f32 v213, v213
    v_rcp_f32 v214, v214
    v_rcp_f32 v215, v215
    v_pk_mul_f32 v[56:57], v[56:57], v[120:121]
    v_pk_mul_f32 v[58:59], v[58:59], v[122:123]
    v_pk_mul_f32 v[56:57], v[56:57], v[212:213]
    v_pk_mul_f32 v[58:59], v[58:59], v[214:215]
    v_cvt_pk_bf16_f32 v222, v56, v57
    v_cvt_pk_bf16_f32 v223, v58, v59
    buffer_store_dwordx4 v[220:223], v249, s[80:83], s26 offen offset:2048
    ds_write_b128 v233, v[220:223] offset:2048
    v_pk_fma_f32 v[12:13], v[166:167], v[128:129], v[12:13]
    v_pk_fma_f32 v[14:15], v[166:167], v[130:131], v[14:15]
    v_pk_mul_f32 v[212:213], v[174:175], v[12:13]
    v_pk_mul_f32 v[214:215], v[174:175], v[14:15]
    v_exp_f32 v212, v212
    v_exp_f32 v213, v213
    v_exp_f32 v214, v214
    v_exp_f32 v215, v215
    v_pk_fma_f32 v[76:77], v[166:167], v[144:145], v[76:77]
    v_pk_fma_f32 v[78:79], v[166:167], v[146:147], v[78:79]
    v_pk_fma_f32 v[212:213], v[212:213], v[182:183], v[182:183]
    v_pk_fma_f32 v[214:215], v[214:215], v[182:183], v[182:183]
    v_rcp_f32 v212, v212
    v_rcp_f32 v213, v213
    v_rcp_f32 v214, v214
    v_rcp_f32 v215, v215
    v_pk_mul_f32 v[12:13], v[12:13], v[76:77]
    v_pk_mul_f32 v[14:15], v[14:15], v[78:79]
    v_pk_mul_f32 v[12:13], v[12:13], v[212:213]
    v_pk_mul_f32 v[14:15], v[14:15], v[214:215]
    v_cvt_pk_bf16_f32 v216, v12, v13
    v_cvt_pk_bf16_f32 v217, v14, v15
    v_pk_fma_f32 v[28:29], v[166:167], v[132:133], v[28:29]
    v_pk_fma_f32 v[30:31], v[166:167], v[134:135], v[30:31]
    v_pk_mul_f32 v[212:213], v[174:175], v[28:29]
    v_pk_mul_f32 v[214:215], v[174:175], v[30:31]
    v_exp_f32 v212, v212
    v_exp_f32 v213, v213
    v_exp_f32 v214, v214
    v_exp_f32 v215, v215
    v_pk_fma_f32 v[92:93], v[166:167], v[148:149], v[92:93]
    v_pk_fma_f32 v[94:95], v[166:167], v[150:151], v[94:95]
    v_pk_fma_f32 v[212:213], v[212:213], v[182:183], v[182:183]
    v_pk_fma_f32 v[214:215], v[214:215], v[182:183], v[182:183]
    v_rcp_f32 v212, v212
    v_rcp_f32 v213, v213
    v_rcp_f32 v214, v214
    v_rcp_f32 v215, v215
    v_pk_mul_f32 v[28:29], v[28:29], v[92:93]
    v_pk_mul_f32 v[30:31], v[30:31], v[94:95]
    v_pk_mul_f32 v[28:29], v[28:29], v[212:213]
    v_pk_mul_f32 v[30:31], v[30:31], v[214:215]
    v_cvt_pk_bf16_f32 v218, v28, v29
    v_cvt_pk_bf16_f32 v219, v30, v31
    buffer_store_dwordx4 v[216:219], v249, s[80:83], s25 offen offset:3072
    ds_write_b128 v232, v[216:219] offset:3072
    v_pk_fma_f32 v[44:45], v[166:167], v[136:137], v[44:45]
    v_pk_fma_f32 v[46:47], v[166:167], v[138:139], v[46:47]
    v_pk_mul_f32 v[212:213], v[174:175], v[44:45]
    v_pk_mul_f32 v[214:215], v[174:175], v[46:47]
    v_exp_f32 v212, v212
    v_exp_f32 v213, v213
    v_exp_f32 v214, v214
    v_exp_f32 v215, v215
    v_pk_fma_f32 v[108:109], v[166:167], v[152:153], v[108:109]
    v_pk_fma_f32 v[110:111], v[166:167], v[154:155], v[110:111]
    v_pk_fma_f32 v[212:213], v[212:213], v[182:183], v[182:183]
    v_pk_fma_f32 v[214:215], v[214:215], v[182:183], v[182:183]
    v_rcp_f32 v212, v212
    v_rcp_f32 v213, v213
    v_rcp_f32 v214, v214
    v_rcp_f32 v215, v215
    v_pk_mul_f32 v[44:45], v[44:45], v[108:109]
    v_pk_mul_f32 v[46:47], v[46:47], v[110:111]
    v_pk_mul_f32 v[44:45], v[44:45], v[212:213]
    v_pk_mul_f32 v[46:47], v[46:47], v[214:215]
    v_cvt_pk_bf16_f32 v220, v44, v45
    v_cvt_pk_bf16_f32 v221, v46, v47
    v_pk_fma_f32 v[60:61], v[166:167], v[140:141], v[60:61]
    v_pk_fma_f32 v[62:63], v[166:167], v[142:143], v[62:63]
    v_pk_mul_f32 v[212:213], v[174:175], v[60:61]
    v_pk_mul_f32 v[214:215], v[174:175], v[62:63]
    v_exp_f32 v212, v212
    v_exp_f32 v213, v213
    v_exp_f32 v214, v214
    v_exp_f32 v215, v215
    v_pk_fma_f32 v[124:125], v[166:167], v[156:157], v[124:125]
    v_pk_fma_f32 v[126:127], v[166:167], v[158:159], v[126:127]
    v_pk_fma_f32 v[212:213], v[212:213], v[182:183], v[182:183]
    v_pk_fma_f32 v[214:215], v[214:215], v[182:183], v[182:183]
    v_rcp_f32 v212, v212
    v_rcp_f32 v213, v213
    v_rcp_f32 v214, v214
    v_rcp_f32 v215, v215
    v_pk_mul_f32 v[60:61], v[60:61], v[124:125]
    v_pk_mul_f32 v[62:63], v[62:63], v[126:127]
    v_pk_mul_f32 v[60:61], v[60:61], v[212:213]
    v_pk_mul_f32 v[62:63], v[62:63], v[214:215]
    v_cvt_pk_bf16_f32 v222, v60, v61
    v_cvt_pk_bf16_f32 v223, v62, v63
    buffer_store_dwordx4 v[220:223], v249, s[80:83], s26 offen offset:3072
    ds_write_b128 v233, v[220:223] offset:3072
    s_lshr_b32 s64, s3, 1
    s_lshl_b32 s64, s64, 11
    s_add_u32 s64, s64, 49152
    v_add_u32 v240, s64, v249
    v_lshrrev_b32 v253, 2, v252
    v_and_b32 v254, 1, v251
    v_lshl_add_u32 v253, v254, 2, v253
    v_mul_u32_u24 v253, 1056, v253
    v_lshrrev_b32 v254, 1, v251
    v_lshl_add_u32 v253, v254, 8, v253
    v_and_b32 v254, 3, v252
    v_lshl_add_u32 v253, v254, 3, v253
    s_and_b32 s64, s3, 1
    s_lshl_b32 s64, s64, 7
    s_add_u32 s64, s64, 65536
    v_add_u32 v241, s64, v253
    s_mov_b32 s16, 33792
    v_add_u32 v242, s16, v241
    s_and_b32 s25, s3, 1
    s_lshl_b32 s25, s25, 3
    s_add_u32 s25, s25, s61
    s_lshl_b32 s18, s73, 4
    s_add_u32 s18, s18, s25
    s_lshl_b32 s18, s18, 2
    s_add_u32 s18, s18, s68
    s_lshl_b32 s18, s18, 12
    s_lshr_b32 s64, s3, 1
    s_lshl_b32 s64, s64, 11
    s_add_u32 s18, s18, s64
    s_mov_b32 s20, s18
    s_add_u32 s20, s20, 4194304
    s_lshl_b32 s66, s75, 23
    s_add_u32 s18, s18, s66
    s_add_u32 s19, s18, 8192
    s_add_u32 s21, s20, 8192
    buffer_load_dwordx4 v[128:131], v249, s[80:83], s18 offen offset:0 sc1
    buffer_load_dwordx4 v[132:135], v249, s[80:83], s19 offen offset:0 sc1
    buffer_load_dwordx4 v[136:139], v249, s[80:83], s18 offen offset:1024 sc1
    buffer_load_dwordx4 v[140:143], v249, s[80:83], s19 offen offset:1024 sc1
    s_lshl_b32 s24, s73, 4
    s_add_u32 s24, s24, s25
    s_lshl_b32 s24, s24, 11
    s_add_u32 s24, s24, 71827456
    s_lshl_b32 s65, s68, 9
    s_add_u32 s24, s24, s65
    s_lshr_b32 s65, s3, 1
    s_lshl_b32 s65, s65, 8
    s_add_u32 s24, s24, s65
    v_lshrrev_b32 v253, 1, v251
    v_lshl_add_u32 v253, v253, 4, v252
    v_lshlrev_b32 v253, 3, v253
    v_and_b32 v254, 1, v251
    v_lshl_add_u32 v239, v254, 10, v253
    s_lshl_b32 s23, s75, 8
    s_add_u32 s23, s23, s2
    s_lshl_b32 s23, s23, 2
    s_add_u32 s23, s23, s3
    s_lshl_b32 s22, s23, 13
    s_add_u32 s22, s22, 54525952
    s_lshl_b32 s23, s23, 7
    s_add_u32 s23, s23, 75759616
    v_mov_b32 v208, 0
    v_mov_b32 v209, 0
    v_mov_b32 v210, 0
    v_mov_b32 v211, 0
    s_nop 1
    v_mfma_f32_32x32x16_bf16 v[0:15], v[208:211], v[208:211], 0
    v_mfma_f32_32x32x16_bf16 v[16:31], v[208:211], v[208:211], 0
    v_mfma_f32_32x32x16_bf16 v[32:47], v[208:211], v[208:211], 0
    v_mfma_f32_32x32x16_bf16 v[48:63], v[208:211], v[208:211], 0
    s_mov_b32 s17, 14
    s_lshl_b32 s64, s75, 15
    s_lshl_b32 s66, s73, 9
    s_add_u32 s64, s64, s66
    s_add_u32 s64, s64, 75513856
    s_lshl_b32 s65, s72, 5
    s_add_u32 s64, s64, s65
    s_lshl_b32 s65, s3, 2
    s_add_u32 s64, s64, s65
    v_mov_b32 v236, 0
    v_mov_b32 v237, 1
    s_cmp_lg_u32 s78, 0
    s_cbranch_scc1 sg_7_slow
    s_waitcnt vmcnt(4)
    s_mov_b64 exec, 1
    buffer_store_dword v237, v236, s[80:83], s64 offen
    s_mov_b64 exec, -1
sg_7_done:
    s_waitcnt lgkmcnt(0)
    s_barrier
    ds_read_b128 v[72:75], v240 offset:12288
    ds_read_b64_tr_b16 v[80:81], v242 offset:8448
    ds_read_b64_tr_b16 v[82:83], v242 offset:8960
    ds_read_b128 v[76:79], v240 offset:13312
    ds_read_b64_tr_b16 v[84:85], v242 offset:8480
    ds_read_b64_tr_b16 v[86:87], v242 offset:8992
    ds_read_b128 v[64:67], v240 offset:8192
    ds_read_b64_tr_b16 v[88:89], v242 offset:8512
    ds_read_b64_tr_b16 v[90:91], v242 offset:9024
    ds_read_b128 v[68:71], v240 offset:9216
    ds_read_b64_tr_b16 v[92:93], v242 offset:8544
    ds_read_b64_tr_b16 v[94:95], v242 offset:9056
    v_add_u16 v240, 0x4000, v240
    s_add_u32 s16, s16, 16896
    s_cmp_eq_u32 s16, 84480
    s_cselect_b32 s16, 0, s16
    v_add_u32 v242, s16, v241
    s_waitcnt lgkmcnt(0)
r3_loop:
    s_bitcmp1_b32 24576, s17
    s_cbranch_scc1 r3_nb0
    s_barrier
r3_nb0:
    v_mfma_f32_16x16x32_bf16 v[32:35], v[80:83], v[72:75], v[32:35]
    ds_read_b128 v[104:107], v240 offset:4096
    ds_read_b64_tr_b16 v[112:113], v242 offset:0
    v_mfma_f32_16x16x32_bf16 v[36:39], v[84:87], v[72:75], v[36:39]
    ds_read_b64_tr_b16 v[114:115], v242 offset:512
    v_mfma_f32_16x16x32_bf16 v[40:43], v[88:91], v[72:75], v[40:43]
    ds_read_b128 v[108:111], v240 offset:5120
    v_mfma_f32_16x16x32_bf16 v[44:47], v[92:95], v[72:75], v[44:47]
    ds_read_b64_tr_b16 v[116:117], v242 offset:32
    v_mfma_f32_16x16x32_bf16 v[48:51], v[80:83], v[76:79], v[48:51]
    ds_read_b64_tr_b16 v[118:119], v242 offset:544
    v_mfma_f32_16x16x32_bf16 v[52:55], v[84:87], v[76:79], v[52:55]
    ds_read_b128 v[96:99], v240 offset:0
    ds_read_b64_tr_b16 v[120:121], v242 offset:64
    v_mfma_f32_16x16x32_bf16 v[56:59], v[88:91], v[76:79], v[56:59]
    ds_read_b64_tr_b16 v[122:123], v242 offset:576
    v_mfma_f32_16x16x32_bf16 v[60:63], v[92:95], v[76:79], v[60:63]
    ds_read_b128 v[100:103], v240 offset:1024
    v_mfma_f32_16x16x32_bf16 v[0:3], v[80:83], v[64:67], v[0:3]
    ds_read_b64_tr_b16 v[124:125], v242 offset:96
    v_mfma_f32_16x16x32_bf16 v[4:7], v[84:87], v[64:67], v[4:7]
    ds_read_b64_tr_b16 v[126:127], v242 offset:608
    v_mfma_f32_16x16x32_bf16 v[8:11], v[88:91], v[64:67], v[8:11]
    v_mfma_f32_16x16x32_bf16 v[12:15], v[92:95], v[64:67], v[12:15]
    v_mfma_f32_16x16x32_bf16 v[16:19], v[80:83], v[68:71], v[16:19]
    v_mfma_f32_16x16x32_bf16 v[20:23], v[84:87], v[68:71], v[20:23]
    v_mfma_f32_16x16x32_bf16 v[24:27], v[88:91], v[68:71], v[24:27]
    v_mfma_f32_16x16x32_bf16 v[28:31], v[92:95], v[68:71], v[28:31]
    s_waitcnt lgkmcnt(0)
    v_mfma_f32_16x16x32_bf16 v[32:35], v[112:115], v[104:107], v[32:35]
    ds_read_b128 v[72:75], v240 offset:12288
    ds_read_b64_tr_b16 v[80:81], v242 offset:8448
    v_mfma_f32_16x16x32_bf16 v[36:39], v[116:119], v[104:107], v[36:39]
    ds_read_b64_tr_b16 v[82:83], v242 offset:8960
    v_mfma_f32_16x16x32_bf16 v[40:43], v[120:123], v[104:107], v[40:43]
    ds_read_b128 v[76:79], v240 offset:13312
    v_mfma_f32_16x16x32_bf16 v[44:47], v[124:127], v[104:107], v[44:47]
    ds_read_b64_tr_b16 v[84:85], v242 offset:8480
    v_mfma_f32_16x16x32_bf16 v[48:51], v[112:115], v[108:111], v[48:51]
    ds_read_b64_tr_b16 v[86:87], v242 offset:8992
    v_mfma_f32_16x16x32_bf16 v[52:55], v[116:119], v[108:111], v[52:55]
    ds_read_b128 v[64:67], v240 offset:8192
    ds_read_b64_tr_b16 v[88:89], v242 offset:8512
    v_mfma_f32_16x16x32_bf16 v[56:59], v[120:123], v[108:111], v[56:59]
    ds_read_b64_tr_b16 v[90:91], v242 offset:9024
    v_mfma_f32_16x16x32_bf16 v[60:63], v[124:127], v[108:111], v[60:63]
    ds_read_b128 v[68:71], v240 offset:9216
    v_mfma_f32_16x16x32_bf16 v[0:3], v[112:115], v[96:99], v[0:3]
    ds_read_b64_tr_b16 v[92:93], v242 offset:8544
    v_mfma_f32_16x16x32_bf16 v[4:7], v[116:119], v[96:99], v[4:7]
    ds_read_b64_tr_b16 v[94:95], v242 offset:9056
    v_mfma_f32_16x16x32_bf16 v[8:11], v[120:123], v[96:99], v[8:11]
    v_add_u16 v240, 0x4000, v240
    v_mfma_f32_16x16x32_bf16 v[12:15], v[124:127], v[96:99], v[12:15]
    s_add_u32 s16, s16, 16896
    s_cmp_eq_u32 s16, 84480
    v_mfma_f32_16x16x32_bf16 v[16:19], v[112:115], v[100:103], v[16:19]
    s_cselect_b32 s16, 0, s16
    v_mfma_f32_16x16x32_bf16 v[20:23], v[116:119], v[100:103], v[20:23]
    v_add_u32 v242, s16, v241
    v_mfma_f32_16x16x32_bf16 v[24:27], v[120:123], v[100:103], v[24:27]
    v_mfma_f32_16x16x32_bf16 v[28:31], v[124:127], v[100:103], v[28:31]
    s_waitcnt lgkmcnt(0)
    s_bitcmp1_b32 2, s17
    s_cbranch_scc1 r3_nb1
    s_barrier
r3_nb1:
    v_mfma_f32_16x16x32_bf16 v[32:35], v[80:83], v[72:75], v[32:35]
    ds_read_b128 v[104:107], v240 offset:4096
    ds_read_b64_tr_b16 v[112:113], v242 offset:0
    v_mfma_f32_16x16x32_bf16 v[36:39], v[84:87], v[72:75], v[36:39]
    ds_read_b64_tr_b16 v[114:115], v242 offset:512
    v_mfma_f32_16x16x32_bf16 v[40:43], v[88:91], v[72:75], v[40:43]
    ds_read_b128 v[108:111], v240 offset:5120
    v_mfma_f32_16x16x32_bf16 v[44:47], v[92:95], v[72:75], v[44:47]
    ds_read_b64_tr_b16 v[116:117], v242 offset:32
    v_mfma_f32_16x16x32_bf16 v[48:51], v[80:83], v[76:79], v[48:51]
    ds_read_b64_tr_b16 v[118:119], v242 offset:544
    v_mfma_f32_16x16x32_bf16 v[52:55], v[84:87], v[76:79], v[52:55]
    ds_read_b128 v[96:99], v240 offset:0
    ds_read_b64_tr_b16 v[120:121], v242 offset:64
    v_mfma_f32_16x16x32_bf16 v[56:59], v[88:91], v[76:79], v[56:59]
    ds_read_b64_tr_b16 v[122:123], v242 offset:576
    v_mfma_f32_16x16x32_bf16 v[60:63], v[92:95], v[76:79], v[60:63]
    ds_read_b128 v[100:103], v240 offset:1024
    v_mfma_f32_16x16x32_bf16 v[0:3], v[80:83], v[64:67], v[0:3]
    ds_read_b64_tr_b16 v[124:125], v242 offset:96
    v_mfma_f32_16x16x32_bf16 v[4:7], v[84:87], v[64:67], v[4:7]
    ds_read_b64_tr_b16 v[126:127], v242 offset:608
    v_mfma_f32_16x16x32_bf16 v[8:11], v[88:91], v[64:67], v[8:11]
    v_mfma_f32_16x16x32_bf16 v[12:15], v[92:95], v[64:67], v[12:15]
    v_mfma_f32_16x16x32_bf16 v[16:19], v[80:83], v[68:71], v[16:19]
    v_mfma_f32_16x16x32_bf16 v[20:23], v[84:87], v[68:71], v[20:23]
    v_mfma_f32_16x16x32_bf16 v[24:27], v[88:91], v[68:71], v[24:27]
    v_mfma_f32_16x16x32_bf16 v[28:31], v[92:95], v[68:71], v[28:31]
    s_waitcnt lgkmcnt(0)
    v_mfma_f32_16x16x32_bf16 v[32:35], v[112:115], v[104:107], v[32:35]
    ds_read_b128 v[72:75], v240 offset:12288
    ds_read_b64_tr_b16 v[80:81], v242 offset:8448
    v_mfma_f32_16x16x32_bf16 v[36:39], v[116:119], v[104:107], v[36:39]
    ds_read_b64_tr_b16 v[82:83], v242 offset:8960
    v_mfma_f32_16x16x32_bf16 v[40:43], v[120:123], v[104:107], v[40:43]
    ds_read_b128 v[76:79], v240 offset:13312
    v_mfma_f32_16x16x32_bf16 v[44:47], v[124:127], v[104:107], v[44:47]
    ds_read_b64_tr_b16 v[84:85], v242 offset:8480
    v_mfma_f32_16x16x32_bf16 v[48:51], v[112:115], v[108:111], v[48:51]
    ds_read_b64_tr_b16 v[86:87], v242 offset:8992
    v_mfma_f32_16x16x32_bf16 v[52:55], v[116:119], v[108:111], v[52:55]
    ds_read_b128 v[64:67], v240 offset:8192
    ds_read_b64_tr_b16 v[88:89], v242 offset:8512
    v_mfma_f32_16x16x32_bf16 v[56:59], v[120:123], v[108:111], v[56:59]
    ds_read_b64_tr_b16 v[90:91], v242 offset:9024
    v_mfma_f32_16x16x32_bf16 v[60:63], v[124:127], v[108:111], v[60:63]
    ds_read_b128 v[68:71], v240 offset:9216
    v_mfma_f32_16x16x32_bf16 v[0:3], v[112:115], v[96:99], v[0:3]
    ds_read_b64_tr_b16 v[92:93], v242 offset:8544
    v_mfma_f32_16x16x32_bf16 v[4:7], v[116:119], v[96:99], v[4:7]
    ds_read_b64_tr_b16 v[94:95], v242 offset:9056
    v_mfma_f32_16x16x32_bf16 v[8:11], v[120:123], v[96:99], v[8:11]
    v_add_u16 v240, 0x4000, v240
    v_mfma_f32_16x16x32_bf16 v[12:15], v[124:127], v[96:99], v[12:15]
    s_add_u32 s16, s16, 16896
    s_cmp_eq_u32 s16, 84480
    v_mfma_f32_16x16x32_bf16 v[16:19], v[112:115], v[100:103], v[16:19]
    s_cselect_b32 s16, 0, s16
    v_mfma_f32_16x16x32_bf16 v[20:23], v[116:119], v[100:103], v[20:23]
    v_add_u32 v242, s16, v241
    v_mfma_f32_16x16x32_bf16 v[24:27], v[120:123], v[100:103], v[24:27]
    s_sub_u32 s17, s17, 1
    s_cmp_lg_u32 s17, 0
    v_mfma_f32_16x16x32_bf16 v[28:31], v[124:127], v[100:103], v[28:31]
    s_waitcnt lgkmcnt(0)
    s_cbranch_scc1 r3_loop
    s_add_u32 s65, s22, 4096
    v_cvt_pk_bf16_f32 v32, v32, v33
    v_cvt_pk_bf16_f32 v33, v34, v35
    v_cvt_pk_bf16_f32 v34, v36, v37
    v_cvt_pk_bf16_f32 v35, v38, v39
    buffer_store_dwordx4 v[32:35], v249, s[80:83], s22 offen offset:0 sc0 sc1
    v_cvt_pk_bf16_f32 v40, v40, v41
    v_cvt_pk_bf16_f32 v41, v42, v43
    v_cvt_pk_bf16_f32 v42, v44, v45
    v_cvt_pk_bf16_f32 v43, v46, v47
    buffer_store_dwordx4 v[40:43], v249, s[80:83], s22 offen offset:1024 sc0 sc1
    v_cvt_pk_bf16_f32 v48, v48, v49
    v_cvt_pk_bf16_f32 v49, v50, v51
    v_cvt_pk_bf16_f32 v50, v52, v53
    v_cvt_pk_bf16_f32 v51, v54, v55
    buffer_store_dwordx4 v[48:51], v249, s[80:83], s22 offen offset:2048 sc0 sc1
    v_cvt_pk_bf16_f32 v56, v56, v57
    v_cvt_pk_bf16_f32 v57, v58, v59
    v_cvt_pk_bf16_f32 v58, v60, v61
    v_cvt_pk_bf16_f32 v59, v62, v63
    buffer_store_dwordx4 v[56:59], v249, s[80:83], s22 offen offset:3072 sc0 sc1
    s_barrier
    s_waitcnt vmcnt(4)
    v_lshlrev_b32 v144, 16, v128
    v_and_b32 v145, 0xffff0000, v128
    v_lshlrev_b32 v146, 16, v129
    v_and_b32 v147, 0xffff0000, v129
    v_lshlrev_b32 v148, 16, v130
    v_and_b32 v149, 0xffff0000, v130
    v_lshlrev_b32 v150, 16, v131
    v_and_b32 v151, 0xffff0000, v131
    v_lshlrev_b32 v152, 16, v132
    v_and_b32 v153, 0xffff0000, v132
    v_lshlrev_b32 v154, 16, v133
    v_and_b32 v155, 0xffff0000, v133
    v_lshlrev_b32 v156, 16, v134
    v_and_b32 v157, 0xffff0000, v134
    v_lshlrev_b32 v158, 16, v135
    v_and_b32 v159, 0xffff0000, v135
    v_lshlrev_b32 v160, 16, v136
    v_and_b32 v161, 0xffff0000, v136
    v_lshlrev_b32 v162, 16, v137
    v_and_b32 v163, 0xffff0000, v137
    v_lshlrev_b32 v164, 16, v138
    v_and_b32 v165, 0xffff0000, v138
    v_lshlrev_b32 v166, 16, v139
    v_and_b32 v167, 0xffff0000, v139
    v_lshlrev_b32 v168, 16, v140
    v_and_b32 v169, 0xffff0000, v140
    v_lshlrev_b32 v170, 16, v141
    v_and_b32 v171, 0xffff0000, v141
    v_lshlrev_b32 v172, 16, v142
    v_and_b32 v173, 0xffff0000, v142
    v_lshlrev_b32 v174, 16, v143
    v_and_b32 v175, 0xffff0000, v143
    v_mov_b32 v208, 0
    v_mov_b32 v209, 1
    s_waitcnt vmcnt(0)
    s_mov_b64 exec, 1
    buffer_store_dword v209, v208, s[80:83], s23 offen sc0 sc1
    s_mov_b64 exec, -1
    s_xor_b32 s23, s23, 512
    s_xor_b32 s22, s22, 32768
    s_mov_b64 exec, 1
pl_8:
    buffer_load_dword v210, v208, s[80:83], s23 offen sc1
    s_sub_u32 s79, s79, 1
    s_cbranch_scc1 L_abort
    s_waitcnt vmcnt(0)
    v_cmp_ne_u32 vcc, 1, v210
    s_cbranch_vccnz pl_8
    s_mov_b64 exec, -1
    s_add_u32 s65, s22, 4096
    buffer_load_dwordx4 v[32:35], v249, s[80:83], s22 offen offset:0 sc1
    buffer_load_dwordx4 v[36:39], v249, s[80:83], s22 offen offset:1024 sc1
    buffer_load_dwordx4 v[40:43], v249, s[80:83], s22 offen offset:2048 sc1
    buffer_load_dwordx4 v[44:47], v249, s[80:83], s22 offen offset:3072 sc1
    v_mov_b32 v88, 0x3f803f80
    s_cmp_lg_u32 s75, 0
    s_cbranch_scc1 fo_9_out
    s_waitcnt vmcnt(3)
    v_lshlrev_b32 v176, 16, v32
    v_and_b32 v177, 0xffff0000, v32
    v_lshlrev_b32 v178, 16, v33
    v_and_b32 v179, 0xffff0000, v33
    v_lshlrev_b32 v180, 16, v34
    v_and_b32 v181, 0xffff0000, v34
    v_lshlrev_b32 v182, 16, v35
    v_and_b32 v183, 0xffff0000, v35
    v_pk_add_f32 v[0:1], v[0:1], v[176:177]
    v_pk_add_f32 v[2:3], v[2:3], v[178:179]
    v_pk_add_f32 v[4:5], v[4:5], v[180:181]
    v_pk_add_f32 v[6:7], v[6:7], v[182:183]
    v_cvt_pk_bf16_f32 v208, v0, v1
    v_cvt_pk_bf16_f32 v209, v2, v3
    v_cvt_pk_bf16_f32 v210, v4, v5
    v_cvt_pk_bf16_f32 v211, v6, v7
    v_lshlrev_b32 v212, 16, v208
    v_and_b32 v213, 0xffff0000, v208
    v_lshlrev_b32 v214, 16, v209
    v_and_b32 v215, 0xffff0000, v209
    v_lshlrev_b32 v216, 16, v210
    v_and_b32 v217, 0xffff0000, v210
    v_lshlrev_b32 v218, 16, v211
    v_and_b32 v219, 0xffff0000, v211
    v_pk_add_f32 v[212:213], v[212:213], v[144:145]
    v_pk_add_f32 v[214:215], v[214:215], v[146:147]
    v_pk_add_f32 v[216:217], v[216:217], v[148:149]
    v_pk_add_f32 v[218:219], v[218:219], v[150:151]
    v_cvt_pk_bf16_f32 v64, v212, v213
    v_cvt_pk_bf16_f32 v65, v214, v215
    v_cvt_pk_bf16_f32 v66, v216, v217
    v_cvt_pk_bf16_f32 v67, v218, v219
    buffer_store_dwordx4 v[64:67], v249, s[80:83], s20 offen offset:0 sc0 sc1
    s_waitcnt vmcnt(3)
    v_lshlrev_b32 v184, 16, v36
    v_and_b32 v185, 0xffff0000, v36
    v_lshlrev_b32 v186, 16, v37
    v_and_b32 v187, 0xffff0000, v37
    v_lshlrev_b32 v188, 16, v38
    v_and_b32 v189, 0xffff0000, v38
    v_lshlrev_b32 v190, 16, v39
    v_and_b32 v191, 0xffff0000, v39
    v_pk_add_f32 v[8:9], v[8:9], v[184:185]
    v_pk_add_f32 v[10:11], v[10:11], v[186:187]
    v_pk_add_f32 v[12:13], v[12:13], v[188:189]
    v_pk_add_f32 v[14:15], v[14:15], v[190:191]
    v_cvt_pk_bf16_f32 v208, v8, v9
    v_cvt_pk_bf16_f32 v209, v10, v11
    v_cvt_pk_bf16_f32 v210, v12, v13
    v_cvt_pk_bf16_f32 v211, v14, v15
    v_lshlrev_b32 v212, 16, v208
    v_and_b32 v213, 0xffff0000, v208
    v_lshlrev_b32 v214, 16, v209
    v_and_b32 v215, 0xffff0000, v209
    v_lshlrev_b32 v216, 16, v210
    v_and_b32 v217, 0xffff0000, v210
    v_lshlrev_b32 v218, 16, v211
    v_and_b32 v219, 0xffff0000, v211
    v_pk_add_f32 v[212:213], v[212:213], v[152:153]
    v_pk_add_f32 v[214:215], v[214:215], v[154:155]
    v_pk_add_f32 v[216:217], v[216:217], v[156:157]
    v_pk_add_f32 v[218:219], v[218:219], v[158:159]
    v_cvt_pk_bf16_f32 v68, v212, v213
    v_cvt_pk_bf16_f32 v69, v214, v215
    v_cvt_pk_bf16_f32 v70, v216, v217
    v_cvt_pk_bf16_f32 v71, v218, v219
    buffer_store_dwordx4 v[68:71], v249, s[80:83], s21 offen offset:0 sc0 sc1
    s_waitcnt vmcnt(3)
    v_lshlrev_b32 v192, 16, v40
    v_and_b32 v193, 0xffff0000, v40
    v_lshlrev_b32 v194, 16, v41
    v_and_b32 v195, 0xffff0000, v41
    v_lshlrev_b32 v196, 16, v42
    v_and_b32 v197, 0xffff0000, v42
    v_lshlrev_b32 v198, 16, v43
    v_and_b32 v199, 0xffff0000, v43
    v_pk_add_f32 v[16:17], v[16:17], v[192:193]
    v_pk_add_f32 v[18:19], v[18:19], v[194:195]
    v_pk_add_f32 v[20:21], v[20:21], v[196:197]
    v_pk_add_f32 v[22:23], v[22:23], v[198:199]
    v_cvt_pk_bf16_f32 v208, v16, v17
    v_cvt_pk_bf16_f32 v209, v18, v19
    v_cvt_pk_bf16_f32 v210, v20, v21
    v_cvt_pk_bf16_f32 v211, v22, v23
    v_lshlrev_b32 v212, 16, v208
    v_and_b32 v213, 0xffff0000, v208
    v_lshlrev_b32 v214, 16, v209
    v_and_b32 v215, 0xffff0000, v209
    v_lshlrev_b32 v216, 16, v210
    v_and_b32 v217, 0xffff0000, v210
    v_lshlrev_b32 v218, 16, v211
    v_and_b32 v219, 0xffff0000, v211
    v_pk_add_f32 v[212:213], v[212:213], v[160:161]
    v_pk_add_f32 v[214:215], v[214:215], v[162:163]
    v_pk_add_f32 v[216:217], v[216:217], v[164:165]
    v_pk_add_f32 v[218:219], v[218:219], v[166:167]
    v_cvt_pk_bf16_f32 v72, v212, v213
    v_cvt_pk_bf16_f32 v73, v214, v215
    v_cvt_pk_bf16_f32 v74, v216, v217
    v_cvt_pk_bf16_f32 v75, v218, v219
    buffer_store_dwordx4 v[72:75], v249, s[80:83], s20 offen offset:1024 sc0 sc1
    s_waitcnt vmcnt(3)
    v_lshlrev_b32 v200, 16, v44
    v_and_b32 v201, 0xffff0000, v44
    v_lshlrev_b32 v202, 16, v45
    v_and_b32 v203, 0xffff0000, v45
    v_lshlrev_b32 v204, 16, v46
    v_and_b32 v205, 0xffff0000, v46
    v_lshlrev_b32 v206, 16, v47
    v_and_b32 v207, 0xffff0000, v47
    v_pk_add_f32 v[24:25], v[24:25], v[200:201]
    v_pk_add_f32 v[26:27], v[26:27], v[202:203]
    v_pk_add_f32 v[28:29], v[28:29], v[204:205]
    v_pk_add_f32 v[30:31], v[30:31], v[206:207]
    v_cvt_pk_bf16_f32 v208, v24, v25
    v_cvt_pk_bf16_f32 v209, v26, v27
    v_cvt_pk_bf16_f32 v210, v28, v29
    v_cvt_pk_bf16_f32 v211, v30, v31
    v_lshlrev_b32 v212, 16, v208
    v_and_b32 v213, 0xffff0000, v208
    v_lshlrev_b32 v214, 16, v209
    v_and_b32 v215, 0xffff0000, v209
    v_lshlrev_b32 v216, 16, v210
    v_and_b32 v217, 0xffff0000, v210
    v_lshlrev_b32 v218, 16, v211
    v_and_b32 v219, 0xffff0000, v211
    v_pk_add_f32 v[212:213], v[212:213], v[168:169]
    v_pk_add_f32 v[214:215], v[214:215], v[170:171]
    v_pk_add_f32 v[216:217], v[216:217], v[172:173]
    v_pk_add_f32 v[218:219], v[218:219], v[174:175]
    v_cvt_pk_bf16_f32 v76, v212, v213
    v_cvt_pk_bf16_f32 v77, v214, v215
    v_cvt_pk_bf16_f32 v78, v216, v217
    v_cvt_pk_bf16_f32 v79, v218, v219
    buffer_store_dwordx4 v[76:79], v249, s[80:83], s21 offen offset:1024 sc0 sc1
    s_lshr_b32 s64, s3, 1
    s_and_b32 s64, s64, s68
    s_cbranch_scc0 hl_10
    v_cmp_eq_u32 vcc, 0, v252
    s_lshl_b32 s64, s73, 4
    s_add_u32 s64, s64, s25
    s_lshl_b32 s64, s64, 11
    s_add_u32 s64, s64, 73400320
    v_cndmask_b32 v212, v72, v88, vcc
    v_cndmask_b32 v213, v73, v88, vcc
    v_cndmask_b32 v214, v74, v88, vcc
    v_cndmask_b32 v215, v75, v88, vcc
    v_cndmask_b32 v216, v76, v88, vcc
    v_cndmask_b32 v217, v77, v88, vcc
    v_cndmask_b32 v218, v78, v88, vcc
    v_cndmask_b32 v219, v79, v88, vcc
    buffer_store_dwordx4 v[212:215], v249, s[80:83], s64 offen offset:0 sc0 sc1
    buffer_store_dwordx4 v[216:219], v249, s[80:83], s64 offen offset:1024 sc0 sc1
hl_10:
    v_dot2_f32_bf16 v80, v64, v88, 0
    v_dot2_f32_bf16 v84, v64, v64, 0
    v_dot2_f32_bf16 v80, v65, v88, v80
    v_dot2_f32_bf16 v84, v65, v65, v84
    v_dot2_f32_bf16 v80, v66, v88, v80
    v_dot2_f32_bf16 v84, v66, v66, v84
    v_dot2_f32_bf16 v80, v67, v88, v80
    v_dot2_f32_bf16 v84, v67, v67, v84
    v_dot2_f32_bf16 v81, v68, v88, 0
    v_dot2_f32_bf16 v85, v68, v68, 0
    v_dot2_f32_bf16 v81, v69, v88, v81
    v_dot2_f32_bf16 v85, v69, v69, v85
    v_dot2_f32_bf16 v81, v70, v88, v81
    v_dot2_f32_bf16 v85, v70, v70, v85
    v_dot2_f32_bf16 v81, v71, v88, v81
    v_dot2_f32_bf16 v85, v71, v71, v85
    v_dot2_f32_bf16 v82, v72, v88, 0
    v_dot2_f32_bf16 v86, v72, v72, 0
    v_dot2_f32_bf16 v82, v73, v88, v82
    v_dot2_f32_bf16 v86, v73, v73, v86
    v_dot2_f32_bf16 v82, v74, v88, v82
    v_dot2_f32_bf16 v86, v74, v74, v86
    v_dot2_f32_bf16 v82, v75, v88, v82
    v_dot2_f32_bf16 v86, v75, v75, v86
    v_dot2_f32_bf16 v83, v76, v88, 0
    v_dot2_f32_bf16 v87, v76, v76, 0
    v_dot2_f32_bf16 v83, v77, v88, v83
    v_dot2_f32_bf16 v87, v77, v77, v87
    v_dot2_f32_bf16 v83, v78, v88, v83
    v_dot2_f32_bf16 v87, v78, v78, v87
    v_dot2_f32_bf16 v83, v79, v88, v83
    v_dot2_f32_bf16 v87, v79, v79, v87
    s_nop 2
    v_permlane16_swap_b32 v80, v81
    v_permlane16_swap_b32 v82, v83
    v_permlane16_swap_b32 v84, v85
    v_permlane16_swap_b32 v86, v87
    v_add_f32 v80, v80, v81
    v_add_f32 v82, v82, v83
    v_add_f32 v84, v84, v85
    v_add_f32 v86, v86, v87
    s_nop 1
    v_permlane32_swap_b32 v80, v82
    v_permlane32_swap_b32 v84, v86
    v_add_f32 v80, v80, v82
    v_add_f32 v81, v84, v86
    buffer_store_dwordx2 v[80:81], v239, s[80:83], s24 offen sc0 sc1
    s_lshl_b32 s64, s75, 15
    s_lshl_b32 s66, s73, 9
    s_add_u32 s64, s64, s66
    s_add_u32 s64, s64, 75522048
    s_lshl_b32 s65, s72, 5
    s_add_u32 s64, s64, s65
    s_lshl_b32 s65, s3, 2
    s_add_u32 s64, s64, s65
    v_mov_b32 v208, 0
    v_mov_b32 v209, 1
    s_cmp_lg_u32 s78, 0
    s_cbranch_scc1 sg_11_slow
    s_waitcnt vmcnt(0)
    s_mov_b64 exec, 1
    buffer_store_dword v209, v208, s[80:83], s64 offen
    s_mov_b64 exec, -1
sg_11_done:
    s_branch fo_9_end
fo_9_out:
    s_mov_b32 s8, s98
    s_mov_b32 s9, s99
    s_mov_b32 s10, 4194304
    s_mov_b32 s11, 0x00020000
    s_lshl_b32 s64, s73, 1
    s_add_u32 s64, s64, s68
    s_lshl_b32 s64, s64, 1
    s_lshr_b32 s65, s3, 1
    s_add_u32 s64, s64, s65
    s_lshl_b32 s64, s64, 16
    s_lshl_b32 s65, s25, 7
    s_add_u32 s64, s64, s65
    v_lshlrev_b32 v243, 11, v252
    v_add_u32 v243, s64, v243
    v_and_b32 v253, 1, v251
    v_lshl_add_u32 v243, v253, 5, v243
    v_lshrrev_b32 v253, 1, v251
    v_lshl_add_u32 v243, v253, 4, v243
    s_waitcnt vmcnt(3)
    v_lshlrev_b32 v176, 16, v32
    v_and_b32 v177, 0xffff0000, v32
    v_lshlrev_b32 v178, 16, v33
    v_and_b32 v179, 0xffff0000, v33
    v_lshlrev_b32 v180, 16, v34
    v_and_b32 v181, 0xffff0000, v34
    v_lshlrev_b32 v182, 16, v35
    v_and_b32 v183, 0xffff0000, v35
    v_pk_add_f32 v[0:1], v[0:1], v[176:177]
    v_pk_add_f32 v[2:3], v[2:3], v[178:179]
    v_pk_add_f32 v[4:5], v[4:5], v[180:181]
    v_pk_add_f32 v[6:7], v[6:7], v[182:183]
    v_cvt_pk_bf16_f32 v208, v0, v1
    v_cvt_pk_bf16_f32 v209, v2, v3
    v_cvt_pk_bf16_f32 v210, v4, v5
    v_cvt_pk_bf16_f32 v211, v6, v7
    v_lshlrev_b32 v212, 16, v208
    v_and_b32 v213, 0xffff0000, v208
    v_lshlrev_b32 v214, 16, v209
    v_and_b32 v215, 0xffff0000, v209
    v_lshlrev_b32 v216, 16, v210
    v_and_b32 v217, 0xffff0000, v210
    v_lshlrev_b32 v218, 16, v211
    v_and_b32 v219, 0xffff0000, v211
    v_pk_add_f32 v[212:213], v[212:213], v[144:145]
    v_pk_add_f32 v[214:215], v[214:215], v[146:147]
    v_pk_add_f32 v[216:217], v[216:217], v[148:149]
    v_pk_add_f32 v[218:219], v[218:219], v[150:151]
    v_cvt_pk_bf16_f32 v64, v212, v213
    v_cvt_pk_bf16_f32 v65, v214, v215
    v_cvt_pk_bf16_f32 v66, v216, v217
    v_cvt_pk_bf16_f32 v67, v218, v219
    s_mov_b32 s64, 0
    s_nop 0
    v_permlane16_swap_b32 v64, v66
    v_permlane16_swap_b32 v65, v67
    buffer_store_dwordx4 v[64:67], v243, s[8:11], s64 offen offset:0
    s_waitcnt vmcnt(3)
    v_lshlrev_b32 v184, 16, v36
    v_and_b32 v185, 0xffff0000, v36
    v_lshlrev_b32 v186, 16, v37
    v_and_b32 v187, 0xffff0000, v37
    v_lshlrev_b32 v188, 16, v38
    v_and_b32 v189, 0xffff0000, v38
    v_lshlrev_b32 v190, 16, v39
    v_and_b32 v191, 0xffff0000, v39
    v_pk_add_f32 v[8:9], v[8:9], v[184:185]
    v_pk_add_f32 v[10:11], v[10:11], v[186:187]
    v_pk_add_f32 v[12:13], v[12:13], v[188:189]
    v_pk_add_f32 v[14:15], v[14:15], v[190:191]
    v_cvt_pk_bf16_f32 v208, v8, v9
    v_cvt_pk_bf16_f32 v209, v10, v11
    v_cvt_pk_bf16_f32 v210, v12, v13
    v_cvt_pk_bf16_f32 v211, v14, v15
    v_lshlrev_b32 v212, 16, v208
    v_and_b32 v213, 0xffff0000, v208
    v_lshlrev_b32 v214, 16, v209
    v_and_b32 v215, 0xffff0000, v209
    v_lshlrev_b32 v216, 16, v210
    v_and_b32 v217, 0xffff0000, v210
    v_lshlrev_b32 v218, 16, v211
    v_and_b32 v219, 0xffff0000, v211
    v_pk_add_f32 v[212:213], v[212:213], v[152:153]
    v_pk_add_f32 v[214:215], v[214:215], v[154:155]
    v_pk_add_f32 v[216:217], v[216:217], v[156:157]
    v_pk_add_f32 v[218:219], v[218:219], v[158:159]
    v_cvt_pk_bf16_f32 v68, v212, v213
    v_cvt_pk_bf16_f32 v69, v214, v215
    v_cvt_pk_bf16_f32 v70, v216, v217
    v_cvt_pk_bf16_f32 v71, v218, v219
    s_mov_b32 s64, 0
    s_nop 0
    v_permlane16_swap_b32 v68, v70
    v_permlane16_swap_b32 v69, v71
    buffer_store_dwordx4 v[68:71], v243, s[8:11], s64 offen offset:64
    s_waitcnt vmcnt(3)
    v_lshlrev_b32 v192, 16, v40
    v_and_b32 v193, 0xffff0000, v40
    v_lshlrev_b32 v194, 16, v41
    v_and_b32 v195, 0xffff0000, v41
    v_lshlrev_b32 v196, 16, v42
    v_and_b32 v197, 0xffff0000, v42
    v_lshlrev_b32 v198, 16, v43
    v_and_b32 v199, 0xffff0000, v43
    v_pk_add_f32 v[16:17], v[16:17], v[192:193]
    v_pk_add_f32 v[18:19], v[18:19], v[194:195]
    v_pk_add_f32 v[20:21], v[20:21], v[196:197]
    v_pk_add_f32 v[22:23], v[22:23], v[198:199]
    v_cvt_pk_bf16_f32 v208, v16, v17
    v_cvt_pk_bf16_f32 v209, v18, v19
    v_cvt_pk_bf16_f32 v210, v20, v21
    v_cvt_pk_bf16_f32 v211, v22, v23
    v_lshlrev_b32 v212, 16, v208
    v_and_b32 v213, 0xffff0000, v208
    v_lshlrev_b32 v214, 16, v209
    v_and_b32 v215, 0xffff0000, v209
    v_lshlrev_b32 v216, 16, v210
    v_and_b32 v217, 0xffff0000, v210
    v_lshlrev_b32 v218, 16, v211
    v_and_b32 v219, 0xffff0000, v211
    v_pk_add_f32 v[212:213], v[212:213], v[160:161]
    v_pk_add_f32 v[214:215], v[214:215], v[162:163]
    v_pk_add_f32 v[216:217], v[216:217], v[164:165]
    v_pk_add_f32 v[218:219], v[218:219], v[166:167]
    v_cvt_pk_bf16_f32 v72, v212, v213
    v_cvt_pk_bf16_f32 v73, v214, v215
    v_cvt_pk_bf16_f32 v74, v216, v217
    v_cvt_pk_bf16_f32 v75, v218, v219
    s_mov_b32 s64, 32768
    s_nop 0
    v_permlane16_swap_b32 v72, v74
    v_permlane16_swap_b32 v73, v75
    buffer_store_dwordx4 v[72:75], v243, s[8:11], s64 offen offset:0
    s_waitcnt vmcnt(3)
    v_lshlrev_b32 v200, 16, v44
    v_and_b32 v201, 0xffff0000, v44
    v_lshlrev_b32 v202, 16, v45
    v_and_b32 v203, 0xffff0000, v45
    v_lshlrev_b32 v204, 16, v46
    v_and_b32 v205, 0xffff0000, v46
    v_lshlrev_b32 v206, 16, v47
    v_and_b32 v207, 0xffff0000, v47
    v_pk_add_f32 v[24:25], v[24:25], v[200:201]
    v_pk_add_f32 v[26:27], v[26:27], v[202:203]
    v_pk_add_f32 v[28:29], v[28:29], v[204:205]
    v_pk_add_f32 v[30:31], v[30:31], v[206:207]
    v_cvt_pk_bf16_f32 v208, v24, v25
    v_cvt_pk_bf16_f32 v209, v26, v27
    v_cvt_pk_bf16_f32 v210, v28, v29
    v_cvt_pk_bf16_f32 v211, v30, v31
    v_lshlrev_b32 v212, 16, v208
    v_and_b32 v213, 0xffff0000, v208
    v_lshlrev_b32 v214, 16, v209
    v_and_b32 v215, 0xffff0000, v209
    v_lshlrev_b32 v216, 16, v210
    v_and_b32 v217, 0xffff0000, v210
    v_lshlrev_b32 v218, 16, v211
    v_and_b32 v219, 0xffff0000, v211
    v_pk_add_f32 v[212:213], v[212:213], v[168:169]
    v_pk_add_f32 v[214:215], v[214:215], v[170:171]
    v_pk_add_f32 v[216:217], v[216:217], v[172:173]
    v_pk_add_f32 v[218:219], v[218:219], v[174:175]
    v_cvt_pk_bf16_f32 v76, v212, v213
    v_cvt_pk_bf16_f32 v77, v214, v215
    v_cvt_pk_bf16_f32 v78, v216, v217
    v_cvt_pk_bf16_f32 v79, v218, v219
    s_mov_b32 s64, 32768
    s_nop 0
    v_permlane16_swap_b32 v76, v78
    v_permlane16_swap_b32 v77, v79
    buffer_store_dwordx4 v[76:79], v243, s[8:11], s64 offen offset:64
fo_9_end:
    s_add_u32 s75, s75, 1
    s_mov_b32 s59, s78
    s_mul_i32 s60, s59, s75
    s_cmp_lt_u32 s75, 2
    s_cbranch_scc1 C_layer
    s_branch L_fin
g1c_rem:
    v_cvt_pk_bf16_f32 v56, v24, v25
    v_cvt_pk_bf16_f32 v57, v26, v27
    v_cvt_pk_bf16_f32 v58, v28, v29
    v_cvt_pk_bf16_f32 v59, v30, v31
    buffer_store_dwordx4 v[56:59], v249, s[80:83], s21 offen offset:0 sc0 sc1
    v_cvt_pk_bf16_f32 v60, v32, v33
    v_cvt_pk_bf16_f32 v61, v34, v35
    v_cvt_pk_bf16_f32 v62, v36, v37
    v_cvt_pk_bf16_f32 v63, v38, v39
    buffer_store_dwordx4 v[60:63], v249, s[80:83], s21 offen offset:1024 sc0 sc1
    v_cvt_pk_bf16_f32 v64, v40, v41
    v_cvt_pk_bf16_f32 v65, v42, v43
    v_cvt_pk_bf16_f32 v66, v44, v45
    v_cvt_pk_bf16_f32 v67, v46, v47
    buffer_store_dwordx4 v[64:67], v249, s[80:83], s21 offen offset:2048 sc0 sc1
    v_cvt_pk_bf16_f32 v68, v48, v49
    v_cvt_pk_bf16_f32 v69, v50, v51
    v_cvt_pk_bf16_f32 v70, v52, v53
    v_cvt_pk_bf16_f32 v71, v54, v55
    buffer_store_dwordx4 v[68:71], v249, s[80:83], s21 offen offset:3072 sc0 sc1
    s_branch g1c_remb
sg_3_slow:
    s_waitcnt vmcnt(0)
    buffer_wbl2 sc1
    s_waitcnt vmcnt(0)
    s_mov_b64 exec, 1
    buffer_store_dword v109, v108, s[80:83], s64 offen sc0 sc1
    s_mov_b64 exec, -1
    s_branch sg_3_done
sg_6_slow:
    s_waitcnt vmcnt(0)
    buffer_wbl2 sc1
    s_waitcnt vmcnt(0)
    s_mov_b64 exec, 1
    buffer_store_dword v209, v208, s[80:83], s64 offen sc0 sc1
    s_mov_b64 exec, -1
    s_branch sg_6_done
sg_7_slow:
    s_waitcnt vmcnt(0)
    buffer_wbl2 sc1
    s_waitcnt vmcnt(0)
    s_mov_b64 exec, 1
    buffer_store_dword v237, v236, s[80:83], s64 offen sc0 sc1
    s_mov_b64 exec, -1
    s_branch sg_7_done
sg_11_slow:
    s_waitcnt vmcnt(0)
    buffer_wbl2 sc1
    s_waitcnt vmcnt(0)
    s_mov_b64 exec, 1
    buffer_store_dword v209, v208, s[80:83], s64 offen sc0 sc1
    s_mov_b64 exec, -1
    s_branch sg_11_done
L_load:
    s_setprio 3
    s_mov_b32 s8, s86
    s_mov_b32 s9, s87
    s_mov_b32 s10, 6291456
    s_mov_b32 s11, 0x00020000
    v_lshrrev_b32 v253, 3, v250
    v_and_b32 v254, 3, v253
    v_lshlrev_b32 v254, 3, v254
    v_and_b32 v253, 4, v253
    v_add_u32 v253, v253, v254
    v_add_u32 v253, s69, v253
    v_mul_u32_u24 v253, 6144, v253
    v_and_b32 v254, 7, v250
    v_lshl_add_u32 v10, v254, 4, v253
    v_add_u32 v11, 2048, v10
    v_add_u32 v12, 4096, v10
    s_mul_i32 s19, s69, 3104
    s_lshl_b32 s17, s74, 7
    s_add_u32 s18, s17, 6291456
    s_mov_b32 s64, s57
    s_mul_i32 s64, s64, 393216
    s_add_u32 s16, s17, s64
    s_add_u32 m0, s19, 86400
    s_nop 0
    buffer_load_dwordx4 v10, s[8:11], s16 offen lds
    s_add_u32 m0, s19, 87424
    s_nop 0
    buffer_load_dwordx4 v11, s[8:11], s16 offen lds
    s_add_u32 m0, s19, 88448
    s_nop 0
    buffer_load_dwordx4 v12, s[8:11], s16 offen lds
    s_add_u32 s16, s16, 196608
    s_cmp_eq_u32 s16, s18
    s_cselect_b32 s16, s17, s16
    s_mov_b32 s12, s84
    s_mov_b32 s13, s85
    s_mov_b32 s14, 4194304
    s_mov_b32 s15, 0x00020000
    v_lshrrev_b32 v253, 3, v250
    v_and_b32 v254, 6, v253
    v_and_b32 v13, 7, v250
    v_xor_b32 v254, v254, v13
    v_lshlrev_b32 v254, 4, v254
    v_lshl_add_u32 v13, v253, 11, v254
    v_add_u32 v14, 16384, v13
    v_add_u32 v15, 32768, v13
    v_add_u32 v16, 49152, v13
    s_lshl_b32 s21, s67, 18
    s_lshl_b32 s64, s69, 16
    s_add_u32 s21, s21, s64
    s_add_u32 s22, s21, 2048
    s_mov_b32 s64, s57
    s_lshl_b32 s64, s64, 7
    s_add_u32 s20, s21, s64
    s_mul_i32 s24, s69, 4294918144
    s_sub_u32 s24, s24, 32768
    s_cmp_eq_u32 s67, 0
    s_cselect_b32 s24, 0x7f000000, s24
    s_lshl_b32 s23, s69, 12
    s_add_u32 s23, s23, 2048
    s_lshl_b32 s25, s69, 10
    s_cmp_eq_u32 s69, 0
    s_cselect_b32 s26, 0xffffff00, -1
    s_mov_b32 s27, -1
    s_mov_b32 s28, s90
    s_mov_b32 s29, s91
    s_mov_b32 s30, 256
    s_mov_b32 s31, 0x00020000
    s_getreg_b32 s32, hwreg(HW_REG_XCC_ID)
    s_and_b32 s32, s32, 15
    s_or_b32 s32, s32, 0x80
    s_lshr_b32 s33, s72, 2
    s_cmp_eq_u32 s69, 3
    s_cselect_b32 s33, s33, 64
    s_cmp_lt_u32 s2, 128
    s_cselect_b32 s36, s92, s94
    s_cselect_b32 s37, s93, s95
    s_mov_b32 s38, 7340032
    s_mov_b32 s39, 0x00020000
    s_and_b32 s34, s2, 127
    s_mul_i32 s34, s34, 57344
    v_lshlrev_b32 v70, 7, v250
    s_mul_i32 s35, s69, 14336
    s_add_u32 s34, s34, s35
    s_lshr_b32 s40, s2, 3
    s_lshl_b32 s40, s40, 2
    s_add_u32 s40, s40, s69
    s_and_b32 s41, s40, 63
    s_mul_i32 s41, s41, 6144
    s_and_b32 s40, s40, 64
    s_add_u32 s40, s40, s41
    s_add_u32 s40, s40, 384
    s_and_b32 s41, s70, 1
    s_lshl_b32 s41, s41, 10
    s_add_u32 s40, s40, s41
    s_add_u32 s40, s86, s40
    s_addc_u32 s41, s87, 0
    s_cmp_ge_u32 s69, 2
    s_cbranch_scc1 nh_12
    s_add_u32 m0, s25, 18432
    s_add_u32 s64, s20, s24
    s_mov_b64 exec, s[26:27]
    buffer_load_dwordx4 v13, s[12:15], s64 offen lds
    s_mov_b64 exec, -1
nh_12:
    s_add_u32 m0, s23, 18432
    s_nop 0
    buffer_load_dwordx4 v13, s[12:15], s20 offen lds
    s_add_u32 m0, s23, 19456
    s_nop 0
    buffer_load_dwordx4 v14, s[12:15], s20 offen lds
    s_add_u32 m0, s23, 20480
    s_nop 0
    buffer_load_dwordx4 v15, s[12:15], s20 offen lds
    s_add_u32 m0, s23, 21504
    s_nop 0
    buffer_load_dwordx4 v16, s[12:15], s20 offen lds
    s_add_u32 s20, s20, 128
    s_cmp_eq_u32 s20, s22
    s_cselect_b32 s20, s21, s20
    s_add_u32 m0, s19, 98816
    s_nop 0
    buffer_load_dwordx4 v10, s[8:11], s16 offen lds
    s_add_u32 m0, s19, 99840
    s_nop 0
    buffer_load_dwordx4 v11, s[8:11], s16 offen lds
    s_add_u32 m0, s19, 100864
    s_nop 0
    buffer_load_dwordx4 v12, s[8:11], s16 offen lds
    s_add_u32 s16, s16, 196608
    s_cmp_eq_u32 s16, s18
    s_cselect_b32 s16, s17, s16
    s_add_u32 m0, s19, 111232
    s_nop 0
    buffer_load_dwordx4 v10, s[8:11], s16 offen lds
    s_add_u32 m0, s19, 112256
    s_nop 0
    buffer_load_dwordx4 v11, s[8:11], s16 offen lds
    s_add_u32 m0, s19, 113280
    s_nop 0
    buffer_load_dwordx4 v12, s[8:11], s16 offen lds
    s_add_u32 s16, s16, 196608
    s_cmp_eq_u32 s16, s18
    s_cselect_b32 s16, s17, s16
    s_cmp_ge_u32 s69, 2
    s_cbranch_scc1 nh_13
    s_add_u32 m0, s25, 36864
    s_add_u32 s64, s20, s24
    s_mov_b64 exec, s[26:27]
    buffer_load_dwordx4 v13, s[12:15], s64 offen lds
    s_mov_b64 exec, -1
nh_13:
    s_add_u32 m0, s23, 36864
    s_nop 0
    buffer_load_dwordx4 v13, s[12:15], s20 offen lds
    s_add_u32 m0, s23, 37888
    s_nop 0
    buffer_load_dwordx4 v14, s[12:15], s20 offen lds
    s_add_u32 m0, s23, 38912
    s_nop 0
    buffer_load_dwordx4 v15, s[12:15], s20 offen lds
    s_add_u32 m0, s23, 39936
    s_nop 0
    buffer_load_dwordx4 v16, s[12:15], s20 offen lds
    s_add_u32 s20, s20, 128
    s_cmp_eq_u32 s20, s22
    s_cselect_b32 s20, s21, s20
    s_add_u32 m0, s19, 123648
    s_nop 0
    buffer_load_dwordx4 v10, s[8:11], s16 offen lds
    s_add_u32 m0, s19, 124672
    s_nop 0
    buffer_load_dwordx4 v11, s[8:11], s16 offen lds
    s_add_u32 m0, s19, 125696
    s_nop 0
    buffer_load_dwordx4 v12, s[8:11], s16 offen lds
    s_add_u32 s16, s16, 196608
    s_cmp_eq_u32 s16, s18
    s_cselect_b32 s16, s17, s16
    s_add_u32 m0, s19, 136064
    s_nop 0
    buffer_load_dwordx4 v10, s[8:11], s16 offen lds
    s_add_u32 m0, s19, 137088
    s_nop 0
    buffer_load_dwordx4 v11, s[8:11], s16 offen lds
    s_add_u32 m0, s19, 138112
    s_nop 0
    buffer_load_dwordx4 v12, s[8:11], s16 offen lds
    s_add_u32 s16, s16, 196608
    s_cmp_eq_u32 s16, s18
    s_cselect_b32 s16, s17, s16
    s_waitcnt vmcnt(16)
    s_barrier
    s_cmp_ge_u32 s69, 2
    s_cbranch_scc1 nh_14
    s_add_u32 m0, s25, 55296
    s_add_u32 s64, s20, s24
    s_mov_b64 exec, s[26:27]
    buffer_load_dwordx4 v13, s[12:15], s64 offen lds
    s_mov_b64 exec, -1
nh_14:
    s_add_u32 m0, s23, 55296
    s_nop 0
    buffer_load_dwordx4 v13, s[12:15], s20 offen lds
    s_add_u32 m0, s23, 56320
    s_nop 0
    buffer_load_dwordx4 v14, s[12:15], s20 offen lds
    s_add_u32 m0, s23, 57344
    s_nop 0
    buffer_load_dwordx4 v15, s[12:15], s20 offen lds
    s_add_u32 m0, s23, 58368
    s_nop 0
    buffer_load_dwordx4 v16, s[12:15], s20 offen lds
    s_add_u32 s20, s20, 128
    s_cmp_eq_u32 s20, s22
    s_cselect_b32 s20, s21, s20
    s_add_u32 m0, s19, 73984
    s_nop 0
    buffer_load_dwordx4 v10, s[8:11], s16 offen lds
    s_add_u32 m0, s19, 75008
    s_nop 0
    buffer_load_dwordx4 v11, s[8:11], s16 offen lds
    s_add_u32 m0, s19, 76032
    s_nop 0
    buffer_load_dwordx4 v12, s[8:11], s16 offen lds
    s_add_u32 s16, s16, 196608
    s_cmp_eq_u32 s16, s18
    s_cselect_b32 s16, s17, s16
    s_add_u32 s42, s57, 2
    s_and_b32 s42, s42, 15
    s_mul_i32 s42, s42, 393216
    s_add_u32 s44, s40, s42
    s_addc_u32 s45, s41, 0
    s_load_dword s43, s[44:45], 0
    s_load_dword s43, s[44:45], 2048
    s_load_dword s43, s[44:45], 4096
    s_add_u32 s42, s57, 3
    s_and_b32 s42, s42, 15
    s_mul_i32 s42, s42, 393216
    s_add_u32 s44, s40, s42
    s_addc_u32 s45, s41, 0
    s_load_dword s43, s[44:45], 0
    s_load_dword s43, s[44:45], 2048
    s_load_dword s43, s[44:45], 4096
    s_waitcnt vmcnt(13)
    s_barrier
    s_cmp_ge_u32 s69, 2
    s_cbranch_scc1 nh_15
    s_add_u32 m0, s25, 0
    s_add_u32 s64, s20, s24
    s_mov_b64 exec, s[26:27]
    buffer_load_dwordx4 v13, s[12:15], s64 offen lds
    s_mov_b64 exec, -1
nh_15:
    s_add_u32 m0, s23, 0
    s_nop 0
    buffer_load_dwordx4 v13, s[12:15], s20 offen lds
    s_add_u32 m0, s23, 1024
    s_nop 0
    buffer_load_dwordx4 v14, s[12:15], s20 offen lds
    s_add_u32 m0, s23, 2048
    s_nop 0
    buffer_load_dwordx4 v15, s[12:15], s20 offen lds
    s_add_u32 m0, s23, 3072
    s_nop 0
    buffer_load_dwordx4 v16, s[12:15], s20 offen lds
    s_add_u32 s20, s20, 128
    s_cmp_eq_u32 s20, s22
    s_cselect_b32 s20, s21, s20
    s_add_u32 m0, s19, 86400
    s_nop 0
    buffer_load_dwordx4 v10, s[8:11], s16 offen lds
    s_add_u32 m0, s19, 87424
    s_nop 0
    buffer_load_dwordx4 v11, s[8:11], s16 offen lds
    s_add_u32 m0, s19, 88448
    s_nop 0
    buffer_load_dwordx4 v12, s[8:11], s16 offen lds
    s_add_u32 s16, s16, 196608
    s_cmp_eq_u32 s16, s18
    s_cselect_b32 s16, s17, s16
    s_add_u32 s42, s57, 4
    s_and_b32 s42, s42, 15
    s_mul_i32 s42, s42, 393216
    s_add_u32 s44, s40, s42
    s_addc_u32 s45, s41, 0
    s_load_dword s43, s[44:45], 0
    s_load_dword s43, s[44:45], 2048
    s_load_dword s43, s[44:45], 4096
    s_waitcnt vmcnt(10)
    s_barrier
    s_add_u32 m0, s19, 98816
    s_nop 0
    buffer_load_dwordx4 v10, s[8:11], s16 offen lds
    s_add_u32 m0, s19, 99840
    s_nop 0
    buffer_load_dwordx4 v11, s[8:11], s16 offen lds
    s_add_u32 m0, s19, 100864
    s_nop 0
    buffer_load_dwordx4 v12, s[8:11], s16 offen lds
    s_add_u32 s16, s16, 196608
    s_cmp_eq_u32 s16, s18
    s_cselect_b32 s16, s17, s16
    s_cmp_ge_u32 s69, 2
    s_cbranch_scc1 nh_16
    s_add_u32 m0, s25, 18432
    s_add_u32 s64, s20, s24
    s_mov_b64 exec, s[26:27]
    buffer_load_dwordx4 v13, s[12:15], s64 offen lds
    s_mov_b64 exec, -1
nh_16:
    s_add_u32 m0, s23, 18432
    s_nop 0
    buffer_load_dwordx4 v13, s[12:15], s20 offen lds
    s_add_u32 m0, s23, 19456
    s_nop 0
    buffer_load_dwordx4 v14, s[12:15], s20 offen lds
    s_add_u32 m0, s23, 20480
    s_nop 0
    buffer_load_dwordx4 v15, s[12:15], s20 offen lds
    s_add_u32 m0, s23, 21504
    s_nop 0
    buffer_load_dwordx4 v16, s[12:15], s20 offen lds
    s_add_u32 s20, s20, 128
    s_cmp_eq_u32 s20, s22
    s_cselect_b32 s20, s21, s20
    s_add_u32 m0, s19, 111232
    s_nop 0
    buffer_load_dwordx4 v10, s[8:11], s16 offen lds
    s_add_u32 m0, s19, 112256
    s_nop 0
    buffer_load_dwordx4 v11, s[8:11], s16 offen lds
    s_add_u32 m0, s19, 113280
    s_nop 0
    buffer_load_dwordx4 v12, s[8:11], s16 offen lds
    s_add_u32 s16, s16, 196608
    s_cmp_eq_u32 s16, s18
    s_cselect_b32 s16, s17, s16
    s_add_u32 s42, s57, 5
    s_and_b32 s42, s42, 15
    s_mul_i32 s42, s42, 393216
    s_add_u32 s44, s40, s42
    s_addc_u32 s45, s41, 0
    s_load_dword s43, s[44:45], 0
    s_load_dword s43, s[44:45], 2048
    s_load_dword s43, s[44:45], 4096
    s_cmp_eq_u32 s33, 0
    s_cbranch_scc1 ar_17
ar_17_b:
    s_mov_b32 exec_lo, 268435455
    s_mov_b32 exec_hi, 0
    buffer_load_dword v69, v70, s[36:39], s34 offen
    s_mov_b64 exec, -1
    s_add_u32 s34, s34, 3584
    s_waitcnt vmcnt(11)
    s_barrier
    s_add_u32 m0, s19, 123648
    s_nop 0
    buffer_load_dwordx4 v10, s[8:11], s16 offen lds
    s_add_u32 m0, s19, 124672
    s_nop 0
    buffer_load_dwordx4 v11, s[8:11], s16 offen lds
    s_add_u32 m0, s19, 125696
    s_nop 0
    buffer_load_dwordx4 v12, s[8:11], s16 offen lds
    s_add_u32 s16, s16, 196608
    s_cmp_eq_u32 s16, s18
    s_cselect_b32 s16, s17, s16
    s_cmp_ge_u32 s69, 2
    s_cbranch_scc1 nh_18
    s_add_u32 m0, s25, 36864
    s_add_u32 s64, s20, s24
    s_mov_b64 exec, s[26:27]
    buffer_load_dwordx4 v13, s[12:15], s64 offen lds
    s_mov_b64 exec, -1
nh_18:
    s_add_u32 m0, s23, 36864
    s_nop 0
    buffer_load_dwordx4 v13, s[12:15], s20 offen lds
    s_add_u32 m0, s23, 37888
    s_nop 0
    buffer_load_dwordx4 v14, s[12:15], s20 offen lds
    s_add_u32 m0, s23, 38912
    s_nop 0
    buffer_load_dwordx4 v15, s[12:15], s20 offen lds
    s_add_u32 m0, s23, 39936
    s_nop 0
    buffer_load_dwordx4 v16, s[12:15], s20 offen lds
    s_add_u32 s20, s20, 128
    s_cmp_eq_u32 s20, s22
    s_cselect_b32 s20, s21, s20
    s_add_u32 m0, s19, 136064
    s_nop 0
    buffer_load_dwordx4 v10, s[8:11], s16 offen lds
    s_add_u32 m0, s19, 137088
    s_nop 0
    buffer_load_dwordx4 v11, s[8:11], s16 offen lds
    s_add_u32 m0, s19, 138112
    s_nop 0
    buffer_load_dwordx4 v12, s[8:11], s16 offen lds
    s_add_u32 s16, s16, 196608
    s_cmp_eq_u32 s16, s18
    s_cselect_b32 s16, s17, s16
    s_add_u32 s42, s57, 6
    s_and_b32 s42, s42, 15
    s_mul_i32 s42, s42, 393216
    s_add_u32 s44, s40, s42
    s_addc_u32 s45, s41, 0
    s_load_dword s43, s[44:45], 0
    s_load_dword s43, s[44:45], 2048
    s_load_dword s43, s[44:45], 4096
    s_cmp_eq_u32 s33, 1
    s_cbranch_scc1 ar_19
ar_19_b:
    s_waitcnt vmcnt(11)
    s_barrier
    s_add_u32 m0, s19, 73984
    s_nop 0
    buffer_load_dwordx4 v10, s[8:11], s16 offen lds
    s_add_u32 m0, s19, 75008
    s_nop 0
    buffer_load_dwordx4 v11, s[8:11], s16 offen lds
    s_add_u32 m0, s19, 76032
    s_nop 0
    buffer_load_dwordx4 v12, s[8:11], s16 offen lds
    s_add_u32 s16, s16, 196608
    s_cmp_eq_u32 s16, s18
    s_cselect_b32 s16, s17, s16
    s_cmp_ge_u32 s69, 2
    s_cbranch_scc1 nh_20
    s_add_u32 m0, s25, 55296
    s_add_u32 s64, s20, s24
    s_mov_b64 exec, s[26:27]
    buffer_load_dwordx4 v13, s[12:15], s64 offen lds
    s_mov_b64 exec, -1
nh_20:
    s_add_u32 m0, s23, 55296
    s_nop 0
    buffer_load_dwordx4 v13, s[12:15], s20 offen lds
    s_add_u32 m0, s23, 56320
    s_nop 0
    buffer_load_dwordx4 v14, s[12:15], s20 offen lds
    s_add_u32 m0, s23, 57344
    s_nop 0
    buffer_load_dwordx4 v15, s[12:15], s20 offen lds
    s_add_u32 m0, s23, 58368
    s_nop 0
    buffer_load_dwordx4 v16, s[12:15], s20 offen lds
    s_add_u32 s20, s20, 128
    s_cmp_eq_u32 s20, s22
    s_cselect_b32 s20, s21, s20
    s_add_u32 m0, s19, 86400
    s_nop 0
    buffer_load_dwordx4 v10, s[8:11], s16 offen lds
    s_add_u32 m0, s19, 87424
    s_nop 0
    buffer_load_dwordx4 v11, s[8:11], s16 offen lds
    s_add_u32 m0, s19, 88448
    s_nop 0
    buffer_load_dwordx4 v12, s[8:11], s16 offen lds
    s_add_u32 s16, s16, 196608
    s_cmp_eq_u32 s16, s18
    s_cselect_b32 s16, s17, s16
    s_add_u32 s42, s57, 7
    s_and_b32 s42, s42, 15
    s_mul_i32 s42, s42, 393216
    s_add_u32 s44, s40, s42
    s_addc_u32 s45, s41, 0
    s_load_dword s43, s[44:45], 0
    s_load_dword s43, s[44:45], 2048
    s_load_dword s43, s[44:45], 4096
    s_cmp_eq_u32 s33, 2
    s_cbranch_scc1 ar_21
ar_21_b:
    s_waitcnt vmcnt(10)
    s_barrier
    s_add_u32 m0, s19, 98816
    s_nop 0
    buffer_load_dwordx4 v10, s[8:11], s16 offen lds
    s_add_u32 m0, s19, 99840
    s_nop 0
    buffer_load_dwordx4 v11, s[8:11], s16 offen lds
    s_add_u32 m0, s19, 100864
    s_nop 0
    buffer_load_dwordx4 v12, s[8:11], s16 offen lds
    s_add_u32 s16, s16, 196608
    s_cmp_eq_u32 s16, s18
    s_cselect_b32 s16, s17, s16
    s_cmp_ge_u32 s69, 2
    s_cbranch_scc1 nh_22
    s_add_u32 m0, s25, 0
    s_add_u32 s64, s20, s24
    s_mov_b64 exec, s[26:27]
    buffer_load_dwordx4 v13, s[12:15], s64 offen lds
    s_mov_b64 exec, -1
nh_22:
    s_add_u32 m0, s23, 0
    s_nop 0
    buffer_load_dwordx4 v13, s[12:15], s20 offen lds
    s_add_u32 m0, s23, 1024
    s_nop 0
    buffer_load_dwordx4 v14, s[12:15], s20 offen lds
    s_add_u32 m0, s23, 2048
    s_nop 0
    buffer_load_dwordx4 v15, s[12:15], s20 offen lds
    s_add_u32 m0, s23, 3072
    s_nop 0
    buffer_load_dwordx4 v16, s[12:15], s20 offen lds
    s_add_u32 s20, s20, 128
    s_cmp_eq_u32 s20, s22
    s_cselect_b32 s20, s21, s20
    s_add_u32 m0, s19, 111232
    s_nop 0
    buffer_load_dwordx4 v10, s[8:11], s16 offen lds
    s_add_u32 m0, s19, 112256
    s_nop 0
    buffer_load_dwordx4 v11, s[8:11], s16 offen lds
    s_add_u32 m0, s19, 113280
    s_nop 0
    buffer_load_dwordx4 v12, s[8:11], s16 offen lds
    s_add_u32 s16, s16, 196608
    s_cmp_eq_u32 s16, s18
    s_cselect_b32 s16, s17, s16
    s_add_u32 s42, s57, 8
    s_and_b32 s42, s42, 15
    s_mul_i32 s42, s42, 393216
    s_add_u32 s44, s40, s42
    s_addc_u32 s45, s41, 0
    s_load_dword s43, s[44:45], 0
    s_load_dword s43, s[44:45], 2048
    s_load_dword s43, s[44:45], 4096
    s_cmp_eq_u32 s33, 3
    s_cbranch_scc1 ar_23
ar_23_b:
    s_waitcnt vmcnt(10)
    s_barrier
    s_add_u32 m0, s19, 123648
    s_nop 0
    buffer_load_dwordx4 v10, s[8:11], s16 offen lds
    s_add_u32 m0, s19, 124672
    s_nop 0
    buffer_load_dwordx4 v11, s[8:11], s16 offen lds
    s_add_u32 m0, s19, 125696
    s_nop 0
    buffer_load_dwordx4 v12, s[8:11], s16 offen lds
    s_add_u32 s16, s16, 196608
    s_cmp_eq_u32 s16, s18
    s_cselect_b32 s16, s17, s16
    s_cmp_ge_u32 s69, 2
    s_cbranch_scc1 nh_24
    s_add_u32 m0, s25, 18432
    s_add_u32 s64, s20, s24
    s_mov_b64 exec, s[26:27]
    buffer_load_dwordx4 v13, s[12:15], s64 offen lds
    s_mov_b64 exec, -1
nh_24:
    s_add_u32 m0, s23, 18432
    s_nop 0
    buffer_load_dwordx4 v13, s[12:15], s20 offen lds
    s_add_u32 m0, s23, 19456
    s_nop 0
    buffer_load_dwordx4 v14, s[12:15], s20 offen lds
    s_add_u32 m0, s23, 20480
    s_nop 0
    buffer_load_dwordx4 v15, s[12:15], s20 offen lds
    s_add_u32 m0, s23, 21504
    s_nop 0
    buffer_load_dwordx4 v16, s[12:15], s20 offen lds
    s_add_u32 s20, s20, 128
    s_cmp_eq_u32 s20, s22
    s_cselect_b32 s20, s21, s20
    s_add_u32 m0, s19, 136064
    s_nop 0
    buffer_load_dwordx4 v10, s[8:11], s16 offen lds
    s_add_u32 m0, s19, 137088
    s_nop 0
    buffer_load_dwordx4 v11, s[8:11], s16 offen lds
    s_add_u32 m0, s19, 138112
    s_nop 0
    buffer_load_dwordx4 v12, s[8:11], s16 offen lds
    s_add_u32 s16, s16, 196608
    s_cmp_eq_u32 s16, s18
    s_cselect_b32 s16, s17, s16
    s_add_u32 s42, s57, 9
    s_and_b32 s42, s42, 15
    s_mul_i32 s42, s42, 393216
    s_add_u32 s44, s40, s42
    s_addc_u32 s45, s41, 0
    s_load_dword s43, s[44:45], 0
    s_load_dword s43, s[44:45], 2048
    s_load_dword s43, s[44:45], 4096
    s_mov_b32 exec_lo, 268435455
    s_mov_b32 exec_hi, 0
    buffer_load_dword v69, v70, s[36:39], s34 offen
    s_mov_b64 exec, -1
    s_add_u32 s34, s34, 3584
    s_waitcnt vmcnt(11)
    s_barrier
    s_add_u32 m0, s19, 73984
    s_nop 0
    buffer_load_dwordx4 v10, s[8:11], s16 offen lds
    s_add_u32 m0, s19, 75008
    s_nop 0
    buffer_load_dwordx4 v11, s[8:11], s16 offen lds
    s_add_u32 m0, s19, 76032
    s_nop 0
    buffer_load_dwordx4 v12, s[8:11], s16 offen lds
    s_add_u32 s16, s16, 196608
    s_cmp_eq_u32 s16, s18
    s_cselect_b32 s16, s17, s16
    s_cmp_ge_u32 s69, 2
    s_cbranch_scc1 nh_25
    s_add_u32 m0, s25, 36864
    s_add_u32 s64, s20, s24
    s_mov_b64 exec, s[26:27]
    buffer_load_dwordx4 v13, s[12:15], s64 offen lds
    s_mov_b64 exec, -1
nh_25:
    s_add_u32 m0, s23, 36864
    s_nop 0
    buffer_load_dwordx4 v13, s[12:15], s20 offen lds
    s_add_u32 m0, s23, 37888
    s_nop 0
    buffer_load_dwordx4 v14, s[12:15], s20 offen lds
    s_add_u32 m0, s23, 38912
    s_nop 0
    buffer_load_dwordx4 v15, s[12:15], s20 offen lds
    s_add_u32 m0, s23, 39936
    s_nop 0
    buffer_load_dwordx4 v16, s[12:15], s20 offen lds
    s_add_u32 s20, s20, 128
    s_cmp_eq_u32 s20, s22
    s_cselect_b32 s20, s21, s20
    s_add_u32 m0, s19, 86400
    s_nop 0
    buffer_load_dwordx4 v10, s[8:11], s16 offen lds
    s_add_u32 m0, s19, 87424
    s_nop 0
    buffer_load_dwordx4 v11, s[8:11], s16 offen lds
    s_add_u32 m0, s19, 88448
    s_nop 0
    buffer_load_dwordx4 v12, s[8:11], s16 offen lds
    s_add_u32 s16, s16, 196608
    s_cmp_eq_u32 s16, s18
    s_cselect_b32 s16, s17, s16
    s_add_u32 s42, s57, 10
    s_and_b32 s42, s42, 15
    s_mul_i32 s42, s42, 393216
    s_add_u32 s44, s40, s42
    s_addc_u32 s45, s41, 0
    s_load_dword s43, s[44:45], 0
    s_load_dword s43, s[44:45], 2048
    s_load_dword s43, s[44:45], 4096
    s_waitcnt vmcnt(11)
    s_barrier
    s_add_u32 m0, s19, 98816
    s_nop 0
    buffer_load_dwordx4 v10, s[8:11], s16 offen lds
    s_add_u32 m0, s19, 99840
    s_nop 0
    buffer_load_dwordx4 v11, s[8:11], s16 offen lds
    s_add_u32 m0, s19, 100864
    s_nop 0
    buffer_load_dwordx4 v12, s[8:11], s16 offen lds
    s_add_u32 s16, s16, 196608
    s_cmp_eq_u32 s16, s18
    s_cselect_b32 s16, s17, s16
    s_cmp_ge_u32 s69, 2
    s_cbranch_scc1 nh_26
    s_add_u32 m0, s25, 55296
    s_add_u32 s64, s20, s24
    s_mov_b64 exec, s[26:27]
    buffer_load_dwordx4 v13, s[12:15], s64 offen lds
    s_mov_b64 exec, -1
nh_26:
    s_add_u32 m0, s23, 55296
    s_nop 0
    buffer_load_dwordx4 v13, s[12:15], s20 offen lds
    s_add_u32 m0, s23, 56320
    s_nop 0
    buffer_load_dwordx4 v14, s[12:15], s20 offen lds
    s_add_u32 m0, s23, 57344
    s_nop 0
    buffer_load_dwordx4 v15, s[12:15], s20 offen lds
    s_add_u32 m0, s23, 58368
    s_nop 0
    buffer_load_dwordx4 v16, s[12:15], s20 offen lds
    s_add_u32 s20, s20, 128
    s_cmp_eq_u32 s20, s22
    s_cselect_b32 s20, s21, s20
    s_add_u32 m0, s19, 111232
    s_nop 0
    buffer_load_dwordx4 v10, s[8:11], s16 offen lds
    s_add_u32 m0, s19, 112256
    s_nop 0
    buffer_load_dwordx4 v11, s[8:11], s16 offen lds
    s_add_u32 m0, s19, 113280
    s_nop 0
    buffer_load_dwordx4 v12, s[8:11], s16 offen lds
    s_add_u32 s16, s16, 196608
    s_cmp_eq_u32 s16, s18
    s_cselect_b32 s16, s17, s16
    s_add_u32 s42, s57, 11
    s_and_b32 s42, s42, 15
    s_mul_i32 s42, s42, 393216
    s_add_u32 s44, s40, s42
    s_addc_u32 s45, s41, 0
    s_load_dword s43, s[44:45], 0
    s_load_dword s43, s[44:45], 2048
    s_load_dword s43, s[44:45], 4096
    s_waitcnt vmcnt(10)
    s_barrier
    s_add_u32 m0, s19, 123648
    s_nop 0
    buffer_load_dwordx4 v10, s[8:11], s16 offen lds
    s_add_u32 m0, s19, 124672
    s_nop 0
    buffer_load_dwordx4 v11, s[8:11], s16 offen lds
    s_add_u32 m0, s19, 125696
    s_nop 0
    buffer_load_dwordx4 v12, s[8:11], s16 offen lds
    s_add_u32 s16, s16, 196608
    s_cmp_eq_u32 s16, s18
    s_cselect_b32 s16, s17, s16
    s_cmp_ge_u32 s69, 2
    s_cbranch_scc1 nh_27
    s_add_u32 m0, s25, 0
    s_add_u32 s64, s20, s24
    s_mov_b64 exec, s[26:27]
    buffer_load_dwordx4 v13, s[12:15], s64 offen lds
    s_mov_b64 exec, -1
nh_27:
    s_add_u32 m0, s23, 0
    s_nop 0
    buffer_load_dwordx4 v13, s[12:15], s20 offen lds
    s_add_u32 m0, s23, 1024
    s_nop 0
    buffer_load_dwordx4 v14, s[12:15], s20 offen lds
    s_add_u32 m0, s23, 2048
    s_nop 0
    buffer_load_dwordx4 v15, s[12:15], s20 offen lds
    s_add_u32 m0, s23, 3072
    s_nop 0
    buffer_load_dwordx4 v16, s[12:15], s20 offen lds
    s_add_u32 s20, s20, 128
    s_cmp_eq_u32 s20, s22
    s_cselect_b32 s20, s21, s20
    s_add_u32 m0, s19, 136064
    s_nop 0
    buffer_load_dwordx4 v10, s[8:11], s16 offen lds
    s_add_u32 m0, s19, 137088
    s_nop 0
    buffer_load_dwordx4 v11, s[8:11], s16 offen lds
    s_add_u32 m0, s19, 138112
    s_nop 0
    buffer_load_dwordx4 v12, s[8:11], s16 offen lds
    s_add_u32 s16, s16, 196608
    s_cmp_eq_u32 s16, s18
    s_cselect_b32 s16, s17, s16
    s_add_u32 s42, s57, 12
    s_and_b32 s42, s42, 15
    s_mul_i32 s42, s42, 393216
    s_add_u32 s44, s40, s42
    s_addc_u32 s45, s41, 0
    s_load_dword s43, s[44:45], 0
    s_load_dword s43, s[44:45], 2048
    s_load_dword s43, s[44:45], 4096
    s_waitcnt vmcnt(10)
    s_barrier
    s_add_u32 m0, s19, 73984
    s_nop 0
    buffer_load_dwordx4 v10, s[8:11], s16 offen lds
    s_add_u32 m0, s19, 75008
    s_nop 0
    buffer_load_dwordx4 v11, s[8:11], s16 offen lds
    s_add_u32 m0, s19, 76032
    s_nop 0
    buffer_load_dwordx4 v12, s[8:11], s16 offen lds
    s_add_u32 s16, s16, 196608
    s_cmp_eq_u32 s16, s18
    s_cselect_b32 s16, s17, s16
    s_cmp_ge_u32 s69, 2
    s_cbranch_scc1 nh_28
    s_add_u32 m0, s25, 18432
    s_add_u32 s64, s20, s24
    s_mov_b64 exec, s[26:27]
    buffer_load_dwordx4 v13, s[12:15], s64 offen lds
    s_mov_b64 exec, -1
nh_28:
    s_add_u32 m0, s23, 18432
    s_nop 0
    buffer_load_dwordx4 v13, s[12:15], s20 offen lds
    s_add_u32 m0, s23, 19456
    s_nop 0
    buffer_load_dwordx4 v14, s[12:15], s20 offen lds
    s_add_u32 m0, s23, 20480
    s_nop 0
    buffer_load_dwordx4 v15, s[12:15], s20 offen lds
    s_add_u32 m0, s23, 21504
    s_nop 0
    buffer_load_dwordx4 v16, s[12:15], s20 offen lds
    s_add_u32 s20, s20, 128
    s_cmp_eq_u32 s20, s22
    s_cselect_b32 s20, s21, s20
    s_add_u32 m0, s19, 86400
    s_nop 0
    buffer_load_dwordx4 v10, s[8:11], s16 offen lds
    s_add_u32 m0, s19, 87424
    s_nop 0
    buffer_load_dwordx4 v11, s[8:11], s16 offen lds
    s_add_u32 m0, s19, 88448
    s_nop 0
    buffer_load_dwordx4 v12, s[8:11], s16 offen lds
    s_add_u32 s16, s16, 196608
    s_cmp_eq_u32 s16, s18
    s_cselect_b32 s16, s17, s16
    s_add_u32 s42, s57, 13
    s_and_b32 s42, s42, 15
    s_mul_i32 s42, s42, 393216
    s_add_u32 s44, s40, s42
    s_addc_u32 s45, s41, 0
    s_load_dword s43, s[44:45], 0
    s_load_dword s43, s[44:45], 2048
    s_load_dword s43, s[44:45], 4096
    s_mov_b32 exec_lo, 268435455
    s_mov_b32 exec_hi, 0
    buffer_load_dword v69, v70, s[36:39], s34 offen
    s_mov_b64 exec, -1
    s_add_u32 s34, s34, 3584
    s_waitcnt vmcnt(11)
    s_barrier
    s_add_u32 m0, s19, 98816
    s_nop 0
    buffer_load_dwordx4 v10, s[8:11], s16 offen lds
    s_add_u32 m0, s19, 99840
    s_nop 0
    buffer_load_dwordx4 v11, s[8:11], s16 offen lds
    s_add_u32 m0, s19, 100864
    s_nop 0
    buffer_load_dwordx4 v12, s[8:11], s16 offen lds
    s_add_u32 s16, s16, 196608
    s_cmp_eq_u32 s16, s18
    s_cselect_b32 s16, s17, s16
    s_cmp_ge_u32 s69, 2
    s_cbranch_scc1 nh_29
    s_add_u32 m0, s25, 36864
    s_add_u32 s64, s20, s24
    s_mov_b64 exec, s[26:27]
    buffer_load_dwordx4 v13, s[12:15], s64 offen lds
    s_mov_b64 exec, -1
nh_29:
    s_add_u32 m0, s23, 36864
    s_nop 0
    buffer_load_dwordx4 v13, s[12:15], s20 offen lds
    s_add_u32 m0, s23, 37888
    s_nop 0
    buffer_load_dwordx4 v14, s[12:15], s20 offen lds
    s_add_u32 m0, s23, 38912
    s_nop 0
    buffer_load_dwordx4 v15, s[12:15], s20 offen lds
    s_add_u32 m0, s23, 39936
    s_nop 0
    buffer_load_dwordx4 v16, s[12:15], s20 offen lds
    s_add_u32 s20, s20, 128
    s_cmp_eq_u32 s20, s22
    s_cselect_b32 s20, s21, s20
    s_add_u32 m0, s19, 111232
    s_nop 0
    buffer_load_dwordx4 v10, s[8:11], s16 offen lds
    s_add_u32 m0, s19, 112256
    s_nop 0
    buffer_load_dwordx4 v11, s[8:11], s16 offen lds
    s_add_u32 m0, s19, 113280
    s_nop 0
    buffer_load_dwordx4 v12, s[8:11], s16 offen lds
    s_add_u32 s16, s16, 196608
    s_cmp_eq_u32 s16, s18
    s_cselect_b32 s16, s17, s16
    s_add_u32 s42, s57, 14
    s_and_b32 s42, s42, 15
    s_mul_i32 s42, s42, 393216
    s_add_u32 s44, s40, s42
    s_addc_u32 s45, s41, 0
    s_load_dword s43, s[44:45], 0
    s_load_dword s43, s[44:45], 2048
    s_load_dword s43, s[44:45], 4096
    s_waitcnt vmcnt(11)
    s_barrier
    s_add_u32 m0, s19, 123648
    s_nop 0
    buffer_load_dwordx4 v10, s[8:11], s16 offen lds
    s_add_u32 m0, s19, 124672
    s_nop 0
    buffer_load_dwordx4 v11, s[8:11], s16 offen lds
    s_add_u32 m0, s19, 125696
    s_nop 0
    buffer_load_dwordx4 v12, s[8:11], s16 offen lds
    s_add_u32 s16, s16, 196608
    s_cmp_eq_u32 s16, s18
    s_cselect_b32 s16, s17, s16
    s_cmp_ge_u32 s69, 2
    s_cbranch_scc1 nh_30
    s_add_u32 m0, s25, 55296
    s_add_u32 s64, s20, s24
    s_mov_b64 exec, s[26:27]
    buffer_load_dwordx4 v13, s[12:15], s64 offen lds
    s_mov_b64 exec, -1
nh_30:
    s_add_u32 m0, s23, 55296
    s_nop 0
    buffer_load_dwordx4 v13, s[12:15], s20 offen lds
    s_add_u32 m0, s23, 56320
    s_nop 0
    buffer_load_dwordx4 v14, s[12:15], s20 offen lds
    s_add_u32 m0, s23, 57344
    s_nop 0
    buffer_load_dwordx4 v15, s[12:15], s20 offen lds
    s_add_u32 m0, s23, 58368
    s_nop 0
    buffer_load_dwordx4 v16, s[12:15], s20 offen lds
    s_add_u32 s20, s20, 128
    s_cmp_eq_u32 s20, s22
    s_cselect_b32 s20, s21, s20
    s_add_u32 m0, s19, 136064
    s_nop 0
    buffer_load_dwordx4 v10, s[8:11], s16 offen lds
    s_add_u32 m0, s19, 137088
    s_nop 0
    buffer_load_dwordx4 v11, s[8:11], s16 offen lds
    s_add_u32 m0, s19, 138112
    s_nop 0
    buffer_load_dwordx4 v12, s[8:11], s16 offen lds
    s_add_u32 s16, s16, 196608
    s_cmp_eq_u32 s16, s18
    s_cselect_b32 s16, s17, s16
    s_add_u32 s42, s57, 15
    s_and_b32 s42, s42, 15
    s_mul_i32 s42, s42, 393216
    s_add_u32 s44, s40, s42
    s_addc_u32 s45, s41, 0
    s_load_dword s43, s[44:45], 0
    s_load_dword s43, s[44:45], 2048
    s_load_dword s43, s[44:45], 4096
    v_lshlrev_b32 v71, 2, v250
    buffer_load_dword v72, v71, s[28:31], 0 offen sc1
    s_waitcnt vmcnt(11)
    s_barrier
    s_add_u32 m0, s19, 73984
    s_nop 0
    buffer_load_dwordx4 v10, s[8:11], s16 offen lds
    s_add_u32 m0, s19, 75008
    s_nop 0
    buffer_load_dwordx4 v11, s[8:11], s16 offen lds
    s_add_u32 m0, s19, 76032
    s_nop 0
    buffer_load_dwordx4 v12, s[8:11], s16 offen lds
    s_add_u32 s16, s16, 196608
    s_cmp_eq_u32 s16, s18
    s_cselect_b32 s16, s17, s16
    s_cmp_ge_u32 s69, 2
    s_cbranch_scc1 nh_31
    s_add_u32 m0, s25, 0
    s_add_u32 s64, s20, s24
    s_mov_b64 exec, s[26:27]
    buffer_load_dwordx4 v13, s[12:15], s64 offen lds
    s_mov_b64 exec, -1
nh_31:
    s_add_u32 m0, s23, 0
    s_nop 0
    buffer_load_dwordx4 v13, s[12:15], s20 offen lds
    s_add_u32 m0, s23, 1024
    s_nop 0
    buffer_load_dwordx4 v14, s[12:15], s20 offen lds
    s_add_u32 m0, s23, 2048
    s_nop 0
    buffer_load_dwordx4 v15, s[12:15], s20 offen lds
    s_add_u32 m0, s23, 3072
    s_nop 0
    buffer_load_dwordx4 v16, s[12:15], s20 offen lds
    s_add_u32 s20, s20, 128
    s_cmp_eq_u32 s20, s22
    s_cselect_b32 s20, s21, s20
    s_add_u32 m0, s19, 86400
    s_nop 0
    buffer_load_dwordx4 v10, s[8:11], s16 offen lds
    s_add_u32 m0, s19, 87424
    s_nop 0
    buffer_load_dwordx4 v11, s[8:11], s16 offen lds
    s_add_u32 m0, s19, 88448
    s_nop 0
    buffer_load_dwordx4 v12, s[8:11], s16 offen lds
    s_add_u32 s16, s16, 196608
    s_cmp_eq_u32 s16, s18
    s_cselect_b32 s16, s17, s16
    s_waitcnt vmcnt(11)
    s_barrier
    s_add_u32 m0, s19, 98816
    s_nop 0
    buffer_load_dwordx4 v10, s[8:11], s16 offen lds
    s_add_u32 m0, s19, 99840
    s_nop 0
    buffer_load_dwordx4 v11, s[8:11], s16 offen lds
    s_add_u32 m0, s19, 100864
    s_nop 0
    buffer_load_dwordx4 v12, s[8:11], s16 offen lds
    s_add_u32 s16, s16, 196608
    s_cmp_eq_u32 s16, s18
    s_cselect_b32 s16, s17, s16
    s_lshl_b32 s64, s67, 4
    s_add_u32 s64, s64, s74
    s_lshl_b32 s64, s64, 2
    s_add_u32 s64, s64, s69
    s_lshl_b32 s64, s64, 12
    s_lshl_b32 s65, s75, 22
    s_add_u32 s64, s64, s65
    s_add_u32 s64, s64, 12582912
    s_cmp_eq_u32 s68, 0
    s_cselect_b32 s64, s64, 0x7f000000
    v_lshlrev_b32 v253, 7, v250
    s_mov_b64 exec, 0xffffffff
    buffer_load_dword v9, v253, s[80:83], s64 offen sc1
    s_mov_b64 exec, -1
    s_mov_b32 s12, s88
    s_mov_b32 s13, s89
    s_mov_b32 s14, 2097152
    s_mov_b32 s15, 0x00020000
    v_lshrrev_b32 v253, 3, v250
    v_lshlrev_b32 v253, 13, v253
    v_and_b32 v254, 7, v250
    v_lshl_add_u32 v253, v254, 4, v253
    s_lshl_b32 s64, s69, 11
    v_add_u32 v244, s64, v253
    s_mul_i32 s51, s69, 1056
    s_lshl_b32 s49, s72, 7
    s_waitcnt vmcnt(14)
    v_and_b32 v73, 0x80808080, v72
    v_cmp_ne_u32 vcc, 0x80808080, v73
    s_cbranch_vccnz hs_32
hs_32_b:
    s_lshl_b32 s64, s67, 11
    s_mul_i32 s65, s69, 288
    s_add_u32 s64, s64, s65
    s_add_u32 s64, s64, 74186752
    s_mov_b64 exec, 0x3ffff
    buffer_load_dwordx4 v[76:79], v249, s[80:83], s64 offen sc0 sc1
    s_mov_b64 exec, -1
    s_add_u32 s65, s65, 159744
    v_add_u32 v75, s65, v249
    s_and_b32 s64, s70, 3
    s_lshl_b32 s64, s64, 3
    v_bfe_u32 v72, v72, s64, 8
    v_cmp_ne_u32 vcc, s32, v72
    s_lshr_b32 s64, s70, 2
    s_lshl_b32 s65, 0x55555555, s64
    s_or_b32 s64, vcc_lo, vcc_hi
    s_and_b32 s64, s64, s65
    s_cselect_b32 s78, 1, 0
    s_mov_b32 s59, s78
    s_mul_i32 s60, s59, s75
    s_mov_b32 exec_lo, 268435455
    s_mov_b32 exec_hi, 0
    buffer_load_dword v69, v70, s[36:39], s34 offen
    s_mov_b64 exec, -1
    s_add_u32 s34, s34, 3584
    s_add_u32 s48, s58, 0
    s_and_b32 s48, s48, 7
    s_and_b32 s66, s74, 8
    s_or_b32 s48, s48, s66
    s_lshl_b32 s48, s48, 17
    s_add_u32 s48, s48, s49
    s_add_u32 m0, s51, 116224
    s_nop 0
    buffer_load_dwordx4 v244, s[12:15], s48 offen lds
    s_add_u32 s48, s48, 65536
    s_waitcnt vmcnt(7)
    s_barrier
    s_add_u32 m0, s51, 120448
    s_nop 0
    buffer_load_dwordx4 v244, s[12:15], s48 offen lds
    s_add_u32 s48, s48, 65536
    s_add_u32 s48, s58, 1
    s_and_b32 s48, s48, 7
    s_and_b32 s66, s74, 8
    s_or_b32 s48, s48, s66
    s_lshl_b32 s48, s48, 17
    s_add_u32 s48, s48, s49
    s_add_u32 m0, s51, 124672
    s_nop 0
    buffer_load_dwordx4 v244, s[12:15], s48 offen lds
    s_add_u32 s48, s48, 65536
    s_add_u32 m0, s51, 128896
    s_nop 0
    buffer_load_dwordx4 v244, s[12:15], s48 offen lds
    s_add_u32 s48, s48, 65536
    s_add_u32 s48, s58, 2
    s_and_b32 s48, s48, 7
    s_and_b32 s66, s74, 8
    s_or_b32 s48, s48, s66
    s_lshl_b32 s48, s48, 17
    s_add_u32 s48, s48, s49
    s_add_u32 m0, s51, 133120
    s_nop 0
    buffer_load_dwordx4 v244, s[12:15], s48 offen lds
    s_add_u32 s48, s48, 65536
    s_add_u32 m0, s51, 137344
    s_nop 0
    buffer_load_dwordx4 v244, s[12:15], s48 offen lds
    s_add_u32 s48, s48, 65536
    s_add_u32 s48, s58, 3
    s_and_b32 s48, s48, 7
    s_and_b32 s66, s74, 8
    s_or_b32 s48, s48, s66
    s_lshl_b32 s48, s48, 17
    s_add_u32 s48, s48, s49
    s_add_u32 m0, s51, 141568
    s_nop 0
    buffer_load_dwordx4 v244, s[12:15], s48 offen lds
    s_add_u32 s48, s48, 65536
    s_add_u32 m0, s51, 145792
    s_nop 0
    buffer_load_dwordx4 v244, s[12:15], s48 offen lds
    s_add_u32 s48, s48, 65536
    s_add_u32 s48, s58, 4
    s_and_b32 s48, s48, 7
    s_and_b32 s66, s74, 8
    s_or_b32 s48, s48, s66
    s_lshl_b32 s48, s48, 17
    s_add_u32 s48, s48, s49
    s_add_u32 m0, s51, 150016
    s_nop 0
    buffer_load_dwordx4 v244, s[12:15], s48 offen lds
    s_add_u32 s48, s48, 65536
    s_waitcnt vmcnt(12)
    s_barrier
    s_waitcnt vmcnt(10)
    v_mov_b32 v72, s78
    v_mov_b32 v73, 163456
    s_mov_b64 exec, 0x3ffff
    ds_write_b128 v75, v[76:79]
    ds_write_b32 v73, v72
    s_mov_b64 exec, -1
    s_add_u32 m0, s51, 154240
    s_nop 0
    buffer_load_dwordx4 v244, s[12:15], s48 offen lds
    s_add_u32 s48, s48, 65536
    s_add_u32 s48, s58, 5
    s_and_b32 s48, s48, 7
    s_and_b32 s66, s74, 8
    s_or_b32 s48, s48, s66
    s_lshl_b32 s48, s48, 17
    s_add_u32 s48, s48, s49
    s_add_u32 m0, s51, 65536
    s_nop 0
    buffer_load_dwordx4 v244, s[12:15], s48 offen lds
    s_add_u32 s48, s48, 65536
    s_add_u32 m0, s51, 69760
    s_nop 0
    buffer_load_dwordx4 v244, s[12:15], s48 offen lds
    s_add_u32 s48, s48, 65536
    s_add_u32 s48, s58, 6
    s_and_b32 s48, s48, 7
    s_and_b32 s66, s74, 8
    s_or_b32 s48, s48, s66
    s_lshl_b32 s48, s48, 17
    s_add_u32 s48, s48, s49
    s_add_u32 m0, s51, 73984
    s_nop 0
    buffer_load_dwordx4 v244, s[12:15], s48 offen lds
    s_add_u32 s48, s48, 65536
    s_add_u32 m0, s51, 78208
    s_nop 0
    buffer_load_dwordx4 v244, s[12:15], s48 offen lds
    s_add_u32 s48, s48, 65536
    s_add_u32 s48, s58, 7
    s_and_b32 s48, s48, 7
    s_and_b32 s66, s74, 8
    s_or_b32 s48, s48, s66
    s_lshl_b32 s48, s48, 17
    s_add_u32 s48, s48, s49
    s_add_u32 m0, s51, 82432
    s_nop 0
    buffer_load_dwordx4 v244, s[12:15], s48 offen lds
    s_add_u32 s48, s48, 65536
    s_add_u32 m0, s51, 86656
    s_nop 0
    buffer_load_dwordx4 v244, s[12:15], s48 offen lds
    s_add_u32 s48, s48, 65536
    s_add_u32 s48, s58, 8
    s_and_b32 s48, s48, 7
    s_and_b32 s66, s74, 8
    s_xor_b32 s66, s66, 8
    s_or_b32 s48, s48, s66
    s_lshl_b32 s48, s48, 17
    s_add_u32 s48, s48, s49
    s_add_u32 m0, s51, 90880
    s_nop 0
    buffer_load_dwordx4 v244, s[12:15], s48 offen lds
    s_add_u32 s48, s48, 65536
    s_waitcnt lgkmcnt(0)
    s_barrier
    s_add_u32 m0, s51, 95104
    s_nop 0
    buffer_load_dwordx4 v244, s[12:15], s48 offen lds
    s_add_u32 s48, s48, 65536
    s_add_u32 s48, s58, 9
    s_and_b32 s48, s48, 7
    s_and_b32 s66, s74, 8
    s_xor_b32 s66, s66, 8
    s_or_b32 s48, s48, s66
    s_lshl_b32 s48, s48, 17
    s_add_u32 s48, s48, s49
    s_add_u32 m0, s51, 99328
    s_nop 0
    buffer_load_dwordx4 v244, s[12:15], s48 offen lds
    s_add_u32 s48, s48, 65536
    s_add_u32 m0, s51, 103552
    s_nop 0
    buffer_load_dwordx4 v244, s[12:15], s48 offen lds
    s_add_u32 s48, s48, 65536
    s_add_u32 s48, s58, 10
    s_and_b32 s48, s48, 7
    s_and_b32 s66, s74, 8
    s_xor_b32 s66, s66, 8
    s_or_b32 s48, s48, s66
    s_lshl_b32 s48, s48, 17
    s_add_u32 s48, s48, s49
    s_add_u32 m0, s51, 107776
    s_nop 0
    buffer_load_dwordx4 v244, s[12:15], s48 offen lds
    s_add_u32 s48, s48, 65536
    s_add_u32 m0, s51, 112000
    s_nop 0
    buffer_load_dwordx4 v244, s[12:15], s48 offen lds
    s_add_u32 s48, s48, 65536
L_g2:
    s_and_b32 s64, s3, 1
    s_cmp_eq_u32 s64, 0
    s_cselect_b32 s8, s92, s94
    s_cselect_b32 s9, s93, s95
    s_mov_b32 s10, 7340032
    s_mov_b32 s11, 0x00020000
    s_mul_i32 s19, s64, 14400
    s_lshr_b32 s64, s69, 1
    s_mul_i32 s65, s64, 7200
    s_add_u32 s19, s19, s65
    s_add_u32 s19, s19, 36736
    s_mul_i32 s17, s64, 28672
    s_mul_i32 s65, s74, 448
    s_add_u32 s17, s17, s65
    s_add_u32 s18, s17, 7340032
    s_lshl_b32 s64, s57, 1
    s_mul_i32 s65, s64, 229376
    s_add_u32 s16, s17, s65
    s_mov_b32 s66, 2341
    v_add_u32 v253, 0, v250
    v_mul_lo_u32 v254, v253, s66
    v_lshrrev_b32 v254, 16, v254
    v_mul_u32_u24 v228, 28, v254
    v_sub_u32 v253, v253, v228
    v_and_b32 v228, 12, v254
    v_add_u32 v254, v254, v228
    v_mul_u32_u24 v254, 7168, v254
    v_lshl_add_u32 v228, v253, 4, v254
    v_add_u32 v253, 64, v250
    v_mul_lo_u32 v254, v253, s66
    v_lshrrev_b32 v254, 16, v254
    v_mul_u32_u24 v229, 28, v254
    v_sub_u32 v253, v253, v229
    v_and_b32 v229, 12, v254
    v_add_u32 v254, v254, v229
    v_mul_u32_u24 v254, 7168, v254
    v_lshl_add_u32 v229, v253, 4, v254
    v_add_u32 v253, 128, v250
    v_mul_lo_u32 v254, v253, s66
    v_lshrrev_b32 v254, 16, v254
    v_mul_u32_u24 v230, 28, v254
    v_sub_u32 v253, v253, v230
    v_and_b32 v230, 12, v254
    v_add_u32 v254, v254, v230
    v_mul_u32_u24 v254, 7168, v254
    v_lshl_add_u32 v230, v253, 4, v254
    v_add_u32 v253, 192, v250
    v_mul_lo_u32 v254, v253, s66
    v_lshrrev_b32 v254, 16, v254
    v_mul_u32_u24 v231, 28, v254
    v_sub_u32 v253, v253, v231
    v_and_b32 v231, 12, v254
    v_add_u32 v254, v254, v231
    v_mul_u32_u24 v254, 7168, v254
    v_lshl_add_u32 v231, v253, 4, v254
    v_add_u32 v253, 256, v250
    v_mul_lo_u32 v254, v253, s66
    v_lshrrev_b32 v254, 16, v254
    v_mul_u32_u24 v232, 28, v254
    v_sub_u32 v253, v253, v232
    v_and_b32 v232, 12, v254
    v_add_u32 v254, v254, v232
    v_mul_u32_u24 v254, 7168, v254
    v_lshl_add_u32 v232, v253, 4, v254
    v_add_u32 v253, 320, v250
    v_mul_lo_u32 v254, v253, s66
    v_lshrrev_b32 v254, 16, v254
    v_mul_u32_u24 v233, 28, v254
    v_sub_u32 v253, v253, v233
    v_and_b32 v233, 12, v254
    v_add_u32 v254, v254, v233
    v_mul_u32_u24 v254, 7168, v254
    v_lshl_add_u32 v233, v253, 4, v254
    v_add_u32 v253, 384, v250
    v_mul_lo_u32 v254, v253, s66
    v_lshrrev_b32 v254, 16, v254
    v_mul_u32_u24 v234, 28, v254
    v_sub_u32 v253, v253, v234
    v_and_b32 v234, 12, v254
    v_add_u32 v254, v254, v234
    v_mul_u32_u24 v254, 7168, v254
    v_lshl_add_u32 v234, v253, 4, v254
    s_lshl_b32 s53, s75, 22
    s_lshl_b32 s64, s73, 18
    s_add_u32 s53, s53, s64
    s_add_u32 s53, s53, 12582912
    s_lshl_b32 s55, s69, 11
    s_add_u32 s53, s53, s55
    s_lshl_b32 s56, s75, 15
    s_lshl_b32 s66, s73, 9
    s_add_u32 s56, s56, s66
    s_add_u32 s56, s56, 75497472
    v_lshlrev_b32 v246, 5, v250
    s_lshl_b32 s62, 1, s72
    s_or_b32 s62, s62, 0x5555
    s_mov_b32 s63, 0
    s_xor_b32 s64, s72, 1
    s_or_b32 s64, s64, s69
    s_cselect_b32 s62, s62, 0xffff
    s_lshl_b32 s46, s75, 12
    s_add_u32 s46, s46, 75575296
    s_xor_b32 s47, s73, 2
    s_lshl_b32 s47, s47, 8
    s_add_u32 s47, s47, s46
    s_add_u32 s47, s47, 128
    s_mov_b64 exec, s[62:63]
pl_33:
    buffer_load_dwordx4 v[240:243], v246, s[80:83], s56 offen sc1
    s_sub_u32 s79, s79, 1
    s_cbranch_scc1 L_abort
    s_waitcnt vmcnt(0)
    v_and_b32 v240, v240, v241
    v_and_b32 v242, v242, v243
    v_and_b32 v240, v240, v242
    v_cmp_ne_u32 vcc, 1, v240
    s_cbranch_vccnz pl_33
    s_mov_b64 exec, -1
    s_cmp_lg_u32 s78, 0
    s_cbranch_scc1 pl_33_acq
pl_33_ok:
    s_lshr_b32 s64, s72, 1
    s_or_b32 s64, s64, s69
    s_cbranch_scc1 rl_34
    s_lshl_b32 s64, s73, 1
    s_add_u32 s64, s64, s68
    s_lshl_b32 s64, s64, 7
    s_add_u32 s64, s64, s46
    v_mov_b32 v242, 0
    v_mov_b32 v243, 1
    s_mov_b64 exec, 1
    buffer_store_dword v243, v242, s[80:83], s64 offen sc0 sc1
    s_mov_b64 exec, -1
rl_34:
    s_add_u32 s52, s58, 0
    s_and_b32 s52, s52, 7
    s_and_b32 s66, s74, 8
    s_or_b32 s52, s52, s66
    s_lshl_b32 s52, s52, 14
    s_add_u32 s52, s52, s53
    s_add_u32 m0, s55, 0
    s_nop 0
    buffer_load_dwordx4 v249, s[80:83], s52 offen offset:0 sc1 lds
    buffer_load_dwordx4 v249, s[80:83], s52 offen offset:1024 sc1 lds
    s_add_u32 s52, s52, 8192
    s_add_u32 m0, s55, 8192
    s_nop 0
    buffer_load_dwordx4 v249, s[80:83], s52 offen offset:0 sc1 lds
    buffer_load_dwordx4 v249, s[80:83], s52 offen offset:1024 sc1 lds
    s_add_u32 s52, s52, 8192
    s_add_u32 s52, s58, 1
    s_and_b32 s52, s52, 7
    s_and_b32 s66, s74, 8
    s_or_b32 s52, s52, s66
    s_lshl_b32 s52, s52, 14
    s_add_u32 s52, s52, s53
    s_add_u32 m0, s55, 16384
    s_nop 0
    buffer_load_dwordx4 v249, s[80:83], s52 offen offset:0 sc1 lds
    buffer_load_dwordx4 v249, s[80:83], s52 offen offset:1024 sc1 lds
    s_add_u32 s52, s52, 8192
    s_add_u32 m0, s55, 24576
    s_nop 0
    buffer_load_dwordx4 v249, s[80:83], s52 offen offset:0 sc1 lds
    buffer_load_dwordx4 v249, s[80:83], s52 offen offset:1024 sc1 lds
    s_add_u32 s52, s52, 8192
    s_waitcnt vmcnt(4) lgkmcnt(0)
    s_barrier
    s_add_u32 s52, s58, 2
    s_and_b32 s52, s52, 7
    s_and_b32 s66, s74, 8
    s_or_b32 s52, s52, s66
    s_lshl_b32 s52, s52, 14
    s_add_u32 s52, s52, s53
    s_add_u32 m0, s55, 32768
    s_nop 0
    buffer_load_dwordx4 v249, s[80:83], s52 offen offset:0 sc1 lds
    buffer_load_dwordx4 v249, s[80:83], s52 offen offset:1024 sc1 lds
    s_add_u32 s52, s52, 8192
    s_add_u32 m0, s55, 40960
    s_nop 0
    buffer_load_dwordx4 v249, s[80:83], s52 offen offset:0 sc1 lds
    buffer_load_dwordx4 v249, s[80:83], s52 offen offset:1024 sc1 lds
    s_add_u32 s52, s52, 8192
    s_add_u32 s52, s58, 3
    s_and_b32 s52, s52, 7
    s_and_b32 s66, s74, 8
    s_or_b32 s52, s52, s66
    s_lshl_b32 s52, s52, 14
    s_add_u32 s52, s52, s53
    s_add_u32 m0, s55, 49152
    s_nop 0
    buffer_load_dwordx4 v249, s[80:83], s52 offen offset:0 sc1 lds
    buffer_load_dwordx4 v249, s[80:83], s52 offen offset:1024 sc1 lds
    s_add_u32 s52, s52, 8192
    s_waitcnt vmcnt(6)
    s_barrier
    s_add_u32 m0, s55, 57344
    s_nop 0
    buffer_load_dwordx4 v249, s[80:83], s52 offen offset:0 sc1 lds
    buffer_load_dwordx4 v249, s[80:83], s52 offen offset:1024 sc1 lds
    s_add_u32 s52, s52, 8192
    s_add_u32 s52, s58, 4
    s_and_b32 s52, s52, 7
    s_and_b32 s66, s74, 8
    s_or_b32 s52, s52, s66
    s_lshl_b32 s52, s52, 14
    s_add_u32 s52, s52, s53
    s_add_u32 m0, s55, 0
    s_nop 0
    buffer_load_dwordx4 v249, s[80:83], s52 offen offset:0 sc1 lds
    buffer_load_dwordx4 v249, s[80:83], s52 offen offset:1024 sc1 lds
    s_add_u32 s52, s52, 8192
    s_add_u32 m0, s55, 8192
    s_nop 0
    buffer_load_dwordx4 v249, s[80:83], s52 offen offset:0 sc1 lds
    buffer_load_dwordx4 v249, s[80:83], s52 offen offset:1024 sc1 lds
    s_add_u32 s52, s52, 8192
    s_waitcnt vmcnt(8)
    s_barrier
    s_add_u32 s52, s58, 5
    s_and_b32 s52, s52, 7
    s_and_b32 s66, s74, 8
    s_or_b32 s52, s52, s66
    s_lshl_b32 s52, s52, 14
    s_add_u32 s52, s52, s53
    s_add_u32 m0, s55, 16384
    s_nop 0
    buffer_load_dwordx4 v249, s[80:83], s52 offen offset:0 sc1 lds
    buffer_load_dwordx4 v249, s[80:83], s52 offen offset:1024 sc1 lds
    s_add_u32 s52, s52, 8192
    s_add_u32 m0, s55, 24576
    s_nop 0
    buffer_load_dwordx4 v249, s[80:83], s52 offen offset:0 sc1 lds
    buffer_load_dwordx4 v249, s[80:83], s52 offen offset:1024 sc1 lds
    s_add_u32 s52, s52, 8192
    s_waitcnt vmcnt(8)
    s_barrier
    s_add_u32 s52, s58, 6
    s_and_b32 s52, s52, 7
    s_and_b32 s66, s74, 8
    s_or_b32 s52, s52, s66
    s_lshl_b32 s52, s52, 14
    s_add_u32 s52, s52, s53
    s_add_u32 m0, s55, 32768
    s_nop 0
    buffer_load_dwordx4 v249, s[80:83], s52 offen offset:0 sc1 lds
    buffer_load_dwordx4 v249, s[80:83], s52 offen offset:1024 sc1 lds
    s_add_u32 s52, s52, 8192
    v_mov_b32 v246, 0
    buffer_load_dword v240, v246, s[80:83], s47 offen sc1
    s_add_u32 m0, s55, 40960
    s_nop 0
    buffer_load_dwordx4 v249, s[80:83], s52 offen offset:0 sc1 lds
    buffer_load_dwordx4 v249, s[80:83], s52 offen offset:1024 sc1 lds
    s_add_u32 s52, s52, 8192
    s_add_u32 s48, s58, 11
    s_and_b32 s48, s48, 7
    s_and_b32 s66, s74, 8
    s_xor_b32 s66, s66, 8
    s_or_b32 s48, s48, s66
    s_lshl_b32 s48, s48, 17
    s_add_u32 s48, s48, s49
    s_add_u32 m0, s51, 116224
    s_nop 0
    buffer_load_dwordx4 v244, s[12:15], s48 offen lds
    s_add_u32 s48, s48, 65536
    s_waitcnt vmcnt(10)
    s_barrier
    s_add_u32 s52, s58, 7
    s_and_b32 s52, s52, 7
    s_and_b32 s66, s74, 8
    s_or_b32 s52, s52, s66
    s_lshl_b32 s52, s52, 14
    s_add_u32 s52, s52, s53
    s_add_u32 m0, s55, 49152
    s_nop 0
    buffer_load_dwordx4 v249, s[80:83], s52 offen offset:0 sc1 lds
    buffer_load_dwordx4 v249, s[80:83], s52 offen offset:1024 sc1 lds
    s_add_u32 s52, s52, 8192
    s_add_u32 m0, s55, 57344
    s_nop 0
    buffer_load_dwordx4 v249, s[80:83], s52 offen offset:0 sc1 lds
    buffer_load_dwordx4 v249, s[80:83], s52 offen offset:1024 sc1 lds
    s_add_u32 s52, s52, 8192
    s_add_u32 m0, s51, 120448
    s_nop 0
    buffer_load_dwordx4 v244, s[12:15], s48 offen lds
    s_add_u32 s48, s48, 65536
    s_waitcnt vmcnt(11)
    s_barrier
    s_waitcnt vmcnt(8)
    v_cmp_ne_u32 vcc, 1, v240
    s_or_b32 s64, vcc_lo, s78
    s_cbranch_scc1 rc_35
rc_35_b:
    s_add_u32 s52, s58, 8
    s_and_b32 s52, s52, 7
    s_and_b32 s66, s74, 8
    s_xor_b32 s66, s66, 8
    s_or_b32 s52, s52, s66
    s_lshl_b32 s52, s52, 14
    s_add_u32 s52, s52, s53
    s_add_u32 m0, s55, 0
    s_nop 0
    buffer_load_dwordx4 v249, s[80:83], s52 offen offset:0 sc1 lds
    buffer_load_dwordx4 v249, s[80:83], s52 offen offset:1024 sc1 lds
    s_add_u32 s52, s52, 8192
    s_add_u32 m0, s55, 8192
    s_nop 0
    buffer_load_dwordx4 v249, s[80:83], s52 offen offset:0 sc1 lds
    buffer_load_dwordx4 v249, s[80:83], s52 offen offset:1024 sc1 lds
    s_add_u32 s52, s52, 8192
    s_add_u32 s48, s58, 12
    s_and_b32 s48, s48, 7
    s_and_b32 s66, s74, 8
    s_xor_b32 s66, s66, 8
    s_or_b32 s48, s48, s66
    s_lshl_b32 s48, s48, 17
    s_add_u32 s48, s48, s49
    s_add_u32 m0, s51, 124672
    s_nop 0
    buffer_load_dwordx4 v244, s[12:15], s48 offen lds
    s_add_u32 s48, s48, 65536
    s_waitcnt vmcnt(11)
    s_barrier
    s_add_u32 s52, s58, 9
    s_and_b32 s52, s52, 7
    s_and_b32 s66, s74, 8
    s_xor_b32 s66, s66, 8
    s_or_b32 s52, s52, s66
    s_lshl_b32 s52, s52, 14
    s_add_u32 s52, s52, s53
    s_add_u32 m0, s55, 16384
    s_nop 0
    buffer_load_dwordx4 v249, s[80:83], s52 offen offset:0 sc1 lds
    buffer_load_dwordx4 v249, s[80:83], s52 offen offset:1024 sc1 lds
    s_add_u32 s52, s52, 8192
    s_add_u32 m0, s55, 24576
    s_nop 0
    buffer_load_dwordx4 v249, s[80:83], s52 offen offset:0 sc1 lds
    buffer_load_dwordx4 v249, s[80:83], s52 offen offset:1024 sc1 lds
    s_add_u32 s52, s52, 8192
    s_add_u32 m0, s51, 128896
    s_nop 0
    buffer_load_dwordx4 v244, s[12:15], s48 offen lds
    s_add_u32 s48, s48, 65536
    s_waitcnt vmcnt(11)
    s_barrier
    s_add_u32 s52, s58, 10
    s_and_b32 s52, s52, 7
    s_and_b32 s66, s74, 8
    s_xor_b32 s66, s66, 8
    s_or_b32 s52, s52, s66
    s_lshl_b32 s52, s52, 14
    s_add_u32 s52, s52, s53
    s_add_u32 m0, s55, 32768
    s_nop 0
    buffer_load_dwordx4 v249, s[80:83], s52 offen offset:0 sc1 lds
    buffer_load_dwordx4 v249, s[80:83], s52 offen offset:1024 sc1 lds
    s_add_u32 s52, s52, 8192
    s_add_u32 m0, s55, 40960
    s_nop 0
    buffer_load_dwordx4 v249, s[80:83], s52 offen offset:0 sc1 lds
    buffer_load_dwordx4 v249, s[80:83], s52 offen offset:1024 sc1 lds
    s_add_u32 s52, s52, 8192
    s_add_u32 s48, s58, 13
    s_and_b32 s48, s48, 7
    s_and_b32 s66, s74, 8
    s_xor_b32 s66, s66, 8
    s_or_b32 s48, s48, s66
    s_lshl_b32 s48, s48, 17
    s_add_u32 s48, s48, s49
    s_add_u32 m0, s51, 133120
    s_nop 0
    buffer_load_dwordx4 v244, s[12:15], s48 offen lds
    s_add_u32 s48, s48, 65536
    s_waitcnt vmcnt(11)
    s_barrier
    s_add_u32 s52, s58, 11
    s_and_b32 s52, s52, 7
    s_and_b32 s66, s74, 8
    s_xor_b32 s66, s66, 8
    s_or_b32 s52, s52, s66
    s_lshl_b32 s52, s52, 14
    s_add_u32 s52, s52, s53
    s_add_u32 m0, s55, 49152
    s_nop 0
    buffer_load_dwordx4 v249, s[80:83], s52 offen offset:0 sc1 lds
    buffer_load_dwordx4 v249, s[80:83], s52 offen offset:1024 sc1 lds
    s_add_u32 s52, s52, 8192
    s_add_u32 m0, s55, 57344
    s_nop 0
    buffer_load_dwordx4 v249, s[80:83], s52 offen offset:0 sc1 lds
    buffer_load_dwordx4 v249, s[80:83], s52 offen offset:1024 sc1 lds
    s_add_u32 s52, s52, 8192
    s_add_u32 m0, s51, 137344
    s_nop 0
    buffer_load_dwordx4 v244, s[12:15], s48 offen lds
    s_add_u32 s48, s48, 65536
    s_waitcnt vmcnt(11)
    s_barrier
    s_add_u32 s52, s58, 12
    s_and_b32 s52, s52, 7
    s_and_b32 s66, s74, 8
    s_xor_b32 s66, s66, 8
    s_or_b32 s52, s52, s66
    s_lshl_b32 s52, s52, 14
    s_add_u32 s52, s52, s53
    s_add_u32 m0, s55, 0
    s_nop 0
    buffer_load_dwordx4 v249, s[80:83], s52 offen offset:0 sc1 lds
    buffer_load_dwordx4 v249, s[80:83], s52 offen offset:1024 sc1 lds
    s_add_u32 s52, s52, 8192
    s_add_u32 m0, s55, 8192
    s_nop 0
    buffer_load_dwordx4 v249, s[80:83], s52 offen offset:0 sc1 lds
    buffer_load_dwordx4 v249, s[80:83], s52 offen offset:1024 sc1 lds
    s_add_u32 s52, s52, 8192
    s_add_u32 s48, s58, 14
    s_and_b32 s48, s48, 7
    s_and_b32 s66, s74, 8
    s_xor_b32 s66, s66, 8
    s_or_b32 s48, s48, s66
    s_lshl_b32 s48, s48, 17
    s_add_u32 s48, s48, s49
    s_add_u32 m0, s51, 141568
    s_nop 0
    buffer_load_dwordx4 v244, s[12:15], s48 offen lds
    s_add_u32 s48, s48, 65536
    s_waitcnt vmcnt(11)
    s_barrier
    s_add_u32 s52, s58, 13
    s_and_b32 s52, s52, 7
    s_and_b32 s66, s74, 8
    s_xor_b32 s66, s66, 8
    s_or_b32 s52, s52, s66
    s_lshl_b32 s52, s52, 14
    s_add_u32 s52, s52, s53
    s_add_u32 m0, s55, 16384
    s_nop 0
    buffer_load_dwordx4 v249, s[80:83], s52 offen offset:0 sc1 lds
    buffer_load_dwordx4 v249, s[80:83], s52 offen offset:1024 sc1 lds
    s_add_u32 s52, s52, 8192
    s_add_u32 m0, s55, 24576
    s_nop 0
    buffer_load_dwordx4 v249, s[80:83], s52 offen offset:0 sc1 lds
    buffer_load_dwordx4 v249, s[80:83], s52 offen offset:1024 sc1 lds
    s_add_u32 s52, s52, 8192
    s_add_u32 m0, s51, 145792
    s_nop 0
    buffer_load_dwordx4 v244, s[12:15], s48 offen lds
    s_add_u32 s48, s48, 65536
    s_waitcnt vmcnt(11)
    s_barrier
    s_add_u32 s52, s58, 14
    s_and_b32 s52, s52, 7
    s_and_b32 s66, s74, 8
    s_xor_b32 s66, s66, 8
    s_or_b32 s52, s52, s66
    s_lshl_b32 s52, s52, 14
    s_add_u32 s52, s52, s53
    s_add_u32 m0, s55, 32768
    s_nop 0
    buffer_load_dwordx4 v249, s[80:83], s52 offen offset:0 sc1 lds
    buffer_load_dwordx4 v249, s[80:83], s52 offen offset:1024 sc1 lds
    s_add_u32 s52, s52, 8192
    s_add_u32 m0, s55, 40960
    s_nop 0
    buffer_load_dwordx4 v249, s[80:83], s52 offen offset:0 sc1 lds
    buffer_load_dwordx4 v249, s[80:83], s52 offen offset:1024 sc1 lds
    s_add_u32 s52, s52, 8192
    s_add_u32 s48, s58, 15
    s_and_b32 s48, s48, 7
    s_and_b32 s66, s74, 8
    s_xor_b32 s66, s66, 8
    s_or_b32 s48, s48, s66
    s_lshl_b32 s48, s48, 17
    s_add_u32 s48, s48, s49
    s_add_u32 m0, s51, 150016
    s_nop 0
    buffer_load_dwordx4 v244, s[12:15], s48 offen lds
    s_add_u32 s48, s48, 65536
    s_waitcnt vmcnt(11)
    s_barrier
    s_add_u32 s52, s58, 15
    s_and_b32 s52, s52, 7
    s_and_b32 s66, s74, 8
    s_xor_b32 s66, s66, 8
    s_or_b32 s52, s52, s66
    s_lshl_b32 s52, s52, 14
    s_add_u32 s52, s52, s53
    s_add_u32 m0, s55, 49152
    s_nop 0
    buffer_load_dwordx4 v249, s[80:83], s52 offen offset:0 sc1 lds
    buffer_load_dwordx4 v249, s[80:83], s52 offen offset:1024 sc1 lds
    s_add_u32 s52, s52, 8192
    s_add_u32 m0, s55, 57344
    s_nop 0
    buffer_load_dwordx4 v249, s[80:83], s52 offen offset:0 sc1 lds
    buffer_load_dwordx4 v249, s[80:83], s52 offen offset:1024 sc1 lds
    s_add_u32 s52, s52, 8192
    s_add_u32 m0, s51, 154240
    s_nop 0
    buffer_load_dwordx4 v244, s[12:15], s48 offen lds
    s_add_u32 s48, s48, 65536
    s_waitcnt vmcnt(11)
    s_barrier
    s_add_u32 m0, s19, 28800
    s_nop 0
    buffer_load_dwordx4 v228, s[8:11], s16 offen lds
    s_add_u32 m0, s19, 29824
    s_nop 0
    buffer_load_dwordx4 v229, s[8:11], s16 offen lds
    s_add_u32 m0, s19, 30848
    s_nop 0
    buffer_load_dwordx4 v230, s[8:11], s16 offen lds
    s_waitcnt vmcnt(3)
    s_barrier
    s_add_u32 m0, s19, 31872
    s_nop 0
    buffer_load_dwordx4 v231, s[8:11], s16 offen lds
    s_add_u32 m0, s19, 32896
    s_nop 0
    buffer_load_dwordx4 v232, s[8:11], s16 offen lds
    s_add_u32 m0, s19, 33920
    s_nop 0
    buffer_load_dwordx4 v233, s[8:11], s16 offen lds
    s_add_u32 m0, s19, 34944
    s_nop 0
    buffer_load_dwordx4 v234, s[8:11], s16 offen lds
    s_add_u32 s16, s16, 229376
    s_cmp_eq_u32 s16, s18
    s_cselect_b32 s16, s17, s16
    s_add_u32 m0, s19, 57600
    s_nop 0
    buffer_load_dwordx4 v228, s[8:11], s16 offen lds
    s_add_u32 m0, s19, 58624
    s_nop 0
    buffer_load_dwordx4 v229, s[8:11], s16 offen lds
    s_add_u32 m0, s19, 59648
    s_nop 0
    buffer_load_dwordx4 v230, s[8:11], s16 offen lds
    s_add_u32 m0, s19, 60672
    s_nop 0
    buffer_load_dwordx4 v231, s[8:11], s16 offen lds
    s_add_u32 m0, s19, 61696
    s_nop 0
    buffer_load_dwordx4 v232, s[8:11], s16 offen lds
    s_add_u32 m0, s19, 62720
    s_nop 0
    buffer_load_dwordx4 v233, s[8:11], s16 offen lds
    s_add_u32 m0, s19, 63744
    s_nop 0
    buffer_load_dwordx4 v234, s[8:11], s16 offen lds
    s_add_u32 s16, s16, 229376
    s_cmp_eq_u32 s16, s18
    s_cselect_b32 s16, s17, s16
    s_barrier
    s_setprio 0
    s_and_b32 s64, s69, 2
    s_xor_b32 s32, s73, s64
    s_lshl_b32 s21, s75, 23
    s_lshl_b32 s64, s32, 18
    s_add_u32 s21, s21, s64
    s_lshl_b32 s64, s68, 1
    s_and_b32 s65, s69, 1
    s_add_u32 s33, s64, s65
    s_lshl_b32 s64, s33, 11
    s_add_u32 s21, s21, s64
    s_lshl_b32 s23, s69, 11
    s_add_u32 s22, s21, 262144
    s_lshl_b32 s64, s57, 14
    s_add_u32 s20, s21, s64
    s_add_u32 s34, s58, s71
    s_lshl_b32 s34, s34, 1
    s_add_u32 s34, s34, s68
    s_and_b32 s64, s3, 1
    s_lshl_b32 s64, s64, 12
    v_add_u32 v235, s64, v249
    v_lshrrev_b32 v253, 1, v251
    v_lshrrev_b32 v254, 2, v252
    v_lshl_add_u32 v253, v253, 2, v254
    v_mul_u32_u24 v253, 448, v253
    v_and_b32 v254, 1, v251
    v_mul_u32_u24 v254, 7200, v254
    v_add_u32 v253, v253, v254
    v_and_b32 v254, 3, v252
    v_lshl_add_u32 v253, v254, 3, v253
    v_add_u32 v253, 36736, v253
    s_lshr_b32 s64, s69, 1
    s_lshl_b32 s28, s64, 2
    s_add_u32 s28, s28, 8
    s_lshl_b32 s65, s28, 5
    v_add_u32 v236, s65, v253
    v_add_u32 v237, 57600, v236
    s_add_u32 s65, s64, 10
    s_lshl_b32 s65, s65, 5
    v_add_u32 v238, s65, v253
    v_add_u32 v239, 57600, v238
    s_mul_i32 s65, s64, 224
    s_and_b32 s64, s3, 1
    s_mul_i32 s64, s64, 14400
    s_add_u32 s65, s65, s64
    v_add_u32 v224, s65, v253
    v_mov_b32 v220, 0x3f803f80
    v_mov_b32 v221, 0x3f803f80
    v_mov_b32 v222, 0x3f803f80
    v_mov_b32 v223, 0x3f803f80
    s_lshl_b32 s25, s73, 1
    s_add_u32 s25, s25, s68
    s_mul_i32 s25, s25, 458752
    s_lshl_b32 s66, s60, 24
    s_add_u32 s25, s25, s66
    s_add_u32 s25, s25, 20971520
    s_and_b32 s64, s74, 7
    s_mul_i32 s64, s64, 57344
    s_add_u32 s25, s25, s64
    s_cmp_eq_u32 s75, 0
    s_cselect_b32 s27, 0, 8
    s_and_b32 s64, s34, 3
    s_or_b32 s27, s27, s64
    s_lshl_b32 s35, s75, 15
    s_lshl_b32 s66, s73, 9
    s_add_u32 s35, s35, s66
    s_add_u32 s35, s35, 75505664
    s_lshl_b32 s65, s68, 3
    s_add_u32 s35, s35, s65
    v_lshlrev_b32 v246, 5, v250
    s_lshl_b32 s36, s75, 12
    s_add_u32 s36, s36, 75563008
    s_xor_b32 s37, s73, 2
    s_lshl_b32 s37, s37, 1
    s_add_u32 s37, s37, s68
    s_lshl_b32 s37, s37, 7
    s_add_u32 s37, s37, s36
    s_cmp_ge_u32 s69, 2
    s_cbranch_scc1 lr_137
    s_mov_b64 exec, 0xffff
pl_138:
    buffer_load_dwordx2 v[240:241], v246, s[80:83], s35 offen sc1
    s_sub_u32 s79, s79, 1
    s_cbranch_scc1 L_abort
    s_waitcnt vmcnt(0)
    v_and_b32 v240, v240, v241
    v_cmp_ne_u32 vcc, 1, v240
    s_cbranch_vccnz pl_138
    s_mov_b64 exec, -1
    s_cmp_lg_u32 s78, 0
    s_cbranch_scc1 pl_138_acq
pl_138_ok:
    s_lshr_b32 s64, s72, 1
    s_or_b32 s64, s64, s69
    s_cbranch_scc1 rl_139
    s_lshl_b32 s64, s73, 1
    s_add_u32 s64, s64, s68
    s_lshl_b32 s64, s64, 7
    s_add_u32 s64, s64, s36
    v_mov_b32 v242, 0
    v_mov_b32 v243, 1
    s_mov_b64 exec, 1
    buffer_store_dword v243, v242, s[80:83], s64 offen sc0 sc1
    s_mov_b64 exec, -1
rl_139:
    s_branch lr_137_d
lr_137:
    s_mov_b64 exec, 1
pl_140:
    buffer_load_dword v240, v246, s[80:83], s37 offen sc1
    s_sub_u32 s79, s79, 1
    s_cbranch_scc1 L_abort
    s_waitcnt vmcnt(0)
    v_cmp_ne_u32 vcc, 1, v240
    s_cbranch_vccnz pl_140
    s_mov_b64 exec, -1
    s_cmp_lg_u32 s78, 0
    s_cbranch_scc1 pl_140_acq
pl_140_ok:
lr_137_d:
    s_add_u32 m0, s23, 0
    s_nop 0
    buffer_load_dwordx4 v249, s[80:83], s20 offen sc1 lds
    s_add_u32 m0, s23, 0
    s_nop 0
    buffer_load_dwordx4 v249, s[80:83], s20 offen offset:1024 sc1 lds
    s_add_u32 s20, s20, 8192
    s_cmp_eq_u32 s20, s22
    s_cselect_b32 s20, s21, s20
    s_add_u32 m0, s23, 8192
    s_nop 0
    buffer_load_dwordx4 v249, s[80:83], s20 offen sc1 lds
    s_add_u32 m0, s23, 8192
    s_nop 0
    buffer_load_dwordx4 v249, s[80:83], s20 offen offset:1024 sc1 lds
    s_add_u32 s20, s20, 8192
    s_cmp_eq_u32 s20, s22
    s_cselect_b32 s20, s21, s20
    s_add_u32 m0, s19, 86400
    s_nop 0
    buffer_load_dwordx4 v228, s[8:11], s16 offen lds
    s_add_u32 m0, s19, 87424
    s_nop 0
    buffer_load_dwordx4 v229, s[8:11], s16 offen lds
    s_add_u32 m0, s19, 88448
    s_nop 0
    buffer_load_dwordx4 v230, s[8:11], s16 offen lds
    s_add_u32 m0, s19, 89472
    s_nop 0
    buffer_load_dwordx4 v231, s[8:11], s16 offen lds
    s_waitcnt vmcnt(6)
    s_barrier
    ds_read_b128 v[144:147], v235 offset:0
    ds_read_b128 v[148:151], v235 offset:1024
    ds_read_b128 v[152:155], v235 offset:2048
    ds_read_b128 v[156:159], v235 offset:3072
    ds_read_b64_tr_b16 v[96:97], v236 offset:28800
    ds_read_b64_tr_b16 v[98:99], v236 offset:32384
    ds_read_b64_tr_b16 v[108:109], v236 offset:43200
    ds_read_b64_tr_b16 v[110:111], v236 offset:46784
    ds_read_b64_tr_b16 v[100:101], v236 offset:28832
    ds_read_b64_tr_b16 v[102:103], v236 offset:32416
    ds_read_b64_tr_b16 v[112:113], v236 offset:43232
    ds_read_b64_tr_b16 v[114:115], v236 offset:46816
    ds_read_b64_tr_b16 v[104:105], v238 offset:28800
    ds_read_b64_tr_b16 v[106:107], v238 offset:32384
    ds_read_b64_tr_b16 v[116:117], v238 offset:43200
    ds_read_b64_tr_b16 v[118:119], v238 offset:46784
    s_add_u32 m0, s19, 90496
    s_nop 0
    buffer_load_dwordx4 v232, s[8:11], s16 offen lds
    s_add_u32 m0, s19, 91520
    s_nop 0
    buffer_load_dwordx4 v233, s[8:11], s16 offen lds
    s_add_u32 m0, s19, 92544
    s_nop 0
    buffer_load_dwordx4 v234, s[8:11], s16 offen lds
    s_add_u32 s16, s16, 229376
    s_cmp_eq_u32 s16, s18
    s_cselect_b32 s16, s17, s16
    s_add_u32 m0, s23, 16384
    s_nop 0
    buffer_load_dwordx4 v249, s[80:83], s20 offen sc1 lds
    s_add_u32 m0, s23, 16384
    s_nop 0
    buffer_load_dwordx4 v249, s[80:83], s20 offen offset:1024 sc1 lds
    s_add_u32 s20, s20, 8192
    s_cmp_eq_u32 s20, s22
    s_cselect_b32 s20, s21, s20
    s_cmp_eq_u32 s27, 0
    s_cbranch_scc1 cs_141
cs_141_b:
    s_waitcnt vmcnt(9) lgkmcnt(0)
    s_barrier
    s_cmp_eq_u32 s27, 0
    s_cbranch_scc1 cs_142
cs_142_b:
    v_mfma_f32_16x16x32_bf16 v[0:3], v[96:99], v[144:147], 0
    ds_read_b128 v[160:163], v235 offset:8192
    ds_read_b128 v[164:167], v235 offset:9216
    v_mfma_f32_16x16x32_bf16 v[4:7], v[96:99], v[148:151], 0
    ds_read_b128 v[168:171], v235 offset:10240
    v_mfma_f32_16x16x32_bf16 v[8:11], v[96:99], v[152:155], 0
    ds_read_b128 v[172:175], v235 offset:11264
    v_mfma_f32_16x16x32_bf16 v[12:15], v[96:99], v[156:159], 0
    s_add_u32 m0, s19, 0
    s_nop 0
    buffer_load_dwordx4 v228, s[8:11], s16 offen lds
    v_mfma_f32_16x16x32_bf16 v[48:51], v[108:111], v[144:147], 0
    ds_read_b64_tr_b16 v[120:121], v237 offset:0
    v_mfma_f32_16x16x32_bf16 v[52:55], v[108:111], v[148:151], 0
    ds_read_b64_tr_b16 v[122:123], v237 offset:3584
    v_mfma_f32_16x16x32_bf16 v[56:59], v[108:111], v[152:155], 0
    ds_read_b64_tr_b16 v[132:133], v237 offset:14400
    v_mfma_f32_16x16x32_bf16 v[60:63], v[108:111], v[156:159], 0
    s_add_u32 m0, s19, 1024
    s_nop 0
    buffer_load_dwordx4 v229, s[8:11], s16 offen lds
    v_mfma_f32_16x16x32_bf16 v[16:19], v[100:103], v[144:147], 0
    ds_read_b64_tr_b16 v[134:135], v237 offset:17984
    v_mfma_f32_16x16x32_bf16 v[20:23], v[100:103], v[148:151], 0
    ds_read_b64_tr_b16 v[124:125], v237 offset:32
    v_mfma_f32_16x16x32_bf16 v[24:27], v[100:103], v[152:155], 0
    ds_read_b64_tr_b16 v[126:127], v237 offset:3616
    v_mfma_f32_16x16x32_bf16 v[28:31], v[100:103], v[156:159], 0
    s_add_u32 m0, s19, 2048
    s_nop 0
    buffer_load_dwordx4 v230, s[8:11], s16 offen lds
    s_add_u32 s16, s16, 229376
    s_cmp_eq_u32 s16, s18
    s_cselect_b32 s16, s17, s16
    v_mfma_f32_16x16x32_bf16 v[64:67], v[112:115], v[144:147], 0
    ds_read_b64_tr_b16 v[136:137], v237 offset:14432
    v_mfma_f32_16x16x32_bf16 v[68:71], v[112:115], v[148:151], 0
    ds_read_b64_tr_b16 v[138:139], v237 offset:18016
    v_mfma_f32_16x16x32_bf16 v[72:75], v[112:115], v[152:155], 0
    ds_read_b64_tr_b16 v[128:129], v239 offset:0
    v_mfma_f32_16x16x32_bf16 v[76:79], v[112:115], v[156:159], 0
    s_add_u32 m0, s23, 24576
    s_nop 0
    buffer_load_dwordx4 v249, s[80:83], s20 offen sc1 lds
    v_mfma_f32_16x16x32_bf16 v[32:35], v[104:107], v[144:147], 0
    ds_read_b64_tr_b16 v[130:131], v239 offset:3584
    v_mfma_f32_16x16x32_bf16 v[36:39], v[104:107], v[148:151], 0
    ds_read_b64_tr_b16 v[140:141], v239 offset:14400
    v_mfma_f32_16x16x32_bf16 v[40:43], v[104:107], v[152:155], 0
    ds_read_b64_tr_b16 v[142:143], v239 offset:17984
    v_mfma_f32_16x16x32_bf16 v[44:47], v[104:107], v[156:159], 0
    s_add_u32 m0, s23, 24576
    s_nop 0
    buffer_load_dwordx4 v249, s[80:83], s20 offen offset:1024 sc1 lds
    s_add_u32 s20, s20, 8192
    s_cmp_eq_u32 s20, s22
    s_cselect_b32 s20, s21, s20
    v_mfma_f32_16x16x32_bf16 v[80:83], v[116:119], v[144:147], 0
    v_mfma_f32_16x16x32_bf16 v[84:87], v[116:119], v[148:151], 0
    v_mfma_f32_16x16x32_bf16 v[88:91], v[116:119], v[152:155], 0
    v_mfma_f32_16x16x32_bf16 v[92:95], v[116:119], v[156:159], 0
    s_waitcnt vmcnt(5) lgkmcnt(0)
    s_barrier
    s_cmp_eq_u32 s27, 1
    s_cbranch_scc1 cs_143
cs_143_b:
    v_mfma_f32_16x16x32_bf16 v[0:3], v[120:123], v[160:163], v[0:3]
    ds_read_b128 v[144:147], v235 offset:16384
    ds_read_b128 v[148:151], v235 offset:17408
    v_mfma_f32_16x16x32_bf16 v[4:7], v[120:123], v[164:167], v[4:7]
    ds_read_b128 v[152:155], v235 offset:18432
    v_mfma_f32_16x16x32_bf16 v[8:11], v[120:123], v[168:171], v[8:11]
    ds_read_b128 v[156:159], v235 offset:19456
    v_mfma_f32_16x16x32_bf16 v[12:15], v[120:123], v[172:175], v[12:15]
    s_add_u32 m0, s19, 28800
    s_nop 0
    buffer_load_dwordx4 v228, s[8:11], s16 offen lds
    v_mfma_f32_16x16x32_bf16 v[48:51], v[132:135], v[160:163], v[48:51]
    ds_read_b64_tr_b16 v[96:97], v237 offset:28800
    v_mfma_f32_16x16x32_bf16 v[52:55], v[132:135], v[164:167], v[52:55]
    ds_read_b64_tr_b16 v[98:99], v237 offset:32384
    v_mfma_f32_16x16x32_bf16 v[56:59], v[132:135], v[168:171], v[56:59]
    ds_read_b64_tr_b16 v[108:109], v237 offset:43200
    v_mfma_f32_16x16x32_bf16 v[60:63], v[132:135], v[172:175], v[60:63]
    s_add_u32 m0, s19, 29824
    s_nop 0
    buffer_load_dwordx4 v229, s[8:11], s16 offen lds
    v_mfma_f32_16x16x32_bf16 v[16:19], v[124:127], v[160:163], v[16:19]
    ds_read_b64_tr_b16 v[110:111], v237 offset:46784
    v_mfma_f32_16x16x32_bf16 v[20:23], v[124:127], v[164:167], v[20:23]
    ds_read_b64_tr_b16 v[100:101], v237 offset:28832
    v_mfma_f32_16x16x32_bf16 v[24:27], v[124:127], v[168:171], v[24:27]
    ds_read_b64_tr_b16 v[102:103], v237 offset:32416
    v_mfma_f32_16x16x32_bf16 v[28:31], v[124:127], v[172:175], v[28:31]
    s_add_u32 m0, s19, 30848
    s_nop 0
    buffer_load_dwordx4 v230, s[8:11], s16 offen lds
    s_add_u32 s16, s16, 229376
    s_cmp_eq_u32 s16, s18
    s_cselect_b32 s16, s17, s16
    v_mfma_f32_16x16x32_bf16 v[64:67], v[136:139], v[160:163], v[64:67]
    ds_read_b64_tr_b16 v[112:113], v237 offset:43232
    v_mfma_f32_16x16x32_bf16 v[68:71], v[136:139], v[164:167], v[68:71]
    ds_read_b64_tr_b16 v[114:115], v237 offset:46816
    v_mfma_f32_16x16x32_bf16 v[72:75], v[136:139], v[168:171], v[72:75]
    ds_read_b64_tr_b16 v[104:105], v239 offset:28800
    v_mfma_f32_16x16x32_bf16 v[76:79], v[136:139], v[172:175], v[76:79]
    s_add_u32 m0, s23, 0
    s_nop 0
    buffer_load_dwordx4 v249, s[80:83], s20 offen sc1 lds
    v_mfma_f32_16x16x32_bf16 v[32:35], v[128:131], v[160:163], v[32:35]
    ds_read_b64_tr_b16 v[106:107], v239 offset:32384
    v_mfma_f32_16x16x32_bf16 v[36:39], v[128:131], v[164:167], v[36:39]
    ds_read_b64_tr_b16 v[116:117], v239 offset:43200
    v_mfma_f32_16x16x32_bf16 v[40:43], v[128:131], v[168:171], v[40:43]
    ds_read_b64_tr_b16 v[118:119], v239 offset:46784
    v_mfma_f32_16x16x32_bf16 v[44:47], v[128:131], v[172:175], v[44:47]
    s_add_u32 m0, s23, 0
    s_nop 0
    buffer_load_dwordx4 v249, s[80:83], s20 offen offset:1024 sc1 lds
    s_add_u32 s20, s20, 8192
    s_cmp_eq_u32 s20, s22
    s_cselect_b32 s20, s21, s20
    v_mfma_f32_16x16x32_bf16 v[80:83], v[140:143], v[160:163], v[80:83]
    v_mfma_f32_16x16x32_bf16 v[84:87], v[140:143], v[164:167], v[84:87]
    v_mfma_f32_16x16x32_bf16 v[88:91], v[140:143], v[168:171], v[88:91]
    v_mfma_f32_16x16x32_bf16 v[92:95], v[140:143], v[172:175], v[92:95]
    s_waitcnt vmcnt(5) lgkmcnt(0)
    s_barrier
    s_cmp_eq_u32 s27, 1
    s_cbranch_scc1 cs_144
cs_144_b:
    v_mfma_f32_16x16x32_bf16 v[0:3], v[96:99], v[144:147], v[0:3]
    ds_read_b128 v[160:163], v235 offset:24576
    ds_read_b128 v[164:167], v235 offset:25600
    v_mfma_f32_16x16x32_bf16 v[4:7], v[96:99], v[148:151], v[4:7]
    ds_read_b128 v[168:171], v235 offset:26624
    v_mfma_f32_16x16x32_bf16 v[8:11], v[96:99], v[152:155], v[8:11]
    ds_read_b128 v[172:175], v235 offset:27648
    v_mfma_f32_16x16x32_bf16 v[12:15], v[96:99], v[156:159], v[12:15]
    s_add_u32 m0, s19, 57600
    s_nop 0
    buffer_load_dwordx4 v228, s[8:11], s16 offen lds
    v_mfma_f32_16x16x32_bf16 v[48:51], v[108:111], v[144:147], v[48:51]
    ds_read_b64_tr_b16 v[120:121], v236 offset:0
    v_mfma_f32_16x16x32_bf16 v[52:55], v[108:111], v[148:151], v[52:55]
    ds_read_b64_tr_b16 v[122:123], v236 offset:3584
    v_mfma_f32_16x16x32_bf16 v[56:59], v[108:111], v[152:155], v[56:59]
    ds_read_b64_tr_b16 v[132:133], v236 offset:14400
    v_mfma_f32_16x16x32_bf16 v[60:63], v[108:111], v[156:159], v[60:63]
    s_add_u32 m0, s19, 58624
    s_nop 0
    buffer_load_dwordx4 v229, s[8:11], s16 offen lds
    v_mfma_f32_16x16x32_bf16 v[16:19], v[100:103], v[144:147], v[16:19]
    ds_read_b64_tr_b16 v[134:135], v236 offset:17984
    v_mfma_f32_16x16x32_bf16 v[20:23], v[100:103], v[148:151], v[20:23]
    ds_read_b64_tr_b16 v[124:125], v236 offset:32
    v_mfma_f32_16x16x32_bf16 v[24:27], v[100:103], v[152:155], v[24:27]
    ds_read_b64_tr_b16 v[126:127], v236 offset:3616
    v_mfma_f32_16x16x32_bf16 v[28:31], v[100:103], v[156:159], v[28:31]
    s_add_u32 m0, s19, 59648
    s_nop 0
    buffer_load_dwordx4 v230, s[8:11], s16 offen lds
    s_add_u32 s16, s16, 229376
    s_cmp_eq_u32 s16, s18
    s_cselect_b32 s16, s17, s16
    v_mfma_f32_16x16x32_bf16 v[64:67], v[112:115], v[144:147], v[64:67]
    ds_read_b64_tr_b16 v[136:137], v236 offset:14432
    v_mfma_f32_16x16x32_bf16 v[68:71], v[112:115], v[148:151], v[68:71]
    ds_read_b64_tr_b16 v[138:139], v236 offset:18016
    v_mfma_f32_16x16x32_bf16 v[72:75], v[112:115], v[152:155], v[72:75]
    ds_read_b64_tr_b16 v[128:129], v238 offset:0
    v_mfma_f32_16x16x32_bf16 v[76:79], v[112:115], v[156:159], v[76:79]
    s_add_u32 m0, s23, 8192
    s_nop 0
    buffer_load_dwordx4 v249, s[80:83], s20 offen sc1 lds
    v_mfma_f32_16x16x32_bf16 v[32:35], v[104:107], v[144:147], v[32:35]
    ds_read_b64_tr_b16 v[130:131], v238 offset:3584
    v_mfma_f32_16x16x32_bf16 v[36:39], v[104:107], v[148:151], v[36:39]
    ds_read_b64_tr_b16 v[140:141], v238 offset:14400
    v_mfma_f32_16x16x32_bf16 v[40:43], v[104:107], v[152:155], v[40:43]
    ds_read_b64_tr_b16 v[142:143], v238 offset:17984
    v_mfma_f32_16x16x32_bf16 v[44:47], v[104:107], v[156:159], v[44:47]
    s_add_u32 m0, s23, 8192
    s_nop 0
    buffer_load_dwordx4 v249, s[80:83], s20 offen offset:1024 sc1 lds
    s_add_u32 s20, s20, 8192
    s_cmp_eq_u32 s20, s22
    s_cselect_b32 s20, s21, s20
    v_mfma_f32_16x16x32_bf16 v[80:83], v[116:119], v[144:147], v[80:83]
    v_mfma_f32_16x16x32_bf16 v[84:87], v[116:119], v[148:151], v[84:87]
    v_mfma_f32_16x16x32_bf16 v[88:91], v[116:119], v[152:155], v[88:91]
    v_mfma_f32_16x16x32_bf16 v[92:95], v[116:119], v[156:159], v[92:95]
    s_waitcnt vmcnt(5) lgkmcnt(0)
    s_barrier
    s_cmp_eq_u32 s27, 2
    s_cbranch_scc1 cs_145
cs_145_b:
    v_mfma_f32_16x16x32_bf16 v[0:3], v[120:123], v[160:163], v[0:3]
    ds_read_b128 v[144:147], v235 offset:0
    ds_read_b128 v[148:151], v235 offset:1024
    v_mfma_f32_16x16x32_bf16 v[4:7], v[120:123], v[164:167], v[4:7]
    ds_read_b128 v[152:155], v235 offset:2048
    v_mfma_f32_16x16x32_bf16 v[8:11], v[120:123], v[168:171], v[8:11]
    ds_read_b128 v[156:159], v235 offset:3072
    v_mfma_f32_16x16x32_bf16 v[12:15], v[120:123], v[172:175], v[12:15]
    s_add_u32 m0, s19, 86400
    s_nop 0
    buffer_load_dwordx4 v228, s[8:11], s16 offen lds
    v_mfma_f32_16x16x32_bf16 v[48:51], v[132:135], v[160:163], v[48:51]
    ds_read_b64_tr_b16 v[96:97], v236 offset:28800
    v_mfma_f32_16x16x32_bf16 v[52:55], v[132:135], v[164:167], v[52:55]
    ds_read_b64_tr_b16 v[98:99], v236 offset:32384
    v_mfma_f32_16x16x32_bf16 v[56:59], v[132:135], v[168:171], v[56:59]
    ds_read_b64_tr_b16 v[108:109], v236 offset:43200
    v_mfma_f32_16x16x32_bf16 v[60:63], v[132:135], v[172:175], v[60:63]
    s_add_u32 m0, s19, 87424
    s_nop 0
    buffer_load_dwordx4 v229, s[8:11], s16 offen lds
    v_mfma_f32_16x16x32_bf16 v[16:19], v[124:127], v[160:163], v[16:19]
    ds_read_b64_tr_b16 v[110:111], v236 offset:46784
    v_mfma_f32_16x16x32_bf16 v[20:23], v[124:127], v[164:167], v[20:23]
    ds_read_b64_tr_b16 v[100:101], v236 offset:28832
    v_mfma_f32_16x16x32_bf16 v[24:27], v[124:127], v[168:171], v[24:27]
    ds_read_b64_tr_b16 v[102:103], v236 offset:32416
    v_mfma_f32_16x16x32_bf16 v[28:31], v[124:127], v[172:175], v[28:31]
    s_add_u32 m0, s19, 88448
    s_nop 0
    buffer_load_dwordx4 v230, s[8:11], s16 offen lds
    s_add_u32 s16, s16, 229376
    s_cmp_eq_u32 s16, s18
    s_cselect_b32 s16, s17, s16
    v_mfma_f32_16x16x32_bf16 v[64:67], v[136:139], v[160:163], v[64:67]
    ds_read_b64_tr_b16 v[112:113], v236 offset:43232
    v_mfma_f32_16x16x32_bf16 v[68:71], v[136:139], v[164:167], v[68:71]
    ds_read_b64_tr_b16 v[114:115], v236 offset:46816
    v_mfma_f32_16x16x32_bf16 v[72:75], v[136:139], v[168:171], v[72:75]
    ds_read_b64_tr_b16 v[104:105], v238 offset:28800
    v_mfma_f32_16x16x32_bf16 v[76:79], v[136:139], v[172:175], v[76:79]
    s_add_u32 m0, s23, 16384
    s_nop 0
    buffer_load_dwordx4 v249, s[80:83], s20 offen sc1 lds
    v_mfma_f32_16x16x32_bf16 v[32:35], v[128:131], v[160:163], v[32:35]
    ds_read_b64_tr_b16 v[106:107], v238 offset:32384
    v_mfma_f32_16x16x32_bf16 v[36:39], v[128:131], v[164:167], v[36:39]
    ds_read_b64_tr_b16 v[116:117], v238 offset:43200
    v_mfma_f32_16x16x32_bf16 v[40:43], v[128:131], v[168:171], v[40:43]
    ds_read_b64_tr_b16 v[118:119], v238 offset:46784
    v_mfma_f32_16x16x32_bf16 v[44:47], v[128:131], v[172:175], v[44:47]
    s_add_u32 m0, s23, 16384
    s_nop 0
    buffer_load_dwordx4 v249, s[80:83], s20 offen offset:1024 sc1 lds
    s_add_u32 s20, s20, 8192
    s_cmp_eq_u32 s20, s22
    s_cselect_b32 s20, s21, s20
    v_mfma_f32_16x16x32_bf16 v[80:83], v[140:143], v[160:163], v[80:83]
    v_mfma_f32_16x16x32_bf16 v[84:87], v[140:143], v[164:167], v[84:87]
    v_mfma_f32_16x16x32_bf16 v[88:91], v[140:143], v[168:171], v[88:91]
    v_mfma_f32_16x16x32_bf16 v[92:95], v[140:143], v[172:175], v[92:95]
    s_waitcnt vmcnt(5) lgkmcnt(0)
    s_barrier
    s_cmp_eq_u32 s27, 2
    s_cbranch_scc1 cs_146
cs_146_b:
    v_mfma_f32_16x16x32_bf16 v[0:3], v[96:99], v[144:147], v[0:3]
    ds_read_b128 v[160:163], v235 offset:8192
    ds_read_b128 v[164:167], v235 offset:9216
    v_mfma_f32_16x16x32_bf16 v[4:7], v[96:99], v[148:151], v[4:7]
    ds_read_b128 v[168:171], v235 offset:10240
    v_mfma_f32_16x16x32_bf16 v[8:11], v[96:99], v[152:155], v[8:11]
    ds_read_b128 v[172:175], v235 offset:11264
    v_mfma_f32_16x16x32_bf16 v[12:15], v[96:99], v[156:159], v[12:15]
    s_add_u32 m0, s19, 0
    s_nop 0
    buffer_load_dwordx4 v228, s[8:11], s16 offen lds
    v_mfma_f32_16x16x32_bf16 v[48:51], v[108:111], v[144:147], v[48:51]
    ds_read_b64_tr_b16 v[120:121], v237 offset:0
    v_mfma_f32_16x16x32_bf16 v[52:55], v[108:111], v[148:151], v[52:55]
    ds_read_b64_tr_b16 v[122:123], v237 offset:3584
    v_mfma_f32_16x16x32_bf16 v[56:59], v[108:111], v[152:155], v[56:59]
    ds_read_b64_tr_b16 v[132:133], v237 offset:14400
    v_mfma_f32_16x16x32_bf16 v[60:63], v[108:111], v[156:159], v[60:63]
    s_add_u32 m0, s19, 1024
    s_nop 0
    buffer_load_dwordx4 v229, s[8:11], s16 offen lds
    v_mfma_f32_16x16x32_bf16 v[16:19], v[100:103], v[144:147], v[16:19]
    ds_read_b64_tr_b16 v[134:135], v237 offset:17984
    v_mfma_f32_16x16x32_bf16 v[20:23], v[100:103], v[148:151], v[20:23]
    ds_read_b64_tr_b16 v[124:125], v237 offset:32
    v_mfma_f32_16x16x32_bf16 v[24:27], v[100:103], v[152:155], v[24:27]
    ds_read_b64_tr_b16 v[126:127], v237 offset:3616
    v_mfma_f32_16x16x32_bf16 v[28:31], v[100:103], v[156:159], v[28:31]
    s_add_u32 m0, s19, 2048
    s_nop 0
    buffer_load_dwordx4 v230, s[8:11], s16 offen lds
    s_add_u32 s16, s16, 229376
    s_cmp_eq_u32 s16, s18
    s_cselect_b32 s16, s17, s16
    v_mfma_f32_16x16x32_bf16 v[64:67], v[112:115], v[144:147], v[64:67]
    ds_read_b64_tr_b16 v[136:137], v237 offset:14432
    v_mfma_f32_16x16x32_bf16 v[68:71], v[112:115], v[148:151], v[68:71]
    ds_read_b64_tr_b16 v[138:139], v237 offset:18016
    v_mfma_f32_16x16x32_bf16 v[72:75], v[112:115], v[152:155], v[72:75]
    ds_read_b64_tr_b16 v[128:129], v239 offset:0
    v_mfma_f32_16x16x32_bf16 v[76:79], v[112:115], v[156:159], v[76:79]
    s_add_u32 m0, s23, 24576
    s_nop 0
    buffer_load_dwordx4 v249, s[80:83], s20 offen sc1 lds
    v_mfma_f32_16x16x32_bf16 v[32:35], v[104:107], v[144:147], v[32:35]
    ds_read_b64_tr_b16 v[130:131], v239 offset:3584
    v_mfma_f32_16x16x32_bf16 v[36:39], v[104:107], v[148:151], v[36:39]
    ds_read_b64_tr_b16 v[140:141], v239 offset:14400
    v_mfma_f32_16x16x32_bf16 v[40:43], v[104:107], v[152:155], v[40:43]
    ds_read_b64_tr_b16 v[142:143], v239 offset:17984
    v_mfma_f32_16x16x32_bf16 v[44:47], v[104:107], v[156:159], v[44:47]
    s_add_u32 m0, s23, 24576
    s_nop 0
    buffer_load_dwordx4 v249, s[80:83], s20 offen offset:1024 sc1 lds
    s_add_u32 s20, s20, 8192
    s_cmp_eq_u32 s20, s22
    s_cselect_b32 s20, s21, s20
    v_mfma_f32_16x16x32_bf16 v[80:83], v[116:119], v[144:147], v[80:83]
    v_mfma_f32_16x16x32_bf16 v[84:87], v[116:119], v[148:151], v[84:87]
    v_mfma_f32_16x16x32_bf16 v[88:91], v[116:119], v[152:155], v[88:91]
    v_mfma_f32_16x16x32_bf16 v[92:95], v[116:119], v[156:159], v[92:95]
    s_waitcnt vmcnt(5) lgkmcnt(0)
    s_barrier
    s_cmp_eq_u32 s27, 3
    s_cbranch_scc1 cs_147
cs_147_b:
    v_mfma_f32_16x16x32_bf16 v[0:3], v[120:123], v[160:163], v[0:3]
    ds_read_b128 v[144:147], v235 offset:16384
    ds_read_b128 v[148:151], v235 offset:17408
    v_mfma_f32_16x16x32_bf16 v[4:7], v[120:123], v[164:167], v[4:7]
    ds_read_b128 v[152:155], v235 offset:18432
    v_mfma_f32_16x16x32_bf16 v[8:11], v[120:123], v[168:171], v[8:11]
    ds_read_b128 v[156:159], v235 offset:19456
    v_mfma_f32_16x16x32_bf16 v[12:15], v[120:123], v[172:175], v[12:15]
    s_add_u32 m0, s19, 28800
    s_nop 0
    buffer_load_dwordx4 v228, s[8:11], s16 offen lds
    v_mfma_f32_16x16x32_bf16 v[48:51], v[132:135], v[160:163], v[48:51]
    ds_read_b64_tr_b16 v[96:97], v237 offset:28800
    v_mfma_f32_16x16x32_bf16 v[52:55], v[132:135], v[164:167], v[52:55]
    ds_read_b64_tr_b16 v[98:99], v237 offset:32384
    v_mfma_f32_16x16x32_bf16 v[56:59], v[132:135], v[168:171], v[56:59]
    ds_read_b64_tr_b16 v[108:109], v237 offset:43200
    v_mfma_f32_16x16x32_bf16 v[60:63], v[132:135], v[172:175], v[60:63]
    s_add_u32 m0, s19, 29824
    s_nop 0
    buffer_load_dwordx4 v229, s[8:11], s16 offen lds
    v_mfma_f32_16x16x32_bf16 v[16:19], v[124:127], v[160:163], v[16:19]
    ds_read_b64_tr_b16 v[110:111], v237 offset:46784
    v_mfma_f32_16x16x32_bf16 v[20:23], v[124:127], v[164:167], v[20:23]
    ds_read_b64_tr_b16 v[100:101], v237 offset:28832
    v_mfma_f32_16x16x32_bf16 v[24:27], v[124:127], v[168:171], v[24:27]
    ds_read_b64_tr_b16 v[102:103], v237 offset:32416
    v_mfma_f32_16x16x32_bf16 v[28:31], v[124:127], v[172:175], v[28:31]
    s_add_u32 m0, s19, 30848
    s_nop 0
    buffer_load_dwordx4 v230, s[8:11], s16 offen lds
    s_add_u32 s16, s16, 229376
    s_cmp_eq_u32 s16, s18
    s_cselect_b32 s16, s17, s16
    v_mfma_f32_16x16x32_bf16 v[64:67], v[136:139], v[160:163], v[64:67]
    ds_read_b64_tr_b16 v[112:113], v237 offset:43232
    v_mfma_f32_16x16x32_bf16 v[68:71], v[136:139], v[164:167], v[68:71]
    ds_read_b64_tr_b16 v[114:115], v237 offset:46816
    v_mfma_f32_16x16x32_bf16 v[72:75], v[136:139], v[168:171], v[72:75]
    ds_read_b64_tr_b16 v[104:105], v239 offset:28800
    v_mfma_f32_16x16x32_bf16 v[76:79], v[136:139], v[172:175], v[76:79]
    s_add_u32 m0, s23, 0
    s_nop 0
    buffer_load_dwordx4 v249, s[80:83], s20 offen sc1 lds
    v_mfma_f32_16x16x32_bf16 v[32:35], v[128:131], v[160:163], v[32:35]
    ds_read_b64_tr_b16 v[106:107], v239 offset:32384
    v_mfma_f32_16x16x32_bf16 v[36:39], v[128:131], v[164:167], v[36:39]
    ds_read_b64_tr_b16 v[116:117], v239 offset:43200
    v_mfma_f32_16x16x32_bf16 v[40:43], v[128:131], v[168:171], v[40:43]
    ds_read_b64_tr_b16 v[118:119], v239 offset:46784
    v_mfma_f32_16x16x32_bf16 v[44:47], v[128:131], v[172:175], v[44:47]
    s_add_u32 m0, s23, 0
    s_nop 0
    buffer_load_dwordx4 v249, s[80:83], s20 offen offset:1024 sc1 lds
    s_add_u32 s20, s20, 8192
    s_cmp_eq_u32 s20, s22
    s_cselect_b32 s20, s21, s20
    v_mfma_f32_16x16x32_bf16 v[80:83], v[140:143], v[160:163], v[80:83]
    v_mfma_f32_16x16x32_bf16 v[84:87], v[140:143], v[164:167], v[84:87]
    v_mfma_f32_16x16x32_bf16 v[88:91], v[140:143], v[168:171], v[88:91]
    v_mfma_f32_16x16x32_bf16 v[92:95], v[140:143], v[172:175], v[92:95]
    s_waitcnt vmcnt(5) lgkmcnt(0)
    s_barrier
    s_cmp_eq_u32 s27, 3
    s_cbranch_scc1 cs_148
cs_148_b:
    v_mfma_f32_16x16x32_bf16 v[0:3], v[96:99], v[144:147], v[0:3]
    ds_read_b128 v[160:163], v235 offset:24576
    ds_read_b128 v[164:167], v235 offset:25600
    v_mfma_f32_16x16x32_bf16 v[4:7], v[96:99], v[148:151], v[4:7]
    ds_read_b128 v[168:171], v235 offset:26624
    v_mfma_f32_16x16x32_bf16 v[8:11], v[96:99], v[152:155], v[8:11]
    ds_read_b128 v[172:175], v235 offset:27648
    v_mfma_f32_16x16x32_bf16 v[12:15], v[96:99], v[156:159], v[12:15]
    s_add_u32 m0, s19, 57600
    s_nop 0
    buffer_load_dwordx4 v228, s[8:11], s16 offen lds
    v_mfma_f32_16x16x32_bf16 v[48:51], v[108:111], v[144:147], v[48:51]
    ds_read_b64_tr_b16 v[120:121], v236 offset:0
    v_mfma_f32_16x16x32_bf16 v[52:55], v[108:111], v[148:151], v[52:55]
    ds_read_b64_tr_b16 v[122:123], v236 offset:3584
    v_mfma_f32_16x16x32_bf16 v[56:59], v[108:111], v[152:155], v[56:59]
    ds_read_b64_tr_b16 v[132:133], v236 offset:14400
    v_mfma_f32_16x16x32_bf16 v[60:63], v[108:111], v[156:159], v[60:63]
    s_add_u32 m0, s19, 58624
    s_nop 0
    buffer_load_dwordx4 v229, s[8:11], s16 offen lds
    v_mfma_f32_16x16x32_bf16 v[16:19], v[100:103], v[144:147], v[16:19]
    ds_read_b64_tr_b16 v[134:135], v236 offset:17984
    v_mfma_f32_16x16x32_bf16 v[20:23], v[100:103], v[148:151], v[20:23]
    ds_read_b64_tr_b16 v[124:125], v236 offset:32
    v_mfma_f32_16x16x32_bf16 v[24:27], v[100:103], v[152:155], v[24:27]
    ds_read_b64_tr_b16 v[126:127], v236 offset:3616
    v_mfma_f32_16x16x32_bf16 v[28:31], v[100:103], v[156:159], v[28:31]
    s_add_u32 m0, s19, 59648
    s_nop 0
    buffer_load_dwordx4 v230, s[8:11], s16 offen lds
    s_add_u32 s16, s16, 229376
    s_cmp_eq_u32 s16, s18
    s_cselect_b32 s16, s17, s16
    v_mfma_f32_16x16x32_bf16 v[64:67], v[112:115], v[144:147], v[64:67]
    ds_read_b64_tr_b16 v[136:137], v236 offset:14432
    v_mfma_f32_16x16x32_bf16 v[68:71], v[112:115], v[148:151], v[68:71]
    ds_read_b64_tr_b16 v[138:139], v236 offset:18016
    v_mfma_f32_16x16x32_bf16 v[72:75], v[112:115], v[152:155], v[72:75]
    ds_read_b64_tr_b16 v[128:129], v238 offset:0
    v_mfma_f32_16x16x32_bf16 v[76:79], v[112:115], v[156:159], v[76:79]
    s_add_u32 m0, s23, 8192
    s_nop 0
    buffer_load_dwordx4 v249, s[80:83], s20 offen sc1 lds
    v_mfma_f32_16x16x32_bf16 v[32:35], v[104:107], v[144:147], v[32:35]
    ds_read_b64_tr_b16 v[130:131], v238 offset:3584
    v_mfma_f32_16x16x32_bf16 v[36:39], v[104:107], v[148:151], v[36:39]
    ds_read_b64_tr_b16 v[140:141], v238 offset:14400
    v_mfma_f32_16x16x32_bf16 v[40:43], v[104:107], v[152:155], v[40:43]
    ds_read_b64_tr_b16 v[142:143], v238 offset:17984
    v_mfma_f32_16x16x32_bf16 v[44:47], v[104:107], v[156:159], v[44:47]
    s_add_u32 m0, s23, 8192
    s_nop 0
    buffer_load_dwordx4 v249, s[80:83], s20 offen offset:1024 sc1 lds
    s_add_u32 s20, s20, 8192
    s_cmp_eq_u32 s20, s22
    s_cselect_b32 s20, s21, s20
    v_mfma_f32_16x16x32_bf16 v[80:83], v[116:119], v[144:147], v[80:83]
    v_mfma_f32_16x16x32_bf16 v[84:87], v[116:119], v[148:151], v[84:87]
    v_mfma_f32_16x16x32_bf16 v[88:91], v[116:119], v[152:155], v[88:91]
    v_mfma_f32_16x16x32_bf16 v[92:95], v[116:119], v[156:159], v[92:95]
    s_waitcnt vmcnt(5) lgkmcnt(0)
    s_barrier
    v_mfma_f32_16x16x32_bf16 v[0:3], v[120:123], v[160:163], v[0:3]
    ds_read_b128 v[144:147], v235 offset:0
    ds_read_b128 v[148:151], v235 offset:1024
    v_mfma_f32_16x16x32_bf16 v[4:7], v[120:123], v[164:167], v[4:7]
    ds_read_b128 v[152:155], v235 offset:2048
    v_mfma_f32_16x16x32_bf16 v[8:11], v[120:123], v[168:171], v[8:11]
    ds_read_b128 v[156:159], v235 offset:3072
    v_mfma_f32_16x16x32_bf16 v[12:15], v[120:123], v[172:175], v[12:15]
    s_add_u32 m0, s19, 86400
    s_nop 0
    buffer_load_dwordx4 v228, s[8:11], s16 offen lds
    v_mfma_f32_16x16x32_bf16 v[48:51], v[132:135], v[160:163], v[48:51]
    ds_read_b64_tr_b16 v[96:97], v236 offset:28800
    v_mfma_f32_16x16x32_bf16 v[52:55], v[132:135], v[164:167], v[52:55]
    ds_read_b64_tr_b16 v[98:99], v236 offset:32384
    v_mfma_f32_16x16x32_bf16 v[56:59], v[132:135], v[168:171], v[56:59]
    ds_read_b64_tr_b16 v[108:109], v236 offset:43200
    v_mfma_f32_16x16x32_bf16 v[60:63], v[132:135], v[172:175], v[60:63]
    s_add_u32 m0, s19, 87424
    s_nop 0
    buffer_load_dwordx4 v229, s[8:11], s16 offen lds
    v_mfma_f32_16x16x32_bf16 v[16:19], v[124:127], v[160:163], v[16:19]
    ds_read_b64_tr_b16 v[110:111], v236 offset:46784
    v_mfma_f32_16x16x32_bf16 v[20:23], v[124:127], v[164:167], v[20:23]
    ds_read_b64_tr_b16 v[100:101], v236 offset:28832
    v_mfma_f32_16x16x32_bf16 v[24:27], v[124:127], v[168:171], v[24:27]
    ds_read_b64_tr_b16 v[102:103], v236 offset:32416
    v_mfma_f32_16x16x32_bf16 v[28:31], v[124:127], v[172:175], v[28:31]
    s_add_u32 m0, s19, 88448
    s_nop 0
    buffer_load_dwordx4 v230, s[8:11], s16 offen lds
    s_add_u32 s16, s16, 229376
    s_cmp_eq_u32 s16, s18
    s_cselect_b32 s16, s17, s16
    v_mfma_f32_16x16x32_bf16 v[64:67], v[136:139], v[160:163], v[64:67]
    ds_read_b64_tr_b16 v[112:113], v236 offset:43232
    s_lshl_b32 s26, s32, 15
    v_mfma_f32_16x16x32_bf16 v[68:71], v[136:139], v[164:167], v[68:71]
    ds_read_b64_tr_b16 v[114:115], v236 offset:46816
    s_lshl_b32 s65, s75, 20
    v_mfma_f32_16x16x32_bf16 v[72:75], v[136:139], v[168:171], v[72:75]
    ds_read_b64_tr_b16 v[104:105], v238 offset:28800
    v_mfma_f32_16x16x32_bf16 v[76:79], v[136:139], v[172:175], v[76:79]
    s_add_u32 m0, s23, 16384
    s_nop 0
    buffer_load_dwordx4 v249, s[80:83], s20 offen sc1 lds
    s_add_u32 s26, s26, s65
    v_mfma_f32_16x16x32_bf16 v[32:35], v[128:131], v[160:163], v[32:35]
    ds_read_b64_tr_b16 v[106:107], v238 offset:32384
    s_lshl_b32 s65, s33, 8
    v_mfma_f32_16x16x32_bf16 v[36:39], v[128:131], v[164:167], v[36:39]
    ds_read_b64_tr_b16 v[116:117], v238 offset:43200
    v_mfma_f32_16x16x32_bf16 v[40:43], v[128:131], v[168:171], v[40:43]
    ds_read_b64_tr_b16 v[118:119], v238 offset:46784
    s_add_u32 s26, s26, s65
    v_mfma_f32_16x16x32_bf16 v[44:47], v[128:131], v[172:175], v[44:47]
    s_add_u32 m0, s23, 16384
    s_nop 0
    buffer_load_dwordx4 v249, s[80:83], s20 offen offset:1024 sc1 lds
    s_add_u32 s20, s20, 8192
    s_cmp_eq_u32 s20, s22
    s_cselect_b32 s20, s21, s20
    s_add_u32 s26, s26, 71303168
    v_mfma_f32_16x16x32_bf16 v[80:83], v[140:143], v[160:163], v[80:83]
    v_mfma_f32_16x16x32_bf16 v[84:87], v[140:143], v[164:167], v[84:87]
    v_lshlrev_b32 v225, 4, v252
    v_mfma_f32_16x16x32_bf16 v[88:91], v[140:143], v[168:171], v[88:91]
    v_lshl_add_u32 v225, v251, 13, v225
    v_mfma_f32_16x16x32_bf16 v[92:95], v[140:143], v[172:175], v[92:95]
    s_waitcnt vmcnt(5) lgkmcnt(0)
    s_barrier
    v_mfma_f32_16x16x32_bf16 v[0:3], v[96:99], v[144:147], v[0:3]
    ds_read_b128 v[160:163], v235 offset:8192
    ds_read_b128 v[164:167], v235 offset:9216
    v_mfma_f32_16x16x32_bf16 v[4:7], v[96:99], v[148:151], v[4:7]
    ds_read_b128 v[168:171], v235 offset:10240
    v_mfma_f32_16x16x32_bf16 v[8:11], v[96:99], v[152:155], v[8:11]
    ds_read_b128 v[172:175], v235 offset:11264
    v_mfma_f32_16x16x32_bf16 v[12:15], v[96:99], v[156:159], v[12:15]
    s_add_u32 m0, s19, 0
    s_nop 0
    buffer_load_dwordx4 v228, s[8:11], s16 offen lds
    v_mfma_f32_16x16x32_bf16 v[48:51], v[108:111], v[144:147], v[48:51]
    ds_read_b64_tr_b16 v[120:121], v237 offset:0
    v_mfma_f32_16x16x32_bf16 v[52:55], v[108:111], v[148:151], v[52:55]
    ds_read_b64_tr_b16 v[122:123], v237 offset:3584
    v_mfma_f32_16x16x32_bf16 v[56:59], v[108:111], v[152:155], v[56:59]
    ds_read_b64_tr_b16 v[132:133], v237 offset:14400
    v_mfma_f32_16x16x32_bf16 v[60:63], v[108:111], v[156:159], v[60:63]
    s_add_u32 m0, s19, 1024
    s_nop 0
    buffer_load_dwordx4 v229, s[8:11], s16 offen lds
    v_mfma_f32_16x16x32_bf16 v[16:19], v[100:103], v[144:147], v[16:19]
    ds_read_b64_tr_b16 v[134:135], v237 offset:17984
    v_mfma_f32_16x16x32_bf16 v[20:23], v[100:103], v[148:151], v[20:23]
    ds_read_b64_tr_b16 v[124:125], v237 offset:32
    v_mfma_f32_16x16x32_bf16 v[24:27], v[100:103], v[152:155], v[24:27]
    ds_read_b64_tr_b16 v[126:127], v237 offset:3616
    v_mfma_f32_16x16x32_bf16 v[28:31], v[100:103], v[156:159], v[28:31]
    s_add_u32 m0, s19, 2048
    s_nop 0
    buffer_load_dwordx4 v230, s[8:11], s16 offen lds
    s_add_u32 s16, s16, 229376
    s_cmp_eq_u32 s16, s18
    s_cselect_b32 s16, s17, s16
    v_mfma_f32_16x16x32_bf16 v[64:67], v[112:115], v[144:147], v[64:67]
    ds_read_b64_tr_b16 v[136:137], v237 offset:14432
    v_mfma_f32_16x16x32_bf16 v[68:71], v[112:115], v[148:151], v[68:71]
    ds_read_b64_tr_b16 v[138:139], v237 offset:18016
    v_mfma_f32_16x16x32_bf16 v[72:75], v[112:115], v[152:155], v[72:75]
    ds_read_b64_tr_b16 v[128:129], v239 offset:0
    v_mfma_f32_16x16x32_bf16 v[76:79], v[112:115], v[156:159], v[76:79]
    s_add_u32 m0, s23, 24576
    s_nop 0
    buffer_load_dwordx4 v249, s[80:83], s20 offen sc1 lds
    v_mfma_f32_16x16x32_bf16 v[32:35], v[104:107], v[144:147], v[32:35]
    ds_read_b64_tr_b16 v[130:131], v239 offset:3584
    v_mfma_f32_16x16x32_bf16 v[36:39], v[104:107], v[148:151], v[36:39]
    ds_read_b64_tr_b16 v[140:141], v239 offset:14400
    v_mfma_f32_16x16x32_bf16 v[40:43], v[104:107], v[152:155], v[40:43]
    ds_read_b64_tr_b16 v[142:143], v239 offset:17984
    v_mfma_f32_16x16x32_bf16 v[44:47], v[104:107], v[156:159], v[44:47]
    s_add_u32 m0, s23, 24576
    s_nop 0
    buffer_load_dwordx4 v249, s[80:83], s20 offen offset:1024 sc1 lds
    s_add_u32 s20, s20, 8192
    s_cmp_eq_u32 s20, s22
    s_cselect_b32 s20, s21, s20
    v_mfma_f32_16x16x32_bf16 v[80:83], v[116:119], v[144:147], v[80:83]
    buffer_load_dwordx4 v[176:179], v225, s[80:83], s26 offen offset:0 sc1
    v_mfma_f32_16x16x32_bf16 v[84:87], v[116:119], v[148:151], v[84:87]
    buffer_load_dwordx4 v[180:183], v225, s[80:83], s26 offen offset:1024 sc1
    v_mfma_f32_16x16x32_bf16 v[88:91], v[116:119], v[152:155], v[88:91]
    buffer_load_dwordx4 v[184:187], v225, s[80:83], s26 offen offset:2048 sc1
    v_mfma_f32_16x16x32_bf16 v[92:95], v[116:119], v[156:159], v[92:95]
    buffer_load_dwordx4 v[188:191], v225, s[80:83], s26 offen offset:3072 sc1
    s_add_u32 s26, s26, 4096
    s_waitcnt vmcnt(9) lgkmcnt(0)
    s_barrier
    v_mfma_f32_16x16x32_bf16 v[0:3], v[120:123], v[160:163], v[0:3]
    ds_read_b128 v[144:147], v235 offset:16384
    ds_read_b128 v[148:151], v235 offset:17408
    v_mfma_f32_16x16x32_bf16 v[4:7], v[120:123], v[164:167], v[4:7]
    ds_read_b128 v[152:155], v235 offset:18432
    v_mfma_f32_16x16x32_bf16 v[8:11], v[120:123], v[168:171], v[8:11]
    ds_read_b128 v[156:159], v235 offset:19456
    v_mfma_f32_16x16x32_bf16 v[12:15], v[120:123], v[172:175], v[12:15]
    s_add_u32 m0, s19, 28800
    s_nop 0
    buffer_load_dwordx4 v228, s[8:11], s16 offen lds
    v_mfma_f32_16x16x32_bf16 v[48:51], v[132:135], v[160:163], v[48:51]
    ds_read_b64_tr_b16 v[96:97], v237 offset:28800
    v_mfma_f32_16x16x32_bf16 v[52:55], v[132:135], v[164:167], v[52:55]
    ds_read_b64_tr_b16 v[98:99], v237 offset:32384
    v_mfma_f32_16x16x32_bf16 v[56:59], v[132:135], v[168:171], v[56:59]
    ds_read_b64_tr_b16 v[108:109], v237 offset:43200
    v_mfma_f32_16x16x32_bf16 v[60:63], v[132:135], v[172:175], v[60:63]
    s_add_u32 m0, s19, 29824
    s_nop 0
    buffer_load_dwordx4 v229, s[8:11], s16 offen lds
    v_mfma_f32_16x16x32_bf16 v[16:19], v[124:127], v[160:163], v[16:19]
    ds_read_b64_tr_b16 v[110:111], v237 offset:46784
    v_mfma_f32_16x16x32_bf16 v[20:23], v[124:127], v[164:167], v[20:23]
    ds_read_b64_tr_b16 v[100:101], v237 offset:28832
    v_mfma_f32_16x16x32_bf16 v[24:27], v[124:127], v[168:171], v[24:27]
    ds_read_b64_tr_b16 v[102:103], v237 offset:32416
    v_mfma_f32_16x16x32_bf16 v[28:31], v[124:127], v[172:175], v[28:31]
    s_add_u32 m0, s19, 30848
    s_nop 0
    buffer_load_dwordx4 v230, s[8:11], s16 offen lds
    s_add_u32 s16, s16, 229376
    s_cmp_eq_u32 s16, s18
    s_cselect_b32 s16, s17, s16
    v_mfma_f32_16x16x32_bf16 v[64:67], v[136:139], v[160:163], v[64:67]
    ds_read_b64_tr_b16 v[112:113], v237 offset:43232
    v_mfma_f32_16x16x32_bf16 v[68:71], v[136:139], v[164:167], v[68:71]
    ds_read_b64_tr_b16 v[114:115], v237 offset:46816
    v_mfma_f32_16x16x32_bf16 v[72:75], v[136:139], v[168:171], v[72:75]
    ds_read_b64_tr_b16 v[104:105], v239 offset:28800
    v_mfma_f32_16x16x32_bf16 v[76:79], v[136:139], v[172:175], v[76:79]
    s_add_u32 m0, s23, 0
    s_nop 0
    buffer_load_dwordx4 v249, s[80:83], s20 offen sc1 lds
    v_mfma_f32_16x16x32_bf16 v[32:35], v[128:131], v[160:163], v[32:35]
    ds_read_b64_tr_b16 v[106:107], v239 offset:32384
    v_mfma_f32_16x16x32_bf16 v[36:39], v[128:131], v[164:167], v[36:39]
    ds_read_b64_tr_b16 v[116:117], v239 offset:43200
    v_mfma_f32_16x16x32_bf16 v[40:43], v[128:131], v[168:171], v[40:43]
    ds_read_b64_tr_b16 v[118:119], v239 offset:46784
    v_mfma_f32_16x16x32_bf16 v[44:47], v[128:131], v[172:175], v[44:47]
    s_add_u32 m0, s23, 0
    s_nop 0
    buffer_load_dwordx4 v249, s[80:83], s20 offen offset:1024 sc1 lds
    s_add_u32 s20, s20, 8192
    s_cmp_eq_u32 s20, s22
    s_cselect_b32 s20, s21, s20
    v_mfma_f32_16x16x32_bf16 v[80:83], v[140:143], v[160:163], v[80:83]
    buffer_load_dwordx4 v[192:195], v225, s[80:83], s26 offen offset:0 sc1
    v_mfma_f32_16x16x32_bf16 v[84:87], v[140:143], v[164:167], v[84:87]
    buffer_load_dwordx4 v[196:199], v225, s[80:83], s26 offen offset:1024 sc1
    v_mfma_f32_16x16x32_bf16 v[88:91], v[140:143], v[168:171], v[88:91]
    buffer_load_dwordx4 v[200:203], v225, s[80:83], s26 offen offset:2048 sc1
    v_mfma_f32_16x16x32_bf16 v[92:95], v[140:143], v[172:175], v[92:95]
    buffer_load_dwordx4 v[204:207], v225, s[80:83], s26 offen offset:3072 sc1
    s_waitcnt vmcnt(13) lgkmcnt(0)
    s_barrier
    s_cmp_eq_u32 s75, 0
    s_cbranch_scc1 cf_649
cf_649_b:
    v_mfma_f32_16x16x32_bf16 v[0:3], v[96:99], v[144:147], v[0:3]
    ds_read_b128 v[160:163], v235 offset:24576
    ds_read_b128 v[164:167], v235 offset:25600
    v_mfma_f32_16x16x32_bf16 v[4:7], v[96:99], v[148:151], v[4:7]
    ds_read_b128 v[168:171], v235 offset:26624
    v_mfma_f32_16x16x32_bf16 v[8:11], v[96:99], v[152:155], v[8:11]
    ds_read_b128 v[172:175], v235 offset:27648
    v_mfma_f32_16x16x32_bf16 v[12:15], v[96:99], v[156:159], v[12:15]
    s_add_u32 m0, s19, 57600
    s_nop 0
    buffer_load_dwordx4 v228, s[8:11], s16 offen lds
    v_mfma_f32_16x16x32_bf16 v[48:51], v[108:111], v[144:147], v[48:51]
    ds_read_b64_tr_b16 v[120:121], v236 offset:0
    v_mfma_f32_16x16x32_bf16 v[52:55], v[108:111], v[148:151], v[52:55]
    ds_read_b64_tr_b16 v[122:123], v236 offset:3584
    v_mfma_f32_16x16x32_bf16 v[56:59], v[108:111], v[152:155], v[56:59]
    ds_read_b64_tr_b16 v[132:133], v236 offset:14400
    v_mfma_f32_16x16x32_bf16 v[60:63], v[108:111], v[156:159], v[60:63]
    s_add_u32 m0, s19, 58624
    s_nop 0
    buffer_load_dwordx4 v229, s[8:11], s16 offen lds
    v_mfma_f32_16x16x32_bf16 v[16:19], v[100:103], v[144:147], v[16:19]
    ds_read_b64_tr_b16 v[134:135], v236 offset:17984
    v_mfma_f32_16x16x32_bf16 v[20:23], v[100:103], v[148:151], v[20:23]
    ds_read_b64_tr_b16 v[124:125], v236 offset:32
    v_mfma_f32_16x16x32_bf16 v[24:27], v[100:103], v[152:155], v[24:27]
    ds_read_b64_tr_b16 v[126:127], v236 offset:3616
    v_mfma_f32_16x16x32_bf16 v[28:31], v[100:103], v[156:159], v[28:31]
    s_add_u32 m0, s19, 59648
    s_nop 0
    buffer_load_dwordx4 v230, s[8:11], s16 offen lds
    s_add_u32 s16, s16, 229376
    s_cmp_eq_u32 s16, s18
    s_cselect_b32 s16, s17, s16
    v_mfma_f32_16x16x32_bf16 v[64:67], v[112:115], v[144:147], v[64:67]
    ds_read_b64_tr_b16 v[136:137], v236 offset:14432
    v_mfma_f32_16x16x32_bf16 v[68:71], v[112:115], v[148:151], v[68:71]
    ds_read_b64_tr_b16 v[138:139], v236 offset:18016
    v_mfma_f32_16x16x32_bf16 v[72:75], v[112:115], v[152:155], v[72:75]
    ds_read_b64_tr_b16 v[128:129], v238 offset:0
    v_mfma_f32_16x16x32_bf16 v[76:79], v[112:115], v[156:159], v[76:79]
    s_add_u32 m0, s23, 8192
    s_nop 0
    buffer_load_dwordx4 v249, s[80:83], s20 offen sc1 lds
    v_mfma_f32_16x16x32_bf16 v[32:35], v[104:107], v[144:147], v[32:35]
    ds_read_b64_tr_b16 v[130:131], v238 offset:3584
    v_mfma_f32_16x16x32_bf16 v[36:39], v[104:107], v[148:151], v[36:39]
    ds_read_b64_tr_b16 v[140:141], v238 offset:14400
    v_mfma_f32_16x16x32_bf16 v[40:43], v[104:107], v[152:155], v[40:43]
    ds_read_b64_tr_b16 v[142:143], v238 offset:17984
    v_mfma_f32_16x16x32_bf16 v[44:47], v[104:107], v[156:159], v[44:47]
    s_add_u32 m0, s23, 8192
    s_nop 0
    buffer_load_dwordx4 v249, s[80:83], s20 offen offset:1024 sc1 lds
    s_add_u32 s20, s20, 8192
    s_cmp_eq_u32 s20, s22
    s_cselect_b32 s20, s21, s20
    v_mfma_f32_16x16x32_bf16 v[80:83], v[116:119], v[144:147], v[80:83]
    v_mfma_f32_16x16x32_bf16 v[84:87], v[116:119], v[148:151], v[84:87]
    v_mfma_f32_16x16x32_bf16 v[88:91], v[116:119], v[152:155], v[88:91]
    v_mfma_f32_16x16x32_bf16 v[92:95], v[116:119], v[156:159], v[92:95]
    s_waitcnt vmcnt(5) lgkmcnt(0)
    s_barrier
    v_mfma_f32_16x16x32_bf16 v[0:3], v[120:123], v[160:163], v[0:3]
    ds_read_b128 v[144:147], v235 offset:0
    ds_read_b128 v[148:151], v235 offset:1024
    s_lshl_b32 s26, s69, 8
    s_add_u32 s26, s26, 159744
    v_pk_add_f32 v[176:177], v[176:177], v[192:193]
    v_mfma_f32_16x16x32_bf16 v[4:7], v[120:123], v[164:167], v[4:7]
    ds_read_b128 v[152:155], v235 offset:2048
    v_pk_add_f32 v[178:179], v[178:179], v[194:195]
    v_pk_add_f32 v[180:181], v[180:181], v[196:197]
    v_mfma_f32_16x16x32_bf16 v[8:11], v[120:123], v[168:171], v[8:11]
    ds_read_b128 v[156:159], v235 offset:3072
    v_pk_add_f32 v[182:183], v[182:183], v[198:199]
    v_pk_add_f32 v[184:185], v[184:185], v[200:201]
    v_mfma_f32_16x16x32_bf16 v[12:15], v[120:123], v[172:175], v[12:15]
    s_add_u32 m0, s19, 86400
    s_nop 0
    buffer_load_dwordx4 v228, s[8:11], s16 offen lds
    v_pk_add_f32 v[186:187], v[186:187], v[202:203]
    v_pk_add_f32 v[188:189], v[188:189], v[204:205]
    v_mfma_f32_16x16x32_bf16 v[48:51], v[132:135], v[160:163], v[48:51]
    ds_read_b64_tr_b16 v[96:97], v236 offset:28800
    v_pk_add_f32 v[190:191], v[190:191], v[206:207]
    v_pk_add_f32 v[176:177], v[176:177], v[184:185]
    v_mfma_f32_16x16x32_bf16 v[52:55], v[132:135], v[164:167], v[52:55]
    ds_read_b64_tr_b16 v[98:99], v236 offset:32384
    v_pk_add_f32 v[178:179], v[178:179], v[186:187]
    v_pk_add_f32 v[180:181], v[180:181], v[188:189]
    v_mfma_f32_16x16x32_bf16 v[56:59], v[132:135], v[168:171], v[56:59]
    ds_read_b64_tr_b16 v[108:109], v236 offset:43200
    v_pk_add_f32 v[182:183], v[182:183], v[190:191]
    v_pk_add_f32 v[176:177], v[176:177], v[180:181]
    v_mfma_f32_16x16x32_bf16 v[60:63], v[132:135], v[172:175], v[60:63]
    s_add_u32 m0, s19, 87424
    s_nop 0
    buffer_load_dwordx4 v229, s[8:11], s16 offen lds
    v_pk_add_f32 v[178:179], v[178:179], v[182:183]
    v_and_b32 v225, 15, v252
    v_mfma_f32_16x16x32_bf16 v[16:19], v[124:127], v[160:163], v[16:19]
    ds_read_b64_tr_b16 v[110:111], v236 offset:46784
    v_and_b32 v180, 1, v251
    v_permlane16_swap_b32 v176, v178
    v_mfma_f32_16x16x32_bf16 v[20:23], v[124:127], v[164:167], v[20:23]
    ds_read_b64_tr_b16 v[100:101], v236 offset:28832
    v_permlane16_swap_b32 v177, v179
    v_add_f32 v176, v176, v178
    v_mfma_f32_16x16x32_bf16 v[24:27], v[124:127], v[168:171], v[24:27]
    ds_read_b64_tr_b16 v[102:103], v236 offset:32416
    v_add_f32 v177, v177, v179
    v_mov_b32 v178, v176
    v_mfma_f32_16x16x32_bf16 v[28:31], v[124:127], v[172:175], v[28:31]
    s_add_u32 m0, s19, 88448
    s_nop 0
    buffer_load_dwordx4 v230, s[8:11], s16 offen lds
    s_add_u32 s16, s16, 229376
    s_cmp_eq_u32 s16, s18
    s_cselect_b32 s16, s17, s16
    v_mov_b32 v179, v177
    v_lshl_add_u32 v225, v225, 1, v180
    v_mfma_f32_16x16x32_bf16 v[64:67], v[136:139], v[160:163], v[64:67]
    ds_read_b64_tr_b16 v[112:113], v236 offset:43232
    v_lshlrev_b32 v225, 3, v225
    v_permlane32_swap_b32 v176, v178
    v_mfma_f32_16x16x32_bf16 v[68:71], v[136:139], v[164:167], v[68:71]
    ds_read_b64_tr_b16 v[114:115], v236 offset:46816
    v_permlane32_swap_b32 v177, v179
    v_add_f32 v176, v176, v178
    v_mfma_f32_16x16x32_bf16 v[72:75], v[136:139], v[168:171], v[72:75]
    ds_read_b64_tr_b16 v[104:105], v238 offset:28800
    v_add_f32 v177, v177, v179
    v_mul_f32 v176, 0x3a800000, v176
    v_mfma_f32_16x16x32_bf16 v[76:79], v[136:139], v[172:175], v[76:79]
    s_add_u32 m0, s23, 16384
    s_nop 0
    buffer_load_dwordx4 v249, s[80:83], s20 offen sc1 lds
    v_mul_f32 v177, 0x3a800000, v177
    v_fma_f32 v177, -v176, v176, v177
    v_mfma_f32_16x16x32_bf16 v[32:35], v[128:131], v[160:163], v[32:35]
    ds_read_b64_tr_b16 v[106:107], v238 offset:32384
    v_max_f32 v177, 0, v177
    v_cvt_pk_bf16_f32 v176, v176, v176
    v_mfma_f32_16x16x32_bf16 v[36:39], v[128:131], v[164:167], v[36:39]
    ds_read_b64_tr_b16 v[116:117], v238 offset:43200
    v_lshlrev_b32 v176, 16, v176
    v_cvt_pk_bf16_f32 v177, v177, v177
    v_mfma_f32_16x16x32_bf16 v[40:43], v[128:131], v[168:171], v[40:43]
    ds_read_b64_tr_b16 v[118:119], v238 offset:46784
    v_lshlrev_b32 v177, 16, v177
    v_add_f32 v177, 0x3727c5ac, v177
    v_mfma_f32_16x16x32_bf16 v[44:47], v[128:131], v[172:175], v[44:47]
    s_add_u32 m0, s23, 16384
    s_nop 0
    buffer_load_dwordx4 v249, s[80:83], s20 offen offset:1024 sc1 lds
    s_add_u32 s20, s20, 8192
    s_cmp_eq_u32 s20, s22
    s_cselect_b32 s20, s21, s20
    v_cvt_pk_bf16_f32 v177, v177, v177
    v_lshlrev_b32 v177, 16, v177
    v_mfma_f32_16x16x32_bf16 v[80:83], v[140:143], v[160:163], v[80:83]
    v_sqrt_f32 v177, v177
    s_nop 0
    v_mfma_f32_16x16x32_bf16 v[84:87], v[140:143], v[164:167], v[84:87]
    v_cvt_pk_bf16_f32 v177, v177, v177
    v_lshlrev_b32 v177, 16, v177
    v_mfma_f32_16x16x32_bf16 v[88:91], v[140:143], v[168:171], v[88:91]
    v_rcp_f32 v177, v177
    s_nop 0
    v_mfma_f32_16x16x32_bf16 v[92:95], v[140:143], v[172:175], v[92:95]
    v_add_u32 v225, s26, v225
    ds_write_b64 v225, v[176:177]
    s_mov_b32 s24, 4
    s_cmp_eq_u32 s75, 0
    s_cselect_b32 s27, 6, 0
    s_lshr_b32 s64, s69, 1
    s_lshl_b32 s64, 8, s64
    s_cmp_eq_u32 s75, 0
    s_cselect_b32 s64, s64, 0
    s_or_b32 s27, s27, s64
g3c1_loop:
    s_waitcnt vmcnt(5) lgkmcnt(0)
    s_barrier
    s_bitcmp1_b32 s27, s24
    s_cbranch_scc1 g3c1_hook
g3c1_hb:
    v_mfma_f32_16x16x32_bf16 v[0:3], v[96:99], v[144:147], v[0:3]
    ds_read_b128 v[160:163], v235 offset:8192
    ds_read_b128 v[164:167], v235 offset:9216
    v_mfma_f32_16x16x32_bf16 v[4:7], v[96:99], v[148:151], v[4:7]
    ds_read_b128 v[168:171], v235 offset:10240
    v_mfma_f32_16x16x32_bf16 v[8:11], v[96:99], v[152:155], v[8:11]
    ds_read_b128 v[172:175], v235 offset:11264
    v_mfma_f32_16x16x32_bf16 v[12:15], v[96:99], v[156:159], v[12:15]
    s_add_u32 m0, s19, 0
    s_nop 0
    buffer_load_dwordx4 v228, s[8:11], s16 offen lds
    v_mfma_f32_16x16x32_bf16 v[48:51], v[108:111], v[144:147], v[48:51]
    ds_read_b64_tr_b16 v[120:121], v237 offset:0
    v_mfma_f32_16x16x32_bf16 v[52:55], v[108:111], v[148:151], v[52:55]
    ds_read_b64_tr_b16 v[122:123], v237 offset:3584
    v_mfma_f32_16x16x32_bf16 v[56:59], v[108:111], v[152:155], v[56:59]
    ds_read_b64_tr_b16 v[132:133], v237 offset:14400
    v_mfma_f32_16x16x32_bf16 v[60:63], v[108:111], v[156:159], v[60:63]
    s_add_u32 m0, s19, 1024
    s_nop 0
    buffer_load_dwordx4 v229, s[8:11], s16 offen lds
    v_mfma_f32_16x16x32_bf16 v[16:19], v[100:103], v[144:147], v[16:19]
    ds_read_b64_tr_b16 v[134:135], v237 offset:17984
    v_mfma_f32_16x16x32_bf16 v[20:23], v[100:103], v[148:151], v[20:23]
    ds_read_b64_tr_b16 v[124:125], v237 offset:32
    v_mfma_f32_16x16x32_bf16 v[24:27], v[100:103], v[152:155], v[24:27]
    ds_read_b64_tr_b16 v[126:127], v237 offset:3616
    v_mfma_f32_16x16x32_bf16 v[28:31], v[100:103], v[156:159], v[28:31]
    s_add_u32 m0, s19, 2048
    s_nop 0
    buffer_load_dwordx4 v230, s[8:11], s16 offen lds
    s_add_u32 s16, s16, 229376
    s_cmp_eq_u32 s16, s18
    s_cselect_b32 s16, s17, s16
    v_mfma_f32_16x16x32_bf16 v[64:67], v[112:115], v[144:147], v[64:67]
    ds_read_b64_tr_b16 v[136:137], v237 offset:14432
    v_mfma_f32_16x16x32_bf16 v[68:71], v[112:115], v[148:151], v[68:71]
    ds_read_b64_tr_b16 v[138:139], v237 offset:18016
    v_mfma_f32_16x16x32_bf16 v[72:75], v[112:115], v[152:155], v[72:75]
    ds_read_b64_tr_b16 v[128:129], v239 offset:0
    v_mfma_f32_16x16x32_bf16 v[76:79], v[112:115], v[156:159], v[76:79]
    s_add_u32 m0, s23, 24576
    s_nop 0
    buffer_load_dwordx4 v249, s[80:83], s20 offen sc1 lds
    v_mfma_f32_16x16x32_bf16 v[32:35], v[104:107], v[144:147], v[32:35]
    ds_read_b64_tr_b16 v[130:131], v239 offset:3584
    v_mfma_f32_16x16x32_bf16 v[36:39], v[104:107], v[148:151], v[36:39]
    ds_read_b64_tr_b16 v[140:141], v239 offset:14400
    v_mfma_f32_16x16x32_bf16 v[40:43], v[104:107], v[152:155], v[40:43]
    ds_read_b64_tr_b16 v[142:143], v239 offset:17984
    v_mfma_f32_16x16x32_bf16 v[44:47], v[104:107], v[156:159], v[44:47]
    s_add_u32 m0, s23, 24576
    s_nop 0
    buffer_load_dwordx4 v249, s[80:83], s20 offen offset:1024 sc1 lds
    s_add_u32 s20, s20, 8192
    s_cmp_eq_u32 s20, s22
    s_cselect_b32 s20, s21, s20
    v_mfma_f32_16x16x32_bf16 v[80:83], v[116:119], v[144:147], v[80:83]
    v_mfma_f32_16x16x32_bf16 v[84:87], v[116:119], v[148:151], v[84:87]
    v_mfma_f32_16x16x32_bf16 v[88:91], v[116:119], v[152:155], v[88:91]
    v_mfma_f32_16x16x32_bf16 v[92:95], v[116:119], v[156:159], v[92:95]
    s_waitcnt vmcnt(5) lgkmcnt(0)
    s_barrier
    v_mfma_f32_16x16x32_bf16 v[0:3], v[120:123], v[160:163], v[0:3]
    ds_read_b128 v[144:147], v235 offset:16384
    ds_read_b128 v[148:151], v235 offset:17408
    v_mfma_f32_16x16x32_bf16 v[4:7], v[120:123], v[164:167], v[4:7]
    ds_read_b128 v[152:155], v235 offset:18432
    v_mfma_f32_16x16x32_bf16 v[8:11], v[120:123], v[168:171], v[8:11]
    ds_read_b128 v[156:159], v235 offset:19456
    v_mfma_f32_16x16x32_bf16 v[12:15], v[120:123], v[172:175], v[12:15]
    s_add_u32 m0, s19, 28800
    s_nop 0
    buffer_load_dwordx4 v228, s[8:11], s16 offen lds
    v_mfma_f32_16x16x32_bf16 v[48:51], v[132:135], v[160:163], v[48:51]
    ds_read_b64_tr_b16 v[96:97], v237 offset:28800
    v_mfma_f32_16x16x32_bf16 v[52:55], v[132:135], v[164:167], v[52:55]
    ds_read_b64_tr_b16 v[98:99], v237 offset:32384
    v_mfma_f32_16x16x32_bf16 v[56:59], v[132:135], v[168:171], v[56:59]
    ds_read_b64_tr_b16 v[108:109], v237 offset:43200
    v_mfma_f32_16x16x32_bf16 v[60:63], v[132:135], v[172:175], v[60:63]
    s_add_u32 m0, s19, 29824
    s_nop 0
    buffer_load_dwordx4 v229, s[8:11], s16 offen lds
    v_mfma_f32_16x16x32_bf16 v[16:19], v[124:127], v[160:163], v[16:19]
    ds_read_b64_tr_b16 v[110:111], v237 offset:46784
    v_mfma_f32_16x16x32_bf16 v[20:23], v[124:127], v[164:167], v[20:23]
    ds_read_b64_tr_b16 v[100:101], v237 offset:28832
    v_mfma_f32_16x16x32_bf16 v[24:27], v[124:127], v[168:171], v[24:27]
    ds_read_b64_tr_b16 v[102:103], v237 offset:32416
    v_mfma_f32_16x16x32_bf16 v[28:31], v[124:127], v[172:175], v[28:31]
    s_add_u32 m0, s19, 30848
    s_nop 0
    buffer_load_dwordx4 v230, s[8:11], s16 offen lds
    s_add_u32 s16, s16, 229376
    s_cmp_eq_u32 s16, s18
    s_cselect_b32 s16, s17, s16
    v_mfma_f32_16x16x32_bf16 v[64:67], v[136:139], v[160:163], v[64:67]
    ds_read_b64_tr_b16 v[112:113], v237 offset:43232
    v_mfma_f32_16x16x32_bf16 v[68:71], v[136:139], v[164:167], v[68:71]
    ds_read_b64_tr_b16 v[114:115], v237 offset:46816
    v_mfma_f32_16x16x32_bf16 v[72:75], v[136:139], v[168:171], v[72:75]
    ds_read_b64_tr_b16 v[104:105], v239 offset:28800
    v_mfma_f32_16x16x32_bf16 v[76:79], v[136:139], v[172:175], v[76:79]
    s_add_u32 m0, s23, 0
    s_nop 0
    buffer_load_dwordx4 v249, s[80:83], s20 offen sc1 lds
    v_mfma_f32_16x16x32_bf16 v[32:35], v[128:131], v[160:163], v[32:35]
    ds_read_b64_tr_b16 v[106:107], v239 offset:32384
    v_mfma_f32_16x16x32_bf16 v[36:39], v[128:131], v[164:167], v[36:39]
    ds_read_b64_tr_b16 v[116:117], v239 offset:43200
    v_mfma_f32_16x16x32_bf16 v[40:43], v[128:131], v[168:171], v[40:43]
    ds_read_b64_tr_b16 v[118:119], v239 offset:46784
    v_mfma_f32_16x16x32_bf16 v[44:47], v[128:131], v[172:175], v[44:47]
    s_add_u32 m0, s23, 0
    s_nop 0
    buffer_load_dwordx4 v249, s[80:83], s20 offen offset:1024 sc1 lds
    s_add_u32 s20, s20, 8192
    s_cmp_eq_u32 s20, s22
    s_cselect_b32 s20, s21, s20
    v_mfma_f32_16x16x32_bf16 v[80:83], v[140:143], v[160:163], v[80:83]
    v_mfma_f32_16x16x32_bf16 v[84:87], v[140:143], v[164:167], v[84:87]
    v_mfma_f32_16x16x32_bf16 v[88:91], v[140:143], v[168:171], v[88:91]
    v_mfma_f32_16x16x32_bf16 v[92:95], v[140:143], v[172:175], v[92:95]
    s_waitcnt vmcnt(5) lgkmcnt(0)
    s_barrier
    v_mfma_f32_16x16x32_bf16 v[0:3], v[96:99], v[144:147], v[0:3]
    ds_read_b128 v[160:163], v235 offset:24576
    ds_read_b128 v[164:167], v235 offset:25600
    v_mfma_f32_16x16x32_bf16 v[4:7], v[96:99], v[148:151], v[4:7]
    ds_read_b128 v[168:171], v235 offset:26624
    v_mfma_f32_16x16x32_bf16 v[8:11], v[96:99], v[152:155], v[8:11]
    ds_read_b128 v[172:175], v235 offset:27648
    v_mfma_f32_16x16x32_bf16 v[12:15], v[96:99], v[156:159], v[12:15]
    s_add_u32 m0, s19, 57600
    s_nop 0
    buffer_load_dwordx4 v228, s[8:11], s16 offen lds
    v_mfma_f32_16x16x32_bf16 v[48:51], v[108:111], v[144:147], v[48:51]
    ds_read_b64_tr_b16 v[120:121], v236 offset:0
    v_mfma_f32_16x16x32_bf16 v[52:55], v[108:111], v[148:151], v[52:55]
    ds_read_b64_tr_b16 v[122:123], v236 offset:3584
    v_mfma_f32_16x16x32_bf16 v[56:59], v[108:111], v[152:155], v[56:59]
    ds_read_b64_tr_b16 v[132:133], v236 offset:14400
    v_mfma_f32_16x16x32_bf16 v[60:63], v[108:111], v[156:159], v[60:63]
    s_add_u32 m0, s19, 58624
    s_nop 0
    buffer_load_dwordx4 v229, s[8:11], s16 offen lds
    v_mfma_f32_16x16x32_bf16 v[16:19], v[100:103], v[144:147], v[16:19]
    ds_read_b64_tr_b16 v[134:135], v236 offset:17984
    v_mfma_f32_16x16x32_bf16 v[20:23], v[100:103], v[148:151], v[20:23]
    ds_read_b64_tr_b16 v[124:125], v236 offset:32
    v_mfma_f32_16x16x32_bf16 v[24:27], v[100:103], v[152:155], v[24:27]
    ds_read_b64_tr_b16 v[126:127], v236 offset:3616
    v_mfma_f32_16x16x32_bf16 v[28:31], v[100:103], v[156:159], v[28:31]
    s_add_u32 m0, s19, 59648
    s_nop 0
    buffer_load_dwordx4 v230, s[8:11], s16 offen lds
    s_add_u32 s16, s16, 229376
    s_cmp_eq_u32 s16, s18
    s_cselect_b32 s16, s17, s16
    v_mfma_f32_16x16x32_bf16 v[64:67], v[112:115], v[144:147], v[64:67]
    ds_read_b64_tr_b16 v[136:137], v236 offset:14432
    v_mfma_f32_16x16x32_bf16 v[68:71], v[112:115], v[148:151], v[68:71]
    ds_read_b64_tr_b16 v[138:139], v236 offset:18016
    v_mfma_f32_16x16x32_bf16 v[72:75], v[112:115], v[152:155], v[72:75]
    ds_read_b64_tr_b16 v[128:129], v238 offset:0
    v_mfma_f32_16x16x32_bf16 v[76:79], v[112:115], v[156:159], v[76:79]
    s_add_u32 m0, s23, 8192
    s_nop 0
    buffer_load_dwordx4 v249, s[80:83], s20 offen sc1 lds
    v_mfma_f32_16x16x32_bf16 v[32:35], v[104:107], v[144:147], v[32:35]
    ds_read_b64_tr_b16 v[130:131], v238 offset:3584
    v_mfma_f32_16x16x32_bf16 v[36:39], v[104:107], v[148:151], v[36:39]
    ds_read_b64_tr_b16 v[140:141], v238 offset:14400
    v_mfma_f32_16x16x32_bf16 v[40:43], v[104:107], v[152:155], v[40:43]
    ds_read_b64_tr_b16 v[142:143], v238 offset:17984
    v_mfma_f32_16x16x32_bf16 v[44:47], v[104:107], v[156:159], v[44:47]
    s_add_u32 m0, s23, 8192
    s_nop 0
    buffer_load_dwordx4 v249, s[80:83], s20 offen offset:1024 sc1 lds
    s_add_u32 s20, s20, 8192
    s_cmp_eq_u32 s20, s22
    s_cselect_b32 s20, s21, s20
    v_mfma_f32_16x16x32_bf16 v[80:83], v[116:119], v[144:147], v[80:83]
    v_mfma_f32_16x16x32_bf16 v[84:87], v[116:119], v[148:151], v[84:87]
    v_mfma_f32_16x16x32_bf16 v[88:91], v[116:119], v[152:155], v[88:91]
    v_mfma_f32_16x16x32_bf16 v[92:95], v[116:119], v[156:159], v[92:95]
    s_waitcnt vmcnt(5) lgkmcnt(0)
    s_barrier
    v_mfma_f32_16x16x32_bf16 v[0:3], v[120:123], v[160:163], v[0:3]
    ds_read_b128 v[144:147], v235 offset:0
    ds_read_b128 v[148:151], v235 offset:1024
    v_mfma_f32_16x16x32_bf16 v[4:7], v[120:123], v[164:167], v[4:7]
    ds_read_b128 v[152:155], v235 offset:2048
    v_mfma_f32_16x16x32_bf16 v[8:11], v[120:123], v[168:171], v[8:11]
    ds_read_b128 v[156:159], v235 offset:3072
    v_mfma_f32_16x16x32_bf16 v[12:15], v[120:123], v[172:175], v[12:15]
    s_add_u32 m0, s19, 86400
    s_nop 0
    buffer_load_dwordx4 v228, s[8:11], s16 offen lds
    v_mfma_f32_16x16x32_bf16 v[48:51], v[132:135], v[160:163], v[48:51]
    ds_read_b64_tr_b16 v[96:97], v236 offset:28800
    v_mfma_f32_16x16x32_bf16 v[52:55], v[132:135], v[164:167], v[52:55]
    ds_read_b64_tr_b16 v[98:99], v236 offset:32384
    v_mfma_f32_16x16x32_bf16 v[56:59], v[132:135], v[168:171], v[56:59]
    ds_read_b64_tr_b16 v[108:109], v236 offset:43200
    v_mfma_f32_16x16x32_bf16 v[60:63], v[132:135], v[172:175], v[60:63]
    s_add_u32 m0, s19, 87424
    s_nop 0
    buffer_load_dwordx4 v229, s[8:11], s16 offen lds
    v_mfma_f32_16x16x32_bf16 v[16:19], v[124:127], v[160:163], v[16:19]
    ds_read_b64_tr_b16 v[110:111], v236 offset:46784
    v_mfma_f32_16x16x32_bf16 v[20:23], v[124:127], v[164:167], v[20:23]
    ds_read_b64_tr_b16 v[100:101], v236 offset:28832
    v_mfma_f32_16x16x32_bf16 v[24:27], v[124:127], v[168:171], v[24:27]
    ds_read_b64_tr_b16 v[102:103], v236 offset:32416
    v_mfma_f32_16x16x32_bf16 v[28:31], v[124:127], v[172:175], v[28:31]
    s_add_u32 m0, s19, 88448
    s_nop 0
    buffer_load_dwordx4 v230, s[8:11], s16 offen lds
    s_add_u32 s16, s16, 229376
    s_cmp_eq_u32 s16, s18
    s_cselect_b32 s16, s17, s16
    v_mfma_f32_16x16x32_bf16 v[64:67], v[136:139], v[160:163], v[64:67]
    ds_read_b64_tr_b16 v[112:113], v236 offset:43232
    v_mfma_f32_16x16x32_bf16 v[68:71], v[136:139], v[164:167], v[68:71]
    ds_read_b64_tr_b16 v[114:115], v236 offset:46816
    v_mfma_f32_16x16x32_bf16 v[72:75], v[136:139], v[168:171], v[72:75]
    ds_read_b64_tr_b16 v[104:105], v238 offset:28800
    v_mfma_f32_16x16x32_bf16 v[76:79], v[136:139], v[172:175], v[76:79]
    s_add_u32 m0, s23, 16384
    s_nop 0
    buffer_load_dwordx4 v249, s[80:83], s20 offen sc1 lds
    v_mfma_f32_16x16x32_bf16 v[32:35], v[128:131], v[160:163], v[32:35]
    ds_read_b64_tr_b16 v[106:107], v238 offset:32384
    v_mfma_f32_16x16x32_bf16 v[36:39], v[128:131], v[164:167], v[36:39]
    ds_read_b64_tr_b16 v[116:117], v238 offset:43200
    v_mfma_f32_16x16x32_bf16 v[40:43], v[128:131], v[168:171], v[40:43]
    ds_read_b64_tr_b16 v[118:119], v238 offset:46784
    v_mfma_f32_16x16x32_bf16 v[44:47], v[128:131], v[172:175], v[44:47]
    s_add_u32 m0, s23, 16384
    s_nop 0
    buffer_load_dwordx4 v249, s[80:83], s20 offen offset:1024 sc1 lds
    s_add_u32 s20, s20, 8192
    s_cmp_eq_u32 s20, s22
    s_cselect_b32 s20, s21, s20
    v_mfma_f32_16x16x32_bf16 v[80:83], v[140:143], v[160:163], v[80:83]
    v_mfma_f32_16x16x32_bf16 v[84:87], v[140:143], v[164:167], v[84:87]
    v_mfma_f32_16x16x32_bf16 v[88:91], v[140:143], v[168:171], v[88:91]
    v_mfma_f32_16x16x32_bf16 v[92:95], v[140:143], v[172:175], v[92:95]
    s_sub_u32 s24, s24, 1
    s_cmp_lg_u32 s24, 0
    s_cbranch_scc1 g3c1_loop
    s_sub_u32 s27, s74, s58
    s_and_b32 s27, s27, 7
    s_cmp_lt_u32 s27, 4
    s_cselect_b32 s27, 14, 0
    s_waitcnt vmcnt(5) lgkmcnt(0)
    s_barrier
    v_mfma_f32_16x16x32_bf16 v[0:3], v[96:99], v[144:147], v[0:3]
    ds_read_b128 v[160:163], v235 offset:8192
    ds_read_b128 v[164:167], v235 offset:9216
    v_pk_add_f32 v[176:177], v[176:177], v[192:193]
    v_pk_add_f32 v[178:179], v[178:179], v[194:195]
    v_mfma_f32_16x16x32_bf16 v[4:7], v[96:99], v[148:151], v[4:7]
    ds_read_b128 v[168:171], v235 offset:10240
    v_pk_add_f32 v[180:181], v[180:181], v[196:197]
    v_mfma_f32_16x16x32_bf16 v[8:11], v[96:99], v[152:155], v[8:11]
    ds_read_b128 v[172:175], v235 offset:11264
    v_pk_add_f32 v[182:183], v[182:183], v[198:199]
    v_mfma_f32_16x16x32_bf16 v[12:15], v[96:99], v[156:159], v[12:15]
    s_add_u32 m0, s19, 0
    s_nop 0
    buffer_load_dwordx4 v228, s[8:11], s16 offen lds
    v_pk_add_f32 v[184:185], v[184:185], v[200:201]
    v_mfma_f32_16x16x32_bf16 v[48:51], v[108:111], v[144:147], v[48:51]
    ds_read_b64_tr_b16 v[120:121], v237 offset:0
    v_pk_add_f32 v[186:187], v[186:187], v[202:203]
    v_mfma_f32_16x16x32_bf16 v[52:55], v[108:111], v[148:151], v[52:55]
    ds_read_b64_tr_b16 v[122:123], v237 offset:3584
    v_pk_add_f32 v[188:189], v[188:189], v[204:205]
    v_mfma_f32_16x16x32_bf16 v[56:59], v[108:111], v[152:155], v[56:59]
    ds_read_b64_tr_b16 v[132:133], v237 offset:14400
    v_pk_add_f32 v[190:191], v[190:191], v[206:207]
    v_pk_add_f32 v[176:177], v[176:177], v[184:185]
    v_mfma_f32_16x16x32_bf16 v[60:63], v[108:111], v[156:159], v[60:63]
    s_add_u32 m0, s19, 1024
    s_nop 0
    buffer_load_dwordx4 v229, s[8:11], s16 offen lds
    v_pk_add_f32 v[178:179], v[178:179], v[186:187]
    v_mfma_f32_16x16x32_bf16 v[16:19], v[100:103], v[144:147], v[16:19]
    ds_read_b64_tr_b16 v[134:135], v237 offset:17984
    v_pk_add_f32 v[180:181], v[180:181], v[188:189]
    v_mfma_f32_16x16x32_bf16 v[20:23], v[100:103], v[148:151], v[20:23]
    ds_read_b64_tr_b16 v[124:125], v237 offset:32
    v_pk_add_f32 v[182:183], v[182:183], v[190:191]
    v_mfma_f32_16x16x32_bf16 v[24:27], v[100:103], v[152:155], v[24:27]
    ds_read_b64_tr_b16 v[126:127], v237 offset:3616
    v_pk_add_f32 v[176:177], v[176:177], v[180:181]
    v_mfma_f32_16x16x32_bf16 v[28:31], v[100:103], v[156:159], v[28:31]
    s_add_u32 m0, s19, 2048
    s_nop 0
    buffer_load_dwordx4 v230, s[8:11], s16 offen lds
    s_add_u32 s16, s16, 229376
    s_cmp_eq_u32 s16, s18
    s_cselect_b32 s16, s17, s16
    v_pk_add_f32 v[178:179], v[178:179], v[182:183]
    v_mfma_f32_16x16x32_bf16 v[64:67], v[112:115], v[144:147], v[64:67]
    ds_read_b64_tr_b16 v[136:137], v237 offset:14432
    v_mov_b32 v180, v176
    v_mov_b32 v181, v177
    v_mfma_f32_16x16x32_bf16 v[68:71], v[112:115], v[148:151], v[68:71]
    ds_read_b64_tr_b16 v[138:139], v237 offset:18016
    v_mov_b32 v182, v178
    v_mfma_f32_16x16x32_bf16 v[72:75], v[112:115], v[152:155], v[72:75]
    ds_read_b64_tr_b16 v[128:129], v239 offset:0
    v_mov_b32 v183, v179
    v_mfma_f32_16x16x32_bf16 v[76:79], v[112:115], v[156:159], v[76:79]
    s_add_u32 m0, s23, 24576
    s_nop 0
    buffer_load_dwordx4 v249, s[80:83], s20 offen sc1 lds
    s_nop 1
    v_mfma_f32_16x16x32_bf16 v[32:35], v[104:107], v[144:147], v[32:35]
    ds_read_b64_tr_b16 v[130:131], v239 offset:3584
    v_permlane32_swap_b32 v176, v180
    v_mfma_f32_16x16x32_bf16 v[36:39], v[104:107], v[148:151], v[36:39]
    ds_read_b64_tr_b16 v[140:141], v239 offset:14400
    v_permlane32_swap_b32 v177, v181
    v_mfma_f32_16x16x32_bf16 v[40:43], v[104:107], v[152:155], v[40:43]
    ds_read_b64_tr_b16 v[142:143], v239 offset:17984
    v_permlane32_swap_b32 v178, v182
    v_permlane32_swap_b32 v179, v183
    v_mfma_f32_16x16x32_bf16 v[44:47], v[104:107], v[156:159], v[44:47]
    s_add_u32 m0, s23, 24576
    s_nop 0
    buffer_load_dwordx4 v249, s[80:83], s20 offen offset:1024 sc1 lds
    s_add_u32 s20, s20, 8192
    s_cmp_eq_u32 s20, s22
    s_cselect_b32 s20, s21, s20
    v_add_f32 v176, v176, v180
    v_mfma_f32_16x16x32_bf16 v[80:83], v[116:119], v[144:147], v[80:83]
    v_add_f32 v177, v177, v181
    v_mfma_f32_16x16x32_bf16 v[84:87], v[116:119], v[148:151], v[84:87]
    v_add_f32 v178, v178, v182
    v_mfma_f32_16x16x32_bf16 v[88:91], v[116:119], v[152:155], v[88:91]
    v_add_f32 v179, v179, v183
    v_mfma_f32_16x16x32_bf16 v[92:95], v[116:119], v[156:159], v[92:95]
    s_and_b32 s64, s3, 1
    s_mul_i32 s64, s64, 896
    s_lshr_b32 s65, s69, 1
    s_mul_i32 s65, s65, 448
    s_add_u32 s64, s64, s65
    s_add_u32 s64, s64, 160896
    v_add_u32 v225, s64, v249
    s_cmp_lg_u32 s75, 0
    s_cbranch_scc1 g3c1_ncs
    s_mov_b64 exec, 0x0fffffff
    ds_write_b128 v225, v[176:179]
    s_mov_b64 exec, -1
g3c1_ncs:
    s_waitcnt vmcnt(5) lgkmcnt(0)
    s_barrier
    v_mfma_f32_16x16x32_bf16 v[0:3], v[120:123], v[160:163], v[0:3]
    ds_read_b128 v[144:147], v235 offset:16384
    s_mov_b32 s12, s96
    v_mfma_f32_16x16x32_bf16 v[4:7], v[120:123], v[164:167], v[4:7]
    ds_read_b128 v[148:151], v235 offset:17408
    s_mov_b32 s13, s97
    v_mfma_f32_16x16x32_bf16 v[8:11], v[120:123], v[168:171], v[8:11]
    ds_read_b128 v[152:155], v235 offset:18432
    s_mov_b32 s14, 7340032
    v_mfma_f32_16x16x32_bf16 v[12:15], v[120:123], v[172:175], v[12:15]
    ds_read_b128 v[156:159], v235 offset:19456
    s_mov_b32 s15, 0x00020000
    v_mfma_f32_16x16x32_bf16 v[48:51], v[132:135], v[160:163], v[48:51]
    v_mfma_f32_16x16x32_bf16 v[52:55], v[132:135], v[164:167], v[52:55]
    ds_read_b64_tr_b16 v[96:97], v237 offset:28800
    v_lshlrev_b32 v253, 14, v251
    v_mfma_f32_16x16x32_bf16 v[56:59], v[132:135], v[168:171], v[56:59]
    ds_read_b64_tr_b16 v[98:99], v237 offset:32384
    v_and_b32 v254, 8, v252
    v_lshlrev_b32 v247, 7, v250
    s_add_u32 s29, s3, 0
    s_lshl_b32 s30, s29, 12
    s_add_u32 s30, s30, s25
    s_cmp_lt_u32 s29, s27
    s_cselect_b32 s30, s30, 0x7f000000
    s_mov_b64 exec, 0xffffffff
    buffer_load_dword v248, v247, s[80:83], s30 offen sc1
    s_mov_b64 exec, -1
    v_mfma_f32_16x16x32_bf16 v[60:63], v[132:135], v[172:175], v[60:63]
    ds_read_b64_tr_b16 v[108:109], v237 offset:43200
    v_lshl_add_u32 v253, v254, 7, v253
    v_mfma_f32_16x16x32_bf16 v[16:19], v[124:127], v[160:163], v[16:19]
    ds_read_b64_tr_b16 v[110:111], v237 offset:46784
    v_and_b32 v254, 7, v252
    v_mfma_f32_16x16x32_bf16 v[20:23], v[124:127], v[164:167], v[20:23]
    v_mfma_f32_16x16x32_bf16 v[24:27], v[124:127], v[168:171], v[24:27]
    ds_read_b64_tr_b16 v[100:101], v237 offset:28832
    v_lshl_add_u32 v253, v254, 4, v253
    v_mfma_f32_16x16x32_bf16 v[28:31], v[124:127], v[172:175], v[28:31]
    ds_read_b64_tr_b16 v[102:103], v237 offset:32416
    s_lshl_b32 s64, s69, 12
    v_mfma_f32_16x16x32_bf16 v[64:67], v[136:139], v[160:163], v[64:67]
    ds_read_b64_tr_b16 v[112:113], v237 offset:43232
    v_add_u32 v244, s64, v253
    v_mfma_f32_16x16x32_bf16 v[68:71], v[136:139], v[164:167], v[68:71]
    ds_read_b64_tr_b16 v[114:115], v237 offset:46816
    v_add_u32 v245, 2048, v244
    v_mfma_f32_16x16x32_bf16 v[72:75], v[136:139], v[168:171], v[72:75]
    v_mfma_f32_16x16x32_bf16 v[76:79], v[136:139], v[172:175], v[76:79]
    ds_read_b64_tr_b16 v[104:105], v239 offset:28800
    s_mul_i32 s51, s69, 2112
    v_mfma_f32_16x16x32_bf16 v[32:35], v[128:131], v[160:163], v[32:35]
    ds_read_b64_tr_b16 v[106:107], v239 offset:32384
    s_lshr_b32 s64, s74, 3
    v_mfma_f32_16x16x32_bf16 v[36:39], v[128:131], v[164:167], v[36:39]
    ds_read_b64_tr_b16 v[116:117], v239 offset:43200
    s_mul_i32 s49, s64, 3670016
    v_mfma_f32_16x16x32_bf16 v[40:43], v[128:131], v[168:171], v[40:43]
    ds_read_b64_tr_b16 v[118:119], v239 offset:46784
    s_lshl_b32 s65, s61, 7
    v_mfma_f32_16x16x32_bf16 v[44:47], v[128:131], v[172:175], v[44:47]
    v_mfma_f32_16x16x32_bf16 v[80:83], v[140:143], v[160:163], v[80:83]
    s_add_u32 s49, s49, s65
    v_lshlrev_b32 v247, 7, v250
    s_add_u32 s29, s3, 8
    s_lshl_b32 s30, s29, 12
    s_add_u32 s30, s30, s25
    s_cmp_lt_u32 s29, s27
    s_cselect_b32 s30, s30, 0x7f000000
    s_mov_b64 exec, 0xffffffff
    buffer_load_dword v248, v247, s[80:83], s30 offen sc1
    s_mov_b64 exec, -1
    v_mfma_f32_16x16x32_bf16 v[84:87], v[140:143], v[164:167], v[84:87]
    s_sub_u32 s50, s74, s58
    v_mfma_f32_16x16x32_bf16 v[88:91], v[140:143], v[168:171], v[88:91]
    s_and_b32 s50, s50, 7
    v_mfma_f32_16x16x32_bf16 v[92:95], v[140:143], v[172:175], v[92:95]
    s_waitcnt vmcnt(2) lgkmcnt(0)
    s_barrier
    s_setprio 1
    ds_read_b128 v[160:163], v235 offset:24576
    ds_read_b128 v[164:167], v235 offset:25600
    ds_read_b128 v[168:171], v235 offset:26624
    ds_read_b128 v[172:175], v235 offset:27648
    ds_read_b64_tr_b16 v[120:121], v236 offset:0
    ds_read_b64_tr_b16 v[122:123], v236 offset:3584
    ds_read_b64_tr_b16 v[132:133], v236 offset:14400
    ds_read_b64_tr_b16 v[134:135], v236 offset:17984
    ds_read_b64_tr_b16 v[124:125], v236 offset:32
    ds_read_b64_tr_b16 v[126:127], v236 offset:3616
    ds_read_b64_tr_b16 v[136:137], v236 offset:14432
    ds_read_b64_tr_b16 v[138:139], v236 offset:18016
    ds_read_b64_tr_b16 v[128:129], v238 offset:0
    ds_read_b64_tr_b16 v[130:131], v238 offset:3584
    ds_read_b64_tr_b16 v[140:141], v238 offset:14400
    ds_read_b64_tr_b16 v[142:143], v238 offset:17984
    s_waitcnt lgkmcnt(0)
    s_and_b32 s48, s74, 7
    s_mul_i32 s48, s48, 458752
    s_add_u32 s48, s48, s49
    s_add_u32 m0, s51, 107776
    s_nop 0
    buffer_load_dwordx4 v244, s[12:15], s48 offen lds
    s_add_u32 m0, s51, 108832
    s_nop 0
    buffer_load_dwordx4 v245, s[12:15], s48 offen lds
    s_add_u32 s48, s48, 65536
    s_barrier
    s_add_u32 m0, s51, 116224
    s_nop 0
    buffer_load_dwordx4 v244, s[12:15], s48 offen lds
    s_add_u32 m0, s51, 117280
    s_nop 0
    buffer_load_dwordx4 v245, s[12:15], s48 offen lds
    s_add_u32 s48, s48, 65536
    s_add_u32 m0, s51, 124672
    s_nop 0
    buffer_load_dwordx4 v244, s[12:15], s48 offen lds
    s_add_u32 m0, s51, 125728
    s_nop 0
    buffer_load_dwordx4 v245, s[12:15], s48 offen lds
    s_add_u32 s48, s48, 65536
    s_add_u32 m0, s51, 133120
    s_nop 0
    buffer_load_dwordx4 v244, s[12:15], s48 offen lds
    s_add_u32 m0, s51, 134176
    s_nop 0
    buffer_load_dwordx4 v245, s[12:15], s48 offen lds
    s_add_u32 s48, s48, 65536
    v_mfma_f32_16x16x32_bf16 v[0:3], v[96:99], v[144:147], v[0:3]
    s_add_u32 m0, s51, 141568
    s_nop 0
    buffer_load_dwordx4 v244, s[12:15], s48 offen lds
    v_mfma_f32_16x16x32_bf16 v[4:7], v[96:99], v[148:151], v[4:7]
    v_mfma_f32_16x16x32_bf16 v[8:11], v[96:99], v[152:155], v[8:11]
    v_mfma_f32_16x16x32_bf16 v[12:15], v[96:99], v[156:159], v[12:15]
    v_mfma_f32_16x16x32_bf16 v[48:51], v[108:111], v[144:147], v[48:51]
    s_add_u32 m0, s51, 142624
    s_nop 0
    buffer_load_dwordx4 v245, s[12:15], s48 offen lds
    s_add_u32 s48, s48, 65536
    v_mfma_f32_16x16x32_bf16 v[52:55], v[108:111], v[148:151], v[52:55]
    v_mfma_f32_16x16x32_bf16 v[56:59], v[108:111], v[152:155], v[56:59]
    v_mfma_f32_16x16x32_bf16 v[60:63], v[108:111], v[156:159], v[60:63]
    v_mfma_f32_16x16x32_bf16 v[16:19], v[100:103], v[144:147], v[16:19]
    s_add_u32 m0, s51, 65536
    s_nop 0
    buffer_load_dwordx4 v244, s[12:15], s48 offen lds
    v_mfma_f32_16x16x32_bf16 v[20:23], v[100:103], v[148:151], v[20:23]
    v_mfma_f32_16x16x32_bf16 v[24:27], v[100:103], v[152:155], v[24:27]
    v_mfma_f32_16x16x32_bf16 v[28:31], v[100:103], v[156:159], v[28:31]
    v_mfma_f32_16x16x32_bf16 v[64:67], v[112:115], v[144:147], v[64:67]
    s_add_u32 m0, s51, 66592
    s_nop 0
    buffer_load_dwordx4 v245, s[12:15], s48 offen lds
    s_add_u32 s48, s48, 65536
    v_mfma_f32_16x16x32_bf16 v[68:71], v[112:115], v[148:151], v[68:71]
    v_mfma_f32_16x16x32_bf16 v[72:75], v[112:115], v[152:155], v[72:75]
    v_mfma_f32_16x16x32_bf16 v[76:79], v[112:115], v[156:159], v[76:79]
    v_mfma_f32_16x16x32_bf16 v[32:35], v[104:107], v[144:147], v[32:35]
    s_add_u32 m0, s51, 73984
    s_nop 0
    buffer_load_dwordx4 v244, s[12:15], s48 offen lds
    v_mfma_f32_16x16x32_bf16 v[36:39], v[104:107], v[148:151], v[36:39]
    v_mfma_f32_16x16x32_bf16 v[40:43], v[104:107], v[152:155], v[40:43]
    v_mfma_f32_16x16x32_bf16 v[44:47], v[104:107], v[156:159], v[44:47]
    v_mfma_f32_16x16x32_bf16 v[80:83], v[116:119], v[144:147], v[80:83]
    s_add_u32 m0, s51, 75040
    s_nop 0
    buffer_load_dwordx4 v245, s[12:15], s48 offen lds
    s_add_u32 s48, s48, 65536
    v_mfma_f32_16x16x32_bf16 v[84:87], v[116:119], v[148:151], v[84:87]
    v_mfma_f32_16x16x32_bf16 v[88:91], v[116:119], v[152:155], v[88:91]
    v_mfma_f32_16x16x32_bf16 v[92:95], v[116:119], v[156:159], v[92:95]
    s_and_b32 s64, s3, 1
    s_lshl_b32 s64, s64, 9
    s_add_u32 s64, s64, 159744
    v_lshlrev_b32 v253, 3, v252
    v_add_u32 v253, s64, v253
    s_lshl_b32 s64, s28, 6
    s_add_u32 s64, s64, 160896
    v_lshlrev_b32 v254, 4, v251
    v_add_u32 v235, s64, v254
    s_lshr_b32 s64, s69, 1
    s_add_u32 s64, s64, 10
    s_lshl_b32 s64, s64, 6
    s_add_u32 s64, s64, 160896
    v_add_u32 v238, s64, v254
    v_mfma_f32_16x16x32_bf16 v[0:3], v[120:123], v[160:163], v[0:3]
    ds_read_b64 v[144:145], v253 offset:0
    s_cmp_le_u32 s50, 0
    s_addc_u32 s48, s58, 0
    s_and_b32 s48, s48, 7
    s_mul_i32 s48, s48, 458752
    s_add_u32 s48, s48, s49
    s_add_u32 m0, s51, 82432
    s_nop 0
    buffer_load_dwordx4 v244, s[12:15], s48 offen lds
    v_mfma_f32_16x16x32_bf16 v[4:7], v[120:123], v[164:167], v[4:7]
    ds_read_b64 v[146:147], v253 offset:128
    v_mfma_f32_16x16x32_bf16 v[8:11], v[120:123], v[168:171], v[8:11]
    ds_read_b64 v[148:149], v253 offset:256
    v_mfma_f32_16x16x32_bf16 v[12:15], v[120:123], v[172:175], v[12:15]
    ds_read_b64 v[150:151], v253 offset:384
    s_add_u32 m0, s51, 83488
    s_nop 0
    buffer_load_dwordx4 v245, s[12:15], s48 offen lds
    s_add_u32 s48, s48, 65536
    v_mfma_f32_16x16x32_bf16 v[48:51], v[132:135], v[160:163], v[48:51]
    v_mfma_f32_16x16x32_bf16 v[52:55], v[132:135], v[164:167], v[52:55]
    ds_read_b128 v[96:99], v235 offset:0
    v_mfma_f32_16x16x32_bf16 v[56:59], v[132:135], v[168:171], v[56:59]
    ds_read_b128 v[100:103], v235 offset:64
    v_mfma_f32_16x16x32_bf16 v[60:63], v[132:135], v[172:175], v[60:63]
    ds_read_b128 v[104:107], v238 offset:0
    s_add_u32 m0, s51, 90880
    s_nop 0
    buffer_load_dwordx4 v244, s[12:15], s48 offen lds
    v_mfma_f32_16x16x32_bf16 v[16:19], v[124:127], v[160:163], v[16:19]
    v_mfma_f32_16x16x32_bf16 v[20:23], v[124:127], v[164:167], v[20:23]
    ds_read_b128 v[108:111], v235 offset:896
    v_mfma_f32_16x16x32_bf16 v[24:27], v[124:127], v[168:171], v[24:27]
    ds_read_b128 v[112:115], v235 offset:960
    v_mfma_f32_16x16x32_bf16 v[28:31], v[124:127], v[172:175], v[28:31]
    ds_read_b128 v[116:119], v238 offset:896
    s_add_u32 m0, s51, 91936
    s_nop 0
    buffer_load_dwordx4 v245, s[12:15], s48 offen lds
    s_add_u32 s48, s48, 65536
    v_mfma_f32_16x16x32_bf16 v[64:67], v[136:139], v[160:163], v[64:67]
    v_mfma_f32_16x16x32_bf16 v[68:71], v[136:139], v[164:167], v[68:71]
    v_mfma_f32_16x16x32_bf16 v[72:75], v[136:139], v[168:171], v[72:75]
    v_mfma_f32_16x16x32_bf16 v[76:79], v[136:139], v[172:175], v[76:79]
    s_add_u32 m0, s51, 99328
    s_nop 0
    buffer_load_dwordx4 v244, s[12:15], s48 offen lds
    v_mfma_f32_16x16x32_bf16 v[32:35], v[128:131], v[160:163], v[32:35]
    v_mfma_f32_16x16x32_bf16 v[36:39], v[128:131], v[164:167], v[36:39]
    v_mfma_f32_16x16x32_bf16 v[40:43], v[128:131], v[168:171], v[40:43]
    v_mfma_f32_16x16x32_bf16 v[44:47], v[128:131], v[172:175], v[44:47]
    s_add_u32 m0, s51, 100384
    s_nop 0
    buffer_load_dwordx4 v245, s[12:15], s48 offen lds
    s_add_u32 s48, s48, 65536
    v_mfma_f32_16x16x32_bf16 v[80:83], v[140:143], v[160:163], v[80:83]
    v_mfma_f32_16x16x32_bf16 v[84:87], v[140:143], v[164:167], v[84:87]
    v_mfma_f32_16x16x32_bf16 v[88:91], v[140:143], v[168:171], v[88:91]
    v_mfma_f32_16x16x32_bf16 v[92:95], v[140:143], v[172:175], v[92:95]
    s_and_b32 s64, s3, 1
    s_lshl_b32 s64, s64, 12
    s_add_u32 s25, s25, s64
    s_lshr_b32 s64, s69, 1
    s_lshl_b32 s65, s64, 3
    s_add_u32 s26, s25, s65
    s_add_u32 s26, s26, 40960
    s_lshl_b32 s64, s64, 14
    s_add_u32 s25, s25, s64
    s_add_u32 s25, s25, 32768
    s_and_b32 s64, s3, 1
    s_lshl_b32 s64, s64, 12
    s_lshr_b32 s65, s69, 1
    s_lshl_b32 s66, s65, 3
    s_add_u32 s66, s66, s64
    s_add_u32 s66, s66, 32768
    v_add_u32 v237, s66, v249
    s_lshl_b32 s65, s65, 14
    s_add_u32 s64, s64, s65
    s_add_u32 s64, s64, 24576
    v_add_u32 v236, s64, v249
    s_waitcnt lgkmcnt(0)
    s_mov_b32 s64, 0xbfb8aa3b
    v_mul_f32 v136, v145, v145
    v_sub_f32 v120, 0, v144
    v_mul_f32 v128, s64, v145
    v_sub_f32 v121, 0, v144
    v_mul_f32 v129, s64, v145
    v_mul_f32 v138, v147, v147
    v_sub_f32 v122, 0, v146
    v_mul_f32 v130, s64, v147
    v_sub_f32 v123, 0, v146
    v_mul_f32 v131, s64, v147
    v_mul_f32 v140, v149, v149
    v_sub_f32 v124, 0, v148
    v_mul_f32 v132, s64, v149
    v_sub_f32 v125, 0, v148
    v_mul_f32 v133, s64, v149
    v_mul_f32 v142, v151, v151
    v_sub_f32 v126, 0, v150
    v_mul_f32 v134, s64, v151
    v_sub_f32 v127, 0, v150
    v_mul_f32 v135, s64, v151
    v_rcp_f32 v137, v136
    v_rcp_f32 v136, v136
    v_rcp_f32 v139, v138
    v_rcp_f32 v138, v138
    v_rcp_f32 v141, v140
    v_rcp_f32 v140, v140
    v_rcp_f32 v143, v142
    v_rcp_f32 v142, v142
    v_pk_fma_f32 v[0:1], v[120:121], v[96:97], v[0:1]
    v_pk_fma_f32 v[2:3], v[120:121], v[98:99], v[2:3]
    v_pk_mul_f32 v[164:165], v[128:129], v[0:1]
    v_pk_mul_f32 v[166:167], v[128:129], v[2:3]
    v_exp_f32 v164, v164
    v_exp_f32 v165, v165
    v_exp_f32 v166, v166
    v_exp_f32 v167, v167
    v_pk_fma_f32 v[48:49], v[120:121], v[108:109], v[48:49]
    v_pk_fma_f32 v[50:51], v[120:121], v[110:111], v[50:51]
    v_pk_fma_f32 v[164:165], v[164:165], v[136:137], v[136:137]
    v_pk_fma_f32 v[166:167], v[166:167], v[136:137], v[136:137]
    v_rcp_f32 v164, v164
    v_rcp_f32 v165, v165
    v_rcp_f32 v166, v166
    v_rcp_f32 v167, v167
    v_pk_mul_f32 v[0:1], v[0:1], v[48:49]
    v_pk_mul_f32 v[2:3], v[2:3], v[50:51]
    v_pk_mul_f32 v[0:1], v[0:1], v[164:165]
    v_pk_mul_f32 v[2:3], v[2:3], v[166:167]
    v_cvt_pk_bf16_f32 v168, v0, v1
    v_cvt_pk_bf16_f32 v169, v2, v3
    v_pk_fma_f32 v[16:17], v[120:121], v[100:101], v[16:17]
    v_pk_fma_f32 v[18:19], v[120:121], v[102:103], v[18:19]
    v_pk_mul_f32 v[164:165], v[128:129], v[16:17]
    v_pk_mul_f32 v[166:167], v[128:129], v[18:19]
    v_exp_f32 v164, v164
    v_exp_f32 v165, v165
    v_exp_f32 v166, v166
    v_exp_f32 v167, v167
    v_pk_fma_f32 v[64:65], v[120:121], v[112:113], v[64:65]
    v_pk_fma_f32 v[66:67], v[120:121], v[114:115], v[66:67]
    v_pk_fma_f32 v[164:165], v[164:165], v[136:137], v[136:137]
    v_pk_fma_f32 v[166:167], v[166:167], v[136:137], v[136:137]
    v_rcp_f32 v164, v164
    v_rcp_f32 v165, v165
    v_rcp_f32 v166, v166
    v_rcp_f32 v167, v167
    v_pk_mul_f32 v[16:17], v[16:17], v[64:65]
    v_pk_mul_f32 v[18:19], v[18:19], v[66:67]
    v_pk_mul_f32 v[16:17], v[16:17], v[164:165]
    v_pk_mul_f32 v[18:19], v[18:19], v[166:167]
    v_cvt_pk_bf16_f32 v170, v16, v17
    v_cvt_pk_bf16_f32 v171, v18, v19
    buffer_store_dwordx4 v[168:171], v249, s[80:83], s25 offen offset:0
    ds_write_b128 v236, v[168:171] offset:0
    v_pk_fma_f32 v[32:33], v[120:121], v[104:105], v[32:33]
    v_pk_fma_f32 v[34:35], v[120:121], v[106:107], v[34:35]
    v_pk_mul_f32 v[164:165], v[128:129], v[32:33]
    v_pk_mul_f32 v[166:167], v[128:129], v[34:35]
    v_exp_f32 v164, v164
    v_exp_f32 v165, v165
    v_exp_f32 v166, v166
    v_exp_f32 v167, v167
    v_pk_fma_f32 v[80:81], v[120:121], v[116:117], v[80:81]
    v_pk_fma_f32 v[82:83], v[120:121], v[118:119], v[82:83]
    v_pk_fma_f32 v[164:165], v[164:165], v[136:137], v[136:137]
    v_pk_fma_f32 v[166:167], v[166:167], v[136:137], v[136:137]
    v_rcp_f32 v164, v164
    v_rcp_f32 v165, v165
    v_rcp_f32 v166, v166
    v_rcp_f32 v167, v167
    v_pk_mul_f32 v[32:33], v[32:33], v[80:81]
    v_pk_mul_f32 v[34:35], v[34:35], v[82:83]
    v_pk_mul_f32 v[32:33], v[32:33], v[164:165]
    v_pk_mul_f32 v[34:35], v[34:35], v[166:167]
    v_cvt_pk_bf16_f32 v172, v32, v33
    v_cvt_pk_bf16_f32 v173, v34, v35
    buffer_store_dwordx2 v[172:173], v249, s[80:83], s26 offen offset:0
    ds_write_b64 v237, v[172:173] offset:0
    v_pk_fma_f32 v[4:5], v[122:123], v[96:97], v[4:5]
    v_pk_fma_f32 v[6:7], v[122:123], v[98:99], v[6:7]
    v_pk_mul_f32 v[164:165], v[130:131], v[4:5]
    v_pk_mul_f32 v[166:167], v[130:131], v[6:7]
    v_exp_f32 v164, v164
    v_exp_f32 v165, v165
    v_exp_f32 v166, v166
    v_exp_f32 v167, v167
    v_pk_fma_f32 v[52:53], v[122:123], v[108:109], v[52:53]
    v_pk_fma_f32 v[54:55], v[122:123], v[110:111], v[54:55]
    v_pk_fma_f32 v[164:165], v[164:165], v[138:139], v[138:139]
    v_pk_fma_f32 v[166:167], v[166:167], v[138:139], v[138:139]
    v_rcp_f32 v164, v164
    v_rcp_f32 v165, v165
    v_rcp_f32 v166, v166
    v_rcp_f32 v167, v167
    v_pk_mul_f32 v[4:5], v[4:5], v[52:53]
    v_pk_mul_f32 v[6:7], v[6:7], v[54:55]
    v_pk_mul_f32 v[4:5], v[4:5], v[164:165]
    v_pk_mul_f32 v[6:7], v[6:7], v[166:167]
    v_cvt_pk_bf16_f32 v168, v4, v5
    v_cvt_pk_bf16_f32 v169, v6, v7
    v_pk_fma_f32 v[20:21], v[122:123], v[100:101], v[20:21]
    v_pk_fma_f32 v[22:23], v[122:123], v[102:103], v[22:23]
    v_pk_mul_f32 v[164:165], v[130:131], v[20:21]
    v_pk_mul_f32 v[166:167], v[130:131], v[22:23]
    v_exp_f32 v164, v164
    v_exp_f32 v165, v165
    v_exp_f32 v166, v166
    v_exp_f32 v167, v167
    v_pk_fma_f32 v[68:69], v[122:123], v[112:113], v[68:69]
    v_pk_fma_f32 v[70:71], v[122:123], v[114:115], v[70:71]
    v_pk_fma_f32 v[164:165], v[164:165], v[138:139], v[138:139]
    v_pk_fma_f32 v[166:167], v[166:167], v[138:139], v[138:139]
    v_rcp_f32 v164, v164
    v_rcp_f32 v165, v165
    v_rcp_f32 v166, v166
    v_rcp_f32 v167, v167
    v_pk_mul_f32 v[20:21], v[20:21], v[68:69]
    v_pk_mul_f32 v[22:23], v[22:23], v[70:71]
    v_pk_mul_f32 v[20:21], v[20:21], v[164:165]
    v_pk_mul_f32 v[22:23], v[22:23], v[166:167]
    v_cvt_pk_bf16_f32 v170, v20, v21
    v_cvt_pk_bf16_f32 v171, v22, v23
    buffer_store_dwordx4 v[168:171], v249, s[80:83], s25 offen offset:1024
    ds_write_b128 v236, v[168:171] offset:1024
    v_pk_fma_f32 v[36:37], v[122:123], v[104:105], v[36:37]
    v_pk_fma_f32 v[38:39], v[122:123], v[106:107], v[38:39]
    v_pk_mul_f32 v[164:165], v[130:131], v[36:37]
    v_pk_mul_f32 v[166:167], v[130:131], v[38:39]
    v_exp_f32 v164, v164
    v_exp_f32 v165, v165
    v_exp_f32 v166, v166
    v_exp_f32 v167, v167
    v_pk_fma_f32 v[84:85], v[122:123], v[116:117], v[84:85]
    v_pk_fma_f32 v[86:87], v[122:123], v[118:119], v[86:87]
    v_pk_fma_f32 v[164:165], v[164:165], v[138:139], v[138:139]
    v_pk_fma_f32 v[166:167], v[166:167], v[138:139], v[138:139]
    v_rcp_f32 v164, v164
    v_rcp_f32 v165, v165
    v_rcp_f32 v166, v166
    v_rcp_f32 v167, v167
    v_pk_mul_f32 v[36:37], v[36:37], v[84:85]
    v_pk_mul_f32 v[38:39], v[38:39], v[86:87]
    v_pk_mul_f32 v[36:37], v[36:37], v[164:165]
    v_pk_mul_f32 v[38:39], v[38:39], v[166:167]
    v_cvt_pk_bf16_f32 v172, v36, v37
    v_cvt_pk_bf16_f32 v173, v38, v39
    buffer_store_dwordx2 v[172:173], v249, s[80:83], s26 offen offset:1024
    ds_write_b64 v237, v[172:173] offset:1024
    v_pk_fma_f32 v[8:9], v[124:125], v[96:97], v[8:9]
    v_pk_fma_f32 v[10:11], v[124:125], v[98:99], v[10:11]
    v_pk_mul_f32 v[164:165], v[132:133], v[8:9]
    v_pk_mul_f32 v[166:167], v[132:133], v[10:11]
    v_exp_f32 v164, v164
    v_exp_f32 v165, v165
    v_exp_f32 v166, v166
    v_exp_f32 v167, v167
    v_pk_fma_f32 v[56:57], v[124:125], v[108:109], v[56:57]
    v_pk_fma_f32 v[58:59], v[124:125], v[110:111], v[58:59]
    v_pk_fma_f32 v[164:165], v[164:165], v[140:141], v[140:141]
    v_pk_fma_f32 v[166:167], v[166:167], v[140:141], v[140:141]
    v_rcp_f32 v164, v164
    v_rcp_f32 v165, v165
    v_rcp_f32 v166, v166
    v_rcp_f32 v167, v167
    v_pk_mul_f32 v[8:9], v[8:9], v[56:57]
    v_pk_mul_f32 v[10:11], v[10:11], v[58:59]
    v_pk_mul_f32 v[8:9], v[8:9], v[164:165]
    v_pk_mul_f32 v[10:11], v[10:11], v[166:167]
    v_cvt_pk_bf16_f32 v168, v8, v9
    v_cvt_pk_bf16_f32 v169, v10, v11
    v_pk_fma_f32 v[24:25], v[124:125], v[100:101], v[24:25]
    v_pk_fma_f32 v[26:27], v[124:125], v[102:103], v[26:27]
    v_pk_mul_f32 v[164:165], v[132:133], v[24:25]
    v_pk_mul_f32 v[166:167], v[132:133], v[26:27]
    v_exp_f32 v164, v164
    v_exp_f32 v165, v165
    v_exp_f32 v166, v166
    v_exp_f32 v167, v167
    v_pk_fma_f32 v[72:73], v[124:125], v[112:113], v[72:73]
    v_pk_fma_f32 v[74:75], v[124:125], v[114:115], v[74:75]
    v_pk_fma_f32 v[164:165], v[164:165], v[140:141], v[140:141]
    v_pk_fma_f32 v[166:167], v[166:167], v[140:141], v[140:141]
    v_rcp_f32 v164, v164
    v_rcp_f32 v165, v165
    v_rcp_f32 v166, v166
    v_rcp_f32 v167, v167
    v_pk_mul_f32 v[24:25], v[24:25], v[72:73]
    v_pk_mul_f32 v[26:27], v[26:27], v[74:75]
    v_pk_mul_f32 v[24:25], v[24:25], v[164:165]
    v_pk_mul_f32 v[26:27], v[26:27], v[166:167]
    v_cvt_pk_bf16_f32 v170, v24, v25
    v_cvt_pk_bf16_f32 v171, v26, v27
    buffer_store_dwordx4 v[168:171], v249, s[80:83], s25 offen offset:2048
    ds_write_b128 v236, v[168:171] offset:2048
    v_pk_fma_f32 v[40:41], v[124:125], v[104:105], v[40:41]
    v_pk_fma_f32 v[42:43], v[124:125], v[106:107], v[42:43]
    v_pk_mul_f32 v[164:165], v[132:133], v[40:41]
    v_pk_mul_f32 v[166:167], v[132:133], v[42:43]
    v_exp_f32 v164, v164
    v_exp_f32 v165, v165
    v_exp_f32 v166, v166
    v_exp_f32 v167, v167
    v_pk_fma_f32 v[88:89], v[124:125], v[116:117], v[88:89]
    v_pk_fma_f32 v[90:91], v[124:125], v[118:119], v[90:91]
    v_pk_fma_f32 v[164:165], v[164:165], v[140:141], v[140:141]
    v_pk_fma_f32 v[166:167], v[166:167], v[140:141], v[140:141]
    v_rcp_f32 v164, v164
    v_rcp_f32 v165, v165
    v_rcp_f32 v166, v166
    v_rcp_f32 v167, v167
    v_pk_mul_f32 v[40:41], v[40:41], v[88:89]
    v_pk_mul_f32 v[42:43], v[42:43], v[90:91]
    v_pk_mul_f32 v[40:41], v[40:41], v[164:165]
    v_pk_mul_f32 v[42:43], v[42:43], v[166:167]
    v_cvt_pk_bf16_f32 v172, v40, v41
    v_cvt_pk_bf16_f32 v173, v42, v43
    buffer_store_dwordx2 v[172:173], v249, s[80:83], s26 offen offset:2048
    ds_write_b64 v237, v[172:173] offset:2048
    v_pk_fma_f32 v[12:13], v[126:127], v[96:97], v[12:13]
    v_pk_fma_f32 v[14:15], v[126:127], v[98:99], v[14:15]
    v_pk_mul_f32 v[164:165], v[134:135], v[12:13]
    v_pk_mul_f32 v[166:167], v[134:135], v[14:15]
    v_exp_f32 v164, v164
    v_exp_f32 v165, v165
    v_exp_f32 v166, v166
    v_exp_f32 v167, v167
    v_pk_fma_f32 v[60:61], v[126:127], v[108:109], v[60:61]
    v_pk_fma_f32 v[62:63], v[126:127], v[110:111], v[62:63]
    v_pk_fma_f32 v[164:165], v[164:165], v[142:143], v[142:143]
    v_pk_fma_f32 v[166:167], v[166:167], v[142:143], v[142:143]
    v_rcp_f32 v164, v164
    v_rcp_f32 v165, v165
    v_rcp_f32 v166, v166
    v_rcp_f32 v167, v167
    v_pk_mul_f32 v[12:13], v[12:13], v[60:61]
    v_pk_mul_f32 v[14:15], v[14:15], v[62:63]
    v_pk_mul_f32 v[12:13], v[12:13], v[164:165]
    v_pk_mul_f32 v[14:15], v[14:15], v[166:167]
    v_cvt_pk_bf16_f32 v168, v12, v13
    v_cvt_pk_bf16_f32 v169, v14, v15
    v_pk_fma_f32 v[28:29], v[126:127], v[100:101], v[28:29]
    v_pk_fma_f32 v[30:31], v[126:127], v[102:103], v[30:31]
    v_pk_mul_f32 v[164:165], v[134:135], v[28:29]
    v_pk_mul_f32 v[166:167], v[134:135], v[30:31]
    v_exp_f32 v164, v164
    v_exp_f32 v165, v165
    v_exp_f32 v166, v166
    v_exp_f32 v167, v167
    v_pk_fma_f32 v[76:77], v[126:127], v[112:113], v[76:77]
    v_pk_fma_f32 v[78:79], v[126:127], v[114:115], v[78:79]
    v_pk_fma_f32 v[164:165], v[164:165], v[142:143], v[142:143]
    v_pk_fma_f32 v[166:167], v[166:167], v[142:143], v[142:143]
    v_rcp_f32 v164, v164
    v_rcp_f32 v165, v165
    v_rcp_f32 v166, v166
    v_rcp_f32 v167, v167
    v_pk_mul_f32 v[28:29], v[28:29], v[76:77]
    v_pk_mul_f32 v[30:31], v[30:31], v[78:79]
    v_pk_mul_f32 v[28:29], v[28:29], v[164:165]
    v_pk_mul_f32 v[30:31], v[30:31], v[166:167]
    v_cvt_pk_bf16_f32 v170, v28, v29
    v_cvt_pk_bf16_f32 v171, v30, v31
    buffer_store_dwordx4 v[168:171], v249, s[80:83], s25 offen offset:3072
    ds_write_b128 v236, v[168:171] offset:3072
    v_pk_fma_f32 v[44:45], v[126:127], v[104:105], v[44:45]
    v_pk_fma_f32 v[46:47], v[126:127], v[106:107], v[46:47]
    v_pk_mul_f32 v[164:165], v[134:135], v[44:45]
    v_pk_mul_f32 v[166:167], v[134:135], v[46:47]
    v_exp_f32 v164, v164
    v_exp_f32 v165, v165
    v_exp_f32 v166, v166
    v_exp_f32 v167, v167
    v_pk_fma_f32 v[92:93], v[126:127], v[116:117], v[92:93]
    v_pk_fma_f32 v[94:95], v[126:127], v[118:119], v[94:95]
    v_pk_fma_f32 v[164:165], v[164:165], v[142:143], v[142:143]
    v_pk_fma_f32 v[166:167], v[166:167], v[142:143], v[142:143]
    v_rcp_f32 v164, v164
    v_rcp_f32 v165, v165
    v_rcp_f32 v166, v166
    v_rcp_f32 v167, v167
    v_pk_mul_f32 v[44:45], v[44:45], v[92:93]
    v_pk_mul_f32 v[46:47], v[46:47], v[94:95]
    v_pk_mul_f32 v[44:45], v[44:45], v[164:165]
    v_pk_mul_f32 v[46:47], v[46:47], v[166:167]
    v_cvt_pk_bf16_f32 v172, v44, v45
    v_cvt_pk_bf16_f32 v173, v46, v47
    buffer_store_dwordx2 v[172:173], v249, s[80:83], s26 offen offset:3072
    ds_write_b64 v237, v[172:173] offset:3072
    s_lshl_b32 s64, s75, 15
    s_lshl_b32 s66, s73, 9
    s_add_u32 s64, s64, s66
    s_add_u32 s64, s64, 75513856
    s_lshl_b32 s65, s72, 5
    s_add_u32 s64, s64, s65
    s_lshl_b32 s65, s3, 2
    s_add_u32 s64, s64, s65
    v_mov_b32 v144, 0
    v_mov_b32 v145, 1
    s_cmp_lg_u32 s78, 0
    s_cbranch_scc1 sg_2651_slow
    s_waitcnt vmcnt(0)
    s_mov_b64 exec, 1
    buffer_store_dword v145, v144, s[80:83], s64 offen
    s_mov_b64 exec, -1
sg_2651_done:
    s_setprio 3
    s_mov_b32 s8, s86
    s_mov_b32 s9, s87
    s_mov_b32 s10, 6291456
    s_mov_b32 s11, 0x00020000
    v_lshrrev_b32 v253, 3, v250
    v_lshlrev_b32 v253, 2, v253
    v_add_u32 v253, s69, v253
    v_mul_u32_u24 v253, 6144, v253
    v_and_b32 v254, 7, v250
    v_lshl_add_u32 v10, v254, 4, v253
    v_add_u32 v11, 2048, v10
    v_add_u32 v12, 4096, v10
    s_mul_i32 s19, s69, 3104
    s_lshl_b32 s17, s74, 7
    s_add_u32 s18, s17, 6291456
    s_mov_b32 s64, s57
    s_mul_i32 s64, s64, 393216
    s_add_u32 s16, s17, s64
    s_lshl_b32 s53, s73, 1
    s_add_u32 s53, s53, s68
    s_mul_i32 s53, s53, 458752
    s_lshl_b32 s66, s60, 24
    s_add_u32 s53, s53, s66
    s_add_u32 s53, s53, 20971520
    s_lshl_b32 s55, s69, 11
    s_add_u32 s53, s53, s55
    s_lshl_b32 s56, s75, 15
    s_lshl_b32 s66, s73, 9
    s_add_u32 s56, s56, s66
    s_add_u32 s56, s56, 75513856
    v_lshlrev_b32 v246, 4, v250
    s_lshl_b32 s64, s68, 1
    s_lshl_b32 s62, 0x33333333, s64
    s_mov_b32 s63, 0
    s_lshr_b32 s40, s2, 3
    s_lshl_b32 s40, s40, 2
    s_add_u32 s40, s40, s69
    s_and_b32 s41, s40, 31
    s_lshl_b32 s41, s41, 11
    s_lshr_b32 s46, s40, 5
    s_and_b32 s46, s46, 1
    s_lshr_b32 s40, s40, 6
    s_lshl_b32 s40, s40, 10
    s_add_u32 s40, s40, s41
    s_lshr_b32 s41, s74, 3
    s_mul_i32 s41, s41, 3670016
    s_add_u32 s40, s40, s41
    s_add_u32 s40, s96, s40
    s_addc_u32 s41, s97, 0
    s_mul_i32 s47, s58, 7
    s_add_u32 s46, s46, s47
    s_waitcnt lgkmcnt(0)
    s_barrier
    s_add_u32 s42, s46, 10
    s_cmp_ge_u32 s42, 56
    s_cselect_b32 s47, 56, 0
    s_sub_u32 s42, s42, s47
    s_lshl_b32 s42, s42, 16
    s_add_u32 s44, s40, s42
    s_addc_u32 s45, s41, 0
    s_load_dword s43, s[44:45], 384
    s_load_dword s43, s[44:45], 448
    s_barrier
    s_add_u32 s42, s46, 12
    s_cmp_ge_u32 s42, 56
    s_cselect_b32 s47, 56, 0
    s_sub_u32 s42, s42, s47
    s_lshl_b32 s42, s42, 16
    s_add_u32 s44, s40, s42
    s_addc_u32 s45, s41, 0
    s_load_dword s43, s[44:45], 384
    s_load_dword s43, s[44:45], 448
    s_add_u32 s42, s46, 14
    s_cmp_ge_u32 s42, 56
    s_cselect_b32 s47, 56, 0
    s_sub_u32 s42, s42, s47
    s_lshl_b32 s42, s42, 16
    s_add_u32 s44, s40, s42
    s_addc_u32 s45, s41, 0
    s_load_dword s43, s[44:45], 384
    s_load_dword s43, s[44:45], 448
    s_mov_b64 exec, s[62:63]
pl_2652:
    buffer_load_dwordx4 v[240:243], v246, s[80:83], s56 offen sc1
    s_sub_u32 s79, s79, 1
    s_cbranch_scc1 L_abort
    s_waitcnt vmcnt(0)
    v_and_b32 v240, v240, v241
    v_and_b32 v242, v242, v243
    v_and_b32 v240, v240, v242
    v_cmp_ne_u32 vcc, 1, v240
    s_cbranch_vccnz pl_2652
    s_mov_b64 exec, -1
    s_cmp_lg_u32 s78, 0
    s_cbranch_scc1 pl_2652_acq
pl_2652_ok:
    s_cmp_le_u32 s50, 0
    s_addc_u32 s52, s58, 0
    s_and_b32 s52, s52, 7
    s_mul_i32 s52, s52, 57344
    s_add_u32 s52, s52, s53
    s_add_u32 m0, s55, 49152
    s_nop 0
    buffer_load_dwordx4 v249, s[80:83], s52 offen offset:0 sc1 lds
    buffer_load_dwordx4 v249, s[80:83], s52 offen offset:1024 sc1 lds
    s_add_u32 s52, s52, 8192
    s_add_u32 m0, s55, 57344
    s_nop 0
    buffer_load_dwordx4 v249, s[80:83], s52 offen offset:0 sc1 lds
    buffer_load_dwordx4 v249, s[80:83], s52 offen offset:1024 sc1 lds
    s_add_u32 s52, s52, 8192
    s_add_u32 m0, s55, 0
    s_nop 0
    buffer_load_dwordx4 v249, s[80:83], s52 offen offset:0 sc1 lds
    buffer_load_dwordx4 v249, s[80:83], s52 offen offset:1024 sc1 lds
    s_add_u32 s52, s52, 8192
    s_add_u32 m0, s55, 8192
    s_nop 0
    buffer_load_dwordx4 v249, s[80:83], s52 offen offset:0 sc1 lds
    buffer_load_dwordx4 v249, s[80:83], s52 offen offset:1024 sc1 lds
    s_add_u32 s52, s52, 8192
    s_waitcnt vmcnt(4)
    s_barrier
    s_add_u32 s42, s46, 16
    s_cmp_ge_u32 s42, 56
    s_cselect_b32 s47, 56, 0
    s_sub_u32 s42, s42, s47
    s_lshl_b32 s42, s42, 16
    s_add_u32 s44, s40, s42
    s_addc_u32 s45, s41, 0
    s_load_dword s43, s[44:45], 384
    s_load_dword s43, s[44:45], 448
    s_add_u32 s42, s46, 18
    s_cmp_ge_u32 s42, 56
    s_cselect_b32 s47, 56, 0
    s_sub_u32 s42, s42, s47
    s_lshl_b32 s42, s42, 16
    s_add_u32 s44, s40, s42
    s_addc_u32 s45, s41, 0
    s_load_dword s43, s[44:45], 384
    s_load_dword s43, s[44:45], 448
    s_add_u32 m0, s51, 107776
    s_nop 0
    buffer_load_dwordx4 v244, s[12:15], s48 offen lds
    s_add_u32 m0, s51, 108832
    s_nop 0
    buffer_load_dwordx4 v245, s[12:15], s48 offen lds
    s_add_u32 s48, s48, 65536
    s_add_u32 m0, s55, 16384
    s_nop 0
    buffer_load_dwordx4 v249, s[80:83], s52 offen offset:0 sc1 lds
    buffer_load_dwordx4 v249, s[80:83], s52 offen offset:1024 sc1 lds
    s_add_u32 s52, s52, 8192
    s_add_u32 m0, s51, 116224
    s_nop 0
    buffer_load_dwordx4 v244, s[12:15], s48 offen lds
    s_add_u32 m0, s51, 117280
    s_nop 0
    buffer_load_dwordx4 v245, s[12:15], s48 offen lds
    s_add_u32 s48, s48, 65536
    s_add_u32 m0, s55, 24576
    s_nop 0
    buffer_load_dwordx4 v249, s[80:83], s52 offen offset:0 sc1 lds
    buffer_load_dwordx4 v249, s[80:83], s52 offen offset:1024 sc1 lds
    s_add_u32 s52, s52, 8192
    s_add_u32 m0, s51, 124672
    s_nop 0
    buffer_load_dwordx4 v244, s[12:15], s48 offen lds
    s_add_u32 m0, s51, 125728
    s_nop 0
    buffer_load_dwordx4 v245, s[12:15], s48 offen lds
    s_add_u32 s48, s48, 65536
    s_waitcnt vmcnt(8)
    s_barrier
    s_add_u32 s42, s46, 20
    s_cmp_ge_u32 s42, 56
    s_cselect_b32 s47, 56, 0
    s_sub_u32 s42, s42, s47
    s_lshl_b32 s42, s42, 16
    s_add_u32 s44, s40, s42
    s_addc_u32 s45, s41, 0
    s_load_dword s43, s[44:45], 384
    s_load_dword s43, s[44:45], 448
    s_add_u32 m0, s55, 32768
    s_nop 0
    buffer_load_dwordx4 v249, s[80:83], s52 offen offset:0 sc1 lds
    buffer_load_dwordx4 v249, s[80:83], s52 offen offset:1024 sc1 lds
    s_add_u32 s52, s52, 8192
    s_add_u32 m0, s51, 133120
    s_nop 0
    buffer_load_dwordx4 v244, s[12:15], s48 offen lds
    s_add_u32 m0, s51, 134176
    s_nop 0
    buffer_load_dwordx4 v245, s[12:15], s48 offen lds
    s_add_u32 s48, s48, 65536
    s_cmp_le_u32 s50, 1
    s_addc_u32 s52, s58, 1
    s_and_b32 s52, s52, 7
    s_mul_i32 s52, s52, 57344
    s_add_u32 s52, s52, s53
    s_add_u32 m0, s55, 40960
    s_nop 0
    buffer_load_dwordx4 v249, s[80:83], s52 offen offset:0 sc1 lds
    buffer_load_dwordx4 v249, s[80:83], s52 offen offset:1024 sc1 lds
    s_add_u32 s52, s52, 8192
    s_cmp_le_u32 s50, 1
    s_addc_u32 s48, s58, 1
    s_and_b32 s48, s48, 7
    s_mul_i32 s48, s48, 458752
    s_add_u32 s48, s48, s49
    s_add_u32 m0, s51, 141568
    s_nop 0
    buffer_load_dwordx4 v244, s[12:15], s48 offen lds
    s_add_u32 m0, s51, 142624
    s_nop 0
    buffer_load_dwordx4 v245, s[12:15], s48 offen lds
    s_add_u32 s48, s48, 65536
    s_add_u32 m0, s55, 49152
    s_nop 0
    buffer_load_dwordx4 v249, s[80:83], s52 offen offset:0 sc1 lds
    buffer_load_dwordx4 v249, s[80:83], s52 offen offset:1024 sc1 lds
    s_add_u32 s52, s52, 8192
    s_waitcnt vmcnt(10)
    s_barrier
    s_add_u32 s42, s46, 22
    s_cmp_ge_u32 s42, 56
    s_cselect_b32 s47, 56, 0
    s_sub_u32 s42, s42, s47
    s_lshl_b32 s42, s42, 16
    s_add_u32 s44, s40, s42
    s_addc_u32 s45, s41, 0
    s_load_dword s43, s[44:45], 384
    s_load_dword s43, s[44:45], 448
    s_add_u32 m0, s51, 65536
    s_nop 0
    buffer_load_dwordx4 v244, s[12:15], s48 offen lds
    s_add_u32 m0, s51, 66592
    s_nop 0
    buffer_load_dwordx4 v245, s[12:15], s48 offen lds
    s_add_u32 s48, s48, 65536
    s_add_u32 m0, s55, 57344
    s_nop 0
    buffer_load_dwordx4 v249, s[80:83], s52 offen offset:0 sc1 lds
    buffer_load_dwordx4 v249, s[80:83], s52 offen offset:1024 sc1 lds
    s_add_u32 s52, s52, 8192
    s_add_u32 m0, s51, 73984
    s_nop 0
    buffer_load_dwordx4 v244, s[12:15], s48 offen lds
    s_add_u32 m0, s51, 75040
    s_nop 0
    buffer_load_dwordx4 v245, s[12:15], s48 offen lds
    s_add_u32 s48, s48, 65536
    s_add_u32 m0, s55, 0
    s_nop 0
    buffer_load_dwordx4 v249, s[80:83], s52 offen offset:0 sc1 lds
    buffer_load_dwordx4 v249, s[80:83], s52 offen offset:1024 sc1 lds
    s_add_u32 s52, s52, 8192
    s_add_u32 m0, s51, 82432
    s_nop 0
    buffer_load_dwordx4 v244, s[12:15], s48 offen lds
    s_add_u32 m0, s51, 83488
    s_nop 0
    buffer_load_dwordx4 v245, s[12:15], s48 offen lds
    s_add_u32 s48, s48, 65536
    s_waitcnt vmcnt(12)
    s_barrier
    s_add_u32 s42, s46, 24
    s_cmp_ge_u32 s42, 56
    s_cselect_b32 s47, 56, 0
    s_sub_u32 s42, s42, s47
    s_lshl_b32 s42, s42, 16
    s_add_u32 s44, s40, s42
    s_addc_u32 s45, s41, 0
    s_load_dword s43, s[44:45], 384
    s_load_dword s43, s[44:45], 448
    s_add_u32 m0, s55, 8192
    s_nop 0
    buffer_load_dwordx4 v249, s[80:83], s52 offen offset:0 sc1 lds
    buffer_load_dwordx4 v249, s[80:83], s52 offen offset:1024 sc1 lds
    s_add_u32 s52, s52, 8192
    s_add_u32 m0, s51, 90880
    s_nop 0
    buffer_load_dwordx4 v244, s[12:15], s48 offen lds
    s_add_u32 m0, s51, 91936
    s_nop 0
    buffer_load_dwordx4 v245, s[12:15], s48 offen lds
    s_add_u32 s48, s48, 65536
    s_add_u32 m0, s55, 16384
    s_nop 0
    buffer_load_dwordx4 v249, s[80:83], s52 offen offset:0 sc1 lds
    buffer_load_dwordx4 v249, s[80:83], s52 offen offset:1024 sc1 lds
    s_add_u32 s52, s52, 8192
    s_add_u32 m0, s51, 99328
    s_nop 0
    buffer_load_dwordx4 v244, s[12:15], s48 offen lds
    s_add_u32 m0, s51, 100384
    s_nop 0
    buffer_load_dwordx4 v245, s[12:15], s48 offen lds
    s_add_u32 s48, s48, 65536
    s_waitcnt vmcnt(12)
    s_barrier
    s_add_u32 s42, s46, 26
    s_cmp_ge_u32 s42, 56
    s_cselect_b32 s47, 56, 0
    s_sub_u32 s42, s42, s47
    s_lshl_b32 s42, s42, 16
    s_add_u32 s44, s40, s42
    s_addc_u32 s45, s41, 0
    s_load_dword s43, s[44:45], 384
    s_load_dword s43, s[44:45], 448
    s_add_u32 m0, s55, 24576
    s_nop 0
    buffer_load_dwordx4 v249, s[80:83], s52 offen offset:0 sc1 lds
    buffer_load_dwordx4 v249, s[80:83], s52 offen offset:1024 sc1 lds
    s_add_u32 s52, s52, 8192
    s_add_u32 m0, s51, 107776
    s_nop 0
    buffer_load_dwordx4 v244, s[12:15], s48 offen lds
    s_add_u32 m0, s51, 108832
    s_nop 0
    buffer_load_dwordx4 v245, s[12:15], s48 offen lds
    s_add_u32 s48, s48, 65536
    s_cmp_le_u32 s50, 2
    s_addc_u32 s52, s58, 2
    s_and_b32 s52, s52, 7
    s_mul_i32 s52, s52, 57344
    s_add_u32 s52, s52, s53
    s_add_u32 m0, s55, 32768
    s_nop 0
    buffer_load_dwordx4 v249, s[80:83], s52 offen offset:0 sc1 lds
    buffer_load_dwordx4 v249, s[80:83], s52 offen offset:1024 sc1 lds
    s_add_u32 s52, s52, 8192
    s_cmp_le_u32 s50, 2
    s_addc_u32 s48, s58, 2
    s_and_b32 s48, s48, 7
    s_mul_i32 s48, s48, 458752
    s_add_u32 s48, s48, s49
    s_add_u32 m0, s51, 116224
    s_nop 0
    buffer_load_dwordx4 v244, s[12:15], s48 offen lds
    s_add_u32 m0, s51, 117280
    s_nop 0
    buffer_load_dwordx4 v245, s[12:15], s48 offen lds
    s_add_u32 s48, s48, 65536
    s_waitcnt vmcnt(12)
    s_barrier
    s_add_u32 s42, s46, 28
    s_cmp_ge_u32 s42, 56
    s_cselect_b32 s47, 56, 0
    s_sub_u32 s42, s42, s47
    s_lshl_b32 s42, s42, 16
    s_add_u32 s44, s40, s42
    s_addc_u32 s45, s41, 0
    s_load_dword s43, s[44:45], 384
    s_load_dword s43, s[44:45], 448
    s_add_u32 m0, s55, 40960
    s_nop 0
    buffer_load_dwordx4 v249, s[80:83], s52 offen offset:0 sc1 lds
    buffer_load_dwordx4 v249, s[80:83], s52 offen offset:1024 sc1 lds
    s_add_u32 s52, s52, 8192
    s_add_u32 m0, s51, 124672
    s_nop 0
    buffer_load_dwordx4 v244, s[12:15], s48 offen lds
    s_add_u32 m0, s51, 125728
    s_nop 0
    buffer_load_dwordx4 v245, s[12:15], s48 offen lds
    s_add_u32 s48, s48, 65536
    s_add_u32 m0, s55, 49152
    s_nop 0
    buffer_load_dwordx4 v249, s[80:83], s52 offen offset:0 sc1 lds
    buffer_load_dwordx4 v249, s[80:83], s52 offen offset:1024 sc1 lds
    s_add_u32 s52, s52, 8192
    s_add_u32 m0, s51, 133120
    s_nop 0
    buffer_load_dwordx4 v244, s[12:15], s48 offen lds
    s_add_u32 m0, s51, 134176
    s_nop 0
    buffer_load_dwordx4 v245, s[12:15], s48 offen lds
    s_add_u32 s48, s48, 65536
    s_waitcnt vmcnt(12)
    s_barrier
    s_add_u32 s42, s46, 30
    s_cmp_ge_u32 s42, 56
    s_cselect_b32 s47, 56, 0
    s_sub_u32 s42, s42, s47
    s_lshl_b32 s42, s42, 16
    s_add_u32 s44, s40, s42
    s_addc_u32 s45, s41, 0
    s_load_dword s43, s[44:45], 384
    s_load_dword s43, s[44:45], 448
    s_add_u32 m0, s55, 57344
    s_nop 0
    buffer_load_dwordx4 v249, s[80:83], s52 offen offset:0 sc1 lds
    buffer_load_dwordx4 v249, s[80:83], s52 offen offset:1024 sc1 lds
    s_add_u32 s52, s52, 8192
    s_add_u32 m0, s51, 141568
    s_nop 0
    buffer_load_dwordx4 v244, s[12:15], s48 offen lds
    s_add_u32 m0, s51, 142624
    s_nop 0
    buffer_load_dwordx4 v245, s[12:15], s48 offen lds
    s_add_u32 s48, s48, 65536
    s_add_u32 m0, s55, 0
    s_nop 0
    buffer_load_dwordx4 v249, s[80:83], s52 offen offset:0 sc1 lds
    buffer_load_dwordx4 v249, s[80:83], s52 offen offset:1024 sc1 lds
    s_add_u32 s52, s52, 8192
    s_add_u32 m0, s51, 65536
    s_nop 0
    buffer_load_dwordx4 v244, s[12:15], s48 offen lds
    s_add_u32 m0, s51, 66592
    s_nop 0
    buffer_load_dwordx4 v245, s[12:15], s48 offen lds
    s_add_u32 s48, s48, 65536
    s_waitcnt vmcnt(12)
    s_barrier
    s_add_u32 s42, s46, 32
    s_cmp_ge_u32 s42, 56
    s_cselect_b32 s47, 56, 0
    s_sub_u32 s42, s42, s47
    s_lshl_b32 s42, s42, 16
    s_add_u32 s44, s40, s42
    s_addc_u32 s45, s41, 0
    s_load_dword s43, s[44:45], 384
    s_load_dword s43, s[44:45], 448
    s_add_u32 m0, s55, 8192
    s_nop 0
    buffer_load_dwordx4 v249, s[80:83], s52 offen offset:0 sc1 lds
    buffer_load_dwordx4 v249, s[80:83], s52 offen offset:1024 sc1 lds
    s_add_u32 s52, s52, 8192
    s_add_u32 m0, s51, 73984
    s_nop 0
    buffer_load_dwordx4 v244, s[12:15], s48 offen lds
    s_add_u32 m0, s51, 75040
    s_nop 0
    buffer_load_dwordx4 v245, s[12:15], s48 offen lds
    s_add_u32 s48, s48, 65536
    s_add_u32 m0, s55, 16384
    s_nop 0
    buffer_load_dwordx4 v249, s[80:83], s52 offen offset:0 sc1 lds
    buffer_load_dwordx4 v249, s[80:83], s52 offen offset:1024 sc1 lds
    s_add_u32 s52, s52, 8192
    s_add_u32 m0, s51, 82432
    s_nop 0
    buffer_load_dwordx4 v244, s[12:15], s48 offen lds
    s_add_u32 m0, s51, 83488
    s_nop 0
    buffer_load_dwordx4 v245, s[12:15], s48 offen lds
    s_add_u32 s48, s48, 65536
    s_waitcnt vmcnt(12)
    s_barrier
    s_add_u32 s42, s46, 34
    s_cmp_ge_u32 s42, 56
    s_cselect_b32 s47, 56, 0
    s_sub_u32 s42, s42, s47
    s_lshl_b32 s42, s42, 16
    s_add_u32 s44, s40, s42
    s_addc_u32 s45, s41, 0
    s_load_dword s43, s[44:45], 384
    s_load_dword s43, s[44:45], 448
    s_cmp_le_u32 s50, 3
    s_addc_u32 s52, s58, 3
    s_and_b32 s52, s52, 7
    s_mul_i32 s52, s52, 57344
    s_add_u32 s52, s52, s53
    s_add_u32 m0, s55, 24576
    s_nop 0
    buffer_load_dwordx4 v249, s[80:83], s52 offen offset:0 sc1 lds
    buffer_load_dwordx4 v249, s[80:83], s52 offen offset:1024 sc1 lds
    s_add_u32 s52, s52, 8192
    s_cmp_le_u32 s50, 3
    s_addc_u32 s48, s58, 3
    s_and_b32 s48, s48, 7
    s_mul_i32 s48, s48, 458752
    s_add_u32 s48, s48, s49
    s_add_u32 m0, s51, 90880
    s_nop 0
    buffer_load_dwordx4 v244, s[12:15], s48 offen lds
    s_add_u32 m0, s51, 91936
    s_nop 0
    buffer_load_dwordx4 v245, s[12:15], s48 offen lds
    s_add_u32 s48, s48, 65536
    s_add_u32 m0, s55, 32768
    s_nop 0
    buffer_load_dwordx4 v249, s[80:83], s52 offen offset:0 sc1 lds
    buffer_load_dwordx4 v249, s[80:83], s52 offen offset:1024 sc1 lds
    s_add_u32 s52, s52, 8192
    s_add_u32 m0, s51, 99328
    s_nop 0
    buffer_load_dwordx4 v244, s[12:15], s48 offen lds
    s_add_u32 m0, s51, 100384
    s_nop 0
    buffer_load_dwordx4 v245, s[12:15], s48 offen lds
    s_add_u32 s48, s48, 65536
    s_waitcnt vmcnt(12)
    s_barrier
    s_add_u32 s42, s46, 36
    s_cmp_ge_u32 s42, 56
    s_cselect_b32 s47, 56, 0
    s_sub_u32 s42, s42, s47
    s_lshl_b32 s42, s42, 16
    s_add_u32 s44, s40, s42
    s_addc_u32 s45, s41, 0
    s_load_dword s43, s[44:45], 384
    s_load_dword s43, s[44:45], 448
    s_add_u32 m0, s55, 40960
    s_nop 0
    buffer_load_dwordx4 v249, s[80:83], s52 offen offset:0 sc1 lds
    buffer_load_dwordx4 v249, s[80:83], s52 offen offset:1024 sc1 lds
    s_add_u32 s52, s52, 8192
    s_add_u32 m0, s51, 107776
    s_nop 0
    buffer_load_dwordx4 v244, s[12:15], s48 offen lds
    s_add_u32 m0, s51, 108832
    s_nop 0
    buffer_load_dwordx4 v245, s[12:15], s48 offen lds
    s_add_u32 s48, s48, 65536
    s_add_u32 m0, s55, 49152
    s_nop 0
    buffer_load_dwordx4 v249, s[80:83], s52 offen offset:0 sc1 lds
    buffer_load_dwordx4 v249, s[80:83], s52 offen offset:1024 sc1 lds
    s_add_u32 s52, s52, 8192
    s_add_u32 m0, s51, 116224
    s_nop 0
    buffer_load_dwordx4 v244, s[12:15], s48 offen lds
    s_add_u32 m0, s51, 117280
    s_nop 0
    buffer_load_dwordx4 v245, s[12:15], s48 offen lds
    s_add_u32 s48, s48, 65536
    s_waitcnt vmcnt(12)
    s_barrier
    s_add_u32 s42, s46, 38
    s_cmp_ge_u32 s42, 56
    s_cselect_b32 s47, 56, 0
    s_sub_u32 s42, s42, s47
    s_lshl_b32 s42, s42, 16
    s_add_u32 s44, s40, s42
    s_addc_u32 s45, s41, 0
    s_load_dword s43, s[44:45], 384
    s_load_dword s43, s[44:45], 448
    s_add_u32 m0, s55, 57344
    s_nop 0
    buffer_load_dwordx4 v249, s[80:83], s52 offen offset:0 sc1 lds
    buffer_load_dwordx4 v249, s[80:83], s52 offen offset:1024 sc1 lds
    s_add_u32 s52, s52, 8192
    s_add_u32 m0, s51, 124672
    s_nop 0
    buffer_load_dwordx4 v244, s[12:15], s48 offen lds
    s_add_u32 m0, s51, 125728
    s_nop 0
    buffer_load_dwordx4 v245, s[12:15], s48 offen lds
    s_add_u32 s48, s48, 65536
    s_add_u32 m0, s55, 0
    s_nop 0
    buffer_load_dwordx4 v249, s[80:83], s52 offen offset:0 sc1 lds
    buffer_load_dwordx4 v249, s[80:83], s52 offen offset:1024 sc1 lds
    s_add_u32 s52, s52, 8192
    s_add_u32 m0, s51, 133120
    s_nop 0
    buffer_load_dwordx4 v244, s[12:15], s48 offen lds
    s_add_u32 m0, s51, 134176
    s_nop 0
    buffer_load_dwordx4 v245, s[12:15], s48 offen lds
    s_add_u32 s48, s48, 65536
    s_waitcnt vmcnt(12)
    s_barrier
    s_add_u32 s42, s46, 40
    s_cmp_ge_u32 s42, 56
    s_cselect_b32 s47, 56, 0
    s_sub_u32 s42, s42, s47
    s_lshl_b32 s42, s42, 16
    s_add_u32 s44, s40, s42
    s_addc_u32 s45, s41, 0
    s_load_dword s43, s[44:45], 384
    s_load_dword s43, s[44:45], 448
    s_add_u32 m0, s55, 8192
    s_nop 0
    buffer_load_dwordx4 v249, s[80:83], s52 offen offset:0 sc1 lds
    buffer_load_dwordx4 v249, s[80:83], s52 offen offset:1024 sc1 lds
    s_add_u32 s52, s52, 8192
    s_add_u32 m0, s51, 141568
    s_nop 0
    buffer_load_dwordx4 v244, s[12:15], s48 offen lds
    s_add_u32 m0, s51, 142624
    s_nop 0
    buffer_load_dwordx4 v245, s[12:15], s48 offen lds
    s_add_u32 s48, s48, 65536
    s_cmp_le_u32 s50, 4
    s_addc_u32 s52, s58, 4
    s_and_b32 s52, s52, 7
    s_mul_i32 s52, s52, 57344
    s_add_u32 s52, s52, s53
    s_add_u32 m0, s55, 16384
    s_nop 0
    buffer_load_dwordx4 v249, s[80:83], s52 offen offset:0 sc1 lds
    buffer_load_dwordx4 v249, s[80:83], s52 offen offset:1024 sc1 lds
    s_add_u32 s52, s52, 8192
    s_cmp_le_u32 s50, 4
    s_addc_u32 s48, s58, 4
    s_and_b32 s48, s48, 7
    s_mul_i32 s48, s48, 458752
    s_add_u32 s48, s48, s49
    s_add_u32 m0, s51, 65536
    s_nop 0
    buffer_load_dwordx4 v244, s[12:15], s48 offen lds
    s_add_u32 m0, s51, 66592
    s_nop 0
    buffer_load_dwordx4 v245, s[12:15], s48 offen lds
    s_add_u32 s48, s48, 65536
    s_waitcnt vmcnt(12)
    s_barrier
    s_add_u32 s42, s46, 42
    s_cmp_ge_u32 s42, 56
    s_cselect_b32 s47, 56, 0
    s_sub_u32 s42, s42, s47
    s_lshl_b32 s42, s42, 16
    s_add_u32 s44, s40, s42
    s_addc_u32 s45, s41, 0
    s_load_dword s43, s[44:45], 384
    s_load_dword s43, s[44:45], 448
    s_add_u32 m0, s55, 24576
    s_nop 0
    buffer_load_dwordx4 v249, s[80:83], s52 offen offset:0 sc1 lds
    buffer_load_dwordx4 v249, s[80:83], s52 offen offset:1024 sc1 lds
    s_add_u32 s52, s52, 8192
    s_add_u32 m0, s51, 73984
    s_nop 0
    buffer_load_dwordx4 v244, s[12:15], s48 offen lds
    s_add_u32 m0, s51, 75040
    s_nop 0
    buffer_load_dwordx4 v245, s[12:15], s48 offen lds
    s_add_u32 s48, s48, 65536
    s_add_u32 m0, s55, 32768
    s_nop 0
    buffer_load_dwordx4 v249, s[80:83], s52 offen offset:0 sc1 lds
    buffer_load_dwordx4 v249, s[80:83], s52 offen offset:1024 sc1 lds
    s_add_u32 s52, s52, 8192
    s_add_u32 m0, s51, 82432
    s_nop 0
    buffer_load_dwordx4 v244, s[12:15], s48 offen lds
    s_add_u32 m0, s51, 83488
    s_nop 0
    buffer_load_dwordx4 v245, s[12:15], s48 offen lds
    s_add_u32 s48, s48, 65536
    s_waitcnt vmcnt(12)
    s_barrier
    s_add_u32 s42, s46, 44
    s_cmp_ge_u32 s42, 56
    s_cselect_b32 s47, 56, 0
    s_sub_u32 s42, s42, s47
    s_lshl_b32 s42, s42, 16
    s_add_u32 s44, s40, s42
    s_addc_u32 s45, s41, 0
    s_load_dword s43, s[44:45], 384
    s_load_dword s43, s[44:45], 448
    s_add_u32 m0, s55, 40960
    s_nop 0
    buffer_load_dwordx4 v249, s[80:83], s52 offen offset:0 sc1 lds
    buffer_load_dwordx4 v249, s[80:83], s52 offen offset:1024 sc1 lds
    s_add_u32 s52, s52, 8192
    s_add_u32 m0, s51, 90880
    s_nop 0
    buffer_load_dwordx4 v244, s[12:15], s48 offen lds
    s_add_u32 m0, s51, 91936
    s_nop 0
    buffer_load_dwordx4 v245, s[12:15], s48 offen lds
    s_add_u32 s48, s48, 65536
    s_add_u32 m0, s55, 49152
    s_nop 0
    buffer_load_dwordx4 v249, s[80:83], s52 offen offset:0 sc1 lds
    buffer_load_dwordx4 v249, s[80:83], s52 offen offset:1024 sc1 lds
    s_add_u32 s52, s52, 8192
    s_add_u32 m0, s51, 99328
    s_nop 0
    buffer_load_dwordx4 v244, s[12:15], s48 offen lds
    s_add_u32 m0, s51, 100384
    s_nop 0
    buffer_load_dwordx4 v245, s[12:15], s48 offen lds
    s_add_u32 s48, s48, 65536
    s_waitcnt vmcnt(12)
    s_barrier
    s_add_u32 s42, s46, 46
    s_cmp_ge_u32 s42, 56
    s_cselect_b32 s47, 56, 0
    s_sub_u32 s42, s42, s47
    s_lshl_b32 s42, s42, 16
    s_add_u32 s44, s40, s42
    s_addc_u32 s45, s41, 0
    s_load_dword s43, s[44:45], 384
    s_load_dword s43, s[44:45], 448
    s_add_u32 m0, s55, 57344
    s_nop 0
    buffer_load_dwordx4 v249, s[80:83], s52 offen offset:0 sc1 lds
    buffer_load_dwordx4 v249, s[80:83], s52 offen offset:1024 sc1 lds
    s_add_u32 s52, s52, 8192
    s_add_u32 m0, s51, 107776
    s_nop 0
    buffer_load_dwordx4 v244, s[12:15], s48 offen lds
    s_add_u32 m0, s51, 108832
    s_nop 0
    buffer_load_dwordx4 v245, s[12:15], s48 offen lds
    s_add_u32 s48, s48, 65536
    s_add_u32 m0, s55, 0
    s_nop 0
    buffer_load_dwordx4 v249, s[80:83], s52 offen offset:0 sc1 lds
    buffer_load_dwordx4 v249, s[80:83], s52 offen offset:1024 sc1 lds
    s_add_u32 s52, s52, 8192
    s_add_u32 m0, s51, 116224
    s_nop 0
    buffer_load_dwordx4 v244, s[12:15], s48 offen lds
    s_add_u32 m0, s51, 117280
    s_nop 0
    buffer_load_dwordx4 v245, s[12:15], s48 offen lds
    s_add_u32 s48, s48, 65536
    s_waitcnt vmcnt(12)
    s_barrier
    s_add_u32 s42, s46, 48
    s_cmp_ge_u32 s42, 56
    s_cselect_b32 s47, 56, 0
    s_sub_u32 s42, s42, s47
    s_lshl_b32 s42, s42, 16
    s_add_u32 s44, s40, s42
    s_addc_u32 s45, s41, 0
    s_load_dword s43, s[44:45], 384
    s_load_dword s43, s[44:45], 448
    s_cmp_le_u32 s50, 5
    s_addc_u32 s52, s58, 5
    s_and_b32 s52, s52, 7
    s_mul_i32 s52, s52, 57344
    s_add_u32 s52, s52, s53
    s_add_u32 m0, s55, 8192
    s_nop 0
    buffer_load_dwordx4 v249, s[80:83], s52 offen offset:0 sc1 lds
    buffer_load_dwordx4 v249, s[80:83], s52 offen offset:1024 sc1 lds
    s_add_u32 s52, s52, 8192
    s_cmp_le_u32 s50, 5
    s_addc_u32 s48, s58, 5
    s_and_b32 s48, s48, 7
    s_mul_i32 s48, s48, 458752
    s_add_u32 s48, s48, s49
    s_add_u32 m0, s51, 124672
    s_nop 0
    buffer_load_dwordx4 v244, s[12:15], s48 offen lds
    s_add_u32 m0, s51, 125728
    s_nop 0
    buffer_load_dwordx4 v245, s[12:15], s48 offen lds
    s_add_u32 s48, s48, 65536
    s_add_u32 m0, s55, 16384
    s_nop 0
    buffer_load_dwordx4 v249, s[80:83], s52 offen offset:0 sc1 lds
    buffer_load_dwordx4 v249, s[80:83], s52 offen offset:1024 sc1 lds
    s_add_u32 s52, s52, 8192
    s_add_u32 m0, s51, 133120
    s_nop 0
    buffer_load_dwordx4 v244, s[12:15], s48 offen lds
    s_add_u32 m0, s51, 134176
    s_nop 0
    buffer_load_dwordx4 v245, s[12:15], s48 offen lds
    s_add_u32 s48, s48, 65536
    s_waitcnt vmcnt(12)
    s_barrier
    s_add_u32 s42, s46, 50
    s_cmp_ge_u32 s42, 56
    s_cselect_b32 s47, 56, 0
    s_sub_u32 s42, s42, s47
    s_lshl_b32 s42, s42, 16
    s_add_u32 s44, s40, s42
    s_addc_u32 s45, s41, 0
    s_load_dword s43, s[44:45], 384
    s_load_dword s43, s[44:45], 448
    s_add_u32 m0, s55, 24576
    s_nop 0
    buffer_load_dwordx4 v249, s[80:83], s52 offen offset:0 sc1 lds
    buffer_load_dwordx4 v249, s[80:83], s52 offen offset:1024 sc1 lds
    s_add_u32 s52, s52, 8192
    s_add_u32 m0, s51, 141568
    s_nop 0
    buffer_load_dwordx4 v244, s[12:15], s48 offen lds
    s_add_u32 m0, s51, 142624
    s_nop 0
    buffer_load_dwordx4 v245, s[12:15], s48 offen lds
    s_add_u32 s48, s48, 65536
    s_add_u32 m0, s55, 32768
    s_nop 0
    buffer_load_dwordx4 v249, s[80:83], s52 offen offset:0 sc1 lds
    buffer_load_dwordx4 v249, s[80:83], s52 offen offset:1024 sc1 lds
    s_add_u32 s52, s52, 8192
    s_add_u32 m0, s51, 65536
    s_nop 0
    buffer_load_dwordx4 v244, s[12:15], s48 offen lds
    s_add_u32 m0, s51, 66592
    s_nop 0
    buffer_load_dwordx4 v245, s[12:15], s48 offen lds
    s_add_u32 s48, s48, 65536
    s_waitcnt vmcnt(12)
    s_barrier
    s_add_u32 s42, s46, 52
    s_cmp_ge_u32 s42, 56
    s_cselect_b32 s47, 56, 0
    s_sub_u32 s42, s42, s47
    s_lshl_b32 s42, s42, 16
    s_add_u32 s44, s40, s42
    s_addc_u32 s45, s41, 0
    s_load_dword s43, s[44:45], 384
    s_load_dword s43, s[44:45], 448
    s_add_u32 m0, s55, 40960
    s_nop 0
    buffer_load_dwordx4 v249, s[80:83], s52 offen offset:0 sc1 lds
    buffer_load_dwordx4 v249, s[80:83], s52 offen offset:1024 sc1 lds
    s_add_u32 s52, s52, 8192
    s_add_u32 m0, s51, 73984
    s_nop 0
    buffer_load_dwordx4 v244, s[12:15], s48 offen lds
    s_add_u32 m0, s51, 75040
    s_nop 0
    buffer_load_dwordx4 v245, s[12:15], s48 offen lds
    s_add_u32 s48, s48, 65536
    s_add_u32 m0, s55, 49152
    s_nop 0
    buffer_load_dwordx4 v249, s[80:83], s52 offen offset:0 sc1 lds
    buffer_load_dwordx4 v249, s[80:83], s52 offen offset:1024 sc1 lds
    s_add_u32 s52, s52, 8192
    s_add_u32 m0, s51, 82432
    s_nop 0
    buffer_load_dwordx4 v244, s[12:15], s48 offen lds
    s_add_u32 m0, s51, 83488
    s_nop 0
    buffer_load_dwordx4 v245, s[12:15], s48 offen lds
    s_add_u32 s48, s48, 65536
    s_waitcnt vmcnt(12)
    s_barrier
    s_add_u32 s42, s46, 54
    s_cmp_ge_u32 s42, 56
    s_cselect_b32 s47, 56, 0
    s_sub_u32 s42, s42, s47
    s_lshl_b32 s42, s42, 16
    s_add_u32 s44, s40, s42
    s_addc_u32 s45, s41, 0
    s_load_dword s43, s[44:45], 384
    s_load_dword s43, s[44:45], 448
    s_add_u32 m0, s55, 57344
    s_nop 0
    buffer_load_dwordx4 v249, s[80:83], s52 offen offset:0 sc1 lds
    buffer_load_dwordx4 v249, s[80:83], s52 offen offset:1024 sc1 lds
    s_add_u32 s52, s52, 8192
    s_add_u32 m0, s51, 90880
    s_nop 0
    buffer_load_dwordx4 v244, s[12:15], s48 offen lds
    s_add_u32 m0, s51, 91936
    s_nop 0
    buffer_load_dwordx4 v245, s[12:15], s48 offen lds
    s_add_u32 s48, s48, 65536
    s_cmp_le_u32 s50, 6
    s_addc_u32 s52, s58, 6
    s_and_b32 s52, s52, 7
    s_mul_i32 s52, s52, 57344
    s_add_u32 s52, s52, s53
    s_add_u32 m0, s55, 0
    s_nop 0
    buffer_load_dwordx4 v249, s[80:83], s52 offen offset:0 sc1 lds
    buffer_load_dwordx4 v249, s[80:83], s52 offen offset:1024 sc1 lds
    s_add_u32 s52, s52, 8192
    s_cmp_le_u32 s50, 6
    s_addc_u32 s48, s58, 6
    s_and_b32 s48, s48, 7
    s_mul_i32 s48, s48, 458752
    s_add_u32 s48, s48, s49
    s_add_u32 m0, s51, 99328
    s_nop 0
    buffer_load_dwordx4 v244, s[12:15], s48 offen lds
    s_add_u32 m0, s51, 100384
    s_nop 0
    buffer_load_dwordx4 v245, s[12:15], s48 offen lds
    s_add_u32 s48, s48, 65536
    s_waitcnt vmcnt(12)
    s_barrier
    s_add_u32 m0, s55, 8192
    s_nop 0
    buffer_load_dwordx4 v249, s[80:83], s52 offen offset:0 sc1 lds
    buffer_load_dwordx4 v249, s[80:83], s52 offen offset:1024 sc1 lds
    s_add_u32 s52, s52, 8192
    s_add_u32 m0, s51, 107776
    s_nop 0
    buffer_load_dwordx4 v244, s[12:15], s48 offen lds
    s_add_u32 m0, s51, 108832
    s_nop 0
    buffer_load_dwordx4 v245, s[12:15], s48 offen lds
    s_add_u32 s48, s48, 65536
    s_add_u32 m0, s55, 16384
    s_nop 0
    buffer_load_dwordx4 v249, s[80:83], s52 offen offset:0 sc1 lds
    buffer_load_dwordx4 v249, s[80:83], s52 offen offset:1024 sc1 lds
    s_add_u32 s52, s52, 8192
    s_add_u32 m0, s51, 116224
    s_nop 0
    buffer_load_dwordx4 v244, s[12:15], s48 offen lds
    s_add_u32 m0, s51, 117280
    s_nop 0
    buffer_load_dwordx4 v245, s[12:15], s48 offen lds
    s_add_u32 s48, s48, 65536
    s_waitcnt vmcnt(12)
    s_barrier
    s_add_u32 m0, s55, 24576
    s_nop 0
    buffer_load_dwordx4 v249, s[80:83], s52 offen offset:0 sc1 lds
    buffer_load_dwordx4 v249, s[80:83], s52 offen offset:1024 sc1 lds
    s_add_u32 s52, s52, 8192
    s_add_u32 m0, s51, 124672
    s_nop 0
    buffer_load_dwordx4 v244, s[12:15], s48 offen lds
    s_add_u32 m0, s51, 125728
    s_nop 0
    buffer_load_dwordx4 v245, s[12:15], s48 offen lds
    s_add_u32 s48, s48, 65536
    s_add_u32 m0, s55, 32768
    s_nop 0
    buffer_load_dwordx4 v249, s[80:83], s52 offen offset:0 sc1 lds
    buffer_load_dwordx4 v249, s[80:83], s52 offen offset:1024 sc1 lds
    s_add_u32 s52, s52, 8192
    s_add_u32 m0, s51, 133120
    s_nop 0
    buffer_load_dwordx4 v244, s[12:15], s48 offen lds
    s_add_u32 m0, s51, 134176
    s_nop 0
    buffer_load_dwordx4 v245, s[12:15], s48 offen lds
    s_add_u32 s48, s48, 65536
    s_waitcnt vmcnt(12)
    s_barrier
    s_add_u32 m0, s55, 40960
    s_nop 0
    buffer_load_dwordx4 v249, s[80:83], s52 offen offset:0 sc1 lds
    buffer_load_dwordx4 v249, s[80:83], s52 offen offset:1024 sc1 lds
    s_add_u32 s52, s52, 8192
    s_add_u32 m0, s51, 141568
    s_nop 0
    buffer_load_dwordx4 v244, s[12:15], s48 offen lds
    s_add_u32 m0, s51, 142624
    s_nop 0
    buffer_load_dwordx4 v245, s[12:15], s48 offen lds
    s_add_u32 s48, s48, 65536
    s_add_u32 m0, s55, 49152
    s_nop 0
    buffer_load_dwordx4 v249, s[80:83], s52 offen offset:0 sc1 lds
    buffer_load_dwordx4 v249, s[80:83], s52 offen offset:1024 sc1 lds
    s_add_u32 s52, s52, 8192
    s_add_u32 m0, s51, 65536
    s_nop 0
    buffer_load_dwordx4 v244, s[12:15], s48 offen lds
    s_add_u32 m0, s51, 66592
    s_nop 0
    buffer_load_dwordx4 v245, s[12:15], s48 offen lds
    s_add_u32 s48, s48, 65536
    s_waitcnt vmcnt(12)
    s_barrier
    s_add_u32 m0, s19, 86400
    s_nop 0
    buffer_load_dwordx4 v10, s[8:11], s16 offen lds
    s_add_u32 m0, s19, 87424
    s_nop 0
    buffer_load_dwordx4 v11, s[8:11], s16 offen lds
    s_add_u32 m0, s19, 88448
    s_nop 0
    buffer_load_dwordx4 v12, s[8:11], s16 offen lds
    s_add_u32 s16, s16, 196608
    s_cmp_eq_u32 s16, s18
    s_cselect_b32 s16, s17, s16
    s_add_u32 m0, s19, 98816
    s_nop 0
    buffer_load_dwordx4 v10, s[8:11], s16 offen lds
    s_add_u32 m0, s19, 99840
    s_nop 0
    buffer_load_dwordx4 v11, s[8:11], s16 offen lds
    s_add_u32 m0, s19, 100864
    s_nop 0
    buffer_load_dwordx4 v12, s[8:11], s16 offen lds
    s_add_u32 s16, s16, 196608
    s_cmp_eq_u32 s16, s18
    s_cselect_b32 s16, s17, s16
    s_waitcnt vmcnt(6)
    s_barrier
    s_add_u32 m0, s19, 111232
    s_nop 0
    buffer_load_dwordx4 v10, s[8:11], s16 offen lds
    s_add_u32 m0, s19, 112256
    s_nop 0
    buffer_load_dwordx4 v11, s[8:11], s16 offen lds
    s_add_u32 m0, s19, 113280
    s_nop 0
    buffer_load_dwordx4 v12, s[8:11], s16 offen lds
    s_add_u32 s16, s16, 196608
    s_cmp_eq_u32 s16, s18
    s_cselect_b32 s16, s17, s16
    s_barrier
    s_cmp_eq_u32 s75, 1
    s_cbranch_scc1 L_fin
    s_mov_b32 s75, 1
    s_mov_b32 s59, s78
    s_mul_i32 s60, s59, s75
    s_lshl_b32 s21, s67, 18
    s_add_u32 s21, s21, 4194304
    s_lshl_b32 s64, s69, 11
    s_add_u32 s21, s21, s64
    s_lshl_b32 s23, s69, 12
    s_add_u32 s23, s23, 2048
    s_add_u32 s22, s21, 262144
    s_mov_b32 s64, s57
    s_lshl_b32 s65, s64, 14
    s_add_u32 s20, s21, s65
    s_sub_u32 s28, s67, 1
    s_and_b32 s28, s28, 15
    s_lshl_b32 s26, s28, 15
    s_add_u32 s26, s26, 73400320
    s_lshl_b32 s27, s64, 11
    v_lshlrev_b32 v246, 5, v250
    s_lshl_b32 s35, s70, 10
    s_add_u32 s35, s35, 75522048
    s_xor_b32 s36, s70, 1
    s_lshl_b32 s36, s36, 9
    s_sub_u32 s37, s58, 1
    s_and_b32 s37, s37, 7
    s_lshl_b32 s37, s37, 9
    v_mov_b32 v8, s36
    v_writelane_b32 v8, s37, 1
    s_mov_b32 s37, 75571584
    s_mov_b64 exec, 0xffffffff
pl_2653:
    buffer_load_dwordx4 v[240:243], v246, s[80:83], s35 offen sc1
    s_sub_u32 s79, s79, 1
    s_cbranch_scc1 L_abort
    s_waitcnt vmcnt(0)
    v_and_b32 v240, v240, v241
    v_and_b32 v242, v242, v243
    v_and_b32 v240, v240, v242
    v_cmp_ne_u32 vcc, 1, v240
    s_cbranch_vccnz pl_2653
    s_mov_b64 exec, -1
    s_cmp_lg_u32 s78, 0
    s_cbranch_scc1 pl_2653_acq
pl_2653_ok:
    s_lshr_b32 s64, s72, 1
    s_or_b32 s64, s64, s69
    s_cbranch_scc1 rl_2654
    s_lshl_b32 s64, s73, 1
    s_add_u32 s64, s64, s68
    s_lshl_b32 s64, s64, 7
    s_add_u32 s64, s64, 75571200
    v_mov_b32 v242, 0
    v_mov_b32 v243, 1
    s_mov_b64 exec, 1
    buffer_store_dword v243, v242, s[80:83], s64 offen sc0 sc1
    s_mov_b64 exec, -1
rl_2654:
    s_mov_b64 exec, 3
pl_2655:
    buffer_load_dword v240, v8, s[80:83], s37 offen sc1
    s_sub_u32 s79, s79, 1
    s_cbranch_scc1 L_abort
    s_waitcnt vmcnt(0)
    v_cmp_ne_u32 vcc, 1, v240
    s_cbranch_vccnz pl_2655
    s_mov_b64 exec, -1
    s_cmp_lg_u32 s78, 0
    s_cbranch_scc1 pl_2655_acq
pl_2655_ok:
    s_lshr_b32 s40, s2, 3
    s_lshl_b32 s40, s40, 2
    s_add_u32 s40, s40, s69
    s_and_b32 s41, s40, 63
    s_mul_i32 s41, s41, 6144
    s_and_b32 s40, s40, 64
    s_add_u32 s40, s40, s41
    s_add_u32 s40, s40, 384
    s_and_b32 s41, s70, 1
    s_lshl_b32 s41, s41, 10
    s_add_u32 s40, s40, s41
    s_add_u32 s40, s86, s40
    s_addc_u32 s41, s87, 0
    s_cmp_lg_u32 s69, 0
    s_cbranch_scc1 nh_2656
    s_add_u32 s64, s27, 0
    s_and_b32 s64, s64, 0x7fff
    s_mov_b32 m0, 18432
    s_add_u32 s64, s64, s26
    buffer_load_dwordx4 v249, s[80:83], s64 offen sc1 lds
nh_2656:
    s_add_u32 m0, s23, 18432
    s_nop 0
    buffer_load_dwordx4 v249, s[80:83], s20 offen offset:0 sc1 lds
    s_add_u32 m0, s23, 19456
    s_nop 0
    buffer_load_dwordx4 v249, s[80:83], s20 offen offset:1024 sc1 lds
    s_add_u32 s20, s20, 8192
    s_cmp_eq_u32 s20, s22
    s_cselect_b32 s20, s21, s20
    s_cmp_lg_u32 s69, 1
    s_cbranch_scc1 nh_2657
    s_add_u32 s64, s27, 1024
    s_and_b32 s64, s64, 0x7fff
    s_mov_b32 m0, 19456
    s_add_u32 s64, s64, s26
    buffer_load_dwordx4 v249, s[80:83], s64 offen sc1 lds
nh_2657:
    s_add_u32 m0, s23, 19456
    s_nop 0
    buffer_load_dwordx4 v249, s[80:83], s20 offen offset:0 sc1 lds
    s_add_u32 m0, s23, 20480
    s_nop 0
    buffer_load_dwordx4 v249, s[80:83], s20 offen offset:1024 sc1 lds
    s_add_u32 s20, s20, 8192
    s_cmp_eq_u32 s20, s22
    s_cselect_b32 s20, s21, s20
    s_cmp_lg_u32 s69, 2
    s_cbranch_scc1 nh_2658
    s_add_u32 s64, s27, 2048
    s_and_b32 s64, s64, 0x7fff
    s_mov_b32 m0, 36864
    s_add_u32 s64, s64, s26
    buffer_load_dwordx4 v249, s[80:83], s64 offen sc1 lds
nh_2658:
    s_add_u32 m0, s23, 36864
    s_nop 0
    buffer_load_dwordx4 v249, s[80:83], s20 offen offset:0 sc1 lds
    s_add_u32 m0, s23, 37888
    s_nop 0
    buffer_load_dwordx4 v249, s[80:83], s20 offen offset:1024 sc1 lds
    s_add_u32 s20, s20, 8192
    s_cmp_eq_u32 s20, s22
    s_cselect_b32 s20, s21, s20
    s_waitcnt vmcnt(4)
    s_barrier
    s_cmp_lg_u32 s69, 3
    s_cbranch_scc1 nh_2659
    s_add_u32 s64, s27, 3072
    s_and_b32 s64, s64, 0x7fff
    s_mov_b32 m0, 37888
    s_add_u32 s64, s64, s26
    buffer_load_dwordx4 v249, s[80:83], s64 offen sc1 lds
nh_2659:
    s_add_u32 m0, s23, 37888
    s_nop 0
    buffer_load_dwordx4 v249, s[80:83], s20 offen offset:0 sc1 lds
    s_add_u32 m0, s23, 38912
    s_nop 0
    buffer_load_dwordx4 v249, s[80:83], s20 offen offset:1024 sc1 lds
    s_add_u32 s20, s20, 8192
    s_cmp_eq_u32 s20, s22
    s_cselect_b32 s20, s21, s20
    s_add_u32 m0, s19, 123648
    s_nop 0
    buffer_load_dwordx4 v10, s[8:11], s16 offen lds
    s_add_u32 m0, s19, 124672
    s_nop 0
    buffer_load_dwordx4 v11, s[8:11], s16 offen lds
    s_add_u32 m0, s19, 125696
    s_nop 0
    buffer_load_dwordx4 v12, s[8:11], s16 offen lds
    s_add_u32 s16, s16, 196608
    s_cmp_eq_u32 s16, s18
    s_cselect_b32 s16, s17, s16
    s_add_u32 s42, s57, 2
    s_and_b32 s42, s42, 15
    s_mul_i32 s42, s42, 393216
    s_add_u32 s44, s40, s42
    s_addc_u32 s45, s41, 0
    s_load_dword s43, s[44:45], 0
    s_load_dword s43, s[44:45], 2048
    s_load_dword s43, s[44:45], 4096
    s_add_u32 s42, s57, 3
    s_and_b32 s42, s42, 15
    s_mul_i32 s42, s42, 393216
    s_add_u32 s44, s40, s42
    s_addc_u32 s45, s41, 0
    s_load_dword s43, s[44:45], 0
    s_load_dword s43, s[44:45], 2048
    s_load_dword s43, s[44:45], 4096
    s_waitcnt vmcnt(5)
    s_barrier
    s_cmp_lg_u32 s69, 0
    s_cbranch_scc1 nh_2660
    s_add_u32 s64, s27, 4096
    s_and_b32 s64, s64, 0x7fff
    s_mov_b32 m0, 55296
    s_add_u32 s64, s64, s26
    buffer_load_dwordx4 v249, s[80:83], s64 offen sc1 lds
nh_2660:
    s_add_u32 m0, s23, 55296
    s_nop 0
    buffer_load_dwordx4 v249, s[80:83], s20 offen offset:0 sc1 lds
    s_add_u32 m0, s23, 56320
    s_nop 0
    buffer_load_dwordx4 v249, s[80:83], s20 offen offset:1024 sc1 lds
    s_add_u32 s20, s20, 8192
    s_cmp_eq_u32 s20, s22
    s_cselect_b32 s20, s21, s20
    s_add_u32 m0, s19, 136064
    s_nop 0
    buffer_load_dwordx4 v10, s[8:11], s16 offen lds
    s_add_u32 m0, s19, 137088
    s_nop 0
    buffer_load_dwordx4 v11, s[8:11], s16 offen lds
    s_add_u32 m0, s19, 138112
    s_nop 0
    buffer_load_dwordx4 v12, s[8:11], s16 offen lds
    s_add_u32 s16, s16, 196608
    s_cmp_eq_u32 s16, s18
    s_cselect_b32 s16, s17, s16
    s_cmp_lg_u32 s69, 1
    s_cbranch_scc1 nh_2661
    s_add_u32 s64, s27, 5120
    s_and_b32 s64, s64, 0x7fff
    s_mov_b32 m0, 56320
    s_add_u32 s64, s64, s26
    buffer_load_dwordx4 v249, s[80:83], s64 offen sc1 lds
nh_2661:
    s_add_u32 m0, s23, 56320
    s_nop 0
    buffer_load_dwordx4 v249, s[80:83], s20 offen offset:0 sc1 lds
    s_add_u32 m0, s23, 57344
    s_nop 0
    buffer_load_dwordx4 v249, s[80:83], s20 offen offset:1024 sc1 lds
    s_add_u32 s20, s20, 8192
    s_cmp_eq_u32 s20, s22
    s_cselect_b32 s20, s21, s20
    s_add_u32 m0, s19, 73984
    s_nop 0
    buffer_load_dwordx4 v10, s[8:11], s16 offen lds
    s_add_u32 m0, s19, 75008
    s_nop 0
    buffer_load_dwordx4 v11, s[8:11], s16 offen lds
    s_add_u32 m0, s19, 76032
    s_nop 0
    buffer_load_dwordx4 v12, s[8:11], s16 offen lds
    s_add_u32 s16, s16, 196608
    s_cmp_eq_u32 s16, s18
    s_cselect_b32 s16, s17, s16
    s_cmp_lg_u32 s69, 2
    s_cbranch_scc1 nh_2662
    s_add_u32 s64, s27, 6144
    s_and_b32 s64, s64, 0x7fff
    s_mov_b32 m0, 0
    s_add_u32 s64, s64, s26
    buffer_load_dwordx4 v249, s[80:83], s64 offen sc1 lds
nh_2662:
    s_add_u32 m0, s23, 0
    s_nop 0
    buffer_load_dwordx4 v249, s[80:83], s20 offen offset:0 sc1 lds
    s_add_u32 m0, s23, 1024
    s_nop 0
    buffer_load_dwordx4 v249, s[80:83], s20 offen offset:1024 sc1 lds
    s_add_u32 s20, s20, 8192
    s_cmp_eq_u32 s20, s22
    s_cselect_b32 s20, s21, s20
    s_add_u32 s42, s57, 4
    s_and_b32 s42, s42, 15
    s_mul_i32 s42, s42, 393216
    s_add_u32 s44, s40, s42
    s_addc_u32 s45, s41, 0
    s_load_dword s43, s[44:45], 0
    s_load_dword s43, s[44:45], 2048
    s_load_dword s43, s[44:45], 4096
    s_waitcnt vmcnt(7)
    s_barrier
    s_add_u32 m0, s19, 86400
    s_nop 0
    buffer_load_dwordx4 v10, s[8:11], s16 offen lds
    s_add_u32 m0, s19, 87424
    s_nop 0
    buffer_load_dwordx4 v11, s[8:11], s16 offen lds
    s_add_u32 m0, s19, 88448
    s_nop 0
    buffer_load_dwordx4 v12, s[8:11], s16 offen lds
    s_add_u32 s16, s16, 196608
    s_cmp_eq_u32 s16, s18
    s_cselect_b32 s16, s17, s16
    s_cmp_lg_u32 s69, 3
    s_cbranch_scc1 nh_2663
    s_add_u32 s64, s27, 7168
    s_and_b32 s64, s64, 0x7fff
    s_mov_b32 m0, 1024
    s_add_u32 s64, s64, s26
    buffer_load_dwordx4 v249, s[80:83], s64 offen sc1 lds
nh_2663:
    s_add_u32 m0, s23, 1024
    s_nop 0
    buffer_load_dwordx4 v249, s[80:83], s20 offen offset:0 sc1 lds
    s_add_u32 m0, s23, 2048
    s_nop 0
    buffer_load_dwordx4 v249, s[80:83], s20 offen offset:1024 sc1 lds
    s_add_u32 s20, s20, 8192
    s_cmp_eq_u32 s20, s22
    s_cselect_b32 s20, s21, s20
    s_add_u32 m0, s19, 98816
    s_nop 0
    buffer_load_dwordx4 v10, s[8:11], s16 offen lds
    s_add_u32 m0, s19, 99840
    s_nop 0
    buffer_load_dwordx4 v11, s[8:11], s16 offen lds
    s_add_u32 m0, s19, 100864
    s_nop 0
    buffer_load_dwordx4 v12, s[8:11], s16 offen lds
    s_add_u32 s16, s16, 196608
    s_cmp_eq_u32 s16, s18
    s_cselect_b32 s16, s17, s16
    s_cmp_lg_u32 s69, 0
    s_cbranch_scc1 nh_2664
    s_add_u32 s64, s27, 8192
    s_and_b32 s64, s64, 0x7fff
    s_mov_b32 m0, 18432
    s_add_u32 s64, s64, s26
    buffer_load_dwordx4 v249, s[80:83], s64 offen sc1 lds
nh_2664:
    s_add_u32 m0, s23, 18432
    s_nop 0
    buffer_load_dwordx4 v249, s[80:83], s20 offen offset:0 sc1 lds
    s_add_u32 m0, s23, 19456
    s_nop 0
    buffer_load_dwordx4 v249, s[80:83], s20 offen offset:1024 sc1 lds
    s_add_u32 s20, s20, 8192
    s_cmp_eq_u32 s20, s22
    s_cselect_b32 s20, s21, s20
    s_add_u32 m0, s19, 111232
    s_nop 0
    buffer_load_dwordx4 v10, s[8:11], s16 offen lds
    s_add_u32 m0, s19, 112256
    s_nop 0
    buffer_load_dwordx4 v11, s[8:11], s16 offen lds
    s_add_u32 m0, s19, 113280
    s_nop 0
    buffer_load_dwordx4 v12, s[8:11], s16 offen lds
    s_add_u32 s16, s16, 196608
    s_cmp_eq_u32 s16, s18
    s_cselect_b32 s16, s17, s16
    s_add_u32 s42, s57, 5
    s_and_b32 s42, s42, 15
    s_mul_i32 s42, s42, 393216
    s_add_u32 s44, s40, s42
    s_addc_u32 s45, s41, 0
    s_load_dword s43, s[44:45], 0
    s_load_dword s43, s[44:45], 2048
    s_load_dword s43, s[44:45], 4096
    s_waitcnt vmcnt(10)
    s_barrier
    s_cmp_lg_u32 s69, 1
    s_cbranch_scc1 nh_2665
    s_add_u32 s64, s27, 9216
    s_and_b32 s64, s64, 0x7fff
    s_mov_b32 m0, 19456
    s_add_u32 s64, s64, s26
    buffer_load_dwordx4 v249, s[80:83], s64 offen sc1 lds
nh_2665:
    s_add_u32 m0, s23, 19456
    s_nop 0
    buffer_load_dwordx4 v249, s[80:83], s20 offen offset:0 sc1 lds
    s_add_u32 m0, s23, 20480
    s_nop 0
    buffer_load_dwordx4 v249, s[80:83], s20 offen offset:1024 sc1 lds
    s_add_u32 s20, s20, 8192
    s_cmp_eq_u32 s20, s22
    s_cselect_b32 s20, s21, s20
    s_add_u32 m0, s19, 123648
    s_nop 0
    buffer_load_dwordx4 v10, s[8:11], s16 offen lds
    s_add_u32 m0, s19, 124672
    s_nop 0
    buffer_load_dwordx4 v11, s[8:11], s16 offen lds
    s_add_u32 m0, s19, 125696
    s_nop 0
    buffer_load_dwordx4 v12, s[8:11], s16 offen lds
    s_add_u32 s16, s16, 196608
    s_cmp_eq_u32 s16, s18
    s_cselect_b32 s16, s17, s16
    s_cmp_lg_u32 s69, 2
    s_cbranch_scc1 nh_2666
    s_add_u32 s64, s27, 10240
    s_and_b32 s64, s64, 0x7fff
    s_mov_b32 m0, 36864
    s_add_u32 s64, s64, s26
    buffer_load_dwordx4 v249, s[80:83], s64 offen sc1 lds
nh_2666:
    s_add_u32 m0, s23, 36864
    s_nop 0
    buffer_load_dwordx4 v249, s[80:83], s20 offen offset:0 sc1 lds
    s_add_u32 m0, s23, 37888
    s_nop 0
    buffer_load_dwordx4 v249, s[80:83], s20 offen offset:1024 sc1 lds
    s_add_u32 s20, s20, 8192
    s_cmp_eq_u32 s20, s22
    s_cselect_b32 s20, s21, s20
    s_add_u32 m0, s19, 136064
    s_nop 0
    buffer_load_dwordx4 v10, s[8:11], s16 offen lds
    s_add_u32 m0, s19, 137088
    s_nop 0
    buffer_load_dwordx4 v11, s[8:11], s16 offen lds
    s_add_u32 m0, s19, 138112
    s_nop 0
    buffer_load_dwordx4 v12, s[8:11], s16 offen lds
    s_add_u32 s16, s16, 196608
    s_cmp_eq_u32 s16, s18
    s_cselect_b32 s16, s17, s16
    s_cmp_lg_u32 s69, 3
    s_cbranch_scc1 nh_2667
    s_add_u32 s64, s27, 11264
    s_and_b32 s64, s64, 0x7fff
    s_mov_b32 m0, 37888
    s_add_u32 s64, s64, s26
    buffer_load_dwordx4 v249, s[80:83], s64 offen sc1 lds
nh_2667:
    s_add_u32 m0, s23, 37888
    s_nop 0
    buffer_load_dwordx4 v249, s[80:83], s20 offen offset:0 sc1 lds
    s_add_u32 m0, s23, 38912
    s_nop 0
    buffer_load_dwordx4 v249, s[80:83], s20 offen offset:1024 sc1 lds
    s_add_u32 s20, s20, 8192
    s_cmp_eq_u32 s20, s22
    s_cselect_b32 s20, s21, s20
    s_add_u32 s42, s57, 6
    s_and_b32 s42, s42, 15
    s_mul_i32 s42, s42, 393216
    s_add_u32 s44, s40, s42
    s_addc_u32 s45, s41, 0
    s_load_dword s43, s[44:45], 0
    s_load_dword s43, s[44:45], 2048
    s_load_dword s43, s[44:45], 4096
    s_waitcnt vmcnt(12)
    s_barrier
    s_add_u32 m0, s19, 73984
    s_nop 0
    buffer_load_dwordx4 v10, s[8:11], s16 offen lds
    s_add_u32 m0, s19, 75008
    s_nop 0
    buffer_load_dwordx4 v11, s[8:11], s16 offen lds
    s_add_u32 m0, s19, 76032
    s_nop 0
    buffer_load_dwordx4 v12, s[8:11], s16 offen lds
    s_add_u32 s16, s16, 196608
    s_cmp_eq_u32 s16, s18
    s_cselect_b32 s16, s17, s16
    s_cmp_lg_u32 s69, 0
    s_cbranch_scc1 nh_2668
    s_add_u32 s64, s27, 12288
    s_and_b32 s64, s64, 0x7fff
    s_mov_b32 m0, 55296
    s_add_u32 s64, s64, s26
    buffer_load_dwordx4 v249, s[80:83], s64 offen sc1 lds
nh_2668:
    s_add_u32 m0, s23, 55296
    s_nop 0
    buffer_load_dwordx4 v249, s[80:83], s20 offen offset:0 sc1 lds
    s_add_u32 m0, s23, 56320
    s_nop 0
    buffer_load_dwordx4 v249, s[80:83], s20 offen offset:1024 sc1 lds
    s_add_u32 s20, s20, 8192
    s_cmp_eq_u32 s20, s22
    s_cselect_b32 s20, s21, s20
    s_add_u32 m0, s19, 86400
    s_nop 0
    buffer_load_dwordx4 v10, s[8:11], s16 offen lds
    s_add_u32 m0, s19, 87424
    s_nop 0
    buffer_load_dwordx4 v11, s[8:11], s16 offen lds
    s_add_u32 m0, s19, 88448
    s_nop 0
    buffer_load_dwordx4 v12, s[8:11], s16 offen lds
    s_add_u32 s16, s16, 196608
    s_cmp_eq_u32 s16, s18
    s_cselect_b32 s16, s17, s16
    s_cmp_lg_u32 s69, 1
    s_cbranch_scc1 nh_2669
    s_add_u32 s64, s27, 13312
    s_and_b32 s64, s64, 0x7fff
    s_mov_b32 m0, 56320
    s_add_u32 s64, s64, s26
    buffer_load_dwordx4 v249, s[80:83], s64 offen sc1 lds
nh_2669:
    s_add_u32 m0, s23, 56320
    s_nop 0
    buffer_load_dwordx4 v249, s[80:83], s20 offen offset:0 sc1 lds
    s_add_u32 m0, s23, 57344
    s_nop 0
    buffer_load_dwordx4 v249, s[80:83], s20 offen offset:1024 sc1 lds
    s_add_u32 s20, s20, 8192
    s_cmp_eq_u32 s20, s22
    s_cselect_b32 s20, s21, s20
    s_add_u32 s42, s57, 7
    s_and_b32 s42, s42, 15
    s_mul_i32 s42, s42, 393216
    s_add_u32 s44, s40, s42
    s_addc_u32 s45, s41, 0
    s_load_dword s43, s[44:45], 0
    s_load_dword s43, s[44:45], 2048
    s_load_dword s43, s[44:45], 4096
    s_waitcnt vmcnt(12)
    s_barrier
    s_add_u32 m0, s19, 98816
    s_nop 0
    buffer_load_dwordx4 v10, s[8:11], s16 offen lds
    s_add_u32 m0, s19, 99840
    s_nop 0
    buffer_load_dwordx4 v11, s[8:11], s16 offen lds
    s_add_u32 m0, s19, 100864
    s_nop 0
    buffer_load_dwordx4 v12, s[8:11], s16 offen lds
    s_add_u32 s16, s16, 196608
    s_cmp_eq_u32 s16, s18
    s_cselect_b32 s16, s17, s16
    s_cmp_lg_u32 s69, 2
    s_cbranch_scc1 nh_2670
    s_add_u32 s64, s27, 14336
    s_and_b32 s64, s64, 0x7fff
    s_mov_b32 m0, 0
    s_add_u32 s64, s64, s26
    buffer_load_dwordx4 v249, s[80:83], s64 offen sc1 lds
nh_2670:
    s_add_u32 m0, s23, 0
    s_nop 0
    buffer_load_dwordx4 v249, s[80:83], s20 offen offset:0 sc1 lds
    s_add_u32 m0, s23, 1024
    s_nop 0
    buffer_load_dwordx4 v249, s[80:83], s20 offen offset:1024 sc1 lds
    s_add_u32 s20, s20, 8192
    s_cmp_eq_u32 s20, s22
    s_cselect_b32 s20, s21, s20
    s_add_u32 m0, s19, 111232
    s_nop 0
    buffer_load_dwordx4 v10, s[8:11], s16 offen lds
    s_add_u32 m0, s19, 112256
    s_nop 0
    buffer_load_dwordx4 v11, s[8:11], s16 offen lds
    s_add_u32 m0, s19, 113280
    s_nop 0
    buffer_load_dwordx4 v12, s[8:11], s16 offen lds
    s_add_u32 s16, s16, 196608
    s_cmp_eq_u32 s16, s18
    s_cselect_b32 s16, s17, s16
    s_cmp_lg_u32 s69, 3
    s_cbranch_scc1 nh_2671
    s_add_u32 s64, s27, 15360
    s_and_b32 s64, s64, 0x7fff
    s_mov_b32 m0, 1024
    s_add_u32 s64, s64, s26
    buffer_load_dwordx4 v249, s[80:83], s64 offen sc1 lds
nh_2671:
    s_add_u32 m0, s23, 1024
    s_nop 0
    buffer_load_dwordx4 v249, s[80:83], s20 offen offset:0 sc1 lds
    s_add_u32 m0, s23, 2048
    s_nop 0
    buffer_load_dwordx4 v249, s[80:83], s20 offen offset:1024 sc1 lds
    s_add_u32 s20, s20, 8192
    s_cmp_eq_u32 s20, s22
    s_cselect_b32 s20, s21, s20
    s_add_u32 s42, s57, 8
    s_and_b32 s42, s42, 15
    s_mul_i32 s42, s42, 393216
    s_add_u32 s44, s40, s42
    s_addc_u32 s45, s41, 0
    s_load_dword s43, s[44:45], 0
    s_load_dword s43, s[44:45], 2048
    s_load_dword s43, s[44:45], 4096
    s_lshl_b32 s64, s28, 15
    s_add_u32 s64, s64, 71828352
    v_and_b32 v81, 7, v252
    v_lshlrev_b32 v81, 4, v81
    v_lshrrev_b32 v253, 3, v250
    v_lshl_add_u32 v81, v253, 12, v81
    s_cmp_lg_u32 s69, 3
    s_cbranch_scc1 hs_2672
    buffer_load_dwordx4 v[64:67], v81, s[80:83], s64 offen offset:0 sc1
    buffer_load_dwordx4 v[68:71], v81, s[80:83], s64 offen offset:1024 sc1
    buffer_load_dwordx4 v[72:75], v81, s[80:83], s64 offen offset:2048 sc1
    buffer_load_dwordx4 v[76:79], v81, s[80:83], s64 offen offset:3072 sc1
hs_2672:
    s_lshl_b32 s29, s67, 15
    s_lshl_b32 s65, s69, 8
    s_add_u32 s29, s29, s65
    s_add_u32 s29, s29, 71827456
    v_lshlrev_b32 v80, 4, v252
    v_lshl_add_u32 v80, v251, 13, v80
    s_waitcnt vmcnt(12)
    s_barrier
    s_add_u32 m0, s19, 123648
    s_nop 0
    buffer_load_dwordx4 v10, s[8:11], s16 offen lds
    s_add_u32 m0, s19, 124672
    s_nop 0
    buffer_load_dwordx4 v11, s[8:11], s16 offen lds
    s_add_u32 m0, s19, 125696
    s_nop 0
    buffer_load_dwordx4 v12, s[8:11], s16 offen lds
    s_add_u32 s16, s16, 196608
    s_cmp_eq_u32 s16, s18
    s_cselect_b32 s16, s17, s16
    s_cmp_lg_u32 s69, 0
    s_cbranch_scc1 nh_2673
    s_add_u32 s64, s27, 16384
    s_and_b32 s64, s64, 0x7fff
    s_mov_b32 m0, 18432
    s_add_u32 s64, s64, s26
    buffer_load_dwordx4 v249, s[80:83], s64 offen sc1 lds
nh_2673:
    s_add_u32 m0, s23, 18432
    s_nop 0
    buffer_load_dwordx4 v249, s[80:83], s20 offen offset:0 sc1 lds
    s_add_u32 m0, s23, 19456
    s_nop 0
    buffer_load_dwordx4 v249, s[80:83], s20 offen offset:1024 sc1 lds
    s_add_u32 s20, s20, 8192
    s_cmp_eq_u32 s20, s22
    s_cselect_b32 s20, s21, s20
    s_add_u32 m0, s19, 136064
    s_nop 0
    buffer_load_dwordx4 v10, s[8:11], s16 offen lds
    s_add_u32 m0, s19, 137088
    s_nop 0
    buffer_load_dwordx4 v11, s[8:11], s16 offen lds
    s_add_u32 m0, s19, 138112
    s_nop 0
    buffer_load_dwordx4 v12, s[8:11], s16 offen lds
    s_add_u32 s16, s16, 196608
    s_cmp_eq_u32 s16, s18
    s_cselect_b32 s16, s17, s16
    s_cmp_lg_u32 s69, 1
    s_cbranch_scc1 nh_2674
    s_add_u32 s64, s27, 17408
    s_and_b32 s64, s64, 0x7fff
    s_mov_b32 m0, 19456
    s_add_u32 s64, s64, s26
    buffer_load_dwordx4 v249, s[80:83], s64 offen sc1 lds
nh_2674:
    s_add_u32 m0, s23, 19456
    s_nop 0
    buffer_load_dwordx4 v249, s[80:83], s20 offen offset:0 sc1 lds
    s_add_u32 m0, s23, 20480
    s_nop 0
    buffer_load_dwordx4 v249, s[80:83], s20 offen offset:1024 sc1 lds
    s_add_u32 s20, s20, 8192
    s_cmp_eq_u32 s20, s22
    s_cselect_b32 s20, s21, s20
    s_add_u32 s42, s57, 9
    s_and_b32 s42, s42, 15
    s_mul_i32 s42, s42, 393216
    s_add_u32 s44, s40, s42
    s_addc_u32 s45, s41, 0
    s_load_dword s43, s[44:45], 0
    s_load_dword s43, s[44:45], 2048
    s_load_dword s43, s[44:45], 4096
    buffer_load_dwordx4 v[32:35], v80, s[80:83], s29 offen offset:0 sc1
    buffer_load_dwordx4 v[36:39], v80, s[80:83], s29 offen offset:1024 sc1
    s_add_u32 s29, s29, 2048
    s_waitcnt vmcnt(14)
    s_barrier
    s_add_u32 m0, s19, 73984
    s_nop 0
    buffer_load_dwordx4 v10, s[8:11], s16 offen lds
    s_add_u32 m0, s19, 75008
    s_nop 0
    buffer_load_dwordx4 v11, s[8:11], s16 offen lds
    s_add_u32 m0, s19, 76032
    s_nop 0
    buffer_load_dwordx4 v12, s[8:11], s16 offen lds
    s_add_u32 s16, s16, 196608
    s_cmp_eq_u32 s16, s18
    s_cselect_b32 s16, s17, s16
    s_cmp_lg_u32 s69, 2
    s_cbranch_scc1 nh_2675
    s_add_u32 s64, s27, 18432
    s_and_b32 s64, s64, 0x7fff
    s_mov_b32 m0, 36864
    s_add_u32 s64, s64, s26
    buffer_load_dwordx4 v249, s[80:83], s64 offen sc1 lds
nh_2675:
    s_add_u32 m0, s23, 36864
    s_nop 0
    buffer_load_dwordx4 v249, s[80:83], s20 offen offset:0 sc1 lds
    s_add_u32 m0, s23, 37888
    s_nop 0
    buffer_load_dwordx4 v249, s[80:83], s20 offen offset:1024 sc1 lds
    s_add_u32 s20, s20, 8192
    s_cmp_eq_u32 s20, s22
    s_cselect_b32 s20, s21, s20
    s_add_u32 m0, s19, 86400
    s_nop 0
    buffer_load_dwordx4 v10, s[8:11], s16 offen lds
    s_add_u32 m0, s19, 87424
    s_nop 0
    buffer_load_dwordx4 v11, s[8:11], s16 offen lds
    s_add_u32 m0, s19, 88448
    s_nop 0
    buffer_load_dwordx4 v12, s[8:11], s16 offen lds
    s_add_u32 s16, s16, 196608
    s_cmp_eq_u32 s16, s18
    s_cselect_b32 s16, s17, s16
    s_cmp_lg_u32 s69, 3
    s_cbranch_scc1 nh_2676
    s_add_u32 s64, s27, 19456
    s_and_b32 s64, s64, 0x7fff
    s_mov_b32 m0, 37888
    s_add_u32 s64, s64, s26
    buffer_load_dwordx4 v249, s[80:83], s64 offen sc1 lds
nh_2676:
    s_add_u32 m0, s23, 37888
    s_nop 0
    buffer_load_dwordx4 v249, s[80:83], s20 offen offset:0 sc1 lds
    s_add_u32 m0, s23, 38912
    s_nop 0
    buffer_load_dwordx4 v249, s[80:83], s20 offen offset:1024 sc1 lds
    s_add_u32 s20, s20, 8192
    s_cmp_eq_u32 s20, s22
    s_cselect_b32 s20, s21, s20
    s_add_u32 s42, s57, 10
    s_and_b32 s42, s42, 15
    s_mul_i32 s42, s42, 393216
    s_add_u32 s44, s40, s42
    s_addc_u32 s45, s41, 0
    s_load_dword s43, s[44:45], 0
    s_load_dword s43, s[44:45], 2048
    s_load_dword s43, s[44:45], 4096
    buffer_load_dwordx4 v[40:43], v80, s[80:83], s29 offen offset:0 sc1
    buffer_load_dwordx4 v[44:47], v80, s[80:83], s29 offen offset:1024 sc1
    s_add_u32 s29, s29, 2048
    s_waitcnt vmcnt(16)
    s_barrier
    s_add_u32 m0, s19, 98816
    s_nop 0
    buffer_load_dwordx4 v10, s[8:11], s16 offen lds
    s_add_u32 m0, s19, 99840
    s_nop 0
    buffer_load_dwordx4 v11, s[8:11], s16 offen lds
    s_add_u32 m0, s19, 100864
    s_nop 0
    buffer_load_dwordx4 v12, s[8:11], s16 offen lds
    s_add_u32 s16, s16, 196608
    s_cmp_eq_u32 s16, s18
    s_cselect_b32 s16, s17, s16
    s_cmp_lg_u32 s69, 0
    s_cbranch_scc1 nh_2677
    s_add_u32 s64, s27, 20480
    s_and_b32 s64, s64, 0x7fff
    s_mov_b32 m0, 55296
    s_add_u32 s64, s64, s26
    buffer_load_dwordx4 v249, s[80:83], s64 offen sc1 lds
nh_2677:
    s_add_u32 m0, s23, 55296
    s_nop 0
    buffer_load_dwordx4 v249, s[80:83], s20 offen offset:0 sc1 lds
    s_add_u32 m0, s23, 56320
    s_nop 0
    buffer_load_dwordx4 v249, s[80:83], s20 offen offset:1024 sc1 lds
    s_add_u32 s20, s20, 8192
    s_cmp_eq_u32 s20, s22
    s_cselect_b32 s20, s21, s20
    s_add_u32 m0, s19, 111232
    s_nop 0
    buffer_load_dwordx4 v10, s[8:11], s16 offen lds
    s_add_u32 m0, s19, 112256
    s_nop 0
    buffer_load_dwordx4 v11, s[8:11], s16 offen lds
    s_add_u32 m0, s19, 113280
    s_nop 0
    buffer_load_dwordx4 v12, s[8:11], s16 offen lds
    s_add_u32 s16, s16, 196608
    s_cmp_eq_u32 s16, s18
    s_cselect_b32 s16, s17, s16
    s_cmp_lg_u32 s69, 1
    s_cbranch_scc1 nh_2678
    s_add_u32 s64, s27, 21504
    s_and_b32 s64, s64, 0x7fff
    s_mov_b32 m0, 56320
    s_add_u32 s64, s64, s26
    buffer_load_dwordx4 v249, s[80:83], s64 offen sc1 lds
nh_2678:
    s_add_u32 m0, s23, 56320
    s_nop 0
    buffer_load_dwordx4 v249, s[80:83], s20 offen offset:0 sc1 lds
    s_add_u32 m0, s23, 57344
    s_nop 0
    buffer_load_dwordx4 v249, s[80:83], s20 offen offset:1024 sc1 lds
    s_add_u32 s20, s20, 8192
    s_cmp_eq_u32 s20, s22
    s_cselect_b32 s20, s21, s20
    s_add_u32 s42, s57, 11
    s_and_b32 s42, s42, 15
    s_mul_i32 s42, s42, 393216
    s_add_u32 s44, s40, s42
    s_addc_u32 s45, s41, 0
    s_load_dword s43, s[44:45], 0
    s_load_dword s43, s[44:45], 2048
    s_load_dword s43, s[44:45], 4096
    buffer_load_dwordx4 v[48:51], v80, s[80:83], s29 offen offset:0 sc1
    buffer_load_dwordx4 v[52:55], v80, s[80:83], s29 offen offset:1024 sc1
    s_add_u32 s29, s29, 2048
    s_waitcnt vmcnt(16)
    s_barrier
    s_add_u32 m0, s19, 123648
    s_nop 0
    buffer_load_dwordx4 v10, s[8:11], s16 offen lds
    s_add_u32 m0, s19, 124672
    s_nop 0
    buffer_load_dwordx4 v11, s[8:11], s16 offen lds
    s_add_u32 m0, s19, 125696
    s_nop 0
    buffer_load_dwordx4 v12, s[8:11], s16 offen lds
    s_add_u32 s16, s16, 196608
    s_cmp_eq_u32 s16, s18
    s_cselect_b32 s16, s17, s16
    s_cmp_lg_u32 s69, 2
    s_cbranch_scc1 nh_2679
    s_add_u32 s64, s27, 22528
    s_and_b32 s64, s64, 0x7fff
    s_mov_b32 m0, 0
    s_add_u32 s64, s64, s26
    buffer_load_dwordx4 v249, s[80:83], s64 offen sc1 lds
nh_2679:
    s_add_u32 m0, s23, 0
    s_nop 0
    buffer_load_dwordx4 v249, s[80:83], s20 offen offset:0 sc1 lds
    s_add_u32 m0, s23, 1024
    s_nop 0
    buffer_load_dwordx4 v249, s[80:83], s20 offen offset:1024 sc1 lds
    s_add_u32 s20, s20, 8192
    s_cmp_eq_u32 s20, s22
    s_cselect_b32 s20, s21, s20
    s_add_u32 m0, s19, 136064
    s_nop 0
    buffer_load_dwordx4 v10, s[8:11], s16 offen lds
    s_add_u32 m0, s19, 137088
    s_nop 0
    buffer_load_dwordx4 v11, s[8:11], s16 offen lds
    s_add_u32 m0, s19, 138112
    s_nop 0
    buffer_load_dwordx4 v12, s[8:11], s16 offen lds
    s_add_u32 s16, s16, 196608
    s_cmp_eq_u32 s16, s18
    s_cselect_b32 s16, s17, s16
    s_cmp_lg_u32 s69, 3
    s_cbranch_scc1 nh_2680
    s_add_u32 s64, s27, 23552
    s_and_b32 s64, s64, 0x7fff
    s_mov_b32 m0, 1024
    s_add_u32 s64, s64, s26
    buffer_load_dwordx4 v249, s[80:83], s64 offen sc1 lds
nh_2680:
    s_add_u32 m0, s23, 1024
    s_nop 0
    buffer_load_dwordx4 v249, s[80:83], s20 offen offset:0 sc1 lds
    s_add_u32 m0, s23, 2048
    s_nop 0
    buffer_load_dwordx4 v249, s[80:83], s20 offen offset:1024 sc1 lds
    s_add_u32 s20, s20, 8192
    s_cmp_eq_u32 s20, s22
    s_cselect_b32 s20, s21, s20
    s_add_u32 s42, s57, 12
    s_and_b32 s42, s42, 15
    s_mul_i32 s42, s42, 393216
    s_add_u32 s44, s40, s42
    s_addc_u32 s45, s41, 0
    s_load_dword s43, s[44:45], 0
    s_load_dword s43, s[44:45], 2048
    s_load_dword s43, s[44:45], 4096
    buffer_load_dwordx4 v[56:59], v80, s[80:83], s29 offen offset:0 sc1
    buffer_load_dwordx4 v[60:63], v80, s[80:83], s29 offen offset:1024 sc1
    s_add_u32 s29, s29, 2048
    s_waitcnt vmcnt(16)
    s_barrier
    s_add_u32 m0, s19, 73984
    s_nop 0
    buffer_load_dwordx4 v10, s[8:11], s16 offen lds
    s_add_u32 m0, s19, 75008
    s_nop 0
    buffer_load_dwordx4 v11, s[8:11], s16 offen lds
    s_add_u32 m0, s19, 76032
    s_nop 0
    buffer_load_dwordx4 v12, s[8:11], s16 offen lds
    s_add_u32 s16, s16, 196608
    s_cmp_eq_u32 s16, s18
    s_cselect_b32 s16, s17, s16
    s_cmp_lg_u32 s69, 0
    s_cbranch_scc1 nh_2681
    s_add_u32 s64, s27, 24576
    s_and_b32 s64, s64, 0x7fff
    s_mov_b32 m0, 18432
    s_add_u32 s64, s64, s26
    buffer_load_dwordx4 v249, s[80:83], s64 offen sc1 lds
nh_2681:
    s_add_u32 m0, s23, 18432
    s_nop 0
    buffer_load_dwordx4 v249, s[80:83], s20 offen offset:0 sc1 lds
    s_add_u32 m0, s23, 19456
    s_nop 0
    buffer_load_dwordx4 v249, s[80:83], s20 offen offset:1024 sc1 lds
    s_add_u32 s20, s20, 8192
    s_cmp_eq_u32 s20, s22
    s_cselect_b32 s20, s21, s20
    s_add_u32 m0, s19, 86400
    s_nop 0
    buffer_load_dwordx4 v10, s[8:11], s16 offen lds
    s_add_u32 m0, s19, 87424
    s_nop 0
    buffer_load_dwordx4 v11, s[8:11], s16 offen lds
    s_add_u32 m0, s19, 88448
    s_nop 0
    buffer_load_dwordx4 v12, s[8:11], s16 offen lds
    s_add_u32 s16, s16, 196608
    s_cmp_eq_u32 s16, s18
    s_cselect_b32 s16, s17, s16
    s_cmp_lg_u32 s69, 1
    s_cbranch_scc1 nh_2682
    s_add_u32 s64, s27, 25600
    s_and_b32 s64, s64, 0x7fff
    s_mov_b32 m0, 19456
    s_add_u32 s64, s64, s26
    buffer_load_dwordx4 v249, s[80:83], s64 offen sc1 lds
nh_2682:
    s_add_u32 m0, s23, 19456
    s_nop 0
    buffer_load_dwordx4 v249, s[80:83], s20 offen offset:0 sc1 lds
    s_add_u32 m0, s23, 20480
    s_nop 0
    buffer_load_dwordx4 v249, s[80:83], s20 offen offset:1024 sc1 lds
    s_add_u32 s20, s20, 8192
    s_cmp_eq_u32 s20, s22
    s_cselect_b32 s20, s21, s20
    s_add_u32 s42, s57, 13
    s_and_b32 s42, s42, 15
    s_mul_i32 s42, s42, 393216
    s_add_u32 s44, s40, s42
    s_addc_u32 s45, s41, 0
    s_load_dword s43, s[44:45], 0
    s_load_dword s43, s[44:45], 2048
    s_load_dword s43, s[44:45], 4096
    s_cmp_lg_u32 s69, 3
    s_cbranch_scc1 hf_2683
    v_pk_add_f32 v[64:65], v[64:65], v[72:73]
    v_pk_add_f32 v[66:67], v[66:67], v[74:75]
    v_pk_add_f32 v[68:69], v[68:69], v[76:77]
    v_pk_add_f32 v[70:71], v[70:71], v[78:79]
    v_pk_add_f32 v[64:65], v[64:65], v[68:69]
    v_pk_add_f32 v[66:67], v[66:67], v[70:71]
    v_and_b32 v81, 7, v252
    v_and_b32 v68, 1, v251
    v_add_f32_dpp v64, v64, v64 row_ror:8 row_mask:0xf bank_mask:0xf
    v_add_f32_dpp v65, v65, v65 row_ror:8 row_mask:0xf bank_mask:0xf
    v_add_f32_dpp v66, v66, v66 row_ror:8 row_mask:0xf bank_mask:0xf
    v_add_f32_dpp v67, v67, v67 row_ror:8 row_mask:0xf bank_mask:0xf
    s_nop 0
    v_permlane16_swap_b32 v64, v66
    v_permlane16_swap_b32 v65, v67
    v_add_f32 v64, v64, v66
    v_add_f32 v65, v65, v67
    v_mov_b32 v66, v64
    v_mov_b32 v67, v65
    v_lshl_add_u32 v81, v81, 1, v68
    v_lshlrev_b32 v81, 3, v81
    v_permlane32_swap_b32 v64, v66
    v_permlane32_swap_b32 v65, v67
    v_add_f32 v64, v64, v66
    v_add_f32 v65, v65, v67
    v_mul_f32 v64, 0x3a800000, v64
    v_mul_f32 v65, 0x3a800000, v65
    v_fma_f32 v65, -v64, v64, v65
    v_max_f32 v65, 0, v65
    v_cvt_pk_bf16_f32 v64, v64, v64
    v_lshlrev_b32 v64, 16, v64
    v_cvt_pk_bf16_f32 v65, v65, v65
    v_lshlrev_b32 v65, 16, v65
    v_add_f32 v65, 0x3727c5ac, v65
    v_cvt_pk_bf16_f32 v65, v65, v65
    v_lshlrev_b32 v65, 16, v65
    v_sqrt_f32 v65, v65
    s_nop 0
    v_cvt_pk_bf16_f32 v65, v65, v65
    v_lshlrev_b32 v65, 16, v65
    v_rcp_f32 v65, v65
    s_nop 0
    v_add_u32 v81, 159744, v81
    ds_write_b64 v81, v[64:65]
hf_2683:
    s_waitcnt vmcnt(14)
    s_barrier
    s_add_u32 m0, s19, 98816
    s_nop 0
    buffer_load_dwordx4 v10, s[8:11], s16 offen lds
    s_add_u32 m0, s19, 99840
    s_nop 0
    buffer_load_dwordx4 v11, s[8:11], s16 offen lds
    s_add_u32 m0, s19, 100864
    s_nop 0
    buffer_load_dwordx4 v12, s[8:11], s16 offen lds
    s_add_u32 s16, s16, 196608
    s_cmp_eq_u32 s16, s18
    s_cselect_b32 s16, s17, s16
    s_cmp_lg_u32 s69, 2
    s_cbranch_scc1 nh_2684
    s_add_u32 s64, s27, 26624
    s_and_b32 s64, s64, 0x7fff
    s_mov_b32 m0, 36864
    s_add_u32 s64, s64, s26
    buffer_load_dwordx4 v249, s[80:83], s64 offen sc1 lds
nh_2684:
    s_add_u32 m0, s23, 36864
    s_nop 0
    buffer_load_dwordx4 v249, s[80:83], s20 offen offset:0 sc1 lds
    s_add_u32 m0, s23, 37888
    s_nop 0
    buffer_load_dwordx4 v249, s[80:83], s20 offen offset:1024 sc1 lds
    s_add_u32 s20, s20, 8192
    s_cmp_eq_u32 s20, s22
    s_cselect_b32 s20, s21, s20
    s_add_u32 m0, s19, 111232
    s_nop 0
    buffer_load_dwordx4 v10, s[8:11], s16 offen lds
    s_add_u32 m0, s19, 112256
    s_nop 0
    buffer_load_dwordx4 v11, s[8:11], s16 offen lds
    s_add_u32 m0, s19, 113280
    s_nop 0
    buffer_load_dwordx4 v12, s[8:11], s16 offen lds
    s_add_u32 s16, s16, 196608
    s_cmp_eq_u32 s16, s18
    s_cselect_b32 s16, s17, s16
    s_cmp_lg_u32 s69, 3
    s_cbranch_scc1 nh_2685
    s_add_u32 s64, s27, 27648
    s_and_b32 s64, s64, 0x7fff
    s_mov_b32 m0, 37888
    s_add_u32 s64, s64, s26
    buffer_load_dwordx4 v249, s[80:83], s64 offen sc1 lds
nh_2685:
    s_add_u32 m0, s23, 37888
    s_nop 0
    buffer_load_dwordx4 v249, s[80:83], s20 offen offset:0 sc1 lds
    s_add_u32 m0, s23, 38912
    s_nop 0
    buffer_load_dwordx4 v249, s[80:83], s20 offen offset:1024 sc1 lds
    s_add_u32 s20, s20, 8192
    s_cmp_eq_u32 s20, s22
    s_cselect_b32 s20, s21, s20
    s_add_u32 s42, s57, 14
    s_and_b32 s42, s42, 15
    s_mul_i32 s42, s42, 393216
    s_add_u32 s44, s40, s42
    s_addc_u32 s45, s41, 0
    s_load_dword s43, s[44:45], 0
    s_load_dword s43, s[44:45], 2048
    s_load_dword s43, s[44:45], 4096
    s_waitcnt vmcnt(12)
    s_barrier
    s_add_u32 m0, s19, 123648
    s_nop 0
    buffer_load_dwordx4 v10, s[8:11], s16 offen lds
    s_add_u32 m0, s19, 124672
    s_nop 0
    buffer_load_dwordx4 v11, s[8:11], s16 offen lds
    s_add_u32 m0, s19, 125696
    s_nop 0
    buffer_load_dwordx4 v12, s[8:11], s16 offen lds
    s_add_u32 s16, s16, 196608
    s_cmp_eq_u32 s16, s18
    s_cselect_b32 s16, s17, s16
    s_cmp_lg_u32 s69, 0
    s_cbranch_scc1 nh_2686
    s_add_u32 s64, s27, 28672
    s_and_b32 s64, s64, 0x7fff
    s_mov_b32 m0, 55296
    s_add_u32 s64, s64, s26
    buffer_load_dwordx4 v249, s[80:83], s64 offen sc1 lds
nh_2686:
    s_add_u32 m0, s23, 55296
    s_nop 0
    buffer_load_dwordx4 v249, s[80:83], s20 offen offset:0 sc1 lds
    s_add_u32 m0, s23, 56320
    s_nop 0
    buffer_load_dwordx4 v249, s[80:83], s20 offen offset:1024 sc1 lds
    s_add_u32 s20, s20, 8192
    s_cmp_eq_u32 s20, s22
    s_cselect_b32 s20, s21, s20
    s_add_u32 m0, s19, 136064
    s_nop 0
    buffer_load_dwordx4 v10, s[8:11], s16 offen lds
    s_add_u32 m0, s19, 137088
    s_nop 0
    buffer_load_dwordx4 v11, s[8:11], s16 offen lds
    s_add_u32 m0, s19, 138112
    s_nop 0
    buffer_load_dwordx4 v12, s[8:11], s16 offen lds
    s_add_u32 s16, s16, 196608
    s_cmp_eq_u32 s16, s18
    s_cselect_b32 s16, s17, s16
    s_cmp_lg_u32 s69, 1
    s_cbranch_scc1 nh_2687
    s_add_u32 s64, s27, 29696
    s_and_b32 s64, s64, 0x7fff
    s_mov_b32 m0, 56320
    s_add_u32 s64, s64, s26
    buffer_load_dwordx4 v249, s[80:83], s64 offen sc1 lds
nh_2687:
    s_add_u32 m0, s23, 56320
    s_nop 0
    buffer_load_dwordx4 v249, s[80:83], s20 offen offset:0 sc1 lds
    s_add_u32 m0, s23, 57344
    s_nop 0
    buffer_load_dwordx4 v249, s[80:83], s20 offen offset:1024 sc1 lds
    s_add_u32 s20, s20, 8192
    s_cmp_eq_u32 s20, s22
    s_cselect_b32 s20, s21, s20
    s_add_u32 s42, s57, 15
    s_and_b32 s42, s42, 15
    s_mul_i32 s42, s42, 393216
    s_add_u32 s44, s40, s42
    s_addc_u32 s45, s41, 0
    s_load_dword s43, s[44:45], 0
    s_load_dword s43, s[44:45], 2048
    s_load_dword s43, s[44:45], 4096
    s_lshl_b32 s29, s69, 8
    s_add_u32 s29, s29, 159872
    v_pk_add_f32 v[32:33], v[32:33], v[48:49]
    v_pk_add_f32 v[34:35], v[34:35], v[50:51]
    v_pk_add_f32 v[36:37], v[36:37], v[52:53]
    v_pk_add_f32 v[38:39], v[38:39], v[54:55]
    v_pk_add_f32 v[40:41], v[40:41], v[56:57]
    v_pk_add_f32 v[42:43], v[42:43], v[58:59]
    v_pk_add_f32 v[44:45], v[44:45], v[60:61]
    v_pk_add_f32 v[46:47], v[46:47], v[62:63]
    s_waitcnt vmcnt(12)
    s_barrier
    s_add_u32 m0, s19, 73984
    s_nop 0
    buffer_load_dwordx4 v10, s[8:11], s16 offen lds
    s_add_u32 m0, s19, 75008
    s_nop 0
    buffer_load_dwordx4 v11, s[8:11], s16 offen lds
    s_add_u32 m0, s19, 76032
    s_nop 0
    buffer_load_dwordx4 v12, s[8:11], s16 offen lds
    s_add_u32 s16, s16, 196608
    s_cmp_eq_u32 s16, s18
    s_cselect_b32 s16, s17, s16
    s_cmp_lg_u32 s69, 2
    s_cbranch_scc1 nh_2688
    s_add_u32 s64, s27, 30720
    s_and_b32 s64, s64, 0x7fff
    s_mov_b32 m0, 0
    s_add_u32 s64, s64, s26
    buffer_load_dwordx4 v249, s[80:83], s64 offen sc1 lds
nh_2688:
    s_add_u32 m0, s23, 0
    s_nop 0
    buffer_load_dwordx4 v249, s[80:83], s20 offen offset:0 sc1 lds
    s_add_u32 m0, s23, 1024
    s_nop 0
    buffer_load_dwordx4 v249, s[80:83], s20 offen offset:1024 sc1 lds
    s_add_u32 s20, s20, 8192
    s_cmp_eq_u32 s20, s22
    s_cselect_b32 s20, s21, s20
    s_add_u32 m0, s19, 86400
    s_nop 0
    buffer_load_dwordx4 v10, s[8:11], s16 offen lds
    s_add_u32 m0, s19, 87424
    s_nop 0
    buffer_load_dwordx4 v11, s[8:11], s16 offen lds
    s_add_u32 m0, s19, 88448
    s_nop 0
    buffer_load_dwordx4 v12, s[8:11], s16 offen lds
    s_add_u32 s16, s16, 196608
    s_cmp_eq_u32 s16, s18
    s_cselect_b32 s16, s17, s16
    s_cmp_lg_u32 s69, 3
    s_cbranch_scc1 nh_2689
    s_add_u32 s64, s27, 31744
    s_and_b32 s64, s64, 0x7fff
    s_mov_b32 m0, 1024
    s_add_u32 s64, s64, s26
    buffer_load_dwordx4 v249, s[80:83], s64 offen sc1 lds
nh_2689:
    s_add_u32 m0, s23, 1024
    s_nop 0
    buffer_load_dwordx4 v249, s[80:83], s20 offen offset:0 sc1 lds
    s_add_u32 m0, s23, 2048
    s_nop 0
    buffer_load_dwordx4 v249, s[80:83], s20 offen offset:1024 sc1 lds
    s_add_u32 s20, s20, 8192
    s_cmp_eq_u32 s20, s22
    s_cselect_b32 s20, s21, s20
    v_pk_add_f32 v[32:33], v[32:33], v[40:41]
    v_pk_add_f32 v[34:35], v[34:35], v[42:43]
    v_pk_add_f32 v[36:37], v[36:37], v[44:45]
    v_pk_add_f32 v[38:39], v[38:39], v[46:47]
    v_pk_add_f32 v[32:33], v[32:33], v[36:37]
    v_pk_add_f32 v[34:35], v[34:35], v[38:39]
    v_and_b32 v80, 15, v252
    v_and_b32 v36, 1, v251
    v_permlane16_swap_b32 v32, v34
    v_permlane16_swap_b32 v33, v35
    s_waitcnt vmcnt(12)
    s_barrier
    s_add_u32 m0, s19, 98816
    s_nop 0
    buffer_load_dwordx4 v10, s[8:11], s16 offen lds
    s_add_u32 m0, s19, 99840
    s_nop 0
    buffer_load_dwordx4 v11, s[8:11], s16 offen lds
    s_add_u32 m0, s19, 100864
    s_nop 0
    buffer_load_dwordx4 v12, s[8:11], s16 offen lds
    s_add_u32 s16, s16, 196608
    s_cmp_eq_u32 s16, s18
    s_cselect_b32 s16, s17, s16
    s_lshl_b32 s64, s67, 4
    s_add_u32 s64, s64, s74
    s_lshl_b32 s64, s64, 2
    s_add_u32 s64, s64, s69
    s_lshl_b32 s64, s64, 12
    s_lshl_b32 s65, s75, 22
    s_add_u32 s64, s64, s65
    s_add_u32 s64, s64, 12582912
    s_cmp_eq_u32 s68, 0
    s_cselect_b32 s64, s64, 0x7f000000
    v_lshlrev_b32 v253, 7, v250
    s_mov_b64 exec, 0xffffffff
    buffer_load_dword v9, v253, s[80:83], s64 offen sc1
    s_mov_b64 exec, -1
    s_mov_b32 s12, s88
    s_mov_b32 s13, s89
    s_mov_b32 s14, 2097152
    s_mov_b32 s15, 0x00020000
    v_lshrrev_b32 v253, 3, v250
    v_lshlrev_b32 v253, 13, v253
    v_and_b32 v254, 7, v250
    v_lshl_add_u32 v253, v254, 4, v253
    s_lshl_b32 s64, s69, 11
    v_add_u32 v244, s64, v253
    s_mul_i32 s51, s69, 1056
    s_lshl_b32 s49, s72, 7
    v_add_f32 v32, v32, v34
    v_add_f32 v33, v33, v35
    v_mov_b32 v34, v32
    v_mov_b32 v35, v33
    v_lshl_add_u32 v80, v80, 1, v36
    v_lshlrev_b32 v80, 3, v80
    v_permlane32_swap_b32 v32, v34
    v_permlane32_swap_b32 v33, v35
    v_add_f32 v32, v32, v34
    v_add_f32 v33, v33, v35
    v_mul_f32 v32, 0x3a800000, v32
    v_mul_f32 v33, 0x3a800000, v33
    v_fma_f32 v33, -v32, v32, v33
    v_max_f32 v33, 0, v33
    v_cvt_pk_bf16_f32 v32, v32, v32
    v_lshlrev_b32 v32, 16, v32
    s_add_u32 s48, s58, 0
    s_and_b32 s48, s48, 7
    s_and_b32 s66, s74, 8
    s_or_b32 s48, s48, s66
    s_lshl_b32 s48, s48, 17
    s_add_u32 s48, s48, s49
    s_add_u32 m0, s51, 116224
    s_nop 0
    buffer_load_dwordx4 v244, s[12:15], s48 offen lds
    s_add_u32 s48, s48, 65536
    s_waitcnt vmcnt(7)
    s_barrier
    v_cvt_pk_bf16_f32 v33, v33, v33
    v_lshlrev_b32 v33, 16, v33
    v_add_f32 v33, 0x3727c5ac, v33
    v_cvt_pk_bf16_f32 v33, v33, v33
    v_lshlrev_b32 v33, 16, v33
    v_sqrt_f32 v33, v33
    s_nop 0
    v_cvt_pk_bf16_f32 v33, v33, v33
    v_lshlrev_b32 v33, 16, v33
    v_rcp_f32 v33, v33
    s_nop 0
    v_add_u32 v80, s29, v80
    ds_write_b64 v80, v[32:33]
    s_add_u32 m0, s51, 120448
    s_nop 0
    buffer_load_dwordx4 v244, s[12:15], s48 offen lds
    s_add_u32 s48, s48, 65536
    s_add_u32 s48, s58, 1
    s_and_b32 s48, s48, 7
    s_and_b32 s66, s74, 8
    s_or_b32 s48, s48, s66
    s_lshl_b32 s48, s48, 17
    s_add_u32 s48, s48, s49
    s_add_u32 m0, s51, 124672
    s_nop 0
    buffer_load_dwordx4 v244, s[12:15], s48 offen lds
    s_add_u32 s48, s48, 65536
    s_add_u32 m0, s51, 128896
    s_nop 0
    buffer_load_dwordx4 v244, s[12:15], s48 offen lds
    s_add_u32 s48, s48, 65536
    s_add_u32 s48, s58, 2
    s_and_b32 s48, s48, 7
    s_and_b32 s66, s74, 8
    s_or_b32 s48, s48, s66
    s_lshl_b32 s48, s48, 17
    s_add_u32 s48, s48, s49
    s_add_u32 m0, s51, 133120
    s_nop 0
    buffer_load_dwordx4 v244, s[12:15], s48 offen lds
    s_add_u32 s48, s48, 65536
    s_add_u32 m0, s51, 137344
    s_nop 0
    buffer_load_dwordx4 v244, s[12:15], s48 offen lds
    s_add_u32 s48, s48, 65536
    s_add_u32 s48, s58, 3
    s_and_b32 s48, s48, 7
    s_and_b32 s66, s74, 8
    s_or_b32 s48, s48, s66
    s_lshl_b32 s48, s48, 17
    s_add_u32 s48, s48, s49
    s_add_u32 m0, s51, 141568
    s_nop 0
    buffer_load_dwordx4 v244, s[12:15], s48 offen lds
    s_add_u32 s48, s48, 65536
    s_add_u32 m0, s51, 145792
    s_nop 0
    buffer_load_dwordx4 v244, s[12:15], s48 offen lds
    s_add_u32 s48, s48, 65536
    s_add_u32 s48, s58, 4
    s_and_b32 s48, s48, 7
    s_and_b32 s66, s74, 8
    s_or_b32 s48, s48, s66
    s_lshl_b32 s48, s48, 17
    s_add_u32 s48, s48, s49
    s_add_u32 m0, s51, 150016
    s_nop 0
    buffer_load_dwordx4 v244, s[12:15], s48 offen lds
    s_add_u32 s48, s48, 65536
    s_waitcnt vmcnt(10)
    s_barrier
    s_add_u32 m0, s51, 154240
    s_nop 0
    buffer_load_dwordx4 v244, s[12:15], s48 offen lds
    s_add_u32 s48, s48, 65536
    s_add_u32 s48, s58, 5
    s_and_b32 s48, s48, 7
    s_and_b32 s66, s74, 8
    s_or_b32 s48, s48, s66
    s_lshl_b32 s48, s48, 17
    s_add_u32 s48, s48, s49
    s_add_u32 m0, s51, 65536
    s_nop 0
    buffer_load_dwordx4 v244, s[12:15], s48 offen lds
    s_add_u32 s48, s48, 65536
    s_add_u32 m0, s51, 69760
    s_nop 0
    buffer_load_dwordx4 v244, s[12:15], s48 offen lds
    s_add_u32 s48, s48, 65536
    s_add_u32 s48, s58, 6
    s_and_b32 s48, s48, 7
    s_and_b32 s66, s74, 8
    s_or_b32 s48, s48, s66
    s_lshl_b32 s48, s48, 17
    s_add_u32 s48, s48, s49
    s_add_u32 m0, s51, 73984
    s_nop 0
    buffer_load_dwordx4 v244, s[12:15], s48 offen lds
    s_add_u32 s48, s48, 65536
    s_add_u32 m0, s51, 78208
    s_nop 0
    buffer_load_dwordx4 v244, s[12:15], s48 offen lds
    s_add_u32 s48, s48, 65536
    s_add_u32 s48, s58, 7
    s_and_b32 s48, s48, 7
    s_and_b32 s66, s74, 8
    s_or_b32 s48, s48, s66
    s_lshl_b32 s48, s48, 17
    s_add_u32 s48, s48, s49
    s_add_u32 m0, s51, 82432
    s_nop 0
    buffer_load_dwordx4 v244, s[12:15], s48 offen lds
    s_add_u32 s48, s48, 65536
    s_add_u32 m0, s51, 86656
    s_nop 0
    buffer_load_dwordx4 v244, s[12:15], s48 offen lds
    s_add_u32 s48, s48, 65536
    s_add_u32 s48, s58, 8
    s_and_b32 s48, s48, 7
    s_and_b32 s66, s74, 8
    s_xor_b32 s66, s66, 8
    s_or_b32 s48, s48, s66
    s_lshl_b32 s48, s48, 17
    s_add_u32 s48, s48, s49
    s_add_u32 m0, s51, 90880
    s_nop 0
    buffer_load_dwordx4 v244, s[12:15], s48 offen lds
    s_add_u32 s48, s48, 65536
    s_waitcnt lgkmcnt(0)
    s_barrier
    s_add_u32 m0, s51, 95104
    s_nop 0
    buffer_load_dwordx4 v244, s[12:15], s48 offen lds
    s_add_u32 s48, s48, 65536
    s_add_u32 s48, s58, 9
    s_and_b32 s48, s48, 7
    s_and_b32 s66, s74, 8
    s_xor_b32 s66, s66, 8
    s_or_b32 s48, s48, s66
    s_lshl_b32 s48, s48, 17
    s_add_u32 s48, s48, s49
    s_add_u32 m0, s51, 99328
    s_nop 0
    buffer_load_dwordx4 v244, s[12:15], s48 offen lds
    s_add_u32 s48, s48, 65536
    s_add_u32 m0, s51, 103552
    s_nop 0
    buffer_load_dwordx4 v244, s[12:15], s48 offen lds
    s_add_u32 s48, s48, 65536
    s_add_u32 s48, s58, 10
    s_and_b32 s48, s48, 7
    s_and_b32 s66, s74, 8
    s_xor_b32 s66, s66, 8
    s_or_b32 s48, s48, s66
    s_lshl_b32 s48, s48, 17
    s_add_u32 s48, s48, s49
    s_add_u32 m0, s51, 107776
    s_nop 0
    buffer_load_dwordx4 v244, s[12:15], s48 offen lds
    s_add_u32 s48, s48, 65536
    s_add_u32 m0, s51, 112000
    s_nop 0
    buffer_load_dwordx4 v244, s[12:15], s48 offen lds
    s_add_u32 s48, s48, 65536
    s_branch L_g2
ar_17:
    v_mov_b32 v72, s32
    v_mov_b32 v73, 0
    s_mov_b64 exec, 1
    buffer_store_byte v72, v73, s[28:31], s2 offen sc0 sc1
    s_mov_b64 exec, -1
    s_branch ar_17_b
ar_19:
    v_mov_b32 v72, s32
    v_mov_b32 v73, 0
    s_mov_b64 exec, 1
    buffer_store_byte v72, v73, s[28:31], s2 offen sc0 sc1
    s_mov_b64 exec, -1
    s_branch ar_19_b
ar_21:
    v_mov_b32 v72, s32
    v_mov_b32 v73, 0
    s_mov_b64 exec, 1
    buffer_store_byte v72, v73, s[28:31], s2 offen sc0 sc1
    s_mov_b64 exec, -1
    s_branch ar_21_b
ar_23:
    v_mov_b32 v72, s32
    v_mov_b32 v73, 0
    s_mov_b64 exec, 1
    buffer_store_byte v72, v73, s[28:31], s2 offen sc0 sc1
    s_mov_b64 exec, -1
    s_branch ar_23_b
hs_32:
    buffer_load_dword v72, v71, s[28:31], 0 offen sc1
    s_sub_u32 s79, s79, 1
    s_cbranch_scc1 L_abort
    s_waitcnt vmcnt(0)
    v_and_b32 v73, 0x80808080, v72
    v_cmp_ne_u32 vcc, 0x80808080, v73
    s_cbranch_vccnz hs_32
    s_branch hs_32_b
pl_33_acq:
    buffer_inv sc1
    s_waitcnt vmcnt(0)
    s_branch pl_33_ok
rc_35:
    s_mov_b64 exec, 1
pl_136:
    buffer_load_dword v240, v246, s[80:83], s47 offen sc1
    s_sub_u32 s79, s79, 1
    s_cbranch_scc1 L_abort
    s_waitcnt vmcnt(0)
    v_cmp_ne_u32 vcc, 1, v240
    s_cbranch_vccnz pl_136
    s_mov_b64 exec, -1
    s_cmp_lg_u32 s78, 0
    s_cbranch_scc1 pl_136_acq
pl_136_ok:
    s_branch rc_35_b
pl_136_acq:
    buffer_inv sc1
    s_waitcnt vmcnt(0)
    s_branch pl_136_ok
pl_138_acq:
    buffer_inv sc1
    s_waitcnt vmcnt(0)
    s_branch pl_138_ok
pl_140_acq:
    buffer_inv sc1
    s_waitcnt vmcnt(0)
    s_branch pl_140_ok
cs_141:
    v_add_u32 v225, 28800, v224
    ds_read_b64_tr_b16 v[204:205], v225 offset:0
    ds_read_b64_tr_b16 v[206:207], v225 offset:3584
    ds_read_b64_tr_b16 v[208:209], v225 offset:32
    ds_read_b64_tr_b16 v[210:211], v225 offset:3616
    ds_read_b64_tr_b16 v[212:213], v225 offset:64
    ds_read_b64_tr_b16 v[214:215], v225 offset:3648
    ds_read_b64_tr_b16 v[216:217], v225 offset:96
    ds_read_b64_tr_b16 v[218:219], v225 offset:3680
    s_waitcnt lgkmcnt(0)
    v_mfma_f32_16x16x32_bf16 v[176:179], v[204:207], v[220:223], 0
    v_mfma_f32_16x16x32_bf16 v[180:183], v[208:211], v[220:223], 0
    v_mfma_f32_16x16x32_bf16 v[184:187], v[212:215], v[220:223], 0
    v_mfma_f32_16x16x32_bf16 v[188:191], v[216:219], v[220:223], 0
    s_nop 7
    ds_read_b64_tr_b16 v[204:205], v225 offset:128
    ds_read_b64_tr_b16 v[206:207], v225 offset:3712
    ds_read_b64_tr_b16 v[208:209], v225 offset:160
    ds_read_b64_tr_b16 v[210:211], v225 offset:3744
    ds_read_b64_tr_b16 v[212:213], v225 offset:192
    ds_read_b64_tr_b16 v[214:215], v225 offset:3776
    s_waitcnt lgkmcnt(0)
    v_mfma_f32_16x16x32_bf16 v[192:195], v[204:207], v[220:223], 0
    v_mfma_f32_16x16x32_bf16 v[196:199], v[208:211], v[220:223], 0
    v_mfma_f32_16x16x32_bf16 v[200:203], v[212:215], v[220:223], 0
    s_nop 7
    s_branch cs_141_b
cs_142:
    v_add_u32 v225, 57600, v224
    ds_read_b64_tr_b16 v[204:205], v225 offset:0
    ds_read_b64_tr_b16 v[206:207], v225 offset:3584
    ds_read_b64_tr_b16 v[208:209], v225 offset:32
    ds_read_b64_tr_b16 v[210:211], v225 offset:3616
    ds_read_b64_tr_b16 v[212:213], v225 offset:64
    ds_read_b64_tr_b16 v[214:215], v225 offset:3648
    ds_read_b64_tr_b16 v[216:217], v225 offset:96
    ds_read_b64_tr_b16 v[218:219], v225 offset:3680
    s_waitcnt lgkmcnt(0)
    v_mfma_f32_16x16x32_bf16 v[176:179], v[204:207], v[220:223], v[176:179]
    v_mfma_f32_16x16x32_bf16 v[180:183], v[208:211], v[220:223], v[180:183]
    v_mfma_f32_16x16x32_bf16 v[184:187], v[212:215], v[220:223], v[184:187]
    v_mfma_f32_16x16x32_bf16 v[188:191], v[216:219], v[220:223], v[188:191]
    s_nop 7
    ds_read_b64_tr_b16 v[204:205], v225 offset:128
    ds_read_b64_tr_b16 v[206:207], v225 offset:3712
    ds_read_b64_tr_b16 v[208:209], v225 offset:160
    ds_read_b64_tr_b16 v[210:211], v225 offset:3744
    ds_read_b64_tr_b16 v[212:213], v225 offset:192
    ds_read_b64_tr_b16 v[214:215], v225 offset:3776
    s_waitcnt lgkmcnt(0)
    v_mfma_f32_16x16x32_bf16 v[192:195], v[204:207], v[220:223], v[192:195]
    v_mfma_f32_16x16x32_bf16 v[196:199], v[208:211], v[220:223], v[196:199]
    v_mfma_f32_16x16x32_bf16 v[200:203], v[212:215], v[220:223], v[200:203]
    s_nop 7
    s_lshl_b32 s64, s34, 1
    s_and_b32 s65, s3, 1
    s_add_u32 s64, s64, s65
    s_mul_i32 s64, s64, 14336
    s_mul_i32 s65, s74, 896
    s_add_u32 s64, s64, s65
    s_lshr_b32 s65, s69, 1
    s_mul_i32 s65, s65, 448
    s_add_u32 s64, s64, s65
    s_add_u32 s64, s64, 74448896
    v_lshlrev_b32 v225, 4, v251
    s_mov_b32 exec_lo, 0x00010001
    s_mov_b32 exec_hi, 0x00010001
    buffer_store_dwordx4 v[176:179], v225, s[80:83], s64 offen offset:0 sc0 sc1
    buffer_store_dwordx4 v[180:183], v225, s[80:83], s64 offen offset:64 sc0 sc1
    buffer_store_dwordx4 v[184:187], v225, s[80:83], s64 offen offset:128 sc0 sc1
    buffer_store_dwordx4 v[188:191], v225, s[80:83], s64 offen offset:192 sc0 sc1
    buffer_store_dwordx4 v[192:195], v225, s[80:83], s64 offen offset:256 sc0 sc1
    buffer_store_dwordx4 v[196:199], v225, s[80:83], s64 offen offset:320 sc0 sc1
    buffer_store_dwordx4 v[200:203], v225, s[80:83], s64 offen offset:384 sc0 sc1
    s_mov_b64 exec, -1
    s_nop 3
    s_branch cs_142_b
cs_143:
    v_add_u32 v225, 86400, v224
    ds_read_b64_tr_b16 v[204:205], v225 offset:0
    ds_read_b64_tr_b16 v[206:207], v225 offset:3584
    ds_read_b64_tr_b16 v[208:209], v225 offset:32
    ds_read_b64_tr_b16 v[210:211], v225 offset:3616
    ds_read_b64_tr_b16 v[212:213], v225 offset:64
    ds_read_b64_tr_b16 v[214:215], v225 offset:3648
    ds_read_b64_tr_b16 v[216:217], v225 offset:96
    ds_read_b64_tr_b16 v[218:219], v225 offset:3680
    s_waitcnt lgkmcnt(0)
    v_mfma_f32_16x16x32_bf16 v[176:179], v[204:207], v[220:223], 0
    v_mfma_f32_16x16x32_bf16 v[180:183], v[208:211], v[220:223], 0
    v_mfma_f32_16x16x32_bf16 v[184:187], v[212:215], v[220:223], 0
    v_mfma_f32_16x16x32_bf16 v[188:191], v[216:219], v[220:223], 0
    s_nop 7
    ds_read_b64_tr_b16 v[204:205], v225 offset:128
    ds_read_b64_tr_b16 v[206:207], v225 offset:3712
    ds_read_b64_tr_b16 v[208:209], v225 offset:160
    ds_read_b64_tr_b16 v[210:211], v225 offset:3744
    ds_read_b64_tr_b16 v[212:213], v225 offset:192
    ds_read_b64_tr_b16 v[214:215], v225 offset:3776
    s_waitcnt lgkmcnt(0)
    v_mfma_f32_16x16x32_bf16 v[192:195], v[204:207], v[220:223], 0
    v_mfma_f32_16x16x32_bf16 v[196:199], v[208:211], v[220:223], 0
    v_mfma_f32_16x16x32_bf16 v[200:203], v[212:215], v[220:223], 0
    s_nop 7
    s_branch cs_143_b
cs_144:
    v_add_u32 v225, 0, v224
    ds_read_b64_tr_b16 v[204:205], v225 offset:0
    ds_read_b64_tr_b16 v[206:207], v225 offset:3584
    ds_read_b64_tr_b16 v[208:209], v225 offset:32
    ds_read_b64_tr_b16 v[210:211], v225 offset:3616
    ds_read_b64_tr_b16 v[212:213], v225 offset:64
    ds_read_b64_tr_b16 v[214:215], v225 offset:3648
    ds_read_b64_tr_b16 v[216:217], v225 offset:96
    ds_read_b64_tr_b16 v[218:219], v225 offset:3680
    s_waitcnt lgkmcnt(0)
    v_mfma_f32_16x16x32_bf16 v[176:179], v[204:207], v[220:223], v[176:179]
    v_mfma_f32_16x16x32_bf16 v[180:183], v[208:211], v[220:223], v[180:183]
    v_mfma_f32_16x16x32_bf16 v[184:187], v[212:215], v[220:223], v[184:187]
    v_mfma_f32_16x16x32_bf16 v[188:191], v[216:219], v[220:223], v[188:191]
    s_nop 7
    ds_read_b64_tr_b16 v[204:205], v225 offset:128
    ds_read_b64_tr_b16 v[206:207], v225 offset:3712
    ds_read_b64_tr_b16 v[208:209], v225 offset:160
    ds_read_b64_tr_b16 v[210:211], v225 offset:3744
    ds_read_b64_tr_b16 v[212:213], v225 offset:192
    ds_read_b64_tr_b16 v[214:215], v225 offset:3776
    s_waitcnt lgkmcnt(0)
    v_mfma_f32_16x16x32_bf16 v[192:195], v[204:207], v[220:223], v[192:195]
    v_mfma_f32_16x16x32_bf16 v[196:199], v[208:211], v[220:223], v[196:199]
    v_mfma_f32_16x16x32_bf16 v[200:203], v[212:215], v[220:223], v[200:203]
    s_nop 7
    s_lshl_b32 s64, s34, 1
    s_and_b32 s65, s3, 1
    s_add_u32 s64, s64, s65
    s_mul_i32 s64, s64, 14336
    s_mul_i32 s65, s74, 896
    s_add_u32 s64, s64, s65
    s_lshr_b32 s65, s69, 1
    s_mul_i32 s65, s65, 448
    s_add_u32 s64, s64, s65
    s_add_u32 s64, s64, 74448896
    v_lshlrev_b32 v225, 4, v251
    s_mov_b32 exec_lo, 0x00010001
    s_mov_b32 exec_hi, 0x00010001
    buffer_store_dwordx4 v[176:179], v225, s[80:83], s64 offen offset:0 sc0 sc1
    buffer_store_dwordx4 v[180:183], v225, s[80:83], s64 offen offset:64 sc0 sc1
    buffer_store_dwordx4 v[184:187], v225, s[80:83], s64 offen offset:128 sc0 sc1
    buffer_store_dwordx4 v[188:191], v225, s[80:83], s64 offen offset:192 sc0 sc1
    buffer_store_dwordx4 v[192:195], v225, s[80:83], s64 offen offset:256 sc0 sc1
    buffer_store_dwordx4 v[196:199], v225, s[80:83], s64 offen offset:320 sc0 sc1
    buffer_store_dwordx4 v[200:203], v225, s[80:83], s64 offen offset:384 sc0 sc1
    s_mov_b64 exec, -1
    s_nop 3
    s_branch cs_144_b
cs_145:
    v_add_u32 v225, 28800, v224
    ds_read_b64_tr_b16 v[204:205], v225 offset:0
    ds_read_b64_tr_b16 v[206:207], v225 offset:3584
    ds_read_b64_tr_b16 v[208:209], v225 offset:32
    ds_read_b64_tr_b16 v[210:211], v225 offset:3616
    ds_read_b64_tr_b16 v[212:213], v225 offset:64
    ds_read_b64_tr_b16 v[214:215], v225 offset:3648
    ds_read_b64_tr_b16 v[216:217], v225 offset:96
    ds_read_b64_tr_b16 v[218:219], v225 offset:3680
    s_waitcnt lgkmcnt(0)
    v_mfma_f32_16x16x32_bf16 v[176:179], v[204:207], v[220:223], 0
    v_mfma_f32_16x16x32_bf16 v[180:183], v[208:211], v[220:223], 0
    v_mfma_f32_16x16x32_bf16 v[184:187], v[212:215], v[220:223], 0
    v_mfma_f32_16x16x32_bf16 v[188:191], v[216:219], v[220:223], 0
    s_nop 7
    ds_read_b64_tr_b16 v[204:205], v225 offset:128
    ds_read_b64_tr_b16 v[206:207], v225 offset:3712
    ds_read_b64_tr_b16 v[208:209], v225 offset:160
    ds_read_b64_tr_b16 v[210:211], v225 offset:3744
    ds_read_b64_tr_b16 v[212:213], v225 offset:192
    ds_read_b64_tr_b16 v[214:215], v225 offset:3776
    s_waitcnt lgkmcnt(0)
    v_mfma_f32_16x16x32_bf16 v[192:195], v[204:207], v[220:223], 0
    v_mfma_f32_16x16x32_bf16 v[196:199], v[208:211], v[220:223], 0
    v_mfma_f32_16x16x32_bf16 v[200:203], v[212:215], v[220:223], 0
    s_nop 7
    s_branch cs_145_b
cs_146:
    v_add_u32 v225, 57600, v224
    ds_read_b64_tr_b16 v[204:205], v225 offset:0
    ds_read_b64_tr_b16 v[206:207], v225 offset:3584
    ds_read_b64_tr_b16 v[208:209], v225 offset:32
    ds_read_b64_tr_b16 v[210:211], v225 offset:3616
    ds_read_b64_tr_b16 v[212:213], v225 offset:64
    ds_read_b64_tr_b16 v[214:215], v225 offset:3648
    ds_read_b64_tr_b16 v[216:217], v225 offset:96
    ds_read_b64_tr_b16 v[218:219], v225 offset:3680
    s_waitcnt lgkmcnt(0)
    v_mfma_f32_16x16x32_bf16 v[176:179], v[204:207], v[220:223], v[176:179]
    v_mfma_f32_16x16x32_bf16 v[180:183], v[208:211], v[220:223], v[180:183]
    v_mfma_f32_16x16x32_bf16 v[184:187], v[212:215], v[220:223], v[184:187]
    v_mfma_f32_16x16x32_bf16 v[188:191], v[216:219], v[220:223], v[188:191]
    s_nop 7
    ds_read_b64_tr_b16 v[204:205], v225 offset:128
    ds_read_b64_tr_b16 v[206:207], v225 offset:3712
    ds_read_b64_tr_b16 v[208:209], v225 offset:160
    ds_read_b64_tr_b16 v[210:211], v225 offset:3744
    ds_read_b64_tr_b16 v[212:213], v225 offset:192
    ds_read_b64_tr_b16 v[214:215], v225 offset:3776
    s_waitcnt lgkmcnt(0)
    v_mfma_f32_16x16x32_bf16 v[192:195], v[204:207], v[220:223], v[192:195]
    v_mfma_f32_16x16x32_bf16 v[196:199], v[208:211], v[220:223], v[196:199]
    v_mfma_f32_16x16x32_bf16 v[200:203], v[212:215], v[220:223], v[200:203]
    s_nop 7
    s_lshl_b32 s64, s34, 1
    s_and_b32 s65, s3, 1
    s_add_u32 s64, s64, s65
    s_mul_i32 s64, s64, 14336
    s_mul_i32 s65, s74, 896
    s_add_u32 s64, s64, s65
    s_lshr_b32 s65, s69, 1
    s_mul_i32 s65, s65, 448
    s_add_u32 s64, s64, s65
    s_add_u32 s64, s64, 74448896
    v_lshlrev_b32 v225, 4, v251
    s_mov_b32 exec_lo, 0x00010001
    s_mov_b32 exec_hi, 0x00010001
    buffer_store_dwordx4 v[176:179], v225, s[80:83], s64 offen offset:0 sc0 sc1
    buffer_store_dwordx4 v[180:183], v225, s[80:83], s64 offen offset:64 sc0 sc1
    buffer_store_dwordx4 v[184:187], v225, s[80:83], s64 offen offset:128 sc0 sc1
    buffer_store_dwordx4 v[188:191], v225, s[80:83], s64 offen offset:192 sc0 sc1
    buffer_store_dwordx4 v[192:195], v225, s[80:83], s64 offen offset:256 sc0 sc1
    buffer_store_dwordx4 v[196:199], v225, s[80:83], s64 offen offset:320 sc0 sc1
    buffer_store_dwordx4 v[200:203], v225, s[80:83], s64 offen offset:384 sc0 sc1
    s_mov_b64 exec, -1
    s_nop 3
    s_branch cs_146_b
cs_147:
    v_add_u32 v225, 86400, v224
    ds_read_b64_tr_b16 v[204:205], v225 offset:0
    ds_read_b64_tr_b16 v[206:207], v225 offset:3584
    ds_read_b64_tr_b16 v[208:209], v225 offset:32
    ds_read_b64_tr_b16 v[210:211], v225 offset:3616
    ds_read_b64_tr_b16 v[212:213], v225 offset:64
    ds_read_b64_tr_b16 v[214:215], v225 offset:3648
    ds_read_b64_tr_b16 v[216:217], v225 offset:96
    ds_read_b64_tr_b16 v[218:219], v225 offset:3680
    s_waitcnt lgkmcnt(0)
    v_mfma_f32_16x16x32_bf16 v[176:179], v[204:207], v[220:223], 0
    v_mfma_f32_16x16x32_bf16 v[180:183], v[208:211], v[220:223], 0
    v_mfma_f32_16x16x32_bf16 v[184:187], v[212:215], v[220:223], 0
    v_mfma_f32_16x16x32_bf16 v[188:191], v[216:219], v[220:223], 0
    s_nop 7
    ds_read_b64_tr_b16 v[204:205], v225 offset:128
    ds_read_b64_tr_b16 v[206:207], v225 offset:3712
    ds_read_b64_tr_b16 v[208:209], v225 offset:160
    ds_read_b64_tr_b16 v[210:211], v225 offset:3744
    ds_read_b64_tr_b16 v[212:213], v225 offset:192
    ds_read_b64_tr_b16 v[214:215], v225 offset:3776
    s_waitcnt lgkmcnt(0)
    v_mfma_f32_16x16x32_bf16 v[192:195], v[204:207], v[220:223], 0
    v_mfma_f32_16x16x32_bf16 v[196:199], v[208:211], v[220:223], 0
    v_mfma_f32_16x16x32_bf16 v[200:203], v[212:215], v[220:223], 0
    s_nop 7
    s_branch cs_147_b
cs_148:
    v_add_u32 v225, 0, v224
    ds_read_b64_tr_b16 v[204:205], v225 offset:0
    ds_read_b64_tr_b16 v[206:207], v225 offset:3584
    ds_read_b64_tr_b16 v[208:209], v225 offset:32
    ds_read_b64_tr_b16 v[210:211], v225 offset:3616
    ds_read_b64_tr_b16 v[212:213], v225 offset:64
    ds_read_b64_tr_b16 v[214:215], v225 offset:3648
    ds_read_b64_tr_b16 v[216:217], v225 offset:96
    ds_read_b64_tr_b16 v[218:219], v225 offset:3680
    s_waitcnt lgkmcnt(0)
    v_mfma_f32_16x16x32_bf16 v[176:179], v[204:207], v[220:223], v[176:179]
    v_mfma_f32_16x16x32_bf16 v[180:183], v[208:211], v[220:223], v[180:183]
    v_mfma_f32_16x16x32_bf16 v[184:187], v[212:215], v[220:223], v[184:187]
    v_mfma_f32_16x16x32_bf16 v[188:191], v[216:219], v[220:223], v[188:191]
    s_nop 7
    ds_read_b64_tr_b16 v[204:205], v225 offset:128
    ds_read_b64_tr_b16 v[206:207], v225 offset:3712
    ds_read_b64_tr_b16 v[208:209], v225 offset:160
    ds_read_b64_tr_b16 v[210:211], v225 offset:3744
    ds_read_b64_tr_b16 v[212:213], v225 offset:192
    ds_read_b64_tr_b16 v[214:215], v225 offset:3776
    s_waitcnt lgkmcnt(0)
    v_mfma_f32_16x16x32_bf16 v[192:195], v[204:207], v[220:223], v[192:195]
    v_mfma_f32_16x16x32_bf16 v[196:199], v[208:211], v[220:223], v[196:199]
    v_mfma_f32_16x16x32_bf16 v[200:203], v[212:215], v[220:223], v[200:203]
    s_nop 7
    s_lshl_b32 s64, s34, 1
    s_and_b32 s65, s3, 1
    s_add_u32 s64, s64, s65
    s_mul_i32 s64, s64, 14336
    s_mul_i32 s65, s74, 896
    s_add_u32 s64, s64, s65
    s_lshr_b32 s65, s69, 1
    s_mul_i32 s65, s65, 448
    s_add_u32 s64, s64, s65
    s_add_u32 s64, s64, 74448896
    v_lshlrev_b32 v225, 4, v251
    s_mov_b32 exec_lo, 0x00010001
    s_mov_b32 exec_hi, 0x00010001
    buffer_store_dwordx4 v[176:179], v225, s[80:83], s64 offen offset:0 sc0 sc1
    buffer_store_dwordx4 v[180:183], v225, s[80:83], s64 offen offset:64 sc0 sc1
    buffer_store_dwordx4 v[184:187], v225, s[80:83], s64 offen offset:128 sc0 sc1
    buffer_store_dwordx4 v[188:191], v225, s[80:83], s64 offen offset:192 sc0 sc1
    buffer_store_dwordx4 v[192:195], v225, s[80:83], s64 offen offset:256 sc0 sc1
    buffer_store_dwordx4 v[196:199], v225, s[80:83], s64 offen offset:320 sc0 sc1
    buffer_store_dwordx4 v[200:203], v225, s[80:83], s64 offen offset:384 sc0 sc1
    s_mov_b64 exec, -1
    s_nop 3
    s_branch cs_148_b
cf_649:
    s_lshl_b32 s64, s74, 4
    s_add_u32 s64, s64, s34
    s_lshl_b32 s64, s64, 3
    s_add_u32 s64, s64, s69
    s_lshl_b32 s64, s64, 2
    s_add_u32 s64, s64, 75628544
    v_mov_b32 v216, 0
    v_mov_b32 v217, 1
    s_mov_b64 exec, 1
    buffer_store_dword v217, v216, s[80:83], s64 offen sc0 sc1
    s_mov_b64 exec, -1
    s_branch cf_649_b
g3c1_hook:
    s_cmp_lt_u32 s24, 3
    s_cbranch_scc1 g3c1_h2
    s_mov_b32 s12, s96
    s_mov_b32 s13, s97
    s_mov_b32 s14, 7340032
    s_mov_b32 s15, 0x00020000
    s_lshl_b32 s64, s2, 2
    s_add_u32 s64, s64, s69
    s_mul_i32 s64, s64, 7168
    v_lshlrev_b32 v247, 7, v250
    s_mov_b32 exec_hi, 0x00ffffff
    buffer_load_dword v248, v247, s[12:15], s64 offen
    s_mov_b64 exec, -1
    s_branch g3c1_hb
g3c1_h2:
    s_lshl_b32 s64, s74, 9
    s_add_u32 s64, s64, 75628544
    v_lshlrev_b32 v225, 5, v252
    s_cmp_eq_u32 s24, 1
    s_cbranch_scc1 g3c1_h1
    buffer_load_dwordx4 v[216:219], v225, s[80:83], s64 offen sc1
    s_branch g3c1_hb
g3c1_h1:
    v_and_b32 v216, v216, v217
    v_and_b32 v218, v218, v219
    v_and_b32 v216, v216, v218
    v_cmp_ne_u32 vcc, 1, v216
    s_cbranch_vccz g3c1_h1b
    s_mov_b64 exec, 0xffff
pl_1650:
    buffer_load_dwordx4 v[216:219], v225, s[80:83], s64 offen sc1
    s_sub_u32 s79, s79, 1
    s_cbranch_scc1 L_abort
    s_waitcnt vmcnt(0)
    v_and_b32 v216, v216, v217
    v_and_b32 v218, v218, v219
    v_and_b32 v216, v216, v218
    v_cmp_ne_u32 vcc, 1, v216
    s_cbranch_vccnz pl_1650
    s_mov_b64 exec, -1
g3c1_h1b:
    s_and_b32 s64, s3, 1
    s_mul_i32 s64, s64, 14336
    s_mul_i32 s65, s74, 896
    s_add_u32 s64, s64, s65
    s_lshr_b32 s65, s69, 1
    s_mul_i32 s65, s65, 448
    s_add_u32 s64, s64, s65
    s_add_u32 s64, s64, 74448896
    v_and_b32 v225, 31, v250
    v_lshlrev_b32 v225, 4, v225
    v_lshrrev_b32 v253, 5, v250
    v_mul_u32_u24 v253, 229376, v253
    v_add_u32 v225, v253, v225
    s_mov_b32 exec_lo, 0x0fffffff
    s_mov_b32 exec_hi, 0x0fffffff
    buffer_load_dwordx4 v[176:179], v225, s[80:83], s64 offen sc1
    s_add_u32 s64, s64, 28672
    buffer_load_dwordx4 v[180:183], v225, s[80:83], s64 offen sc1
    s_add_u32 s64, s64, 28672
    buffer_load_dwordx4 v[184:187], v225, s[80:83], s64 offen sc1
    s_add_u32 s64, s64, 28672
    buffer_load_dwordx4 v[188:191], v225, s[80:83], s64 offen sc1
    s_add_u32 s64, s64, 28672
    buffer_load_dwordx4 v[192:195], v225, s[80:83], s64 offen sc1
    s_add_u32 s64, s64, 28672
    buffer_load_dwordx4 v[196:199], v225, s[80:83], s64 offen sc1
    s_add_u32 s64, s64, 28672
    buffer_load_dwordx4 v[200:203], v225, s[80:83], s64 offen sc1
    s_add_u32 s64, s64, 28672
    buffer_load_dwordx4 v[204:207], v225, s[80:83], s64 offen sc1
    s_add_u32 s64, s64, 28672
    s_mov_b64 exec, -1
    s_branch g3c1_hb
sg_2651_slow:
    s_waitcnt vmcnt(0)
    buffer_wbl2 sc1
    s_waitcnt vmcnt(0)
    s_mov_b64 exec, 1
    buffer_store_dword v145, v144, s[80:83], s64 offen sc0 sc1
    s_mov_b64 exec, -1
    s_branch sg_2651_done
pl_2652_acq:
    buffer_inv sc1
    s_waitcnt vmcnt(0)
    s_branch pl_2652_ok
pl_2653_acq:
    buffer_inv sc1
    s_waitcnt vmcnt(0)
    s_branch pl_2653_ok
pl_2655_acq:
    buffer_inv sc1
    s_waitcnt vmcnt(0)
    s_branch pl_2655_ok
L_fin:
L_abort:
L_end:
    s_endpgm
.section .rodata,"a"
.p2align 6
.amdhsa_kernel interleave_layers__sliding_local_dilated__glu_gated_swiglu__prompt_kernel
  .amdhsa_next_free_vgpr 256
  .amdhsa_next_free_sgpr 102
  .amdhsa_accum_offset 256
  .amdhsa_group_segment_fixed_size 0
  .amdhsa_kernarg_size 80
  .amdhsa_user_sgpr_count 2
  .amdhsa_user_sgpr_kernarg_segment_ptr 1
  .amdhsa_system_sgpr_workgroup_id_x 1
.end_amdhsa_kernel
```

```asm
; @launch grid=(256,1,1) block=(512,1,1) lds=163840
.amdgcn_target "amdgcn-amd-amdhsa--gfx950"
.text
.globl interleave_layers__sliding_local_dilated__glu_gated_swiglu__prompt_kernel
.p2align 8
.type interleave_layers__sliding_local_dilated__glu_gated_swiglu__prompt_kernel,@function
interleave_layers__sliding_local_dilated__glu_gated_swiglu__prompt_kernel:
    s_cmp_ge_u32 s2, 256
    s_cbranch_scc1 L_end
    s_load_dwordx4 s[84:87], s[0:1], 0
    s_load_dwordx2 s[4:5], s[0:1], 72
    s_load_dwordx2 s[88:89], s[0:1], 16
    s_load_dwordx4 s[92:95], s[0:1], 32
    s_load_dwordx4 s[96:99], s[0:1], 48
    s_load_dwordx2 s[90:91], s[0:1], 64
    v_lshrrev_b32 v1, 6, v0
    v_and_b32 v250, 63, v0
    v_readfirstlane_b32 s3, v1
    v_lshrrev_b32 v251, 4, v250
    v_and_b32 v252, 15, v250
    v_lshlrev_b32 v249, 4, v250
    s_and_b32 s70, s2, 7
    s_lshr_b32 s72, s2, 4
    s_lshr_b32 s71, s2, 3
    s_and_b32 s71, s71, 1
    s_lshl_b32 s73, s70, 1
    s_add_u32 s73, s73, s71
    s_and_b32 s68, s72, 1
    s_lshl_b32 s67, s68, 1
    s_xor_b32 s67, s67, s73
    s_and_b32 s64, s70, 1
    s_lshl_b32 s64, s64, 3
    s_lshr_b32 s74, s72, 1
    s_add_u32 s74, s74, s64
    s_and_b32 s58, s70, 6
    s_lshl_b32 s57, s58, 1
    s_sub_u32 s61, s74, s58
    s_add_u32 s61, s61, 3
    s_and_b32 s61, s61, 7
    s_mov_b32 s60, 0
    s_mov_b32 s59, 1
    s_and_b32 s69, s3, 3
    s_mov_b32 s75, 0
    s_mov_b32 s78, 1
    s_mov_b32 s79, 4194304
    s_waitcnt lgkmcnt(0)
    s_mov_b32 s80, s4
    s_mov_b32 s81, s5
    s_mov_b32 s82, 79691776
    s_mov_b32 s83, 0x00020000
    s_cmp_ge_u32 s3, 4
    s_cbranch_scc1 L_load
    s_mul_i32 s64, s3, 18432
    v_add_u32 v8, s64, v249
    v_mov_b32 v4, 0x3f803f80
    v_mov_b32 v5, 0x3f803f80
    v_mov_b32 v6, 0x3f803f80
    v_mov_b32 v7, 0x3f803f80
    s_mov_b64 exec, 0xff
    ds_write_b128 v8, v[4:7]
    s_mov_b64 exec, -1
    v_mov_b32 v0, 0
    s_mov_b32 s8, s84
    s_mov_b32 s9, s85
    s_mov_b32 s10, 4194304
    s_mov_b32 s11, 0x00020000
    s_lshl_b32 s16, s72, 2
    s_add_u32 s16, s16, s3
    s_lshl_b32 s16, s16, 1
    s_lshl_b32 s17, s73, 7
    s_add_u32 s18, s17, s16
    s_lshl_b32 s18, s18, 11
    s_add_u32 s19, s17, s72
    s_sub_u32 s19, s19, 16
    s_lshl_b32 s19, s19, 11
    s_cmp_eq_u32 s73, 0
    s_cselect_b32 s19, 0x7f000000, s19
    s_cmp_lg_u32 s3, 0
    s_cselect_b32 s19, 0x7f000000, s19
    buffer_load_dwordx4 v[16:19], v249, s[8:11], s18 offen offset:0
    buffer_load_dwordx4 v[20:23], v249, s[8:11], s18 offen offset:1024
    buffer_load_dwordx4 v[24:27], v249, s[8:11], s18 offen offset:2048
    buffer_load_dwordx4 v[28:31], v249, s[8:11], s18 offen offset:3072
    v_mov_b32 v32, 0
    v_mov_b32 v33, 0
    v_mov_b32 v34, 0
    v_mov_b32 v35, 0
    v_mov_b32 v36, 0
    v_mov_b32 v37, 0
    v_mov_b32 v38, 0
    v_mov_b32 v39, 0
    s_cbranch_scc1 xs_1
    buffer_load_dwordx4 v[32:35], v249, s[8:11], s19 offen offset:0
    buffer_load_dwordx4 v[36:39], v249, s[8:11], s19 offen offset:1024
xs_1:
    v_mov_b32 v56, 0x3f803f80
    s_waitcnt vmcnt(0)
    v_dot2_f32_bf16 v48, v16, v56, 0
    v_dot2_f32_bf16 v49, v16, v16, 0
    v_dot2_f32_bf16 v48, v17, v56, v48
    v_dot2_f32_bf16 v49, v17, v17, v49
    v_dot2_f32_bf16 v48, v18, v56, v48
    v_dot2_f32_bf16 v49, v18, v18, v49
    v_dot2_f32_bf16 v48, v19, v56, v48
    v_dot2_f32_bf16 v49, v19, v19, v49
    v_dot2_f32_bf16 v48, v20, v56, v48
    v_dot2_f32_bf16 v49, v20, v20, v49
    v_dot2_f32_bf16 v48, v21, v56, v48
    v_dot2_f32_bf16 v49, v21, v21, v49
    v_dot2_f32_bf16 v48, v22, v56, v48
    v_dot2_f32_bf16 v49, v22, v22, v49
    v_dot2_f32_bf16 v48, v23, v56, v48
    v_dot2_f32_bf16 v49, v23, v23, v49
    v_dot2_f32_bf16 v50, v24, v56, 0
    v_dot2_f32_bf16 v51, v24, v24, 0
    v_dot2_f32_bf16 v50, v25, v56, v50
    v_dot2_f32_bf16 v51, v25, v25, v51
    v_dot2_f32_bf16 v50, v26, v56, v50
    v_dot2_f32_bf16 v51, v26, v26, v51
    v_dot2_f32_bf16 v50, v27, v56, v50
    v_dot2_f32_bf16 v51, v27, v27, v51
    v_dot2_f32_bf16 v50, v28, v56, v50
    v_dot2_f32_bf16 v51, v28, v28, v51
    v_dot2_f32_bf16 v50, v29, v56, v50
    v_dot2_f32_bf16 v51, v29, v29, v51
    v_dot2_f32_bf16 v50, v30, v56, v50
    v_dot2_f32_bf16 v51, v30, v30, v51
    v_dot2_f32_bf16 v50, v31, v56, v50
    v_dot2_f32_bf16 v51, v31, v31, v51
    v_dot2_f32_bf16 v52, v32, v56, 0
    v_dot2_f32_bf16 v53, v32, v32, 0
    v_dot2_f32_bf16 v52, v33, v56, v52
    v_dot2_f32_bf16 v53, v33, v33, v53
    v_dot2_f32_bf16 v52, v34, v56, v52
    v_dot2_f32_bf16 v53, v34, v34, v53
    v_dot2_f32_bf16 v52, v35, v56, v52
    v_dot2_f32_bf16 v53, v35, v35, v53
    v_dot2_f32_bf16 v52, v36, v56, v52
    v_dot2_f32_bf16 v53, v36, v36, v53
    v_dot2_f32_bf16 v52, v37, v56, v52
    v_dot2_f32_bf16 v53, v37, v37, v53
    v_dot2_f32_bf16 v52, v38, v56, v52
    v_dot2_f32_bf16 v53, v38, v38, v53
    v_dot2_f32_bf16 v52, v39, v56, v52
    v_dot2_f32_bf16 v53, v39, v39, v53
    s_nop 2
    v_add_f32_dpp v48, v48, v48 quad_perm:[1,0,3,2] row_mask:0xf bank_mask:0xf
    v_add_f32_dpp v49, v49, v49 quad_perm:[1,0,3,2] row_mask:0xf bank_mask:0xf
    v_add_f32_dpp v50, v50, v50 quad_perm:[1,0,3,2] row_mask:0xf bank_mask:0xf
    v_add_f32_dpp v51, v51, v51 quad_perm:[1,0,3,2] row_mask:0xf bank_mask:0xf
    v_add_f32_dpp v52, v52, v52 quad_perm:[1,0,3,2] row_mask:0xf bank_mask:0xf
    v_add_f32_dpp v53, v53, v53 quad_perm:[1,0,3,2] row_mask:0xf bank_mask:0xf
    v_add_f32_dpp v48, v48, v48 quad_perm:[2,3,0,1] row_mask:0xf bank_mask:0xf
    v_add_f32_dpp v49, v49, v49 quad_perm:[2,3,0,1] row_mask:0xf bank_mask:0xf
    v_add_f32_dpp v50, v50, v50 quad_perm:[2,3,0,1] row_mask:0xf bank_mask:0xf
    v_add_f32_dpp v51, v51, v51 quad_perm:[2,3,0,1] row_mask:0xf bank_mask:0xf
    v_add_f32_dpp v52, v52, v52 quad_perm:[2,3,0,1] row_mask:0xf bank_mask:0xf
    v_add_f32_dpp v53, v53, v53 quad_perm:[2,3,0,1] row_mask:0xf bank_mask:0xf
    v_add_f32_dpp v48, v48, v48 row_half_mirror row_mask:0xf bank_mask:0xf
    v_add_f32_dpp v49, v49, v49 row_half_mirror row_mask:0xf bank_mask:0xf
    v_add_f32_dpp v50, v50, v50 row_half_mirror row_mask:0xf bank_mask:0xf
    v_add_f32_dpp v51, v51, v51 row_half_mirror row_mask:0xf bank_mask:0xf
    v_add_f32_dpp v52, v52, v52 row_half_mirror row_mask:0xf bank_mask:0xf
    v_add_f32_dpp v53, v53, v53 row_half_mirror row_mask:0xf bank_mask:0xf
    v_add_f32_dpp v48, v48, v48 row_mirror row_mask:0xf bank_mask:0xf
    v_add_f32_dpp v49, v49, v49 row_mirror row_mask:0xf bank_mask:0xf
    v_add_f32_dpp v50, v50, v50 row_mirror row_mask:0xf bank_mask:0xf
    v_add_f32_dpp v51, v51, v51 row_mirror row_mask:0xf bank_mask:0xf
    v_add_f32_dpp v52, v52, v52 row_mirror row_mask:0xf bank_mask:0xf
    v_add_f32_dpp v53, v53, v53 row_mirror row_mask:0xf bank_mask:0xf
    v_mov_b32 v16, v48
    v_mov_b32 v17, v49
    v_mov_b32 v18, v50
    v_mov_b32 v19, v51
    v_mov_b32 v20, v52
    v_mov_b32 v21, v53
    s_nop 1
    v_permlane16_swap_b32 v48, v16
    v_permlane16_swap_b32 v49, v17
    v_permlane16_swap_b32 v50, v18
    v_permlane16_swap_b32 v51, v19
    v_permlane16_swap_b32 v52, v20
    v_permlane16_swap_b32 v53, v21
    v_add_f32 v48, v48, v16
    v_add_f32 v49, v49, v17
    v_add_f32 v50, v50, v18
    v_add_f32 v51, v51, v19
    v_add_f32 v52, v52, v20
    v_add_f32 v53, v53, v21
    v_mov_b32 v16, v48
    v_mov_b32 v17, v49
    v_mov_b32 v18, v50
    v_mov_b32 v19, v51
    v_mov_b32 v20, v52
    v_mov_b32 v21, v53
    s_nop 1
    v_permlane32_swap_b32 v48, v16
    v_permlane32_swap_b32 v49, v17
    v_permlane32_swap_b32 v50, v18
    v_permlane32_swap_b32 v51, v19
    v_permlane32_swap_b32 v52, v20
    v_permlane32_swap_b32 v53, v21
    v_add_f32 v48, v48, v16
    v_add_f32 v49, v49, v17
    v_add_f32 v50, v50, v18
    v_add_f32 v51, v51, v19
    v_add_f32 v52, v52, v20
    v_add_f32 v53, v53, v21
    v_cmp_eq_u32 vcc, 1, v250
    s_nop 1
    v_cndmask_b32 v48, v48, v50, vcc
    v_cndmask_b32 v49, v49, v51, vcc
    v_cmp_eq_u32 vcc, 2, v250
    s_nop 1
    v_cndmask_b32 v48, v48, v52, vcc
    v_cndmask_b32 v49, v49, v53, vcc
    v_mul_f32 v48, 0x3a800000, v48
    v_mul_f32 v49, 0x3a800000, v49
    v_fma_f32 v49, -v48, v48, v49
    v_max_f32 v49, 0, v49
    v_cvt_pk_bf16_f32 v48, v48, v48
    v_lshlrev_b32 v48, 16, v48
    v_cvt_pk_bf16_f32 v49, v49, v49
    v_lshlrev_b32 v49, 16, v49
    v_add_f32 v49, 0x3727c5ac, v49
    v_cvt_pk_bf16_f32 v49, v49, v49
    v_lshlrev_b32 v49, 16, v49
    v_sqrt_f32 v49, v49
    s_nop 0
    v_cvt_pk_bf16_f32 v49, v49, v49
    v_lshlrev_b32 v49, 16, v49
    v_rcp_f32 v49, v49
    s_nop 0
    v_lshlrev_b32 v16, 3, v250
    s_lshl_b32 s17, s73, 12
    s_lshl_b32 s16, s16, 5
    s_add_u32 s17, s17, s16
    s_add_u32 s17, s17, 74186752
    s_mov_b64 exec, 0xff
    buffer_store_dwordx2 v[48:49], v16, s[80:83], s17 offen sc0 sc1
    s_mov_b64 exec, -1
    s_cmp_lg_u32 s3, 3
    s_cbranch_scc1 L_noinit
    v_mov_b32 v0, 0
    v_mov_b32 v1, 0
    v_mov_b32 v2, 0
    v_mov_b32 v3, 0
    s_lshl_b32 s64, s2, 10
    s_add_u32 s64, s64, 75628544
    buffer_store_dwordx4 v[0:3], v249, s[80:83], s64 offen sc0 sc1
    s_mul_i32 s64, s2, 384
    s_add_u32 s64, s64, 75497472
    s_mov_b64 exec, 0xffffff
    buffer_store_dwordx4 v[0:3], v249, s[80:83], s64 offen sc0 sc1
    s_mov_b64 exec, -1
L_noinit:
    s_waitcnt lgkmcnt(0)
C_layer:
    s_and_b32 s19, s3, 1
    s_lshr_b32 s20, s3, 1
    s_cmp_lg_u32 s75, 0
    s_cbranch_scc1 ad_2_f
    v_lshlrev_b32 v253, 7, v252
    v_and_b32 v254, 6, v250
    v_xor_b32 v254, v254, v251
    v_lshl_add_u32 v204, v254, 4, v253
    v_xor_b32 v205, 64, v204
    s_branch ad_2_d
ad_2_f:
    v_mov_b32 v204, v249
    v_add_u32 v205, 1024, v249
ad_2_d:
    v_lshrrev_b32 v253, 2, v252
    v_mul_u32_u24 v253, 3104, v253
    v_lshl_add_u32 v253, v251, 7, v253
    v_and_b32 v254, 3, v252
    v_lshl_add_u32 v253, v254, 3, v253
    s_lshl_b32 s64, s19, 6
    s_add_u32 s64, s64, 73984
    v_add_u32 v208, s64, v253
    v_mov_b32 v209, v208
    s_mov_b32 s16, 0
    s_mov_b32 s17, 18432
    v_add_u32 v206, s17, v204
    v_add_u32 v207, s17, v205
    s_lshl_b32 s21, s67, 4
    s_add_u32 s21, s21, s74
    s_lshl_b32 s21, s21, 1
    s_add_u32 s21, s21, s19
    s_lshl_b32 s21, s21, 1
    s_add_u32 s21, s21, s20
    s_lshl_b32 s21, s21, 12
    s_lshl_b32 s64, s75, 22
    s_add_u32 s21, s21, s64
    s_add_u32 s21, s21, 12582912
    v_and_b32 v254, 1, v252
    v_cmp_eq_u32 s[28:29], 1, v254
    v_lshlrev_b32 v253, 2, v251
    v_sub_u32 v253, v252, v253
    v_sub_u32 v253, v253, v254
    v_lshlrev_b32 v254, 4, v254
    v_mov_b32 v210, 0xffff
    v_lshlrev_b32 v210, v254, v210
    v_cmp_le_i32 s[30:31], 0, v253
    v_cmp_le_i32 s[32:33], 2, v253
    s_or_b32 s22, s67, s20
    s_cmp_eq_u32 s22, 0
    s_cselect_b64 s[34:35], s[30:31], -1
    s_cselect_b64 s[36:37], s[32:33], -1
    v_cndmask_b32 v232, v210, 0, s[30:31]
    v_cndmask_b32 v234, 0, v210, s[30:31]
    v_cndmask_b32 v233, v210, 0, s[32:33]
    v_cndmask_b32 v235, 0, v210, s[32:33]
    s_mov_b32 s23, 0x3e8293ee
    s_mul_i32 s64, s19, 6144
    s_add_u32 s64, s64, 18432
    v_add_u32 v236, s64, v249
    s_mul_i32 s64, s19, 384
    s_add_u32 s64, s64, 162688
    v_lshlrev_b32 v237, 4, v251
    v_add_u32 v237, s64, v237
    v_lshlrev_b32 v238, 2, v252
    v_add_u32 v238, s64, v238
    s_lshl_b32 s64, s20, 9
    s_add_u32 s64, s64, 159744
    v_lshlrev_b32 v239, 3, v252
    v_add_u32 v239, s64, v239
    v_lshlrev_b32 v240, 5, v251
    v_add_u32 v240, s64, v240
    v_mov_b32 v241, 163456
    v_mov_b32 v212, 0
    v_mov_b32 v213, 0
    v_mov_b32 v214, 0
    v_mov_b32 v215, 0
    s_mov_b32 s18, 16
    s_nop 0
    v_mfma_f32_32x32x16_bf16 v[0:15], v[212:215], v[212:215], 0
    v_mfma_f32_32x32x16_bf16 v[16:31], v[212:215], v[212:215], 0
    v_mfma_f32_32x32x16_bf16 v[32:47], v[212:215], v[212:215], 0
    v_mfma_f32_32x32x16_bf16 v[48:63], v[212:215], v[212:215], 0
    v_mfma_f32_32x32x16_bf16 v[64:79], v[212:215], v[212:215], 0
    v_mfma_f32_32x32x16_bf16 v[80:95], v[212:215], v[212:215], 0
    v_mfma_f32_32x32x16_bf16 v[96:111], v[212:215], v[212:215], 0
    v_mfma_f32_32x32x16_bf16 v[112:127], v[212:215], v[212:215], 0
    s_nop 7
    s_nop 3
    s_cmp_eq_u32 s20, 1
    s_cbranch_scc1 g1c_r1
    s_barrier
    ds_read_b128 v[116:119], v206 offset:0
    ds_read_b64_tr_b16 v[164:165], v209 offset:13440
    ds_read_b64_tr_b16 v[166:167], v209 offset:13952
    ds_read_b128 v[120:123], v206 offset:2048
    ds_read_b64_tr_b16 v[168:169], v209 offset:13472
    ds_read_b64_tr_b16 v[170:171], v209 offset:13984
    ds_read_b128 v[124:127], v206 offset:4096
    ds_read_b64_tr_b16 v[172:173], v209 offset:14464
    ds_read_b64_tr_b16 v[174:175], v209 offset:14976
    ds_read_b128 v[128:131], v206 offset:6144
    ds_read_b64_tr_b16 v[176:177], v209 offset:14496
    ds_read_b64_tr_b16 v[178:179], v209 offset:15008
    ds_read_b128 v[132:135], v206 offset:8192
    ds_read_b64_tr_b16 v[156:157], v209 offset:12416
    ds_read_b64_tr_b16 v[158:159], v209 offset:12928
    ds_read_b64_tr_b16 v[160:161], v209 offset:12448
    ds_read_b64_tr_b16 v[162:163], v209 offset:12960
    s_add_u32 s16, s16, 24832
    s_cmp_eq_u32 s16, 74496
    s_cselect_b32 s16, 0, s16
    v_add_u32 v209, s16, v208
    s_waitcnt lgkmcnt(0)
g1c_loop0:
    s_barrier
    v_mfma_f32_16x16x32_bf16 v[104:107], v[132:135], v[172:175], v[104:107]
    ds_read_b128 v[136:139], v207 offset:0
    v_mfma_f32_16x16x32_bf16 v[96:99], v[128:131], v[172:175], v[96:99]
    ds_read_b64_tr_b16 v[188:189], v209 offset:1024
    v_mfma_f32_16x16x32_bf16 v[88:91], v[124:127], v[172:175], v[88:91]
    ds_read_b64_tr_b16 v[190:191], v209 offset:1536
    v_mfma_f32_16x16x32_bf16 v[80:83], v[120:123], v[172:175], v[80:83]
    ds_read_b128 v[140:143], v207 offset:2048
    v_mfma_f32_16x16x32_bf16 v[84:87], v[120:123], v[176:179], v[84:87]
    ds_read_b64_tr_b16 v[192:193], v209 offset:1056
    v_mfma_f32_16x16x32_bf16 v[92:95], v[124:127], v[176:179], v[92:95]
    ds_read_b64_tr_b16 v[194:195], v209 offset:1568
    v_mfma_f32_16x16x32_bf16 v[100:103], v[128:131], v[176:179], v[100:103]
    ds_read_b128 v[144:147], v207 offset:4096
    v_mfma_f32_16x16x32_bf16 v[108:111], v[132:135], v[176:179], v[108:111]
    ds_read_b64_tr_b16 v[196:197], v209 offset:2048
    v_mfma_f32_16x16x32_bf16 v[112:115], v[156:159], v[116:119], v[112:115]
    ds_read_b64_tr_b16 v[198:199], v209 offset:2560
    v_mfma_f32_16x16x32_bf16 v[36:39], v[168:171], v[116:119], v[36:39]
    ds_read_b128 v[148:151], v207 offset:6144
    v_mfma_f32_16x16x32_bf16 v[32:35], v[164:167], v[116:119], v[32:35]
    ds_read_b64_tr_b16 v[200:201], v209 offset:2080
    v_mfma_f32_16x16x32_bf16 v[64:67], v[164:167], v[132:135], v[64:67]
    ds_read_b64_tr_b16 v[202:203], v209 offset:2592
    v_mfma_f32_16x16x32_bf16 v[56:59], v[164:167], v[128:131], v[56:59]
    ds_read_b128 v[152:155], v207 offset:8192
    v_mfma_f32_16x16x32_bf16 v[48:51], v[164:167], v[124:127], v[48:51]
    ds_read_b64_tr_b16 v[180:181], v209 offset:0
    v_mfma_f32_16x16x32_bf16 v[40:43], v[164:167], v[120:123], v[40:43]
    ds_read_b64_tr_b16 v[182:183], v209 offset:512
    v_mfma_f32_16x16x32_bf16 v[44:47], v[168:171], v[120:123], v[44:47]
    ds_read_b64_tr_b16 v[184:185], v209 offset:32
    v_mfma_f32_16x16x32_bf16 v[52:55], v[168:171], v[124:127], v[52:55]
    ds_read_b64_tr_b16 v[186:187], v209 offset:544
    v_mfma_f32_16x16x32_bf16 v[60:63], v[168:171], v[128:131], v[60:63]
    v_mfma_f32_16x16x32_bf16 v[68:71], v[168:171], v[132:135], v[68:71]
    s_add_u32 s17, s17, 18432
    s_cmp_eq_u32 s17, 73728
    v_mfma_f32_16x16x32_bf16 v[24:27], v[156:159], v[132:135], v[24:27]
    v_mfma_f32_16x16x32_bf16 v[16:19], v[156:159], v[128:131], v[16:19]
    s_cselect_b32 s17, 0, s17
    v_mfma_f32_16x16x32_bf16 v[8:11], v[156:159], v[124:127], v[8:11]
    v_mfma_f32_16x16x32_bf16 v[0:3], v[156:159], v[120:123], v[0:3]
    v_add_u32 v206, s17, v204
    v_mfma_f32_16x16x32_bf16 v[4:7], v[160:163], v[120:123], v[4:7]
    v_mfma_f32_16x16x32_bf16 v[12:15], v[160:163], v[124:127], v[12:15]
    v_add_u32 v207, s17, v205
    v_mfma_f32_16x16x32_bf16 v[20:23], v[160:163], v[128:131], v[20:23]
    v_mfma_f32_16x16x32_bf16 v[28:31], v[160:163], v[132:135], v[28:31]
    s_waitcnt lgkmcnt(0)
    v_mfma_f32_16x16x32_bf16 v[104:107], v[152:155], v[196:199], v[104:107]
    ds_read_b128 v[116:119], v206 offset:0
    v_mfma_f32_16x16x32_bf16 v[96:99], v[148:151], v[196:199], v[96:99]
    ds_read_b64_tr_b16 v[164:165], v209 offset:13440
    v_mfma_f32_16x16x32_bf16 v[88:91], v[144:147], v[196:199], v[88:91]
    ds_read_b64_tr_b16 v[166:167], v209 offset:13952
    v_mfma_f32_16x16x32_bf16 v[80:83], v[140:143], v[196:199], v[80:83]
    ds_read_b128 v[120:123], v206 offset:2048
    v_mfma_f32_16x16x32_bf16 v[84:87], v[140:143], v[200:203], v[84:87]
    ds_read_b64_tr_b16 v[168:169], v209 offset:13472
    v_mfma_f32_16x16x32_bf16 v[92:95], v[144:147], v[200:203], v[92:95]
    ds_read_b64_tr_b16 v[170:171], v209 offset:13984
    v_mfma_f32_16x16x32_bf16 v[100:103], v[148:151], v[200:203], v[100:103]
    ds_read_b128 v[124:127], v206 offset:4096
    v_mfma_f32_16x16x32_bf16 v[108:111], v[152:155], v[200:203], v[108:111]
    ds_read_b64_tr_b16 v[172:173], v209 offset:14464
    v_mfma_f32_16x16x32_bf16 v[112:115], v[180:183], v[136:139], v[112:115]
    ds_read_b64_tr_b16 v[174:175], v209 offset:14976
    v_mfma_f32_16x16x32_bf16 v[36:39], v[192:195], v[136:139], v[36:39]
    ds_read_b128 v[128:131], v206 offset:6144
    v_mfma_f32_16x16x32_bf16 v[32:35], v[188:191], v[136:139], v[32:35]
    ds_read_b64_tr_b16 v[176:177], v209 offset:14496
    v_mfma_f32_16x16x32_bf16 v[64:67], v[188:191], v[152:155], v[64:67]
    ds_read_b64_tr_b16 v[178:179], v209 offset:15008
    v_mfma_f32_16x16x32_bf16 v[56:59], v[188:191], v[148:151], v[56:59]
    ds_read_b128 v[132:135], v206 offset:8192
    v_mfma_f32_16x16x32_bf16 v[48:51], v[188:191], v[144:147], v[48:51]
    ds_read_b64_tr_b16 v[156:157], v209 offset:12416
    v_mfma_f32_16x16x32_bf16 v[40:43], v[188:191], v[140:143], v[40:43]
    ds_read_b64_tr_b16 v[158:159], v209 offset:12928
    v_mfma_f32_16x16x32_bf16 v[44:47], v[192:195], v[140:143], v[44:47]
    ds_read_b64_tr_b16 v[160:161], v209 offset:12448
    v_mfma_f32_16x16x32_bf16 v[52:55], v[192:195], v[144:147], v[52:55]
    ds_read_b64_tr_b16 v[162:163], v209 offset:12960
    v_mfma_f32_16x16x32_bf16 v[60:63], v[192:195], v[148:151], v[60:63]
    v_mfma_f32_16x16x32_bf16 v[68:71], v[192:195], v[152:155], v[68:71]
    s_add_u32 s16, s16, 24832
    s_cmp_eq_u32 s16, 74496
    v_mfma_f32_16x16x32_bf16 v[24:27], v[180:183], v[152:155], v[24:27]
    v_mfma_f32_16x16x32_bf16 v[16:19], v[180:183], v[148:151], v[16:19]
    s_cselect_b32 s16, 0, s16
    v_mfma_f32_16x16x32_bf16 v[8:11], v[180:183], v[144:147], v[8:11]
    v_mfma_f32_16x16x32_bf16 v[0:3], v[180:183], v[140:143], v[0:3]
    v_add_u32 v209, s16, v208
    v_mfma_f32_16x16x32_bf16 v[4:7], v[184:187], v[140:143], v[4:7]
    v_mfma_f32_16x16x32_bf16 v[12:15], v[184:187], v[144:147], v[12:15]
    s_sub_u32 s18, s18, 1
    s_cmp_lg_u32 s18, 0
    v_mfma_f32_16x16x32_bf16 v[20:23], v[184:187], v[148:151], v[20:23]
    v_mfma_f32_16x16x32_bf16 v[28:31], v[184:187], v[152:155], v[28:31]
    s_waitcnt vmcnt(0) lgkmcnt(0)
    s_cbranch_scc1 g1c_loop0
    ds_write_b128 v236, v[64:67] offset:0
    ds_write_b128 v236, v[68:71] offset:1024
    ds_write_b128 v236, v[104:107] offset:2048
    ds_write_b128 v236, v[108:111] offset:3072
    s_mov_b32 exec_lo, 0x00010001
    s_mov_b32 exec_hi, 0x00010001
    ds_write_b128 v237, v[112:115]
    ds_write_b128 v237, v[32:35] offset:128
    ds_write_b128 v237, v[36:39] offset:192
    s_mov_b64 exec, -1
    s_waitcnt lgkmcnt(0)
    s_barrier
    ds_read_b128 v[116:119], v237 offset:0
    ds_read_b128 v[120:123], v237 offset:64
    ds_read_b128 v[124:127], v237 offset:128
    ds_read_b128 v[128:131], v237 offset:192
    ds_read2_b32 v[136:137], v239 offset0:32 offset1:32
    ds_read2_b32 v[138:139], v239 offset0:33 offset1:33
    ds_read2_b32 v[140:141], v239 offset0:64 offset1:64
    ds_read2_b32 v[142:143], v239 offset0:65 offset1:65
    ds_read2_b32 v[144:145], v239 offset0:96 offset1:96
    ds_read2_b32 v[146:147], v239 offset0:97 offset1:97
    ds_read2_b32 v[148:149], v239 offset0:128 offset1:128
    ds_read2_b32 v[150:151], v239 offset0:129 offset1:129
    ds_read2_b32 v[132:133], v239 offset0:0 offset1:0
    ds_read2_b32 v[134:135], v239 offset0:1 offset1:1
    s_waitcnt lgkmcnt(2)
    ds_read_b128 v[72:75], v236 offset:4096
    ds_read_b128 v[76:79], v236 offset:5120
    s_branch g1c_epi
g1c_r1:
    s_barrier
    ds_read_b128 v[116:119], v206 offset:0
    ds_read_b64_tr_b16 v[164:165], v209 offset:13440
    ds_read_b64_tr_b16 v[166:167], v209 offset:13952
    ds_read_b128 v[120:123], v206 offset:10240
    ds_read_b64_tr_b16 v[168:169], v209 offset:13472
    ds_read_b64_tr_b16 v[170:171], v209 offset:13984
    ds_read_b128 v[124:127], v206 offset:12288
    ds_read_b64_tr_b16 v[172:173], v209 offset:14464
    ds_read_b64_tr_b16 v[174:175], v209 offset:14976
    ds_read_b128 v[128:131], v206 offset:14336
    ds_read_b64_tr_b16 v[176:177], v209 offset:14496
    ds_read_b64_tr_b16 v[178:179], v209 offset:15008
    ds_read_b128 v[132:135], v206 offset:16384
    ds_read_b64_tr_b16 v[156:157], v209 offset:12416
    ds_read_b64_tr_b16 v[158:159], v209 offset:12928
    ds_read_b64_tr_b16 v[160:161], v209 offset:12448
    ds_read_b64_tr_b16 v[162:163], v209 offset:12960
    s_add_u32 s16, s16, 24832
    s_cmp_eq_u32 s16, 74496
    s_cselect_b32 s16, 0, s16
    v_add_u32 v209, s16, v208
    s_waitcnt lgkmcnt(0)
g1c_loop1:
    s_barrier
    v_mfma_f32_16x16x32_bf16 v[112:115], v[160:163], v[116:119], v[112:115]
    ds_read_b128 v[136:139], v207 offset:0
    v_mfma_f32_16x16x32_bf16 v[76:79], v[116:119], v[176:179], v[76:79]
    ds_read_b64_tr_b16 v[188:189], v209 offset:1024
    v_mfma_f32_16x16x32_bf16 v[72:75], v[116:119], v[172:175], v[72:75]
    ds_read_b64_tr_b16 v[190:191], v209 offset:1536
    v_mfma_f32_16x16x32_bf16 v[104:107], v[132:135], v[172:175], v[104:107]
    ds_read_b128 v[140:143], v207 offset:10240
    v_mfma_f32_16x16x32_bf16 v[96:99], v[128:131], v[172:175], v[96:99]
    ds_read_b64_tr_b16 v[192:193], v209 offset:1056
    v_mfma_f32_16x16x32_bf16 v[88:91], v[124:127], v[172:175], v[88:91]
    ds_read_b64_tr_b16 v[194:195], v209 offset:1568
    v_mfma_f32_16x16x32_bf16 v[80:83], v[120:123], v[172:175], v[80:83]
    ds_read_b128 v[144:147], v207 offset:12288
    v_mfma_f32_16x16x32_bf16 v[84:87], v[120:123], v[176:179], v[84:87]
    ds_read_b64_tr_b16 v[196:197], v209 offset:2048
    v_mfma_f32_16x16x32_bf16 v[92:95], v[124:127], v[176:179], v[92:95]
    ds_read_b64_tr_b16 v[198:199], v209 offset:2560
    v_mfma_f32_16x16x32_bf16 v[100:103], v[128:131], v[176:179], v[100:103]
    ds_read_b128 v[148:151], v207 offset:14336
    v_mfma_f32_16x16x32_bf16 v[108:111], v[132:135], v[176:179], v[108:111]
    ds_read_b64_tr_b16 v[200:201], v209 offset:2080
    v_mfma_f32_16x16x32_bf16 v[64:67], v[164:167], v[132:135], v[64:67]
    ds_read_b64_tr_b16 v[202:203], v209 offset:2592
    v_mfma_f32_16x16x32_bf16 v[56:59], v[164:167], v[128:131], v[56:59]
    ds_read_b128 v[152:155], v207 offset:16384
    v_mfma_f32_16x16x32_bf16 v[48:51], v[164:167], v[124:127], v[48:51]
    ds_read_b64_tr_b16 v[180:181], v209 offset:0
    v_mfma_f32_16x16x32_bf16 v[40:43], v[164:167], v[120:123], v[40:43]
    ds_read_b64_tr_b16 v[182:183], v209 offset:512
    v_mfma_f32_16x16x32_bf16 v[44:47], v[168:171], v[120:123], v[44:47]
    ds_read_b64_tr_b16 v[184:185], v209 offset:32
    v_mfma_f32_16x16x32_bf16 v[52:55], v[168:171], v[124:127], v[52:55]
    ds_read_b64_tr_b16 v[186:187], v209 offset:544
    v_mfma_f32_16x16x32_bf16 v[60:63], v[168:171], v[128:131], v[60:63]
    v_mfma_f32_16x16x32_bf16 v[68:71], v[168:171], v[132:135], v[68:71]
    s_add_u32 s17, s17, 18432
    s_cmp_eq_u32 s17, 73728
    v_mfma_f32_16x16x32_bf16 v[24:27], v[156:159], v[132:135], v[24:27]
    v_mfma_f32_16x16x32_bf16 v[16:19], v[156:159], v[128:131], v[16:19]
    s_cselect_b32 s17, 0, s17
    v_mfma_f32_16x16x32_bf16 v[8:11], v[156:159], v[124:127], v[8:11]
    v_mfma_f32_16x16x32_bf16 v[0:3], v[156:159], v[120:123], v[0:3]
    v_add_u32 v206, s17, v204
    v_mfma_f32_16x16x32_bf16 v[4:7], v[160:163], v[120:123], v[4:7]
    v_mfma_f32_16x16x32_bf16 v[12:15], v[160:163], v[124:127], v[12:15]
    v_add_u32 v207, s17, v205
    v_mfma_f32_16x16x32_bf16 v[20:23], v[160:163], v[128:131], v[20:23]
    v_mfma_f32_16x16x32_bf16 v[28:31], v[160:163], v[132:135], v[28:31]
    s_waitcnt lgkmcnt(0)
    v_mfma_f32_16x16x32_bf16 v[112:115], v[184:187], v[136:139], v[112:115]
    ds_read_b128 v[116:119], v206 offset:0
    v_mfma_f32_16x16x32_bf16 v[76:79], v[136:139], v[200:203], v[76:79]
    ds_read_b64_tr_b16 v[164:165], v209 offset:13440
    v_mfma_f32_16x16x32_bf16 v[72:75], v[136:139], v[196:199], v[72:75]
    ds_read_b64_tr_b16 v[166:167], v209 offset:13952
    v_mfma_f32_16x16x32_bf16 v[104:107], v[152:155], v[196:199], v[104:107]
    ds_read_b128 v[120:123], v206 offset:10240
    v_mfma_f32_16x16x32_bf16 v[96:99], v[148:151], v[196:199], v[96:99]
    ds_read_b64_tr_b16 v[168:169], v209 offset:13472
    v_mfma_f32_16x16x32_bf16 v[88:91], v[144:147], v[196:199], v[88:91]
    ds_read_b64_tr_b16 v[170:171], v209 offset:13984
    v_mfma_f32_16x16x32_bf16 v[80:83], v[140:143], v[196:199], v[80:83]
    ds_read_b128 v[124:127], v206 offset:12288
    v_mfma_f32_16x16x32_bf16 v[84:87], v[140:143], v[200:203], v[84:87]
    ds_read_b64_tr_b16 v[172:173], v209 offset:14464
    v_mfma_f32_16x16x32_bf16 v[92:95], v[144:147], v[200:203], v[92:95]
    ds_read_b64_tr_b16 v[174:175], v209 offset:14976
    v_mfma_f32_16x16x32_bf16 v[100:103], v[148:151], v[200:203], v[100:103]
    ds_read_b128 v[128:131], v206 offset:14336
    v_mfma_f32_16x16x32_bf16 v[108:111], v[152:155], v[200:203], v[108:111]
    ds_read_b64_tr_b16 v[176:177], v209 offset:14496
    v_mfma_f32_16x16x32_bf16 v[64:67], v[188:191], v[152:155], v[64:67]
    ds_read_b64_tr_b16 v[178:179], v209 offset:15008
    v_mfma_f32_16x16x32_bf16 v[56:59], v[188:191], v[148:151], v[56:59]
    ds_read_b128 v[132:135], v206 offset:16384
    v_mfma_f32_16x16x32_bf16 v[48:51], v[188:191], v[144:147], v[48:51]
    ds_read_b64_tr_b16 v[156:157], v209 offset:12416
    v_mfma_f32_16x16x32_bf16 v[40:43], v[188:191], v[140:143], v[40:43]
    ds_read_b64_tr_b16 v[158:159], v209 offset:12928
    v_mfma_f32_16x16x32_bf16 v[44:47], v[192:195], v[140:143], v[44:47]
    ds_read_b64_tr_b16 v[160:161], v209 offset:12448
    v_mfma_f32_16x16x32_bf16 v[52:55], v[192:195], v[144:147], v[52:55]
    ds_read_b64_tr_b16 v[162:163], v209 offset:12960
    v_mfma_f32_16x16x32_bf16 v[60:63], v[192:195], v[148:151], v[60:63]
    v_mfma_f32_16x16x32_bf16 v[68:71], v[192:195], v[152:155], v[68:71]
    s_add_u32 s16, s16, 24832
    s_cmp_eq_u32 s16, 74496
    v_mfma_f32_16x16x32_bf16 v[24:27], v[180:183], v[152:155], v[24:27]
    v_mfma_f32_16x16x32_bf16 v[16:19], v[180:183], v[148:151], v[16:19]
    s_cselect_b32 s16, 0, s16
    v_mfma_f32_16x16x32_bf16 v[8:11], v[180:183], v[144:147], v[8:11]
    v_mfma_f32_16x16x32_bf16 v[0:3], v[180:183], v[140:143], v[0:3]
    v_add_u32 v209, s16, v208
    v_mfma_f32_16x16x32_bf16 v[4:7], v[184:187], v[140:143], v[4:7]
    v_mfma_f32_16x16x32_bf16 v[12:15], v[184:187], v[144:147], v[12:15]
    s_sub_u32 s18, s18, 1
    s_cmp_lg_u32 s18, 0
    v_mfma_f32_16x16x32_bf16 v[20:23], v[184:187], v[148:151], v[20:23]
    v_mfma_f32_16x16x32_bf16 v[28:31], v[184:187], v[152:155], v[28:31]
    s_waitcnt vmcnt(0) lgkmcnt(0)
    s_cbranch_scc1 g1c_loop1
    ds_write_b128 v236, v[72:75] offset:4096
    ds_write_b128 v236, v[76:79] offset:5120
    s_mov_b32 exec_lo, 0x00010001
    s_mov_b32 exec_hi, 0x00010001
    ds_write_b128 v237, v[112:115] offset:64
    s_mov_b64 exec, 0xffff
    ds_write_b32 v238, v72 offset:256
    ds_write_b32 v238, v76 offset:320
    s_mov_b64 exec, -1
    s_waitcnt lgkmcnt(0)
    s_barrier
    ds_read_b128 v[116:119], v237 offset:0
    ds_read_b128 v[120:123], v237 offset:64
    ds_read_b128 v[124:127], v237 offset:128
    ds_read_b128 v[128:131], v237 offset:192
    ds_read2_b32 v[136:137], v239 offset0:32 offset1:32
    ds_read2_b32 v[138:139], v239 offset0:33 offset1:33
    ds_read2_b32 v[140:141], v239 offset0:64 offset1:64
    ds_read2_b32 v[142:143], v239 offset0:65 offset1:65
    ds_read2_b32 v[144:145], v239 offset0:96 offset1:96
    ds_read2_b32 v[146:147], v239 offset0:97 offset1:97
    ds_read2_b32 v[148:149], v239 offset0:128 offset1:128
    ds_read2_b32 v[150:151], v239 offset0:129 offset1:129
    ds_read2_b32 v[132:133], v239 offset0:0 offset1:0
    ds_read2_b32 v[134:135], v239 offset0:1 offset1:1
    s_waitcnt lgkmcnt(2)
    ds_read_b128 v[32:35], v236 offset:0
    ds_read_b128 v[36:39], v236 offset:1024
    ds_read_b128 v[72:75], v236 offset:2048
    ds_read_b128 v[76:79], v236 offset:3072
g1c_epi:
    ds_read_b32 v241, v241
    ds_read2_b32 v[196:197], v238 offset0:64 offset1:64
    ds_read2_b32 v[198:199], v238 offset0:80 offset1:80
    v_pk_fma_f32 v[0:1], v[136:137], v[116:117], v[0:1] neg_lo:[1,0,0] neg_hi:[1,0,0]
    v_pk_fma_f32 v[2:3], v[136:137], v[118:119], v[2:3] neg_lo:[1,0,0] neg_hi:[1,0,0]
    v_pk_fma_f32 v[4:5], v[136:137], v[120:121], v[4:5] neg_lo:[1,0,0] neg_hi:[1,0,0]
    v_pk_fma_f32 v[6:7], v[136:137], v[122:123], v[6:7] neg_lo:[1,0,0] neg_hi:[1,0,0]
    v_cvt_pk_bf16_f32 v0, v0, v1
    v_cvt_pk_bf16_f32 v1, v2, v3
    v_cvt_pk_bf16_f32 v2, v4, v5
    v_cvt_pk_bf16_f32 v3, v6, v7
    v_mul_f32 v200, s23, v138
    ds_read2_b32 v[164:165], v240 offset0:32 offset1:34
    ds_read2_b32 v[166:167], v240 offset0:36 offset1:38
    ds_read2_b32 v[168:169], v240 offset0:33 offset1:35
    ds_read2_b32 v[170:171], v240 offset0:37 offset1:39
    v_pk_fma_f32 v[40:41], v[136:137], v[124:125], v[40:41] neg_lo:[1,0,0] neg_hi:[1,0,0]
    v_pk_fma_f32 v[42:43], v[136:137], v[126:127], v[42:43] neg_lo:[1,0,0] neg_hi:[1,0,0]
    v_pk_fma_f32 v[44:45], v[136:137], v[128:129], v[44:45] neg_lo:[1,0,0] neg_hi:[1,0,0]
    v_pk_fma_f32 v[46:47], v[136:137], v[130:131], v[46:47] neg_lo:[1,0,0] neg_hi:[1,0,0]
    v_pk_mul_f32 v[40:41], v[138:139], v[40:41]
    v_pk_mul_f32 v[42:43], v[138:139], v[42:43]
    v_pk_mul_f32 v[44:45], v[138:139], v[44:45]
    v_pk_mul_f32 v[46:47], v[138:139], v[46:47]
    v_cvt_pk_bf16_f32 v40, v40, v41
    v_cvt_pk_bf16_f32 v41, v42, v43
    v_cvt_pk_bf16_f32 v42, v44, v45
    v_cvt_pk_bf16_f32 v43, v46, v47
    v_pk_fma_f32 v[8:9], v[140:141], v[116:117], v[8:9] neg_lo:[1,0,0] neg_hi:[1,0,0]
    v_pk_fma_f32 v[10:11], v[140:141], v[118:119], v[10:11] neg_lo:[1,0,0] neg_hi:[1,0,0]
    v_pk_fma_f32 v[12:13], v[140:141], v[120:121], v[12:13] neg_lo:[1,0,0] neg_hi:[1,0,0]
    v_pk_fma_f32 v[14:15], v[140:141], v[122:123], v[14:15] neg_lo:[1,0,0] neg_hi:[1,0,0]
    v_cvt_pk_bf16_f32 v8, v8, v9
    v_cvt_pk_bf16_f32 v9, v10, v11
    v_cvt_pk_bf16_f32 v10, v12, v13
    v_cvt_pk_bf16_f32 v11, v14, v15
    v_mul_f32 v201, s23, v142
    ds_read2_b32 v[172:173], v240 offset0:64 offset1:66
    ds_read2_b32 v[174:175], v240 offset0:68 offset1:70
    ds_read2_b32 v[176:177], v240 offset0:65 offset1:67
    ds_read2_b32 v[178:179], v240 offset0:69 offset1:71
    v_pk_fma_f32 v[48:49], v[140:141], v[124:125], v[48:49] neg_lo:[1,0,0] neg_hi:[1,0,0]
    v_pk_fma_f32 v[50:51], v[140:141], v[126:127], v[50:51] neg_lo:[1,0,0] neg_hi:[1,0,0]
    v_pk_fma_f32 v[52:53], v[140:141], v[128:129], v[52:53] neg_lo:[1,0,0] neg_hi:[1,0,0]
    v_pk_fma_f32 v[54:55], v[140:141], v[130:131], v[54:55] neg_lo:[1,0,0] neg_hi:[1,0,0]
    v_pk_mul_f32 v[48:49], v[142:143], v[48:49]
    v_pk_mul_f32 v[50:51], v[142:143], v[50:51]
    v_pk_mul_f32 v[52:53], v[142:143], v[52:53]
    v_pk_mul_f32 v[54:55], v[142:143], v[54:55]
    v_cvt_pk_bf16_f32 v48, v48, v49
    v_cvt_pk_bf16_f32 v49, v50, v51
    v_cvt_pk_bf16_f32 v50, v52, v53
    v_cvt_pk_bf16_f32 v51, v54, v55
    s_waitcnt lgkmcnt(4)
    v_pk_fma_f32 v[16:17], v[144:145], v[116:117], v[16:17] neg_lo:[1,0,0] neg_hi:[1,0,0]
    v_pk_fma_f32 v[18:19], v[144:145], v[118:119], v[18:19] neg_lo:[1,0,0] neg_hi:[1,0,0]
    v_pk_fma_f32 v[20:21], v[144:145], v[120:121], v[20:21] neg_lo:[1,0,0] neg_hi:[1,0,0]
    v_pk_fma_f32 v[22:23], v[144:145], v[122:123], v[22:23] neg_lo:[1,0,0] neg_hi:[1,0,0]
    v_cvt_pk_bf16_f32 v16, v16, v17
    v_cvt_pk_bf16_f32 v17, v18, v19
    v_cvt_pk_bf16_f32 v18, v20, v21
    v_cvt_pk_bf16_f32 v19, v22, v23
    v_mul_f32 v202, s23, v146
    ds_read2_b32 v[180:181], v240 offset0:96 offset1:98
    ds_read2_b32 v[182:183], v240 offset0:100 offset1:102
    ds_read2_b32 v[184:185], v240 offset0:97 offset1:99
    ds_read2_b32 v[186:187], v240 offset0:101 offset1:103
    v_pk_fma_f32 v[56:57], v[144:145], v[124:125], v[56:57] neg_lo:[1,0,0] neg_hi:[1,0,0]
    v_pk_fma_f32 v[58:59], v[144:145], v[126:127], v[58:59] neg_lo:[1,0,0] neg_hi:[1,0,0]
    v_pk_fma_f32 v[60:61], v[144:145], v[128:129], v[60:61] neg_lo:[1,0,0] neg_hi:[1,0,0]
    v_pk_fma_f32 v[62:63], v[144:145], v[130:131], v[62:63] neg_lo:[1,0,0] neg_hi:[1,0,0]
    v_pk_mul_f32 v[56:57], v[146:147], v[56:57]
    v_pk_mul_f32 v[58:59], v[146:147], v[58:59]
    v_pk_mul_f32 v[60:61], v[146:147], v[60:61]
    v_pk_mul_f32 v[62:63], v[146:147], v[62:63]
    v_cvt_pk_bf16_f32 v56, v56, v57
    v_cvt_pk_bf16_f32 v57, v58, v59
    v_cvt_pk_bf16_f32 v58, v60, v61
    v_cvt_pk_bf16_f32 v59, v62, v63
    v_pk_fma_f32 v[24:25], v[148:149], v[116:117], v[24:25] neg_lo:[1,0,0] neg_hi:[1,0,0]
    v_pk_fma_f32 v[26:27], v[148:149], v[118:119], v[26:27] neg_lo:[1,0,0] neg_hi:[1,0,0]
    v_pk_fma_f32 v[28:29], v[148:149], v[120:121], v[28:29] neg_lo:[1,0,0] neg_hi:[1,0,0]
    v_pk_fma_f32 v[30:31], v[148:149], v[122:123], v[30:31] neg_lo:[1,0,0] neg_hi:[1,0,0]
    v_cvt_pk_bf16_f32 v24, v24, v25
    v_cvt_pk_bf16_f32 v25, v26, v27
    v_cvt_pk_bf16_f32 v26, v28, v29
    v_cvt_pk_bf16_f32 v27, v30, v31
    v_mul_f32 v203, s23, v150
    ds_read2_b32 v[188:189], v240 offset0:128 offset1:130
    ds_read2_b32 v[190:191], v240 offset0:132 offset1:134
    ds_read2_b32 v[192:193], v240 offset0:129 offset1:131
    ds_read2_b32 v[194:195], v240 offset0:133 offset1:135
    v_pk_fma_f32 v[64:65], v[148:149], v[124:125], v[64:65] neg_lo:[1,0,0] neg_hi:[1,0,0]
    v_pk_fma_f32 v[66:67], v[148:149], v[126:127], v[66:67] neg_lo:[1,0,0] neg_hi:[1,0,0]
    v_pk_fma_f32 v[68:69], v[148:149], v[128:129], v[68:69] neg_lo:[1,0,0] neg_hi:[1,0,0]
    v_pk_fma_f32 v[70:71], v[148:149], v[130:131], v[70:71] neg_lo:[1,0,0] neg_hi:[1,0,0]
    v_pk_mul_f32 v[64:65], v[150:151], v[64:65]
    v_pk_mul_f32 v[66:67], v[150:151], v[66:67]
    v_pk_mul_f32 v[68:69], v[150:151], v[68:69]
    v_pk_mul_f32 v[70:71], v[150:151], v[70:71]
    v_cvt_pk_bf16_f32 v64, v64, v65
    v_cvt_pk_bf16_f32 v65, v66, v67
    v_cvt_pk_bf16_f32 v66, v68, v69
    v_cvt_pk_bf16_f32 v67, v70, v71
    ds_read2_b32 v[156:157], v240 offset0:0 offset1:2
    ds_read2_b32 v[158:159], v240 offset0:4 offset1:6
    ds_read2_b32 v[160:161], v240 offset0:1 offset1:3
    ds_read2_b32 v[162:163], v240 offset0:5 offset1:7
    s_waitcnt lgkmcnt(4)
    v_pk_fma_f32 v[32:33], v[132:133], v[124:125], v[32:33] neg_lo:[1,0,0] neg_hi:[1,0,0]
    v_pk_fma_f32 v[34:35], v[132:133], v[126:127], v[34:35] neg_lo:[1,0,0] neg_hi:[1,0,0]
    v_pk_fma_f32 v[36:37], v[132:133], v[128:129], v[36:37] neg_lo:[1,0,0] neg_hi:[1,0,0]
    v_pk_fma_f32 v[38:39], v[132:133], v[130:131], v[38:39] neg_lo:[1,0,0] neg_hi:[1,0,0]
    v_pk_mul_f32 v[32:33], v[134:135], v[32:33]
    v_pk_mul_f32 v[34:35], v[134:135], v[34:35]
    v_pk_mul_f32 v[36:37], v[134:135], v[36:37]
    v_pk_mul_f32 v[38:39], v[134:135], v[38:39]
    v_cvt_pk_bf16_f32 v32, v32, v33
    v_cvt_pk_bf16_f32 v33, v34, v35
    v_cvt_pk_bf16_f32 v34, v36, v37
    v_cvt_pk_bf16_f32 v35, v38, v39
    v_readfirstlane_b32 s78, v241
    s_mov_b32 s59, s78
    s_mul_i32 s60, s59, s75
    v_mfma_f32_16x16x32_bf16 v[116:119], v[40:43], v[0:3], 0
    v_mfma_f32_16x16x32_bf16 v[120:123], v[32:35], v[0:3], 0
    v_mfma_f32_16x16x32_bf16 v[124:127], v[48:51], v[8:11], 0
    v_mfma_f32_16x16x32_bf16 v[128:131], v[40:43], v[8:11], 0
    v_mfma_f32_16x16x32_bf16 v[132:135], v[56:59], v[16:19], 0
    v_mfma_f32_16x16x32_bf16 v[136:139], v[48:51], v[16:19], 0
    v_mfma_f32_16x16x32_bf16 v[140:143], v[64:67], v[24:27], 0
    v_mfma_f32_16x16x32_bf16 v[144:147], v[56:59], v[24:27], 0
    v_pk_fma_f32 v[80:81], v[164:165], v[196:197], v[80:81] neg_lo:[1,0,0] neg_hi:[1,0,0]
    v_pk_fma_f32 v[82:83], v[166:167], v[196:197], v[82:83] neg_lo:[1,0,0] neg_hi:[1,0,0]
    v_pk_mul_f32 v[80:81], v[168:169], v[80:81]
    v_pk_mul_f32 v[82:83], v[170:171], v[82:83]
    v_cvt_pk_bf16_f32 v214, v80, v81
    v_cvt_pk_bf16_f32 v215, v82, v83
    v_pk_fma_f32 v[84:85], v[164:165], v[198:199], v[84:85] neg_lo:[1,0,0] neg_hi:[1,0,0]
    v_pk_fma_f32 v[86:87], v[166:167], v[198:199], v[86:87] neg_lo:[1,0,0] neg_hi:[1,0,0]
    v_pk_mul_f32 v[84:85], v[168:169], v[84:85]
    v_pk_mul_f32 v[86:87], v[170:171], v[86:87]
    v_cvt_pk_bf16_f32 v224, v84, v85
    v_cvt_pk_bf16_f32 v225, v86, v87
    v_pk_fma_f32 v[88:89], v[172:173], v[196:197], v[88:89] neg_lo:[1,0,0] neg_hi:[1,0,0]
    v_pk_fma_f32 v[90:91], v[174:175], v[196:197], v[90:91] neg_lo:[1,0,0] neg_hi:[1,0,0]
    v_pk_mul_f32 v[88:89], v[176:177], v[88:89]
    v_pk_mul_f32 v[90:91], v[178:179], v[90:91]
    v_cvt_pk_bf16_f32 v216, v88, v89
    v_cvt_pk_bf16_f32 v217, v90, v91
    v_pk_fma_f32 v[92:93], v[172:173], v[198:199], v[92:93] neg_lo:[1,0,0] neg_hi:[1,0,0]
    v_pk_fma_f32 v[94:95], v[174:175], v[198:199], v[94:95] neg_lo:[1,0,0] neg_hi:[1,0,0]
    v_pk_mul_f32 v[92:93], v[176:177], v[92:93]
    v_pk_mul_f32 v[94:95], v[178:179], v[94:95]
    v_cvt_pk_bf16_f32 v226, v92, v93
    v_cvt_pk_bf16_f32 v227, v94, v95
    v_pk_fma_f32 v[96:97], v[180:181], v[196:197], v[96:97] neg_lo:[1,0,0] neg_hi:[1,0,0]
    v_pk_fma_f32 v[98:99], v[182:183], v[196:197], v[98:99] neg_lo:[1,0,0] neg_hi:[1,0,0]
    v_pk_mul_f32 v[96:97], v[184:185], v[96:97]
    v_pk_mul_f32 v[98:99], v[186:187], v[98:99]
    v_cvt_pk_bf16_f32 v218, v96, v97
    v_cvt_pk_bf16_f32 v219, v98, v99
    v_pk_fma_f32 v[100:101], v[180:181], v[198:199], v[100:101] neg_lo:[1,0,0] neg_hi:[1,0,0]
    v_pk_fma_f32 v[102:103], v[182:183], v[198:199], v[102:103] neg_lo:[1,0,0] neg_hi:[1,0,0]
    v_pk_mul_f32 v[100:101], v[184:185], v[100:101]
    v_pk_mul_f32 v[102:103], v[186:187], v[102:103]
    v_cvt_pk_bf16_f32 v228, v100, v101
    v_cvt_pk_bf16_f32 v229, v102, v103
    v_pk_fma_f32 v[104:105], v[188:189], v[196:197], v[104:105] neg_lo:[1,0,0] neg_hi:[1,0,0]
    v_pk_fma_f32 v[106:107], v[190:191], v[196:197], v[106:107] neg_lo:[1,0,0] neg_hi:[1,0,0]
    v_pk_mul_f32 v[104:105], v[192:193], v[104:105]
    v_pk_mul_f32 v[106:107], v[194:195], v[106:107]
    v_cvt_pk_bf16_f32 v220, v104, v105
    v_cvt_pk_bf16_f32 v221, v106, v107
    v_pk_fma_f32 v[108:109], v[188:189], v[198:199], v[108:109] neg_lo:[1,0,0] neg_hi:[1,0,0]
    v_pk_fma_f32 v[110:111], v[190:191], v[198:199], v[110:111] neg_lo:[1,0,0] neg_hi:[1,0,0]
    v_pk_mul_f32 v[108:109], v[192:193], v[108:109]
    v_pk_mul_f32 v[110:111], v[194:195], v[110:111]
    v_cvt_pk_bf16_f32 v230, v108, v109
    v_cvt_pk_bf16_f32 v231, v110, v111
    s_waitcnt lgkmcnt(0)
    v_pk_fma_f32 v[72:73], v[156:157], v[196:197], v[72:73] neg_lo:[1,0,0] neg_hi:[1,0,0]
    v_pk_fma_f32 v[74:75], v[158:159], v[196:197], v[74:75] neg_lo:[1,0,0] neg_hi:[1,0,0]
    v_pk_mul_f32 v[72:73], v[160:161], v[72:73]
    v_pk_mul_f32 v[74:75], v[162:163], v[74:75]
    v_cvt_pk_bf16_f32 v212, v72, v73
    v_cvt_pk_bf16_f32 v213, v74, v75
    v_pk_fma_f32 v[76:77], v[156:157], v[198:199], v[76:77] neg_lo:[1,0,0] neg_hi:[1,0,0]
    v_pk_fma_f32 v[78:79], v[158:159], v[198:199], v[78:79] neg_lo:[1,0,0] neg_hi:[1,0,0]
    v_pk_mul_f32 v[76:77], v[160:161], v[76:77]
    v_pk_mul_f32 v[78:79], v[162:163], v[78:79]
    v_cvt_pk_bf16_f32 v222, v76, v77
    v_cvt_pk_bf16_f32 v223, v78, v79
    s_cmp_lg_u32 s75, 0
    s_cbranch_scc1 xo_3_f
    s_mov_b32 s8, s84
    s_mov_b32 s9, s85
    s_mov_b32 s10, 4194304
    s_mov_b32 s11, 0x00020000
    s_lshl_b32 s64, s73, 1
    s_lshr_b32 s65, s3, 1
    s_add_u32 s64, s64, s65
    s_lshl_b32 s64, s64, 17
    s_and_b32 s65, s3, 1
    s_lshl_b32 s65, s65, 6
    s_add_u32 s64, s64, s65
    s_lshl_b32 s65, s72, 7
    s_add_u32 s64, s64, s65
    v_lshlrev_b32 v243, 11, v252
    v_lshl_add_u32 v243, v251, 3, v243
    buffer_load_dwordx2 v[176:177], v243, s[8:11], s64 offen
    buffer_load_dwordx2 v[178:179], v243, s[8:11], s64 offen offset:32
    s_add_u32 s64, s64, 32768
    buffer_load_dwordx2 v[180:181], v243, s[8:11], s64 offen
    buffer_load_dwordx2 v[182:183], v243, s[8:11], s64 offen offset:32
    s_add_u32 s64, s64, 32768
    buffer_load_dwordx2 v[184:185], v243, s[8:11], s64 offen
    buffer_load_dwordx2 v[186:187], v243, s[8:11], s64 offen offset:32
    s_add_u32 s64, s64, 32768
    buffer_load_dwordx2 v[188:189], v243, s[8:11], s64 offen
    buffer_load_dwordx2 v[190:191], v243, s[8:11], s64 offen offset:32
    s_add_u32 s64, s64, 32768
    s_branch xo_3_d
xo_3_f:
    s_lshl_b32 s12, s73, 4
    s_add_u32 s12, s12, s72
    s_lshl_b32 s12, s12, 14
    s_and_b32 s64, s3, 1
    s_lshl_b32 s64, s64, 13
    s_add_u32 s12, s12, s64
    s_lshr_b32 s64, s3, 1
    s_lshl_b32 s64, s64, 12
    s_add_u32 s12, s12, s64
    s_add_u32 s12, s12, 4194304
    buffer_load_dwordx4 v[176:179], v249, s[80:83], s12 offen offset:0 sc1
    buffer_load_dwordx4 v[180:183], v249, s[80:83], s12 offen offset:1024 sc1
    buffer_load_dwordx4 v[184:187], v249, s[80:83], s12 offen offset:2048 sc1
    buffer_load_dwordx4 v[188:191], v249, s[80:83], s12 offen offset:3072 sc1
xo_3_d:
    s_mov_b64 vcc, s[28:29]
    v_mov_b32 v4, 0xf149f2ca
    v_cndmask_b32 v116, v116, v117, vcc
    v_cndmask_b32 v120, v120, v121, vcc
    v_cndmask_b32 v118, v118, v119, vcc
    v_cndmask_b32 v122, v122, v123, vcc
    v_cndmask_b32 v148, v120, v116, s[30:31]
    v_cndmask_b32 v149, v122, v118, s[32:33]
    v_cndmask_b32 v124, v124, v125, vcc
    v_cndmask_b32 v128, v128, v129, vcc
    v_cndmask_b32 v126, v126, v127, vcc
    v_cndmask_b32 v130, v130, v131, vcc
    v_cndmask_b32 v150, v128, v124, s[30:31]
    v_cndmask_b32 v151, v130, v126, s[32:33]
    v_cndmask_b32 v132, v132, v133, vcc
    v_cndmask_b32 v136, v136, v137, vcc
    v_cndmask_b32 v134, v134, v135, vcc
    v_cndmask_b32 v138, v138, v139, vcc
    v_cndmask_b32 v152, v136, v132, s[30:31]
    v_cndmask_b32 v153, v138, v134, s[32:33]
    v_cndmask_b32 v140, v140, v141, vcc
    v_cndmask_b32 v144, v144, v145, vcc
    v_cndmask_b32 v142, v142, v143, vcc
    v_cndmask_b32 v146, v146, v147, vcc
    v_cndmask_b32 v154, v144, v140, s[30:31]
    v_cndmask_b32 v155, v146, v142, s[32:33]
    v_cndmask_b32 v148, v4, v148, s[34:35]
    v_cndmask_b32 v149, v4, v149, s[36:37]
    v_max_f32 v0, v148, v149
    v_max_f32 v1, v150, v151
    v_max_f32 v2, v152, v153
    v_max_f32 v3, v154, v155
    s_nop 0
    v_permlane16_swap_b32 v0, v1
    v_permlane16_swap_b32 v2, v3
    v_max_f32 v0, v0, v1
    v_max_f32 v2, v2, v3
    s_nop 1
    v_permlane32_swap_b32 v0, v2
    v_max_f32 v0, v0, v2
    v_mov_b32 v2, v0
    s_nop 1
    v_permlane32_swap_b32 v0, v2
    v_mov_b32 v1, v0
    v_mov_b32 v3, v2
    s_nop 0
    v_permlane16_swap_b32 v0, v1
    v_permlane16_swap_b32 v2, v3
    v_sub_f32 v148, v148, v0
    v_sub_f32 v149, v149, v0
    v_sub_f32 v150, v150, v1
    v_sub_f32 v151, v151, v1
    v_sub_f32 v152, v152, v2
    v_sub_f32 v153, v153, v2
    v_sub_f32 v154, v154, v3
    v_sub_f32 v155, v155, v3
    v_mul_f32 v148, v200, v148
    v_mul_f32 v149, v200, v149
    v_mul_f32 v150, v201, v150
    v_mul_f32 v151, v201, v151
    v_mul_f32 v152, v202, v152
    v_mul_f32 v153, v202, v153
    v_mul_f32 v154, v203, v154
    v_mul_f32 v155, v203, v155
    v_exp_f32 v148, v148
    v_exp_f32 v149, v149
    v_exp_f32 v150, v150
    v_exp_f32 v151, v151
    v_exp_f32 v152, v152
    v_exp_f32 v153, v153
    v_exp_f32 v154, v154
    v_exp_f32 v155, v155
    v_add_f32 v0, v148, v149
    v_add_f32 v1, v150, v151
    v_add_f32 v2, v152, v153
    v_add_f32 v3, v154, v155
    s_nop 0
    v_permlane16_swap_b32 v0, v1
    v_permlane16_swap_b32 v2, v3
    v_add_f32 v0, v0, v1
    v_add_f32 v2, v2, v3
    s_nop 1
    v_permlane32_swap_b32 v0, v2
    v_add_f32 v0, v0, v2
    v_rcp_f32 v0, v0
    s_nop 0
    v_mov_b32 v2, v0
    s_nop 1
    v_permlane32_swap_b32 v0, v2
    v_mov_b32 v1, v0
    v_mov_b32 v3, v2
    s_nop 0
    v_permlane16_swap_b32 v0, v1
    v_permlane16_swap_b32 v2, v3
    v_mul_f32 v148, v148, v0
    v_mul_f32 v149, v149, v0
    v_cvt_pk_bf16_f32 v148, v148, v148
    v_cvt_pk_bf16_f32 v149, v149, v149
    v_and_b32 v8, v148, v232
    v_and_b32 v9, v149, v233
    v_and_b32 v10, v148, v234
    v_and_b32 v11, v149, v235
    v_mul_f32 v150, v150, v1
    v_mul_f32 v151, v151, v1
    v_cvt_pk_bf16_f32 v150, v150, v150
    v_cvt_pk_bf16_f32 v151, v151, v151
    v_and_b32 v12, v150, v232
    v_and_b32 v13, v151, v233
    v_and_b32 v14, v150, v234
    v_and_b32 v15, v151, v235
    v_mfma_f32_16x16x32_bf16 v[24:27], v[212:215], v[8:11], 0
    v_mfma_f32_16x16x32_bf16 v[28:31], v[222:225], v[8:11], 0
    v_mul_f32 v152, v152, v2
    v_mul_f32 v153, v153, v2
    v_cvt_pk_bf16_f32 v152, v152, v152
    v_cvt_pk_bf16_f32 v153, v153, v153
    v_and_b32 v16, v152, v232
    v_and_b32 v17, v153, v233
    v_and_b32 v18, v152, v234
    v_and_b32 v19, v153, v235
    v_mfma_f32_16x16x32_bf16 v[32:35], v[214:217], v[12:15], 0
    v_mfma_f32_16x16x32_bf16 v[36:39], v[224:227], v[12:15], 0
    v_mul_f32 v154, v154, v3
    v_mul_f32 v155, v155, v3
    v_cvt_pk_bf16_f32 v154, v154, v154
    v_cvt_pk_bf16_f32 v155, v155, v155
    v_and_b32 v20, v154, v232
    v_and_b32 v21, v155, v233
    v_and_b32 v22, v154, v234
    v_and_b32 v23, v155, v235
    v_mfma_f32_16x16x32_bf16 v[40:43], v[216:219], v[16:19], 0
    v_mfma_f32_16x16x32_bf16 v[44:47], v[226:229], v[16:19], 0
    v_mfma_f32_16x16x32_bf16 v[48:51], v[218:221], v[20:23], 0
    v_mfma_f32_16x16x32_bf16 v[52:55], v[228:231], v[20:23], 0
    s_cmp_lg_u32 s68, 0
    s_cbranch_scc1 g1c_rem
    v_cvt_pk_bf16_f32 v56, v24, v25
    v_cvt_pk_bf16_f32 v57, v26, v27
    v_cvt_pk_bf16_f32 v58, v28, v29
    v_cvt_pk_bf16_f32 v59, v30, v31
    buffer_store_dwordx4 v[56:59], v249, s[80:83], s21 offen offset:0
    v_cvt_pk_bf16_f32 v60, v32, v33
    v_cvt_pk_bf16_f32 v61, v34, v35
    v_cvt_pk_bf16_f32 v62, v36, v37
    v_cvt_pk_bf16_f32 v63, v38, v39
    buffer_store_dwordx4 v[60:63], v249, s[80:83], s21 offen offset:1024
    v_cvt_pk_bf16_f32 v64, v40, v41
    v_cvt_pk_bf16_f32 v65, v42, v43
    v_cvt_pk_bf16_f32 v66, v44, v45
    v_cvt_pk_bf16_f32 v67, v46, v47
    buffer_store_dwordx4 v[64:67], v249, s[80:83], s21 offen offset:2048
    v_cvt_pk_bf16_f32 v68, v48, v49
    v_cvt_pk_bf16_f32 v69, v50, v51
    v_cvt_pk_bf16_f32 v70, v52, v53
    v_cvt_pk_bf16_f32 v71, v54, v55
    buffer_store_dwordx4 v[68:71], v249, s[80:83], s21 offen offset:3072
g1c_remb:
    s_lshl_b32 s64, s75, 15
    s_lshl_b32 s66, s73, 9
    s_add_u32 s64, s64, s66
    s_add_u32 s64, s64, 75497472
    s_lshl_b32 s65, s72, 5
    s_add_u32 s64, s64, s65
    s_lshl_b32 s65, s3, 2
    s_add_u32 s64, s64, s65
    v_mov_b32 v108, 0
    v_mov_b32 v109, 1
    s_cmp_lg_u32 s78, 0
    s_cbranch_scc1 sg_4_slow
    s_waitcnt vmcnt(0)
    s_mov_b64 exec, 1
    buffer_store_dword v109, v108, s[80:83], s64 offen
    s_mov_b64 exec, -1
sg_4_done:
    s_lshr_b32 s64, s3, 1
    s_lshl_b32 s64, s64, 12
    v_add_u32 v240, s64, v249
    v_lshrrev_b32 v253, 2, v252
    v_mul_u32_u24 v253, 1056, v253
    v_lshl_add_u32 v253, v251, 7, v253
    v_and_b32 v254, 3, v252
    v_lshl_add_u32 v253, v254, 3, v253
    s_and_b32 s64, s3, 1
    s_lshl_b32 s64, s64, 6
    s_add_u32 s64, s64, 65536
    v_add_u32 v241, s64, v253
    s_mov_b32 s16, 50688
    v_add_u32 v242, s16, v241
    s_mov_b32 s25, s72
    s_lshl_b32 s18, s73, 4
    s_add_u32 s18, s18, s72
    s_lshl_b32 s18, s18, 14
    s_and_b32 s64, s3, 1
    s_lshl_b32 s64, s64, 13
    s_add_u32 s18, s18, s64
    s_lshr_b32 s64, s3, 1
    s_lshl_b32 s64, s64, 12
    s_add_u32 s18, s18, s64
    s_mov_b32 s20, s18
    s_lshl_b32 s66, s75, 23
    s_add_u32 s20, s20, s66
    s_lshl_b32 s24, s73, 4
    s_add_u32 s24, s24, s25
    s_lshl_b32 s24, s24, 11
    s_lshl_b32 s65, s75, 20
    s_add_u32 s24, s24, s65
    s_add_u32 s24, s24, 71303168
    s_lshr_b32 s65, s3, 1
    s_lshl_b32 s65, s65, 9
    s_add_u32 s24, s24, s65
    s_and_b32 s65, s3, 1
    s_lshl_b32 s65, s65, 10
    s_add_u32 s24, s24, s65
    v_lshlrev_b32 v239, 3, v250
    v_mov_b32 v208, 0
    v_mov_b32 v209, 0
    v_mov_b32 v210, 0
    v_mov_b32 v211, 0
    s_nop 1
    v_mfma_f32_32x32x16_bf16 v[0:15], v[208:211], v[208:211], 0
    v_mfma_f32_32x32x16_bf16 v[16:31], v[208:211], v[208:211], 0
    s_mov_b32 s17, 8
    s_waitcnt vmcnt(1)
    v_lshlrev_b32 v144, 16, v176
    v_and_b32 v145, 0xffff0000, v176
    v_lshlrev_b32 v146, 16, v177
    v_and_b32 v147, 0xffff0000, v177
    v_lshlrev_b32 v148, 16, v178
    v_and_b32 v149, 0xffff0000, v178
    v_lshlrev_b32 v150, 16, v179
    v_and_b32 v151, 0xffff0000, v179
    v_lshlrev_b32 v152, 16, v180
    v_and_b32 v153, 0xffff0000, v180
    v_lshlrev_b32 v154, 16, v181
    v_and_b32 v155, 0xffff0000, v181
    v_lshlrev_b32 v156, 16, v182
    v_and_b32 v157, 0xffff0000, v182
    v_lshlrev_b32 v158, 16, v183
    v_and_b32 v159, 0xffff0000, v183
    v_lshlrev_b32 v160, 16, v184
    v_and_b32 v161, 0xffff0000, v184
    v_lshlrev_b32 v162, 16, v185
    v_and_b32 v163, 0xffff0000, v185
    v_lshlrev_b32 v164, 16, v186
    v_and_b32 v165, 0xffff0000, v186
    v_lshlrev_b32 v166, 16, v187
    v_and_b32 v167, 0xffff0000, v187
    v_lshlrev_b32 v168, 16, v188
    v_and_b32 v169, 0xffff0000, v188
    v_lshlrev_b32 v170, 16, v189
    v_and_b32 v171, 0xffff0000, v189
    v_lshlrev_b32 v172, 16, v190
    v_and_b32 v173, 0xffff0000, v190
    v_lshlrev_b32 v174, 16, v191
    v_and_b32 v175, 0xffff0000, v191
    s_waitcnt lgkmcnt(0)
    s_barrier
    ds_read_b128 v[32:35], v240 offset:0
    ds_read_b64_tr_b16 v[48:49], v242 offset:0
    ds_read_b64_tr_b16 v[50:51], v242 offset:512
    ds_read_b128 v[36:39], v240 offset:1024
    ds_read_b64_tr_b16 v[52:53], v242 offset:32
    ds_read_b64_tr_b16 v[54:55], v242 offset:544
    ds_read_b128 v[40:43], v240 offset:2048
    ds_read_b128 v[44:47], v240 offset:3072
    ds_read_b128 v[56:59], v240 offset:8192
    ds_read_b64_tr_b16 v[72:73], v242 offset:4224
    ds_read_b64_tr_b16 v[74:75], v242 offset:4736
    ds_read_b128 v[60:63], v240 offset:9216
    ds_read_b64_tr_b16 v[76:77], v242 offset:4256
    ds_read_b64_tr_b16 v[78:79], v242 offset:4768
    ds_read_b128 v[64:67], v240 offset:10240
    ds_read_b128 v[68:71], v240 offset:11264
    v_add_u16 v240, 0x4000, v240
    s_add_u32 s16, s16, 8448
    s_cmp_eq_u32 s16, 92928
    s_cselect_b32 s16, 0, s16
    v_add_u32 v242, s16, v241
    s_waitcnt lgkmcnt(0)
r1_loop:
    s_bitcmp1_b32 2, s17
    s_cbranch_scc1 r1_nb0
    s_barrier
r1_nb0:
    v_mfma_f32_16x16x32_bf16 v[0:3], v[48:51], v[32:35], v[0:3]
    ds_read_b128 v[80:83], v240 offset:0
    ds_read_b64_tr_b16 v[96:97], v242 offset:0
    v_mfma_f32_16x16x32_bf16 v[8:11], v[48:51], v[36:39], v[8:11]
    ds_read_b64_tr_b16 v[98:99], v242 offset:512
    v_mfma_f32_16x16x32_bf16 v[16:19], v[48:51], v[40:43], v[16:19]
    ds_read_b128 v[84:87], v240 offset:1024
    ds_read_b64_tr_b16 v[100:101], v242 offset:32
    v_mfma_f32_16x16x32_bf16 v[24:27], v[48:51], v[44:47], v[24:27]
    ds_read_b64_tr_b16 v[102:103], v242 offset:544
    v_mfma_f32_16x16x32_bf16 v[28:31], v[52:55], v[44:47], v[28:31]
    ds_read_b128 v[88:91], v240 offset:2048
    ds_read_b128 v[92:95], v240 offset:3072
    v_mfma_f32_16x16x32_bf16 v[20:23], v[52:55], v[40:43], v[20:23]
    ds_read_b128 v[104:107], v240 offset:8192
    v_mfma_f32_16x16x32_bf16 v[12:15], v[52:55], v[36:39], v[12:15]
    ds_read_b64_tr_b16 v[120:121], v242 offset:4224
    ds_read_b64_tr_b16 v[122:123], v242 offset:4736
    v_mfma_f32_16x16x32_bf16 v[4:7], v[52:55], v[32:35], v[4:7]
    ds_read_b128 v[108:111], v240 offset:9216
    v_mfma_f32_16x16x32_bf16 v[0:3], v[72:75], v[56:59], v[0:3]
    ds_read_b64_tr_b16 v[124:125], v242 offset:4256
    ds_read_b64_tr_b16 v[126:127], v242 offset:4768
    v_mfma_f32_16x16x32_bf16 v[8:11], v[72:75], v[60:63], v[8:11]
    ds_read_b128 v[112:115], v240 offset:10240
    v_mfma_f32_16x16x32_bf16 v[16:19], v[72:75], v[64:67], v[16:19]
    ds_read_b128 v[116:119], v240 offset:11264
    v_mfma_f32_16x16x32_bf16 v[24:27], v[72:75], v[68:71], v[24:27]
    v_add_u16 v240, 0x4000, v240
    v_mfma_f32_16x16x32_bf16 v[28:31], v[76:79], v[68:71], v[28:31]
    s_add_u32 s16, s16, 8448
    s_cmp_eq_u32 s16, 92928
    v_mfma_f32_16x16x32_bf16 v[20:23], v[76:79], v[64:67], v[20:23]
    s_cselect_b32 s16, 0, s16
    v_mfma_f32_16x16x32_bf16 v[12:15], v[76:79], v[60:63], v[12:15]
    v_add_u32 v242, s16, v241
    v_mfma_f32_16x16x32_bf16 v[4:7], v[76:79], v[56:59], v[4:7]
    s_waitcnt lgkmcnt(0)
    s_bitcmp1_b32 2, s17
    s_cbranch_scc1 r1_nb1
    s_barrier
r1_nb1:
    v_mfma_f32_16x16x32_bf16 v[0:3], v[96:99], v[80:83], v[0:3]
    ds_read_b128 v[32:35], v240 offset:0
    ds_read_b64_tr_b16 v[48:49], v242 offset:0
    v_mfma_f32_16x16x32_bf16 v[8:11], v[96:99], v[84:87], v[8:11]
    ds_read_b64_tr_b16 v[50:51], v242 offset:512
    v_mfma_f32_16x16x32_bf16 v[16:19], v[96:99], v[88:91], v[16:19]
    ds_read_b128 v[36:39], v240 offset:1024
    ds_read_b64_tr_b16 v[52:53], v242 offset:32
    v_mfma_f32_16x16x32_bf16 v[24:27], v[96:99], v[92:95], v[24:27]
    ds_read_b64_tr_b16 v[54:55], v242 offset:544
    v_mfma_f32_16x16x32_bf16 v[28:31], v[100:103], v[92:95], v[28:31]
    ds_read_b128 v[40:43], v240 offset:2048
    ds_read_b128 v[44:47], v240 offset:3072
    v_mfma_f32_16x16x32_bf16 v[20:23], v[100:103], v[88:91], v[20:23]
    ds_read_b128 v[56:59], v240 offset:8192
    v_mfma_f32_16x16x32_bf16 v[12:15], v[100:103], v[84:87], v[12:15]
    ds_read_b64_tr_b16 v[72:73], v242 offset:4224
    ds_read_b64_tr_b16 v[74:75], v242 offset:4736
    v_mfma_f32_16x16x32_bf16 v[4:7], v[100:103], v[80:83], v[4:7]
    ds_read_b128 v[60:63], v240 offset:9216
    v_mfma_f32_16x16x32_bf16 v[0:3], v[120:123], v[104:107], v[0:3]
    ds_read_b64_tr_b16 v[76:77], v242 offset:4256
    ds_read_b64_tr_b16 v[78:79], v242 offset:4768
    v_mfma_f32_16x16x32_bf16 v[8:11], v[120:123], v[108:111], v[8:11]
    ds_read_b128 v[64:67], v240 offset:10240
    v_mfma_f32_16x16x32_bf16 v[16:19], v[120:123], v[112:115], v[16:19]
    ds_read_b128 v[68:71], v240 offset:11264
    v_mfma_f32_16x16x32_bf16 v[24:27], v[120:123], v[116:119], v[24:27]
    v_add_u16 v240, 0x4000, v240
    s_add_u32 s16, s16, 8448
    s_cmp_eq_u32 s16, 92928
    v_mfma_f32_16x16x32_bf16 v[28:31], v[124:127], v[116:119], v[28:31]
    s_cselect_b32 s16, 0, s16
    v_mfma_f32_16x16x32_bf16 v[20:23], v[124:127], v[112:115], v[20:23]
    v_add_u32 v242, s16, v241
    v_mfma_f32_16x16x32_bf16 v[12:15], v[124:127], v[108:111], v[12:15]
    s_sub_u32 s17, s17, 1
    s_cmp_lg_u32 s17, 0
    v_mfma_f32_16x16x32_bf16 v[4:7], v[124:127], v[104:107], v[4:7]
    s_waitcnt lgkmcnt(0)
    s_cbranch_scc1 r1_loop
    s_barrier
    s_nop 5
    v_mov_b32 v88, 0x3f803f80
    v_cvt_pk_bf16_f32 v208, v0, v1
    v_cvt_pk_bf16_f32 v209, v2, v3
    v_cvt_pk_bf16_f32 v210, v4, v5
    v_cvt_pk_bf16_f32 v211, v6, v7
    v_cvt_pk_bf16_f32 v212, v8, v9
    v_cvt_pk_bf16_f32 v213, v10, v11
    v_cvt_pk_bf16_f32 v214, v12, v13
    v_cvt_pk_bf16_f32 v215, v14, v15
    v_lshlrev_b32 v96, 16, v208
    v_lshlrev_b32 v98, 16, v209
    v_lshlrev_b32 v100, 16, v210
    v_lshlrev_b32 v102, 16, v211
    v_lshlrev_b32 v104, 16, v212
    v_lshlrev_b32 v106, 16, v213
    v_lshlrev_b32 v108, 16, v214
    v_lshlrev_b32 v110, 16, v215
    v_and_b32 v97, 0xffff0000, v208
    v_and_b32 v99, 0xffff0000, v209
    v_and_b32 v101, 0xffff0000, v210
    v_and_b32 v103, 0xffff0000, v211
    v_and_b32 v105, 0xffff0000, v212
    v_and_b32 v107, 0xffff0000, v213
    v_and_b32 v109, 0xffff0000, v214
    v_and_b32 v111, 0xffff0000, v215
    v_pk_add_f32 v[96:97], v[96:97], v[144:145]
    v_pk_add_f32 v[98:99], v[98:99], v[146:147]
    v_pk_add_f32 v[100:101], v[100:101], v[148:149]
    v_pk_add_f32 v[102:103], v[102:103], v[150:151]
    v_pk_add_f32 v[104:105], v[104:105], v[152:153]
    v_pk_add_f32 v[106:107], v[106:107], v[154:155]
    v_pk_add_f32 v[108:109], v[108:109], v[156:157]
    v_pk_add_f32 v[110:111], v[110:111], v[158:159]
    v_cvt_pk_bf16_f32 v64, v96, v97
    v_cvt_pk_bf16_f32 v65, v98, v99
    v_cvt_pk_bf16_f32 v66, v100, v101
    v_cvt_pk_bf16_f32 v67, v102, v103
    v_cvt_pk_bf16_f32 v68, v104, v105
    v_cvt_pk_bf16_f32 v69, v106, v107
    v_cvt_pk_bf16_f32 v70, v108, v109
    v_cvt_pk_bf16_f32 v71, v110, v111
    buffer_store_dwordx4 v[64:67], v249, s[80:83], s20 offen offset:0 sc0 sc1
    buffer_store_dwordx4 v[68:71], v249, s[80:83], s20 offen offset:1024 sc0 sc1
    v_cvt_pk_bf16_f32 v208, v16, v17
    v_cvt_pk_bf16_f32 v209, v18, v19
    v_cvt_pk_bf16_f32 v210, v20, v21
    v_cvt_pk_bf16_f32 v211, v22, v23
    v_cvt_pk_bf16_f32 v212, v24, v25
    v_cvt_pk_bf16_f32 v213, v26, v27
    v_cvt_pk_bf16_f32 v214, v28, v29
    v_cvt_pk_bf16_f32 v215, v30, v31
    v_lshlrev_b32 v96, 16, v208
    v_lshlrev_b32 v98, 16, v209
    v_lshlrev_b32 v100, 16, v210
    v_lshlrev_b32 v102, 16, v211
    v_lshlrev_b32 v104, 16, v212
    v_lshlrev_b32 v106, 16, v213
    v_lshlrev_b32 v108, 16, v214
    v_lshlrev_b32 v110, 16, v215
    v_and_b32 v97, 0xffff0000, v208
    v_and_b32 v99, 0xffff0000, v209
    v_and_b32 v101, 0xffff0000, v210
    v_and_b32 v103, 0xffff0000, v211
    v_and_b32 v105, 0xffff0000, v212
    v_and_b32 v107, 0xffff0000, v213
    v_and_b32 v109, 0xffff0000, v214
    v_and_b32 v111, 0xffff0000, v215
    v_pk_add_f32 v[96:97], v[96:97], v[160:161]
    v_pk_add_f32 v[98:99], v[98:99], v[162:163]
    v_pk_add_f32 v[100:101], v[100:101], v[164:165]
    v_pk_add_f32 v[102:103], v[102:103], v[166:167]
    v_pk_add_f32 v[104:105], v[104:105], v[168:169]
    v_pk_add_f32 v[106:107], v[106:107], v[170:171]
    v_pk_add_f32 v[108:109], v[108:109], v[172:173]
    v_pk_add_f32 v[110:111], v[110:111], v[174:175]
    v_cvt_pk_bf16_f32 v72, v96, v97
    v_cvt_pk_bf16_f32 v73, v98, v99
    v_cvt_pk_bf16_f32 v74, v100, v101
    v_cvt_pk_bf16_f32 v75, v102, v103
    v_cvt_pk_bf16_f32 v76, v104, v105
    v_cvt_pk_bf16_f32 v77, v106, v107
    v_cvt_pk_bf16_f32 v78, v108, v109
    v_cvt_pk_bf16_f32 v79, v110, v111
    buffer_store_dwordx4 v[72:75], v249, s[80:83], s20 offen offset:2048 sc0 sc1
    buffer_store_dwordx4 v[76:79], v249, s[80:83], s20 offen offset:3072 sc0 sc1
    v_dot2_f32_bf16 v80, v64, v88, 0
    v_dot2_f32_bf16 v84, v64, v64, 0
    v_dot2_f32_bf16 v81, v68, v88, 0
    v_dot2_f32_bf16 v85, v68, v68, 0
    v_dot2_f32_bf16 v82, v72, v88, 0
    v_dot2_f32_bf16 v86, v72, v72, 0
    v_dot2_f32_bf16 v83, v76, v88, 0
    v_dot2_f32_bf16 v87, v76, v76, 0
    v_dot2_f32_bf16 v80, v65, v88, v80
    v_dot2_f32_bf16 v84, v65, v65, v84
    v_dot2_f32_bf16 v81, v69, v88, v81
    v_dot2_f32_bf16 v85, v69, v69, v85
    v_dot2_f32_bf16 v82, v73, v88, v82
    v_dot2_f32_bf16 v86, v73, v73, v86
    v_dot2_f32_bf16 v83, v77, v88, v83
    v_dot2_f32_bf16 v87, v77, v77, v87
    v_dot2_f32_bf16 v80, v66, v88, v80
    v_dot2_f32_bf16 v84, v66, v66, v84
    v_dot2_f32_bf16 v81, v70, v88, v81
    v_dot2_f32_bf16 v85, v70, v70, v85
    v_dot2_f32_bf16 v82, v74, v88, v82
    v_dot2_f32_bf16 v86, v74, v74, v86
    v_dot2_f32_bf16 v83, v78, v88, v83
    v_dot2_f32_bf16 v87, v78, v78, v87
    v_dot2_f32_bf16 v80, v67, v88, v80
    v_dot2_f32_bf16 v84, v67, v67, v84
    v_dot2_f32_bf16 v81, v71, v88, v81
    v_dot2_f32_bf16 v85, v71, v71, v85
    v_dot2_f32_bf16 v82, v75, v88, v82
    v_dot2_f32_bf16 v86, v75, v75, v86
    v_dot2_f32_bf16 v83, v79, v88, v83
    v_dot2_f32_bf16 v87, v79, v79, v87
    s_nop 2
    v_permlane16_swap_b32 v80, v81
    v_permlane16_swap_b32 v82, v83
    v_permlane16_swap_b32 v84, v85
    v_permlane16_swap_b32 v86, v87
    v_add_f32 v80, v80, v81
    v_add_f32 v82, v82, v83
    v_add_f32 v84, v84, v85
    v_add_f32 v86, v86, v87
    s_nop 1
    v_permlane32_swap_b32 v80, v82
    v_permlane32_swap_b32 v84, v86
    v_add_f32 v80, v80, v82
    v_add_f32 v81, v84, v86
    buffer_store_dwordx2 v[80:81], v239, s[80:83], s24 offen sc0 sc1
    s_lshl_b32 s64, s75, 15
    s_lshl_b32 s66, s73, 9
    s_add_u32 s64, s64, s66
    s_add_u32 s64, s64, 75505664
    s_lshl_b32 s65, s72, 5
    s_add_u32 s64, s64, s65
    s_lshl_b32 s65, s3, 2
    s_add_u32 s64, s64, s65
    v_mov_b32 v208, 0
    v_mov_b32 v209, 1
    s_cmp_lg_u32 s78, 0
    s_cbranch_scc1 sg_6_slow
    s_waitcnt vmcnt(0)
    s_mov_b64 exec, 1
    buffer_store_dword v209, v208, s[80:83], s64 offen
    s_mov_b64 exec, -1
sg_6_done:
    s_and_b32 s64, s3, 1
    s_cmp_eq_u32 s64, 0
    s_cselect_b32 s8, s92, s94
    s_cselect_b32 s9, s93, s95
    s_mov_b32 s10, 7340032
    s_mov_b32 s11, 0x00020000
    s_mul_i32 s19, s64, 14400
    s_lshr_b32 s64, s69, 1
    s_mul_i32 s65, s64, 7200
    s_add_u32 s19, s19, s65
    s_add_u32 s19, s19, 36736
    s_mul_i32 s17, s64, 28672
    s_mul_i32 s65, s74, 448
    s_add_u32 s17, s17, s65
    s_add_u32 s18, s17, 7340032
    s_lshl_b32 s64, s57, 1
    s_add_u32 s64, s64, 3
    s_and_b32 s64, s64, 31
    s_mul_i32 s65, s64, 229376
    s_add_u32 s16, s17, s65
    s_mov_b32 s66, 2341
    v_add_u32 v253, 192, v250
    v_mul_lo_u32 v254, v253, s66
    v_lshrrev_b32 v254, 16, v254
    v_mul_u32_u24 v224, 28, v254
    v_sub_u32 v253, v253, v224
    v_and_b32 v224, 12, v254
    v_add_u32 v254, v254, v224
    v_mul_u32_u24 v254, 7168, v254
    v_lshl_add_u32 v224, v253, 4, v254
    v_add_u32 v253, 256, v250
    v_mul_lo_u32 v254, v253, s66
    v_lshrrev_b32 v254, 16, v254
    v_mul_u32_u24 v225, 28, v254
    v_sub_u32 v253, v253, v225
    v_and_b32 v225, 12, v254
    v_add_u32 v254, v254, v225
    v_mul_u32_u24 v254, 7168, v254
    v_lshl_add_u32 v225, v253, 4, v254
    v_add_u32 v253, 320, v250
    v_mul_lo_u32 v254, v253, s66
    v_lshrrev_b32 v254, 16, v254
    v_mul_u32_u24 v226, 28, v254
    v_sub_u32 v253, v253, v226
    v_and_b32 v226, 12, v254
    v_add_u32 v254, v254, v226
    v_mul_u32_u24 v254, 7168, v254
    v_lshl_add_u32 v226, v253, 4, v254
    v_add_u32 v253, 384, v250
    v_mul_lo_u32 v254, v253, s66
    v_lshrrev_b32 v254, 16, v254
    v_mul_u32_u24 v227, 28, v254
    v_sub_u32 v253, v253, v227
    v_and_b32 v227, 12, v254
    v_add_u32 v254, v254, v227
    v_mul_u32_u24 v254, 7168, v254
    v_lshl_add_u32 v227, v253, 4, v254
    s_and_b32 s64, s3, 1
    s_lshl_b32 s64, s64, 12
    v_add_u32 v231, s64, v249
    v_lshrrev_b32 v253, 1, v251
    v_lshrrev_b32 v254, 2, v252
    v_lshl_add_u32 v253, v253, 2, v254
    v_mul_u32_u24 v253, 448, v253
    v_and_b32 v254, 1, v251
    v_mul_u32_u24 v254, 7200, v254
    v_add_u32 v253, v253, v254
    v_and_b32 v254, 3, v252
    v_lshl_add_u32 v253, v254, 3, v253
    v_add_u32 v253, 36736, v253
    s_lshr_b32 s64, s69, 1
    s_lshl_b32 s28, s64, 2
    s_lshl_b32 s65, s28, 5
    v_add_u32 v232, s65, v253
    v_add_u32 v233, 57600, v232
    s_lshl_b32 s25, s73, 1
    s_add_u32 s25, s25, s68
    s_mul_i32 s25, s25, 458752
    s_lshl_b32 s66, s60, 24
    s_add_u32 s25, s25, s66
    s_add_u32 s25, s25, 20971520
    s_and_b32 s64, s74, 7
    s_mul_i32 s64, s64, 57344
    s_add_u32 s25, s25, s64
    v_mov_b32 v192, 0
    v_mov_b32 v193, 0
    v_mov_b32 v194, 0
    v_mov_b32 v195, 0
    s_nop 1
    v_mfma_f32_32x32x16_bf16 v[0:15], v[192:195], v[192:195], 0
    v_mfma_f32_32x32x16_bf16 v[16:31], v[192:195], v[192:195], 0
    v_mfma_f32_32x32x16_bf16 v[32:47], v[192:195], v[192:195], 0
    v_mfma_f32_32x32x16_bf16 v[48:63], v[192:195], v[192:195], 0
    v_mfma_f32_32x32x16_bf16 v[64:79], v[192:195], v[192:195], 0
    v_mfma_f32_32x32x16_bf16 v[80:95], v[192:195], v[192:195], 0
    v_mfma_f32_32x32x16_bf16 v[96:111], v[192:195], v[192:195], 0
    v_mfma_f32_32x32x16_bf16 v[112:127], v[192:195], v[192:195], 0
    s_mov_b32 s12, s96
    s_mov_b32 s13, s97
    s_mov_b32 s14, 7340032
    s_mov_b32 s15, 0x00020000
    s_lshl_b32 s34, s2, 2
    s_add_u32 s34, s34, s3
    s_mul_i32 s34, s34, 7168
    s_cmp_eq_u32 s75, 0
    s_cselect_b32 s34, s34, 0x40000000
    v_lshlrev_b32 v247, 7, v250
    v_and_b32 v248, 56, v250
    v_lshl_add_u32 v247, v248, 24, v247
    s_barrier
    ds_read_b128 v[192:195], v231 offset:0
    ds_read_b128 v[196:199], v231 offset:1024
    ds_read_b128 v[200:203], v231 offset:2048
    ds_read_b128 v[204:207], v231 offset:3072
    ds_read_b64_tr_b16 v[128:129], v232 offset:28800
    ds_read_b64_tr_b16 v[130:131], v232 offset:32384
    ds_read_b64_tr_b16 v[144:145], v232 offset:43200
    ds_read_b64_tr_b16 v[146:147], v232 offset:46784
    ds_read_b64_tr_b16 v[132:133], v232 offset:28832
    ds_read_b64_tr_b16 v[134:135], v232 offset:32416
    ds_read_b64_tr_b16 v[148:149], v232 offset:43232
    ds_read_b64_tr_b16 v[150:151], v232 offset:46816
    ds_read_b64_tr_b16 v[136:137], v232 offset:28864
    ds_read_b64_tr_b16 v[138:139], v232 offset:32448
    ds_read_b64_tr_b16 v[152:153], v232 offset:43264
    ds_read_b64_tr_b16 v[154:155], v232 offset:46848
    ds_read_b64_tr_b16 v[140:141], v232 offset:28896
    ds_read_b64_tr_b16 v[142:143], v232 offset:32480
    ds_read_b64_tr_b16 v[156:157], v232 offset:43296
    ds_read_b64_tr_b16 v[158:159], v232 offset:46880
    s_mov_b32 s24, 7
g3c0_loop:
    s_waitcnt vmcnt(4) lgkmcnt(0)
    s_barrier
    v_mfma_f32_16x16x32_bf16 v[0:3], v[128:131], v[192:195], v[0:3]
    ds_read_b128 v[208:211], v231 offset:8192
    v_mfma_f32_16x16x32_bf16 v[4:7], v[128:131], v[196:199], v[4:7]
    ds_read_b128 v[212:215], v231 offset:9216
    v_mfma_f32_16x16x32_bf16 v[8:11], v[128:131], v[200:203], v[8:11]
    ds_read_b128 v[216:219], v231 offset:10240
    v_mfma_f32_16x16x32_bf16 v[12:15], v[128:131], v[204:207], v[12:15]
    ds_read_b128 v[220:223], v231 offset:11264
    v_mfma_f32_16x16x32_bf16 v[76:79], v[144:147], v[204:207], v[76:79]
    ds_read_b64_tr_b16 v[160:161], v233 offset:0
    v_mfma_f32_16x16x32_bf16 v[72:75], v[144:147], v[200:203], v[72:75]
    s_add_u32 m0, s19, 3072
    s_nop 0
    buffer_load_dwordx4 v224, s[8:11], s16 offen lds
    v_mfma_f32_16x16x32_bf16 v[68:71], v[144:147], v[196:199], v[68:71]
    ds_read_b64_tr_b16 v[162:163], v233 offset:3584
    v_mfma_f32_16x16x32_bf16 v[64:67], v[144:147], v[192:195], v[64:67]
    ds_read_b64_tr_b16 v[176:177], v233 offset:14400
    v_mfma_f32_16x16x32_bf16 v[16:19], v[132:135], v[192:195], v[16:19]
    ds_read_b64_tr_b16 v[178:179], v233 offset:17984
    v_mfma_f32_16x16x32_bf16 v[20:23], v[132:135], v[196:199], v[20:23]
    ds_read_b64_tr_b16 v[164:165], v233 offset:32
    v_mfma_f32_16x16x32_bf16 v[24:27], v[132:135], v[200:203], v[24:27]
    ds_read_b64_tr_b16 v[166:167], v233 offset:3616
    v_mfma_f32_16x16x32_bf16 v[28:31], v[132:135], v[204:207], v[28:31]
    s_add_u32 m0, s19, 4096
    s_nop 0
    buffer_load_dwordx4 v225, s[8:11], s16 offen lds
    v_mfma_f32_16x16x32_bf16 v[92:95], v[148:151], v[204:207], v[92:95]
    v_mfma_f32_16x16x32_bf16 v[88:91], v[148:151], v[200:203], v[88:91]
    ds_read_b64_tr_b16 v[180:181], v233 offset:14432
    v_mfma_f32_16x16x32_bf16 v[84:87], v[148:151], v[196:199], v[84:87]
    ds_read_b64_tr_b16 v[182:183], v233 offset:18016
    v_mfma_f32_16x16x32_bf16 v[80:83], v[148:151], v[192:195], v[80:83]
    ds_read_b64_tr_b16 v[168:169], v233 offset:64
    v_mfma_f32_16x16x32_bf16 v[32:35], v[136:139], v[192:195], v[32:35]
    ds_read_b64_tr_b16 v[170:171], v233 offset:3648
    v_mfma_f32_16x16x32_bf16 v[36:39], v[136:139], v[196:199], v[36:39]
    ds_read_b64_tr_b16 v[184:185], v233 offset:14464
    v_mfma_f32_16x16x32_bf16 v[40:43], v[136:139], v[200:203], v[40:43]
    s_add_u32 m0, s19, 5120
    s_nop 0
    buffer_load_dwordx4 v226, s[8:11], s16 offen lds
    v_mfma_f32_16x16x32_bf16 v[44:47], v[136:139], v[204:207], v[44:47]
    ds_read_b64_tr_b16 v[186:187], v233 offset:18048
    v_mfma_f32_16x16x32_bf16 v[108:111], v[152:155], v[204:207], v[108:111]
    ds_read_b64_tr_b16 v[172:173], v233 offset:96
    v_mfma_f32_16x16x32_bf16 v[104:107], v[152:155], v[200:203], v[104:107]
    ds_read_b64_tr_b16 v[174:175], v233 offset:3680
    v_mfma_f32_16x16x32_bf16 v[100:103], v[152:155], v[196:199], v[100:103]
    ds_read_b64_tr_b16 v[188:189], v233 offset:14496
    v_mfma_f32_16x16x32_bf16 v[96:99], v[152:155], v[192:195], v[96:99]
    ds_read_b64_tr_b16 v[190:191], v233 offset:18080
    v_mfma_f32_16x16x32_bf16 v[48:51], v[140:143], v[192:195], v[48:51]
    s_add_u32 m0, s19, 6144
    s_nop 0
    buffer_load_dwordx4 v227, s[8:11], s16 offen lds
    s_add_u32 s16, s16, 229376
    s_cmp_eq_u32 s16, s18
    s_cselect_b32 s16, s17, s16
    v_mfma_f32_16x16x32_bf16 v[52:55], v[140:143], v[196:199], v[52:55]
    v_mfma_f32_16x16x32_bf16 v[56:59], v[140:143], v[200:203], v[56:59]
    v_mfma_f32_16x16x32_bf16 v[60:63], v[140:143], v[204:207], v[60:63]
    buffer_load_dword v248, v247, s[12:15], s34 offen
    s_add_u32 s34, s34, 1024
    v_mfma_f32_16x16x32_bf16 v[124:127], v[156:159], v[204:207], v[124:127]
    v_mfma_f32_16x16x32_bf16 v[120:123], v[156:159], v[200:203], v[120:123]
    v_mfma_f32_16x16x32_bf16 v[116:119], v[156:159], v[196:199], v[116:119]
    v_mfma_f32_16x16x32_bf16 v[112:115], v[156:159], v[192:195], v[112:115]
    s_waitcnt vmcnt(5) lgkmcnt(0)
    s_barrier
    v_mfma_f32_16x16x32_bf16 v[0:3], v[160:163], v[208:211], v[0:3]
    ds_read_b128 v[192:195], v231 offset:16384
    v_mfma_f32_16x16x32_bf16 v[4:7], v[160:163], v[212:215], v[4:7]
    ds_read_b128 v[196:199], v231 offset:17408
    v_mfma_f32_16x16x32_bf16 v[8:11], v[160:163], v[216:219], v[8:11]
    ds_read_b128 v[200:203], v231 offset:18432
    v_mfma_f32_16x16x32_bf16 v[12:15], v[160:163], v[220:223], v[12:15]
    ds_read_b128 v[204:207], v231 offset:19456
    v_mfma_f32_16x16x32_bf16 v[76:79], v[176:179], v[220:223], v[76:79]
    ds_read_b64_tr_b16 v[128:129], v233 offset:28800
    v_mfma_f32_16x16x32_bf16 v[72:75], v[176:179], v[216:219], v[72:75]
    s_add_u32 m0, s19, 31872
    s_nop 0
    buffer_load_dwordx4 v224, s[8:11], s16 offen lds
    v_mfma_f32_16x16x32_bf16 v[68:71], v[176:179], v[212:215], v[68:71]
    ds_read_b64_tr_b16 v[130:131], v233 offset:32384
    v_mfma_f32_16x16x32_bf16 v[64:67], v[176:179], v[208:211], v[64:67]
    ds_read_b64_tr_b16 v[144:145], v233 offset:43200
    v_mfma_f32_16x16x32_bf16 v[16:19], v[164:167], v[208:211], v[16:19]
    ds_read_b64_tr_b16 v[146:147], v233 offset:46784
    v_mfma_f32_16x16x32_bf16 v[20:23], v[164:167], v[212:215], v[20:23]
    ds_read_b64_tr_b16 v[132:133], v233 offset:28832
    v_mfma_f32_16x16x32_bf16 v[24:27], v[164:167], v[216:219], v[24:27]
    ds_read_b64_tr_b16 v[134:135], v233 offset:32416
    v_mfma_f32_16x16x32_bf16 v[28:31], v[164:167], v[220:223], v[28:31]
    s_add_u32 m0, s19, 32896
    s_nop 0
    buffer_load_dwordx4 v225, s[8:11], s16 offen lds
    v_mfma_f32_16x16x32_bf16 v[92:95], v[180:183], v[220:223], v[92:95]
    v_mfma_f32_16x16x32_bf16 v[88:91], v[180:183], v[216:219], v[88:91]
    ds_read_b64_tr_b16 v[148:149], v233 offset:43232
    v_mfma_f32_16x16x32_bf16 v[84:87], v[180:183], v[212:215], v[84:87]
    ds_read_b64_tr_b16 v[150:151], v233 offset:46816
    v_mfma_f32_16x16x32_bf16 v[80:83], v[180:183], v[208:211], v[80:83]
    ds_read_b64_tr_b16 v[136:137], v233 offset:28864
    v_mfma_f32_16x16x32_bf16 v[32:35], v[168:171], v[208:211], v[32:35]
    ds_read_b64_tr_b16 v[138:139], v233 offset:32448
    v_mfma_f32_16x16x32_bf16 v[36:39], v[168:171], v[212:215], v[36:39]
    ds_read_b64_tr_b16 v[152:153], v233 offset:43264
    v_mfma_f32_16x16x32_bf16 v[40:43], v[168:171], v[216:219], v[40:43]
    s_add_u32 m0, s19, 33920
    s_nop 0
    buffer_load_dwordx4 v226, s[8:11], s16 offen lds
    v_mfma_f32_16x16x32_bf16 v[44:47], v[168:171], v[220:223], v[44:47]
    ds_read_b64_tr_b16 v[154:155], v233 offset:46848
    v_mfma_f32_16x16x32_bf16 v[108:111], v[184:187], v[220:223], v[108:111]
    ds_read_b64_tr_b16 v[140:141], v233 offset:28896
    v_mfma_f32_16x16x32_bf16 v[104:107], v[184:187], v[216:219], v[104:107]
    ds_read_b64_tr_b16 v[142:143], v233 offset:32480
    v_mfma_f32_16x16x32_bf16 v[100:103], v[184:187], v[212:215], v[100:103]
    ds_read_b64_tr_b16 v[156:157], v233 offset:43296
    v_mfma_f32_16x16x32_bf16 v[96:99], v[184:187], v[208:211], v[96:99]
    ds_read_b64_tr_b16 v[158:159], v233 offset:46880
    v_mfma_f32_16x16x32_bf16 v[48:51], v[172:175], v[208:211], v[48:51]
    s_add_u32 m0, s19, 34944
    s_nop 0
    buffer_load_dwordx4 v227, s[8:11], s16 offen lds
    s_add_u32 s16, s16, 229376
    s_cmp_eq_u32 s16, s18
    s_cselect_b32 s16, s17, s16
    v_mfma_f32_16x16x32_bf16 v[52:55], v[172:175], v[212:215], v[52:55]
    v_mfma_f32_16x16x32_bf16 v[56:59], v[172:175], v[216:219], v[56:59]
    v_mfma_f32_16x16x32_bf16 v[60:63], v[172:175], v[220:223], v[60:63]
    v_mfma_f32_16x16x32_bf16 v[124:127], v[188:191], v[220:223], v[124:127]
    v_mfma_f32_16x16x32_bf16 v[120:123], v[188:191], v[216:219], v[120:123]
    v_mfma_f32_16x16x32_bf16 v[116:119], v[188:191], v[212:215], v[116:119]
    v_mfma_f32_16x16x32_bf16 v[112:115], v[188:191], v[208:211], v[112:115]
    s_waitcnt vmcnt(5) lgkmcnt(0)
    s_barrier
    v_mfma_f32_16x16x32_bf16 v[0:3], v[128:131], v[192:195], v[0:3]
    ds_read_b128 v[208:211], v231 offset:24576
    v_mfma_f32_16x16x32_bf16 v[4:7], v[128:131], v[196:199], v[4:7]
    ds_read_b128 v[212:215], v231 offset:25600
    v_mfma_f32_16x16x32_bf16 v[8:11], v[128:131], v[200:203], v[8:11]
    ds_read_b128 v[216:219], v231 offset:26624
    v_mfma_f32_16x16x32_bf16 v[12:15], v[128:131], v[204:207], v[12:15]
    ds_read_b128 v[220:223], v231 offset:27648
    v_mfma_f32_16x16x32_bf16 v[76:79], v[144:147], v[204:207], v[76:79]
    ds_read_b64_tr_b16 v[160:161], v232 offset:0
    v_mfma_f32_16x16x32_bf16 v[72:75], v[144:147], v[200:203], v[72:75]
    s_add_u32 m0, s19, 60672
    s_nop 0
    buffer_load_dwordx4 v224, s[8:11], s16 offen lds
    v_mfma_f32_16x16x32_bf16 v[68:71], v[144:147], v[196:199], v[68:71]
    ds_read_b64_tr_b16 v[162:163], v232 offset:3584
    v_mfma_f32_16x16x32_bf16 v[64:67], v[144:147], v[192:195], v[64:67]
    ds_read_b64_tr_b16 v[176:177], v232 offset:14400
    v_mfma_f32_16x16x32_bf16 v[16:19], v[132:135], v[192:195], v[16:19]
    ds_read_b64_tr_b16 v[178:179], v232 offset:17984
    v_mfma_f32_16x16x32_bf16 v[20:23], v[132:135], v[196:199], v[20:23]
    ds_read_b64_tr_b16 v[164:165], v232 offset:32
    v_mfma_f32_16x16x32_bf16 v[24:27], v[132:135], v[200:203], v[24:27]
    ds_read_b64_tr_b16 v[166:167], v232 offset:3616
    v_mfma_f32_16x16x32_bf16 v[28:31], v[132:135], v[204:207], v[28:31]
    s_add_u32 m0, s19, 61696
    s_nop 0
    buffer_load_dwordx4 v225, s[8:11], s16 offen lds
    v_mfma_f32_16x16x32_bf16 v[92:95], v[148:151], v[204:207], v[92:95]
    v_mfma_f32_16x16x32_bf16 v[88:91], v[148:151], v[200:203], v[88:91]
    ds_read_b64_tr_b16 v[180:181], v232 offset:14432
    v_mfma_f32_16x16x32_bf16 v[84:87], v[148:151], v[196:199], v[84:87]
    ds_read_b64_tr_b16 v[182:183], v232 offset:18016
    v_mfma_f32_16x16x32_bf16 v[80:83], v[148:151], v[192:195], v[80:83]
    ds_read_b64_tr_b16 v[168:169], v232 offset:64
    v_mfma_f32_16x16x32_bf16 v[32:35], v[136:139], v[192:195], v[32:35]
    ds_read_b64_tr_b16 v[170:171], v232 offset:3648
    v_mfma_f32_16x16x32_bf16 v[36:39], v[136:139], v[196:199], v[36:39]
    ds_read_b64_tr_b16 v[184:185], v232 offset:14464
    v_mfma_f32_16x16x32_bf16 v[40:43], v[136:139], v[200:203], v[40:43]
    s_add_u32 m0, s19, 62720
    s_nop 0
    buffer_load_dwordx4 v226, s[8:11], s16 offen lds
    v_mfma_f32_16x16x32_bf16 v[44:47], v[136:139], v[204:207], v[44:47]
    ds_read_b64_tr_b16 v[186:187], v232 offset:18048
    v_mfma_f32_16x16x32_bf16 v[108:111], v[152:155], v[204:207], v[108:111]
    ds_read_b64_tr_b16 v[172:173], v232 offset:96
    v_mfma_f32_16x16x32_bf16 v[104:107], v[152:155], v[200:203], v[104:107]
    ds_read_b64_tr_b16 v[174:175], v232 offset:3680
    v_mfma_f32_16x16x32_bf16 v[100:103], v[152:155], v[196:199], v[100:103]
    ds_read_b64_tr_b16 v[188:189], v232 offset:14496
    v_mfma_f32_16x16x32_bf16 v[96:99], v[152:155], v[192:195], v[96:99]
    ds_read_b64_tr_b16 v[190:191], v232 offset:18080
    v_mfma_f32_16x16x32_bf16 v[48:51], v[140:143], v[192:195], v[48:51]
    s_add_u32 m0, s19, 63744
    s_nop 0
    buffer_load_dwordx4 v227, s[8:11], s16 offen lds
    s_add_u32 s16, s16, 229376
    s_cmp_eq_u32 s16, s18
    s_cselect_b32 s16, s17, s16
    v_mfma_f32_16x16x32_bf16 v[52:55], v[140:143], v[196:199], v[52:55]
    v_mfma_f32_16x16x32_bf16 v[56:59], v[140:143], v[200:203], v[56:59]
    v_mfma_f32_16x16x32_bf16 v[60:63], v[140:143], v[204:207], v[60:63]
    v_mfma_f32_16x16x32_bf16 v[124:127], v[156:159], v[204:207], v[124:127]
    v_mfma_f32_16x16x32_bf16 v[120:123], v[156:159], v[200:203], v[120:123]
    v_mfma_f32_16x16x32_bf16 v[116:119], v[156:159], v[196:199], v[116:119]
    v_mfma_f32_16x16x32_bf16 v[112:115], v[156:159], v[192:195], v[112:115]
    s_waitcnt vmcnt(4) lgkmcnt(0)
    s_barrier
    v_mfma_f32_16x16x32_bf16 v[0:3], v[160:163], v[208:211], v[0:3]
    ds_read_b128 v[192:195], v231 offset:0
    v_mfma_f32_16x16x32_bf16 v[4:7], v[160:163], v[212:215], v[4:7]
    ds_read_b128 v[196:199], v231 offset:1024
    v_mfma_f32_16x16x32_bf16 v[8:11], v[160:163], v[216:219], v[8:11]
    ds_read_b128 v[200:203], v231 offset:2048
    v_mfma_f32_16x16x32_bf16 v[12:15], v[160:163], v[220:223], v[12:15]
    ds_read_b128 v[204:207], v231 offset:3072
    v_mfma_f32_16x16x32_bf16 v[76:79], v[176:179], v[220:223], v[76:79]
    ds_read_b64_tr_b16 v[128:129], v232 offset:28800
    v_mfma_f32_16x16x32_bf16 v[72:75], v[176:179], v[216:219], v[72:75]
    s_add_u32 m0, s19, 89472
    s_nop 0
    buffer_load_dwordx4 v224, s[8:11], s16 offen lds
    v_mfma_f32_16x16x32_bf16 v[68:71], v[176:179], v[212:215], v[68:71]
    ds_read_b64_tr_b16 v[130:131], v232 offset:32384
    v_mfma_f32_16x16x32_bf16 v[64:67], v[176:179], v[208:211], v[64:67]
    ds_read_b64_tr_b16 v[144:145], v232 offset:43200
    v_mfma_f32_16x16x32_bf16 v[16:19], v[164:167], v[208:211], v[16:19]
    ds_read_b64_tr_b16 v[146:147], v232 offset:46784
    v_mfma_f32_16x16x32_bf16 v[20:23], v[164:167], v[212:215], v[20:23]
    ds_read_b64_tr_b16 v[132:133], v232 offset:28832
    v_mfma_f32_16x16x32_bf16 v[24:27], v[164:167], v[216:219], v[24:27]
    ds_read_b64_tr_b16 v[134:135], v232 offset:32416
    v_mfma_f32_16x16x32_bf16 v[28:31], v[164:167], v[220:223], v[28:31]
    s_add_u32 m0, s19, 90496
    s_nop 0
    buffer_load_dwordx4 v225, s[8:11], s16 offen lds
    v_mfma_f32_16x16x32_bf16 v[92:95], v[180:183], v[220:223], v[92:95]
    v_mfma_f32_16x16x32_bf16 v[88:91], v[180:183], v[216:219], v[88:91]
    ds_read_b64_tr_b16 v[148:149], v232 offset:43232
    v_mfma_f32_16x16x32_bf16 v[84:87], v[180:183], v[212:215], v[84:87]
    ds_read_b64_tr_b16 v[150:151], v232 offset:46816
    v_mfma_f32_16x16x32_bf16 v[80:83], v[180:183], v[208:211], v[80:83]
    ds_read_b64_tr_b16 v[136:137], v232 offset:28864
    v_mfma_f32_16x16x32_bf16 v[32:35], v[168:171], v[208:211], v[32:35]
    ds_read_b64_tr_b16 v[138:139], v232 offset:32448
    v_mfma_f32_16x16x32_bf16 v[36:39], v[168:171], v[212:215], v[36:39]
    ds_read_b64_tr_b16 v[152:153], v232 offset:43264
    v_mfma_f32_16x16x32_bf16 v[40:43], v[168:171], v[216:219], v[40:43]
    s_add_u32 m0, s19, 91520
    s_nop 0
    buffer_load_dwordx4 v226, s[8:11], s16 offen lds
    v_mfma_f32_16x16x32_bf16 v[44:47], v[168:171], v[220:223], v[44:47]
    ds_read_b64_tr_b16 v[154:155], v232 offset:46848
    v_mfma_f32_16x16x32_bf16 v[108:111], v[184:187], v[220:223], v[108:111]
    ds_read_b64_tr_b16 v[140:141], v232 offset:28896
    v_mfma_f32_16x16x32_bf16 v[104:107], v[184:187], v[216:219], v[104:107]
    ds_read_b64_tr_b16 v[142:143], v232 offset:32480
    v_mfma_f32_16x16x32_bf16 v[100:103], v[184:187], v[212:215], v[100:103]
    ds_read_b64_tr_b16 v[156:157], v232 offset:43296
    v_mfma_f32_16x16x32_bf16 v[96:99], v[184:187], v[208:211], v[96:99]
    ds_read_b64_tr_b16 v[158:159], v232 offset:46880
    v_mfma_f32_16x16x32_bf16 v[48:51], v[172:175], v[208:211], v[48:51]
    s_add_u32 m0, s19, 92544
    s_nop 0
    buffer_load_dwordx4 v227, s[8:11], s16 offen lds
    s_add_u32 s16, s16, 229376
    s_cmp_eq_u32 s16, s18
    s_cselect_b32 s16, s17, s16
    v_mfma_f32_16x16x32_bf16 v[52:55], v[172:175], v[212:215], v[52:55]
    v_mfma_f32_16x16x32_bf16 v[56:59], v[172:175], v[216:219], v[56:59]
    v_mfma_f32_16x16x32_bf16 v[60:63], v[172:175], v[220:223], v[60:63]
    v_mfma_f32_16x16x32_bf16 v[124:127], v[188:191], v[220:223], v[124:127]
    v_mfma_f32_16x16x32_bf16 v[120:123], v[188:191], v[216:219], v[120:123]
    v_mfma_f32_16x16x32_bf16 v[116:119], v[188:191], v[212:215], v[116:119]
    v_mfma_f32_16x16x32_bf16 v[112:115], v[188:191], v[208:211], v[112:115]
    s_sub_u32 s24, s24, 1
    s_cmp_lg_u32 s24, 0
    s_cbranch_scc1 g3c0_loop
    s_sub_u32 s27, s74, s58
    s_and_b32 s27, s27, 7
    s_cmp_lt_u32 s27, 4
    s_cselect_b32 s27, 14, 0
    s_waitcnt vmcnt(4) lgkmcnt(0)
    s_barrier
    v_mfma_f32_16x16x32_bf16 v[0:3], v[128:131], v[192:195], v[0:3]
    ds_read_b128 v[208:211], v231 offset:8192
    v_mfma_f32_16x16x32_bf16 v[4:7], v[128:131], v[196:199], v[4:7]
    ds_read_b128 v[212:215], v231 offset:9216
    v_mfma_f32_16x16x32_bf16 v[8:11], v[128:131], v[200:203], v[8:11]
    ds_read_b128 v[216:219], v231 offset:10240
    v_mfma_f32_16x16x32_bf16 v[12:15], v[128:131], v[204:207], v[12:15]
    ds_read_b128 v[220:223], v231 offset:11264
    v_mfma_f32_16x16x32_bf16 v[76:79], v[144:147], v[204:207], v[76:79]
    ds_read_b64_tr_b16 v[160:161], v233 offset:0
    v_mfma_f32_16x16x32_bf16 v[72:75], v[144:147], v[200:203], v[72:75]
    s_add_u32 m0, s19, 3072
    s_nop 0
    buffer_load_dwordx4 v224, s[8:11], s16 offen lds
    v_mfma_f32_16x16x32_bf16 v[68:71], v[144:147], v[196:199], v[68:71]
    ds_read_b64_tr_b16 v[162:163], v233 offset:3584
    v_mfma_f32_16x16x32_bf16 v[64:67], v[144:147], v[192:195], v[64:67]
    ds_read_b64_tr_b16 v[176:177], v233 offset:14400
    v_mfma_f32_16x16x32_bf16 v[16:19], v[132:135], v[192:195], v[16:19]
    ds_read_b64_tr_b16 v[178:179], v233 offset:17984
    v_mfma_f32_16x16x32_bf16 v[20:23], v[132:135], v[196:199], v[20:23]
    ds_read_b64_tr_b16 v[164:165], v233 offset:32
    v_mfma_f32_16x16x32_bf16 v[24:27], v[132:135], v[200:203], v[24:27]
    ds_read_b64_tr_b16 v[166:167], v233 offset:3616
    v_mfma_f32_16x16x32_bf16 v[28:31], v[132:135], v[204:207], v[28:31]
    s_add_u32 m0, s19, 4096
    s_nop 0
    buffer_load_dwordx4 v225, s[8:11], s16 offen lds
    v_mfma_f32_16x16x32_bf16 v[92:95], v[148:151], v[204:207], v[92:95]
    v_mfma_f32_16x16x32_bf16 v[88:91], v[148:151], v[200:203], v[88:91]
    ds_read_b64_tr_b16 v[180:181], v233 offset:14432
    v_mfma_f32_16x16x32_bf16 v[84:87], v[148:151], v[196:199], v[84:87]
    ds_read_b64_tr_b16 v[182:183], v233 offset:18016
    v_mfma_f32_16x16x32_bf16 v[80:83], v[148:151], v[192:195], v[80:83]
    ds_read_b64_tr_b16 v[168:169], v233 offset:64
    v_mfma_f32_16x16x32_bf16 v[32:35], v[136:139], v[192:195], v[32:35]
    ds_read_b64_tr_b16 v[170:171], v233 offset:3648
    v_mfma_f32_16x16x32_bf16 v[36:39], v[136:139], v[196:199], v[36:39]
    ds_read_b64_tr_b16 v[184:185], v233 offset:14464
    v_mfma_f32_16x16x32_bf16 v[40:43], v[136:139], v[200:203], v[40:43]
    s_add_u32 m0, s19, 5120
    s_nop 0
    buffer_load_dwordx4 v226, s[8:11], s16 offen lds
    v_mfma_f32_16x16x32_bf16 v[44:47], v[136:139], v[204:207], v[44:47]
    ds_read_b64_tr_b16 v[186:187], v233 offset:18048
    v_mfma_f32_16x16x32_bf16 v[108:111], v[152:155], v[204:207], v[108:111]
    ds_read_b64_tr_b16 v[172:173], v233 offset:96
    v_mfma_f32_16x16x32_bf16 v[104:107], v[152:155], v[200:203], v[104:107]
    ds_read_b64_tr_b16 v[174:175], v233 offset:3680
    v_mfma_f32_16x16x32_bf16 v[100:103], v[152:155], v[196:199], v[100:103]
    ds_read_b64_tr_b16 v[188:189], v233 offset:14496
    v_mfma_f32_16x16x32_bf16 v[96:99], v[152:155], v[192:195], v[96:99]
    ds_read_b64_tr_b16 v[190:191], v233 offset:18080
    v_mfma_f32_16x16x32_bf16 v[48:51], v[140:143], v[192:195], v[48:51]
    s_add_u32 m0, s19, 6144
    s_nop 0
    buffer_load_dwordx4 v227, s[8:11], s16 offen lds
    s_add_u32 s16, s16, 229376
    s_cmp_eq_u32 s16, s18
    s_cselect_b32 s16, s17, s16
    v_mfma_f32_16x16x32_bf16 v[52:55], v[140:143], v[196:199], v[52:55]
    v_mfma_f32_16x16x32_bf16 v[56:59], v[140:143], v[200:203], v[56:59]
    v_mfma_f32_16x16x32_bf16 v[60:63], v[140:143], v[204:207], v[60:63]
    v_mfma_f32_16x16x32_bf16 v[124:127], v[156:159], v[204:207], v[124:127]
    v_mfma_f32_16x16x32_bf16 v[120:123], v[156:159], v[200:203], v[120:123]
    v_mfma_f32_16x16x32_bf16 v[116:119], v[156:159], v[196:199], v[116:119]
    v_mfma_f32_16x16x32_bf16 v[112:115], v[156:159], v[192:195], v[112:115]
    s_waitcnt vmcnt(4) lgkmcnt(0)
    s_barrier
    v_mfma_f32_16x16x32_bf16 v[0:3], v[160:163], v[208:211], v[0:3]
    ds_read_b128 v[192:195], v231 offset:16384
    v_mfma_f32_16x16x32_bf16 v[4:7], v[160:163], v[212:215], v[4:7]
    ds_read_b128 v[196:199], v231 offset:17408
    v_lshlrev_b32 v247, 7, v250
    s_add_u32 s29, s3, 0
    s_lshl_b32 s30, s29, 12
    s_add_u32 s30, s30, s25
    s_cmp_lt_u32 s29, s27
    s_cselect_b32 s30, s30, 0x7f000000
    s_mov_b64 exec, 0xffffffff
    buffer_load_dword v248, v247, s[80:83], s30 offen sc1
    s_mov_b64 exec, -1
    v_mfma_f32_16x16x32_bf16 v[8:11], v[160:163], v[216:219], v[8:11]
    ds_read_b128 v[200:203], v231 offset:18432
    v_mfma_f32_16x16x32_bf16 v[12:15], v[160:163], v[220:223], v[12:15]
    ds_read_b128 v[204:207], v231 offset:19456
    v_mfma_f32_16x16x32_bf16 v[76:79], v[176:179], v[220:223], v[76:79]
    v_mfma_f32_16x16x32_bf16 v[72:75], v[176:179], v[216:219], v[72:75]
    ds_read_b64_tr_b16 v[128:129], v233 offset:28800
    v_mfma_f32_16x16x32_bf16 v[68:71], v[176:179], v[212:215], v[68:71]
    ds_read_b64_tr_b16 v[130:131], v233 offset:32384
    v_mfma_f32_16x16x32_bf16 v[64:67], v[176:179], v[208:211], v[64:67]
    ds_read_b64_tr_b16 v[144:145], v233 offset:43200
    v_mfma_f32_16x16x32_bf16 v[16:19], v[164:167], v[208:211], v[16:19]
    v_mfma_f32_16x16x32_bf16 v[20:23], v[164:167], v[212:215], v[20:23]
    ds_read_b64_tr_b16 v[146:147], v233 offset:46784
    v_mfma_f32_16x16x32_bf16 v[24:27], v[164:167], v[216:219], v[24:27]
    ds_read_b64_tr_b16 v[132:133], v233 offset:28832
    v_mfma_f32_16x16x32_bf16 v[28:31], v[164:167], v[220:223], v[28:31]
    ds_read_b64_tr_b16 v[134:135], v233 offset:32416
    v_mfma_f32_16x16x32_bf16 v[92:95], v[180:183], v[220:223], v[92:95]
    v_mfma_f32_16x16x32_bf16 v[88:91], v[180:183], v[216:219], v[88:91]
    ds_read_b64_tr_b16 v[148:149], v233 offset:43232
    v_mfma_f32_16x16x32_bf16 v[84:87], v[180:183], v[212:215], v[84:87]
    ds_read_b64_tr_b16 v[150:151], v233 offset:46816
    v_mfma_f32_16x16x32_bf16 v[80:83], v[180:183], v[208:211], v[80:83]
    ds_read_b64_tr_b16 v[136:137], v233 offset:28864
    v_mfma_f32_16x16x32_bf16 v[32:35], v[168:171], v[208:211], v[32:35]
    ds_read_b64_tr_b16 v[138:139], v233 offset:32448
    v_mfma_f32_16x16x32_bf16 v[36:39], v[168:171], v[212:215], v[36:39]
    v_lshlrev_b32 v247, 7, v250
    s_add_u32 s29, s3, 8
    s_lshl_b32 s30, s29, 12
    s_add_u32 s30, s30, s25
    s_cmp_lt_u32 s29, s27
    s_cselect_b32 s30, s30, 0x7f000000
    s_mov_b64 exec, 0xffffffff
    buffer_load_dword v248, v247, s[80:83], s30 offen sc1
    s_mov_b64 exec, -1
    v_mfma_f32_16x16x32_bf16 v[40:43], v[168:171], v[216:219], v[40:43]
    ds_read_b64_tr_b16 v[152:153], v233 offset:43264
    v_mfma_f32_16x16x32_bf16 v[44:47], v[168:171], v[220:223], v[44:47]
    ds_read_b64_tr_b16 v[154:155], v233 offset:46848
    v_mfma_f32_16x16x32_bf16 v[108:111], v[184:187], v[220:223], v[108:111]
    ds_read_b64_tr_b16 v[140:141], v233 offset:28896
    v_mfma_f32_16x16x32_bf16 v[104:107], v[184:187], v[216:219], v[104:107]
    v_mfma_f32_16x16x32_bf16 v[100:103], v[184:187], v[212:215], v[100:103]
    ds_read_b64_tr_b16 v[142:143], v233 offset:32480
    v_mfma_f32_16x16x32_bf16 v[96:99], v[184:187], v[208:211], v[96:99]
    ds_read_b64_tr_b16 v[156:157], v233 offset:43296
    v_mfma_f32_16x16x32_bf16 v[48:51], v[172:175], v[208:211], v[48:51]
    ds_read_b64_tr_b16 v[158:159], v233 offset:46880
    v_mfma_f32_16x16x32_bf16 v[52:55], v[172:175], v[212:215], v[52:55]
    v_mfma_f32_16x16x32_bf16 v[56:59], v[172:175], v[216:219], v[56:59]
    v_mfma_f32_16x16x32_bf16 v[60:63], v[172:175], v[220:223], v[60:63]
    v_mfma_f32_16x16x32_bf16 v[124:127], v[188:191], v[220:223], v[124:127]
    v_mfma_f32_16x16x32_bf16 v[120:123], v[188:191], v[216:219], v[120:123]
    v_mfma_f32_16x16x32_bf16 v[116:119], v[188:191], v[212:215], v[116:119]
    v_mfma_f32_16x16x32_bf16 v[112:115], v[188:191], v[208:211], v[112:115]
    s_waitcnt vmcnt(2) lgkmcnt(0)
    s_barrier
    s_setprio 2
    v_mfma_f32_16x16x32_bf16 v[0:3], v[128:131], v[192:195], v[0:3]
    ds_read_b128 v[208:211], v231 offset:24576
    ds_read_b128 v[212:215], v231 offset:25600
    v_mfma_f32_16x16x32_bf16 v[4:7], v[128:131], v[196:199], v[4:7]
    ds_read_b128 v[216:219], v231 offset:26624
    v_mfma_f32_16x16x32_bf16 v[8:11], v[128:131], v[200:203], v[8:11]
    ds_read_b128 v[220:223], v231 offset:27648
    ds_read_b64_tr_b16 v[160:161], v232 offset:0
    v_mfma_f32_16x16x32_bf16 v[12:15], v[128:131], v[204:207], v[12:15]
    ds_read_b64_tr_b16 v[162:163], v232 offset:3584
    v_mfma_f32_16x16x32_bf16 v[76:79], v[144:147], v[204:207], v[76:79]
    ds_read_b64_tr_b16 v[176:177], v232 offset:14400
    ds_read_b64_tr_b16 v[178:179], v232 offset:17984
    v_mfma_f32_16x16x32_bf16 v[72:75], v[144:147], v[200:203], v[72:75]
    ds_read_b64_tr_b16 v[164:165], v232 offset:32
    v_mfma_f32_16x16x32_bf16 v[68:71], v[144:147], v[196:199], v[68:71]
    ds_read_b64_tr_b16 v[166:167], v232 offset:3616
    v_mfma_f32_16x16x32_bf16 v[64:67], v[144:147], v[192:195], v[64:67]
    ds_read_b64_tr_b16 v[180:181], v232 offset:14432
    ds_read_b64_tr_b16 v[182:183], v232 offset:18016
    v_mfma_f32_16x16x32_bf16 v[16:19], v[132:135], v[192:195], v[16:19]
    ds_read_b64_tr_b16 v[168:169], v232 offset:64
    v_mfma_f32_16x16x32_bf16 v[20:23], v[132:135], v[196:199], v[20:23]
    ds_read_b64_tr_b16 v[170:171], v232 offset:3648
    ds_read_b64_tr_b16 v[184:185], v232 offset:14464
    v_mfma_f32_16x16x32_bf16 v[24:27], v[132:135], v[200:203], v[24:27]
    ds_read_b64_tr_b16 v[186:187], v232 offset:18048
    v_mfma_f32_16x16x32_bf16 v[28:31], v[132:135], v[204:207], v[28:31]
    ds_read_b64_tr_b16 v[172:173], v232 offset:96
    ds_read_b64_tr_b16 v[174:175], v232 offset:3680
    v_mfma_f32_16x16x32_bf16 v[92:95], v[148:151], v[204:207], v[92:95]
    ds_read_b64_tr_b16 v[188:189], v232 offset:14496
    v_mfma_f32_16x16x32_bf16 v[88:91], v[148:151], v[200:203], v[88:91]
    ds_read_b64_tr_b16 v[190:191], v232 offset:18080
    v_mfma_f32_16x16x32_bf16 v[84:87], v[148:151], v[196:199], v[84:87]
    v_mfma_f32_16x16x32_bf16 v[80:83], v[148:151], v[192:195], v[80:83]
    v_mfma_f32_16x16x32_bf16 v[32:35], v[136:139], v[192:195], v[32:35]
    v_mfma_f32_16x16x32_bf16 v[36:39], v[136:139], v[196:199], v[36:39]
    v_mfma_f32_16x16x32_bf16 v[40:43], v[136:139], v[200:203], v[40:43]
    v_mfma_f32_16x16x32_bf16 v[44:47], v[136:139], v[204:207], v[44:47]
    v_mfma_f32_16x16x32_bf16 v[108:111], v[152:155], v[204:207], v[108:111]
    s_waitcnt lgkmcnt(0)
    s_barrier
    v_mfma_f32_16x16x32_bf16 v[104:107], v[152:155], v[200:203], v[104:107]
    v_mfma_f32_16x16x32_bf16 v[100:103], v[152:155], v[196:199], v[100:103]
    v_mfma_f32_16x16x32_bf16 v[96:99], v[152:155], v[192:195], v[96:99]
    v_mfma_f32_16x16x32_bf16 v[48:51], v[140:143], v[192:195], v[48:51]
    v_mfma_f32_16x16x32_bf16 v[52:55], v[140:143], v[196:199], v[52:55]
    v_mfma_f32_16x16x32_bf16 v[56:59], v[140:143], v[200:203], v[56:59]
    v_mfma_f32_16x16x32_bf16 v[60:63], v[140:143], v[204:207], v[60:63]
    v_mfma_f32_16x16x32_bf16 v[124:127], v[156:159], v[204:207], v[124:127]
    v_mfma_f32_16x16x32_bf16 v[120:123], v[156:159], v[200:203], v[120:123]
    v_mfma_f32_16x16x32_bf16 v[116:119], v[156:159], v[196:199], v[116:119]
    v_mfma_f32_16x16x32_bf16 v[112:115], v[156:159], v[192:195], v[112:115]
    s_and_b32 s64, s3, 1
    s_lshl_b32 s64, s64, 9
    s_add_u32 s64, s64, 159744
    v_lshlrev_b32 v253, 3, v252
    v_add_u32 v253, s64, v253
    s_lshl_b32 s64, s28, 6
    s_add_u32 s64, s64, 160896
    v_lshlrev_b32 v254, 4, v251
    v_add_u32 v231, s64, v254
    v_mfma_f32_16x16x32_bf16 v[0:3], v[160:163], v[208:211], v[0:3]
    ds_read_b64 v[192:193], v253 offset:0
    v_mfma_f32_16x16x32_bf16 v[4:7], v[160:163], v[212:215], v[4:7]
    ds_read_b64 v[194:195], v253 offset:128
    v_mfma_f32_16x16x32_bf16 v[8:11], v[160:163], v[216:219], v[8:11]
    ds_read_b64 v[196:197], v253 offset:256
    v_mfma_f32_16x16x32_bf16 v[12:15], v[160:163], v[220:223], v[12:15]
    v_mfma_f32_16x16x32_bf16 v[76:79], v[176:179], v[220:223], v[76:79]
    ds_read_b64 v[198:199], v253 offset:384
    v_mfma_f32_16x16x32_bf16 v[72:75], v[176:179], v[216:219], v[72:75]
    ds_read_b128 v[128:131], v231 offset:0
    v_mfma_f32_16x16x32_bf16 v[68:71], v[176:179], v[212:215], v[68:71]
    v_mfma_f32_16x16x32_bf16 v[64:67], v[176:179], v[208:211], v[64:67]
    ds_read_b128 v[132:135], v231 offset:64
    v_mfma_f32_16x16x32_bf16 v[16:19], v[164:167], v[208:211], v[16:19]
    ds_read_b128 v[136:139], v231 offset:128
    v_mfma_f32_16x16x32_bf16 v[20:23], v[164:167], v[212:215], v[20:23]
    ds_read_b128 v[140:143], v231 offset:192
    v_mfma_f32_16x16x32_bf16 v[24:27], v[164:167], v[216:219], v[24:27]
    v_mfma_f32_16x16x32_bf16 v[28:31], v[164:167], v[220:223], v[28:31]
    ds_read_b128 v[144:147], v231 offset:896
    v_mfma_f32_16x16x32_bf16 v[92:95], v[180:183], v[220:223], v[92:95]
    ds_read_b128 v[148:151], v231 offset:960
    v_mfma_f32_16x16x32_bf16 v[88:91], v[180:183], v[216:219], v[88:91]
    v_mfma_f32_16x16x32_bf16 v[84:87], v[180:183], v[212:215], v[84:87]
    ds_read_b128 v[152:155], v231 offset:1024
    v_mfma_f32_16x16x32_bf16 v[80:83], v[180:183], v[208:211], v[80:83]
    ds_read_b128 v[156:159], v231 offset:1088
    v_mfma_f32_16x16x32_bf16 v[32:35], v[168:171], v[208:211], v[32:35]
    v_mfma_f32_16x16x32_bf16 v[36:39], v[168:171], v[212:215], v[36:39]
    v_mfma_f32_16x16x32_bf16 v[40:43], v[168:171], v[216:219], v[40:43]
    v_mfma_f32_16x16x32_bf16 v[44:47], v[168:171], v[220:223], v[44:47]
    v_mfma_f32_16x16x32_bf16 v[108:111], v[184:187], v[220:223], v[108:111]
    v_mfma_f32_16x16x32_bf16 v[104:107], v[184:187], v[216:219], v[104:107]
    v_mfma_f32_16x16x32_bf16 v[100:103], v[184:187], v[212:215], v[100:103]
    v_mfma_f32_16x16x32_bf16 v[96:99], v[184:187], v[208:211], v[96:99]
    v_mfma_f32_16x16x32_bf16 v[48:51], v[172:175], v[208:211], v[48:51]
    v_mfma_f32_16x16x32_bf16 v[52:55], v[172:175], v[212:215], v[52:55]
    v_mfma_f32_16x16x32_bf16 v[56:59], v[172:175], v[216:219], v[56:59]
    v_mfma_f32_16x16x32_bf16 v[60:63], v[172:175], v[220:223], v[60:63]
    v_mfma_f32_16x16x32_bf16 v[124:127], v[188:191], v[220:223], v[124:127]
    v_mfma_f32_16x16x32_bf16 v[120:123], v[188:191], v[216:219], v[120:123]
    v_mfma_f32_16x16x32_bf16 v[116:119], v[188:191], v[212:215], v[116:119]
    v_mfma_f32_16x16x32_bf16 v[112:115], v[188:191], v[208:211], v[112:115]
    s_setprio 0
    s_and_b32 s64, s3, 1
    s_lshl_b32 s64, s64, 12
    s_add_u32 s25, s25, s64
    s_lshr_b32 s64, s69, 1
    s_lshl_b32 s64, s64, 14
    s_add_u32 s25, s25, s64
    s_add_u32 s26, s25, 8192
    s_and_b32 s64, s3, 1
    s_lshl_b32 s64, s64, 12
    s_lshr_b32 s65, s69, 1
    s_lshl_b32 s65, s65, 14
    s_add_u32 s64, s64, s65
    v_add_u32 v233, s64, v249
    v_add_u16 v232, 0xe000, v233
    s_waitcnt lgkmcnt(0)
    s_mov_b32 s64, 0xbfb8aa3b
    v_mul_f32 v176, v193, v193
    v_sub_f32 v160, 0, v192
    v_mul_f32 v168, s64, v193
    v_sub_f32 v161, 0, v192
    v_mul_f32 v169, s64, v193
    v_mul_f32 v178, v195, v195
    v_sub_f32 v162, 0, v194
    v_mul_f32 v170, s64, v195
    v_sub_f32 v163, 0, v194
    v_mul_f32 v171, s64, v195
    v_mul_f32 v180, v197, v197
    v_sub_f32 v164, 0, v196
    v_mul_f32 v172, s64, v197
    v_sub_f32 v165, 0, v196
    v_mul_f32 v173, s64, v197
    v_mul_f32 v182, v199, v199
    v_sub_f32 v166, 0, v198
    v_mul_f32 v174, s64, v199
    v_sub_f32 v167, 0, v198
    v_mul_f32 v175, s64, v199
    v_rcp_f32 v177, v176
    v_rcp_f32 v176, v176
    v_rcp_f32 v179, v178
    v_rcp_f32 v178, v178
    v_rcp_f32 v181, v180
    v_rcp_f32 v180, v180
    v_rcp_f32 v183, v182
    v_rcp_f32 v182, v182
    v_pk_fma_f32 v[0:1], v[160:161], v[128:129], v[0:1]
    v_pk_fma_f32 v[2:3], v[160:161], v[130:131], v[2:3]
    v_pk_fma_f32 v[16:17], v[160:161], v[132:133], v[16:17]
    v_pk_fma_f32 v[18:19], v[160:161], v[134:135], v[18:19]
    v_pk_fma_f32 v[32:33], v[160:161], v[136:137], v[32:33]
    v_pk_fma_f32 v[34:35], v[160:161], v[138:139], v[34:35]
    v_pk_fma_f32 v[48:49], v[160:161], v[140:141], v[48:49]
    v_pk_fma_f32 v[50:51], v[160:161], v[142:143], v[50:51]
    v_pk_mul_f32 v[200:201], v[168:169], v[0:1]
    v_pk_mul_f32 v[202:203], v[168:169], v[2:3]
    v_pk_mul_f32 v[204:205], v[168:169], v[16:17]
    v_pk_mul_f32 v[206:207], v[168:169], v[18:19]
    v_pk_mul_f32 v[208:209], v[168:169], v[32:33]
    v_pk_mul_f32 v[210:211], v[168:169], v[34:35]
    v_pk_mul_f32 v[212:213], v[168:169], v[48:49]
    v_pk_mul_f32 v[214:215], v[168:169], v[50:51]
    v_exp_f32 v200, v200
    v_exp_f32 v201, v201
    v_exp_f32 v202, v202
    v_exp_f32 v203, v203
    v_exp_f32 v204, v204
    v_exp_f32 v205, v205
    v_exp_f32 v206, v206
    v_exp_f32 v207, v207
    v_exp_f32 v208, v208
    v_exp_f32 v209, v209
    v_exp_f32 v210, v210
    v_exp_f32 v211, v211
    v_exp_f32 v212, v212
    v_exp_f32 v213, v213
    v_exp_f32 v214, v214
    v_exp_f32 v215, v215
    v_pk_fma_f32 v[64:65], v[160:161], v[144:145], v[64:65]
    v_pk_fma_f32 v[66:67], v[160:161], v[146:147], v[66:67]
    v_pk_fma_f32 v[80:81], v[160:161], v[148:149], v[80:81]
    v_pk_fma_f32 v[82:83], v[160:161], v[150:151], v[82:83]
    v_pk_fma_f32 v[96:97], v[160:161], v[152:153], v[96:97]
    v_pk_fma_f32 v[98:99], v[160:161], v[154:155], v[98:99]
    v_pk_fma_f32 v[112:113], v[160:161], v[156:157], v[112:113]
    v_pk_fma_f32 v[114:115], v[160:161], v[158:159], v[114:115]
    v_pk_fma_f32 v[200:201], v[200:201], v[176:177], v[176:177]
    v_pk_fma_f32 v[202:203], v[202:203], v[176:177], v[176:177]
    v_pk_fma_f32 v[204:205], v[204:205], v[176:177], v[176:177]
    v_pk_fma_f32 v[206:207], v[206:207], v[176:177], v[176:177]
    v_pk_fma_f32 v[208:209], v[208:209], v[176:177], v[176:177]
    v_pk_fma_f32 v[210:211], v[210:211], v[176:177], v[176:177]
    v_pk_fma_f32 v[212:213], v[212:213], v[176:177], v[176:177]
    v_pk_fma_f32 v[214:215], v[214:215], v[176:177], v[176:177]
    v_rcp_f32 v200, v200
    v_rcp_f32 v201, v201
    v_rcp_f32 v202, v202
    v_rcp_f32 v203, v203
    v_rcp_f32 v204, v204
    v_rcp_f32 v205, v205
    v_rcp_f32 v206, v206
    v_rcp_f32 v207, v207
    v_rcp_f32 v208, v208
    v_rcp_f32 v209, v209
    v_rcp_f32 v210, v210
    v_rcp_f32 v211, v211
    v_rcp_f32 v212, v212
    v_rcp_f32 v213, v213
    v_rcp_f32 v214, v214
    v_rcp_f32 v215, v215
    v_pk_mul_f32 v[0:1], v[0:1], v[64:65]
    v_pk_mul_f32 v[2:3], v[2:3], v[66:67]
    v_pk_mul_f32 v[16:17], v[16:17], v[80:81]
    v_pk_mul_f32 v[18:19], v[18:19], v[82:83]
    v_pk_mul_f32 v[32:33], v[32:33], v[96:97]
    v_pk_mul_f32 v[34:35], v[34:35], v[98:99]
    v_pk_mul_f32 v[48:49], v[48:49], v[112:113]
    v_pk_mul_f32 v[50:51], v[50:51], v[114:115]
    v_pk_mul_f32 v[0:1], v[0:1], v[200:201]
    v_pk_mul_f32 v[2:3], v[2:3], v[202:203]
    v_pk_mul_f32 v[16:17], v[16:17], v[204:205]
    v_pk_mul_f32 v[18:19], v[18:19], v[206:207]
    v_pk_mul_f32 v[32:33], v[32:33], v[208:209]
    v_pk_mul_f32 v[34:35], v[34:35], v[210:211]
    v_pk_mul_f32 v[48:49], v[48:49], v[212:213]
    v_pk_mul_f32 v[50:51], v[50:51], v[214:215]
    v_cvt_pk_bf16_f32 v216, v0, v1
    v_cvt_pk_bf16_f32 v217, v2, v3
    v_cvt_pk_bf16_f32 v218, v16, v17
    v_cvt_pk_bf16_f32 v219, v18, v19
    v_cvt_pk_bf16_f32 v220, v32, v33
    v_cvt_pk_bf16_f32 v221, v34, v35
    v_cvt_pk_bf16_f32 v222, v48, v49
    v_cvt_pk_bf16_f32 v223, v50, v51
    buffer_store_dwordx4 v[216:219], v249, s[80:83], s25 offen offset:0
    ds_write_b128 v232, v[216:219] offset:0
    buffer_store_dwordx4 v[220:223], v249, s[80:83], s26 offen offset:0
    ds_write_b128 v233, v[220:223] offset:0
    v_pk_fma_f32 v[4:5], v[162:163], v[128:129], v[4:5]
    v_pk_fma_f32 v[6:7], v[162:163], v[130:131], v[6:7]
    v_pk_fma_f32 v[20:21], v[162:163], v[132:133], v[20:21]
    v_pk_fma_f32 v[22:23], v[162:163], v[134:135], v[22:23]
    v_pk_fma_f32 v[36:37], v[162:163], v[136:137], v[36:37]
    v_pk_fma_f32 v[38:39], v[162:163], v[138:139], v[38:39]
    v_pk_fma_f32 v[52:53], v[162:163], v[140:141], v[52:53]
    v_pk_fma_f32 v[54:55], v[162:163], v[142:143], v[54:55]
    v_pk_mul_f32 v[200:201], v[170:171], v[4:5]
    v_pk_mul_f32 v[202:203], v[170:171], v[6:7]
    v_pk_mul_f32 v[204:205], v[170:171], v[20:21]
    v_pk_mul_f32 v[206:207], v[170:171], v[22:23]
    v_pk_mul_f32 v[208:209], v[170:171], v[36:37]
    v_pk_mul_f32 v[210:211], v[170:171], v[38:39]
    v_pk_mul_f32 v[212:213], v[170:171], v[52:53]
    v_pk_mul_f32 v[214:215], v[170:171], v[54:55]
    v_exp_f32 v200, v200
    v_exp_f32 v201, v201
    v_exp_f32 v202, v202
    v_exp_f32 v203, v203
    v_exp_f32 v204, v204
    v_exp_f32 v205, v205
    v_exp_f32 v206, v206
    v_exp_f32 v207, v207
    v_exp_f32 v208, v208
    v_exp_f32 v209, v209
    v_exp_f32 v210, v210
    v_exp_f32 v211, v211
    v_exp_f32 v212, v212
    v_exp_f32 v213, v213
    v_exp_f32 v214, v214
    v_exp_f32 v215, v215
    v_pk_fma_f32 v[68:69], v[162:163], v[144:145], v[68:69]
    v_pk_fma_f32 v[70:71], v[162:163], v[146:147], v[70:71]
    v_pk_fma_f32 v[84:85], v[162:163], v[148:149], v[84:85]
    v_pk_fma_f32 v[86:87], v[162:163], v[150:151], v[86:87]
    v_pk_fma_f32 v[100:101], v[162:163], v[152:153], v[100:101]
    v_pk_fma_f32 v[102:103], v[162:163], v[154:155], v[102:103]
    v_pk_fma_f32 v[116:117], v[162:163], v[156:157], v[116:117]
    v_pk_fma_f32 v[118:119], v[162:163], v[158:159], v[118:119]
    v_pk_fma_f32 v[200:201], v[200:201], v[178:179], v[178:179]
    v_pk_fma_f32 v[202:203], v[202:203], v[178:179], v[178:179]
    v_pk_fma_f32 v[204:205], v[204:205], v[178:179], v[178:179]
    v_pk_fma_f32 v[206:207], v[206:207], v[178:179], v[178:179]
    v_pk_fma_f32 v[208:209], v[208:209], v[178:179], v[178:179]
    v_pk_fma_f32 v[210:211], v[210:211], v[178:179], v[178:179]
    v_pk_fma_f32 v[212:213], v[212:213], v[178:179], v[178:179]
    v_pk_fma_f32 v[214:215], v[214:215], v[178:179], v[178:179]
    v_rcp_f32 v200, v200
    v_rcp_f32 v201, v201
    v_rcp_f32 v202, v202
    v_rcp_f32 v203, v203
    v_rcp_f32 v204, v204
    v_rcp_f32 v205, v205
    v_rcp_f32 v206, v206
    v_rcp_f32 v207, v207
    v_rcp_f32 v208, v208
    v_rcp_f32 v209, v209
    v_rcp_f32 v210, v210
    v_rcp_f32 v211, v211
    v_rcp_f32 v212, v212
    v_rcp_f32 v213, v213
    v_rcp_f32 v214, v214
    v_rcp_f32 v215, v215
    v_pk_mul_f32 v[4:5], v[4:5], v[68:69]
    v_pk_mul_f32 v[6:7], v[6:7], v[70:71]
    v_pk_mul_f32 v[20:21], v[20:21], v[84:85]
    v_pk_mul_f32 v[22:23], v[22:23], v[86:87]
    v_pk_mul_f32 v[36:37], v[36:37], v[100:101]
    v_pk_mul_f32 v[38:39], v[38:39], v[102:103]
    v_pk_mul_f32 v[52:53], v[52:53], v[116:117]
    v_pk_mul_f32 v[54:55], v[54:55], v[118:119]
    v_pk_mul_f32 v[4:5], v[4:5], v[200:201]
    v_pk_mul_f32 v[6:7], v[6:7], v[202:203]
    v_pk_mul_f32 v[20:21], v[20:21], v[204:205]
    v_pk_mul_f32 v[22:23], v[22:23], v[206:207]
    v_pk_mul_f32 v[36:37], v[36:37], v[208:209]
    v_pk_mul_f32 v[38:39], v[38:39], v[210:211]
    v_pk_mul_f32 v[52:53], v[52:53], v[212:213]
    v_pk_mul_f32 v[54:55], v[54:55], v[214:215]
    v_cvt_pk_bf16_f32 v216, v4, v5
    v_cvt_pk_bf16_f32 v217, v6, v7
    v_cvt_pk_bf16_f32 v218, v20, v21
    v_cvt_pk_bf16_f32 v219, v22, v23
    v_cvt_pk_bf16_f32 v220, v36, v37
    v_cvt_pk_bf16_f32 v221, v38, v39
    v_cvt_pk_bf16_f32 v222, v52, v53
    v_cvt_pk_bf16_f32 v223, v54, v55
    buffer_store_dwordx4 v[216:219], v249, s[80:83], s25 offen offset:1024
    ds_write_b128 v232, v[216:219] offset:1024
    buffer_store_dwordx4 v[220:223], v249, s[80:83], s26 offen offset:1024
    ds_write_b128 v233, v[220:223] offset:1024
    v_pk_fma_f32 v[8:9], v[164:165], v[128:129], v[8:9]
    v_pk_fma_f32 v[10:11], v[164:165], v[130:131], v[10:11]
    v_pk_fma_f32 v[24:25], v[164:165], v[132:133], v[24:25]
    v_pk_fma_f32 v[26:27], v[164:165], v[134:135], v[26:27]
    v_pk_fma_f32 v[40:41], v[164:165], v[136:137], v[40:41]
    v_pk_fma_f32 v[42:43], v[164:165], v[138:139], v[42:43]
    v_pk_fma_f32 v[56:57], v[164:165], v[140:141], v[56:57]
    v_pk_fma_f32 v[58:59], v[164:165], v[142:143], v[58:59]
    v_pk_mul_f32 v[200:201], v[172:173], v[8:9]
    v_pk_mul_f32 v[202:203], v[172:173], v[10:11]
    v_pk_mul_f32 v[204:205], v[172:173], v[24:25]
    v_pk_mul_f32 v[206:207], v[172:173], v[26:27]
    v_pk_mul_f32 v[208:209], v[172:173], v[40:41]
    v_pk_mul_f32 v[210:211], v[172:173], v[42:43]
    v_pk_mul_f32 v[212:213], v[172:173], v[56:57]
    v_pk_mul_f32 v[214:215], v[172:173], v[58:59]
    v_exp_f32 v200, v200
    v_exp_f32 v201, v201
    v_exp_f32 v202, v202
    v_exp_f32 v203, v203
    v_exp_f32 v204, v204
    v_exp_f32 v205, v205
    v_exp_f32 v206, v206
    v_exp_f32 v207, v207
    v_exp_f32 v208, v208
    v_exp_f32 v209, v209
    v_exp_f32 v210, v210
    v_exp_f32 v211, v211
    v_exp_f32 v212, v212
    v_exp_f32 v213, v213
    v_exp_f32 v214, v214
    v_exp_f32 v215, v215
    v_pk_fma_f32 v[72:73], v[164:165], v[144:145], v[72:73]
    v_pk_fma_f32 v[74:75], v[164:165], v[146:147], v[74:75]
    v_pk_fma_f32 v[88:89], v[164:165], v[148:149], v[88:89]
    v_pk_fma_f32 v[90:91], v[164:165], v[150:151], v[90:91]
    v_pk_fma_f32 v[104:105], v[164:165], v[152:153], v[104:105]
    v_pk_fma_f32 v[106:107], v[164:165], v[154:155], v[106:107]
    v_pk_fma_f32 v[120:121], v[164:165], v[156:157], v[120:121]
    v_pk_fma_f32 v[122:123], v[164:165], v[158:159], v[122:123]
    v_pk_fma_f32 v[200:201], v[200:201], v[180:181], v[180:181]
    v_pk_fma_f32 v[202:203], v[202:203], v[180:181], v[180:181]
    v_pk_fma_f32 v[204:205], v[204:205], v[180:181], v[180:181]
    v_pk_fma_f32 v[206:207], v[206:207], v[180:181], v[180:181]
    v_pk_fma_f32 v[208:209], v[208:209], v[180:181], v[180:181]
    v_pk_fma_f32 v[210:211], v[210:211], v[180:181], v[180:181]
    v_pk_fma_f32 v[212:213], v[212:213], v[180:181], v[180:181]
    v_pk_fma_f32 v[214:215], v[214:215], v[180:181], v[180:181]
    v_rcp_f32 v200, v200
    v_rcp_f32 v201, v201
    v_rcp_f32 v202, v202
    v_rcp_f32 v203, v203
    v_rcp_f32 v204, v204
    v_rcp_f32 v205, v205
    v_rcp_f32 v206, v206
    v_rcp_f32 v207, v207
    v_rcp_f32 v208, v208
    v_rcp_f32 v209, v209
    v_rcp_f32 v210, v210
    v_rcp_f32 v211, v211
    v_rcp_f32 v212, v212
    v_rcp_f32 v213, v213
    v_rcp_f32 v214, v214
    v_rcp_f32 v215, v215
    v_pk_mul_f32 v[8:9], v[8:9], v[72:73]
    v_pk_mul_f32 v[10:11], v[10:11], v[74:75]
    v_pk_mul_f32 v[24:25], v[24:25], v[88:89]
    v_pk_mul_f32 v[26:27], v[26:27], v[90:91]
    v_pk_mul_f32 v[40:41], v[40:41], v[104:105]
    v_pk_mul_f32 v[42:43], v[42:43], v[106:107]
    v_pk_mul_f32 v[56:57], v[56:57], v[120:121]
    v_pk_mul_f32 v[58:59], v[58:59], v[122:123]
    v_pk_mul_f32 v[8:9], v[8:9], v[200:201]
    v_pk_mul_f32 v[10:11], v[10:11], v[202:203]
    v_pk_mul_f32 v[24:25], v[24:25], v[204:205]
    v_pk_mul_f32 v[26:27], v[26:27], v[206:207]
    v_pk_mul_f32 v[40:41], v[40:41], v[208:209]
    v_pk_mul_f32 v[42:43], v[42:43], v[210:211]
    v_pk_mul_f32 v[56:57], v[56:57], v[212:213]
    v_pk_mul_f32 v[58:59], v[58:59], v[214:215]
    v_cvt_pk_bf16_f32 v216, v8, v9
    v_cvt_pk_bf16_f32 v217, v10, v11
    v_cvt_pk_bf16_f32 v218, v24, v25
    v_cvt_pk_bf16_f32 v219, v26, v27
    v_cvt_pk_bf16_f32 v220, v40, v41
    v_cvt_pk_bf16_f32 v221, v42, v43
    v_cvt_pk_bf16_f32 v222, v56, v57
    v_cvt_pk_bf16_f32 v223, v58, v59
    buffer_store_dwordx4 v[216:219], v249, s[80:83], s25 offen offset:2048
    ds_write_b128 v232, v[216:219] offset:2048
    buffer_store_dwordx4 v[220:223], v249, s[80:83], s26 offen offset:2048
    ds_write_b128 v233, v[220:223] offset:2048
    v_pk_fma_f32 v[12:13], v[166:167], v[128:129], v[12:13]
    v_pk_fma_f32 v[14:15], v[166:167], v[130:131], v[14:15]
    v_pk_fma_f32 v[28:29], v[166:167], v[132:133], v[28:29]
    v_pk_fma_f32 v[30:31], v[166:167], v[134:135], v[30:31]
    v_pk_fma_f32 v[44:45], v[166:167], v[136:137], v[44:45]
    v_pk_fma_f32 v[46:47], v[166:167], v[138:139], v[46:47]
    v_pk_fma_f32 v[60:61], v[166:167], v[140:141], v[60:61]
    v_pk_fma_f32 v[62:63], v[166:167], v[142:143], v[62:63]
    v_pk_mul_f32 v[200:201], v[174:175], v[12:13]
    v_pk_mul_f32 v[202:203], v[174:175], v[14:15]
    v_pk_mul_f32 v[204:205], v[174:175], v[28:29]
    v_pk_mul_f32 v[206:207], v[174:175], v[30:31]
    v_pk_mul_f32 v[208:209], v[174:175], v[44:45]
    v_pk_mul_f32 v[210:211], v[174:175], v[46:47]
    v_pk_mul_f32 v[212:213], v[174:175], v[60:61]
    v_pk_mul_f32 v[214:215], v[174:175], v[62:63]
    v_exp_f32 v200, v200
    v_exp_f32 v201, v201
    v_exp_f32 v202, v202
    v_exp_f32 v203, v203
    v_exp_f32 v204, v204
    v_exp_f32 v205, v205
    v_exp_f32 v206, v206
    v_exp_f32 v207, v207
    v_exp_f32 v208, v208
    v_exp_f32 v209, v209
    v_exp_f32 v210, v210
    v_exp_f32 v211, v211
    v_exp_f32 v212, v212
    v_exp_f32 v213, v213
    v_exp_f32 v214, v214
    v_exp_f32 v215, v215
    v_pk_fma_f32 v[76:77], v[166:167], v[144:145], v[76:77]
    v_pk_fma_f32 v[78:79], v[166:167], v[146:147], v[78:79]
    v_pk_fma_f32 v[92:93], v[166:167], v[148:149], v[92:93]
    v_pk_fma_f32 v[94:95], v[166:167], v[150:151], v[94:95]
    v_pk_fma_f32 v[108:109], v[166:167], v[152:153], v[108:109]
    v_pk_fma_f32 v[110:111], v[166:167], v[154:155], v[110:111]
    v_pk_fma_f32 v[124:125], v[166:167], v[156:157], v[124:125]
    v_pk_fma_f32 v[126:127], v[166:167], v[158:159], v[126:127]
    v_pk_fma_f32 v[200:201], v[200:201], v[182:183], v[182:183]
    v_pk_fma_f32 v[202:203], v[202:203], v[182:183], v[182:183]
    v_pk_fma_f32 v[204:205], v[204:205], v[182:183], v[182:183]
    v_pk_fma_f32 v[206:207], v[206:207], v[182:183], v[182:183]
    v_pk_fma_f32 v[208:209], v[208:209], v[182:183], v[182:183]
    v_pk_fma_f32 v[210:211], v[210:211], v[182:183], v[182:183]
    v_pk_fma_f32 v[212:213], v[212:213], v[182:183], v[182:183]
    v_pk_fma_f32 v[214:215], v[214:215], v[182:183], v[182:183]
    v_rcp_f32 v200, v200
    v_rcp_f32 v201, v201
    v_rcp_f32 v202, v202
    v_rcp_f32 v203, v203
    v_rcp_f32 v204, v204
    v_rcp_f32 v205, v205
    v_rcp_f32 v206, v206
    v_rcp_f32 v207, v207
    v_rcp_f32 v208, v208
    v_rcp_f32 v209, v209
    v_rcp_f32 v210, v210
    v_rcp_f32 v211, v211
    v_rcp_f32 v212, v212
    v_rcp_f32 v213, v213
    v_rcp_f32 v214, v214
    v_rcp_f32 v215, v215
    v_pk_mul_f32 v[12:13], v[12:13], v[76:77]
    v_pk_mul_f32 v[14:15], v[14:15], v[78:79]
    v_pk_mul_f32 v[28:29], v[28:29], v[92:93]
    v_pk_mul_f32 v[30:31], v[30:31], v[94:95]
    v_pk_mul_f32 v[44:45], v[44:45], v[108:109]
    v_pk_mul_f32 v[46:47], v[46:47], v[110:111]
    v_pk_mul_f32 v[60:61], v[60:61], v[124:125]
    v_pk_mul_f32 v[62:63], v[62:63], v[126:127]
    v_pk_mul_f32 v[12:13], v[12:13], v[200:201]
    v_pk_mul_f32 v[14:15], v[14:15], v[202:203]
    v_pk_mul_f32 v[28:29], v[28:29], v[204:205]
    v_pk_mul_f32 v[30:31], v[30:31], v[206:207]
    v_pk_mul_f32 v[44:45], v[44:45], v[208:209]
    v_pk_mul_f32 v[46:47], v[46:47], v[210:211]
    v_pk_mul_f32 v[60:61], v[60:61], v[212:213]
    v_pk_mul_f32 v[62:63], v[62:63], v[214:215]
    v_cvt_pk_bf16_f32 v216, v12, v13
    v_cvt_pk_bf16_f32 v217, v14, v15
    v_cvt_pk_bf16_f32 v218, v28, v29
    v_cvt_pk_bf16_f32 v219, v30, v31
    v_cvt_pk_bf16_f32 v220, v44, v45
    v_cvt_pk_bf16_f32 v221, v46, v47
    v_cvt_pk_bf16_f32 v222, v60, v61
    v_cvt_pk_bf16_f32 v223, v62, v63
    buffer_store_dwordx4 v[216:219], v249, s[80:83], s25 offen offset:3072
    ds_write_b128 v232, v[216:219] offset:3072
    buffer_store_dwordx4 v[220:223], v249, s[80:83], s26 offen offset:3072
    ds_write_b128 v233, v[220:223] offset:3072
    s_lshr_b32 s64, s3, 1
    s_lshl_b32 s64, s64, 11
    s_add_u32 s64, s64, 49152
    v_add_u32 v240, s64, v249
    v_lshrrev_b32 v253, 2, v252
    v_and_b32 v254, 1, v251
    v_lshl_add_u32 v253, v254, 2, v253
    v_mul_u32_u24 v253, 1056, v253
    v_lshrrev_b32 v254, 1, v251
    v_lshl_add_u32 v253, v254, 8, v253
    v_and_b32 v254, 3, v252
    v_lshl_add_u32 v253, v254, 3, v253
    s_and_b32 s64, s3, 1
    s_lshl_b32 s64, s64, 7
    s_add_u32 s64, s64, 65536
    v_add_u32 v241, s64, v253
    s_mov_b32 s16, 33792
    v_add_u32 v242, s16, v241
    s_and_b32 s25, s3, 1
    s_lshl_b32 s25, s25, 3
    s_add_u32 s25, s25, s61
    s_lshl_b32 s18, s73, 4
    s_add_u32 s18, s18, s25
    s_lshl_b32 s18, s18, 2
    s_add_u32 s18, s18, s68
    s_lshl_b32 s18, s18, 12
    s_lshr_b32 s64, s3, 1
    s_lshl_b32 s64, s64, 11
    s_add_u32 s18, s18, s64
    s_mov_b32 s20, s18
    s_add_u32 s20, s20, 4194304
    s_lshl_b32 s66, s75, 23
    s_add_u32 s18, s18, s66
    s_add_u32 s19, s18, 8192
    s_add_u32 s21, s20, 8192
    buffer_load_dwordx4 v[128:131], v249, s[80:83], s18 offen offset:0 sc1
    buffer_load_dwordx4 v[132:135], v249, s[80:83], s19 offen offset:0 sc1
    buffer_load_dwordx4 v[136:139], v249, s[80:83], s18 offen offset:1024 sc1
    buffer_load_dwordx4 v[140:143], v249, s[80:83], s19 offen offset:1024 sc1
    s_lshl_b32 s24, s73, 4
    s_add_u32 s24, s24, s25
    s_lshl_b32 s24, s24, 11
    s_add_u32 s24, s24, 71827456
    s_lshl_b32 s65, s68, 9
    s_add_u32 s24, s24, s65
    s_lshr_b32 s65, s3, 1
    s_lshl_b32 s65, s65, 8
    s_add_u32 s24, s24, s65
    v_lshrrev_b32 v253, 1, v251
    v_lshl_add_u32 v253, v253, 4, v252
    v_lshlrev_b32 v253, 3, v253
    v_and_b32 v254, 1, v251
    v_lshl_add_u32 v239, v254, 10, v253
    s_lshl_b32 s23, s75, 8
    s_add_u32 s23, s23, s2
    s_lshl_b32 s23, s23, 2
    s_add_u32 s23, s23, s3
    s_lshl_b32 s22, s23, 13
    s_add_u32 s22, s22, 54525952
    s_lshl_b32 s23, s23, 7
    s_add_u32 s23, s23, 75628544
    v_mov_b32 v208, 0
    v_mov_b32 v209, 0
    v_mov_b32 v210, 0
    v_mov_b32 v211, 0
    s_nop 1
    v_mfma_f32_32x32x16_bf16 v[0:15], v[208:211], v[208:211], 0
    v_mfma_f32_32x32x16_bf16 v[16:31], v[208:211], v[208:211], 0
    v_mfma_f32_32x32x16_bf16 v[32:47], v[208:211], v[208:211], 0
    v_mfma_f32_32x32x16_bf16 v[48:63], v[208:211], v[208:211], 0
    s_mov_b32 s17, 14
    s_lshl_b32 s64, s75, 15
    s_lshl_b32 s66, s73, 9
    s_add_u32 s64, s64, s66
    s_add_u32 s64, s64, 75513856
    s_lshl_b32 s65, s72, 5
    s_add_u32 s64, s64, s65
    s_lshl_b32 s65, s3, 2
    s_add_u32 s64, s64, s65
    v_mov_b32 v236, 0
    v_mov_b32 v237, 1
    s_cmp_lg_u32 s78, 0
    s_cbranch_scc1 sg_7_slow
    s_waitcnt vmcnt(4)
    s_mov_b64 exec, 1
    buffer_store_dword v237, v236, s[80:83], s64 offen
    s_mov_b64 exec, -1
sg_7_done:
    s_waitcnt lgkmcnt(0)
    s_barrier
    ds_read_b128 v[72:75], v240 offset:12288
    ds_read_b64_tr_b16 v[80:81], v242 offset:8448
    ds_read_b64_tr_b16 v[82:83], v242 offset:8960
    ds_read_b128 v[76:79], v240 offset:13312
    ds_read_b64_tr_b16 v[84:85], v242 offset:8480
    ds_read_b64_tr_b16 v[86:87], v242 offset:8992
    ds_read_b128 v[64:67], v240 offset:8192
    ds_read_b64_tr_b16 v[88:89], v242 offset:8512
    ds_read_b64_tr_b16 v[90:91], v242 offset:9024
    ds_read_b128 v[68:71], v240 offset:9216
    ds_read_b64_tr_b16 v[92:93], v242 offset:8544
    ds_read_b64_tr_b16 v[94:95], v242 offset:9056
    v_add_u16 v240, 0x4000, v240
    s_add_u32 s16, s16, 16896
    s_cmp_eq_u32 s16, 84480
    s_cselect_b32 s16, 0, s16
    v_add_u32 v242, s16, v241
    s_waitcnt lgkmcnt(0)
r3_loop:
    s_bitcmp1_b32 24576, s17
    s_cbranch_scc1 r3_nb0
    s_barrier
r3_nb0:
    v_mfma_f32_16x16x32_bf16 v[32:35], v[80:83], v[72:75], v[32:35]
    ds_read_b128 v[104:107], v240 offset:4096
    ds_read_b64_tr_b16 v[112:113], v242 offset:0
    v_mfma_f32_16x16x32_bf16 v[36:39], v[84:87], v[72:75], v[36:39]
    ds_read_b64_tr_b16 v[114:115], v242 offset:512
    v_mfma_f32_16x16x32_bf16 v[40:43], v[88:91], v[72:75], v[40:43]
    ds_read_b128 v[108:111], v240 offset:5120
    v_mfma_f32_16x16x32_bf16 v[44:47], v[92:95], v[72:75], v[44:47]
    ds_read_b64_tr_b16 v[116:117], v242 offset:32
    v_mfma_f32_16x16x32_bf16 v[60:63], v[92:95], v[76:79], v[60:63]
    ds_read_b64_tr_b16 v[118:119], v242 offset:544
    v_mfma_f32_16x16x32_bf16 v[56:59], v[88:91], v[76:79], v[56:59]
    ds_read_b128 v[96:99], v240 offset:0
    ds_read_b64_tr_b16 v[120:121], v242 offset:64
    v_mfma_f32_16x16x32_bf16 v[52:55], v[84:87], v[76:79], v[52:55]
    ds_read_b64_tr_b16 v[122:123], v242 offset:576
    v_mfma_f32_16x16x32_bf16 v[48:51], v[80:83], v[76:79], v[48:51]
    ds_read_b128 v[100:103], v240 offset:1024
    v_mfma_f32_16x16x32_bf16 v[0:3], v[80:83], v[64:67], v[0:3]
    ds_read_b64_tr_b16 v[124:125], v242 offset:96
    v_mfma_f32_16x16x32_bf16 v[4:7], v[84:87], v[64:67], v[4:7]
    ds_read_b64_tr_b16 v[126:127], v242 offset:608
    v_mfma_f32_16x16x32_bf16 v[8:11], v[88:91], v[64:67], v[8:11]
    v_mfma_f32_16x16x32_bf16 v[12:15], v[92:95], v[64:67], v[12:15]
    v_mfma_f32_16x16x32_bf16 v[28:31], v[92:95], v[68:71], v[28:31]
    v_mfma_f32_16x16x32_bf16 v[24:27], v[88:91], v[68:71], v[24:27]
    v_mfma_f32_16x16x32_bf16 v[20:23], v[84:87], v[68:71], v[20:23]
    v_mfma_f32_16x16x32_bf16 v[16:19], v[80:83], v[68:71], v[16:19]
    s_waitcnt lgkmcnt(0)
    v_mfma_f32_16x16x32_bf16 v[32:35], v[112:115], v[104:107], v[32:35]
    ds_read_b128 v[72:75], v240 offset:12288
    ds_read_b64_tr_b16 v[80:81], v242 offset:8448
    v_mfma_f32_16x16x32_bf16 v[36:39], v[116:119], v[104:107], v[36:39]
    ds_read_b64_tr_b16 v[82:83], v242 offset:8960
    v_mfma_f32_16x16x32_bf16 v[40:43], v[120:123], v[104:107], v[40:43]
    ds_read_b128 v[76:79], v240 offset:13312
    v_mfma_f32_16x16x32_bf16 v[44:47], v[124:127], v[104:107], v[44:47]
    ds_read_b64_tr_b16 v[84:85], v242 offset:8480
    v_mfma_f32_16x16x32_bf16 v[60:63], v[124:127], v[108:111], v[60:63]
    ds_read_b64_tr_b16 v[86:87], v242 offset:8992
    v_mfma_f32_16x16x32_bf16 v[56:59], v[120:123], v[108:111], v[56:59]
    ds_read_b128 v[64:67], v240 offset:8192
    ds_read_b64_tr_b16 v[88:89], v242 offset:8512
    v_mfma_f32_16x16x32_bf16 v[52:55], v[116:119], v[108:111], v[52:55]
    ds_read_b64_tr_b16 v[90:91], v242 offset:9024
    v_mfma_f32_16x16x32_bf16 v[48:51], v[112:115], v[108:111], v[48:51]
    ds_read_b128 v[68:71], v240 offset:9216
    v_mfma_f32_16x16x32_bf16 v[0:3], v[112:115], v[96:99], v[0:3]
    ds_read_b64_tr_b16 v[92:93], v242 offset:8544
    v_mfma_f32_16x16x32_bf16 v[4:7], v[116:119], v[96:99], v[4:7]
    ds_read_b64_tr_b16 v[94:95], v242 offset:9056
    v_mfma_f32_16x16x32_bf16 v[8:11], v[120:123], v[96:99], v[8:11]
    v_add_u16 v240, 0x4000, v240
    v_mfma_f32_16x16x32_bf16 v[12:15], v[124:127], v[96:99], v[12:15]
    s_add_u32 s16, s16, 16896
    s_cmp_eq_u32 s16, 84480
    v_mfma_f32_16x16x32_bf16 v[28:31], v[124:127], v[100:103], v[28:31]
    s_cselect_b32 s16, 0, s16
    v_mfma_f32_16x16x32_bf16 v[24:27], v[120:123], v[100:103], v[24:27]
    v_add_u32 v242, s16, v241
    v_mfma_f32_16x16x32_bf16 v[20:23], v[116:119], v[100:103], v[20:23]
    v_mfma_f32_16x16x32_bf16 v[16:19], v[112:115], v[100:103], v[16:19]
    s_waitcnt lgkmcnt(0)
    s_bitcmp1_b32 2, s17
    s_cbranch_scc1 r3_nb1
    s_barrier
r3_nb1:
    v_mfma_f32_16x16x32_bf16 v[32:35], v[80:83], v[72:75], v[32:35]
    ds_read_b128 v[104:107], v240 offset:4096
    ds_read_b64_tr_b16 v[112:113], v242 offset:0
    v_mfma_f32_16x16x32_bf16 v[36:39], v[84:87], v[72:75], v[36:39]
    ds_read_b64_tr_b16 v[114:115], v242 offset:512
    v_mfma_f32_16x16x32_bf16 v[40:43], v[88:91], v[72:75], v[40:43]
    ds_read_b128 v[108:111], v240 offset:5120
    v_mfma_f32_16x16x32_bf16 v[44:47], v[92:95], v[72:75], v[44:47]
    ds_read_b64_tr_b16 v[116:117], v242 offset:32
    v_mfma_f32_16x16x32_bf16 v[60:63], v[92:95], v[76:79], v[60:63]
    ds_read_b64_tr_b16 v[118:119], v242 offset:544
    v_mfma_f32_16x16x32_bf16 v[56:59], v[88:91], v[76:79], v[56:59]
    ds_read_b128 v[96:99], v240 offset:0
    ds_read_b64_tr_b16 v[120:121], v242 offset:64
    v_mfma_f32_16x16x32_bf16 v[52:55], v[84:87], v[76:79], v[52:55]
    ds_read_b64_tr_b16 v[122:123], v242 offset:576
    v_mfma_f32_16x16x32_bf16 v[48:51], v[80:83], v[76:79], v[48:51]
    ds_read_b128 v[100:103], v240 offset:1024
    v_mfma_f32_16x16x32_bf16 v[0:3], v[80:83], v[64:67], v[0:3]
    ds_read_b64_tr_b16 v[124:125], v242 offset:96
    v_mfma_f32_16x16x32_bf16 v[4:7], v[84:87], v[64:67], v[4:7]
    ds_read_b64_tr_b16 v[126:127], v242 offset:608
    v_mfma_f32_16x16x32_bf16 v[8:11], v[88:91], v[64:67], v[8:11]
    v_mfma_f32_16x16x32_bf16 v[12:15], v[92:95], v[64:67], v[12:15]
    v_mfma_f32_16x16x32_bf16 v[28:31], v[92:95], v[68:71], v[28:31]
    v_mfma_f32_16x16x32_bf16 v[24:27], v[88:91], v[68:71], v[24:27]
    v_mfma_f32_16x16x32_bf16 v[20:23], v[84:87], v[68:71], v[20:23]
    v_mfma_f32_16x16x32_bf16 v[16:19], v[80:83], v[68:71], v[16:19]
    s_waitcnt lgkmcnt(0)
    v_mfma_f32_16x16x32_bf16 v[32:35], v[112:115], v[104:107], v[32:35]
    ds_read_b128 v[72:75], v240 offset:12288
    ds_read_b64_tr_b16 v[80:81], v242 offset:8448
    v_mfma_f32_16x16x32_bf16 v[36:39], v[116:119], v[104:107], v[36:39]
    ds_read_b64_tr_b16 v[82:83], v242 offset:8960
    v_mfma_f32_16x16x32_bf16 v[40:43], v[120:123], v[104:107], v[40:43]
    ds_read_b128 v[76:79], v240 offset:13312
    v_mfma_f32_16x16x32_bf16 v[44:47], v[124:127], v[104:107], v[44:47]
    ds_read_b64_tr_b16 v[84:85], v242 offset:8480
    v_mfma_f32_16x16x32_bf16 v[60:63], v[124:127], v[108:111], v[60:63]
    ds_read_b64_tr_b16 v[86:87], v242 offset:8992
    v_mfma_f32_16x16x32_bf16 v[56:59], v[120:123], v[108:111], v[56:59]
    ds_read_b128 v[64:67], v240 offset:8192
    ds_read_b64_tr_b16 v[88:89], v242 offset:8512
    v_mfma_f32_16x16x32_bf16 v[52:55], v[116:119], v[108:111], v[52:55]
    ds_read_b64_tr_b16 v[90:91], v242 offset:9024
    v_mfma_f32_16x16x32_bf16 v[48:51], v[112:115], v[108:111], v[48:51]
    ds_read_b128 v[68:71], v240 offset:9216
    v_mfma_f32_16x16x32_bf16 v[0:3], v[112:115], v[96:99], v[0:3]
    ds_read_b64_tr_b16 v[92:93], v242 offset:8544
    v_mfma_f32_16x16x32_bf16 v[4:7], v[116:119], v[96:99], v[4:7]
    ds_read_b64_tr_b16 v[94:95], v242 offset:9056
    v_mfma_f32_16x16x32_bf16 v[8:11], v[120:123], v[96:99], v[8:11]
    v_add_u16 v240, 0x4000, v240
    v_mfma_f32_16x16x32_bf16 v[12:15], v[124:127], v[96:99], v[12:15]
    s_add_u32 s16, s16, 16896
    s_cmp_eq_u32 s16, 84480
    v_mfma_f32_16x16x32_bf16 v[28:31], v[124:127], v[100:103], v[28:31]
    s_cselect_b32 s16, 0, s16
    v_mfma_f32_16x16x32_bf16 v[24:27], v[120:123], v[100:103], v[24:27]
    v_add_u32 v242, s16, v241
    v_mfma_f32_16x16x32_bf16 v[20:23], v[116:119], v[100:103], v[20:23]
    s_sub_u32 s17, s17, 1
    s_cmp_lg_u32 s17, 0
    v_mfma_f32_16x16x32_bf16 v[16:19], v[112:115], v[100:103], v[16:19]
    s_waitcnt lgkmcnt(0)
    s_cbranch_scc1 r3_loop
    s_add_u32 s65, s22, 4096
    v_cvt_pk_bf16_f32 v32, v32, v33
    v_cvt_pk_bf16_f32 v33, v34, v35
    v_cvt_pk_bf16_f32 v34, v36, v37
    v_cvt_pk_bf16_f32 v35, v38, v39
    buffer_store_dwordx4 v[32:35], v249, s[80:83], s22 offen offset:0 sc0 sc1
    v_cvt_pk_bf16_f32 v40, v40, v41
    v_cvt_pk_bf16_f32 v41, v42, v43
    v_cvt_pk_bf16_f32 v42, v44, v45
    v_cvt_pk_bf16_f32 v43, v46, v47
    buffer_store_dwordx4 v[40:43], v249, s[80:83], s22 offen offset:1024 sc0 sc1
    v_cvt_pk_bf16_f32 v48, v48, v49
    v_cvt_pk_bf16_f32 v49, v50, v51
    v_cvt_pk_bf16_f32 v50, v52, v53
    v_cvt_pk_bf16_f32 v51, v54, v55
    buffer_store_dwordx4 v[48:51], v249, s[80:83], s22 offen offset:2048 sc0 sc1
    v_cvt_pk_bf16_f32 v56, v56, v57
    v_cvt_pk_bf16_f32 v57, v58, v59
    v_cvt_pk_bf16_f32 v58, v60, v61
    v_cvt_pk_bf16_f32 v59, v62, v63
    buffer_store_dwordx4 v[56:59], v249, s[80:83], s22 offen offset:3072 sc0 sc1
    s_waitcnt vmcnt(4)
    v_lshlrev_b32 v144, 16, v128
    v_and_b32 v145, 0xffff0000, v128
    v_lshlrev_b32 v146, 16, v129
    v_and_b32 v147, 0xffff0000, v129
    v_lshlrev_b32 v148, 16, v130
    v_and_b32 v149, 0xffff0000, v130
    v_lshlrev_b32 v150, 16, v131
    v_and_b32 v151, 0xffff0000, v131
    v_lshlrev_b32 v152, 16, v132
    v_and_b32 v153, 0xffff0000, v132
    v_lshlrev_b32 v154, 16, v133
    v_and_b32 v155, 0xffff0000, v133
    v_lshlrev_b32 v156, 16, v134
    v_and_b32 v157, 0xffff0000, v134
    v_lshlrev_b32 v158, 16, v135
    v_and_b32 v159, 0xffff0000, v135
    v_lshlrev_b32 v160, 16, v136
    v_and_b32 v161, 0xffff0000, v136
    v_lshlrev_b32 v162, 16, v137
    v_and_b32 v163, 0xffff0000, v137
    v_lshlrev_b32 v164, 16, v138
    v_and_b32 v165, 0xffff0000, v138
    v_lshlrev_b32 v166, 16, v139
    v_and_b32 v167, 0xffff0000, v139
    v_lshlrev_b32 v168, 16, v140
    v_and_b32 v169, 0xffff0000, v140
    v_lshlrev_b32 v170, 16, v141
    v_and_b32 v171, 0xffff0000, v141
    v_lshlrev_b32 v172, 16, v142
    v_and_b32 v173, 0xffff0000, v142
    v_lshlrev_b32 v174, 16, v143
    v_and_b32 v175, 0xffff0000, v143
    v_mov_b32 v208, 0
    v_mov_b32 v209, 1
    s_waitcnt vmcnt(0)
    s_mov_b64 exec, 1
    buffer_store_dword v209, v208, s[80:83], s23 offen sc0 sc1
    s_mov_b64 exec, -1
    s_barrier
    s_xor_b32 s23, s23, 512
    s_xor_b32 s22, s22, 32768
    s_mov_b64 exec, 1
pl_8:
    buffer_load_dword v210, v208, s[80:83], s23 offen sc1
    s_sub_u32 s79, s79, 1
    s_cbranch_scc1 L_abort
    s_waitcnt vmcnt(0)
    v_cmp_ne_u32 vcc, 1, v210
    s_cbranch_vccnz pl_8
    s_mov_b64 exec, -1
    s_add_u32 s65, s22, 4096
    buffer_load_dwordx4 v[32:35], v249, s[80:83], s22 offen offset:0 sc1
    buffer_load_dwordx4 v[36:39], v249, s[80:83], s22 offen offset:1024 sc1
    buffer_load_dwordx4 v[40:43], v249, s[80:83], s22 offen offset:2048 sc1
    buffer_load_dwordx4 v[44:47], v249, s[80:83], s22 offen offset:3072 sc1
    v_mov_b32 v88, 0x3f803f80
    s_cmp_lg_u32 s75, 0
    s_cbranch_scc1 fo_9_out
    s_waitcnt vmcnt(2)
    v_lshlrev_b32 v176, 16, v32
    v_lshlrev_b32 v178, 16, v33
    v_lshlrev_b32 v180, 16, v34
    v_lshlrev_b32 v182, 16, v35
    v_lshlrev_b32 v184, 16, v36
    v_lshlrev_b32 v186, 16, v37
    v_lshlrev_b32 v188, 16, v38
    v_lshlrev_b32 v190, 16, v39
    v_and_b32 v177, 0xffff0000, v32
    v_and_b32 v179, 0xffff0000, v33
    v_and_b32 v181, 0xffff0000, v34
    v_and_b32 v183, 0xffff0000, v35
    v_and_b32 v185, 0xffff0000, v36
    v_and_b32 v187, 0xffff0000, v37
    v_and_b32 v189, 0xffff0000, v38
    v_and_b32 v191, 0xffff0000, v39
    v_pk_add_f32 v[0:1], v[0:1], v[176:177]
    v_pk_add_f32 v[2:3], v[2:3], v[178:179]
    v_pk_add_f32 v[4:5], v[4:5], v[180:181]
    v_pk_add_f32 v[6:7], v[6:7], v[182:183]
    v_pk_add_f32 v[8:9], v[8:9], v[184:185]
    v_pk_add_f32 v[10:11], v[10:11], v[186:187]
    v_pk_add_f32 v[12:13], v[12:13], v[188:189]
    v_pk_add_f32 v[14:15], v[14:15], v[190:191]
    v_cvt_pk_bf16_f32 v208, v0, v1
    v_cvt_pk_bf16_f32 v209, v2, v3
    v_cvt_pk_bf16_f32 v210, v4, v5
    v_cvt_pk_bf16_f32 v211, v6, v7
    v_cvt_pk_bf16_f32 v212, v8, v9
    v_cvt_pk_bf16_f32 v213, v10, v11
    v_cvt_pk_bf16_f32 v214, v12, v13
    v_cvt_pk_bf16_f32 v215, v14, v15
    v_lshlrev_b32 v96, 16, v208
    v_lshlrev_b32 v98, 16, v209
    v_lshlrev_b32 v100, 16, v210
    v_lshlrev_b32 v102, 16, v211
    v_lshlrev_b32 v104, 16, v212
    v_lshlrev_b32 v106, 16, v213
    v_lshlrev_b32 v108, 16, v214
    v_lshlrev_b32 v110, 16, v215
    v_and_b32 v97, 0xffff0000, v208
    v_and_b32 v99, 0xffff0000, v209
    v_and_b32 v101, 0xffff0000, v210
    v_and_b32 v103, 0xffff0000, v211
    v_and_b32 v105, 0xffff0000, v212
    v_and_b32 v107, 0xffff0000, v213
    v_and_b32 v109, 0xffff0000, v214
    v_and_b32 v111, 0xffff0000, v215
    v_pk_add_f32 v[96:97], v[96:97], v[144:145]
    v_pk_add_f32 v[98:99], v[98:99], v[146:147]
    v_pk_add_f32 v[100:101], v[100:101], v[148:149]
    v_pk_add_f32 v[102:103], v[102:103], v[150:151]
    v_pk_add_f32 v[104:105], v[104:105], v[152:153]
    v_pk_add_f32 v[106:107], v[106:107], v[154:155]
    v_pk_add_f32 v[108:109], v[108:109], v[156:157]
    v_pk_add_f32 v[110:111], v[110:111], v[158:159]
    v_cvt_pk_bf16_f32 v64, v96, v97
    v_cvt_pk_bf16_f32 v65, v98, v99
    v_cvt_pk_bf16_f32 v66, v100, v101
    v_cvt_pk_bf16_f32 v67, v102, v103
    v_cvt_pk_bf16_f32 v68, v104, v105
    v_cvt_pk_bf16_f32 v69, v106, v107
    v_cvt_pk_bf16_f32 v70, v108, v109
    v_cvt_pk_bf16_f32 v71, v110, v111
    buffer_store_dwordx4 v[64:67], v249, s[80:83], s20 offen offset:0 sc0 sc1
    buffer_store_dwordx4 v[68:71], v249, s[80:83], s21 offen offset:0 sc0 sc1
    s_waitcnt vmcnt(2)
    v_lshlrev_b32 v192, 16, v40
    v_lshlrev_b32 v194, 16, v41
    v_lshlrev_b32 v196, 16, v42
    v_lshlrev_b32 v198, 16, v43
    v_lshlrev_b32 v200, 16, v44
    v_lshlrev_b32 v202, 16, v45
    v_lshlrev_b32 v204, 16, v46
    v_lshlrev_b32 v206, 16, v47
    v_and_b32 v193, 0xffff0000, v40
    v_and_b32 v195, 0xffff0000, v41
    v_and_b32 v197, 0xffff0000, v42
    v_and_b32 v199, 0xffff0000, v43
    v_and_b32 v201, 0xffff0000, v44
    v_and_b32 v203, 0xffff0000, v45
    v_and_b32 v205, 0xffff0000, v46
    v_and_b32 v207, 0xffff0000, v47
    v_pk_add_f32 v[16:17], v[16:17], v[192:193]
    v_pk_add_f32 v[18:19], v[18:19], v[194:195]
    v_pk_add_f32 v[20:21], v[20:21], v[196:197]
    v_pk_add_f32 v[22:23], v[22:23], v[198:199]
    v_pk_add_f32 v[24:25], v[24:25], v[200:201]
    v_pk_add_f32 v[26:27], v[26:27], v[202:203]
    v_pk_add_f32 v[28:29], v[28:29], v[204:205]
    v_pk_add_f32 v[30:31], v[30:31], v[206:207]
    v_cvt_pk_bf16_f32 v208, v16, v17
    v_cvt_pk_bf16_f32 v209, v18, v19
    v_cvt_pk_bf16_f32 v210, v20, v21
    v_cvt_pk_bf16_f32 v211, v22, v23
    v_cvt_pk_bf16_f32 v212, v24, v25
    v_cvt_pk_bf16_f32 v213, v26, v27
    v_cvt_pk_bf16_f32 v214, v28, v29
    v_cvt_pk_bf16_f32 v215, v30, v31
    v_lshlrev_b32 v96, 16, v208
    v_lshlrev_b32 v98, 16, v209
    v_lshlrev_b32 v100, 16, v210
    v_lshlrev_b32 v102, 16, v211
    v_lshlrev_b32 v104, 16, v212
    v_lshlrev_b32 v106, 16, v213
    v_lshlrev_b32 v108, 16, v214
    v_lshlrev_b32 v110, 16, v215
    v_and_b32 v97, 0xffff0000, v208
    v_and_b32 v99, 0xffff0000, v209
    v_and_b32 v101, 0xffff0000, v210
    v_and_b32 v103, 0xffff0000, v211
    v_and_b32 v105, 0xffff0000, v212
    v_and_b32 v107, 0xffff0000, v213
    v_and_b32 v109, 0xffff0000, v214
    v_and_b32 v111, 0xffff0000, v215
    v_pk_add_f32 v[96:97], v[96:97], v[160:161]
    v_pk_add_f32 v[98:99], v[98:99], v[162:163]
    v_pk_add_f32 v[100:101], v[100:101], v[164:165]
    v_pk_add_f32 v[102:103], v[102:103], v[166:167]
    v_pk_add_f32 v[104:105], v[104:105], v[168:169]
    v_pk_add_f32 v[106:107], v[106:107], v[170:171]
    v_pk_add_f32 v[108:109], v[108:109], v[172:173]
    v_pk_add_f32 v[110:111], v[110:111], v[174:175]
    v_cvt_pk_bf16_f32 v72, v96, v97
    v_cvt_pk_bf16_f32 v73, v98, v99
    v_cvt_pk_bf16_f32 v74, v100, v101
    v_cvt_pk_bf16_f32 v75, v102, v103
    v_cvt_pk_bf16_f32 v76, v104, v105
    v_cvt_pk_bf16_f32 v77, v106, v107
    v_cvt_pk_bf16_f32 v78, v108, v109
    v_cvt_pk_bf16_f32 v79, v110, v111
    buffer_store_dwordx4 v[72:75], v249, s[80:83], s20 offen offset:1024 sc0 sc1
    buffer_store_dwordx4 v[76:79], v249, s[80:83], s21 offen offset:1024 sc0 sc1
    s_lshr_b32 s64, s3, 1
    s_and_b32 s64, s64, s68
    s_cbranch_scc0 hl_10
    v_cmp_eq_u32 vcc, 0, v252
    s_lshl_b32 s64, s73, 4
    s_add_u32 s64, s64, s25
    s_lshl_b32 s64, s64, 11
    s_add_u32 s64, s64, 73400320
    v_cndmask_b32 v212, v72, v88, vcc
    v_cndmask_b32 v213, v73, v88, vcc
    v_cndmask_b32 v214, v74, v88, vcc
    v_cndmask_b32 v215, v75, v88, vcc
    v_cndmask_b32 v216, v76, v88, vcc
    v_cndmask_b32 v217, v77, v88, vcc
    v_cndmask_b32 v218, v78, v88, vcc
    v_cndmask_b32 v219, v79, v88, vcc
    buffer_store_dwordx4 v[212:215], v249, s[80:83], s64 offen offset:0 sc0 sc1
    buffer_store_dwordx4 v[216:219], v249, s[80:83], s64 offen offset:1024 sc0 sc1
hl_10:
    v_dot2_f32_bf16 v80, v64, v88, 0
    v_dot2_f32_bf16 v84, v64, v64, 0
    v_dot2_f32_bf16 v81, v68, v88, 0
    v_dot2_f32_bf16 v85, v68, v68, 0
    v_dot2_f32_bf16 v82, v72, v88, 0
    v_dot2_f32_bf16 v86, v72, v72, 0
    v_dot2_f32_bf16 v83, v76, v88, 0
    v_dot2_f32_bf16 v87, v76, v76, 0
    v_dot2_f32_bf16 v80, v65, v88, v80
    v_dot2_f32_bf16 v84, v65, v65, v84
    v_dot2_f32_bf16 v81, v69, v88, v81
    v_dot2_f32_bf16 v85, v69, v69, v85
    v_dot2_f32_bf16 v82, v73, v88, v82
    v_dot2_f32_bf16 v86, v73, v73, v86
    v_dot2_f32_bf16 v83, v77, v88, v83
    v_dot2_f32_bf16 v87, v77, v77, v87
    v_dot2_f32_bf16 v80, v66, v88, v80
    v_dot2_f32_bf16 v84, v66, v66, v84
    v_dot2_f32_bf16 v81, v70, v88, v81
    v_dot2_f32_bf16 v85, v70, v70, v85
    v_dot2_f32_bf16 v82, v74, v88, v82
    v_dot2_f32_bf16 v86, v74, v74, v86
    v_dot2_f32_bf16 v83, v78, v88, v83
    v_dot2_f32_bf16 v87, v78, v78, v87
    v_dot2_f32_bf16 v80, v67, v88, v80
    v_dot2_f32_bf16 v84, v67, v67, v84
    v_dot2_f32_bf16 v81, v71, v88, v81
    v_dot2_f32_bf16 v85, v71, v71, v85
    v_dot2_f32_bf16 v82, v75, v88, v82
    v_dot2_f32_bf16 v86, v75, v75, v86
    v_dot2_f32_bf16 v83, v79, v88, v83
    v_dot2_f32_bf16 v87, v79, v79, v87
    s_nop 2
    v_permlane16_swap_b32 v80, v81
    v_permlane16_swap_b32 v82, v83
    v_permlane16_swap_b32 v84, v85
    v_permlane16_swap_b32 v86, v87
    v_add_f32 v80, v80, v81
    v_add_f32 v82, v82, v83
    v_add_f32 v84, v84, v85
    v_add_f32 v86, v86, v87
    s_nop 1
    v_permlane32_swap_b32 v80, v82
    v_permlane32_swap_b32 v84, v86
    v_add_f32 v80, v80, v82
    v_add_f32 v81, v84, v86
    buffer_store_dwordx2 v[80:81], v239, s[80:83], s24 offen sc0 sc1
    s_lshl_b32 s64, s75, 15
    s_lshl_b32 s66, s73, 9
    s_add_u32 s64, s64, s66
    s_add_u32 s64, s64, 75522048
    s_lshl_b32 s65, s72, 5
    s_add_u32 s64, s64, s65
    s_lshl_b32 s65, s3, 2
    s_add_u32 s64, s64, s65
    v_mov_b32 v208, 0
    v_mov_b32 v209, 1
    s_cmp_lg_u32 s78, 0
    s_cbranch_scc1 sg_11_slow
    s_waitcnt vmcnt(0)
    s_mov_b64 exec, 1
    buffer_store_dword v209, v208, s[80:83], s64 offen
    s_mov_b64 exec, -1
sg_11_done:
    s_branch fo_9_end
fo_9_out:
    s_mov_b32 s8, s98
    s_mov_b32 s9, s99
    s_mov_b32 s10, 4194304
    s_mov_b32 s11, 0x00020000
    s_lshl_b32 s64, s73, 1
    s_add_u32 s64, s64, s68
    s_lshl_b32 s64, s64, 1
    s_lshr_b32 s65, s3, 1
    s_add_u32 s64, s64, s65
    s_lshl_b32 s64, s64, 16
    s_lshl_b32 s65, s25, 7
    s_add_u32 s64, s64, s65
    v_lshlrev_b32 v243, 11, v252
    v_add_u32 v243, s64, v243
    v_and_b32 v253, 1, v251
    v_lshl_add_u32 v243, v253, 5, v243
    v_lshrrev_b32 v253, 1, v251
    v_lshl_add_u32 v243, v253, 4, v243
    s_waitcnt vmcnt(2)
    v_lshlrev_b32 v176, 16, v32
    v_lshlrev_b32 v178, 16, v33
    v_lshlrev_b32 v180, 16, v34
    v_lshlrev_b32 v182, 16, v35
    v_lshlrev_b32 v184, 16, v36
    v_lshlrev_b32 v186, 16, v37
    v_lshlrev_b32 v188, 16, v38
    v_lshlrev_b32 v190, 16, v39
    v_and_b32 v177, 0xffff0000, v32
    v_and_b32 v179, 0xffff0000, v33
    v_and_b32 v181, 0xffff0000, v34
    v_and_b32 v183, 0xffff0000, v35
    v_and_b32 v185, 0xffff0000, v36
    v_and_b32 v187, 0xffff0000, v37
    v_and_b32 v189, 0xffff0000, v38
    v_and_b32 v191, 0xffff0000, v39
    v_pk_add_f32 v[0:1], v[0:1], v[176:177]
    v_pk_add_f32 v[2:3], v[2:3], v[178:179]
    v_pk_add_f32 v[4:5], v[4:5], v[180:181]
    v_pk_add_f32 v[6:7], v[6:7], v[182:183]
    v_pk_add_f32 v[8:9], v[8:9], v[184:185]
    v_pk_add_f32 v[10:11], v[10:11], v[186:187]
    v_pk_add_f32 v[12:13], v[12:13], v[188:189]
    v_pk_add_f32 v[14:15], v[14:15], v[190:191]
    v_cvt_pk_bf16_f32 v208, v0, v1
    v_cvt_pk_bf16_f32 v209, v2, v3
    v_cvt_pk_bf16_f32 v210, v4, v5
    v_cvt_pk_bf16_f32 v211, v6, v7
    v_cvt_pk_bf16_f32 v212, v8, v9
    v_cvt_pk_bf16_f32 v213, v10, v11
    v_cvt_pk_bf16_f32 v214, v12, v13
    v_cvt_pk_bf16_f32 v215, v14, v15
    v_lshlrev_b32 v96, 16, v208
    v_lshlrev_b32 v98, 16, v209
    v_lshlrev_b32 v100, 16, v210
    v_lshlrev_b32 v102, 16, v211
    v_lshlrev_b32 v104, 16, v212
    v_lshlrev_b32 v106, 16, v213
    v_lshlrev_b32 v108, 16, v214
    v_lshlrev_b32 v110, 16, v215
    v_and_b32 v97, 0xffff0000, v208
    v_and_b32 v99, 0xffff0000, v209
    v_and_b32 v101, 0xffff0000, v210
    v_and_b32 v103, 0xffff0000, v211
    v_and_b32 v105, 0xffff0000, v212
    v_and_b32 v107, 0xffff0000, v213
    v_and_b32 v109, 0xffff0000, v214
    v_and_b32 v111, 0xffff0000, v215
    v_pk_add_f32 v[96:97], v[96:97], v[144:145]
    v_pk_add_f32 v[98:99], v[98:99], v[146:147]
    v_pk_add_f32 v[100:101], v[100:101], v[148:149]
    v_pk_add_f32 v[102:103], v[102:103], v[150:151]
    v_pk_add_f32 v[104:105], v[104:105], v[152:153]
    v_pk_add_f32 v[106:107], v[106:107], v[154:155]
    v_pk_add_f32 v[108:109], v[108:109], v[156:157]
    v_pk_add_f32 v[110:111], v[110:111], v[158:159]
    v_cvt_pk_bf16_f32 v64, v96, v97
    v_cvt_pk_bf16_f32 v65, v98, v99
    v_cvt_pk_bf16_f32 v66, v100, v101
    v_cvt_pk_bf16_f32 v67, v102, v103
    v_cvt_pk_bf16_f32 v68, v104, v105
    v_cvt_pk_bf16_f32 v69, v106, v107
    v_cvt_pk_bf16_f32 v70, v108, v109
    v_cvt_pk_bf16_f32 v71, v110, v111
    s_mov_b32 s64, 0
    s_nop 0
    v_permlane16_swap_b32 v64, v66
    v_permlane16_swap_b32 v65, v67
    buffer_store_dwordx4 v[64:67], v243, s[8:11], s64 offen offset:0
    s_mov_b32 s64, 0
    s_nop 0
    v_permlane16_swap_b32 v68, v70
    v_permlane16_swap_b32 v69, v71
    buffer_store_dwordx4 v[68:71], v243, s[8:11], s64 offen offset:64
    s_waitcnt vmcnt(2)
    v_lshlrev_b32 v192, 16, v40
    v_lshlrev_b32 v194, 16, v41
    v_lshlrev_b32 v196, 16, v42
    v_lshlrev_b32 v198, 16, v43
    v_lshlrev_b32 v200, 16, v44
    v_lshlrev_b32 v202, 16, v45
    v_lshlrev_b32 v204, 16, v46
    v_lshlrev_b32 v206, 16, v47
    v_and_b32 v193, 0xffff0000, v40
    v_and_b32 v195, 0xffff0000, v41
    v_and_b32 v197, 0xffff0000, v42
    v_and_b32 v199, 0xffff0000, v43
    v_and_b32 v201, 0xffff0000, v44
    v_and_b32 v203, 0xffff0000, v45
    v_and_b32 v205, 0xffff0000, v46
    v_and_b32 v207, 0xffff0000, v47
    v_pk_add_f32 v[16:17], v[16:17], v[192:193]
    v_pk_add_f32 v[18:19], v[18:19], v[194:195]
    v_pk_add_f32 v[20:21], v[20:21], v[196:197]
    v_pk_add_f32 v[22:23], v[22:23], v[198:199]
    v_pk_add_f32 v[24:25], v[24:25], v[200:201]
    v_pk_add_f32 v[26:27], v[26:27], v[202:203]
    v_pk_add_f32 v[28:29], v[28:29], v[204:205]
    v_pk_add_f32 v[30:31], v[30:31], v[206:207]
    v_cvt_pk_bf16_f32 v208, v16, v17
    v_cvt_pk_bf16_f32 v209, v18, v19
    v_cvt_pk_bf16_f32 v210, v20, v21
    v_cvt_pk_bf16_f32 v211, v22, v23
    v_cvt_pk_bf16_f32 v212, v24, v25
    v_cvt_pk_bf16_f32 v213, v26, v27
    v_cvt_pk_bf16_f32 v214, v28, v29
    v_cvt_pk_bf16_f32 v215, v30, v31
    v_lshlrev_b32 v96, 16, v208
    v_lshlrev_b32 v98, 16, v209
    v_lshlrev_b32 v100, 16, v210
    v_lshlrev_b32 v102, 16, v211
    v_lshlrev_b32 v104, 16, v212
    v_lshlrev_b32 v106, 16, v213
    v_lshlrev_b32 v108, 16, v214
    v_lshlrev_b32 v110, 16, v215
    v_and_b32 v97, 0xffff0000, v208
    v_and_b32 v99, 0xffff0000, v209
    v_and_b32 v101, 0xffff0000, v210
    v_and_b32 v103, 0xffff0000, v211
    v_and_b32 v105, 0xffff0000, v212
    v_and_b32 v107, 0xffff0000, v213
    v_and_b32 v109, 0xffff0000, v214
    v_and_b32 v111, 0xffff0000, v215
    v_pk_add_f32 v[96:97], v[96:97], v[160:161]
    v_pk_add_f32 v[98:99], v[98:99], v[162:163]
    v_pk_add_f32 v[100:101], v[100:101], v[164:165]
    v_pk_add_f32 v[102:103], v[102:103], v[166:167]
    v_pk_add_f32 v[104:105], v[104:105], v[168:169]
    v_pk_add_f32 v[106:107], v[106:107], v[170:171]
    v_pk_add_f32 v[108:109], v[108:109], v[172:173]
    v_pk_add_f32 v[110:111], v[110:111], v[174:175]
    v_cvt_pk_bf16_f32 v72, v96, v97
    v_cvt_pk_bf16_f32 v73, v98, v99
    v_cvt_pk_bf16_f32 v74, v100, v101
    v_cvt_pk_bf16_f32 v75, v102, v103
    v_cvt_pk_bf16_f32 v76, v104, v105
    v_cvt_pk_bf16_f32 v77, v106, v107
    v_cvt_pk_bf16_f32 v78, v108, v109
    v_cvt_pk_bf16_f32 v79, v110, v111
    s_mov_b32 s64, 32768
    s_nop 0
    v_permlane16_swap_b32 v72, v74
    v_permlane16_swap_b32 v73, v75
    buffer_store_dwordx4 v[72:75], v243, s[8:11], s64 offen offset:0
    s_mov_b32 s64, 32768
    s_nop 0
    v_permlane16_swap_b32 v76, v78
    v_permlane16_swap_b32 v77, v79
    buffer_store_dwordx4 v[76:79], v243, s[8:11], s64 offen offset:64
fo_9_end:
    s_add_u32 s75, s75, 1
    s_mov_b32 s59, s78
    s_mul_i32 s60, s59, s75
    s_cmp_lt_u32 s75, 2
    s_cbranch_scc1 C_layer
    s_branch L_fin
g1c_rem:
    v_cvt_pk_bf16_f32 v56, v24, v25
    v_cvt_pk_bf16_f32 v57, v26, v27
    v_cvt_pk_bf16_f32 v58, v28, v29
    v_cvt_pk_bf16_f32 v59, v30, v31
    buffer_store_dwordx4 v[56:59], v249, s[80:83], s21 offen offset:0 sc0 sc1
    v_cvt_pk_bf16_f32 v60, v32, v33
    v_cvt_pk_bf16_f32 v61, v34, v35
    v_cvt_pk_bf16_f32 v62, v36, v37
    v_cvt_pk_bf16_f32 v63, v38, v39
    buffer_store_dwordx4 v[60:63], v249, s[80:83], s21 offen offset:1024 sc0 sc1
    v_cvt_pk_bf16_f32 v64, v40, v41
    v_cvt_pk_bf16_f32 v65, v42, v43
    v_cvt_pk_bf16_f32 v66, v44, v45
    v_cvt_pk_bf16_f32 v67, v46, v47
    buffer_store_dwordx4 v[64:67], v249, s[80:83], s21 offen offset:2048 sc0 sc1
    v_cvt_pk_bf16_f32 v68, v48, v49
    v_cvt_pk_bf16_f32 v69, v50, v51
    v_cvt_pk_bf16_f32 v70, v52, v53
    v_cvt_pk_bf16_f32 v71, v54, v55
    buffer_store_dwordx4 v[68:71], v249, s[80:83], s21 offen offset:3072 sc0 sc1
    s_branch g1c_remb
sg_4_slow:
    s_waitcnt vmcnt(0)
    buffer_wbl2 sc1
    s_waitcnt vmcnt(0)
    s_mov_b64 exec, 1
    buffer_store_dword v109, v108, s[80:83], s64 offen sc0 sc1
    s_mov_b64 exec, -1
    s_branch sg_4_done
sg_6_slow:
    s_waitcnt vmcnt(0)
    buffer_wbl2 sc1
    s_waitcnt vmcnt(0)
    s_mov_b64 exec, 1
    buffer_store_dword v209, v208, s[80:83], s64 offen sc0 sc1
    s_mov_b64 exec, -1
    s_branch sg_6_done
sg_7_slow:
    s_waitcnt vmcnt(0)
    buffer_wbl2 sc1
    s_waitcnt vmcnt(0)
    s_mov_b64 exec, 1
    buffer_store_dword v237, v236, s[80:83], s64 offen sc0 sc1
    s_mov_b64 exec, -1
    s_branch sg_7_done
sg_11_slow:
    s_waitcnt vmcnt(0)
    buffer_wbl2 sc1
    s_waitcnt vmcnt(0)
    s_mov_b64 exec, 1
    buffer_store_dword v209, v208, s[80:83], s64 offen sc0 sc1
    s_mov_b64 exec, -1
    s_branch sg_11_done
L_load:
    s_setprio 3
    s_mov_b32 s12, s84
    s_mov_b32 s13, s85
    s_mov_b32 s14, 4194304
    s_mov_b32 s15, 0x00020000
    s_mov_b32 s8, s86
    s_mov_b32 s9, s87
    s_mov_b32 s10, 6291456
    s_mov_b32 s11, 0x00020000
    v_lshrrev_b32 v253, 3, v250
    v_and_b32 v254, 3, v253
    v_lshlrev_b32 v254, 3, v254
    v_and_b32 v253, 4, v253
    v_add_u32 v253, v253, v254
    v_add_u32 v253, s69, v253
    v_mul_u32_u24 v253, 6144, v253
    v_and_b32 v254, 7, v250
    v_lshl_add_u32 v10, v254, 4, v253
    v_add_u32 v11, 2048, v10
    v_add_u32 v12, 4096, v10
    s_mul_i32 s19, s69, 3104
    s_lshl_b32 s17, s74, 7
    s_add_u32 s18, s17, 6291456
    s_mov_b32 s64, s57
    s_mul_i32 s64, s64, 393216
    s_add_u32 s16, s17, s64
    s_add_u32 m0, s19, 86400
    s_nop 0
    buffer_load_dwordx4 v10, s[8:11], s16 offen lds
    s_add_u32 m0, s19, 87424
    s_nop 0
    buffer_load_dwordx4 v11, s[8:11], s16 offen lds
    s_add_u32 m0, s19, 88448
    s_nop 0
    buffer_load_dwordx4 v12, s[8:11], s16 offen lds
    s_add_u32 s16, s16, 196608
    s_cmp_eq_u32 s16, s18
    s_cselect_b32 s16, s17, s16
    v_lshrrev_b32 v253, 3, v250
    v_and_b32 v254, 6, v253
    v_and_b32 v13, 7, v250
    v_xor_b32 v254, v254, v13
    v_lshlrev_b32 v254, 4, v254
    v_lshl_add_u32 v13, v253, 11, v254
    v_add_u32 v14, 16384, v13
    v_add_u32 v15, 32768, v13
    v_add_u32 v16, 49152, v13
    s_lshl_b32 s21, s67, 18
    s_lshl_b32 s64, s69, 16
    s_add_u32 s21, s21, s64
    s_add_u32 s22, s21, 2048
    s_mov_b32 s64, s57
    s_lshl_b32 s64, s64, 7
    s_add_u32 s20, s21, s64
    s_mul_i32 s24, s69, 4294918144
    s_sub_u32 s24, s24, 32768
    s_cmp_eq_u32 s67, 0
    s_cselect_b32 s24, 0x7f000000, s24
    s_lshl_b32 s23, s69, 12
    s_add_u32 s23, s23, 2048
    s_lshl_b32 s25, s69, 10
    s_cmp_eq_u32 s69, 0
    s_cselect_b32 s26, 0xffffff00, -1
    s_mov_b32 s27, -1
    s_mov_b32 s28, s90
    s_mov_b32 s29, s91
    s_mov_b32 s30, 256
    s_mov_b32 s31, 0x00020000
    s_getreg_b32 s32, hwreg(HW_REG_XCC_ID)
    s_and_b32 s32, s32, 15
    s_or_b32 s32, s32, 0x80
    s_cmp_lt_u32 s2, 128
    s_cselect_b32 s36, s92, s94
    s_cselect_b32 s37, s93, s95
    s_mov_b32 s38, 7340032
    s_mov_b32 s39, 0x00020000
    s_and_b32 s34, s2, 127
    s_mul_i32 s34, s34, 57344
    v_lshlrev_b32 v70, 7, v250
    s_mul_i32 s35, s69, 14336
    s_add_u32 s34, s34, s35
    s_lshr_b32 s35, s2, 3
    s_mul_i32 s33, s35, 10923
    s_lshr_b32 s33, s33, 16
    s_mul_i32 s33, s33, 6
    s_sub_u32 s35, s35, s33
    s_lshr_b32 s40, s2, 3
    s_lshl_b32 s40, s40, 2
    s_add_u32 s40, s40, s69
    s_and_b32 s41, s40, 63
    s_mul_i32 s41, s41, 6144
    s_and_b32 s40, s40, 64
    s_add_u32 s40, s40, s41
    s_add_u32 s40, s40, 384
    s_and_b32 s41, s70, 1
    s_lshl_b32 s41, s41, 10
    s_add_u32 s40, s40, s41
    s_add_u32 s40, s86, s40
    s_addc_u32 s41, s87, 0
    s_cmp_ge_u32 s69, 2
    s_cbranch_scc1 nh_12
    s_add_u32 m0, s25, 18432
    s_add_u32 s64, s20, s24
    s_mov_b64 exec, s[26:27]
    buffer_load_dwordx4 v13, s[12:15], s64 offen lds
    s_mov_b64 exec, -1
nh_12:
    s_add_u32 m0, s23, 18432
    s_nop 0
    buffer_load_dwordx4 v13, s[12:15], s20 offen lds
    s_add_u32 m0, s23, 19456
    s_nop 0
    buffer_load_dwordx4 v14, s[12:15], s20 offen lds
    s_add_u32 m0, s23, 20480
    s_nop 0
    buffer_load_dwordx4 v15, s[12:15], s20 offen lds
    s_add_u32 m0, s23, 21504
    s_nop 0
    buffer_load_dwordx4 v16, s[12:15], s20 offen lds
    s_add_u32 s20, s20, 128
    s_cmp_eq_u32 s20, s22
    s_cselect_b32 s20, s21, s20
    s_add_u32 m0, s19, 98816
    s_nop 0
    buffer_load_dwordx4 v10, s[8:11], s16 offen lds
    s_add_u32 m0, s19, 99840
    s_nop 0
    buffer_load_dwordx4 v11, s[8:11], s16 offen lds
    s_add_u32 m0, s19, 100864
    s_nop 0
    buffer_load_dwordx4 v12, s[8:11], s16 offen lds
    s_add_u32 s16, s16, 196608
    s_cmp_eq_u32 s16, s18
    s_cselect_b32 s16, s17, s16
    s_add_u32 m0, s19, 111232
    s_nop 0
    buffer_load_dwordx4 v10, s[8:11], s16 offen lds
    s_add_u32 m0, s19, 112256
    s_nop 0
    buffer_load_dwordx4 v11, s[8:11], s16 offen lds
    s_add_u32 m0, s19, 113280
    s_nop 0
    buffer_load_dwordx4 v12, s[8:11], s16 offen lds
    s_add_u32 s16, s16, 196608
    s_cmp_eq_u32 s16, s18
    s_cselect_b32 s16, s17, s16
    s_cmp_ge_u32 s69, 2
    s_cbranch_scc1 nh_13
    s_add_u32 m0, s25, 36864
    s_add_u32 s64, s20, s24
    s_mov_b64 exec, s[26:27]
    buffer_load_dwordx4 v13, s[12:15], s64 offen lds
    s_mov_b64 exec, -1
nh_13:
    s_add_u32 m0, s23, 36864
    s_nop 0
    buffer_load_dwordx4 v13, s[12:15], s20 offen lds
    s_add_u32 m0, s23, 37888
    s_nop 0
    buffer_load_dwordx4 v14, s[12:15], s20 offen lds
    s_add_u32 m0, s23, 38912
    s_nop 0
    buffer_load_dwordx4 v15, s[12:15], s20 offen lds
    s_add_u32 m0, s23, 39936
    s_nop 0
    buffer_load_dwordx4 v16, s[12:15], s20 offen lds
    s_add_u32 s20, s20, 128
    s_cmp_eq_u32 s20, s22
    s_cselect_b32 s20, s21, s20
    s_add_u32 m0, s19, 123648
    s_nop 0
    buffer_load_dwordx4 v10, s[8:11], s16 offen lds
    s_add_u32 m0, s19, 124672
    s_nop 0
    buffer_load_dwordx4 v11, s[8:11], s16 offen lds
    s_add_u32 m0, s19, 125696
    s_nop 0
    buffer_load_dwordx4 v12, s[8:11], s16 offen lds
    s_add_u32 s16, s16, 196608
    s_cmp_eq_u32 s16, s18
    s_cselect_b32 s16, s17, s16
    s_add_u32 m0, s19, 136064
    s_nop 0
    buffer_load_dwordx4 v10, s[8:11], s16 offen lds
    s_add_u32 m0, s19, 137088
    s_nop 0
    buffer_load_dwordx4 v11, s[8:11], s16 offen lds
    s_add_u32 m0, s19, 138112
    s_nop 0
    buffer_load_dwordx4 v12, s[8:11], s16 offen lds
    s_add_u32 s16, s16, 196608
    s_cmp_eq_u32 s16, s18
    s_cselect_b32 s16, s17, s16
    s_waitcnt vmcnt(16)
    s_barrier
    s_cmp_ge_u32 s69, 2
    s_cbranch_scc1 nh_14
    s_add_u32 m0, s25, 55296
    s_add_u32 s64, s20, s24
    s_mov_b64 exec, s[26:27]
    buffer_load_dwordx4 v13, s[12:15], s64 offen lds
    s_mov_b64 exec, -1
nh_14:
    s_add_u32 m0, s23, 55296
    s_nop 0
    buffer_load_dwordx4 v13, s[12:15], s20 offen lds
    s_add_u32 m0, s23, 56320
    s_nop 0
    buffer_load_dwordx4 v14, s[12:15], s20 offen lds
    s_add_u32 m0, s23, 57344
    s_nop 0
    buffer_load_dwordx4 v15, s[12:15], s20 offen lds
    s_add_u32 m0, s23, 58368
    s_nop 0
    buffer_load_dwordx4 v16, s[12:15], s20 offen lds
    s_add_u32 s20, s20, 128
    s_cmp_eq_u32 s20, s22
    s_cselect_b32 s20, s21, s20
    s_add_u32 m0, s19, 73984
    s_nop 0
    buffer_load_dwordx4 v10, s[8:11], s16 offen lds
    s_add_u32 m0, s19, 75008
    s_nop 0
    buffer_load_dwordx4 v11, s[8:11], s16 offen lds
    s_add_u32 m0, s19, 76032
    s_nop 0
    buffer_load_dwordx4 v12, s[8:11], s16 offen lds
    s_add_u32 s16, s16, 196608
    s_cmp_eq_u32 s16, s18
    s_cselect_b32 s16, s17, s16
    s_add_u32 s42, s57, 2
    s_and_b32 s42, s42, 15
    s_mul_i32 s42, s42, 393216
    s_add_u32 s44, s40, s42
    s_addc_u32 s45, s41, 0
    s_load_dword s43, s[44:45], 0
    s_load_dword s43, s[44:45], 2048
    s_load_dword s43, s[44:45], 4096
    s_add_u32 s42, s57, 3
    s_and_b32 s42, s42, 15
    s_mul_i32 s42, s42, 393216
    s_add_u32 s44, s40, s42
    s_addc_u32 s45, s41, 0
    s_load_dword s43, s[44:45], 0
    s_load_dword s43, s[44:45], 2048
    s_load_dword s43, s[44:45], 4096
    s_waitcnt vmcnt(13)
    s_barrier
    s_cmp_ge_u32 s69, 2
    s_cbranch_scc1 nh_15
    s_add_u32 m0, s25, 0
    s_add_u32 s64, s20, s24
    s_mov_b64 exec, s[26:27]
    buffer_load_dwordx4 v13, s[12:15], s64 offen lds
    s_mov_b64 exec, -1
nh_15:
    s_add_u32 m0, s23, 0
    s_nop 0
    buffer_load_dwordx4 v13, s[12:15], s20 offen lds
    s_add_u32 m0, s23, 1024
    s_nop 0
    buffer_load_dwordx4 v14, s[12:15], s20 offen lds
    s_add_u32 m0, s23, 2048
    s_nop 0
    buffer_load_dwordx4 v15, s[12:15], s20 offen lds
    s_add_u32 m0, s23, 3072
    s_nop 0
    buffer_load_dwordx4 v16, s[12:15], s20 offen lds
    s_add_u32 s20, s20, 128
    s_cmp_eq_u32 s20, s22
    s_cselect_b32 s20, s21, s20
    s_add_u32 m0, s19, 86400
    s_nop 0
    buffer_load_dwordx4 v10, s[8:11], s16 offen lds
    s_add_u32 m0, s19, 87424
    s_nop 0
    buffer_load_dwordx4 v11, s[8:11], s16 offen lds
    s_add_u32 m0, s19, 88448
    s_nop 0
    buffer_load_dwordx4 v12, s[8:11], s16 offen lds
    s_add_u32 s16, s16, 196608
    s_cmp_eq_u32 s16, s18
    s_cselect_b32 s16, s17, s16
    s_add_u32 s42, s57, 4
    s_and_b32 s42, s42, 15
    s_mul_i32 s42, s42, 393216
    s_add_u32 s44, s40, s42
    s_addc_u32 s45, s41, 0
    s_load_dword s43, s[44:45], 0
    s_load_dword s43, s[44:45], 2048
    s_load_dword s43, s[44:45], 4096
    s_waitcnt vmcnt(10)
    s_barrier
    s_add_u32 m0, s19, 98816
    s_nop 0
    buffer_load_dwordx4 v10, s[8:11], s16 offen lds
    s_add_u32 m0, s19, 99840
    s_nop 0
    buffer_load_dwordx4 v11, s[8:11], s16 offen lds
    s_add_u32 m0, s19, 100864
    s_nop 0
    buffer_load_dwordx4 v12, s[8:11], s16 offen lds
    s_add_u32 s16, s16, 196608
    s_cmp_eq_u32 s16, s18
    s_cselect_b32 s16, s17, s16
    s_cmp_ge_u32 s69, 2
    s_cbranch_scc1 nh_16
    s_add_u32 m0, s25, 18432
    s_add_u32 s64, s20, s24
    s_mov_b64 exec, s[26:27]
    buffer_load_dwordx4 v13, s[12:15], s64 offen lds
    s_mov_b64 exec, -1
nh_16:
    s_add_u32 m0, s23, 18432
    s_nop 0
    buffer_load_dwordx4 v13, s[12:15], s20 offen lds
    s_add_u32 m0, s23, 19456
    s_nop 0
    buffer_load_dwordx4 v14, s[12:15], s20 offen lds
    s_add_u32 m0, s23, 20480
    s_nop 0
    buffer_load_dwordx4 v15, s[12:15], s20 offen lds
    s_add_u32 m0, s23, 21504
    s_nop 0
    buffer_load_dwordx4 v16, s[12:15], s20 offen lds
    s_add_u32 s20, s20, 128
    s_cmp_eq_u32 s20, s22
    s_cselect_b32 s20, s21, s20
    s_add_u32 m0, s19, 111232
    s_nop 0
    buffer_load_dwordx4 v10, s[8:11], s16 offen lds
    s_add_u32 m0, s19, 112256
    s_nop 0
    buffer_load_dwordx4 v11, s[8:11], s16 offen lds
    s_add_u32 m0, s19, 113280
    s_nop 0
    buffer_load_dwordx4 v12, s[8:11], s16 offen lds
    s_add_u32 s16, s16, 196608
    s_cmp_eq_u32 s16, s18
    s_cselect_b32 s16, s17, s16
    s_add_u32 s42, s57, 5
    s_and_b32 s42, s42, 15
    s_mul_i32 s42, s42, 393216
    s_add_u32 s44, s40, s42
    s_addc_u32 s45, s41, 0
    s_load_dword s43, s[44:45], 0
    s_load_dword s43, s[44:45], 2048
    s_load_dword s43, s[44:45], 4096
    s_cmp_lg_u32 s69, 3
    s_cbranch_scc1 ar_17
    s_and_b32 s33, s2, 3
    s_lshl_b32 s33, s33, 3
    s_lshl_b32 s33, s32, s33
    s_and_b32 s46, s2, 0xfc
    s_add_u32 s46, s90, s46
    s_addc_u32 s47, s91, 0
    s_atomic_or s33, s[46:47], 0
ar_17:
    s_cmp_lg_u32 s35, 0
    s_cbranch_scc1 vw_18
    s_mov_b32 exec_lo, 4294967295
    s_mov_b32 exec_hi, 16777215
    buffer_load_dword v69, v70, s[36:39], s34 offen
    s_mov_b64 exec, -1
    s_add_u32 s34, s34, 7168
vw_18:
    s_waitcnt vmcnt(10)
    s_barrier
    s_add_u32 m0, s19, 123648
    s_nop 0
    buffer_load_dwordx4 v10, s[8:11], s16 offen lds
    s_add_u32 m0, s19, 124672
    s_nop 0
    buffer_load_dwordx4 v11, s[8:11], s16 offen lds
    s_add_u32 m0, s19, 125696
    s_nop 0
    buffer_load_dwordx4 v12, s[8:11], s16 offen lds
    s_add_u32 s16, s16, 196608
    s_cmp_eq_u32 s16, s18
    s_cselect_b32 s16, s17, s16
    s_cmp_ge_u32 s69, 2
    s_cbranch_scc1 nh_19
    s_add_u32 m0, s25, 36864
    s_add_u32 s64, s20, s24
    s_mov_b64 exec, s[26:27]
    buffer_load_dwordx4 v13, s[12:15], s64 offen lds
    s_mov_b64 exec, -1
nh_19:
    s_add_u32 m0, s23, 36864
    s_nop 0
    buffer_load_dwordx4 v13, s[12:15], s20 offen lds
    s_add_u32 m0, s23, 37888
    s_nop 0
    buffer_load_dwordx4 v14, s[12:15], s20 offen lds
    s_add_u32 m0, s23, 38912
    s_nop 0
    buffer_load_dwordx4 v15, s[12:15], s20 offen lds
    s_add_u32 m0, s23, 39936
    s_nop 0
    buffer_load_dwordx4 v16, s[12:15], s20 offen lds
    s_add_u32 s20, s20, 128
    s_cmp_eq_u32 s20, s22
    s_cselect_b32 s20, s21, s20
    s_add_u32 m0, s19, 136064
    s_nop 0
    buffer_load_dwordx4 v10, s[8:11], s16 offen lds
    s_add_u32 m0, s19, 137088
    s_nop 0
    buffer_load_dwordx4 v11, s[8:11], s16 offen lds
    s_add_u32 m0, s19, 138112
    s_nop 0
    buffer_load_dwordx4 v12, s[8:11], s16 offen lds
    s_add_u32 s16, s16, 196608
    s_cmp_eq_u32 s16, s18
    s_cselect_b32 s16, s17, s16
    s_add_u32 s42, s57, 6
    s_and_b32 s42, s42, 15
    s_mul_i32 s42, s42, 393216
    s_add_u32 s44, s40, s42
    s_addc_u32 s45, s41, 0
    s_load_dword s43, s[44:45], 0
    s_load_dword s43, s[44:45], 2048
    s_load_dword s43, s[44:45], 4096
    s_cmp_lg_u32 s35, 1
    s_cbranch_scc1 vw_20
    s_mov_b32 exec_lo, 4294967295
    s_mov_b32 exec_hi, 16777215
    buffer_load_dword v69, v70, s[36:39], s34 offen
    s_mov_b64 exec, -1
    s_add_u32 s34, s34, 7168
vw_20:
    s_waitcnt vmcnt(10)
    s_barrier
    s_add_u32 m0, s19, 73984
    s_nop 0
    buffer_load_dwordx4 v10, s[8:11], s16 offen lds
    s_add_u32 m0, s19, 75008
    s_nop 0
    buffer_load_dwordx4 v11, s[8:11], s16 offen lds
    s_add_u32 m0, s19, 76032
    s_nop 0
    buffer_load_dwordx4 v12, s[8:11], s16 offen lds
    s_add_u32 s16, s16, 196608
    s_cmp_eq_u32 s16, s18
    s_cselect_b32 s16, s17, s16
    s_cmp_ge_u32 s69, 2
    s_cbranch_scc1 nh_21
    s_add_u32 m0, s25, 55296
    s_add_u32 s64, s20, s24
    s_mov_b64 exec, s[26:27]
    buffer_load_dwordx4 v13, s[12:15], s64 offen lds
    s_mov_b64 exec, -1
nh_21:
    s_add_u32 m0, s23, 55296
    s_nop 0
    buffer_load_dwordx4 v13, s[12:15], s20 offen lds
    s_add_u32 m0, s23, 56320
    s_nop 0
    buffer_load_dwordx4 v14, s[12:15], s20 offen lds
    s_add_u32 m0, s23, 57344
    s_nop 0
    buffer_load_dwordx4 v15, s[12:15], s20 offen lds
    s_add_u32 m0, s23, 58368
    s_nop 0
    buffer_load_dwordx4 v16, s[12:15], s20 offen lds
    s_add_u32 s20, s20, 128
    s_cmp_eq_u32 s20, s22
    s_cselect_b32 s20, s21, s20
    s_add_u32 m0, s19, 86400
    s_nop 0
    buffer_load_dwordx4 v10, s[8:11], s16 offen lds
    s_add_u32 m0, s19, 87424
    s_nop 0
    buffer_load_dwordx4 v11, s[8:11], s16 offen lds
    s_add_u32 m0, s19, 88448
    s_nop 0
    buffer_load_dwordx4 v12, s[8:11], s16 offen lds
    s_add_u32 s16, s16, 196608
    s_cmp_eq_u32 s16, s18
    s_cselect_b32 s16, s17, s16
    s_add_u32 s42, s57, 7
    s_and_b32 s42, s42, 15
    s_mul_i32 s42, s42, 393216
    s_add_u32 s44, s40, s42
    s_addc_u32 s45, s41, 0
    s_load_dword s43, s[44:45], 0
    s_load_dword s43, s[44:45], 2048
    s_load_dword s43, s[44:45], 4096
    s_cmp_lg_u32 s35, 2
    s_cbranch_scc1 vw_22
    s_mov_b32 exec_lo, 4294967295
    s_mov_b32 exec_hi, 16777215
    buffer_load_dword v69, v70, s[36:39], s34 offen
    s_mov_b64 exec, -1
    s_add_u32 s34, s34, 7168
vw_22:
    s_waitcnt vmcnt(10)
    s_barrier
    s_add_u32 m0, s19, 98816
    s_nop 0
    buffer_load_dwordx4 v10, s[8:11], s16 offen lds
    s_add_u32 m0, s19, 99840
    s_nop 0
    buffer_load_dwordx4 v11, s[8:11], s16 offen lds
    s_add_u32 m0, s19, 100864
    s_nop 0
    buffer_load_dwordx4 v12, s[8:11], s16 offen lds
    s_add_u32 s16, s16, 196608
    s_cmp_eq_u32 s16, s18
    s_cselect_b32 s16, s17, s16
    s_cmp_ge_u32 s69, 2
    s_cbranch_scc1 nh_23
    s_add_u32 m0, s25, 0
    s_add_u32 s64, s20, s24
    s_mov_b64 exec, s[26:27]
    buffer_load_dwordx4 v13, s[12:15], s64 offen lds
    s_mov_b64 exec, -1
nh_23:
    s_add_u32 m0, s23, 0
    s_nop 0
    buffer_load_dwordx4 v13, s[12:15], s20 offen lds
    s_add_u32 m0, s23, 1024
    s_nop 0
    buffer_load_dwordx4 v14, s[12:15], s20 offen lds
    s_add_u32 m0, s23, 2048
    s_nop 0
    buffer_load_dwordx4 v15, s[12:15], s20 offen lds
    s_add_u32 m0, s23, 3072
    s_nop 0
    buffer_load_dwordx4 v16, s[12:15], s20 offen lds
    s_add_u32 s20, s20, 128
    s_cmp_eq_u32 s20, s22
    s_cselect_b32 s20, s21, s20
    s_add_u32 m0, s19, 111232
    s_nop 0
    buffer_load_dwordx4 v10, s[8:11], s16 offen lds
    s_add_u32 m0, s19, 112256
    s_nop 0
    buffer_load_dwordx4 v11, s[8:11], s16 offen lds
    s_add_u32 m0, s19, 113280
    s_nop 0
    buffer_load_dwordx4 v12, s[8:11], s16 offen lds
    s_add_u32 s16, s16, 196608
    s_cmp_eq_u32 s16, s18
    s_cselect_b32 s16, s17, s16
    s_add_u32 s42, s57, 8
    s_and_b32 s42, s42, 15
    s_mul_i32 s42, s42, 393216
    s_add_u32 s44, s40, s42
    s_addc_u32 s45, s41, 0
    s_load_dword s43, s[44:45], 0
    s_load_dword s43, s[44:45], 2048
    s_load_dword s43, s[44:45], 4096
    s_cmp_lg_u32 s35, 3
    s_cbranch_scc1 vw_24
    s_mov_b32 exec_lo, 4294967295
    s_mov_b32 exec_hi, 16777215
    buffer_load_dword v69, v70, s[36:39], s34 offen
    s_mov_b64 exec, -1
    s_add_u32 s34, s34, 7168
vw_24:
    s_waitcnt vmcnt(10)
    s_barrier
    s_add_u32 m0, s19, 123648
    s_nop 0
    buffer_load_dwordx4 v10, s[8:11], s16 offen lds
    s_add_u32 m0, s19, 124672
    s_nop 0
    buffer_load_dwordx4 v11, s[8:11], s16 offen lds
    s_add_u32 m0, s19, 125696
    s_nop 0
    buffer_load_dwordx4 v12, s[8:11], s16 offen lds
    s_add_u32 s16, s16, 196608
    s_cmp_eq_u32 s16, s18
    s_cselect_b32 s16, s17, s16
    s_cmp_ge_u32 s69, 2
    s_cbranch_scc1 nh_25
    s_add_u32 m0, s25, 18432
    s_add_u32 s64, s20, s24
    s_mov_b64 exec, s[26:27]
    buffer_load_dwordx4 v13, s[12:15], s64 offen lds
    s_mov_b64 exec, -1
nh_25:
    s_add_u32 m0, s23, 18432
    s_nop 0
    buffer_load_dwordx4 v13, s[12:15], s20 offen lds
    s_add_u32 m0, s23, 19456
    s_nop 0
    buffer_load_dwordx4 v14, s[12:15], s20 offen lds
    s_add_u32 m0, s23, 20480
    s_nop 0
    buffer_load_dwordx4 v15, s[12:15], s20 offen lds
    s_add_u32 m0, s23, 21504
    s_nop 0
    buffer_load_dwordx4 v16, s[12:15], s20 offen lds
    s_add_u32 s20, s20, 128
    s_cmp_eq_u32 s20, s22
    s_cselect_b32 s20, s21, s20
    s_add_u32 m0, s19, 136064
    s_nop 0
    buffer_load_dwordx4 v10, s[8:11], s16 offen lds
    s_add_u32 m0, s19, 137088
    s_nop 0
    buffer_load_dwordx4 v11, s[8:11], s16 offen lds
    s_add_u32 m0, s19, 138112
    s_nop 0
    buffer_load_dwordx4 v12, s[8:11], s16 offen lds
    s_add_u32 s16, s16, 196608
    s_cmp_eq_u32 s16, s18
    s_cselect_b32 s16, s17, s16
    s_add_u32 s42, s57, 9
    s_and_b32 s42, s42, 15
    s_mul_i32 s42, s42, 393216
    s_add_u32 s44, s40, s42
    s_addc_u32 s45, s41, 0
    s_load_dword s43, s[44:45], 0
    s_load_dword s43, s[44:45], 2048
    s_load_dword s43, s[44:45], 4096
    s_cmp_lg_u32 s35, 4
    s_cbranch_scc1 vw_26
    s_mov_b32 exec_lo, 4294967295
    s_mov_b32 exec_hi, 16777215
    buffer_load_dword v69, v70, s[36:39], s34 offen
    s_mov_b64 exec, -1
    s_add_u32 s34, s34, 7168
vw_26:
    s_waitcnt vmcnt(10)
    s_barrier
    s_add_u32 m0, s19, 73984
    s_nop 0
    buffer_load_dwordx4 v10, s[8:11], s16 offen lds
    s_add_u32 m0, s19, 75008
    s_nop 0
    buffer_load_dwordx4 v11, s[8:11], s16 offen lds
    s_add_u32 m0, s19, 76032
    s_nop 0
    buffer_load_dwordx4 v12, s[8:11], s16 offen lds
    s_add_u32 s16, s16, 196608
    s_cmp_eq_u32 s16, s18
    s_cselect_b32 s16, s17, s16
    s_cmp_ge_u32 s69, 2
    s_cbranch_scc1 nh_27
    s_add_u32 m0, s25, 36864
    s_add_u32 s64, s20, s24
    s_mov_b64 exec, s[26:27]
    buffer_load_dwordx4 v13, s[12:15], s64 offen lds
    s_mov_b64 exec, -1
nh_27:
    s_add_u32 m0, s23, 36864
    s_nop 0
    buffer_load_dwordx4 v13, s[12:15], s20 offen lds
    s_add_u32 m0, s23, 37888
    s_nop 0
    buffer_load_dwordx4 v14, s[12:15], s20 offen lds
    s_add_u32 m0, s23, 38912
    s_nop 0
    buffer_load_dwordx4 v15, s[12:15], s20 offen lds
    s_add_u32 m0, s23, 39936
    s_nop 0
    buffer_load_dwordx4 v16, s[12:15], s20 offen lds
    s_add_u32 s20, s20, 128
    s_cmp_eq_u32 s20, s22
    s_cselect_b32 s20, s21, s20
    s_add_u32 m0, s19, 86400
    s_nop 0
    buffer_load_dwordx4 v10, s[8:11], s16 offen lds
    s_add_u32 m0, s19, 87424
    s_nop 0
    buffer_load_dwordx4 v11, s[8:11], s16 offen lds
    s_add_u32 m0, s19, 88448
    s_nop 0
    buffer_load_dwordx4 v12, s[8:11], s16 offen lds
    s_add_u32 s16, s16, 196608
    s_cmp_eq_u32 s16, s18
    s_cselect_b32 s16, s17, s16
    s_add_u32 s42, s57, 10
    s_and_b32 s42, s42, 15
    s_mul_i32 s42, s42, 393216
    s_add_u32 s44, s40, s42
    s_addc_u32 s45, s41, 0
    s_load_dword s43, s[44:45], 0
    s_load_dword s43, s[44:45], 2048
    s_load_dword s43, s[44:45], 4096
    s_cmp_lg_u32 s35, 5
    s_cbranch_scc1 vw_28
    s_mov_b32 exec_lo, 4294967295
    s_mov_b32 exec_hi, 16777215
    buffer_load_dword v69, v70, s[36:39], s34 offen
    s_mov_b64 exec, -1
    s_add_u32 s34, s34, 7168
vw_28:
    s_waitcnt vmcnt(10)
    s_barrier
    s_add_u32 m0, s19, 98816
    s_nop 0
    buffer_load_dwordx4 v10, s[8:11], s16 offen lds
    s_add_u32 m0, s19, 99840
    s_nop 0
    buffer_load_dwordx4 v11, s[8:11], s16 offen lds
    s_add_u32 m0, s19, 100864
    s_nop 0
    buffer_load_dwordx4 v12, s[8:11], s16 offen lds
    s_add_u32 s16, s16, 196608
    s_cmp_eq_u32 s16, s18
    s_cselect_b32 s16, s17, s16
    s_cmp_ge_u32 s69, 2
    s_cbranch_scc1 nh_29
    s_add_u32 m0, s25, 55296
    s_add_u32 s64, s20, s24
    s_mov_b64 exec, s[26:27]
    buffer_load_dwordx4 v13, s[12:15], s64 offen lds
    s_mov_b64 exec, -1
nh_29:
    s_add_u32 m0, s23, 55296
    s_nop 0
    buffer_load_dwordx4 v13, s[12:15], s20 offen lds
    s_add_u32 m0, s23, 56320
    s_nop 0
    buffer_load_dwordx4 v14, s[12:15], s20 offen lds
    s_add_u32 m0, s23, 57344
    s_nop 0
    buffer_load_dwordx4 v15, s[12:15], s20 offen lds
    s_add_u32 m0, s23, 58368
    s_nop 0
    buffer_load_dwordx4 v16, s[12:15], s20 offen lds
    s_add_u32 s20, s20, 128
    s_cmp_eq_u32 s20, s22
    s_cselect_b32 s20, s21, s20
    s_add_u32 m0, s19, 111232
    s_nop 0
    buffer_load_dwordx4 v10, s[8:11], s16 offen lds
    s_add_u32 m0, s19, 112256
    s_nop 0
    buffer_load_dwordx4 v11, s[8:11], s16 offen lds
    s_add_u32 m0, s19, 113280
    s_nop 0
    buffer_load_dwordx4 v12, s[8:11], s16 offen lds
    s_add_u32 s16, s16, 196608
    s_cmp_eq_u32 s16, s18
    s_cselect_b32 s16, s17, s16
    s_add_u32 s42, s57, 11
    s_and_b32 s42, s42, 15
    s_mul_i32 s42, s42, 393216
    s_add_u32 s44, s40, s42
    s_addc_u32 s45, s41, 0
    s_load_dword s43, s[44:45], 0
    s_load_dword s43, s[44:45], 2048
    s_load_dword s43, s[44:45], 4096
    s_cmp_lg_u32 s35, 0
    s_cbranch_scc1 vw_30
    s_mov_b32 exec_lo, 4294967295
    s_mov_b32 exec_hi, 16777215
    buffer_load_dword v69, v70, s[36:39], s34 offen
    s_mov_b64 exec, -1
    s_add_u32 s34, s34, 7168
vw_30:
    s_waitcnt vmcnt(10)
    s_barrier
    s_add_u32 m0, s19, 123648
    s_nop 0
    buffer_load_dwordx4 v10, s[8:11], s16 offen lds
    s_add_u32 m0, s19, 124672
    s_nop 0
    buffer_load_dwordx4 v11, s[8:11], s16 offen lds
    s_add_u32 m0, s19, 125696
    s_nop 0
    buffer_load_dwordx4 v12, s[8:11], s16 offen lds
    s_add_u32 s16, s16, 196608
    s_cmp_eq_u32 s16, s18
    s_cselect_b32 s16, s17, s16
    s_cmp_ge_u32 s69, 2
    s_cbranch_scc1 nh_31
    s_add_u32 m0, s25, 0
    s_add_u32 s64, s20, s24
    s_mov_b64 exec, s[26:27]
    buffer_load_dwordx4 v13, s[12:15], s64 offen lds
    s_mov_b64 exec, -1
nh_31:
    s_add_u32 m0, s23, 0
    s_nop 0
    buffer_load_dwordx4 v13, s[12:15], s20 offen lds
    s_add_u32 m0, s23, 1024
    s_nop 0
    buffer_load_dwordx4 v14, s[12:15], s20 offen lds
    s_add_u32 m0, s23, 2048
    s_nop 0
    buffer_load_dwordx4 v15, s[12:15], s20 offen lds
    s_add_u32 m0, s23, 3072
    s_nop 0
    buffer_load_dwordx4 v16, s[12:15], s20 offen lds
    s_add_u32 s20, s20, 128
    s_cmp_eq_u32 s20, s22
    s_cselect_b32 s20, s21, s20
    s_add_u32 m0, s19, 136064
    s_nop 0
    buffer_load_dwordx4 v10, s[8:11], s16 offen lds
    s_add_u32 m0, s19, 137088
    s_nop 0
    buffer_load_dwordx4 v11, s[8:11], s16 offen lds
    s_add_u32 m0, s19, 138112
    s_nop 0
    buffer_load_dwordx4 v12, s[8:11], s16 offen lds
    s_add_u32 s16, s16, 196608
    s_cmp_eq_u32 s16, s18
    s_cselect_b32 s16, s17, s16
    s_add_u32 s42, s57, 12
    s_and_b32 s42, s42, 15
    s_mul_i32 s42, s42, 393216
    s_add_u32 s44, s40, s42
    s_addc_u32 s45, s41, 0
    s_load_dword s43, s[44:45], 0
    s_load_dword s43, s[44:45], 2048
    s_load_dword s43, s[44:45], 4096
    s_cmp_lg_u32 s35, 1
    s_cbranch_scc1 vw_32
    s_mov_b32 exec_lo, 4294967295
    s_mov_b32 exec_hi, 16777215
    buffer_load_dword v69, v70, s[36:39], s34 offen
    s_mov_b64 exec, -1
    s_add_u32 s34, s34, 7168
vw_32:
    s_waitcnt vmcnt(10)
    s_barrier
    s_add_u32 m0, s19, 73984
    s_nop 0
    buffer_load_dwordx4 v10, s[8:11], s16 offen lds
    s_add_u32 m0, s19, 75008
    s_nop 0
    buffer_load_dwordx4 v11, s[8:11], s16 offen lds
    s_add_u32 m0, s19, 76032
    s_nop 0
    buffer_load_dwordx4 v12, s[8:11], s16 offen lds
    s_add_u32 s16, s16, 196608
    s_cmp_eq_u32 s16, s18
    s_cselect_b32 s16, s17, s16
    s_cmp_ge_u32 s69, 2
    s_cbranch_scc1 nh_33
    s_add_u32 m0, s25, 18432
    s_add_u32 s64, s20, s24
    s_mov_b64 exec, s[26:27]
    buffer_load_dwordx4 v13, s[12:15], s64 offen lds
    s_mov_b64 exec, -1
nh_33:
    s_add_u32 m0, s23, 18432
    s_nop 0
    buffer_load_dwordx4 v13, s[12:15], s20 offen lds
    s_add_u32 m0, s23, 19456
    s_nop 0
    buffer_load_dwordx4 v14, s[12:15], s20 offen lds
    s_add_u32 m0, s23, 20480
    s_nop 0
    buffer_load_dwordx4 v15, s[12:15], s20 offen lds
    s_add_u32 m0, s23, 21504
    s_nop 0
    buffer_load_dwordx4 v16, s[12:15], s20 offen lds
    s_add_u32 s20, s20, 128
    s_cmp_eq_u32 s20, s22
    s_cselect_b32 s20, s21, s20
    s_add_u32 m0, s19, 86400
    s_nop 0
    buffer_load_dwordx4 v10, s[8:11], s16 offen lds
    s_add_u32 m0, s19, 87424
    s_nop 0
    buffer_load_dwordx4 v11, s[8:11], s16 offen lds
    s_add_u32 m0, s19, 88448
    s_nop 0
    buffer_load_dwordx4 v12, s[8:11], s16 offen lds
    s_add_u32 s16, s16, 196608
    s_cmp_eq_u32 s16, s18
    s_cselect_b32 s16, s17, s16
    s_add_u32 s42, s57, 13
    s_and_b32 s42, s42, 15
    s_mul_i32 s42, s42, 393216
    s_add_u32 s44, s40, s42
    s_addc_u32 s45, s41, 0
    s_load_dword s43, s[44:45], 0
    s_load_dword s43, s[44:45], 2048
    s_load_dword s43, s[44:45], 4096
    s_cmp_lg_u32 s35, 2
    s_cbranch_scc1 vw_34
    s_mov_b32 exec_lo, 4294967295
    s_mov_b32 exec_hi, 16777215
    buffer_load_dword v69, v70, s[36:39], s34 offen
    s_mov_b64 exec, -1
    s_add_u32 s34, s34, 7168
vw_34:
    s_waitcnt vmcnt(10)
    s_barrier
    s_add_u32 m0, s19, 98816
    s_nop 0
    buffer_load_dwordx4 v10, s[8:11], s16 offen lds
    s_add_u32 m0, s19, 99840
    s_nop 0
    buffer_load_dwordx4 v11, s[8:11], s16 offen lds
    s_add_u32 m0, s19, 100864
    s_nop 0
    buffer_load_dwordx4 v12, s[8:11], s16 offen lds
    s_add_u32 s16, s16, 196608
    s_cmp_eq_u32 s16, s18
    s_cselect_b32 s16, s17, s16
    s_cmp_ge_u32 s69, 2
    s_cbranch_scc1 nh_35
    s_add_u32 m0, s25, 36864
    s_add_u32 s64, s20, s24
    s_mov_b64 exec, s[26:27]
    buffer_load_dwordx4 v13, s[12:15], s64 offen lds
    s_mov_b64 exec, -1
nh_35:
    s_add_u32 m0, s23, 36864
    s_nop 0
    buffer_load_dwordx4 v13, s[12:15], s20 offen lds
    s_add_u32 m0, s23, 37888
    s_nop 0
    buffer_load_dwordx4 v14, s[12:15], s20 offen lds
    s_add_u32 m0, s23, 38912
    s_nop 0
    buffer_load_dwordx4 v15, s[12:15], s20 offen lds
    s_add_u32 m0, s23, 39936
    s_nop 0
    buffer_load_dwordx4 v16, s[12:15], s20 offen lds
    s_add_u32 s20, s20, 128
    s_cmp_eq_u32 s20, s22
    s_cselect_b32 s20, s21, s20
    s_add_u32 m0, s19, 111232
    s_nop 0
    buffer_load_dwordx4 v10, s[8:11], s16 offen lds
    s_add_u32 m0, s19, 112256
    s_nop 0
    buffer_load_dwordx4 v11, s[8:11], s16 offen lds
    s_add_u32 m0, s19, 113280
    s_nop 0
    buffer_load_dwordx4 v12, s[8:11], s16 offen lds
    s_add_u32 s16, s16, 196608
    s_cmp_eq_u32 s16, s18
    s_cselect_b32 s16, s17, s16
    s_add_u32 s42, s57, 14
    s_and_b32 s42, s42, 15
    s_mul_i32 s42, s42, 393216
    s_add_u32 s44, s40, s42
    s_addc_u32 s45, s41, 0
    s_load_dword s43, s[44:45], 0
    s_load_dword s43, s[44:45], 2048
    s_load_dword s43, s[44:45], 4096
    s_cmp_lg_u32 s35, 3
    s_cbranch_scc1 vw_36
    s_mov_b32 exec_lo, 4294967295
    s_mov_b32 exec_hi, 16777215
    buffer_load_dword v69, v70, s[36:39], s34 offen
    s_mov_b64 exec, -1
    s_add_u32 s34, s34, 7168
vw_36:
    s_waitcnt vmcnt(10)
    s_barrier
    s_add_u32 m0, s19, 123648
    s_nop 0
    buffer_load_dwordx4 v10, s[8:11], s16 offen lds
    s_add_u32 m0, s19, 124672
    s_nop 0
    buffer_load_dwordx4 v11, s[8:11], s16 offen lds
    s_add_u32 m0, s19, 125696
    s_nop 0
    buffer_load_dwordx4 v12, s[8:11], s16 offen lds
    s_add_u32 s16, s16, 196608
    s_cmp_eq_u32 s16, s18
    s_cselect_b32 s16, s17, s16
    s_cmp_ge_u32 s69, 2
    s_cbranch_scc1 nh_37
    s_add_u32 m0, s25, 55296
    s_add_u32 s64, s20, s24
    s_mov_b64 exec, s[26:27]
    buffer_load_dwordx4 v13, s[12:15], s64 offen lds
    s_mov_b64 exec, -1
nh_37:
    s_add_u32 m0, s23, 55296
    s_nop 0
    buffer_load_dwordx4 v13, s[12:15], s20 offen lds
    s_add_u32 m0, s23, 56320
    s_nop 0
    buffer_load_dwordx4 v14, s[12:15], s20 offen lds
    s_add_u32 m0, s23, 57344
    s_nop 0
    buffer_load_dwordx4 v15, s[12:15], s20 offen lds
    s_add_u32 m0, s23, 58368
    s_nop 0
    buffer_load_dwordx4 v16, s[12:15], s20 offen lds
    s_add_u32 s20, s20, 128
    s_cmp_eq_u32 s20, s22
    s_cselect_b32 s20, s21, s20
    s_add_u32 m0, s19, 136064
    s_nop 0
    buffer_load_dwordx4 v10, s[8:11], s16 offen lds
    s_add_u32 m0, s19, 137088
    s_nop 0
    buffer_load_dwordx4 v11, s[8:11], s16 offen lds
    s_add_u32 m0, s19, 138112
    s_nop 0
    buffer_load_dwordx4 v12, s[8:11], s16 offen lds
    s_add_u32 s16, s16, 196608
    s_cmp_eq_u32 s16, s18
    s_cselect_b32 s16, s17, s16
    s_add_u32 s42, s57, 15
    s_and_b32 s42, s42, 15
    s_mul_i32 s42, s42, 393216
    s_add_u32 s44, s40, s42
    s_addc_u32 s45, s41, 0
    s_load_dword s43, s[44:45], 0
    s_load_dword s43, s[44:45], 2048
    s_load_dword s43, s[44:45], 4096
    v_lshlrev_b32 v71, 2, v250
    buffer_load_dword v72, v71, s[28:31], 0 offen sc1
    s_cmp_lg_u32 s35, 4
    s_cbranch_scc1 vw_38
    s_mov_b32 exec_lo, 4294967295
    s_mov_b32 exec_hi, 16777215
    buffer_load_dword v69, v70, s[36:39], s34 offen
    s_mov_b64 exec, -1
    s_add_u32 s34, s34, 7168
vw_38:
    s_waitcnt vmcnt(11)
    s_barrier
    s_add_u32 m0, s19, 73984
    s_nop 0
    buffer_load_dwordx4 v10, s[8:11], s16 offen lds
    s_add_u32 m0, s19, 75008
    s_nop 0
    buffer_load_dwordx4 v11, s[8:11], s16 offen lds
    s_add_u32 m0, s19, 76032
    s_nop 0
    buffer_load_dwordx4 v12, s[8:11], s16 offen lds
    s_add_u32 s16, s16, 196608
    s_cmp_eq_u32 s16, s18
    s_cselect_b32 s16, s17, s16
    s_cmp_ge_u32 s69, 2
    s_cbranch_scc1 nh_39
    s_add_u32 m0, s25, 0
    s_add_u32 s64, s20, s24
    s_mov_b64 exec, s[26:27]
    buffer_load_dwordx4 v13, s[12:15], s64 offen lds
    s_mov_b64 exec, -1
nh_39:
    s_add_u32 m0, s23, 0
    s_nop 0
    buffer_load_dwordx4 v13, s[12:15], s20 offen lds
    s_add_u32 m0, s23, 1024
    s_nop 0
    buffer_load_dwordx4 v14, s[12:15], s20 offen lds
    s_add_u32 m0, s23, 2048
    s_nop 0
    buffer_load_dwordx4 v15, s[12:15], s20 offen lds
    s_add_u32 m0, s23, 3072
    s_nop 0
    buffer_load_dwordx4 v16, s[12:15], s20 offen lds
    s_add_u32 s20, s20, 128
    s_cmp_eq_u32 s20, s22
    s_cselect_b32 s20, s21, s20
    s_add_u32 m0, s19, 86400
    s_nop 0
    buffer_load_dwordx4 v10, s[8:11], s16 offen lds
    s_add_u32 m0, s19, 87424
    s_nop 0
    buffer_load_dwordx4 v11, s[8:11], s16 offen lds
    s_add_u32 m0, s19, 88448
    s_nop 0
    buffer_load_dwordx4 v12, s[8:11], s16 offen lds
    s_add_u32 s16, s16, 196608
    s_cmp_eq_u32 s16, s18
    s_cselect_b32 s16, s17, s16
    s_cmp_lg_u32 s35, 5
    s_cbranch_scc1 vw_40
    s_mov_b32 exec_lo, 4294967295
    s_mov_b32 exec_hi, 16777215
    buffer_load_dword v69, v70, s[36:39], s34 offen
    s_mov_b64 exec, -1
    s_add_u32 s34, s34, 7168
vw_40:
    s_waitcnt vmcnt(11)
    s_barrier
    s_add_u32 m0, s19, 98816
    s_nop 0
    buffer_load_dwordx4 v10, s[8:11], s16 offen lds
    s_add_u32 m0, s19, 99840
    s_nop 0
    buffer_load_dwordx4 v11, s[8:11], s16 offen lds
    s_add_u32 m0, s19, 100864
    s_nop 0
    buffer_load_dwordx4 v12, s[8:11], s16 offen lds
    s_add_u32 s16, s16, 196608
    s_cmp_eq_u32 s16, s18
    s_cselect_b32 s16, s17, s16
    s_lshl_b32 s64, s67, 4
    s_add_u32 s64, s64, s74
    s_lshl_b32 s64, s64, 2
    s_add_u32 s64, s64, s69
    s_lshl_b32 s64, s64, 12
    s_lshl_b32 s65, s75, 22
    s_add_u32 s64, s64, s65
    s_add_u32 s64, s64, 12582912
    s_cmp_eq_u32 s68, 0
    s_cselect_b32 s64, s64, 0x7f000000
    v_lshlrev_b32 v253, 7, v250
    s_mov_b64 exec, 0xffffffff
    buffer_load_dword v9, v253, s[80:83], s64 offen sc1
    s_mov_b64 exec, -1
    s_mov_b32 s12, s88
    s_mov_b32 s13, s89
    s_mov_b32 s14, 2097152
    s_mov_b32 s15, 0x00020000
    v_lshrrev_b32 v253, 3, v250
    v_lshlrev_b32 v253, 13, v253
    v_and_b32 v254, 7, v250
    v_lshl_add_u32 v253, v254, 4, v253
    s_lshl_b32 s64, s69, 11
    v_add_u32 v244, s64, v253
    s_mul_i32 s51, s69, 1056
    s_lshl_b32 s49, s72, 7
    s_waitcnt vmcnt(14)
    v_and_b32 v73, 0x80808080, v72
    v_cmp_ne_u32 vcc, 0x80808080, v73
    s_cbranch_vccnz hs_41
hs_41_b:
    s_mul_i32 s65, s69, 36
    v_add_u32 v75, s65, v250
    v_subrev_u32 v76, 16, v75
    v_lshrrev_b32 v77, 1, v76
    v_and_b32 v76, 1, v76
    v_lshlrev_b32 v77, 6, v77
    v_lshl_add_u32 v76, v76, 3, v77
    v_cmp_gt_u32 vcc, 16, v75
    v_lshlrev_b32 v77, 8, v75
    v_add_u32 v77, 16, v77
    v_cndmask_b32 v74, v76, v77, vcc
    s_lshl_b32 s64, s67, 12
    s_add_u32 s64, s64, 74186752
    s_mov_b32 exec_hi, 15
    buffer_load_dwordx2 v[76:77], v74, s[80:83], s64 offen sc1
    s_mov_b64 exec, -1
    v_lshlrev_b32 v75, 3, v75
    v_add_u32 v75, 159744, v75
    s_and_b32 s64, s70, 3
    s_lshl_b32 s64, s64, 3
    v_bfe_u32 v72, v72, s64, 8
    v_cmp_ne_u32 vcc, s32, v72
    s_lshr_b32 s64, s70, 2
    s_lshl_b32 s65, 0x55555555, s64
    s_or_b32 s64, vcc_lo, vcc_hi
    s_and_b32 s64, s64, s65
    s_cselect_b32 s78, 1, 0
    s_mov_b32 s59, s78
    s_mul_i32 s60, s59, s75
    s_add_u32 s48, s58, 0
    s_and_b32 s48, s48, 7
    s_and_b32 s66, s74, 8
    s_or_b32 s48, s48, s66
    s_lshl_b32 s48, s48, 17
    s_add_u32 s48, s48, s49
    s_add_u32 m0, s51, 116224
    s_nop 0
    buffer_load_dwordx4 v244, s[12:15], s48 offen lds
    s_add_u32 s48, s48, 65536
    s_waitcnt vmcnt(6)
    s_barrier
    s_add_u32 m0, s51, 120448
    s_nop 0
    buffer_load_dwordx4 v244, s[12:15], s48 offen lds
    s_add_u32 s48, s48, 65536
    s_add_u32 s48, s58, 1
    s_and_b32 s48, s48, 7
    s_and_b32 s66, s74, 8
    s_or_b32 s48, s48, s66
    s_lshl_b32 s48, s48, 17
    s_add_u32 s48, s48, s49
    s_add_u32 m0, s51, 124672
    s_nop 0
    buffer_load_dwordx4 v244, s[12:15], s48 offen lds
    s_add_u32 s48, s48, 65536
    s_add_u32 m0, s51, 128896
    s_nop 0
    buffer_load_dwordx4 v244, s[12:15], s48 offen lds
    s_add_u32 s48, s48, 65536
    s_add_u32 s48, s58, 2
    s_and_b32 s48, s48, 7
    s_and_b32 s66, s74, 8
    s_or_b32 s48, s48, s66
    s_lshl_b32 s48, s48, 17
    s_add_u32 s48, s48, s49
    s_add_u32 m0, s51, 133120
    s_nop 0
    buffer_load_dwordx4 v244, s[12:15], s48 offen lds
    s_add_u32 s48, s48, 65536
    s_add_u32 m0, s51, 137344
    s_nop 0
    buffer_load_dwordx4 v244, s[12:15], s48 offen lds
    s_add_u32 s48, s48, 65536
    s_add_u32 s48, s58, 3
    s_and_b32 s48, s48, 7
    s_and_b32 s66, s74, 8
    s_or_b32 s48, s48, s66
    s_lshl_b32 s48, s48, 17
    s_add_u32 s48, s48, s49
    s_add_u32 m0, s51, 141568
    s_nop 0
    buffer_load_dwordx4 v244, s[12:15], s48 offen lds
    s_add_u32 s48, s48, 65536
    s_add_u32 m0, s51, 145792
    s_nop 0
    buffer_load_dwordx4 v244, s[12:15], s48 offen lds
    s_add_u32 s48, s48, 65536
    s_add_u32 s48, s58, 4
    s_and_b32 s48, s48, 7
    s_and_b32 s66, s74, 8
    s_or_b32 s48, s48, s66
    s_lshl_b32 s48, s48, 17
    s_add_u32 s48, s48, s49
    s_add_u32 m0, s51, 150016
    s_nop 0
    buffer_load_dwordx4 v244, s[12:15], s48 offen lds
    s_add_u32 s48, s48, 65536
    s_waitcnt vmcnt(11)
    s_barrier
    s_waitcnt vmcnt(9)
    v_mov_b32 v72, s78
    v_mov_b32 v73, 163456
    s_mov_b32 exec_hi, 15
    ds_write_b64 v75, v[76:77]
    ds_write_b32 v73, v72
    s_mov_b64 exec, -1
    s_add_u32 m0, s51, 154240
    s_nop 0
    buffer_load_dwordx4 v244, s[12:15], s48 offen lds
    s_add_u32 s48, s48, 65536
    s_add_u32 s48, s58, 5
    s_and_b32 s48, s48, 7
    s_and_b32 s66, s74, 8
    s_or_b32 s48, s48, s66
    s_lshl_b32 s48, s48, 17
    s_add_u32 s48, s48, s49
    s_add_u32 m0, s51, 65536
    s_nop 0
    buffer_load_dwordx4 v244, s[12:15], s48 offen lds
    s_add_u32 s48, s48, 65536
    s_add_u32 m0, s51, 69760
    s_nop 0
    buffer_load_dwordx4 v244, s[12:15], s48 offen lds
    s_add_u32 s48, s48, 65536
    s_add_u32 s48, s58, 6
    s_and_b32 s48, s48, 7
    s_and_b32 s66, s74, 8
    s_or_b32 s48, s48, s66
    s_lshl_b32 s48, s48, 17
    s_add_u32 s48, s48, s49
    s_add_u32 m0, s51, 73984
    s_nop 0
    buffer_load_dwordx4 v244, s[12:15], s48 offen lds
    s_add_u32 s48, s48, 65536
    s_add_u32 m0, s51, 78208
    s_nop 0
    buffer_load_dwordx4 v244, s[12:15], s48 offen lds
    s_add_u32 s48, s48, 65536
    s_add_u32 s48, s58, 7
    s_and_b32 s48, s48, 7
    s_and_b32 s66, s74, 8
    s_or_b32 s48, s48, s66
    s_lshl_b32 s48, s48, 17
    s_add_u32 s48, s48, s49
    s_add_u32 m0, s51, 82432
    s_nop 0
    buffer_load_dwordx4 v244, s[12:15], s48 offen lds
    s_add_u32 s48, s48, 65536
    s_add_u32 m0, s51, 86656
    s_nop 0
    buffer_load_dwordx4 v244, s[12:15], s48 offen lds
    s_add_u32 s48, s48, 65536
    s_add_u32 s48, s58, 8
    s_and_b32 s48, s48, 7
    s_and_b32 s66, s74, 8
    s_xor_b32 s66, s66, 8
    s_or_b32 s48, s48, s66
    s_lshl_b32 s48, s48, 17
    s_add_u32 s48, s48, s49
    s_add_u32 m0, s51, 90880
    s_nop 0
    buffer_load_dwordx4 v244, s[12:15], s48 offen lds
    s_add_u32 s48, s48, 65536
    s_waitcnt lgkmcnt(0)
    s_barrier
    s_add_u32 m0, s51, 95104
    s_nop 0
    buffer_load_dwordx4 v244, s[12:15], s48 offen lds
    s_add_u32 s48, s48, 65536
    s_add_u32 s48, s58, 9
    s_and_b32 s48, s48, 7
    s_and_b32 s66, s74, 8
    s_xor_b32 s66, s66, 8
    s_or_b32 s48, s48, s66
    s_lshl_b32 s48, s48, 17
    s_add_u32 s48, s48, s49
    s_add_u32 m0, s51, 99328
    s_nop 0
    buffer_load_dwordx4 v244, s[12:15], s48 offen lds
    s_add_u32 s48, s48, 65536
    s_add_u32 m0, s51, 103552
    s_nop 0
    buffer_load_dwordx4 v244, s[12:15], s48 offen lds
    s_add_u32 s48, s48, 65536
    s_add_u32 s48, s58, 10
    s_and_b32 s48, s48, 7
    s_and_b32 s66, s74, 8
    s_xor_b32 s66, s66, 8
    s_or_b32 s48, s48, s66
    s_lshl_b32 s48, s48, 17
    s_add_u32 s48, s48, s49
    s_add_u32 m0, s51, 107776
    s_nop 0
    buffer_load_dwordx4 v244, s[12:15], s48 offen lds
    s_add_u32 s48, s48, 65536
    s_add_u32 m0, s51, 112000
    s_nop 0
    buffer_load_dwordx4 v244, s[12:15], s48 offen lds
    s_add_u32 s48, s48, 65536
L_g2:
    s_and_b32 s64, s3, 1
    s_cmp_eq_u32 s64, 0
    s_cselect_b32 s8, s92, s94
    s_cselect_b32 s9, s93, s95
    s_mov_b32 s10, 7340032
    s_mov_b32 s11, 0x00020000
    s_mul_i32 s19, s64, 14400
    s_lshr_b32 s64, s69, 1
    s_mul_i32 s65, s64, 7200
    s_add_u32 s19, s19, s65
    s_add_u32 s19, s19, 36736
    s_mul_i32 s17, s64, 28672
    s_mul_i32 s65, s74, 448
    s_add_u32 s17, s17, s65
    s_add_u32 s18, s17, 7340032
    s_lshl_b32 s64, s57, 1
    s_mul_i32 s65, s64, 229376
    s_add_u32 s16, s17, s65
    s_mov_b32 s66, 2341
    v_add_u32 v253, 0, v250
    v_mul_lo_u32 v254, v253, s66
    v_lshrrev_b32 v254, 16, v254
    v_mul_u32_u24 v228, 28, v254
    v_sub_u32 v253, v253, v228
    v_and_b32 v228, 12, v254
    v_add_u32 v254, v254, v228
    v_mul_u32_u24 v254, 7168, v254
    v_lshl_add_u32 v228, v253, 4, v254
    v_add_u32 v253, 64, v250
    v_mul_lo_u32 v254, v253, s66
    v_lshrrev_b32 v254, 16, v254
    v_mul_u32_u24 v229, 28, v254
    v_sub_u32 v253, v253, v229
    v_and_b32 v229, 12, v254
    v_add_u32 v254, v254, v229
    v_mul_u32_u24 v254, 7168, v254
    v_lshl_add_u32 v229, v253, 4, v254
    v_add_u32 v253, 128, v250
    v_mul_lo_u32 v254, v253, s66
    v_lshrrev_b32 v254, 16, v254
    v_mul_u32_u24 v230, 28, v254
    v_sub_u32 v253, v253, v230
    v_and_b32 v230, 12, v254
    v_add_u32 v254, v254, v230
    v_mul_u32_u24 v254, 7168, v254
    v_lshl_add_u32 v230, v253, 4, v254
    v_add_u32 v253, 192, v250
    v_mul_lo_u32 v254, v253, s66
    v_lshrrev_b32 v254, 16, v254
    v_mul_u32_u24 v231, 28, v254
    v_sub_u32 v253, v253, v231
    v_and_b32 v231, 12, v254
    v_add_u32 v254, v254, v231
    v_mul_u32_u24 v254, 7168, v254
    v_lshl_add_u32 v231, v253, 4, v254
    v_add_u32 v253, 256, v250
    v_mul_lo_u32 v254, v253, s66
    v_lshrrev_b32 v254, 16, v254
    v_mul_u32_u24 v232, 28, v254
    v_sub_u32 v253, v253, v232
    v_and_b32 v232, 12, v254
    v_add_u32 v254, v254, v232
    v_mul_u32_u24 v254, 7168, v254
    v_lshl_add_u32 v232, v253, 4, v254
    v_add_u32 v253, 320, v250
    v_mul_lo_u32 v254, v253, s66
    v_lshrrev_b32 v254, 16, v254
    v_mul_u32_u24 v233, 28, v254
    v_sub_u32 v253, v253, v233
    v_and_b32 v233, 12, v254
    v_add_u32 v254, v254, v233
    v_mul_u32_u24 v254, 7168, v254
    v_lshl_add_u32 v233, v253, 4, v254
    v_add_u32 v253, 384, v250
    v_mul_lo_u32 v254, v253, s66
    v_lshrrev_b32 v254, 16, v254
    v_mul_u32_u24 v234, 28, v254
    v_sub_u32 v253, v253, v234
    v_and_b32 v234, 12, v254
    v_add_u32 v254, v254, v234
    v_mul_u32_u24 v254, 7168, v254
    v_lshl_add_u32 v234, v253, 4, v254
    s_lshl_b32 s53, s75, 22
    s_lshl_b32 s64, s73, 18
    s_add_u32 s53, s53, s64
    s_add_u32 s53, s53, 12582912
    s_lshl_b32 s55, s69, 11
    s_add_u32 s53, s53, s55
    s_lshl_b32 s56, s75, 15
    s_lshl_b32 s66, s73, 9
    s_add_u32 s56, s56, s66
    s_add_u32 s56, s56, 75497472
    v_lshlrev_b32 v246, 5, v250
    s_lshl_b32 s62, 1, s72
    s_or_b32 s62, s62, 0x5555
    s_mov_b32 s63, 0
    s_xor_b32 s64, s72, 1
    s_or_b32 s64, s64, s69
    s_cselect_b32 s62, s62, 0xffff
    s_lshl_b32 s46, s75, 12
    s_add_u32 s46, s46, 75575296
    s_xor_b32 s47, s73, 2
    s_lshl_b32 s47, s47, 8
    s_add_u32 s47, s47, s46
    s_add_u32 s47, s47, 128
    s_mov_b64 exec, s[62:63]
pl_42:
    buffer_load_dwordx4 v[240:243], v246, s[80:83], s56 offen sc1
    s_sub_u32 s79, s79, 1
    s_cbranch_scc1 L_abort
    s_waitcnt vmcnt(0)
    v_and_b32 v240, v240, v241
    v_and_b32 v242, v242, v243
    v_and_b32 v240, v240, v242
    v_cmp_ne_u32 vcc, 1, v240
    s_cbranch_vccnz pl_42
    s_mov_b64 exec, -1
    s_cmp_lg_u32 s78, 0
    s_cbranch_scc1 pl_42_acq
pl_42_ok:
    s_lshr_b32 s64, s72, 1
    s_or_b32 s64, s64, s69
    s_cbranch_scc1 rl_43
    s_lshl_b32 s64, s73, 1
    s_add_u32 s64, s64, s68
    s_lshl_b32 s64, s64, 7
    s_add_u32 s64, s64, s46
    v_mov_b32 v242, 0
    v_mov_b32 v243, 1
    s_mov_b64 exec, 1
    buffer_store_dword v243, v242, s[80:83], s64 offen sc0 sc1
    s_mov_b64 exec, -1
rl_43:
    s_add_u32 s52, s58, 0
    s_and_b32 s52, s52, 7
    s_and_b32 s66, s74, 8
    s_or_b32 s52, s52, s66
    s_lshl_b32 s52, s52, 14
    s_add_u32 s52, s52, s53
    s_add_u32 m0, s55, 0
    s_nop 0
    buffer_load_dwordx4 v249, s[80:83], s52 offen offset:0 sc1 lds
    buffer_load_dwordx4 v249, s[80:83], s52 offen offset:1024 sc1 lds
    s_add_u32 s52, s52, 8192
    s_add_u32 m0, s55, 8192
    s_nop 0
    buffer_load_dwordx4 v249, s[80:83], s52 offen offset:0 sc1 lds
    buffer_load_dwordx4 v249, s[80:83], s52 offen offset:1024 sc1 lds
    s_add_u32 s52, s52, 8192
    s_add_u32 s52, s58, 1
    s_and_b32 s52, s52, 7
    s_and_b32 s66, s74, 8
    s_or_b32 s52, s52, s66
    s_lshl_b32 s52, s52, 14
    s_add_u32 s52, s52, s53
    s_add_u32 m0, s55, 16384
    s_nop 0
    buffer_load_dwordx4 v249, s[80:83], s52 offen offset:0 sc1 lds
    buffer_load_dwordx4 v249, s[80:83], s52 offen offset:1024 sc1 lds
    s_add_u32 s52, s52, 8192
    s_add_u32 m0, s55, 24576
    s_nop 0
    buffer_load_dwordx4 v249, s[80:83], s52 offen offset:0 sc1 lds
    buffer_load_dwordx4 v249, s[80:83], s52 offen offset:1024 sc1 lds
    s_add_u32 s52, s52, 8192
    s_waitcnt vmcnt(4) lgkmcnt(0)
    s_barrier
    s_add_u32 s52, s58, 2
    s_and_b32 s52, s52, 7
    s_and_b32 s66, s74, 8
    s_or_b32 s52, s52, s66
    s_lshl_b32 s52, s52, 14
    s_add_u32 s52, s52, s53
    s_add_u32 m0, s55, 32768
    s_nop 0
    buffer_load_dwordx4 v249, s[80:83], s52 offen offset:0 sc1 lds
    buffer_load_dwordx4 v249, s[80:83], s52 offen offset:1024 sc1 lds
    s_add_u32 s52, s52, 8192
    s_add_u32 m0, s55, 40960
    s_nop 0
    buffer_load_dwordx4 v249, s[80:83], s52 offen offset:0 sc1 lds
    buffer_load_dwordx4 v249, s[80:83], s52 offen offset:1024 sc1 lds
    s_add_u32 s52, s52, 8192
    s_add_u32 s52, s58, 3
    s_and_b32 s52, s52, 7
    s_and_b32 s66, s74, 8
    s_or_b32 s52, s52, s66
    s_lshl_b32 s52, s52, 14
    s_add_u32 s52, s52, s53
    s_add_u32 m0, s55, 49152
    s_nop 0
    buffer_load_dwordx4 v249, s[80:83], s52 offen offset:0 sc1 lds
    buffer_load_dwordx4 v249, s[80:83], s52 offen offset:1024 sc1 lds
    s_add_u32 s52, s52, 8192
    s_waitcnt vmcnt(6)
    s_barrier
    s_add_u32 m0, s55, 57344
    s_nop 0
    buffer_load_dwordx4 v249, s[80:83], s52 offen offset:0 sc1 lds
    buffer_load_dwordx4 v249, s[80:83], s52 offen offset:1024 sc1 lds
    s_add_u32 s52, s52, 8192
    s_add_u32 s52, s58, 4
    s_and_b32 s52, s52, 7
    s_and_b32 s66, s74, 8
    s_or_b32 s52, s52, s66
    s_lshl_b32 s52, s52, 14
    s_add_u32 s52, s52, s53
    s_add_u32 m0, s55, 0
    s_nop 0
    buffer_load_dwordx4 v249, s[80:83], s52 offen offset:0 sc1 lds
    buffer_load_dwordx4 v249, s[80:83], s52 offen offset:1024 sc1 lds
    s_add_u32 s52, s52, 8192
    s_add_u32 m0, s55, 8192
    s_nop 0
    buffer_load_dwordx4 v249, s[80:83], s52 offen offset:0 sc1 lds
    buffer_load_dwordx4 v249, s[80:83], s52 offen offset:1024 sc1 lds
    s_add_u32 s52, s52, 8192
    s_waitcnt vmcnt(8)
    s_barrier
    s_add_u32 s52, s58, 5
    s_and_b32 s52, s52, 7
    s_and_b32 s66, s74, 8
    s_or_b32 s52, s52, s66
    s_lshl_b32 s52, s52, 14
    s_add_u32 s52, s52, s53
    s_add_u32 m0, s55, 16384
    s_nop 0
    buffer_load_dwordx4 v249, s[80:83], s52 offen offset:0 sc1 lds
    buffer_load_dwordx4 v249, s[80:83], s52 offen offset:1024 sc1 lds
    s_add_u32 s52, s52, 8192
    s_add_u32 m0, s55, 24576
    s_nop 0
    buffer_load_dwordx4 v249, s[80:83], s52 offen offset:0 sc1 lds
    buffer_load_dwordx4 v249, s[80:83], s52 offen offset:1024 sc1 lds
    s_add_u32 s52, s52, 8192
    s_waitcnt vmcnt(8)
    s_barrier
    s_add_u32 s52, s58, 6
    s_and_b32 s52, s52, 7
    s_and_b32 s66, s74, 8
    s_or_b32 s52, s52, s66
    s_lshl_b32 s52, s52, 14
    s_add_u32 s52, s52, s53
    s_add_u32 m0, s55, 32768
    s_nop 0
    buffer_load_dwordx4 v249, s[80:83], s52 offen offset:0 sc1 lds
    buffer_load_dwordx4 v249, s[80:83], s52 offen offset:1024 sc1 lds
    s_add_u32 s52, s52, 8192
    v_mov_b32 v246, 0
    buffer_load_dword v240, v246, s[80:83], s47 offen sc1
    s_add_u32 m0, s55, 40960
    s_nop 0
    buffer_load_dwordx4 v249, s[80:83], s52 offen offset:0 sc1 lds
    buffer_load_dwordx4 v249, s[80:83], s52 offen offset:1024 sc1 lds
    s_add_u32 s52, s52, 8192
    s_add_u32 s48, s58, 11
    s_and_b32 s48, s48, 7
    s_and_b32 s66, s74, 8
    s_xor_b32 s66, s66, 8
    s_or_b32 s48, s48, s66
    s_lshl_b32 s48, s48, 17
    s_add_u32 s48, s48, s49
    s_add_u32 m0, s51, 116224
    s_nop 0
    buffer_load_dwordx4 v244, s[12:15], s48 offen lds
    s_add_u32 s48, s48, 65536
    s_waitcnt vmcnt(10)
    s_barrier
    s_add_u32 s52, s58, 7
    s_and_b32 s52, s52, 7
    s_and_b32 s66, s74, 8
    s_or_b32 s52, s52, s66
    s_lshl_b32 s52, s52, 14
    s_add_u32 s52, s52, s53
    s_add_u32 m0, s55, 49152
    s_nop 0
    buffer_load_dwordx4 v249, s[80:83], s52 offen offset:0 sc1 lds
    buffer_load_dwordx4 v249, s[80:83], s52 offen offset:1024 sc1 lds
    s_add_u32 s52, s52, 8192
    s_add_u32 m0, s55, 57344
    s_nop 0
    buffer_load_dwordx4 v249, s[80:83], s52 offen offset:0 sc1 lds
    buffer_load_dwordx4 v249, s[80:83], s52 offen offset:1024 sc1 lds
    s_add_u32 s52, s52, 8192
    s_add_u32 m0, s51, 120448
    s_nop 0
    buffer_load_dwordx4 v244, s[12:15], s48 offen lds
    s_add_u32 s48, s48, 65536
    s_waitcnt vmcnt(11)
    s_barrier
    s_waitcnt vmcnt(8)
    v_cmp_ne_u32 vcc, 1, v240
    s_or_b32 s64, vcc_lo, s78
    s_cbranch_scc1 rc_44
rc_44_b:
    s_add_u32 s52, s58, 8
    s_and_b32 s52, s52, 7
    s_and_b32 s66, s74, 8
    s_xor_b32 s66, s66, 8
    s_or_b32 s52, s52, s66
    s_lshl_b32 s52, s52, 14
    s_add_u32 s52, s52, s53
    s_add_u32 m0, s55, 0
    s_nop 0
    buffer_load_dwordx4 v249, s[80:83], s52 offen offset:0 sc1 lds
    buffer_load_dwordx4 v249, s[80:83], s52 offen offset:1024 sc1 lds
    s_add_u32 s52, s52, 8192
    s_add_u32 m0, s55, 8192
    s_nop 0
    buffer_load_dwordx4 v249, s[80:83], s52 offen offset:0 sc1 lds
    buffer_load_dwordx4 v249, s[80:83], s52 offen offset:1024 sc1 lds
    s_add_u32 s52, s52, 8192
    s_add_u32 s48, s58, 12
    s_and_b32 s48, s48, 7
    s_and_b32 s66, s74, 8
    s_xor_b32 s66, s66, 8
    s_or_b32 s48, s48, s66
    s_lshl_b32 s48, s48, 17
    s_add_u32 s48, s48, s49
    s_add_u32 m0, s51, 124672
    s_nop 0
    buffer_load_dwordx4 v244, s[12:15], s48 offen lds
    s_add_u32 s48, s48, 65536
    s_waitcnt vmcnt(11)
    s_barrier
    s_add_u32 s52, s58, 9
    s_and_b32 s52, s52, 7
    s_and_b32 s66, s74, 8
    s_xor_b32 s66, s66, 8
    s_or_b32 s52, s52, s66
    s_lshl_b32 s52, s52, 14
    s_add_u32 s52, s52, s53
    s_add_u32 m0, s55, 16384
    s_nop 0
    buffer_load_dwordx4 v249, s[80:83], s52 offen offset:0 sc1 lds
    buffer_load_dwordx4 v249, s[80:83], s52 offen offset:1024 sc1 lds
    s_add_u32 s52, s52, 8192
    s_add_u32 m0, s55, 24576
    s_nop 0
    buffer_load_dwordx4 v249, s[80:83], s52 offen offset:0 sc1 lds
    buffer_load_dwordx4 v249, s[80:83], s52 offen offset:1024 sc1 lds
    s_add_u32 s52, s52, 8192
    s_add_u32 m0, s51, 128896
    s_nop 0
    buffer_load_dwordx4 v244, s[12:15], s48 offen lds
    s_add_u32 s48, s48, 65536
    s_waitcnt vmcnt(11)
    s_barrier
    s_add_u32 s52, s58, 10
    s_and_b32 s52, s52, 7
    s_and_b32 s66, s74, 8
    s_xor_b32 s66, s66, 8
    s_or_b32 s52, s52, s66
    s_lshl_b32 s52, s52, 14
    s_add_u32 s52, s52, s53
    s_add_u32 m0, s55, 32768
    s_nop 0
    buffer_load_dwordx4 v249, s[80:83], s52 offen offset:0 sc1 lds
    buffer_load_dwordx4 v249, s[80:83], s52 offen offset:1024 sc1 lds
    s_add_u32 s52, s52, 8192
    s_add_u32 m0, s55, 40960
    s_nop 0
    buffer_load_dwordx4 v249, s[80:83], s52 offen offset:0 sc1 lds
    buffer_load_dwordx4 v249, s[80:83], s52 offen offset:1024 sc1 lds
    s_add_u32 s52, s52, 8192
    s_add_u32 s48, s58, 13
    s_and_b32 s48, s48, 7
    s_and_b32 s66, s74, 8
    s_xor_b32 s66, s66, 8
    s_or_b32 s48, s48, s66
    s_lshl_b32 s48, s48, 17
    s_add_u32 s48, s48, s49
    s_add_u32 m0, s51, 133120
    s_nop 0
    buffer_load_dwordx4 v244, s[12:15], s48 offen lds
    s_add_u32 s48, s48, 65536
    s_waitcnt vmcnt(11)
    s_barrier
    s_add_u32 s52, s58, 11
    s_and_b32 s52, s52, 7
    s_and_b32 s66, s74, 8
    s_xor_b32 s66, s66, 8
    s_or_b32 s52, s52, s66
    s_lshl_b32 s52, s52, 14
    s_add_u32 s52, s52, s53
    s_add_u32 m0, s55, 49152
    s_nop 0
    buffer_load_dwordx4 v249, s[80:83], s52 offen offset:0 sc1 lds
    buffer_load_dwordx4 v249, s[80:83], s52 offen offset:1024 sc1 lds
    s_add_u32 s52, s52, 8192
    s_add_u32 m0, s55, 57344
    s_nop 0
    buffer_load_dwordx4 v249, s[80:83], s52 offen offset:0 sc1 lds
    buffer_load_dwordx4 v249, s[80:83], s52 offen offset:1024 sc1 lds
    s_add_u32 s52, s52, 8192
    s_add_u32 m0, s51, 137344
    s_nop 0
    buffer_load_dwordx4 v244, s[12:15], s48 offen lds
    s_add_u32 s48, s48, 65536
    s_waitcnt vmcnt(11)
    s_barrier
    s_add_u32 s52, s58, 12
    s_and_b32 s52, s52, 7
    s_and_b32 s66, s74, 8
    s_xor_b32 s66, s66, 8
    s_or_b32 s52, s52, s66
    s_lshl_b32 s52, s52, 14
    s_add_u32 s52, s52, s53
    s_add_u32 m0, s55, 0
    s_nop 0
    buffer_load_dwordx4 v249, s[80:83], s52 offen offset:0 sc1 lds
    buffer_load_dwordx4 v249, s[80:83], s52 offen offset:1024 sc1 lds
    s_add_u32 s52, s52, 8192
    s_add_u32 m0, s55, 8192
    s_nop 0
    buffer_load_dwordx4 v249, s[80:83], s52 offen offset:0 sc1 lds
    buffer_load_dwordx4 v249, s[80:83], s52 offen offset:1024 sc1 lds
    s_add_u32 s52, s52, 8192
    s_add_u32 s48, s58, 14
    s_and_b32 s48, s48, 7
    s_and_b32 s66, s74, 8
    s_xor_b32 s66, s66, 8
    s_or_b32 s48, s48, s66
    s_lshl_b32 s48, s48, 17
    s_add_u32 s48, s48, s49
    s_add_u32 m0, s51, 141568
    s_nop 0
    buffer_load_dwordx4 v244, s[12:15], s48 offen lds
    s_add_u32 s48, s48, 65536
    s_waitcnt vmcnt(11)
    s_barrier
    s_add_u32 s52, s58, 13
    s_and_b32 s52, s52, 7
    s_and_b32 s66, s74, 8
    s_xor_b32 s66, s66, 8
    s_or_b32 s52, s52, s66
    s_lshl_b32 s52, s52, 14
    s_add_u32 s52, s52, s53
    s_add_u32 m0, s55, 16384
    s_nop 0
    buffer_load_dwordx4 v249, s[80:83], s52 offen offset:0 sc1 lds
    buffer_load_dwordx4 v249, s[80:83], s52 offen offset:1024 sc1 lds
    s_add_u32 s52, s52, 8192
    s_add_u32 m0, s55, 24576
    s_nop 0
    buffer_load_dwordx4 v249, s[80:83], s52 offen offset:0 sc1 lds
    buffer_load_dwordx4 v249, s[80:83], s52 offen offset:1024 sc1 lds
    s_add_u32 s52, s52, 8192
    s_add_u32 m0, s51, 145792
    s_nop 0
    buffer_load_dwordx4 v244, s[12:15], s48 offen lds
    s_add_u32 s48, s48, 65536
    s_waitcnt vmcnt(11)
    s_barrier
    s_add_u32 s52, s58, 14
    s_and_b32 s52, s52, 7
    s_and_b32 s66, s74, 8
    s_xor_b32 s66, s66, 8
    s_or_b32 s52, s52, s66
    s_lshl_b32 s52, s52, 14
    s_add_u32 s52, s52, s53
    s_add_u32 m0, s55, 32768
    s_nop 0
    buffer_load_dwordx4 v249, s[80:83], s52 offen offset:0 sc1 lds
    buffer_load_dwordx4 v249, s[80:83], s52 offen offset:1024 sc1 lds
    s_add_u32 s52, s52, 8192
    s_add_u32 m0, s55, 40960
    s_nop 0
    buffer_load_dwordx4 v249, s[80:83], s52 offen offset:0 sc1 lds
    buffer_load_dwordx4 v249, s[80:83], s52 offen offset:1024 sc1 lds
    s_add_u32 s52, s52, 8192
    s_add_u32 s48, s58, 15
    s_and_b32 s48, s48, 7
    s_and_b32 s66, s74, 8
    s_xor_b32 s66, s66, 8
    s_or_b32 s48, s48, s66
    s_lshl_b32 s48, s48, 17
    s_add_u32 s48, s48, s49
    s_add_u32 m0, s51, 150016
    s_nop 0
    buffer_load_dwordx4 v244, s[12:15], s48 offen lds
    s_add_u32 s48, s48, 65536
    s_waitcnt vmcnt(11)
    s_barrier
    s_add_u32 s52, s58, 15
    s_and_b32 s52, s52, 7
    s_and_b32 s66, s74, 8
    s_xor_b32 s66, s66, 8
    s_or_b32 s52, s52, s66
    s_lshl_b32 s52, s52, 14
    s_add_u32 s52, s52, s53
    s_add_u32 m0, s55, 49152
    s_nop 0
    buffer_load_dwordx4 v249, s[80:83], s52 offen offset:0 sc1 lds
    buffer_load_dwordx4 v249, s[80:83], s52 offen offset:1024 sc1 lds
    s_add_u32 s52, s52, 8192
    s_add_u32 m0, s55, 57344
    s_nop 0
    buffer_load_dwordx4 v249, s[80:83], s52 offen offset:0 sc1 lds
    buffer_load_dwordx4 v249, s[80:83], s52 offen offset:1024 sc1 lds
    s_add_u32 s52, s52, 8192
    s_add_u32 m0, s51, 154240
    s_nop 0
    buffer_load_dwordx4 v244, s[12:15], s48 offen lds
    s_add_u32 s48, s48, 65536
    s_waitcnt vmcnt(11)
    s_barrier
    s_add_u32 m0, s19, 28800
    s_nop 0
    buffer_load_dwordx4 v228, s[8:11], s16 offen lds
    s_add_u32 m0, s19, 29824
    s_nop 0
    buffer_load_dwordx4 v229, s[8:11], s16 offen lds
    s_add_u32 m0, s19, 30848
    s_nop 0
    buffer_load_dwordx4 v230, s[8:11], s16 offen lds
    s_waitcnt vmcnt(3)
    s_barrier
    s_add_u32 m0, s19, 31872
    s_nop 0
    buffer_load_dwordx4 v231, s[8:11], s16 offen lds
    s_add_u32 m0, s19, 32896
    s_nop 0
    buffer_load_dwordx4 v232, s[8:11], s16 offen lds
    s_add_u32 m0, s19, 33920
    s_nop 0
    buffer_load_dwordx4 v233, s[8:11], s16 offen lds
    s_add_u32 m0, s19, 34944
    s_nop 0
    buffer_load_dwordx4 v234, s[8:11], s16 offen lds
    s_add_u32 s16, s16, 229376
    s_cmp_eq_u32 s16, s18
    s_cselect_b32 s16, s17, s16
    s_add_u32 m0, s19, 57600
    s_nop 0
    buffer_load_dwordx4 v228, s[8:11], s16 offen lds
    s_add_u32 m0, s19, 58624
    s_nop 0
    buffer_load_dwordx4 v229, s[8:11], s16 offen lds
    s_add_u32 m0, s19, 59648
    s_nop 0
    buffer_load_dwordx4 v230, s[8:11], s16 offen lds
    s_add_u32 m0, s19, 60672
    s_nop 0
    buffer_load_dwordx4 v231, s[8:11], s16 offen lds
    s_add_u32 m0, s19, 61696
    s_nop 0
    buffer_load_dwordx4 v232, s[8:11], s16 offen lds
    s_add_u32 m0, s19, 62720
    s_nop 0
    buffer_load_dwordx4 v233, s[8:11], s16 offen lds
    s_add_u32 m0, s19, 63744
    s_nop 0
    buffer_load_dwordx4 v234, s[8:11], s16 offen lds
    s_add_u32 s16, s16, 229376
    s_cmp_eq_u32 s16, s18
    s_cselect_b32 s16, s17, s16
    s_barrier
    s_setprio 1
    s_and_b32 s64, s69, 2
    s_xor_b32 s32, s73, s64
    s_lshl_b32 s21, s75, 23
    s_lshl_b32 s64, s32, 18
    s_add_u32 s21, s21, s64
    s_lshl_b32 s64, s68, 1
    s_and_b32 s65, s69, 1
    s_add_u32 s33, s64, s65
    s_lshl_b32 s64, s33, 11
    s_add_u32 s21, s21, s64
    s_lshl_b32 s23, s69, 11
    s_add_u32 s22, s21, 262144
    s_lshl_b32 s64, s57, 14
    s_add_u32 s20, s21, s64
    s_add_u32 s34, s58, s71
    s_lshl_b32 s34, s34, 1
    s_add_u32 s34, s34, s68
    s_and_b32 s64, s3, 1
    s_lshl_b32 s64, s64, 12
    v_add_u32 v235, s64, v249
    v_lshrrev_b32 v253, 1, v251
    v_lshrrev_b32 v254, 2, v252
    v_lshl_add_u32 v253, v253, 2, v254
    v_mul_u32_u24 v253, 448, v253
    v_and_b32 v254, 1, v251
    v_mul_u32_u24 v254, 7200, v254
    v_add_u32 v253, v253, v254
    v_and_b32 v254, 3, v252
    v_lshl_add_u32 v253, v254, 3, v253
    v_add_u32 v253, 36736, v253
    s_lshr_b32 s64, s69, 1
    s_lshl_b32 s28, s64, 2
    s_add_u32 s28, s28, 8
    s_lshl_b32 s65, s28, 5
    v_add_u32 v236, s65, v253
    v_add_u32 v237, 57600, v236
    s_add_u32 s65, s64, 10
    s_lshl_b32 s65, s65, 5
    v_add_u32 v238, s65, v253
    v_add_u32 v239, 57600, v238
    s_mul_i32 s65, s64, 224
    s_and_b32 s64, s3, 1
    s_mul_i32 s64, s64, 14400
    s_add_u32 s65, s65, s64
    v_add_u32 v224, s65, v253
    v_mov_b32 v220, 0x3f803f80
    v_mov_b32 v221, 0x3f803f80
    v_mov_b32 v222, 0x3f803f80
    v_mov_b32 v223, 0x3f803f80
    s_lshl_b32 s25, s73, 1
    s_add_u32 s25, s25, s68
    s_mul_i32 s25, s25, 458752
    s_lshl_b32 s66, s60, 24
    s_add_u32 s25, s25, s66
    s_add_u32 s25, s25, 20971520
    s_and_b32 s64, s74, 7
    s_mul_i32 s64, s64, 57344
    s_add_u32 s25, s25, s64
    s_cmp_eq_u32 s75, 0
    s_cselect_b32 s27, 0, 8
    s_and_b32 s64, s34, 3
    s_or_b32 s27, s27, s64
    s_lshl_b32 s35, s75, 15
    s_lshl_b32 s66, s73, 9
    s_add_u32 s35, s35, s66
    s_add_u32 s35, s35, 75505664
    s_lshl_b32 s65, s68, 3
    s_add_u32 s35, s35, s65
    v_lshlrev_b32 v246, 5, v250
    s_lshl_b32 s36, s75, 12
    s_add_u32 s36, s36, 75563008
    s_xor_b32 s37, s73, 2
    s_lshl_b32 s37, s37, 1
    s_add_u32 s37, s37, s68
    s_lshl_b32 s37, s37, 7
    s_add_u32 s37, s37, s36
    s_cmp_ge_u32 s69, 2
    s_cbranch_scc1 lr_146
    s_mov_b64 exec, 0xffff
pl_147:
    buffer_load_dwordx2 v[240:241], v246, s[80:83], s35 offen sc1
    s_sub_u32 s79, s79, 1
    s_cbranch_scc1 L_abort
    s_waitcnt vmcnt(0)
    v_and_b32 v240, v240, v241
    v_cmp_ne_u32 vcc, 1, v240
    s_cbranch_vccnz pl_147
    s_mov_b64 exec, -1
    s_cmp_lg_u32 s78, 0
    s_cbranch_scc1 pl_147_acq
pl_147_ok:
    s_lshr_b32 s64, s72, 1
    s_or_b32 s64, s64, s69
    s_cbranch_scc1 rl_148
    s_lshl_b32 s64, s73, 1
    s_add_u32 s64, s64, s68
    s_lshl_b32 s64, s64, 7
    s_add_u32 s64, s64, s36
    v_mov_b32 v242, 0
    v_mov_b32 v243, 1
    s_mov_b64 exec, 1
    buffer_store_dword v243, v242, s[80:83], s64 offen sc0 sc1
    s_mov_b64 exec, -1
rl_148:
    s_branch lr_146_d
lr_146:
    s_mov_b64 exec, 1
pl_149:
    buffer_load_dword v240, v246, s[80:83], s37 offen sc1
    s_sub_u32 s79, s79, 1
    s_cbranch_scc1 L_abort
    s_waitcnt vmcnt(0)
    v_cmp_ne_u32 vcc, 1, v240
    s_cbranch_vccnz pl_149
    s_mov_b64 exec, -1
    s_cmp_lg_u32 s78, 0
    s_cbranch_scc1 pl_149_acq
pl_149_ok:
lr_146_d:
    s_add_u32 m0, s23, 0
    s_nop 0
    buffer_load_dwordx4 v249, s[80:83], s20 offen sc1 lds
    s_add_u32 m0, s23, 0
    s_nop 0
    buffer_load_dwordx4 v249, s[80:83], s20 offen offset:1024 sc1 lds
    s_add_u32 s20, s20, 8192
    s_cmp_eq_u32 s20, s22
    s_cselect_b32 s20, s21, s20
    s_add_u32 m0, s23, 8192
    s_nop 0
    buffer_load_dwordx4 v249, s[80:83], s20 offen sc1 lds
    s_add_u32 m0, s23, 8192
    s_nop 0
    buffer_load_dwordx4 v249, s[80:83], s20 offen offset:1024 sc1 lds
    s_add_u32 s20, s20, 8192
    s_cmp_eq_u32 s20, s22
    s_cselect_b32 s20, s21, s20
    s_add_u32 m0, s19, 86400
    s_nop 0
    buffer_load_dwordx4 v228, s[8:11], s16 offen lds
    s_add_u32 m0, s19, 87424
    s_nop 0
    buffer_load_dwordx4 v229, s[8:11], s16 offen lds
    s_add_u32 m0, s19, 88448
    s_nop 0
    buffer_load_dwordx4 v230, s[8:11], s16 offen lds
    s_add_u32 m0, s19, 89472
    s_nop 0
    buffer_load_dwordx4 v231, s[8:11], s16 offen lds
    s_waitcnt vmcnt(6)
    s_barrier
    ds_read_b128 v[144:147], v235 offset:0
    ds_read_b128 v[148:151], v235 offset:1024
    ds_read_b128 v[152:155], v235 offset:2048
    ds_read_b128 v[156:159], v235 offset:3072
    ds_read_b64_tr_b16 v[96:97], v236 offset:28800
    ds_read_b64_tr_b16 v[98:99], v236 offset:32384
    ds_read_b64_tr_b16 v[108:109], v236 offset:43200
    ds_read_b64_tr_b16 v[110:111], v236 offset:46784
    ds_read_b64_tr_b16 v[100:101], v236 offset:28832
    ds_read_b64_tr_b16 v[102:103], v236 offset:32416
    ds_read_b64_tr_b16 v[112:113], v236 offset:43232
    ds_read_b64_tr_b16 v[114:115], v236 offset:46816
    ds_read_b64_tr_b16 v[104:105], v238 offset:28800
    ds_read_b64_tr_b16 v[106:107], v238 offset:32384
    ds_read_b64_tr_b16 v[116:117], v238 offset:43200
    ds_read_b64_tr_b16 v[118:119], v238 offset:46784
    s_add_u32 m0, s19, 90496
    s_nop 0
    buffer_load_dwordx4 v232, s[8:11], s16 offen lds
    s_add_u32 m0, s19, 91520
    s_nop 0
    buffer_load_dwordx4 v233, s[8:11], s16 offen lds
    s_add_u32 m0, s19, 92544
    s_nop 0
    buffer_load_dwordx4 v234, s[8:11], s16 offen lds
    s_add_u32 s16, s16, 229376
    s_cmp_eq_u32 s16, s18
    s_cselect_b32 s16, s17, s16
    s_add_u32 m0, s23, 16384
    s_nop 0
    buffer_load_dwordx4 v249, s[80:83], s20 offen sc1 lds
    s_add_u32 m0, s23, 16384
    s_nop 0
    buffer_load_dwordx4 v249, s[80:83], s20 offen offset:1024 sc1 lds
    s_add_u32 s20, s20, 8192
    s_cmp_eq_u32 s20, s22
    s_cselect_b32 s20, s21, s20
    s_cmp_eq_u32 s27, 0
    s_cbranch_scc1 cs_150
cs_150_b:
    s_waitcnt vmcnt(9) lgkmcnt(0)
    s_barrier
    s_cmp_eq_u32 s27, 0
    s_cbranch_scc1 cs_651
cs_651_b:
    v_mfma_f32_16x16x32_bf16 v[0:3], v[96:99], v[144:147], 0
    ds_read_b128 v[160:163], v235 offset:8192
    ds_read_b128 v[164:167], v235 offset:9216
    v_mfma_f32_16x16x32_bf16 v[4:7], v[96:99], v[148:151], 0
    ds_read_b128 v[168:171], v235 offset:10240
    v_mfma_f32_16x16x32_bf16 v[8:11], v[96:99], v[152:155], 0
    ds_read_b128 v[172:175], v235 offset:11264
    v_mfma_f32_16x16x32_bf16 v[12:15], v[96:99], v[156:159], 0
    s_add_u32 m0, s19, 0
    s_nop 0
    buffer_load_dwordx4 v228, s[8:11], s16 offen lds
    v_mfma_f32_16x16x32_bf16 v[60:63], v[108:111], v[156:159], 0
    ds_read_b64_tr_b16 v[120:121], v237 offset:0
    v_mfma_f32_16x16x32_bf16 v[56:59], v[108:111], v[152:155], 0
    ds_read_b64_tr_b16 v[122:123], v237 offset:3584
    v_mfma_f32_16x16x32_bf16 v[52:55], v[108:111], v[148:151], 0
    ds_read_b64_tr_b16 v[132:133], v237 offset:14400
    v_mfma_f32_16x16x32_bf16 v[48:51], v[108:111], v[144:147], 0
    s_add_u32 m0, s19, 1024
    s_nop 0
    buffer_load_dwordx4 v229, s[8:11], s16 offen lds
    v_mfma_f32_16x16x32_bf16 v[16:19], v[100:103], v[144:147], 0
    ds_read_b64_tr_b16 v[134:135], v237 offset:17984
    v_mfma_f32_16x16x32_bf16 v[20:23], v[100:103], v[148:151], 0
    ds_read_b64_tr_b16 v[124:125], v237 offset:32
    v_mfma_f32_16x16x32_bf16 v[24:27], v[100:103], v[152:155], 0
    ds_read_b64_tr_b16 v[126:127], v237 offset:3616
    v_mfma_f32_16x16x32_bf16 v[28:31], v[100:103], v[156:159], 0
    s_add_u32 m0, s19, 2048
    s_nop 0
    buffer_load_dwordx4 v230, s[8:11], s16 offen lds
    s_add_u32 s16, s16, 229376
    s_cmp_eq_u32 s16, s18
    s_cselect_b32 s16, s17, s16
    v_mfma_f32_16x16x32_bf16 v[76:79], v[112:115], v[156:159], 0
    ds_read_b64_tr_b16 v[136:137], v237 offset:14432
    v_mfma_f32_16x16x32_bf16 v[72:75], v[112:115], v[152:155], 0
    ds_read_b64_tr_b16 v[138:139], v237 offset:18016
    v_mfma_f32_16x16x32_bf16 v[68:71], v[112:115], v[148:151], 0
    ds_read_b64_tr_b16 v[128:129], v239 offset:0
    v_mfma_f32_16x16x32_bf16 v[64:67], v[112:115], v[144:147], 0
    s_add_u32 m0, s23, 24576
    s_nop 0
    buffer_load_dwordx4 v249, s[80:83], s20 offen sc1 lds
    v_mfma_f32_16x16x32_bf16 v[32:35], v[104:107], v[144:147], 0
    ds_read_b64_tr_b16 v[130:131], v239 offset:3584
    v_mfma_f32_16x16x32_bf16 v[36:39], v[104:107], v[148:151], 0
    ds_read_b64_tr_b16 v[140:141], v239 offset:14400
    v_mfma_f32_16x16x32_bf16 v[40:43], v[104:107], v[152:155], 0
    ds_read_b64_tr_b16 v[142:143], v239 offset:17984
    v_mfma_f32_16x16x32_bf16 v[44:47], v[104:107], v[156:159], 0
    s_add_u32 m0, s23, 24576
    s_nop 0
    buffer_load_dwordx4 v249, s[80:83], s20 offen offset:1024 sc1 lds
    s_add_u32 s20, s20, 8192
    s_cmp_eq_u32 s20, s22
    s_cselect_b32 s20, s21, s20
    v_mfma_f32_16x16x32_bf16 v[92:95], v[116:119], v[156:159], 0
    v_mfma_f32_16x16x32_bf16 v[88:91], v[116:119], v[152:155], 0
    v_mfma_f32_16x16x32_bf16 v[84:87], v[116:119], v[148:151], 0
    v_mfma_f32_16x16x32_bf16 v[80:83], v[116:119], v[144:147], 0
    s_waitcnt vmcnt(5) lgkmcnt(0)
    s_barrier
    s_cmp_eq_u32 s27, 1
    s_cbranch_scc1 cs_652
cs_652_b:
    v_mfma_f32_16x16x32_bf16 v[0:3], v[120:123], v[160:163], v[0:3]
    ds_read_b128 v[144:147], v235 offset:16384
    ds_read_b128 v[148:151], v235 offset:17408
    v_mfma_f32_16x16x32_bf16 v[4:7], v[120:123], v[164:167], v[4:7]
    ds_read_b128 v[152:155], v235 offset:18432
    v_mfma_f32_16x16x32_bf16 v[8:11], v[120:123], v[168:171], v[8:11]
    ds_read_b128 v[156:159], v235 offset:19456
    v_mfma_f32_16x16x32_bf16 v[12:15], v[120:123], v[172:175], v[12:15]
    s_add_u32 m0, s19, 28800
    s_nop 0
    buffer_load_dwordx4 v228, s[8:11], s16 offen lds
    v_mfma_f32_16x16x32_bf16 v[60:63], v[132:135], v[172:175], v[60:63]
    ds_read_b64_tr_b16 v[96:97], v237 offset:28800
    v_mfma_f32_16x16x32_bf16 v[56:59], v[132:135], v[168:171], v[56:59]
    ds_read_b64_tr_b16 v[98:99], v237 offset:32384
    v_mfma_f32_16x16x32_bf16 v[52:55], v[132:135], v[164:167], v[52:55]
    ds_read_b64_tr_b16 v[108:109], v237 offset:43200
    v_mfma_f32_16x16x32_bf16 v[48:51], v[132:135], v[160:163], v[48:51]
    s_add_u32 m0, s19, 29824
    s_nop 0
    buffer_load_dwordx4 v229, s[8:11], s16 offen lds
    v_mfma_f32_16x16x32_bf16 v[16:19], v[124:127], v[160:163], v[16:19]
    ds_read_b64_tr_b16 v[110:111], v237 offset:46784
    v_mfma_f32_16x16x32_bf16 v[20:23], v[124:127], v[164:167], v[20:23]
    ds_read_b64_tr_b16 v[100:101], v237 offset:28832
    v_mfma_f32_16x16x32_bf16 v[24:27], v[124:127], v[168:171], v[24:27]
    ds_read_b64_tr_b16 v[102:103], v237 offset:32416
    v_mfma_f32_16x16x32_bf16 v[28:31], v[124:127], v[172:175], v[28:31]
    s_add_u32 m0, s19, 30848
    s_nop 0
    buffer_load_dwordx4 v230, s[8:11], s16 offen lds
    s_add_u32 s16, s16, 229376
    s_cmp_eq_u32 s16, s18
    s_cselect_b32 s16, s17, s16
    v_mfma_f32_16x16x32_bf16 v[76:79], v[136:139], v[172:175], v[76:79]
    ds_read_b64_tr_b16 v[112:113], v237 offset:43232
    v_mfma_f32_16x16x32_bf16 v[72:75], v[136:139], v[168:171], v[72:75]
    ds_read_b64_tr_b16 v[114:115], v237 offset:46816
    v_mfma_f32_16x16x32_bf16 v[68:71], v[136:139], v[164:167], v[68:71]
    ds_read_b64_tr_b16 v[104:105], v239 offset:28800
    v_mfma_f32_16x16x32_bf16 v[64:67], v[136:139], v[160:163], v[64:67]
    s_add_u32 m0, s23, 0
    s_nop 0
    buffer_load_dwordx4 v249, s[80:83], s20 offen sc1 lds
    v_mfma_f32_16x16x32_bf16 v[32:35], v[128:131], v[160:163], v[32:35]
    ds_read_b64_tr_b16 v[106:107], v239 offset:32384
    v_mfma_f32_16x16x32_bf16 v[36:39], v[128:131], v[164:167], v[36:39]
    ds_read_b64_tr_b16 v[116:117], v239 offset:43200
    v_mfma_f32_16x16x32_bf16 v[40:43], v[128:131], v[168:171], v[40:43]
    ds_read_b64_tr_b16 v[118:119], v239 offset:46784
    v_mfma_f32_16x16x32_bf16 v[44:47], v[128:131], v[172:175], v[44:47]
    s_add_u32 m0, s23, 0
    s_nop 0
    buffer_load_dwordx4 v249, s[80:83], s20 offen offset:1024 sc1 lds
    s_add_u32 s20, s20, 8192
    s_cmp_eq_u32 s20, s22
    s_cselect_b32 s20, s21, s20
    v_mfma_f32_16x16x32_bf16 v[92:95], v[140:143], v[172:175], v[92:95]
    v_mfma_f32_16x16x32_bf16 v[88:91], v[140:143], v[168:171], v[88:91]
    v_mfma_f32_16x16x32_bf16 v[84:87], v[140:143], v[164:167], v[84:87]
    v_mfma_f32_16x16x32_bf16 v[80:83], v[140:143], v[160:163], v[80:83]
    s_waitcnt vmcnt(5) lgkmcnt(0)
    s_barrier
    s_cmp_eq_u32 s27, 1
    s_cbranch_scc1 cs_653
cs_653_b:
    v_mfma_f32_16x16x32_bf16 v[0:3], v[96:99], v[144:147], v[0:3]
    ds_read_b128 v[160:163], v235 offset:24576
    ds_read_b128 v[164:167], v235 offset:25600
    v_mfma_f32_16x16x32_bf16 v[4:7], v[96:99], v[148:151], v[4:7]
    ds_read_b128 v[168:171], v235 offset:26624
    v_mfma_f32_16x16x32_bf16 v[8:11], v[96:99], v[152:155], v[8:11]
    ds_read_b128 v[172:175], v235 offset:27648
    v_mfma_f32_16x16x32_bf16 v[12:15], v[96:99], v[156:159], v[12:15]
    s_add_u32 m0, s19, 57600
    s_nop 0
    buffer_load_dwordx4 v228, s[8:11], s16 offen lds
    v_mfma_f32_16x16x32_bf16 v[60:63], v[108:111], v[156:159], v[60:63]
    ds_read_b64_tr_b16 v[120:121], v236 offset:0
    v_mfma_f32_16x16x32_bf16 v[56:59], v[108:111], v[152:155], v[56:59]
    ds_read_b64_tr_b16 v[122:123], v236 offset:3584
    v_mfma_f32_16x16x32_bf16 v[52:55], v[108:111], v[148:151], v[52:55]
    ds_read_b64_tr_b16 v[132:133], v236 offset:14400
    v_mfma_f32_16x16x32_bf16 v[48:51], v[108:111], v[144:147], v[48:51]
    s_add_u32 m0, s19, 58624
    s_nop 0
    buffer_load_dwordx4 v229, s[8:11], s16 offen lds
    v_mfma_f32_16x16x32_bf16 v[16:19], v[100:103], v[144:147], v[16:19]
    ds_read_b64_tr_b16 v[134:135], v236 offset:17984
    v_mfma_f32_16x16x32_bf16 v[20:23], v[100:103], v[148:151], v[20:23]
    ds_read_b64_tr_b16 v[124:125], v236 offset:32
    v_mfma_f32_16x16x32_bf16 v[24:27], v[100:103], v[152:155], v[24:27]
    ds_read_b64_tr_b16 v[126:127], v236 offset:3616
    v_mfma_f32_16x16x32_bf16 v[28:31], v[100:103], v[156:159], v[28:31]
    s_add_u32 m0, s19, 59648
    s_nop 0
    buffer_load_dwordx4 v230, s[8:11], s16 offen lds
    s_add_u32 s16, s16, 229376
    s_cmp_eq_u32 s16, s18
    s_cselect_b32 s16, s17, s16
    v_mfma_f32_16x16x32_bf16 v[76:79], v[112:115], v[156:159], v[76:79]
    ds_read_b64_tr_b16 v[136:137], v236 offset:14432
    v_mfma_f32_16x16x32_bf16 v[72:75], v[112:115], v[152:155], v[72:75]
    ds_read_b64_tr_b16 v[138:139], v236 offset:18016
    v_mfma_f32_16x16x32_bf16 v[68:71], v[112:115], v[148:151], v[68:71]
    ds_read_b64_tr_b16 v[128:129], v238 offset:0
    v_mfma_f32_16x16x32_bf16 v[64:67], v[112:115], v[144:147], v[64:67]
    s_add_u32 m0, s23, 8192
    s_nop 0
    buffer_load_dwordx4 v249, s[80:83], s20 offen sc1 lds
    v_mfma_f32_16x16x32_bf16 v[32:35], v[104:107], v[144:147], v[32:35]
    ds_read_b64_tr_b16 v[130:131], v238 offset:3584
    v_mfma_f32_16x16x32_bf16 v[36:39], v[104:107], v[148:151], v[36:39]
    ds_read_b64_tr_b16 v[140:141], v238 offset:14400
    v_mfma_f32_16x16x32_bf16 v[40:43], v[104:107], v[152:155], v[40:43]
    ds_read_b64_tr_b16 v[142:143], v238 offset:17984
    v_mfma_f32_16x16x32_bf16 v[44:47], v[104:107], v[156:159], v[44:47]
    s_add_u32 m0, s23, 8192
    s_nop 0
    buffer_load_dwordx4 v249, s[80:83], s20 offen offset:1024 sc1 lds
    s_add_u32 s20, s20, 8192
    s_cmp_eq_u32 s20, s22
    s_cselect_b32 s20, s21, s20
    v_mfma_f32_16x16x32_bf16 v[92:95], v[116:119], v[156:159], v[92:95]
    v_mfma_f32_16x16x32_bf16 v[88:91], v[116:119], v[152:155], v[88:91]
    v_mfma_f32_16x16x32_bf16 v[84:87], v[116:119], v[148:151], v[84:87]
    v_mfma_f32_16x16x32_bf16 v[80:83], v[116:119], v[144:147], v[80:83]
    s_waitcnt vmcnt(5) lgkmcnt(0)
    s_barrier
    s_cmp_eq_u32 s27, 2
    s_cbranch_scc1 cs_654
cs_654_b:
    v_mfma_f32_16x16x32_bf16 v[0:3], v[120:123], v[160:163], v[0:3]
    ds_read_b128 v[144:147], v235 offset:0
    ds_read_b128 v[148:151], v235 offset:1024
    v_mfma_f32_16x16x32_bf16 v[4:7], v[120:123], v[164:167], v[4:7]
    ds_read_b128 v[152:155], v235 offset:2048
    v_mfma_f32_16x16x32_bf16 v[8:11], v[120:123], v[168:171], v[8:11]
    ds_read_b128 v[156:159], v235 offset:3072
    v_mfma_f32_16x16x32_bf16 v[12:15], v[120:123], v[172:175], v[12:15]
    s_add_u32 m0, s19, 86400
    s_nop 0
    buffer_load_dwordx4 v228, s[8:11], s16 offen lds
    v_mfma_f32_16x16x32_bf16 v[60:63], v[132:135], v[172:175], v[60:63]
    ds_read_b64_tr_b16 v[96:97], v236 offset:28800
    v_mfma_f32_16x16x32_bf16 v[56:59], v[132:135], v[168:171], v[56:59]
    ds_read_b64_tr_b16 v[98:99], v236 offset:32384
    v_mfma_f32_16x16x32_bf16 v[52:55], v[132:135], v[164:167], v[52:55]
    ds_read_b64_tr_b16 v[108:109], v236 offset:43200
    v_mfma_f32_16x16x32_bf16 v[48:51], v[132:135], v[160:163], v[48:51]
    s_add_u32 m0, s19, 87424
    s_nop 0
    buffer_load_dwordx4 v229, s[8:11], s16 offen lds
    v_mfma_f32_16x16x32_bf16 v[16:19], v[124:127], v[160:163], v[16:19]
    ds_read_b64_tr_b16 v[110:111], v236 offset:46784
    v_mfma_f32_16x16x32_bf16 v[20:23], v[124:127], v[164:167], v[20:23]
    ds_read_b64_tr_b16 v[100:101], v236 offset:28832
    v_mfma_f32_16x16x32_bf16 v[24:27], v[124:127], v[168:171], v[24:27]
    ds_read_b64_tr_b16 v[102:103], v236 offset:32416
    v_mfma_f32_16x16x32_bf16 v[28:31], v[124:127], v[172:175], v[28:31]
    s_add_u32 m0, s19, 88448
    s_nop 0
    buffer_load_dwordx4 v230, s[8:11], s16 offen lds
    s_add_u32 s16, s16, 229376
    s_cmp_eq_u32 s16, s18
    s_cselect_b32 s16, s17, s16
    v_mfma_f32_16x16x32_bf16 v[76:79], v[136:139], v[172:175], v[76:79]
    ds_read_b64_tr_b16 v[112:113], v236 offset:43232
    v_mfma_f32_16x16x32_bf16 v[72:75], v[136:139], v[168:171], v[72:75]
    ds_read_b64_tr_b16 v[114:115], v236 offset:46816
    v_mfma_f32_16x16x32_bf16 v[68:71], v[136:139], v[164:167], v[68:71]
    ds_read_b64_tr_b16 v[104:105], v238 offset:28800
    v_mfma_f32_16x16x32_bf16 v[64:67], v[136:139], v[160:163], v[64:67]
    s_add_u32 m0, s23, 16384
    s_nop 0
    buffer_load_dwordx4 v249, s[80:83], s20 offen sc1 lds
    v_mfma_f32_16x16x32_bf16 v[32:35], v[128:131], v[160:163], v[32:35]
    ds_read_b64_tr_b16 v[106:107], v238 offset:32384
    v_mfma_f32_16x16x32_bf16 v[36:39], v[128:131], v[164:167], v[36:39]
    ds_read_b64_tr_b16 v[116:117], v238 offset:43200
    v_mfma_f32_16x16x32_bf16 v[40:43], v[128:131], v[168:171], v[40:43]
    ds_read_b64_tr_b16 v[118:119], v238 offset:46784
    v_mfma_f32_16x16x32_bf16 v[44:47], v[128:131], v[172:175], v[44:47]
    s_add_u32 m0, s23, 16384
    s_nop 0
    buffer_load_dwordx4 v249, s[80:83], s20 offen offset:1024 sc1 lds
    s_add_u32 s20, s20, 8192
    s_cmp_eq_u32 s20, s22
    s_cselect_b32 s20, s21, s20
    v_mfma_f32_16x16x32_bf16 v[92:95], v[140:143], v[172:175], v[92:95]
    v_mfma_f32_16x16x32_bf16 v[88:91], v[140:143], v[168:171], v[88:91]
    v_mfma_f32_16x16x32_bf16 v[84:87], v[140:143], v[164:167], v[84:87]
    v_mfma_f32_16x16x32_bf16 v[80:83], v[140:143], v[160:163], v[80:83]
    s_waitcnt vmcnt(5) lgkmcnt(0)
    s_barrier
    s_cmp_eq_u32 s27, 2
    s_cbranch_scc1 cs_655
cs_655_b:
    v_mfma_f32_16x16x32_bf16 v[0:3], v[96:99], v[144:147], v[0:3]
    ds_read_b128 v[160:163], v235 offset:8192
    ds_read_b128 v[164:167], v235 offset:9216
    v_mfma_f32_16x16x32_bf16 v[4:7], v[96:99], v[148:151], v[4:7]
    ds_read_b128 v[168:171], v235 offset:10240
    v_mfma_f32_16x16x32_bf16 v[8:11], v[96:99], v[152:155], v[8:11]
    ds_read_b128 v[172:175], v235 offset:11264
    v_mfma_f32_16x16x32_bf16 v[12:15], v[96:99], v[156:159], v[12:15]
    s_add_u32 m0, s19, 0
    s_nop 0
    buffer_load_dwordx4 v228, s[8:11], s16 offen lds
    v_mfma_f32_16x16x32_bf16 v[60:63], v[108:111], v[156:159], v[60:63]
    ds_read_b64_tr_b16 v[120:121], v237 offset:0
    v_mfma_f32_16x16x32_bf16 v[56:59], v[108:111], v[152:155], v[56:59]
    ds_read_b64_tr_b16 v[122:123], v237 offset:3584
    v_mfma_f32_16x16x32_bf16 v[52:55], v[108:111], v[148:151], v[52:55]
    ds_read_b64_tr_b16 v[132:133], v237 offset:14400
    v_mfma_f32_16x16x32_bf16 v[48:51], v[108:111], v[144:147], v[48:51]
    s_add_u32 m0, s19, 1024
    s_nop 0
    buffer_load_dwordx4 v229, s[8:11], s16 offen lds
    v_mfma_f32_16x16x32_bf16 v[16:19], v[100:103], v[144:147], v[16:19]
    ds_read_b64_tr_b16 v[134:135], v237 offset:17984
    v_mfma_f32_16x16x32_bf16 v[20:23], v[100:103], v[148:151], v[20:23]
    ds_read_b64_tr_b16 v[124:125], v237 offset:32
    v_mfma_f32_16x16x32_bf16 v[24:27], v[100:103], v[152:155], v[24:27]
    ds_read_b64_tr_b16 v[126:127], v237 offset:3616
    v_mfma_f32_16x16x32_bf16 v[28:31], v[100:103], v[156:159], v[28:31]
    s_add_u32 m0, s19, 2048
    s_nop 0
    buffer_load_dwordx4 v230, s[8:11], s16 offen lds
    s_add_u32 s16, s16, 229376
    s_cmp_eq_u32 s16, s18
    s_cselect_b32 s16, s17, s16
    v_mfma_f32_16x16x32_bf16 v[76:79], v[112:115], v[156:159], v[76:79]
    ds_read_b64_tr_b16 v[136:137], v237 offset:14432
    v_mfma_f32_16x16x32_bf16 v[72:75], v[112:115], v[152:155], v[72:75]
    ds_read_b64_tr_b16 v[138:139], v237 offset:18016
    v_mfma_f32_16x16x32_bf16 v[68:71], v[112:115], v[148:151], v[68:71]
    ds_read_b64_tr_b16 v[128:129], v239 offset:0
    v_mfma_f32_16x16x32_bf16 v[64:67], v[112:115], v[144:147], v[64:67]
    s_add_u32 m0, s23, 24576
    s_nop 0
    buffer_load_dwordx4 v249, s[80:83], s20 offen sc1 lds
    v_mfma_f32_16x16x32_bf16 v[32:35], v[104:107], v[144:147], v[32:35]
    ds_read_b64_tr_b16 v[130:131], v239 offset:3584
    v_mfma_f32_16x16x32_bf16 v[36:39], v[104:107], v[148:151], v[36:39]
    ds_read_b64_tr_b16 v[140:141], v239 offset:14400
    v_mfma_f32_16x16x32_bf16 v[40:43], v[104:107], v[152:155], v[40:43]
    ds_read_b64_tr_b16 v[142:143], v239 offset:17984
    v_mfma_f32_16x16x32_bf16 v[44:47], v[104:107], v[156:159], v[44:47]
    s_add_u32 m0, s23, 24576
    s_nop 0
    buffer_load_dwordx4 v249, s[80:83], s20 offen offset:1024 sc1 lds
    s_add_u32 s20, s20, 8192
    s_cmp_eq_u32 s20, s22
    s_cselect_b32 s20, s21, s20
    v_mfma_f32_16x16x32_bf16 v[92:95], v[116:119], v[156:159], v[92:95]
    v_mfma_f32_16x16x32_bf16 v[88:91], v[116:119], v[152:155], v[88:91]
    v_mfma_f32_16x16x32_bf16 v[84:87], v[116:119], v[148:151], v[84:87]
    v_mfma_f32_16x16x32_bf16 v[80:83], v[116:119], v[144:147], v[80:83]
    s_waitcnt vmcnt(5) lgkmcnt(0)
    s_barrier
    s_cmp_eq_u32 s27, 3
    s_cbranch_scc1 cs_656
cs_656_b:
    v_mfma_f32_16x16x32_bf16 v[0:3], v[120:123], v[160:163], v[0:3]
    ds_read_b128 v[144:147], v235 offset:16384
    ds_read_b128 v[148:151], v235 offset:17408
    v_mfma_f32_16x16x32_bf16 v[4:7], v[120:123], v[164:167], v[4:7]
    ds_read_b128 v[152:155], v235 offset:18432
    v_mfma_f32_16x16x32_bf16 v[8:11], v[120:123], v[168:171], v[8:11]
    ds_read_b128 v[156:159], v235 offset:19456
    v_mfma_f32_16x16x32_bf16 v[12:15], v[120:123], v[172:175], v[12:15]
    s_add_u32 m0, s19, 28800
    s_nop 0
    buffer_load_dwordx4 v228, s[8:11], s16 offen lds
    v_mfma_f32_16x16x32_bf16 v[60:63], v[132:135], v[172:175], v[60:63]
    ds_read_b64_tr_b16 v[96:97], v237 offset:28800
    v_mfma_f32_16x16x32_bf16 v[56:59], v[132:135], v[168:171], v[56:59]
    ds_read_b64_tr_b16 v[98:99], v237 offset:32384
    v_mfma_f32_16x16x32_bf16 v[52:55], v[132:135], v[164:167], v[52:55]
    ds_read_b64_tr_b16 v[108:109], v237 offset:43200
    v_mfma_f32_16x16x32_bf16 v[48:51], v[132:135], v[160:163], v[48:51]
    s_add_u32 m0, s19, 29824
    s_nop 0
    buffer_load_dwordx4 v229, s[8:11], s16 offen lds
    v_mfma_f32_16x16x32_bf16 v[16:19], v[124:127], v[160:163], v[16:19]
    ds_read_b64_tr_b16 v[110:111], v237 offset:46784
    v_mfma_f32_16x16x32_bf16 v[20:23], v[124:127], v[164:167], v[20:23]
    ds_read_b64_tr_b16 v[100:101], v237 offset:28832
    v_mfma_f32_16x16x32_bf16 v[24:27], v[124:127], v[168:171], v[24:27]
    ds_read_b64_tr_b16 v[102:103], v237 offset:32416
    v_mfma_f32_16x16x32_bf16 v[28:31], v[124:127], v[172:175], v[28:31]
    s_add_u32 m0, s19, 30848
    s_nop 0
    buffer_load_dwordx4 v230, s[8:11], s16 offen lds
    s_add_u32 s16, s16, 229376
    s_cmp_eq_u32 s16, s18
    s_cselect_b32 s16, s17, s16
    v_mfma_f32_16x16x32_bf16 v[76:79], v[136:139], v[172:175], v[76:79]
    ds_read_b64_tr_b16 v[112:113], v237 offset:43232
    v_mfma_f32_16x16x32_bf16 v[72:75], v[136:139], v[168:171], v[72:75]
    ds_read_b64_tr_b16 v[114:115], v237 offset:46816
    v_mfma_f32_16x16x32_bf16 v[68:71], v[136:139], v[164:167], v[68:71]
    ds_read_b64_tr_b16 v[104:105], v239 offset:28800
    v_mfma_f32_16x16x32_bf16 v[64:67], v[136:139], v[160:163], v[64:67]
    s_add_u32 m0, s23, 0
    s_nop 0
    buffer_load_dwordx4 v249, s[80:83], s20 offen sc1 lds
    v_mfma_f32_16x16x32_bf16 v[32:35], v[128:131], v[160:163], v[32:35]
    ds_read_b64_tr_b16 v[106:107], v239 offset:32384
    v_mfma_f32_16x16x32_bf16 v[36:39], v[128:131], v[164:167], v[36:39]
    ds_read_b64_tr_b16 v[116:117], v239 offset:43200
    v_mfma_f32_16x16x32_bf16 v[40:43], v[128:131], v[168:171], v[40:43]
    ds_read_b64_tr_b16 v[118:119], v239 offset:46784
    v_mfma_f32_16x16x32_bf16 v[44:47], v[128:131], v[172:175], v[44:47]
    s_add_u32 m0, s23, 0
    s_nop 0
    buffer_load_dwordx4 v249, s[80:83], s20 offen offset:1024 sc1 lds
    s_add_u32 s20, s20, 8192
    s_cmp_eq_u32 s20, s22
    s_cselect_b32 s20, s21, s20
    v_mfma_f32_16x16x32_bf16 v[92:95], v[140:143], v[172:175], v[92:95]
    v_mfma_f32_16x16x32_bf16 v[88:91], v[140:143], v[168:171], v[88:91]
    v_mfma_f32_16x16x32_bf16 v[84:87], v[140:143], v[164:167], v[84:87]
    v_mfma_f32_16x16x32_bf16 v[80:83], v[140:143], v[160:163], v[80:83]
    s_waitcnt vmcnt(5) lgkmcnt(0)
    s_barrier
    s_cmp_eq_u32 s27, 3
    s_cbranch_scc1 cs_657
cs_657_b:
    v_mfma_f32_16x16x32_bf16 v[0:3], v[96:99], v[144:147], v[0:3]
    ds_read_b128 v[160:163], v235 offset:24576
    ds_read_b128 v[164:167], v235 offset:25600
    v_mfma_f32_16x16x32_bf16 v[4:7], v[96:99], v[148:151], v[4:7]
    ds_read_b128 v[168:171], v235 offset:26624
    v_mfma_f32_16x16x32_bf16 v[8:11], v[96:99], v[152:155], v[8:11]
    ds_read_b128 v[172:175], v235 offset:27648
    v_mfma_f32_16x16x32_bf16 v[12:15], v[96:99], v[156:159], v[12:15]
    s_add_u32 m0, s19, 57600
    s_nop 0
    buffer_load_dwordx4 v228, s[8:11], s16 offen lds
    v_mfma_f32_16x16x32_bf16 v[60:63], v[108:111], v[156:159], v[60:63]
    ds_read_b64_tr_b16 v[120:121], v236 offset:0
    v_mfma_f32_16x16x32_bf16 v[56:59], v[108:111], v[152:155], v[56:59]
    ds_read_b64_tr_b16 v[122:123], v236 offset:3584
    v_mfma_f32_16x16x32_bf16 v[52:55], v[108:111], v[148:151], v[52:55]
    ds_read_b64_tr_b16 v[132:133], v236 offset:14400
    v_mfma_f32_16x16x32_bf16 v[48:51], v[108:111], v[144:147], v[48:51]
    s_add_u32 m0, s19, 58624
    s_nop 0
    buffer_load_dwordx4 v229, s[8:11], s16 offen lds
    v_mfma_f32_16x16x32_bf16 v[16:19], v[100:103], v[144:147], v[16:19]
    ds_read_b64_tr_b16 v[134:135], v236 offset:17984
    v_mfma_f32_16x16x32_bf16 v[20:23], v[100:103], v[148:151], v[20:23]
    ds_read_b64_tr_b16 v[124:125], v236 offset:32
    v_mfma_f32_16x16x32_bf16 v[24:27], v[100:103], v[152:155], v[24:27]
    ds_read_b64_tr_b16 v[126:127], v236 offset:3616
    v_mfma_f32_16x16x32_bf16 v[28:31], v[100:103], v[156:159], v[28:31]
    s_add_u32 m0, s19, 59648
    s_nop 0
    buffer_load_dwordx4 v230, s[8:11], s16 offen lds
    s_add_u32 s16, s16, 229376
    s_cmp_eq_u32 s16, s18
    s_cselect_b32 s16, s17, s16
    v_mfma_f32_16x16x32_bf16 v[76:79], v[112:115], v[156:159], v[76:79]
    ds_read_b64_tr_b16 v[136:137], v236 offset:14432
    v_mfma_f32_16x16x32_bf16 v[72:75], v[112:115], v[152:155], v[72:75]
    ds_read_b64_tr_b16 v[138:139], v236 offset:18016
    v_mfma_f32_16x16x32_bf16 v[68:71], v[112:115], v[148:151], v[68:71]
    ds_read_b64_tr_b16 v[128:129], v238 offset:0
    v_mfma_f32_16x16x32_bf16 v[64:67], v[112:115], v[144:147], v[64:67]
    s_add_u32 m0, s23, 8192
    s_nop 0
    buffer_load_dwordx4 v249, s[80:83], s20 offen sc1 lds
    v_mfma_f32_16x16x32_bf16 v[32:35], v[104:107], v[144:147], v[32:35]
    ds_read_b64_tr_b16 v[130:131], v238 offset:3584
    v_mfma_f32_16x16x32_bf16 v[36:39], v[104:107], v[148:151], v[36:39]
    ds_read_b64_tr_b16 v[140:141], v238 offset:14400
    v_mfma_f32_16x16x32_bf16 v[40:43], v[104:107], v[152:155], v[40:43]
    ds_read_b64_tr_b16 v[142:143], v238 offset:17984
    v_mfma_f32_16x16x32_bf16 v[44:47], v[104:107], v[156:159], v[44:47]
    s_add_u32 m0, s23, 8192
    s_nop 0
    buffer_load_dwordx4 v249, s[80:83], s20 offen offset:1024 sc1 lds
    s_add_u32 s20, s20, 8192
    s_cmp_eq_u32 s20, s22
    s_cselect_b32 s20, s21, s20
    v_mfma_f32_16x16x32_bf16 v[92:95], v[116:119], v[156:159], v[92:95]
    v_mfma_f32_16x16x32_bf16 v[88:91], v[116:119], v[152:155], v[88:91]
    v_mfma_f32_16x16x32_bf16 v[84:87], v[116:119], v[148:151], v[84:87]
    v_mfma_f32_16x16x32_bf16 v[80:83], v[116:119], v[144:147], v[80:83]
    s_waitcnt vmcnt(5) lgkmcnt(0)
    s_barrier
    v_mfma_f32_16x16x32_bf16 v[0:3], v[120:123], v[160:163], v[0:3]
    ds_read_b128 v[144:147], v235 offset:0
    ds_read_b128 v[148:151], v235 offset:1024
    v_mfma_f32_16x16x32_bf16 v[4:7], v[120:123], v[164:167], v[4:7]
    ds_read_b128 v[152:155], v235 offset:2048
    v_mfma_f32_16x16x32_bf16 v[8:11], v[120:123], v[168:171], v[8:11]
    ds_read_b128 v[156:159], v235 offset:3072
    v_mfma_f32_16x16x32_bf16 v[12:15], v[120:123], v[172:175], v[12:15]
    s_add_u32 m0, s19, 86400
    s_nop 0
    buffer_load_dwordx4 v228, s[8:11], s16 offen lds
    v_mfma_f32_16x16x32_bf16 v[60:63], v[132:135], v[172:175], v[60:63]
    ds_read_b64_tr_b16 v[96:97], v236 offset:28800
    v_mfma_f32_16x16x32_bf16 v[56:59], v[132:135], v[168:171], v[56:59]
    ds_read_b64_tr_b16 v[98:99], v236 offset:32384
    v_mfma_f32_16x16x32_bf16 v[52:55], v[132:135], v[164:167], v[52:55]
    ds_read_b64_tr_b16 v[108:109], v236 offset:43200
    s_lshl_b32 s26, s32, 15
    s_lshl_b32 s65, s75, 20
    s_add_u32 s26, s26, s65
    s_lshl_b32 s65, s33, 8
    s_add_u32 s26, s26, s65
    s_add_u32 s26, s26, 71303168
    v_lshlrev_b32 v225, 4, v252
    v_lshl_add_u32 v225, v251, 13, v225
    v_mfma_f32_16x16x32_bf16 v[48:51], v[132:135], v[160:163], v[48:51]
    s_add_u32 m0, s19, 87424
    s_nop 0
    buffer_load_dwordx4 v229, s[8:11], s16 offen lds
    v_mfma_f32_16x16x32_bf16 v[16:19], v[124:127], v[160:163], v[16:19]
    ds_read_b64_tr_b16 v[110:111], v236 offset:46784
    v_mfma_f32_16x16x32_bf16 v[20:23], v[124:127], v[164:167], v[20:23]
    ds_read_b64_tr_b16 v[100:101], v236 offset:28832
    v_mfma_f32_16x16x32_bf16 v[24:27], v[124:127], v[168:171], v[24:27]
    ds_read_b64_tr_b16 v[102:103], v236 offset:32416
    v_mfma_f32_16x16x32_bf16 v[28:31], v[124:127], v[172:175], v[28:31]
    s_add_u32 m0, s19, 88448
    s_nop 0
    buffer_load_dwordx4 v230, s[8:11], s16 offen lds
    s_add_u32 s16, s16, 229376
    s_cmp_eq_u32 s16, s18
    s_cselect_b32 s16, s17, s16
    v_mfma_f32_16x16x32_bf16 v[76:79], v[136:139], v[172:175], v[76:79]
    ds_read_b64_tr_b16 v[112:113], v236 offset:43232
    v_mfma_f32_16x16x32_bf16 v[72:75], v[136:139], v[168:171], v[72:75]
    ds_read_b64_tr_b16 v[114:115], v236 offset:46816
    v_mfma_f32_16x16x32_bf16 v[68:71], v[136:139], v[164:167], v[68:71]
    ds_read_b64_tr_b16 v[104:105], v238 offset:28800
    v_mfma_f32_16x16x32_bf16 v[64:67], v[136:139], v[160:163], v[64:67]
    s_add_u32 m0, s23, 16384
    s_nop 0
    buffer_load_dwordx4 v249, s[80:83], s20 offen sc1 lds
    v_mfma_f32_16x16x32_bf16 v[32:35], v[128:131], v[160:163], v[32:35]
    ds_read_b64_tr_b16 v[106:107], v238 offset:32384
    v_mfma_f32_16x16x32_bf16 v[36:39], v[128:131], v[164:167], v[36:39]
    ds_read_b64_tr_b16 v[116:117], v238 offset:43200
    v_mfma_f32_16x16x32_bf16 v[40:43], v[128:131], v[168:171], v[40:43]
    ds_read_b64_tr_b16 v[118:119], v238 offset:46784
    v_mfma_f32_16x16x32_bf16 v[44:47], v[128:131], v[172:175], v[44:47]
    s_add_u32 m0, s23, 16384
    s_nop 0
    buffer_load_dwordx4 v249, s[80:83], s20 offen offset:1024 sc1 lds
    s_add_u32 s20, s20, 8192
    s_cmp_eq_u32 s20, s22
    s_cselect_b32 s20, s21, s20
    v_mfma_f32_16x16x32_bf16 v[92:95], v[140:143], v[172:175], v[92:95]
    buffer_load_dwordx4 v[176:179], v225, s[80:83], s26 offen offset:0 sc1
    v_mfma_f32_16x16x32_bf16 v[88:91], v[140:143], v[168:171], v[88:91]
    buffer_load_dwordx4 v[180:183], v225, s[80:83], s26 offen offset:1024 sc1
    v_mfma_f32_16x16x32_bf16 v[84:87], v[140:143], v[164:167], v[84:87]
    buffer_load_dwordx4 v[184:187], v225, s[80:83], s26 offen offset:2048 sc1
    v_mfma_f32_16x16x32_bf16 v[80:83], v[140:143], v[160:163], v[80:83]
    buffer_load_dwordx4 v[188:191], v225, s[80:83], s26 offen offset:3072 sc1
    s_add_u32 s26, s26, 4096
    s_waitcnt vmcnt(9) lgkmcnt(0)
    s_barrier
    v_mfma_f32_16x16x32_bf16 v[0:3], v[96:99], v[144:147], v[0:3]
    ds_read_b128 v[160:163], v235 offset:8192
    ds_read_b128 v[164:167], v235 offset:9216
    v_mfma_f32_16x16x32_bf16 v[4:7], v[96:99], v[148:151], v[4:7]
    ds_read_b128 v[168:171], v235 offset:10240
    v_mfma_f32_16x16x32_bf16 v[8:11], v[96:99], v[152:155], v[8:11]
    ds_read_b128 v[172:175], v235 offset:11264
    v_mfma_f32_16x16x32_bf16 v[12:15], v[96:99], v[156:159], v[12:15]
    s_add_u32 m0, s19, 0
    s_nop 0
    buffer_load_dwordx4 v228, s[8:11], s16 offen lds
    v_mfma_f32_16x16x32_bf16 v[60:63], v[108:111], v[156:159], v[60:63]
    ds_read_b64_tr_b16 v[120:121], v237 offset:0
    v_mfma_f32_16x16x32_bf16 v[56:59], v[108:111], v[152:155], v[56:59]
    ds_read_b64_tr_b16 v[122:123], v237 offset:3584
    v_mfma_f32_16x16x32_bf16 v[52:55], v[108:111], v[148:151], v[52:55]
    ds_read_b64_tr_b16 v[132:133], v237 offset:14400
    v_mfma_f32_16x16x32_bf16 v[48:51], v[108:111], v[144:147], v[48:51]
    s_add_u32 m0, s19, 1024
    s_nop 0
    buffer_load_dwordx4 v229, s[8:11], s16 offen lds
    v_mfma_f32_16x16x32_bf16 v[16:19], v[100:103], v[144:147], v[16:19]
    ds_read_b64_tr_b16 v[134:135], v237 offset:17984
    v_mfma_f32_16x16x32_bf16 v[20:23], v[100:103], v[148:151], v[20:23]
    ds_read_b64_tr_b16 v[124:125], v237 offset:32
    v_mfma_f32_16x16x32_bf16 v[24:27], v[100:103], v[152:155], v[24:27]
    ds_read_b64_tr_b16 v[126:127], v237 offset:3616
    v_mfma_f32_16x16x32_bf16 v[28:31], v[100:103], v[156:159], v[28:31]
    s_add_u32 m0, s19, 2048
    s_nop 0
    buffer_load_dwordx4 v230, s[8:11], s16 offen lds
    s_add_u32 s16, s16, 229376
    s_cmp_eq_u32 s16, s18
    s_cselect_b32 s16, s17, s16
    v_mfma_f32_16x16x32_bf16 v[76:79], v[112:115], v[156:159], v[76:79]
    ds_read_b64_tr_b16 v[136:137], v237 offset:14432
    v_mfma_f32_16x16x32_bf16 v[72:75], v[112:115], v[152:155], v[72:75]
    ds_read_b64_tr_b16 v[138:139], v237 offset:18016
    v_mfma_f32_16x16x32_bf16 v[68:71], v[112:115], v[148:151], v[68:71]
    ds_read_b64_tr_b16 v[128:129], v239 offset:0
    v_mfma_f32_16x16x32_bf16 v[64:67], v[112:115], v[144:147], v[64:67]
    s_add_u32 m0, s23, 24576
    s_nop 0
    buffer_load_dwordx4 v249, s[80:83], s20 offen sc1 lds
    v_mfma_f32_16x16x32_bf16 v[32:35], v[104:107], v[144:147], v[32:35]
    ds_read_b64_tr_b16 v[130:131], v239 offset:3584
    v_mfma_f32_16x16x32_bf16 v[36:39], v[104:107], v[148:151], v[36:39]
    ds_read_b64_tr_b16 v[140:141], v239 offset:14400
    v_mfma_f32_16x16x32_bf16 v[40:43], v[104:107], v[152:155], v[40:43]
    ds_read_b64_tr_b16 v[142:143], v239 offset:17984
    v_mfma_f32_16x16x32_bf16 v[44:47], v[104:107], v[156:159], v[44:47]
    s_add_u32 m0, s23, 24576
    s_nop 0
    buffer_load_dwordx4 v249, s[80:83], s20 offen offset:1024 sc1 lds
    s_add_u32 s20, s20, 8192
    s_cmp_eq_u32 s20, s22
    s_cselect_b32 s20, s21, s20
    v_mfma_f32_16x16x32_bf16 v[92:95], v[116:119], v[156:159], v[92:95]
    buffer_load_dwordx4 v[192:195], v225, s[80:83], s26 offen offset:0 sc1
    v_mfma_f32_16x16x32_bf16 v[88:91], v[116:119], v[152:155], v[88:91]
    buffer_load_dwordx4 v[196:199], v225, s[80:83], s26 offen offset:1024 sc1
    v_mfma_f32_16x16x32_bf16 v[84:87], v[116:119], v[148:151], v[84:87]
    buffer_load_dwordx4 v[200:203], v225, s[80:83], s26 offen offset:2048 sc1
    v_mfma_f32_16x16x32_bf16 v[80:83], v[116:119], v[144:147], v[80:83]
    buffer_load_dwordx4 v[204:207], v225, s[80:83], s26 offen offset:3072 sc1
    s_waitcnt vmcnt(13) lgkmcnt(0)
    s_barrier
    s_cmp_eq_u32 s75, 0
    s_cbranch_scc1 cf_1158
cf_1158_b:
    v_mfma_f32_16x16x32_bf16 v[0:3], v[120:123], v[160:163], v[0:3]
    ds_read_b128 v[144:147], v235 offset:16384
    ds_read_b128 v[148:151], v235 offset:17408
    v_mfma_f32_16x16x32_bf16 v[4:7], v[120:123], v[164:167], v[4:7]
    ds_read_b128 v[152:155], v235 offset:18432
    v_mfma_f32_16x16x32_bf16 v[8:11], v[120:123], v[168:171], v[8:11]
    ds_read_b128 v[156:159], v235 offset:19456
    v_mfma_f32_16x16x32_bf16 v[12:15], v[120:123], v[172:175], v[12:15]
    s_add_u32 m0, s19, 28800
    s_nop 0
    buffer_load_dwordx4 v228, s[8:11], s16 offen lds
    v_mfma_f32_16x16x32_bf16 v[60:63], v[132:135], v[172:175], v[60:63]
    ds_read_b64_tr_b16 v[96:97], v237 offset:28800
    v_mfma_f32_16x16x32_bf16 v[56:59], v[132:135], v[168:171], v[56:59]
    ds_read_b64_tr_b16 v[98:99], v237 offset:32384
    v_mfma_f32_16x16x32_bf16 v[52:55], v[132:135], v[164:167], v[52:55]
    ds_read_b64_tr_b16 v[108:109], v237 offset:43200
    v_mfma_f32_16x16x32_bf16 v[48:51], v[132:135], v[160:163], v[48:51]
    s_add_u32 m0, s19, 29824
    s_nop 0
    buffer_load_dwordx4 v229, s[8:11], s16 offen lds
    v_mfma_f32_16x16x32_bf16 v[16:19], v[124:127], v[160:163], v[16:19]
    ds_read_b64_tr_b16 v[110:111], v237 offset:46784
    v_mfma_f32_16x16x32_bf16 v[20:23], v[124:127], v[164:167], v[20:23]
    ds_read_b64_tr_b16 v[100:101], v237 offset:28832
    v_mfma_f32_16x16x32_bf16 v[24:27], v[124:127], v[168:171], v[24:27]
    ds_read_b64_tr_b16 v[102:103], v237 offset:32416
    v_mfma_f32_16x16x32_bf16 v[28:31], v[124:127], v[172:175], v[28:31]
    s_add_u32 m0, s19, 30848
    s_nop 0
    buffer_load_dwordx4 v230, s[8:11], s16 offen lds
    s_add_u32 s16, s16, 229376
    s_cmp_eq_u32 s16, s18
    s_cselect_b32 s16, s17, s16
    v_mfma_f32_16x16x32_bf16 v[76:79], v[136:139], v[172:175], v[76:79]
    ds_read_b64_tr_b16 v[112:113], v237 offset:43232
    v_mfma_f32_16x16x32_bf16 v[72:75], v[136:139], v[168:171], v[72:75]
    ds_read_b64_tr_b16 v[114:115], v237 offset:46816
    v_mfma_f32_16x16x32_bf16 v[68:71], v[136:139], v[164:167], v[68:71]
    ds_read_b64_tr_b16 v[104:105], v239 offset:28800
    v_mfma_f32_16x16x32_bf16 v[64:67], v[136:139], v[160:163], v[64:67]
    s_add_u32 m0, s23, 0
    s_nop 0
    buffer_load_dwordx4 v249, s[80:83], s20 offen sc1 lds
    v_mfma_f32_16x16x32_bf16 v[32:35], v[128:131], v[160:163], v[32:35]
    ds_read_b64_tr_b16 v[106:107], v239 offset:32384
    v_mfma_f32_16x16x32_bf16 v[36:39], v[128:131], v[164:167], v[36:39]
    ds_read_b64_tr_b16 v[116:117], v239 offset:43200
    v_mfma_f32_16x16x32_bf16 v[40:43], v[128:131], v[168:171], v[40:43]
    ds_read_b64_tr_b16 v[118:119], v239 offset:46784
    v_mfma_f32_16x16x32_bf16 v[44:47], v[128:131], v[172:175], v[44:47]
    s_add_u32 m0, s23, 0
    s_nop 0
    buffer_load_dwordx4 v249, s[80:83], s20 offen offset:1024 sc1 lds
    s_add_u32 s20, s20, 8192
    s_cmp_eq_u32 s20, s22
    s_cselect_b32 s20, s21, s20
    v_mfma_f32_16x16x32_bf16 v[92:95], v[140:143], v[172:175], v[92:95]
    v_mfma_f32_16x16x32_bf16 v[88:91], v[140:143], v[168:171], v[88:91]
    v_mfma_f32_16x16x32_bf16 v[84:87], v[140:143], v[164:167], v[84:87]
    v_mfma_f32_16x16x32_bf16 v[80:83], v[140:143], v[160:163], v[80:83]
    s_waitcnt vmcnt(5) lgkmcnt(0)
    s_barrier
    v_mfma_f32_16x16x32_bf16 v[0:3], v[96:99], v[144:147], v[0:3]
    ds_read_b128 v[160:163], v235 offset:24576
    ds_read_b128 v[164:167], v235 offset:25600
    s_lshl_b32 s26, s69, 8
    s_add_u32 s26, s26, 159744
    v_mfma_f32_16x16x32_bf16 v[4:7], v[96:99], v[148:151], v[4:7]
    ds_read_b128 v[168:171], v235 offset:26624
    v_add_f32 v176, v176, v192
    v_mfma_f32_16x16x32_bf16 v[8:11], v[96:99], v[152:155], v[8:11]
    ds_read_b128 v[172:175], v235 offset:27648
    v_add_f32 v177, v177, v193
    v_add_f32 v178, v178, v194
    v_mfma_f32_16x16x32_bf16 v[12:15], v[96:99], v[156:159], v[12:15]
    s_add_u32 m0, s19, 57600
    s_nop 0
    buffer_load_dwordx4 v228, s[8:11], s16 offen lds
    v_add_f32 v179, v179, v195
    v_mfma_f32_16x16x32_bf16 v[60:63], v[108:111], v[156:159], v[60:63]
    ds_read_b64_tr_b16 v[120:121], v236 offset:0
    v_add_f32 v180, v180, v196
    v_add_f32 v181, v181, v197
    v_mfma_f32_16x16x32_bf16 v[56:59], v[108:111], v[152:155], v[56:59]
    ds_read_b64_tr_b16 v[122:123], v236 offset:3584
    v_add_f32 v182, v182, v198
    v_mfma_f32_16x16x32_bf16 v[52:55], v[108:111], v[148:151], v[52:55]
    ds_read_b64_tr_b16 v[132:133], v236 offset:14400
    v_add_f32 v183, v183, v199
    v_mfma_f32_16x16x32_bf16 v[48:51], v[108:111], v[144:147], v[48:51]
    s_add_u32 m0, s19, 58624
    s_nop 0
    buffer_load_dwordx4 v229, s[8:11], s16 offen lds
    v_add_f32 v184, v184, v200
    v_add_f32 v185, v185, v201
    v_mfma_f32_16x16x32_bf16 v[16:19], v[100:103], v[144:147], v[16:19]
    ds_read_b64_tr_b16 v[134:135], v236 offset:17984
    v_add_f32 v186, v186, v202
    v_mfma_f32_16x16x32_bf16 v[20:23], v[100:103], v[148:151], v[20:23]
    ds_read_b64_tr_b16 v[124:125], v236 offset:32
    v_add_f32 v187, v187, v203
    v_add_f32 v188, v188, v204
    v_mfma_f32_16x16x32_bf16 v[24:27], v[100:103], v[152:155], v[24:27]
    ds_read_b64_tr_b16 v[126:127], v236 offset:3616
    v_add_f32 v189, v189, v205
    v_mfma_f32_16x16x32_bf16 v[28:31], v[100:103], v[156:159], v[28:31]
    s_add_u32 m0, s19, 59648
    s_nop 0
    buffer_load_dwordx4 v230, s[8:11], s16 offen lds
    s_add_u32 s16, s16, 229376
    s_cmp_eq_u32 s16, s18
    s_cselect_b32 s16, s17, s16
    v_add_f32 v190, v190, v206
    v_mfma_f32_16x16x32_bf16 v[76:79], v[112:115], v[156:159], v[76:79]
    ds_read_b64_tr_b16 v[136:137], v236 offset:14432
    v_add_f32 v191, v191, v207
    v_add_f32 v176, v176, v184
    v_mfma_f32_16x16x32_bf16 v[72:75], v[112:115], v[152:155], v[72:75]
    ds_read_b64_tr_b16 v[138:139], v236 offset:18016
    v_add_f32 v177, v177, v185
    v_mfma_f32_16x16x32_bf16 v[68:71], v[112:115], v[148:151], v[68:71]
    ds_read_b64_tr_b16 v[128:129], v238 offset:0
    v_add_f32 v178, v178, v186
    v_add_f32 v179, v179, v187
    v_mfma_f32_16x16x32_bf16 v[64:67], v[112:115], v[144:147], v[64:67]
    s_add_u32 m0, s23, 8192
    s_nop 0
    buffer_load_dwordx4 v249, s[80:83], s20 offen sc1 lds
    v_add_f32 v180, v180, v188
    v_mfma_f32_16x16x32_bf16 v[32:35], v[104:107], v[144:147], v[32:35]
    ds_read_b64_tr_b16 v[130:131], v238 offset:3584
    v_add_f32 v181, v181, v189
    v_add_f32 v182, v182, v190
    v_mfma_f32_16x16x32_bf16 v[36:39], v[104:107], v[148:151], v[36:39]
    ds_read_b64_tr_b16 v[140:141], v238 offset:14400
    v_add_f32 v183, v183, v191
    v_mfma_f32_16x16x32_bf16 v[40:43], v[104:107], v[152:155], v[40:43]
    ds_read_b64_tr_b16 v[142:143], v238 offset:17984
    v_add_f32 v176, v176, v180
    v_mfma_f32_16x16x32_bf16 v[44:47], v[104:107], v[156:159], v[44:47]
    s_add_u32 m0, s23, 8192
    s_nop 0
    buffer_load_dwordx4 v249, s[80:83], s20 offen offset:1024 sc1 lds
    s_add_u32 s20, s20, 8192
    s_cmp_eq_u32 s20, s22
    s_cselect_b32 s20, s21, s20
    v_add_f32 v177, v177, v181
    v_add_f32 v178, v178, v182
    v_mfma_f32_16x16x32_bf16 v[92:95], v[116:119], v[156:159], v[92:95]
    v_add_f32 v179, v179, v183
    v_mfma_f32_16x16x32_bf16 v[88:91], v[116:119], v[152:155], v[88:91]
    v_and_b32 v225, 15, v252
    v_and_b32 v180, 1, v251
    v_mfma_f32_16x16x32_bf16 v[84:87], v[116:119], v[148:151], v[84:87]
    v_permlane16_swap_b32 v176, v178
    v_mfma_f32_16x16x32_bf16 v[80:83], v[116:119], v[144:147], v[80:83]
    v_permlane16_swap_b32 v177, v179
    s_waitcnt vmcnt(5) lgkmcnt(0)
    s_barrier
    v_mfma_f32_16x16x32_bf16 v[0:3], v[120:123], v[160:163], v[0:3]
    ds_read_b128 v[144:147], v235 offset:0
    ds_read_b128 v[148:151], v235 offset:1024
    v_add_f32 v176, v176, v178
    v_add_f32 v177, v177, v179
    v_mfma_f32_16x16x32_bf16 v[4:7], v[120:123], v[164:167], v[4:7]
    ds_read_b128 v[152:155], v235 offset:2048
    v_mov_b32 v178, v176
    v_mfma_f32_16x16x32_bf16 v[8:11], v[120:123], v[168:171], v[8:11]
    ds_read_b128 v[156:159], v235 offset:3072
    v_mov_b32 v179, v177
    v_mfma_f32_16x16x32_bf16 v[12:15], v[120:123], v[172:175], v[12:15]
    s_add_u32 m0, s19, 86400
    s_nop 0
    buffer_load_dwordx4 v228, s[8:11], s16 offen lds
    v_lshl_add_u32 v225, v225, 1, v180
    v_mfma_f32_16x16x32_bf16 v[60:63], v[132:135], v[172:175], v[60:63]
    ds_read_b64_tr_b16 v[96:97], v236 offset:28800
    v_lshlrev_b32 v225, 3, v225
    v_permlane32_swap_b32 v176, v178
    v_mfma_f32_16x16x32_bf16 v[56:59], v[132:135], v[168:171], v[56:59]
    ds_read_b64_tr_b16 v[98:99], v236 offset:32384
    v_permlane32_swap_b32 v177, v179
    v_mfma_f32_16x16x32_bf16 v[52:55], v[132:135], v[164:167], v[52:55]
    ds_read_b64_tr_b16 v[108:109], v236 offset:43200
    v_add_f32 v176, v176, v178
    v_mfma_f32_16x16x32_bf16 v[48:51], v[132:135], v[160:163], v[48:51]
    s_add_u32 m0, s19, 87424
    s_nop 0
    buffer_load_dwordx4 v229, s[8:11], s16 offen lds
    v_add_f32 v177, v177, v179
    v_mfma_f32_16x16x32_bf16 v[16:19], v[124:127], v[160:163], v[16:19]
    ds_read_b64_tr_b16 v[110:111], v236 offset:46784
    v_mul_f32 v176, 0x3a800000, v176
    v_mfma_f32_16x16x32_bf16 v[20:23], v[124:127], v[164:167], v[20:23]
    ds_read_b64_tr_b16 v[100:101], v236 offset:28832
    v_mul_f32 v177, 0x3a800000, v177
    v_fma_f32 v177, -v176, v176, v177
    v_mfma_f32_16x16x32_bf16 v[24:27], v[124:127], v[168:171], v[24:27]
    ds_read_b64_tr_b16 v[102:103], v236 offset:32416
    v_max_f32 v177, 0, v177
    v_mfma_f32_16x16x32_bf16 v[28:31], v[124:127], v[172:175], v[28:31]
    s_add_u32 m0, s19, 88448
    s_nop 0
    buffer_load_dwordx4 v230, s[8:11], s16 offen lds
    s_add_u32 s16, s16, 229376
    s_cmp_eq_u32 s16, s18
    s_cselect_b32 s16, s17, s16
    v_cvt_pk_bf16_f32 v176, v176, v176
    v_mfma_f32_16x16x32_bf16 v[76:79], v[136:139], v[172:175], v[76:79]
    ds_read_b64_tr_b16 v[112:113], v236 offset:43232
    v_lshlrev_b32 v176, 16, v176
    v_mfma_f32_16x16x32_bf16 v[72:75], v[136:139], v[168:171], v[72:75]
    ds_read_b64_tr_b16 v[114:115], v236 offset:46816
    v_cvt_pk_bf16_f32 v177, v177, v177
    v_mfma_f32_16x16x32_bf16 v[68:71], v[136:139], v[164:167], v[68:71]
    ds_read_b64_tr_b16 v[104:105], v238 offset:28800
    v_lshlrev_b32 v177, 16, v177
    v_add_f32 v177, 0x3727c5ac, v177
    v_mfma_f32_16x16x32_bf16 v[64:67], v[136:139], v[160:163], v[64:67]
    s_add_u32 m0, s23, 16384
    s_nop 0
    buffer_load_dwordx4 v249, s[80:83], s20 offen sc1 lds
    v_cvt_pk_bf16_f32 v177, v177, v177
    v_mfma_f32_16x16x32_bf16 v[32:35], v[128:131], v[160:163], v[32:35]
    ds_read_b64_tr_b16 v[106:107], v238 offset:32384
    v_lshlrev_b32 v177, 16, v177
    v_mfma_f32_16x16x32_bf16 v[36:39], v[128:131], v[164:167], v[36:39]
    ds_read_b64_tr_b16 v[116:117], v238 offset:43200
    v_sqrt_f32 v177, v177
    v_mfma_f32_16x16x32_bf16 v[40:43], v[128:131], v[168:171], v[40:43]
    ds_read_b64_tr_b16 v[118:119], v238 offset:46784
    s_nop 0
    v_mfma_f32_16x16x32_bf16 v[44:47], v[128:131], v[172:175], v[44:47]
    s_add_u32 m0, s23, 16384
    s_nop 0
    buffer_load_dwordx4 v249, s[80:83], s20 offen offset:1024 sc1 lds
    s_add_u32 s20, s20, 8192
    s_cmp_eq_u32 s20, s22
    s_cselect_b32 s20, s21, s20
    v_cvt_pk_bf16_f32 v177, v177, v177
    v_lshlrev_b32 v177, 16, v177
    v_mfma_f32_16x16x32_bf16 v[92:95], v[140:143], v[172:175], v[92:95]
    v_rcp_f32 v177, v177
    v_mfma_f32_16x16x32_bf16 v[88:91], v[140:143], v[168:171], v[88:91]
    s_nop 0
    v_mfma_f32_16x16x32_bf16 v[84:87], v[140:143], v[164:167], v[84:87]
    v_add_u32 v225, s26, v225
    v_mfma_f32_16x16x32_bf16 v[80:83], v[140:143], v[160:163], v[80:83]
    ds_write_b64 v225, v[176:177]
    s_mov_b32 s24, 4
    s_cmp_eq_u32 s75, 0
    s_cselect_b32 s27, 6, 0
g3c1_loop:
    s_waitcnt vmcnt(5) lgkmcnt(0)
    s_barrier
    s_bitcmp1_b32 s27, s24
    s_cbranch_scc1 g3c1_hook
g3c1_hb:
    v_mfma_f32_16x16x32_bf16 v[0:3], v[96:99], v[144:147], v[0:3]
    ds_read_b128 v[160:163], v235 offset:8192
    ds_read_b128 v[164:167], v235 offset:9216
    v_mfma_f32_16x16x32_bf16 v[4:7], v[96:99], v[148:151], v[4:7]
    ds_read_b128 v[168:171], v235 offset:10240
    v_mfma_f32_16x16x32_bf16 v[8:11], v[96:99], v[152:155], v[8:11]
    ds_read_b128 v[172:175], v235 offset:11264
    v_mfma_f32_16x16x32_bf16 v[12:15], v[96:99], v[156:159], v[12:15]
    s_add_u32 m0, s19, 0
    s_nop 0
    buffer_load_dwordx4 v228, s[8:11], s16 offen lds
    v_mfma_f32_16x16x32_bf16 v[60:63], v[108:111], v[156:159], v[60:63]
    ds_read_b64_tr_b16 v[120:121], v237 offset:0
    v_mfma_f32_16x16x32_bf16 v[56:59], v[108:111], v[152:155], v[56:59]
    ds_read_b64_tr_b16 v[122:123], v237 offset:3584
    v_mfma_f32_16x16x32_bf16 v[52:55], v[108:111], v[148:151], v[52:55]
    ds_read_b64_tr_b16 v[132:133], v237 offset:14400
    v_mfma_f32_16x16x32_bf16 v[48:51], v[108:111], v[144:147], v[48:51]
    s_add_u32 m0, s19, 1024
    s_nop 0
    buffer_load_dwordx4 v229, s[8:11], s16 offen lds
    v_mfma_f32_16x16x32_bf16 v[16:19], v[100:103], v[144:147], v[16:19]
    ds_read_b64_tr_b16 v[134:135], v237 offset:17984
    v_mfma_f32_16x16x32_bf16 v[20:23], v[100:103], v[148:151], v[20:23]
    ds_read_b64_tr_b16 v[124:125], v237 offset:32
    v_mfma_f32_16x16x32_bf16 v[24:27], v[100:103], v[152:155], v[24:27]
    ds_read_b64_tr_b16 v[126:127], v237 offset:3616
    v_mfma_f32_16x16x32_bf16 v[28:31], v[100:103], v[156:159], v[28:31]
    s_add_u32 m0, s19, 2048
    s_nop 0
    buffer_load_dwordx4 v230, s[8:11], s16 offen lds
    s_add_u32 s16, s16, 229376
    s_cmp_eq_u32 s16, s18
    s_cselect_b32 s16, s17, s16
    v_mfma_f32_16x16x32_bf16 v[76:79], v[112:115], v[156:159], v[76:79]
    ds_read_b64_tr_b16 v[136:137], v237 offset:14432
    v_mfma_f32_16x16x32_bf16 v[72:75], v[112:115], v[152:155], v[72:75]
    ds_read_b64_tr_b16 v[138:139], v237 offset:18016
    v_mfma_f32_16x16x32_bf16 v[68:71], v[112:115], v[148:151], v[68:71]
    ds_read_b64_tr_b16 v[128:129], v239 offset:0
    v_mfma_f32_16x16x32_bf16 v[64:67], v[112:115], v[144:147], v[64:67]
    s_add_u32 m0, s23, 24576
    s_nop 0
    buffer_load_dwordx4 v249, s[80:83], s20 offen sc1 lds
    v_mfma_f32_16x16x32_bf16 v[32:35], v[104:107], v[144:147], v[32:35]
    ds_read_b64_tr_b16 v[130:131], v239 offset:3584
    v_mfma_f32_16x16x32_bf16 v[36:39], v[104:107], v[148:151], v[36:39]
    ds_read_b64_tr_b16 v[140:141], v239 offset:14400
    v_mfma_f32_16x16x32_bf16 v[40:43], v[104:107], v[152:155], v[40:43]
    ds_read_b64_tr_b16 v[142:143], v239 offset:17984
    v_mfma_f32_16x16x32_bf16 v[44:47], v[104:107], v[156:159], v[44:47]
    s_add_u32 m0, s23, 24576
    s_nop 0
    buffer_load_dwordx4 v249, s[80:83], s20 offen offset:1024 sc1 lds
    s_add_u32 s20, s20, 8192
    s_cmp_eq_u32 s20, s22
    s_cselect_b32 s20, s21, s20
    v_mfma_f32_16x16x32_bf16 v[92:95], v[116:119], v[156:159], v[92:95]
    v_mfma_f32_16x16x32_bf16 v[88:91], v[116:119], v[152:155], v[88:91]
    v_mfma_f32_16x16x32_bf16 v[84:87], v[116:119], v[148:151], v[84:87]
    v_mfma_f32_16x16x32_bf16 v[80:83], v[116:119], v[144:147], v[80:83]
    s_waitcnt vmcnt(5) lgkmcnt(0)
    s_barrier
    v_mfma_f32_16x16x32_bf16 v[0:3], v[120:123], v[160:163], v[0:3]
    ds_read_b128 v[144:147], v235 offset:16384
    ds_read_b128 v[148:151], v235 offset:17408
    v_mfma_f32_16x16x32_bf16 v[4:7], v[120:123], v[164:167], v[4:7]
    ds_read_b128 v[152:155], v235 offset:18432
    v_mfma_f32_16x16x32_bf16 v[8:11], v[120:123], v[168:171], v[8:11]
    ds_read_b128 v[156:159], v235 offset:19456
    v_mfma_f32_16x16x32_bf16 v[12:15], v[120:123], v[172:175], v[12:15]
    s_add_u32 m0, s19, 28800
    s_nop 0
    buffer_load_dwordx4 v228, s[8:11], s16 offen lds
    v_mfma_f32_16x16x32_bf16 v[60:63], v[132:135], v[172:175], v[60:63]
    ds_read_b64_tr_b16 v[96:97], v237 offset:28800
    v_mfma_f32_16x16x32_bf16 v[56:59], v[132:135], v[168:171], v[56:59]
    ds_read_b64_tr_b16 v[98:99], v237 offset:32384
    v_mfma_f32_16x16x32_bf16 v[52:55], v[132:135], v[164:167], v[52:55]
    ds_read_b64_tr_b16 v[108:109], v237 offset:43200
    v_mfma_f32_16x16x32_bf16 v[48:51], v[132:135], v[160:163], v[48:51]
    s_add_u32 m0, s19, 29824
    s_nop 0
    buffer_load_dwordx4 v229, s[8:11], s16 offen lds
    v_mfma_f32_16x16x32_bf16 v[16:19], v[124:127], v[160:163], v[16:19]
    ds_read_b64_tr_b16 v[110:111], v237 offset:46784
    v_mfma_f32_16x16x32_bf16 v[20:23], v[124:127], v[164:167], v[20:23]
    ds_read_b64_tr_b16 v[100:101], v237 offset:28832
    v_mfma_f32_16x16x32_bf16 v[24:27], v[124:127], v[168:171], v[24:27]
    ds_read_b64_tr_b16 v[102:103], v237 offset:32416
    v_mfma_f32_16x16x32_bf16 v[28:31], v[124:127], v[172:175], v[28:31]
    s_add_u32 m0, s19, 30848
    s_nop 0
    buffer_load_dwordx4 v230, s[8:11], s16 offen lds
    s_add_u32 s16, s16, 229376
    s_cmp_eq_u32 s16, s18
    s_cselect_b32 s16, s17, s16
    v_mfma_f32_16x16x32_bf16 v[76:79], v[136:139], v[172:175], v[76:79]
    ds_read_b64_tr_b16 v[112:113], v237 offset:43232
    v_mfma_f32_16x16x32_bf16 v[72:75], v[136:139], v[168:171], v[72:75]
    ds_read_b64_tr_b16 v[114:115], v237 offset:46816
    v_mfma_f32_16x16x32_bf16 v[68:71], v[136:139], v[164:167], v[68:71]
    ds_read_b64_tr_b16 v[104:105], v239 offset:28800
    v_mfma_f32_16x16x32_bf16 v[64:67], v[136:139], v[160:163], v[64:67]
    s_add_u32 m0, s23, 0
    s_nop 0
    buffer_load_dwordx4 v249, s[80:83], s20 offen sc1 lds
    v_mfma_f32_16x16x32_bf16 v[32:35], v[128:131], v[160:163], v[32:35]
    ds_read_b64_tr_b16 v[106:107], v239 offset:32384
    v_mfma_f32_16x16x32_bf16 v[36:39], v[128:131], v[164:167], v[36:39]
    ds_read_b64_tr_b16 v[116:117], v239 offset:43200
    v_mfma_f32_16x16x32_bf16 v[40:43], v[128:131], v[168:171], v[40:43]
    ds_read_b64_tr_b16 v[118:119], v239 offset:46784
    v_mfma_f32_16x16x32_bf16 v[44:47], v[128:131], v[172:175], v[44:47]
    s_add_u32 m0, s23, 0
    s_nop 0
    buffer_load_dwordx4 v249, s[80:83], s20 offen offset:1024 sc1 lds
    s_add_u32 s20, s20, 8192
    s_cmp_eq_u32 s20, s22
    s_cselect_b32 s20, s21, s20
    v_mfma_f32_16x16x32_bf16 v[92:95], v[140:143], v[172:175], v[92:95]
    v_mfma_f32_16x16x32_bf16 v[88:91], v[140:143], v[168:171], v[88:91]
    v_mfma_f32_16x16x32_bf16 v[84:87], v[140:143], v[164:167], v[84:87]
    v_mfma_f32_16x16x32_bf16 v[80:83], v[140:143], v[160:163], v[80:83]
    s_waitcnt vmcnt(5) lgkmcnt(0)
    s_barrier
    v_mfma_f32_16x16x32_bf16 v[0:3], v[96:99], v[144:147], v[0:3]
    ds_read_b128 v[160:163], v235 offset:24576
    ds_read_b128 v[164:167], v235 offset:25600
    v_mfma_f32_16x16x32_bf16 v[4:7], v[96:99], v[148:151], v[4:7]
    ds_read_b128 v[168:171], v235 offset:26624
    v_mfma_f32_16x16x32_bf16 v[8:11], v[96:99], v[152:155], v[8:11]
    ds_read_b128 v[172:175], v235 offset:27648
    v_mfma_f32_16x16x32_bf16 v[12:15], v[96:99], v[156:159], v[12:15]
    s_add_u32 m0, s19, 57600
    s_nop 0
    buffer_load_dwordx4 v228, s[8:11], s16 offen lds
    v_mfma_f32_16x16x32_bf16 v[60:63], v[108:111], v[156:159], v[60:63]
    ds_read_b64_tr_b16 v[120:121], v236 offset:0
    v_mfma_f32_16x16x32_bf16 v[56:59], v[108:111], v[152:155], v[56:59]
    ds_read_b64_tr_b16 v[122:123], v236 offset:3584
    v_mfma_f32_16x16x32_bf16 v[52:55], v[108:111], v[148:151], v[52:55]
    ds_read_b64_tr_b16 v[132:133], v236 offset:14400
    v_mfma_f32_16x16x32_bf16 v[48:51], v[108:111], v[144:147], v[48:51]
    s_add_u32 m0, s19, 58624
    s_nop 0
    buffer_load_dwordx4 v229, s[8:11], s16 offen lds
    v_mfma_f32_16x16x32_bf16 v[16:19], v[100:103], v[144:147], v[16:19]
    ds_read_b64_tr_b16 v[134:135], v236 offset:17984
    v_mfma_f32_16x16x32_bf16 v[20:23], v[100:103], v[148:151], v[20:23]
    ds_read_b64_tr_b16 v[124:125], v236 offset:32
    v_mfma_f32_16x16x32_bf16 v[24:27], v[100:103], v[152:155], v[24:27]
    ds_read_b64_tr_b16 v[126:127], v236 offset:3616
    v_mfma_f32_16x16x32_bf16 v[28:31], v[100:103], v[156:159], v[28:31]
    s_add_u32 m0, s19, 59648
    s_nop 0
    buffer_load_dwordx4 v230, s[8:11], s16 offen lds
    s_add_u32 s16, s16, 229376
    s_cmp_eq_u32 s16, s18
    s_cselect_b32 s16, s17, s16
    v_mfma_f32_16x16x32_bf16 v[76:79], v[112:115], v[156:159], v[76:79]
    ds_read_b64_tr_b16 v[136:137], v236 offset:14432
    v_mfma_f32_16x16x32_bf16 v[72:75], v[112:115], v[152:155], v[72:75]
    ds_read_b64_tr_b16 v[138:139], v236 offset:18016
    v_mfma_f32_16x16x32_bf16 v[68:71], v[112:115], v[148:151], v[68:71]
    ds_read_b64_tr_b16 v[128:129], v238 offset:0
    v_mfma_f32_16x16x32_bf16 v[64:67], v[112:115], v[144:147], v[64:67]
    s_add_u32 m0, s23, 8192
    s_nop 0
    buffer_load_dwordx4 v249, s[80:83], s20 offen sc1 lds
    v_mfma_f32_16x16x32_bf16 v[32:35], v[104:107], v[144:147], v[32:35]
    ds_read_b64_tr_b16 v[130:131], v238 offset:3584
    v_mfma_f32_16x16x32_bf16 v[36:39], v[104:107], v[148:151], v[36:39]
    ds_read_b64_tr_b16 v[140:141], v238 offset:14400
    v_mfma_f32_16x16x32_bf16 v[40:43], v[104:107], v[152:155], v[40:43]
    ds_read_b64_tr_b16 v[142:143], v238 offset:17984
    v_mfma_f32_16x16x32_bf16 v[44:47], v[104:107], v[156:159], v[44:47]
    s_add_u32 m0, s23, 8192
    s_nop 0
    buffer_load_dwordx4 v249, s[80:83], s20 offen offset:1024 sc1 lds
    s_add_u32 s20, s20, 8192
    s_cmp_eq_u32 s20, s22
    s_cselect_b32 s20, s21, s20
    v_mfma_f32_16x16x32_bf16 v[92:95], v[116:119], v[156:159], v[92:95]
    v_mfma_f32_16x16x32_bf16 v[88:91], v[116:119], v[152:155], v[88:91]
    v_mfma_f32_16x16x32_bf16 v[84:87], v[116:119], v[148:151], v[84:87]
    v_mfma_f32_16x16x32_bf16 v[80:83], v[116:119], v[144:147], v[80:83]
    s_waitcnt vmcnt(5) lgkmcnt(0)
    s_barrier
    v_mfma_f32_16x16x32_bf16 v[0:3], v[120:123], v[160:163], v[0:3]
    ds_read_b128 v[144:147], v235 offset:0
    ds_read_b128 v[148:151], v235 offset:1024
    v_mfma_f32_16x16x32_bf16 v[4:7], v[120:123], v[164:167], v[4:7]
    ds_read_b128 v[152:155], v235 offset:2048
    v_mfma_f32_16x16x32_bf16 v[8:11], v[120:123], v[168:171], v[8:11]
    ds_read_b128 v[156:159], v235 offset:3072
    v_mfma_f32_16x16x32_bf16 v[12:15], v[120:123], v[172:175], v[12:15]
    s_add_u32 m0, s19, 86400
    s_nop 0
    buffer_load_dwordx4 v228, s[8:11], s16 offen lds
    v_mfma_f32_16x16x32_bf16 v[60:63], v[132:135], v[172:175], v[60:63]
    ds_read_b64_tr_b16 v[96:97], v236 offset:28800
    v_mfma_f32_16x16x32_bf16 v[56:59], v[132:135], v[168:171], v[56:59]
    ds_read_b64_tr_b16 v[98:99], v236 offset:32384
    v_mfma_f32_16x16x32_bf16 v[52:55], v[132:135], v[164:167], v[52:55]
    ds_read_b64_tr_b16 v[108:109], v236 offset:43200
    v_mfma_f32_16x16x32_bf16 v[48:51], v[132:135], v[160:163], v[48:51]
    s_add_u32 m0, s19, 87424
    s_nop 0
    buffer_load_dwordx4 v229, s[8:11], s16 offen lds
    v_mfma_f32_16x16x32_bf16 v[16:19], v[124:127], v[160:163], v[16:19]
    ds_read_b64_tr_b16 v[110:111], v236 offset:46784
    v_mfma_f32_16x16x32_bf16 v[20:23], v[124:127], v[164:167], v[20:23]
    ds_read_b64_tr_b16 v[100:101], v236 offset:28832
    v_mfma_f32_16x16x32_bf16 v[24:27], v[124:127], v[168:171], v[24:27]
    ds_read_b64_tr_b16 v[102:103], v236 offset:32416
    v_mfma_f32_16x16x32_bf16 v[28:31], v[124:127], v[172:175], v[28:31]
    s_add_u32 m0, s19, 88448
    s_nop 0
    buffer_load_dwordx4 v230, s[8:11], s16 offen lds
    s_add_u32 s16, s16, 229376
    s_cmp_eq_u32 s16, s18
    s_cselect_b32 s16, s17, s16
    v_mfma_f32_16x16x32_bf16 v[76:79], v[136:139], v[172:175], v[76:79]
    ds_read_b64_tr_b16 v[112:113], v236 offset:43232
    v_mfma_f32_16x16x32_bf16 v[72:75], v[136:139], v[168:171], v[72:75]
    ds_read_b64_tr_b16 v[114:115], v236 offset:46816
    v_mfma_f32_16x16x32_bf16 v[68:71], v[136:139], v[164:167], v[68:71]
    ds_read_b64_tr_b16 v[104:105], v238 offset:28800
    v_mfma_f32_16x16x32_bf16 v[64:67], v[136:139], v[160:163], v[64:67]
    s_add_u32 m0, s23, 16384
    s_nop 0
    buffer_load_dwordx4 v249, s[80:83], s20 offen sc1 lds
    v_mfma_f32_16x16x32_bf16 v[32:35], v[128:131], v[160:163], v[32:35]
    ds_read_b64_tr_b16 v[106:107], v238 offset:32384
    v_mfma_f32_16x16x32_bf16 v[36:39], v[128:131], v[164:167], v[36:39]
    ds_read_b64_tr_b16 v[116:117], v238 offset:43200
    v_mfma_f32_16x16x32_bf16 v[40:43], v[128:131], v[168:171], v[40:43]
    ds_read_b64_tr_b16 v[118:119], v238 offset:46784
    v_mfma_f32_16x16x32_bf16 v[44:47], v[128:131], v[172:175], v[44:47]
    s_add_u32 m0, s23, 16384
    s_nop 0
    buffer_load_dwordx4 v249, s[80:83], s20 offen offset:1024 sc1 lds
    s_add_u32 s20, s20, 8192
    s_cmp_eq_u32 s20, s22
    s_cselect_b32 s20, s21, s20
    v_mfma_f32_16x16x32_bf16 v[92:95], v[140:143], v[172:175], v[92:95]
    v_mfma_f32_16x16x32_bf16 v[88:91], v[140:143], v[168:171], v[88:91]
    v_mfma_f32_16x16x32_bf16 v[84:87], v[140:143], v[164:167], v[84:87]
    v_mfma_f32_16x16x32_bf16 v[80:83], v[140:143], v[160:163], v[80:83]
    s_sub_u32 s24, s24, 1
    s_cmp_lg_u32 s24, 0
    s_cbranch_scc1 g3c1_loop
    s_sub_u32 s27, s74, s58
    s_and_b32 s27, s27, 7
    s_cmp_lt_u32 s27, 4
    s_cselect_b32 s27, 14, 0
    s_waitcnt vmcnt(5) lgkmcnt(0)
    s_barrier
    v_mfma_f32_16x16x32_bf16 v[0:3], v[96:99], v[144:147], v[0:3]
    ds_read_b128 v[160:163], v235 offset:8192
    ds_read_b128 v[164:167], v235 offset:9216
    v_mfma_f32_16x16x32_bf16 v[4:7], v[96:99], v[148:151], v[4:7]
    s_and_b32 s26, s3, 1
    s_mul_i32 s26, s26, 14336
    s_mul_i32 s65, s74, 896
    s_add_u32 s26, s26, s65
    s_lshr_b32 s65, s69, 1
    s_mul_i32 s65, s65, 448
    s_add_u32 s26, s26, s65
    s_add_u32 s26, s26, 74448896
    v_and_b32 v225, 31, v250
    v_min_u32 v225, 27, v225
    v_lshlrev_b32 v225, 4, v225
    v_lshrrev_b32 v253, 5, v250
    v_mul_u32_u24 v253, 229376, v253
    v_add_u32 v225, v253, v225
    v_mfma_f32_16x16x32_bf16 v[8:11], v[96:99], v[152:155], v[8:11]
    ds_read_b128 v[168:171], v235 offset:10240
    s_cmp_lg_u32 s75, 0
    s_cbranch_scc1 cl_1660_0
    buffer_load_dwordx4 v[176:179], v225, s[80:83], s26 offen sc1
    s_add_u32 s26, s26, 28672
cl_1660_0:
    v_mfma_f32_16x16x32_bf16 v[12:15], v[96:99], v[156:159], v[12:15]
    ds_read_b128 v[172:175], v235 offset:11264
    v_mfma_f32_16x16x32_bf16 v[60:63], v[108:111], v[156:159], v[60:63]
    s_cmp_lg_u32 s75, 0
    s_cbranch_scc1 cl_1660_1
    buffer_load_dwordx4 v[180:183], v225, s[80:83], s26 offen sc1
    s_add_u32 s26, s26, 28672
cl_1660_1:
    ds_read_b64_tr_b16 v[120:121], v237 offset:0
    v_mfma_f32_16x16x32_bf16 v[56:59], v[108:111], v[152:155], v[56:59]
    s_cmp_lg_u32 s75, 0
    s_cbranch_scc1 cl_1660_2
    buffer_load_dwordx4 v[184:187], v225, s[80:83], s26 offen sc1
    s_add_u32 s26, s26, 28672
cl_1660_2:
    v_mfma_f32_16x16x32_bf16 v[52:55], v[108:111], v[148:151], v[52:55]
    ds_read_b64_tr_b16 v[122:123], v237 offset:3584
    s_cmp_lg_u32 s75, 0
    s_cbranch_scc1 cl_1660_3
    buffer_load_dwordx4 v[188:191], v225, s[80:83], s26 offen sc1
    s_add_u32 s26, s26, 28672
cl_1660_3:
    v_mfma_f32_16x16x32_bf16 v[48:51], v[108:111], v[144:147], v[48:51]
    ds_read_b64_tr_b16 v[132:133], v237 offset:14400
    v_mfma_f32_16x16x32_bf16 v[16:19], v[100:103], v[144:147], v[16:19]
    s_cmp_lg_u32 s75, 0
    s_cbranch_scc1 cl_1660_4
    buffer_load_dwordx4 v[192:195], v225, s[80:83], s26 offen sc1
    s_add_u32 s26, s26, 28672
cl_1660_4:
    ds_read_b64_tr_b16 v[134:135], v237 offset:17984
    v_mfma_f32_16x16x32_bf16 v[20:23], v[100:103], v[148:151], v[20:23]
    s_cmp_lg_u32 s75, 0
    s_cbranch_scc1 cl_1660_5
    buffer_load_dwordx4 v[196:199], v225, s[80:83], s26 offen sc1
    s_add_u32 s26, s26, 28672
cl_1660_5:
    v_mfma_f32_16x16x32_bf16 v[24:27], v[100:103], v[152:155], v[24:27]
    ds_read_b64_tr_b16 v[124:125], v237 offset:32
    ds_read_b64_tr_b16 v[126:127], v237 offset:3616
    v_mfma_f32_16x16x32_bf16 v[28:31], v[100:103], v[156:159], v[28:31]
    s_cmp_lg_u32 s75, 0
    s_cbranch_scc1 cl_1660_6
    buffer_load_dwordx4 v[200:203], v225, s[80:83], s26 offen sc1
    s_add_u32 s26, s26, 28672
cl_1660_6:
    v_mfma_f32_16x16x32_bf16 v[76:79], v[112:115], v[156:159], v[76:79]
    ds_read_b64_tr_b16 v[136:137], v237 offset:14432
    s_cmp_lg_u32 s75, 0
    s_cbranch_scc1 cl_1660_7
    buffer_load_dwordx4 v[204:207], v225, s[80:83], s26 offen sc1
    s_add_u32 s26, s26, 28672
cl_1660_7:
    v_mfma_f32_16x16x32_bf16 v[72:75], v[112:115], v[152:155], v[72:75]
    ds_read_b64_tr_b16 v[138:139], v237 offset:18016
    v_mfma_f32_16x16x32_bf16 v[68:71], v[112:115], v[148:151], v[68:71]
    s_add_u32 m0, s19, 0
    s_nop 0
    buffer_load_dwordx4 v228, s[8:11], s16 offen lds
    ds_read_b64_tr_b16 v[128:129], v239 offset:0
    v_mfma_f32_16x16x32_bf16 v[64:67], v[112:115], v[144:147], v[64:67]
    s_add_u32 m0, s19, 1024
    s_nop 0
    buffer_load_dwordx4 v229, s[8:11], s16 offen lds
    v_mfma_f32_16x16x32_bf16 v[32:35], v[104:107], v[144:147], v[32:35]
    ds_read_b64_tr_b16 v[130:131], v239 offset:3584
    s_add_u32 m0, s19, 2048
    s_nop 0
    buffer_load_dwordx4 v230, s[8:11], s16 offen lds
    s_add_u32 s16, s16, 229376
    s_cmp_eq_u32 s16, s18
    s_cselect_b32 s16, s17, s16
    v_mfma_f32_16x16x32_bf16 v[36:39], v[104:107], v[148:151], v[36:39]
    ds_read_b64_tr_b16 v[140:141], v239 offset:14400
    v_mfma_f32_16x16x32_bf16 v[40:43], v[104:107], v[152:155], v[40:43]
    s_add_u32 m0, s23, 24576
    s_nop 0
    buffer_load_dwordx4 v249, s[80:83], s20 offen sc1 lds
    ds_read_b64_tr_b16 v[142:143], v239 offset:17984
    v_mfma_f32_16x16x32_bf16 v[44:47], v[104:107], v[156:159], v[44:47]
    s_add_u32 m0, s23, 24576
    s_nop 0
    buffer_load_dwordx4 v249, s[80:83], s20 offen offset:1024 sc1 lds
    s_add_u32 s20, s20, 8192
    s_cmp_eq_u32 s20, s22
    s_cselect_b32 s20, s21, s20
    v_mfma_f32_16x16x32_bf16 v[92:95], v[116:119], v[156:159], v[92:95]
    v_mfma_f32_16x16x32_bf16 v[88:91], v[116:119], v[152:155], v[88:91]
    v_mfma_f32_16x16x32_bf16 v[84:87], v[116:119], v[148:151], v[84:87]
    v_mfma_f32_16x16x32_bf16 v[80:83], v[116:119], v[144:147], v[80:83]
    s_waitcnt vmcnt(5) lgkmcnt(0)
    s_barrier
    v_mfma_f32_16x16x32_bf16 v[0:3], v[120:123], v[160:163], v[0:3]
    ds_read_b128 v[144:147], v235 offset:16384
    v_add_f32 v176, v176, v192
    v_add_f32 v177, v177, v193
    v_add_f32 v178, v178, v194
    v_mfma_f32_16x16x32_bf16 v[4:7], v[120:123], v[164:167], v[4:7]
    ds_read_b128 v[148:151], v235 offset:17408
    v_add_f32 v179, v179, v195
    v_add_f32 v180, v180, v196
    v_add_f32 v181, v181, v197
    v_mfma_f32_16x16x32_bf16 v[8:11], v[120:123], v[168:171], v[8:11]
    ds_read_b128 v[152:155], v235 offset:18432
    v_add_f32 v182, v182, v198
    v_add_f32 v183, v183, v199
    v_mfma_f32_16x16x32_bf16 v[12:15], v[120:123], v[172:175], v[12:15]
    ds_read_b128 v[156:159], v235 offset:19456
    v_add_f32 v184, v184, v200
    v_add_f32 v185, v185, v201
    v_add_f32 v186, v186, v202
    v_mfma_f32_16x16x32_bf16 v[60:63], v[132:135], v[172:175], v[60:63]
    v_add_f32 v187, v187, v203
    v_add_f32 v188, v188, v204
    v_mfma_f32_16x16x32_bf16 v[56:59], v[132:135], v[168:171], v[56:59]
    ds_read_b64_tr_b16 v[96:97], v237 offset:28800
    v_add_f32 v189, v189, v205
    v_add_f32 v190, v190, v206
    v_add_f32 v191, v191, v207
    v_mfma_f32_16x16x32_bf16 v[52:55], v[132:135], v[164:167], v[52:55]
    ds_read_b64_tr_b16 v[98:99], v237 offset:32384
    v_add_f32 v176, v176, v184
    v_add_f32 v177, v177, v185
    v_lshlrev_b32 v247, 7, v250
    s_add_u32 s29, s3, 0
    s_lshl_b32 s30, s29, 12
    s_add_u32 s30, s30, s25
    s_cmp_lt_u32 s29, s27
    s_cselect_b32 s30, s30, 0x7f000000
    s_mov_b64 exec, 0xffffffff
    buffer_load_dword v248, v247, s[80:83], s30 offen sc1
    s_mov_b64 exec, -1
    v_mfma_f32_16x16x32_bf16 v[48:51], v[132:135], v[160:163], v[48:51]
    ds_read_b64_tr_b16 v[108:109], v237 offset:43200
    v_add_f32 v178, v178, v186
    v_add_f32 v179, v179, v187
    v_add_f32 v180, v180, v188
    v_mfma_f32_16x16x32_bf16 v[16:19], v[124:127], v[160:163], v[16:19]
    ds_read_b64_tr_b16 v[110:111], v237 offset:46784
    v_add_f32 v181, v181, v189
    v_add_f32 v182, v182, v190
    v_mfma_f32_16x16x32_bf16 v[20:23], v[124:127], v[164:167], v[20:23]
    v_add_f32 v183, v183, v191
    v_add_f32 v176, v176, v180
    v_add_f32 v177, v177, v181
    v_mfma_f32_16x16x32_bf16 v[24:27], v[124:127], v[168:171], v[24:27]
    ds_read_b64_tr_b16 v[100:101], v237 offset:28832
    v_add_f32 v178, v178, v182
    v_add_f32 v179, v179, v183
    v_mfma_f32_16x16x32_bf16 v[28:31], v[124:127], v[172:175], v[28:31]
    ds_read_b64_tr_b16 v[102:103], v237 offset:32416
    v_mov_b32 v180, v176
    v_mov_b32 v181, v177
    v_mov_b32 v182, v178
    v_mfma_f32_16x16x32_bf16 v[76:79], v[136:139], v[172:175], v[76:79]
    ds_read_b64_tr_b16 v[112:113], v237 offset:43232
    v_mov_b32 v183, v179
    s_nop 1
    v_permlane32_swap_b32 v176, v180
    v_mfma_f32_16x16x32_bf16 v[72:75], v[136:139], v[168:171], v[72:75]
    ds_read_b64_tr_b16 v[114:115], v237 offset:46816
    v_permlane32_swap_b32 v177, v181
    v_permlane32_swap_b32 v178, v182
    v_mfma_f32_16x16x32_bf16 v[68:71], v[136:139], v[164:167], v[68:71]
    v_permlane32_swap_b32 v179, v183
    v_add_f32 v176, v176, v180
    v_add_f32 v177, v177, v181
    v_mfma_f32_16x16x32_bf16 v[64:67], v[136:139], v[160:163], v[64:67]
    ds_read_b64_tr_b16 v[104:105], v239 offset:28800
    v_add_f32 v178, v178, v182
    v_add_f32 v179, v179, v183
    v_mfma_f32_16x16x32_bf16 v[32:35], v[128:131], v[160:163], v[32:35]
    ds_read_b64_tr_b16 v[106:107], v239 offset:32384
    s_and_b32 s64, s3, 1
    s_mul_i32 s64, s64, 896
    s_lshr_b32 s65, s69, 1
    s_mul_i32 s65, s65, 448
    s_add_u32 s64, s64, s65
    s_add_u32 s64, s64, 160896
    v_add_u32 v225, s64, v249
    s_cmp_lg_u32 s75, 0
    s_cbranch_scc1 g3c1_ncs
    s_mov_b64 exec, 0x0fffffff
    ds_write_b128 v225, v[176:179]
    s_mov_b64 exec, -1
g3c1_ncs:
    s_mov_b32 s12, s96
    s_mov_b32 s13, s97
    v_mfma_f32_16x16x32_bf16 v[36:39], v[128:131], v[164:167], v[36:39]
    ds_read_b64_tr_b16 v[116:117], v239 offset:43200
    s_mov_b32 s14, 7340032
    s_mov_b32 s15, 0x00020000
    v_mfma_f32_16x16x32_bf16 v[40:43], v[128:131], v[168:171], v[40:43]
    ds_read_b64_tr_b16 v[118:119], v239 offset:46784
    v_lshlrev_b32 v253, 14, v251
    v_and_b32 v254, 8, v252
    v_lshl_add_u32 v253, v254, 7, v253
    v_mfma_f32_16x16x32_bf16 v[44:47], v[128:131], v[172:175], v[44:47]
    v_and_b32 v254, 7, v252
    v_lshl_add_u32 v253, v254, 4, v253
    v_mfma_f32_16x16x32_bf16 v[92:95], v[140:143], v[172:175], v[92:95]
    s_lshl_b32 s64, s69, 12
    v_add_u32 v244, s64, v253
    v_add_u32 v245, 2048, v244
    v_lshlrev_b32 v247, 7, v250
    s_add_u32 s29, s3, 8
    s_lshl_b32 s30, s29, 12
    s_add_u32 s30, s30, s25
    s_cmp_lt_u32 s29, s27
    s_cselect_b32 s30, s30, 0x7f000000
    s_mov_b64 exec, 0xffffffff
    buffer_load_dword v248, v247, s[80:83], s30 offen sc1
    s_mov_b64 exec, -1
    v_mfma_f32_16x16x32_bf16 v[88:91], v[140:143], v[168:171], v[88:91]
    s_mul_i32 s51, s69, 2112
    s_lshr_b32 s64, s74, 3
    v_mfma_f32_16x16x32_bf16 v[84:87], v[140:143], v[164:167], v[84:87]
    s_mul_i32 s49, s64, 3670016
    s_lshl_b32 s65, s61, 7
    s_add_u32 s49, s49, s65
    v_mfma_f32_16x16x32_bf16 v[80:83], v[140:143], v[160:163], v[80:83]
    s_sub_u32 s50, s74, s58
    s_and_b32 s50, s50, 7
    s_waitcnt vmcnt(2) lgkmcnt(0)
    s_barrier
    s_setprio 1
    ds_read_b128 v[160:163], v235 offset:24576
    ds_read_b128 v[164:167], v235 offset:25600
    ds_read_b128 v[168:171], v235 offset:26624
    ds_read_b128 v[172:175], v235 offset:27648
    ds_read_b64_tr_b16 v[120:121], v236 offset:0
    ds_read_b64_tr_b16 v[122:123], v236 offset:3584
    ds_read_b64_tr_b16 v[132:133], v236 offset:14400
    ds_read_b64_tr_b16 v[134:135], v236 offset:17984
    ds_read_b64_tr_b16 v[124:125], v236 offset:32
    ds_read_b64_tr_b16 v[126:127], v236 offset:3616
    ds_read_b64_tr_b16 v[136:137], v236 offset:14432
    ds_read_b64_tr_b16 v[138:139], v236 offset:18016
    ds_read_b64_tr_b16 v[128:129], v238 offset:0
    ds_read_b64_tr_b16 v[130:131], v238 offset:3584
    ds_read_b64_tr_b16 v[140:141], v238 offset:14400
    ds_read_b64_tr_b16 v[142:143], v238 offset:17984
    s_waitcnt lgkmcnt(0)
    s_and_b32 s48, s74, 7
    s_mul_i32 s48, s48, 458752
    s_add_u32 s48, s48, s49
    s_add_u32 m0, s51, 107776
    s_nop 0
    buffer_load_dwordx4 v244, s[12:15], s48 offen lds
    s_add_u32 m0, s51, 108832
    s_nop 0
    buffer_load_dwordx4 v245, s[12:15], s48 offen lds
    s_add_u32 s48, s48, 65536
    s_barrier
    s_add_u32 m0, s51, 116224
    s_nop 0
    buffer_load_dwordx4 v244, s[12:15], s48 offen lds
    s_add_u32 m0, s51, 117280
    s_nop 0
    buffer_load_dwordx4 v245, s[12:15], s48 offen lds
    s_add_u32 s48, s48, 65536
    s_add_u32 m0, s51, 124672
    s_nop 0
    buffer_load_dwordx4 v244, s[12:15], s48 offen lds
    s_add_u32 m0, s51, 125728
    s_nop 0
    buffer_load_dwordx4 v245, s[12:15], s48 offen lds
    s_add_u32 s48, s48, 65536
    s_add_u32 m0, s51, 133120
    s_nop 0
    buffer_load_dwordx4 v244, s[12:15], s48 offen lds
    s_add_u32 m0, s51, 134176
    s_nop 0
    buffer_load_dwordx4 v245, s[12:15], s48 offen lds
    s_add_u32 s48, s48, 65536
    v_mfma_f32_16x16x32_bf16 v[0:3], v[96:99], v[144:147], v[0:3]
    s_add_u32 m0, s51, 141568
    s_nop 0
    buffer_load_dwordx4 v244, s[12:15], s48 offen lds
    v_mfma_f32_16x16x32_bf16 v[4:7], v[96:99], v[148:151], v[4:7]
    v_mfma_f32_16x16x32_bf16 v[8:11], v[96:99], v[152:155], v[8:11]
    v_mfma_f32_16x16x32_bf16 v[12:15], v[96:99], v[156:159], v[12:15]
    v_mfma_f32_16x16x32_bf16 v[60:63], v[108:111], v[156:159], v[60:63]
    s_add_u32 m0, s51, 142624
    s_nop 0
    buffer_load_dwordx4 v245, s[12:15], s48 offen lds
    s_add_u32 s48, s48, 65536
    v_mfma_f32_16x16x32_bf16 v[56:59], v[108:111], v[152:155], v[56:59]
    v_mfma_f32_16x16x32_bf16 v[52:55], v[108:111], v[148:151], v[52:55]
    v_mfma_f32_16x16x32_bf16 v[48:51], v[108:111], v[144:147], v[48:51]
    v_mfma_f32_16x16x32_bf16 v[16:19], v[100:103], v[144:147], v[16:19]
    s_add_u32 m0, s51, 65536
    s_nop 0
    buffer_load_dwordx4 v244, s[12:15], s48 offen lds
    v_mfma_f32_16x16x32_bf16 v[20:23], v[100:103], v[148:151], v[20:23]
    v_mfma_f32_16x16x32_bf16 v[24:27], v[100:103], v[152:155], v[24:27]
    v_mfma_f32_16x16x32_bf16 v[28:31], v[100:103], v[156:159], v[28:31]
    v_mfma_f32_16x16x32_bf16 v[76:79], v[112:115], v[156:159], v[76:79]
    s_add_u32 m0, s51, 66592
    s_nop 0
    buffer_load_dwordx4 v245, s[12:15], s48 offen lds
    s_add_u32 s48, s48, 65536
    v_mfma_f32_16x16x32_bf16 v[72:75], v[112:115], v[152:155], v[72:75]
    v_mfma_f32_16x16x32_bf16 v[68:71], v[112:115], v[148:151], v[68:71]
    v_mfma_f32_16x16x32_bf16 v[64:67], v[112:115], v[144:147], v[64:67]
    v_mfma_f32_16x16x32_bf16 v[32:35], v[104:107], v[144:147], v[32:35]
    s_add_u32 m0, s51, 73984
    s_nop 0
    buffer_load_dwordx4 v244, s[12:15], s48 offen lds
    v_mfma_f32_16x16x32_bf16 v[36:39], v[104:107], v[148:151], v[36:39]
    v_mfma_f32_16x16x32_bf16 v[40:43], v[104:107], v[152:155], v[40:43]
    v_mfma_f32_16x16x32_bf16 v[44:47], v[104:107], v[156:159], v[44:47]
    v_mfma_f32_16x16x32_bf16 v[92:95], v[116:119], v[156:159], v[92:95]
    s_add_u32 m0, s51, 75040
    s_nop 0
    buffer_load_dwordx4 v245, s[12:15], s48 offen lds
    s_add_u32 s48, s48, 65536
    v_mfma_f32_16x16x32_bf16 v[88:91], v[116:119], v[152:155], v[88:91]
    v_mfma_f32_16x16x32_bf16 v[84:87], v[116:119], v[148:151], v[84:87]
    v_mfma_f32_16x16x32_bf16 v[80:83], v[116:119], v[144:147], v[80:83]
    s_and_b32 s64, s3, 1
    s_lshl_b32 s64, s64, 9
    s_add_u32 s64, s64, 159744
    v_lshlrev_b32 v253, 3, v252
    v_add_u32 v253, s64, v253
    s_lshl_b32 s64, s28, 6
    s_add_u32 s64, s64, 160896
    v_lshlrev_b32 v254, 4, v251
    v_add_u32 v235, s64, v254
    s_lshr_b32 s64, s69, 1
    s_add_u32 s64, s64, 10
    s_lshl_b32 s64, s64, 6
    s_add_u32 s64, s64, 160896
    v_add_u32 v238, s64, v254
    v_mfma_f32_16x16x32_bf16 v[0:3], v[120:123], v[160:163], v[0:3]
    ds_read_b64 v[144:145], v253 offset:0
    s_cmp_le_u32 s50, 0
    s_addc_u32 s48, s58, 0
    s_and_b32 s48, s48, 7
    s_mul_i32 s48, s48, 458752
    s_add_u32 s48, s48, s49
    s_add_u32 m0, s51, 82432
    s_nop 0
    buffer_load_dwordx4 v244, s[12:15], s48 offen lds
    v_mfma_f32_16x16x32_bf16 v[4:7], v[120:123], v[164:167], v[4:7]
    ds_read_b64 v[146:147], v253 offset:128
    v_mfma_f32_16x16x32_bf16 v[8:11], v[120:123], v[168:171], v[8:11]
    ds_read_b64 v[148:149], v253 offset:256
    v_mfma_f32_16x16x32_bf16 v[12:15], v[120:123], v[172:175], v[12:15]
    ds_read_b64 v[150:151], v253 offset:384
    s_add_u32 m0, s51, 83488
    s_nop 0
    buffer_load_dwordx4 v245, s[12:15], s48 offen lds
    s_add_u32 s48, s48, 65536
    v_mfma_f32_16x16x32_bf16 v[60:63], v[132:135], v[172:175], v[60:63]
    v_mfma_f32_16x16x32_bf16 v[56:59], v[132:135], v[168:171], v[56:59]
    ds_read_b128 v[96:99], v235 offset:0
    v_mfma_f32_16x16x32_bf16 v[52:55], v[132:135], v[164:167], v[52:55]
    ds_read_b128 v[100:103], v235 offset:64
    v_mfma_f32_16x16x32_bf16 v[48:51], v[132:135], v[160:163], v[48:51]
    ds_read_b128 v[104:107], v238 offset:0
    s_add_u32 m0, s51, 90880
    s_nop 0
    buffer_load_dwordx4 v244, s[12:15], s48 offen lds
    v_mfma_f32_16x16x32_bf16 v[16:19], v[124:127], v[160:163], v[16:19]
    v_mfma_f32_16x16x32_bf16 v[20:23], v[124:127], v[164:167], v[20:23]
    ds_read_b128 v[108:111], v235 offset:896
    v_mfma_f32_16x16x32_bf16 v[24:27], v[124:127], v[168:171], v[24:27]
    ds_read_b128 v[112:115], v235 offset:960
    v_mfma_f32_16x16x32_bf16 v[28:31], v[124:127], v[172:175], v[28:31]
    ds_read_b128 v[116:119], v238 offset:896
    s_add_u32 m0, s51, 91936
    s_nop 0
    buffer_load_dwordx4 v245, s[12:15], s48 offen lds
    s_add_u32 s48, s48, 65536
    v_mfma_f32_16x16x32_bf16 v[76:79], v[136:139], v[172:175], v[76:79]
    v_mfma_f32_16x16x32_bf16 v[72:75], v[136:139], v[168:171], v[72:75]
    v_mfma_f32_16x16x32_bf16 v[68:71], v[136:139], v[164:167], v[68:71]
    v_mfma_f32_16x16x32_bf16 v[64:67], v[136:139], v[160:163], v[64:67]
    s_add_u32 m0, s51, 99328
    s_nop 0
    buffer_load_dwordx4 v244, s[12:15], s48 offen lds
    v_mfma_f32_16x16x32_bf16 v[32:35], v[128:131], v[160:163], v[32:35]
    v_mfma_f32_16x16x32_bf16 v[36:39], v[128:131], v[164:167], v[36:39]
    v_mfma_f32_16x16x32_bf16 v[40:43], v[128:131], v[168:171], v[40:43]
    v_mfma_f32_16x16x32_bf16 v[44:47], v[128:131], v[172:175], v[44:47]
    s_add_u32 m0, s51, 100384
    s_nop 0
    buffer_load_dwordx4 v245, s[12:15], s48 offen lds
    s_add_u32 s48, s48, 65536
    v_mfma_f32_16x16x32_bf16 v[92:95], v[140:143], v[172:175], v[92:95]
    v_mfma_f32_16x16x32_bf16 v[88:91], v[140:143], v[168:171], v[88:91]
    v_mfma_f32_16x16x32_bf16 v[84:87], v[140:143], v[164:167], v[84:87]
    v_mfma_f32_16x16x32_bf16 v[80:83], v[140:143], v[160:163], v[80:83]
    s_and_b32 s64, s3, 1
    s_lshl_b32 s64, s64, 12
    s_add_u32 s25, s25, s64
    s_lshr_b32 s64, s69, 1
    s_lshl_b32 s65, s64, 3
    s_add_u32 s26, s25, s65
    s_add_u32 s26, s26, 40960
    s_lshl_b32 s64, s64, 14
    s_add_u32 s25, s25, s64
    s_add_u32 s25, s25, 32768
    s_and_b32 s64, s3, 1
    s_lshl_b32 s64, s64, 12
    s_lshr_b32 s65, s69, 1
    s_lshl_b32 s66, s65, 3
    s_add_u32 s66, s66, s64
    s_add_u32 s66, s66, 32768
    v_add_u32 v237, s66, v249
    s_lshl_b32 s65, s65, 14
    s_add_u32 s64, s64, s65
    s_add_u32 s64, s64, 24576
    v_add_u32 v236, s64, v249
    s_waitcnt lgkmcnt(0)
    s_mov_b32 s64, 0xbfb8aa3b
    v_mul_f32 v136, v145, v145
    v_sub_f32 v120, 0, v144
    v_mul_f32 v128, s64, v145
    v_sub_f32 v121, 0, v144
    v_mul_f32 v129, s64, v145
    v_mul_f32 v138, v147, v147
    v_sub_f32 v122, 0, v146
    v_mul_f32 v130, s64, v147
    v_sub_f32 v123, 0, v146
    v_mul_f32 v131, s64, v147
    v_mul_f32 v140, v149, v149
    v_sub_f32 v124, 0, v148
    v_mul_f32 v132, s64, v149
    v_sub_f32 v125, 0, v148
    v_mul_f32 v133, s64, v149
    v_mul_f32 v142, v151, v151
    v_sub_f32 v126, 0, v150
    v_mul_f32 v134, s64, v151
    v_sub_f32 v127, 0, v150
    v_mul_f32 v135, s64, v151
    v_rcp_f32 v137, v136
    v_rcp_f32 v136, v136
    v_rcp_f32 v139, v138
    v_rcp_f32 v138, v138
    v_rcp_f32 v141, v140
    v_rcp_f32 v140, v140
    v_rcp_f32 v143, v142
    v_rcp_f32 v142, v142
    v_pk_fma_f32 v[0:1], v[120:121], v[96:97], v[0:1]
    v_pk_fma_f32 v[2:3], v[120:121], v[98:99], v[2:3]
    v_pk_fma_f32 v[16:17], v[120:121], v[100:101], v[16:17]
    v_pk_fma_f32 v[18:19], v[120:121], v[102:103], v[18:19]
    v_pk_fma_f32 v[32:33], v[120:121], v[104:105], v[32:33]
    v_pk_fma_f32 v[34:35], v[120:121], v[106:107], v[34:35]
    v_pk_mul_f32 v[152:153], v[128:129], v[0:1]
    v_pk_mul_f32 v[154:155], v[128:129], v[2:3]
    v_pk_mul_f32 v[156:157], v[128:129], v[16:17]
    v_pk_mul_f32 v[158:159], v[128:129], v[18:19]
    v_pk_mul_f32 v[160:161], v[128:129], v[32:33]
    v_pk_mul_f32 v[162:163], v[128:129], v[34:35]
    v_exp_f32 v152, v152
    v_exp_f32 v153, v153
    v_exp_f32 v154, v154
    v_exp_f32 v155, v155
    v_exp_f32 v156, v156
    v_exp_f32 v157, v157
    v_exp_f32 v158, v158
    v_exp_f32 v159, v159
    v_exp_f32 v160, v160
    v_exp_f32 v161, v161
    v_exp_f32 v162, v162
    v_exp_f32 v163, v163
    v_pk_fma_f32 v[48:49], v[120:121], v[108:109], v[48:49]
    v_pk_fma_f32 v[50:51], v[120:121], v[110:111], v[50:51]
    v_pk_fma_f32 v[64:65], v[120:121], v[112:113], v[64:65]
    v_pk_fma_f32 v[66:67], v[120:121], v[114:115], v[66:67]
    v_pk_fma_f32 v[80:81], v[120:121], v[116:117], v[80:81]
    v_pk_fma_f32 v[82:83], v[120:121], v[118:119], v[82:83]
    v_pk_fma_f32 v[152:153], v[152:153], v[136:137], v[136:137]
    v_pk_fma_f32 v[154:155], v[154:155], v[136:137], v[136:137]
    v_pk_fma_f32 v[156:157], v[156:157], v[136:137], v[136:137]
    v_pk_fma_f32 v[158:159], v[158:159], v[136:137], v[136:137]
    v_pk_fma_f32 v[160:161], v[160:161], v[136:137], v[136:137]
    v_pk_fma_f32 v[162:163], v[162:163], v[136:137], v[136:137]
    v_rcp_f32 v152, v152
    v_rcp_f32 v153, v153
    v_rcp_f32 v154, v154
    v_rcp_f32 v155, v155
    v_rcp_f32 v156, v156
    v_rcp_f32 v157, v157
    v_rcp_f32 v158, v158
    v_rcp_f32 v159, v159
    v_rcp_f32 v160, v160
    v_rcp_f32 v161, v161
    v_rcp_f32 v162, v162
    v_rcp_f32 v163, v163
    v_pk_mul_f32 v[0:1], v[0:1], v[48:49]
    v_pk_mul_f32 v[2:3], v[2:3], v[50:51]
    v_pk_mul_f32 v[16:17], v[16:17], v[64:65]
    v_pk_mul_f32 v[18:19], v[18:19], v[66:67]
    v_pk_mul_f32 v[32:33], v[32:33], v[80:81]
    v_pk_mul_f32 v[34:35], v[34:35], v[82:83]
    v_pk_mul_f32 v[0:1], v[0:1], v[152:153]
    v_pk_mul_f32 v[2:3], v[2:3], v[154:155]
    v_pk_mul_f32 v[16:17], v[16:17], v[156:157]
    v_pk_mul_f32 v[18:19], v[18:19], v[158:159]
    v_pk_mul_f32 v[32:33], v[32:33], v[160:161]
    v_pk_mul_f32 v[34:35], v[34:35], v[162:163]
    v_cvt_pk_bf16_f32 v168, v0, v1
    v_cvt_pk_bf16_f32 v169, v2, v3
    v_cvt_pk_bf16_f32 v170, v16, v17
    v_cvt_pk_bf16_f32 v171, v18, v19
    v_cvt_pk_bf16_f32 v172, v32, v33
    v_cvt_pk_bf16_f32 v173, v34, v35
    buffer_store_dwordx4 v[168:171], v249, s[80:83], s25 offen offset:0
    ds_write_b128 v236, v[168:171] offset:0
    buffer_store_dwordx2 v[172:173], v249, s[80:83], s26 offen offset:0
    ds_write_b64 v237, v[172:173] offset:0
    v_pk_fma_f32 v[4:5], v[122:123], v[96:97], v[4:5]
    v_pk_fma_f32 v[6:7], v[122:123], v[98:99], v[6:7]
    v_pk_fma_f32 v[20:21], v[122:123], v[100:101], v[20:21]
    v_pk_fma_f32 v[22:23], v[122:123], v[102:103], v[22:23]
    v_pk_fma_f32 v[36:37], v[122:123], v[104:105], v[36:37]
    v_pk_fma_f32 v[38:39], v[122:123], v[106:107], v[38:39]
    v_pk_mul_f32 v[152:153], v[130:131], v[4:5]
    v_pk_mul_f32 v[154:155], v[130:131], v[6:7]
    v_pk_mul_f32 v[156:157], v[130:131], v[20:21]
    v_pk_mul_f32 v[158:159], v[130:131], v[22:23]
    v_pk_mul_f32 v[160:161], v[130:131], v[36:37]
    v_pk_mul_f32 v[162:163], v[130:131], v[38:39]
    v_exp_f32 v152, v152
    v_exp_f32 v153, v153
    v_exp_f32 v154, v154
    v_exp_f32 v155, v155
    v_exp_f32 v156, v156
    v_exp_f32 v157, v157
    v_exp_f32 v158, v158
    v_exp_f32 v159, v159
    v_exp_f32 v160, v160
    v_exp_f32 v161, v161
    v_exp_f32 v162, v162
    v_exp_f32 v163, v163
    v_pk_fma_f32 v[52:53], v[122:123], v[108:109], v[52:53]
    v_pk_fma_f32 v[54:55], v[122:123], v[110:111], v[54:55]
    v_pk_fma_f32 v[68:69], v[122:123], v[112:113], v[68:69]
    v_pk_fma_f32 v[70:71], v[122:123], v[114:115], v[70:71]
    v_pk_fma_f32 v[84:85], v[122:123], v[116:117], v[84:85]
    v_pk_fma_f32 v[86:87], v[122:123], v[118:119], v[86:87]
    v_pk_fma_f32 v[152:153], v[152:153], v[138:139], v[138:139]
    v_pk_fma_f32 v[154:155], v[154:155], v[138:139], v[138:139]
    v_pk_fma_f32 v[156:157], v[156:157], v[138:139], v[138:139]
    v_pk_fma_f32 v[158:159], v[158:159], v[138:139], v[138:139]
    v_pk_fma_f32 v[160:161], v[160:161], v[138:139], v[138:139]
    v_pk_fma_f32 v[162:163], v[162:163], v[138:139], v[138:139]
    v_rcp_f32 v152, v152
    v_rcp_f32 v153, v153
    v_rcp_f32 v154, v154
    v_rcp_f32 v155, v155
    v_rcp_f32 v156, v156
    v_rcp_f32 v157, v157
    v_rcp_f32 v158, v158
    v_rcp_f32 v159, v159
    v_rcp_f32 v160, v160
    v_rcp_f32 v161, v161
    v_rcp_f32 v162, v162
    v_rcp_f32 v163, v163
    v_pk_mul_f32 v[4:5], v[4:5], v[52:53]
    v_pk_mul_f32 v[6:7], v[6:7], v[54:55]
    v_pk_mul_f32 v[20:21], v[20:21], v[68:69]
    v_pk_mul_f32 v[22:23], v[22:23], v[70:71]
    v_pk_mul_f32 v[36:37], v[36:37], v[84:85]
    v_pk_mul_f32 v[38:39], v[38:39], v[86:87]
    v_pk_mul_f32 v[4:5], v[4:5], v[152:153]
    v_pk_mul_f32 v[6:7], v[6:7], v[154:155]
    v_pk_mul_f32 v[20:21], v[20:21], v[156:157]
    v_pk_mul_f32 v[22:23], v[22:23], v[158:159]
    v_pk_mul_f32 v[36:37], v[36:37], v[160:161]
    v_pk_mul_f32 v[38:39], v[38:39], v[162:163]
    v_cvt_pk_bf16_f32 v168, v4, v5
    v_cvt_pk_bf16_f32 v169, v6, v7
    v_cvt_pk_bf16_f32 v170, v20, v21
    v_cvt_pk_bf16_f32 v171, v22, v23
    v_cvt_pk_bf16_f32 v172, v36, v37
    v_cvt_pk_bf16_f32 v173, v38, v39
    buffer_store_dwordx4 v[168:171], v249, s[80:83], s25 offen offset:1024
    ds_write_b128 v236, v[168:171] offset:1024
    buffer_store_dwordx2 v[172:173], v249, s[80:83], s26 offen offset:1024
    ds_write_b64 v237, v[172:173] offset:1024
    v_pk_fma_f32 v[8:9], v[124:125], v[96:97], v[8:9]
    v_pk_fma_f32 v[10:11], v[124:125], v[98:99], v[10:11]
    v_pk_fma_f32 v[24:25], v[124:125], v[100:101], v[24:25]
    v_pk_fma_f32 v[26:27], v[124:125], v[102:103], v[26:27]
    v_pk_fma_f32 v[40:41], v[124:125], v[104:105], v[40:41]
    v_pk_fma_f32 v[42:43], v[124:125], v[106:107], v[42:43]
    v_pk_mul_f32 v[152:153], v[132:133], v[8:9]
    v_pk_mul_f32 v[154:155], v[132:133], v[10:11]
    v_pk_mul_f32 v[156:157], v[132:133], v[24:25]
    v_pk_mul_f32 v[158:159], v[132:133], v[26:27]
    v_pk_mul_f32 v[160:161], v[132:133], v[40:41]
    v_pk_mul_f32 v[162:163], v[132:133], v[42:43]
    v_exp_f32 v152, v152
    v_exp_f32 v153, v153
    v_exp_f32 v154, v154
    v_exp_f32 v155, v155
    v_exp_f32 v156, v156
    v_exp_f32 v157, v157
    v_exp_f32 v158, v158
    v_exp_f32 v159, v159
    v_exp_f32 v160, v160
    v_exp_f32 v161, v161
    v_exp_f32 v162, v162
    v_exp_f32 v163, v163
    v_pk_fma_f32 v[56:57], v[124:125], v[108:109], v[56:57]
    v_pk_fma_f32 v[58:59], v[124:125], v[110:111], v[58:59]
    v_pk_fma_f32 v[72:73], v[124:125], v[112:113], v[72:73]
    v_pk_fma_f32 v[74:75], v[124:125], v[114:115], v[74:75]
    v_pk_fma_f32 v[88:89], v[124:125], v[116:117], v[88:89]
    v_pk_fma_f32 v[90:91], v[124:125], v[118:119], v[90:91]
    v_pk_fma_f32 v[152:153], v[152:153], v[140:141], v[140:141]
    v_pk_fma_f32 v[154:155], v[154:155], v[140:141], v[140:141]
    v_pk_fma_f32 v[156:157], v[156:157], v[140:141], v[140:141]
    v_pk_fma_f32 v[158:159], v[158:159], v[140:141], v[140:141]
    v_pk_fma_f32 v[160:161], v[160:161], v[140:141], v[140:141]
    v_pk_fma_f32 v[162:163], v[162:163], v[140:141], v[140:141]
    v_rcp_f32 v152, v152
    v_rcp_f32 v153, v153
    v_rcp_f32 v154, v154
    v_rcp_f32 v155, v155
    v_rcp_f32 v156, v156
    v_rcp_f32 v157, v157
    v_rcp_f32 v158, v158
    v_rcp_f32 v159, v159
    v_rcp_f32 v160, v160
    v_rcp_f32 v161, v161
    v_rcp_f32 v162, v162
    v_rcp_f32 v163, v163
    v_pk_mul_f32 v[8:9], v[8:9], v[56:57]
    v_pk_mul_f32 v[10:11], v[10:11], v[58:59]
    v_pk_mul_f32 v[24:25], v[24:25], v[72:73]
    v_pk_mul_f32 v[26:27], v[26:27], v[74:75]
    v_pk_mul_f32 v[40:41], v[40:41], v[88:89]
    v_pk_mul_f32 v[42:43], v[42:43], v[90:91]
    v_pk_mul_f32 v[8:9], v[8:9], v[152:153]
    v_pk_mul_f32 v[10:11], v[10:11], v[154:155]
    v_pk_mul_f32 v[24:25], v[24:25], v[156:157]
    v_pk_mul_f32 v[26:27], v[26:27], v[158:159]
    v_pk_mul_f32 v[40:41], v[40:41], v[160:161]
    v_pk_mul_f32 v[42:43], v[42:43], v[162:163]
    v_cvt_pk_bf16_f32 v168, v8, v9
    v_cvt_pk_bf16_f32 v169, v10, v11
    v_cvt_pk_bf16_f32 v170, v24, v25
    v_cvt_pk_bf16_f32 v171, v26, v27
    v_cvt_pk_bf16_f32 v172, v40, v41
    v_cvt_pk_bf16_f32 v173, v42, v43
    buffer_store_dwordx4 v[168:171], v249, s[80:83], s25 offen offset:2048
    ds_write_b128 v236, v[168:171] offset:2048
    buffer_store_dwordx2 v[172:173], v249, s[80:83], s26 offen offset:2048
    ds_write_b64 v237, v[172:173] offset:2048
    v_pk_fma_f32 v[12:13], v[126:127], v[96:97], v[12:13]
    v_pk_fma_f32 v[14:15], v[126:127], v[98:99], v[14:15]
    v_pk_fma_f32 v[28:29], v[126:127], v[100:101], v[28:29]
    v_pk_fma_f32 v[30:31], v[126:127], v[102:103], v[30:31]
    v_pk_fma_f32 v[44:45], v[126:127], v[104:105], v[44:45]
    v_pk_fma_f32 v[46:47], v[126:127], v[106:107], v[46:47]
    v_pk_mul_f32 v[152:153], v[134:135], v[12:13]
    v_pk_mul_f32 v[154:155], v[134:135], v[14:15]
    v_pk_mul_f32 v[156:157], v[134:135], v[28:29]
    v_pk_mul_f32 v[158:159], v[134:135], v[30:31]
    v_pk_mul_f32 v[160:161], v[134:135], v[44:45]
    v_pk_mul_f32 v[162:163], v[134:135], v[46:47]
    v_exp_f32 v152, v152
    v_exp_f32 v153, v153
    v_exp_f32 v154, v154
    v_exp_f32 v155, v155
    v_exp_f32 v156, v156
    v_exp_f32 v157, v157
    v_exp_f32 v158, v158
    v_exp_f32 v159, v159
    v_exp_f32 v160, v160
    v_exp_f32 v161, v161
    v_exp_f32 v162, v162
    v_exp_f32 v163, v163
    v_pk_fma_f32 v[60:61], v[126:127], v[108:109], v[60:61]
    v_pk_fma_f32 v[62:63], v[126:127], v[110:111], v[62:63]
    v_pk_fma_f32 v[76:77], v[126:127], v[112:113], v[76:77]
    v_pk_fma_f32 v[78:79], v[126:127], v[114:115], v[78:79]
    v_pk_fma_f32 v[92:93], v[126:127], v[116:117], v[92:93]
    v_pk_fma_f32 v[94:95], v[126:127], v[118:119], v[94:95]
    v_pk_fma_f32 v[152:153], v[152:153], v[142:143], v[142:143]
    v_pk_fma_f32 v[154:155], v[154:155], v[142:143], v[142:143]
    v_pk_fma_f32 v[156:157], v[156:157], v[142:143], v[142:143]
    v_pk_fma_f32 v[158:159], v[158:159], v[142:143], v[142:143]
    v_pk_fma_f32 v[160:161], v[160:161], v[142:143], v[142:143]
    v_pk_fma_f32 v[162:163], v[162:163], v[142:143], v[142:143]
    v_rcp_f32 v152, v152
    v_rcp_f32 v153, v153
    v_rcp_f32 v154, v154
    v_rcp_f32 v155, v155
    v_rcp_f32 v156, v156
    v_rcp_f32 v157, v157
    v_rcp_f32 v158, v158
    v_rcp_f32 v159, v159
    v_rcp_f32 v160, v160
    v_rcp_f32 v161, v161
    v_rcp_f32 v162, v162
    v_rcp_f32 v163, v163
    v_pk_mul_f32 v[12:13], v[12:13], v[60:61]
    v_pk_mul_f32 v[14:15], v[14:15], v[62:63]
    v_pk_mul_f32 v[28:29], v[28:29], v[76:77]
    v_pk_mul_f32 v[30:31], v[30:31], v[78:79]
    v_pk_mul_f32 v[44:45], v[44:45], v[92:93]
    v_pk_mul_f32 v[46:47], v[46:47], v[94:95]
    v_pk_mul_f32 v[12:13], v[12:13], v[152:153]
    v_pk_mul_f32 v[14:15], v[14:15], v[154:155]
    v_pk_mul_f32 v[28:29], v[28:29], v[156:157]
    v_pk_mul_f32 v[30:31], v[30:31], v[158:159]
    v_pk_mul_f32 v[44:45], v[44:45], v[160:161]
    v_pk_mul_f32 v[46:47], v[46:47], v[162:163]
    v_cvt_pk_bf16_f32 v168, v12, v13
    v_cvt_pk_bf16_f32 v169, v14, v15
    v_cvt_pk_bf16_f32 v170, v28, v29
    v_cvt_pk_bf16_f32 v171, v30, v31
    v_cvt_pk_bf16_f32 v172, v44, v45
    v_cvt_pk_bf16_f32 v173, v46, v47
    buffer_store_dwordx4 v[168:171], v249, s[80:83], s25 offen offset:3072
    ds_write_b128 v236, v[168:171] offset:3072
    buffer_store_dwordx2 v[172:173], v249, s[80:83], s26 offen offset:3072
    ds_write_b64 v237, v[172:173] offset:3072
    s_lshl_b32 s64, s75, 15
    s_lshl_b32 s66, s73, 9
    s_add_u32 s64, s64, s66
    s_add_u32 s64, s64, 75513856
    s_lshl_b32 s65, s72, 5
    s_add_u32 s64, s64, s65
    s_lshl_b32 s65, s3, 2
    s_add_u32 s64, s64, s65
    v_mov_b32 v144, 0
    v_mov_b32 v145, 1
    s_cmp_lg_u32 s78, 0
    s_cbranch_scc1 sg_3161_slow
    s_waitcnt vmcnt(0)
    s_mov_b64 exec, 1
    buffer_store_dword v145, v144, s[80:83], s64 offen
    s_mov_b64 exec, -1
sg_3161_done:
    s_setprio 3
    s_mov_b32 s8, s86
    s_mov_b32 s9, s87
    s_mov_b32 s10, 6291456
    s_mov_b32 s11, 0x00020000
    v_lshrrev_b32 v253, 3, v250
    v_lshlrev_b32 v253, 2, v253
    v_add_u32 v253, s69, v253
    v_mul_u32_u24 v253, 6144, v253
    v_and_b32 v254, 7, v250
    v_lshl_add_u32 v10, v254, 4, v253
    v_add_u32 v11, 2048, v10
    v_add_u32 v12, 4096, v10
    s_mul_i32 s19, s69, 3104
    s_lshl_b32 s17, s74, 7
    s_add_u32 s18, s17, 6291456
    s_mov_b32 s64, s57
    s_mul_i32 s64, s64, 393216
    s_add_u32 s16, s17, s64
    s_lshl_b32 s53, s73, 1
    s_add_u32 s53, s53, s68
    s_mul_i32 s53, s53, 458752
    s_lshl_b32 s66, s60, 24
    s_add_u32 s53, s53, s66
    s_add_u32 s53, s53, 20971520
    s_lshl_b32 s55, s69, 11
    s_add_u32 s53, s53, s55
    s_lshl_b32 s56, s75, 15
    s_lshl_b32 s66, s73, 9
    s_add_u32 s56, s56, s66
    s_add_u32 s56, s56, 75513856
    v_lshlrev_b32 v246, 4, v250
    s_lshl_b32 s64, s68, 1
    s_lshl_b32 s62, 0x33333333, s64
    s_mov_b32 s63, 0
    s_lshr_b32 s40, s2, 3
    s_lshl_b32 s40, s40, 2
    s_add_u32 s40, s40, s69
    s_and_b32 s41, s40, 31
    s_lshl_b32 s41, s41, 11
    s_lshr_b32 s46, s40, 5
    s_and_b32 s46, s46, 1
    s_lshr_b32 s40, s40, 6
    s_lshl_b32 s40, s40, 10
    s_add_u32 s40, s40, s41
    s_lshr_b32 s41, s74, 3
    s_mul_i32 s41, s41, 3670016
    s_add_u32 s40, s40, s41
    s_add_u32 s40, s96, s40
    s_addc_u32 s41, s97, 0
    s_mul_i32 s47, s58, 7
    s_add_u32 s46, s46, s47
    s_waitcnt lgkmcnt(0)
    s_barrier
    s_add_u32 s42, s46, 10
    s_cmp_ge_u32 s42, 56
    s_cselect_b32 s47, 56, 0
    s_sub_u32 s42, s42, s47
    s_lshl_b32 s42, s42, 16
    s_add_u32 s44, s40, s42
    s_addc_u32 s45, s41, 0
    s_load_dword s43, s[44:45], 384
    s_load_dword s43, s[44:45], 448
    s_barrier
    s_add_u32 s42, s46, 12
    s_cmp_ge_u32 s42, 56
    s_cselect_b32 s47, 56, 0
    s_sub_u32 s42, s42, s47
    s_lshl_b32 s42, s42, 16
    s_add_u32 s44, s40, s42
    s_addc_u32 s45, s41, 0
    s_load_dword s43, s[44:45], 384
    s_load_dword s43, s[44:45], 448
    s_add_u32 s42, s46, 14
    s_cmp_ge_u32 s42, 56
    s_cselect_b32 s47, 56, 0
    s_sub_u32 s42, s42, s47
    s_lshl_b32 s42, s42, 16
    s_add_u32 s44, s40, s42
    s_addc_u32 s45, s41, 0
    s_load_dword s43, s[44:45], 384
    s_load_dword s43, s[44:45], 448
    s_add_u32 m0, s51, 107776
    s_nop 0
    buffer_load_dwordx4 v244, s[12:15], s48 offen lds
    s_add_u32 m0, s51, 108832
    s_nop 0
    buffer_load_dwordx4 v245, s[12:15], s48 offen lds
    s_add_u32 s48, s48, 65536
    s_add_u32 m0, s51, 116224
    s_nop 0
    buffer_load_dwordx4 v244, s[12:15], s48 offen lds
    s_add_u32 m0, s51, 117280
    s_nop 0
    buffer_load_dwordx4 v245, s[12:15], s48 offen lds
    s_add_u32 s48, s48, 65536
    s_add_u32 m0, s51, 124672
    s_nop 0
    buffer_load_dwordx4 v244, s[12:15], s48 offen lds
    s_add_u32 m0, s51, 125728
    s_nop 0
    buffer_load_dwordx4 v245, s[12:15], s48 offen lds
    s_add_u32 s48, s48, 65536
    s_mov_b64 exec, s[62:63]
pl_3162:
    buffer_load_dwordx4 v[240:243], v246, s[80:83], s56 offen sc1
    s_sub_u32 s79, s79, 1
    s_cbranch_scc1 L_abort
    s_waitcnt vmcnt(0)
    v_and_b32 v240, v240, v241
    v_and_b32 v242, v242, v243
    v_and_b32 v240, v240, v242
    v_cmp_ne_u32 vcc, 1, v240
    s_cbranch_vccnz pl_3162
    s_mov_b64 exec, -1
    s_cmp_lg_u32 s78, 0
    s_cbranch_scc1 pl_3162_acq
pl_3162_ok:
    s_cmp_le_u32 s50, 0
    s_addc_u32 s52, s58, 0
    s_and_b32 s52, s52, 7
    s_mul_i32 s52, s52, 57344
    s_add_u32 s52, s52, s53
    s_add_u32 m0, s55, 49152
    s_nop 0
    buffer_load_dwordx4 v249, s[80:83], s52 offen offset:0 sc1 lds
    buffer_load_dwordx4 v249, s[80:83], s52 offen offset:1024 sc1 lds
    s_add_u32 s52, s52, 8192
    s_add_u32 m0, s55, 57344
    s_nop 0
    buffer_load_dwordx4 v249, s[80:83], s52 offen offset:0 sc1 lds
    buffer_load_dwordx4 v249, s[80:83], s52 offen offset:1024 sc1 lds
    s_add_u32 s52, s52, 8192
    s_add_u32 m0, s55, 0
    s_nop 0
    buffer_load_dwordx4 v249, s[80:83], s52 offen offset:0 sc1 lds
    buffer_load_dwordx4 v249, s[80:83], s52 offen offset:1024 sc1 lds
    s_add_u32 s52, s52, 8192
    s_add_u32 m0, s55, 8192
    s_nop 0
    buffer_load_dwordx4 v249, s[80:83], s52 offen offset:0 sc1 lds
    buffer_load_dwordx4 v249, s[80:83], s52 offen offset:1024 sc1 lds
    s_add_u32 s52, s52, 8192
    s_waitcnt vmcnt(4)
    s_barrier
    s_add_u32 m0, s55, 16384
    s_nop 0
    buffer_load_dwordx4 v249, s[80:83], s52 offen offset:0 sc1 lds
    buffer_load_dwordx4 v249, s[80:83], s52 offen offset:1024 sc1 lds
    s_add_u32 s52, s52, 8192
    s_add_u32 s42, s46, 16
    s_cmp_ge_u32 s42, 56
    s_cselect_b32 s47, 56, 0
    s_sub_u32 s42, s42, s47
    s_lshl_b32 s42, s42, 16
    s_add_u32 s44, s40, s42
    s_addc_u32 s45, s41, 0
    s_load_dword s43, s[44:45], 384
    s_load_dword s43, s[44:45], 448
    s_add_u32 s42, s46, 18
    s_cmp_ge_u32 s42, 56
    s_cselect_b32 s47, 56, 0
    s_sub_u32 s42, s42, s47
    s_lshl_b32 s42, s42, 16
    s_add_u32 s44, s40, s42
    s_addc_u32 s45, s41, 0
    s_load_dword s43, s[44:45], 384
    s_load_dword s43, s[44:45], 448
    s_add_u32 m0, s55, 24576
    s_nop 0
    buffer_load_dwordx4 v249, s[80:83], s52 offen offset:0 sc1 lds
    buffer_load_dwordx4 v249, s[80:83], s52 offen offset:1024 sc1 lds
    s_add_u32 s52, s52, 8192
    s_add_u32 m0, s55, 32768
    s_nop 0
    buffer_load_dwordx4 v249, s[80:83], s52 offen offset:0 sc1 lds
    buffer_load_dwordx4 v249, s[80:83], s52 offen offset:1024 sc1 lds
    s_add_u32 s52, s52, 8192
    s_add_u32 m0, s51, 133120
    s_nop 0
    buffer_load_dwordx4 v244, s[12:15], s48 offen lds
    s_add_u32 m0, s51, 134176
    s_nop 0
    buffer_load_dwordx4 v245, s[12:15], s48 offen lds
    s_add_u32 s48, s48, 65536
    s_waitcnt vmcnt(8)
    s_barrier
    s_cmp_le_u32 s50, 1
    s_addc_u32 s52, s58, 1
    s_and_b32 s52, s52, 7
    s_mul_i32 s52, s52, 57344
    s_add_u32 s52, s52, s53
    s_add_u32 m0, s55, 40960
    s_nop 0
    buffer_load_dwordx4 v249, s[80:83], s52 offen offset:0 sc1 lds
    buffer_load_dwordx4 v249, s[80:83], s52 offen offset:1024 sc1 lds
    s_add_u32 s52, s52, 8192
    s_add_u32 s42, s46, 20
    s_cmp_ge_u32 s42, 56
    s_cselect_b32 s47, 56, 0
    s_sub_u32 s42, s42, s47
    s_lshl_b32 s42, s42, 16
    s_add_u32 s44, s40, s42
    s_addc_u32 s45, s41, 0
    s_load_dword s43, s[44:45], 384
    s_load_dword s43, s[44:45], 448
    s_cmp_le_u32 s50, 1
    s_addc_u32 s48, s58, 1
    s_and_b32 s48, s48, 7
    s_mul_i32 s48, s48, 458752
    s_add_u32 s48, s48, s49
    s_add_u32 m0, s51, 141568
    s_nop 0
    buffer_load_dwordx4 v244, s[12:15], s48 offen lds
    s_add_u32 m0, s51, 142624
    s_nop 0
    buffer_load_dwordx4 v245, s[12:15], s48 offen lds
    s_add_u32 s48, s48, 65536
    s_add_u32 m0, s55, 49152
    s_nop 0
    buffer_load_dwordx4 v249, s[80:83], s52 offen offset:0 sc1 lds
    buffer_load_dwordx4 v249, s[80:83], s52 offen offset:1024 sc1 lds
    s_add_u32 s52, s52, 8192
    s_add_u32 m0, s51, 65536
    s_nop 0
    buffer_load_dwordx4 v244, s[12:15], s48 offen lds
    s_add_u32 m0, s51, 66592
    s_nop 0
    buffer_load_dwordx4 v245, s[12:15], s48 offen lds
    s_add_u32 s48, s48, 65536
    s_waitcnt vmcnt(12)
    s_barrier
    s_add_u32 m0, s55, 57344
    s_nop 0
    buffer_load_dwordx4 v249, s[80:83], s52 offen offset:0 sc1 lds
    buffer_load_dwordx4 v249, s[80:83], s52 offen offset:1024 sc1 lds
    s_add_u32 s52, s52, 8192
    s_add_u32 s42, s46, 22
    s_cmp_ge_u32 s42, 56
    s_cselect_b32 s47, 56, 0
    s_sub_u32 s42, s42, s47
    s_lshl_b32 s42, s42, 16
    s_add_u32 s44, s40, s42
    s_addc_u32 s45, s41, 0
    s_load_dword s43, s[44:45], 384
    s_load_dword s43, s[44:45], 448
    s_add_u32 m0, s51, 73984
    s_nop 0
    buffer_load_dwordx4 v244, s[12:15], s48 offen lds
    s_add_u32 m0, s51, 75040
    s_nop 0
    buffer_load_dwordx4 v245, s[12:15], s48 offen lds
    s_add_u32 s48, s48, 65536
    s_add_u32 m0, s55, 0
    s_nop 0
    buffer_load_dwordx4 v249, s[80:83], s52 offen offset:0 sc1 lds
    buffer_load_dwordx4 v249, s[80:83], s52 offen offset:1024 sc1 lds
    s_add_u32 s52, s52, 8192
    s_add_u32 m0, s51, 82432
    s_nop 0
    buffer_load_dwordx4 v244, s[12:15], s48 offen lds
    s_add_u32 m0, s51, 83488
    s_nop 0
    buffer_load_dwordx4 v245, s[12:15], s48 offen lds
    s_add_u32 s48, s48, 65536
    s_waitcnt vmcnt(12)
    s_barrier
    s_add_u32 m0, s55, 8192
    s_nop 0
    buffer_load_dwordx4 v249, s[80:83], s52 offen offset:0 sc1 lds
    buffer_load_dwordx4 v249, s[80:83], s52 offen offset:1024 sc1 lds
    s_add_u32 s52, s52, 8192
    s_add_u32 s42, s46, 24
    s_cmp_ge_u32 s42, 56
    s_cselect_b32 s47, 56, 0
    s_sub_u32 s42, s42, s47
    s_lshl_b32 s42, s42, 16
    s_add_u32 s44, s40, s42
    s_addc_u32 s45, s41, 0
    s_load_dword s43, s[44:45], 384
    s_load_dword s43, s[44:45], 448
    s_add_u32 m0, s51, 90880
    s_nop 0
    buffer_load_dwordx4 v244, s[12:15], s48 offen lds
    s_add_u32 m0, s51, 91936
    s_nop 0
    buffer_load_dwordx4 v245, s[12:15], s48 offen lds
    s_add_u32 s48, s48, 65536
    s_add_u32 m0, s55, 16384
    s_nop 0
    buffer_load_dwordx4 v249, s[80:83], s52 offen offset:0 sc1 lds
    buffer_load_dwordx4 v249, s[80:83], s52 offen offset:1024 sc1 lds
    s_add_u32 s52, s52, 8192
    s_add_u32 m0, s51, 99328
    s_nop 0
    buffer_load_dwordx4 v244, s[12:15], s48 offen lds
    s_add_u32 m0, s51, 100384
    s_nop 0
    buffer_load_dwordx4 v245, s[12:15], s48 offen lds
    s_add_u32 s48, s48, 65536
    s_waitcnt vmcnt(12)
    s_barrier
    s_add_u32 m0, s55, 24576
    s_nop 0
    buffer_load_dwordx4 v249, s[80:83], s52 offen offset:0 sc1 lds
    buffer_load_dwordx4 v249, s[80:83], s52 offen offset:1024 sc1 lds
    s_add_u32 s52, s52, 8192
    s_add_u32 s42, s46, 26
    s_cmp_ge_u32 s42, 56
    s_cselect_b32 s47, 56, 0
    s_sub_u32 s42, s42, s47
    s_lshl_b32 s42, s42, 16
    s_add_u32 s44, s40, s42
    s_addc_u32 s45, s41, 0
    s_load_dword s43, s[44:45], 384
    s_load_dword s43, s[44:45], 448
    s_add_u32 m0, s51, 107776
    s_nop 0
    buffer_load_dwordx4 v244, s[12:15], s48 offen lds
    s_add_u32 m0, s51, 108832
    s_nop 0
    buffer_load_dwordx4 v245, s[12:15], s48 offen lds
    s_add_u32 s48, s48, 65536
    s_cmp_le_u32 s50, 2
    s_addc_u32 s52, s58, 2
    s_and_b32 s52, s52, 7
    s_mul_i32 s52, s52, 57344
    s_add_u32 s52, s52, s53
    s_add_u32 m0, s55, 32768
    s_nop 0
    buffer_load_dwordx4 v249, s[80:83], s52 offen offset:0 sc1 lds
    buffer_load_dwordx4 v249, s[80:83], s52 offen offset:1024 sc1 lds
    s_add_u32 s52, s52, 8192
    s_cmp_le_u32 s50, 2
    s_addc_u32 s48, s58, 2
    s_and_b32 s48, s48, 7
    s_mul_i32 s48, s48, 458752
    s_add_u32 s48, s48, s49
    s_add_u32 m0, s51, 116224
    s_nop 0
    buffer_load_dwordx4 v244, s[12:15], s48 offen lds
    s_add_u32 m0, s51, 117280
    s_nop 0
    buffer_load_dwordx4 v245, s[12:15], s48 offen lds
    s_add_u32 s48, s48, 65536
    s_waitcnt vmcnt(12)
    s_barrier
    s_add_u32 m0, s55, 40960
    s_nop 0
    buffer_load_dwordx4 v249, s[80:83], s52 offen offset:0 sc1 lds
    buffer_load_dwordx4 v249, s[80:83], s52 offen offset:1024 sc1 lds
    s_add_u32 s52, s52, 8192
    s_add_u32 s42, s46, 28
    s_cmp_ge_u32 s42, 56
    s_cselect_b32 s47, 56, 0
    s_sub_u32 s42, s42, s47
    s_lshl_b32 s42, s42, 16
    s_add_u32 s44, s40, s42
    s_addc_u32 s45, s41, 0
    s_load_dword s43, s[44:45], 384
    s_load_dword s43, s[44:45], 448
    s_add_u32 m0, s51, 124672
    s_nop 0
    buffer_load_dwordx4 v244, s[12:15], s48 offen lds
    s_add_u32 m0, s51, 125728
    s_nop 0
    buffer_load_dwordx4 v245, s[12:15], s48 offen lds
    s_add_u32 s48, s48, 65536
    s_add_u32 m0, s55, 49152
    s_nop 0
    buffer_load_dwordx4 v249, s[80:83], s52 offen offset:0 sc1 lds
    buffer_load_dwordx4 v249, s[80:83], s52 offen offset:1024 sc1 lds
    s_add_u32 s52, s52, 8192
    s_add_u32 m0, s51, 133120
    s_nop 0
    buffer_load_dwordx4 v244, s[12:15], s48 offen lds
    s_add_u32 m0, s51, 134176
    s_nop 0
    buffer_load_dwordx4 v245, s[12:15], s48 offen lds
    s_add_u32 s48, s48, 65536
    s_waitcnt vmcnt(12)
    s_barrier
    s_add_u32 m0, s55, 57344
    s_nop 0
    buffer_load_dwordx4 v249, s[80:83], s52 offen offset:0 sc1 lds
    buffer_load_dwordx4 v249, s[80:83], s52 offen offset:1024 sc1 lds
    s_add_u32 s52, s52, 8192
    s_add_u32 s42, s46, 30
    s_cmp_ge_u32 s42, 56
    s_cselect_b32 s47, 56, 0
    s_sub_u32 s42, s42, s47
    s_lshl_b32 s42, s42, 16
    s_add_u32 s44, s40, s42
    s_addc_u32 s45, s41, 0
    s_load_dword s43, s[44:45], 384
    s_load_dword s43, s[44:45], 448
    s_add_u32 m0, s51, 141568
    s_nop 0
    buffer_load_dwordx4 v244, s[12:15], s48 offen lds
    s_add_u32 m0, s51, 142624
    s_nop 0
    buffer_load_dwordx4 v245, s[12:15], s48 offen lds
    s_add_u32 s48, s48, 65536
    s_add_u32 m0, s55, 0
    s_nop 0
    buffer_load_dwordx4 v249, s[80:83], s52 offen offset:0 sc1 lds
    buffer_load_dwordx4 v249, s[80:83], s52 offen offset:1024 sc1 lds
    s_add_u32 s52, s52, 8192
    s_add_u32 m0, s51, 65536
    s_nop 0
    buffer_load_dwordx4 v244, s[12:15], s48 offen lds
    s_add_u32 m0, s51, 66592
    s_nop 0
    buffer_load_dwordx4 v245, s[12:15], s48 offen lds
    s_add_u32 s48, s48, 65536
    s_waitcnt vmcnt(12)
    s_barrier
    s_add_u32 m0, s55, 8192
    s_nop 0
    buffer_load_dwordx4 v249, s[80:83], s52 offen offset:0 sc1 lds
    buffer_load_dwordx4 v249, s[80:83], s52 offen offset:1024 sc1 lds
    s_add_u32 s52, s52, 8192
    s_add_u32 s42, s46, 32
    s_cmp_ge_u32 s42, 56
    s_cselect_b32 s47, 56, 0
    s_sub_u32 s42, s42, s47
    s_lshl_b32 s42, s42, 16
    s_add_u32 s44, s40, s42
    s_addc_u32 s45, s41, 0
    s_load_dword s43, s[44:45], 384
    s_load_dword s43, s[44:45], 448
    s_add_u32 m0, s51, 73984
    s_nop 0
    buffer_load_dwordx4 v244, s[12:15], s48 offen lds
    s_add_u32 m0, s51, 75040
    s_nop 0
    buffer_load_dwordx4 v245, s[12:15], s48 offen lds
    s_add_u32 s48, s48, 65536
    s_add_u32 m0, s55, 16384
    s_nop 0
    buffer_load_dwordx4 v249, s[80:83], s52 offen offset:0 sc1 lds
    buffer_load_dwordx4 v249, s[80:83], s52 offen offset:1024 sc1 lds
    s_add_u32 s52, s52, 8192
    s_add_u32 m0, s51, 82432
    s_nop 0
    buffer_load_dwordx4 v244, s[12:15], s48 offen lds
    s_add_u32 m0, s51, 83488
    s_nop 0
    buffer_load_dwordx4 v245, s[12:15], s48 offen lds
    s_add_u32 s48, s48, 65536
    s_waitcnt vmcnt(12)
    s_barrier
    s_cmp_le_u32 s50, 3
    s_addc_u32 s52, s58, 3
    s_and_b32 s52, s52, 7
    s_mul_i32 s52, s52, 57344
    s_add_u32 s52, s52, s53
    s_add_u32 m0, s55, 24576
    s_nop 0
    buffer_load_dwordx4 v249, s[80:83], s52 offen offset:0 sc1 lds
    buffer_load_dwordx4 v249, s[80:83], s52 offen offset:1024 sc1 lds
    s_add_u32 s52, s52, 8192
    s_add_u32 s42, s46, 34
    s_cmp_ge_u32 s42, 56
    s_cselect_b32 s47, 56, 0
    s_sub_u32 s42, s42, s47
    s_lshl_b32 s42, s42, 16
    s_add_u32 s44, s40, s42
    s_addc_u32 s45, s41, 0
    s_load_dword s43, s[44:45], 384
    s_load_dword s43, s[44:45], 448
    s_cmp_le_u32 s50, 3
    s_addc_u32 s48, s58, 3
    s_and_b32 s48, s48, 7
    s_mul_i32 s48, s48, 458752
    s_add_u32 s48, s48, s49
    s_add_u32 m0, s51, 90880
    s_nop 0
    buffer_load_dwordx4 v244, s[12:15], s48 offen lds
    s_add_u32 m0, s51, 91936
    s_nop 0
    buffer_load_dwordx4 v245, s[12:15], s48 offen lds
    s_add_u32 s48, s48, 65536
    s_add_u32 m0, s55, 32768
    s_nop 0
    buffer_load_dwordx4 v249, s[80:83], s52 offen offset:0 sc1 lds
    buffer_load_dwordx4 v249, s[80:83], s52 offen offset:1024 sc1 lds
    s_add_u32 s52, s52, 8192
    s_add_u32 m0, s51, 99328
    s_nop 0
    buffer_load_dwordx4 v244, s[12:15], s48 offen lds
    s_add_u32 m0, s51, 100384
    s_nop 0
    buffer_load_dwordx4 v245, s[12:15], s48 offen lds
    s_add_u32 s48, s48, 65536
    s_waitcnt vmcnt(12)
    s_barrier
    s_add_u32 m0, s55, 40960
    s_nop 0
    buffer_load_dwordx4 v249, s[80:83], s52 offen offset:0 sc1 lds
    buffer_load_dwordx4 v249, s[80:83], s52 offen offset:1024 sc1 lds
    s_add_u32 s52, s52, 8192
    s_add_u32 s42, s46, 36
    s_cmp_ge_u32 s42, 56
    s_cselect_b32 s47, 56, 0
    s_sub_u32 s42, s42, s47
    s_lshl_b32 s42, s42, 16
    s_add_u32 s44, s40, s42
    s_addc_u32 s45, s41, 0
    s_load_dword s43, s[44:45], 384
    s_load_dword s43, s[44:45], 448
    s_add_u32 m0, s51, 107776
    s_nop 0
    buffer_load_dwordx4 v244, s[12:15], s48 offen lds
    s_add_u32 m0, s51, 108832
    s_nop 0
    buffer_load_dwordx4 v245, s[12:15], s48 offen lds
    s_add_u32 s48, s48, 65536
    s_add_u32 m0, s55, 49152
    s_nop 0
    buffer_load_dwordx4 v249, s[80:83], s52 offen offset:0 sc1 lds
    buffer_load_dwordx4 v249, s[80:83], s52 offen offset:1024 sc1 lds
    s_add_u32 s52, s52, 8192
    s_add_u32 m0, s51, 116224
    s_nop 0
    buffer_load_dwordx4 v244, s[12:15], s48 offen lds
    s_add_u32 m0, s51, 117280
    s_nop 0
    buffer_load_dwordx4 v245, s[12:15], s48 offen lds
    s_add_u32 s48, s48, 65536
    s_waitcnt vmcnt(12)
    s_barrier
    s_add_u32 m0, s55, 57344
    s_nop 0
    buffer_load_dwordx4 v249, s[80:83], s52 offen offset:0 sc1 lds
    buffer_load_dwordx4 v249, s[80:83], s52 offen offset:1024 sc1 lds
    s_add_u32 s52, s52, 8192
    s_add_u32 s42, s46, 38
    s_cmp_ge_u32 s42, 56
    s_cselect_b32 s47, 56, 0
    s_sub_u32 s42, s42, s47
    s_lshl_b32 s42, s42, 16
    s_add_u32 s44, s40, s42
    s_addc_u32 s45, s41, 0
    s_load_dword s43, s[44:45], 384
    s_load_dword s43, s[44:45], 448
    s_add_u32 m0, s51, 124672
    s_nop 0
    buffer_load_dwordx4 v244, s[12:15], s48 offen lds
    s_add_u32 m0, s51, 125728
    s_nop 0
    buffer_load_dwordx4 v245, s[12:15], s48 offen lds
    s_add_u32 s48, s48, 65536
    s_add_u32 m0, s55, 0
    s_nop 0
    buffer_load_dwordx4 v249, s[80:83], s52 offen offset:0 sc1 lds
    buffer_load_dwordx4 v249, s[80:83], s52 offen offset:1024 sc1 lds
    s_add_u32 s52, s52, 8192
    s_add_u32 m0, s51, 133120
    s_nop 0
    buffer_load_dwordx4 v244, s[12:15], s48 offen lds
    s_add_u32 m0, s51, 134176
    s_nop 0
    buffer_load_dwordx4 v245, s[12:15], s48 offen lds
    s_add_u32 s48, s48, 65536
    s_waitcnt vmcnt(12)
    s_barrier
    s_add_u32 m0, s55, 8192
    s_nop 0
    buffer_load_dwordx4 v249, s[80:83], s52 offen offset:0 sc1 lds
    buffer_load_dwordx4 v249, s[80:83], s52 offen offset:1024 sc1 lds
    s_add_u32 s52, s52, 8192
    s_add_u32 s42, s46, 40
    s_cmp_ge_u32 s42, 56
    s_cselect_b32 s47, 56, 0
    s_sub_u32 s42, s42, s47
    s_lshl_b32 s42, s42, 16
    s_add_u32 s44, s40, s42
    s_addc_u32 s45, s41, 0
    s_load_dword s43, s[44:45], 384
    s_load_dword s43, s[44:45], 448
    s_add_u32 m0, s51, 141568
    s_nop 0
    buffer_load_dwordx4 v244, s[12:15], s48 offen lds
    s_add_u32 m0, s51, 142624
    s_nop 0
    buffer_load_dwordx4 v245, s[12:15], s48 offen lds
    s_add_u32 s48, s48, 65536
    s_cmp_le_u32 s50, 4
    s_addc_u32 s52, s58, 4
    s_and_b32 s52, s52, 7
    s_mul_i32 s52, s52, 57344
    s_add_u32 s52, s52, s53
    s_add_u32 m0, s55, 16384
    s_nop 0
    buffer_load_dwordx4 v249, s[80:83], s52 offen offset:0 sc1 lds
    buffer_load_dwordx4 v249, s[80:83], s52 offen offset:1024 sc1 lds
    s_add_u32 s52, s52, 8192
    s_cmp_le_u32 s50, 4
    s_addc_u32 s48, s58, 4
    s_and_b32 s48, s48, 7
    s_mul_i32 s48, s48, 458752
    s_add_u32 s48, s48, s49
    s_add_u32 m0, s51, 65536
    s_nop 0
    buffer_load_dwordx4 v244, s[12:15], s48 offen lds
    s_add_u32 m0, s51, 66592
    s_nop 0
    buffer_load_dwordx4 v245, s[12:15], s48 offen lds
    s_add_u32 s48, s48, 65536
    s_waitcnt vmcnt(12)
    s_barrier
    s_add_u32 m0, s55, 24576
    s_nop 0
    buffer_load_dwordx4 v249, s[80:83], s52 offen offset:0 sc1 lds
    buffer_load_dwordx4 v249, s[80:83], s52 offen offset:1024 sc1 lds
    s_add_u32 s52, s52, 8192
    s_add_u32 s42, s46, 42
    s_cmp_ge_u32 s42, 56
    s_cselect_b32 s47, 56, 0
    s_sub_u32 s42, s42, s47
    s_lshl_b32 s42, s42, 16
    s_add_u32 s44, s40, s42
    s_addc_u32 s45, s41, 0
    s_load_dword s43, s[44:45], 384
    s_load_dword s43, s[44:45], 448
    s_add_u32 m0, s51, 73984
    s_nop 0
    buffer_load_dwordx4 v244, s[12:15], s48 offen lds
    s_add_u32 m0, s51, 75040
    s_nop 0
    buffer_load_dwordx4 v245, s[12:15], s48 offen lds
    s_add_u32 s48, s48, 65536
    s_add_u32 m0, s55, 32768
    s_nop 0
    buffer_load_dwordx4 v249, s[80:83], s52 offen offset:0 sc1 lds
    buffer_load_dwordx4 v249, s[80:83], s52 offen offset:1024 sc1 lds
    s_add_u32 s52, s52, 8192
    s_add_u32 m0, s51, 82432
    s_nop 0
    buffer_load_dwordx4 v244, s[12:15], s48 offen lds
    s_add_u32 m0, s51, 83488
    s_nop 0
    buffer_load_dwordx4 v245, s[12:15], s48 offen lds
    s_add_u32 s48, s48, 65536
    s_waitcnt vmcnt(12)
    s_barrier
    s_add_u32 m0, s55, 40960
    s_nop 0
    buffer_load_dwordx4 v249, s[80:83], s52 offen offset:0 sc1 lds
    buffer_load_dwordx4 v249, s[80:83], s52 offen offset:1024 sc1 lds
    s_add_u32 s52, s52, 8192
    s_add_u32 s42, s46, 44
    s_cmp_ge_u32 s42, 56
    s_cselect_b32 s47, 56, 0
    s_sub_u32 s42, s42, s47
    s_lshl_b32 s42, s42, 16
    s_add_u32 s44, s40, s42
    s_addc_u32 s45, s41, 0
    s_load_dword s43, s[44:45], 384
    s_load_dword s43, s[44:45], 448
    s_add_u32 m0, s51, 90880
    s_nop 0
    buffer_load_dwordx4 v244, s[12:15], s48 offen lds
    s_add_u32 m0, s51, 91936
    s_nop 0
    buffer_load_dwordx4 v245, s[12:15], s48 offen lds
    s_add_u32 s48, s48, 65536
    s_add_u32 m0, s55, 49152
    s_nop 0
    buffer_load_dwordx4 v249, s[80:83], s52 offen offset:0 sc1 lds
    buffer_load_dwordx4 v249, s[80:83], s52 offen offset:1024 sc1 lds
    s_add_u32 s52, s52, 8192
    s_add_u32 m0, s51, 99328
    s_nop 0
    buffer_load_dwordx4 v244, s[12:15], s48 offen lds
    s_add_u32 m0, s51, 100384
    s_nop 0
    buffer_load_dwordx4 v245, s[12:15], s48 offen lds
    s_add_u32 s48, s48, 65536
    s_waitcnt vmcnt(12)
    s_barrier
    s_add_u32 m0, s55, 57344
    s_nop 0
    buffer_load_dwordx4 v249, s[80:83], s52 offen offset:0 sc1 lds
    buffer_load_dwordx4 v249, s[80:83], s52 offen offset:1024 sc1 lds
    s_add_u32 s52, s52, 8192
    s_add_u32 s42, s46, 46
    s_cmp_ge_u32 s42, 56
    s_cselect_b32 s47, 56, 0
    s_sub_u32 s42, s42, s47
    s_lshl_b32 s42, s42, 16
    s_add_u32 s44, s40, s42
    s_addc_u32 s45, s41, 0
    s_load_dword s43, s[44:45], 384
    s_load_dword s43, s[44:45], 448
    s_add_u32 m0, s51, 107776
    s_nop 0
    buffer_load_dwordx4 v244, s[12:15], s48 offen lds
    s_add_u32 m0, s51, 108832
    s_nop 0
    buffer_load_dwordx4 v245, s[12:15], s48 offen lds
    s_add_u32 s48, s48, 65536
    s_add_u32 m0, s55, 0
    s_nop 0
    buffer_load_dwordx4 v249, s[80:83], s52 offen offset:0 sc1 lds
    buffer_load_dwordx4 v249, s[80:83], s52 offen offset:1024 sc1 lds
    s_add_u32 s52, s52, 8192
    s_add_u32 m0, s51, 116224
    s_nop 0
    buffer_load_dwordx4 v244, s[12:15], s48 offen lds
    s_add_u32 m0, s51, 117280
    s_nop 0
    buffer_load_dwordx4 v245, s[12:15], s48 offen lds
    s_add_u32 s48, s48, 65536
    s_waitcnt vmcnt(12)
    s_barrier
    s_cmp_le_u32 s50, 5
    s_addc_u32 s52, s58, 5
    s_and_b32 s52, s52, 7
    s_mul_i32 s52, s52, 57344
    s_add_u32 s52, s52, s53
    s_add_u32 m0, s55, 8192
    s_nop 0
    buffer_load_dwordx4 v249, s[80:83], s52 offen offset:0 sc1 lds
    buffer_load_dwordx4 v249, s[80:83], s52 offen offset:1024 sc1 lds
    s_add_u32 s52, s52, 8192
    s_add_u32 s42, s46, 48
    s_cmp_ge_u32 s42, 56
    s_cselect_b32 s47, 56, 0
    s_sub_u32 s42, s42, s47
    s_lshl_b32 s42, s42, 16
    s_add_u32 s44, s40, s42
    s_addc_u32 s45, s41, 0
    s_load_dword s43, s[44:45], 384
    s_load_dword s43, s[44:45], 448
    s_cmp_le_u32 s50, 5
    s_addc_u32 s48, s58, 5
    s_and_b32 s48, s48, 7
    s_mul_i32 s48, s48, 458752
    s_add_u32 s48, s48, s49
    s_add_u32 m0, s51, 124672
    s_nop 0
    buffer_load_dwordx4 v244, s[12:15], s48 offen lds
    s_add_u32 m0, s51, 125728
    s_nop 0
    buffer_load_dwordx4 v245, s[12:15], s48 offen lds
    s_add_u32 s48, s48, 65536
    s_add_u32 m0, s55, 16384
    s_nop 0
    buffer_load_dwordx4 v249, s[80:83], s52 offen offset:0 sc1 lds
    buffer_load_dwordx4 v249, s[80:83], s52 offen offset:1024 sc1 lds
    s_add_u32 s52, s52, 8192
    s_add_u32 m0, s51, 133120
    s_nop 0
    buffer_load_dwordx4 v244, s[12:15], s48 offen lds
    s_add_u32 m0, s51, 134176
    s_nop 0
    buffer_load_dwordx4 v245, s[12:15], s48 offen lds
    s_add_u32 s48, s48, 65536
    s_waitcnt vmcnt(12)
    s_barrier
    s_add_u32 m0, s55, 24576
    s_nop 0
    buffer_load_dwordx4 v249, s[80:83], s52 offen offset:0 sc1 lds
    buffer_load_dwordx4 v249, s[80:83], s52 offen offset:1024 sc1 lds
    s_add_u32 s52, s52, 8192
    s_add_u32 s42, s46, 50
    s_cmp_ge_u32 s42, 56
    s_cselect_b32 s47, 56, 0
    s_sub_u32 s42, s42, s47
    s_lshl_b32 s42, s42, 16
    s_add_u32 s44, s40, s42
    s_addc_u32 s45, s41, 0
    s_load_dword s43, s[44:45], 384
    s_load_dword s43, s[44:45], 448
    s_add_u32 m0, s51, 141568
    s_nop 0
    buffer_load_dwordx4 v244, s[12:15], s48 offen lds
    s_add_u32 m0, s51, 142624
    s_nop 0
    buffer_load_dwordx4 v245, s[12:15], s48 offen lds
    s_add_u32 s48, s48, 65536
    s_add_u32 m0, s55, 32768
    s_nop 0
    buffer_load_dwordx4 v249, s[80:83], s52 offen offset:0 sc1 lds
    buffer_load_dwordx4 v249, s[80:83], s52 offen offset:1024 sc1 lds
    s_add_u32 s52, s52, 8192
    s_add_u32 m0, s51, 65536
    s_nop 0
    buffer_load_dwordx4 v244, s[12:15], s48 offen lds
    s_add_u32 m0, s51, 66592
    s_nop 0
    buffer_load_dwordx4 v245, s[12:15], s48 offen lds
    s_add_u32 s48, s48, 65536
    s_waitcnt vmcnt(12)
    s_barrier
    s_add_u32 m0, s55, 40960
    s_nop 0
    buffer_load_dwordx4 v249, s[80:83], s52 offen offset:0 sc1 lds
    buffer_load_dwordx4 v249, s[80:83], s52 offen offset:1024 sc1 lds
    s_add_u32 s52, s52, 8192
    s_add_u32 s42, s46, 52
    s_cmp_ge_u32 s42, 56
    s_cselect_b32 s47, 56, 0
    s_sub_u32 s42, s42, s47
    s_lshl_b32 s42, s42, 16
    s_add_u32 s44, s40, s42
    s_addc_u32 s45, s41, 0
    s_load_dword s43, s[44:45], 384
    s_load_dword s43, s[44:45], 448
    s_add_u32 m0, s51, 73984
    s_nop 0
    buffer_load_dwordx4 v244, s[12:15], s48 offen lds
    s_add_u32 m0, s51, 75040
    s_nop 0
    buffer_load_dwordx4 v245, s[12:15], s48 offen lds
    s_add_u32 s48, s48, 65536
    s_add_u32 m0, s55, 49152
    s_nop 0
    buffer_load_dwordx4 v249, s[80:83], s52 offen offset:0 sc1 lds
    buffer_load_dwordx4 v249, s[80:83], s52 offen offset:1024 sc1 lds
    s_add_u32 s52, s52, 8192
    s_add_u32 m0, s51, 82432
    s_nop 0
    buffer_load_dwordx4 v244, s[12:15], s48 offen lds
    s_add_u32 m0, s51, 83488
    s_nop 0
    buffer_load_dwordx4 v245, s[12:15], s48 offen lds
    s_add_u32 s48, s48, 65536
    s_waitcnt vmcnt(12)
    s_barrier
    s_add_u32 m0, s55, 57344
    s_nop 0
    buffer_load_dwordx4 v249, s[80:83], s52 offen offset:0 sc1 lds
    buffer_load_dwordx4 v249, s[80:83], s52 offen offset:1024 sc1 lds
    s_add_u32 s52, s52, 8192
    s_add_u32 s42, s46, 54
    s_cmp_ge_u32 s42, 56
    s_cselect_b32 s47, 56, 0
    s_sub_u32 s42, s42, s47
    s_lshl_b32 s42, s42, 16
    s_add_u32 s44, s40, s42
    s_addc_u32 s45, s41, 0
    s_load_dword s43, s[44:45], 384
    s_load_dword s43, s[44:45], 448
    s_add_u32 m0, s51, 90880
    s_nop 0
    buffer_load_dwordx4 v244, s[12:15], s48 offen lds
    s_add_u32 m0, s51, 91936
    s_nop 0
    buffer_load_dwordx4 v245, s[12:15], s48 offen lds
    s_add_u32 s48, s48, 65536
    s_cmp_le_u32 s50, 6
    s_addc_u32 s52, s58, 6
    s_and_b32 s52, s52, 7
    s_mul_i32 s52, s52, 57344
    s_add_u32 s52, s52, s53
    s_add_u32 m0, s55, 0
    s_nop 0
    buffer_load_dwordx4 v249, s[80:83], s52 offen offset:0 sc1 lds
    buffer_load_dwordx4 v249, s[80:83], s52 offen offset:1024 sc1 lds
    s_add_u32 s52, s52, 8192
    s_cmp_le_u32 s50, 6
    s_addc_u32 s48, s58, 6
    s_and_b32 s48, s48, 7
    s_mul_i32 s48, s48, 458752
    s_add_u32 s48, s48, s49
    s_add_u32 m0, s51, 99328
    s_nop 0
    buffer_load_dwordx4 v244, s[12:15], s48 offen lds
    s_add_u32 m0, s51, 100384
    s_nop 0
    buffer_load_dwordx4 v245, s[12:15], s48 offen lds
    s_add_u32 s48, s48, 65536
    s_waitcnt vmcnt(12)
    s_barrier
    s_add_u32 m0, s55, 8192
    s_nop 0
    buffer_load_dwordx4 v249, s[80:83], s52 offen offset:0 sc1 lds
    buffer_load_dwordx4 v249, s[80:83], s52 offen offset:1024 sc1 lds
    s_add_u32 s52, s52, 8192
    s_add_u32 m0, s51, 107776
    s_nop 0
    buffer_load_dwordx4 v244, s[12:15], s48 offen lds
    s_add_u32 m0, s51, 108832
    s_nop 0
    buffer_load_dwordx4 v245, s[12:15], s48 offen lds
    s_add_u32 s48, s48, 65536
    s_add_u32 m0, s55, 16384
    s_nop 0
    buffer_load_dwordx4 v249, s[80:83], s52 offen offset:0 sc1 lds
    buffer_load_dwordx4 v249, s[80:83], s52 offen offset:1024 sc1 lds
    s_add_u32 s52, s52, 8192
    s_add_u32 m0, s51, 116224
    s_nop 0
    buffer_load_dwordx4 v244, s[12:15], s48 offen lds
    s_add_u32 m0, s51, 117280
    s_nop 0
    buffer_load_dwordx4 v245, s[12:15], s48 offen lds
    s_add_u32 s48, s48, 65536
    s_waitcnt vmcnt(12)
    s_barrier
    s_add_u32 m0, s55, 24576
    s_nop 0
    buffer_load_dwordx4 v249, s[80:83], s52 offen offset:0 sc1 lds
    buffer_load_dwordx4 v249, s[80:83], s52 offen offset:1024 sc1 lds
    s_add_u32 s52, s52, 8192
    s_add_u32 m0, s51, 124672
    s_nop 0
    buffer_load_dwordx4 v244, s[12:15], s48 offen lds
    s_add_u32 m0, s51, 125728
    s_nop 0
    buffer_load_dwordx4 v245, s[12:15], s48 offen lds
    s_add_u32 s48, s48, 65536
    s_add_u32 m0, s55, 32768
    s_nop 0
    buffer_load_dwordx4 v249, s[80:83], s52 offen offset:0 sc1 lds
    buffer_load_dwordx4 v249, s[80:83], s52 offen offset:1024 sc1 lds
    s_add_u32 s52, s52, 8192
    s_add_u32 m0, s51, 133120
    s_nop 0
    buffer_load_dwordx4 v244, s[12:15], s48 offen lds
    s_add_u32 m0, s51, 134176
    s_nop 0
    buffer_load_dwordx4 v245, s[12:15], s48 offen lds
    s_add_u32 s48, s48, 65536
    s_waitcnt vmcnt(12)
    s_barrier
    s_add_u32 m0, s55, 40960
    s_nop 0
    buffer_load_dwordx4 v249, s[80:83], s52 offen offset:0 sc1 lds
    buffer_load_dwordx4 v249, s[80:83], s52 offen offset:1024 sc1 lds
    s_add_u32 s52, s52, 8192
    s_add_u32 m0, s51, 141568
    s_nop 0
    buffer_load_dwordx4 v244, s[12:15], s48 offen lds
    s_add_u32 m0, s51, 142624
    s_nop 0
    buffer_load_dwordx4 v245, s[12:15], s48 offen lds
    s_add_u32 s48, s48, 65536
    s_add_u32 m0, s55, 49152
    s_nop 0
    buffer_load_dwordx4 v249, s[80:83], s52 offen offset:0 sc1 lds
    buffer_load_dwordx4 v249, s[80:83], s52 offen offset:1024 sc1 lds
    s_add_u32 s52, s52, 8192
    s_add_u32 m0, s51, 65536
    s_nop 0
    buffer_load_dwordx4 v244, s[12:15], s48 offen lds
    s_add_u32 m0, s51, 66592
    s_nop 0
    buffer_load_dwordx4 v245, s[12:15], s48 offen lds
    s_add_u32 s48, s48, 65536
    s_waitcnt vmcnt(12)
    s_barrier
    s_add_u32 m0, s19, 86400
    s_nop 0
    buffer_load_dwordx4 v10, s[8:11], s16 offen lds
    s_add_u32 m0, s19, 87424
    s_nop 0
    buffer_load_dwordx4 v11, s[8:11], s16 offen lds
    s_add_u32 m0, s19, 88448
    s_nop 0
    buffer_load_dwordx4 v12, s[8:11], s16 offen lds
    s_add_u32 s16, s16, 196608
    s_cmp_eq_u32 s16, s18
    s_cselect_b32 s16, s17, s16
    s_add_u32 m0, s19, 98816
    s_nop 0
    buffer_load_dwordx4 v10, s[8:11], s16 offen lds
    s_add_u32 m0, s19, 99840
    s_nop 0
    buffer_load_dwordx4 v11, s[8:11], s16 offen lds
    s_add_u32 m0, s19, 100864
    s_nop 0
    buffer_load_dwordx4 v12, s[8:11], s16 offen lds
    s_add_u32 s16, s16, 196608
    s_cmp_eq_u32 s16, s18
    s_cselect_b32 s16, s17, s16
    s_waitcnt vmcnt(6)
    s_barrier
    s_add_u32 m0, s19, 111232
    s_nop 0
    buffer_load_dwordx4 v10, s[8:11], s16 offen lds
    s_add_u32 m0, s19, 112256
    s_nop 0
    buffer_load_dwordx4 v11, s[8:11], s16 offen lds
    s_add_u32 m0, s19, 113280
    s_nop 0
    buffer_load_dwordx4 v12, s[8:11], s16 offen lds
    s_add_u32 s16, s16, 196608
    s_cmp_eq_u32 s16, s18
    s_cselect_b32 s16, s17, s16
    s_barrier
    s_add_u32 m0, s19, 123648
    s_nop 0
    buffer_load_dwordx4 v10, s[8:11], s16 offen lds
    s_add_u32 m0, s19, 124672
    s_nop 0
    buffer_load_dwordx4 v11, s[8:11], s16 offen lds
    s_add_u32 m0, s19, 125696
    s_nop 0
    buffer_load_dwordx4 v12, s[8:11], s16 offen lds
    s_add_u32 s16, s16, 196608
    s_cmp_eq_u32 s16, s18
    s_cselect_b32 s16, s17, s16
    s_add_u32 m0, s19, 136064
    s_nop 0
    buffer_load_dwordx4 v10, s[8:11], s16 offen lds
    s_add_u32 m0, s19, 137088
    s_nop 0
    buffer_load_dwordx4 v11, s[8:11], s16 offen lds
    s_add_u32 m0, s19, 138112
    s_nop 0
    buffer_load_dwordx4 v12, s[8:11], s16 offen lds
    s_add_u32 s16, s16, 196608
    s_cmp_eq_u32 s16, s18
    s_cselect_b32 s16, s17, s16
    s_add_u32 m0, s19, 73984
    s_nop 0
    buffer_load_dwordx4 v10, s[8:11], s16 offen lds
    s_add_u32 m0, s19, 75008
    s_nop 0
    buffer_load_dwordx4 v11, s[8:11], s16 offen lds
    s_add_u32 m0, s19, 76032
    s_nop 0
    buffer_load_dwordx4 v12, s[8:11], s16 offen lds
    s_add_u32 s16, s16, 196608
    s_cmp_eq_u32 s16, s18
    s_cselect_b32 s16, s17, s16
    s_cmp_eq_u32 s75, 1
    s_cbranch_scc1 L_fin
    s_mov_b32 s75, 1
    s_mov_b32 s59, s78
    s_mul_i32 s60, s59, s75
    s_lshl_b32 s21, s67, 18
    s_add_u32 s21, s21, 4194304
    s_lshl_b32 s64, s69, 11
    s_add_u32 s21, s21, s64
    s_lshl_b32 s23, s69, 12
    s_add_u32 s23, s23, 2048
    s_add_u32 s22, s21, 262144
    s_mov_b32 s64, s57
    s_lshl_b32 s65, s64, 14
    s_add_u32 s20, s21, s65
    s_sub_u32 s28, s67, 1
    s_and_b32 s28, s28, 15
    s_lshl_b32 s26, s28, 15
    s_add_u32 s26, s26, 73400320
    s_lshl_b32 s27, s64, 11
    v_lshlrev_b32 v246, 5, v250
    s_lshl_b32 s35, s70, 10
    s_add_u32 s35, s35, 75522048
    s_xor_b32 s36, s70, 1
    s_lshl_b32 s36, s36, 9
    s_sub_u32 s37, s58, 1
    s_and_b32 s37, s37, 7
    s_lshl_b32 s37, s37, 9
    v_mov_b32 v8, s36
    v_writelane_b32 v8, s37, 1
    s_mov_b32 s37, 75571584
    s_mov_b64 exec, 0xffffffff
pl_3163:
    buffer_load_dwordx4 v[240:243], v246, s[80:83], s35 offen sc1
    s_sub_u32 s79, s79, 1
    s_cbranch_scc1 L_abort
    s_waitcnt vmcnt(0)
    v_and_b32 v240, v240, v241
    v_and_b32 v242, v242, v243
    v_and_b32 v240, v240, v242
    v_cmp_ne_u32 vcc, 1, v240
    s_cbranch_vccnz pl_3163
    s_mov_b64 exec, -1
    s_cmp_lg_u32 s78, 0
    s_cbranch_scc1 pl_3163_acq
pl_3163_ok:
    s_lshr_b32 s64, s72, 1
    s_or_b32 s64, s64, s69
    s_cbranch_scc1 rl_3164
    s_lshl_b32 s64, s73, 1
    s_add_u32 s64, s64, s68
    s_lshl_b32 s64, s64, 7
    s_add_u32 s64, s64, 75571200
    v_mov_b32 v242, 0
    v_mov_b32 v243, 1
    s_mov_b64 exec, 1
    buffer_store_dword v243, v242, s[80:83], s64 offen sc0 sc1
    s_mov_b64 exec, -1
rl_3164:
    s_mov_b64 exec, 3
pl_3165:
    buffer_load_dword v240, v8, s[80:83], s37 offen sc1
    s_sub_u32 s79, s79, 1
    s_cbranch_scc1 L_abort
    s_waitcnt vmcnt(0)
    v_cmp_ne_u32 vcc, 1, v240
    s_cbranch_vccnz pl_3165
    s_mov_b64 exec, -1
    s_cmp_lg_u32 s78, 0
    s_cbranch_scc1 pl_3165_acq
pl_3165_ok:
    s_lshr_b32 s40, s2, 3
    s_lshl_b32 s40, s40, 2
    s_add_u32 s40, s40, s69
    s_and_b32 s41, s40, 63
    s_mul_i32 s41, s41, 6144
    s_and_b32 s40, s40, 64
    s_add_u32 s40, s40, s41
    s_add_u32 s40, s40, 384
    s_and_b32 s41, s70, 1
    s_lshl_b32 s41, s41, 10
    s_add_u32 s40, s40, s41
    s_add_u32 s40, s86, s40
    s_addc_u32 s41, s87, 0
    s_cmp_lg_u32 s69, 0
    s_cbranch_scc1 nh_3166
    s_add_u32 s64, s27, 0
    s_and_b32 s64, s64, 0x7fff
    s_mov_b32 m0, 18432
    s_add_u32 s64, s64, s26
    buffer_load_dwordx4 v249, s[80:83], s64 offen sc1 lds
nh_3166:
    s_add_u32 m0, s23, 18432
    s_nop 0
    buffer_load_dwordx4 v249, s[80:83], s20 offen offset:0 sc1 lds
    s_add_u32 m0, s23, 19456
    s_nop 0
    buffer_load_dwordx4 v249, s[80:83], s20 offen offset:1024 sc1 lds
    s_add_u32 s20, s20, 8192
    s_cmp_eq_u32 s20, s22
    s_cselect_b32 s20, s21, s20
    s_cmp_lg_u32 s69, 1
    s_cbranch_scc1 nh_3167
    s_add_u32 s64, s27, 1024
    s_and_b32 s64, s64, 0x7fff
    s_mov_b32 m0, 19456
    s_add_u32 s64, s64, s26
    buffer_load_dwordx4 v249, s[80:83], s64 offen sc1 lds
nh_3167:
    s_add_u32 m0, s23, 19456
    s_nop 0
    buffer_load_dwordx4 v249, s[80:83], s20 offen offset:0 sc1 lds
    s_add_u32 m0, s23, 20480
    s_nop 0
    buffer_load_dwordx4 v249, s[80:83], s20 offen offset:1024 sc1 lds
    s_add_u32 s20, s20, 8192
    s_cmp_eq_u32 s20, s22
    s_cselect_b32 s20, s21, s20
    s_cmp_lg_u32 s69, 2
    s_cbranch_scc1 nh_3168
    s_add_u32 s64, s27, 2048
    s_and_b32 s64, s64, 0x7fff
    s_mov_b32 m0, 36864
    s_add_u32 s64, s64, s26
    buffer_load_dwordx4 v249, s[80:83], s64 offen sc1 lds
nh_3168:
    s_add_u32 m0, s23, 36864
    s_nop 0
    buffer_load_dwordx4 v249, s[80:83], s20 offen offset:0 sc1 lds
    s_add_u32 m0, s23, 37888
    s_nop 0
    buffer_load_dwordx4 v249, s[80:83], s20 offen offset:1024 sc1 lds
    s_add_u32 s20, s20, 8192
    s_cmp_eq_u32 s20, s22
    s_cselect_b32 s20, s21, s20
    s_waitcnt vmcnt(4)
    s_barrier
    s_cmp_lg_u32 s69, 3
    s_cbranch_scc1 nh_3169
    s_add_u32 s64, s27, 3072
    s_and_b32 s64, s64, 0x7fff
    s_mov_b32 m0, 37888
    s_add_u32 s64, s64, s26
    buffer_load_dwordx4 v249, s[80:83], s64 offen sc1 lds
nh_3169:
    s_add_u32 m0, s23, 37888
    s_nop 0
    buffer_load_dwordx4 v249, s[80:83], s20 offen offset:0 sc1 lds
    s_add_u32 m0, s23, 38912
    s_nop 0
    buffer_load_dwordx4 v249, s[80:83], s20 offen offset:1024 sc1 lds
    s_add_u32 s20, s20, 8192
    s_cmp_eq_u32 s20, s22
    s_cselect_b32 s20, s21, s20
    s_cmp_lg_u32 s69, 0
    s_cbranch_scc1 nh_3170
    s_add_u32 s64, s27, 4096
    s_and_b32 s64, s64, 0x7fff
    s_mov_b32 m0, 55296
    s_add_u32 s64, s64, s26
    buffer_load_dwordx4 v249, s[80:83], s64 offen sc1 lds
nh_3170:
    s_add_u32 m0, s23, 55296
    s_nop 0
    buffer_load_dwordx4 v249, s[80:83], s20 offen offset:0 sc1 lds
    s_add_u32 m0, s23, 56320
    s_nop 0
    buffer_load_dwordx4 v249, s[80:83], s20 offen offset:1024 sc1 lds
    s_add_u32 s20, s20, 8192
    s_cmp_eq_u32 s20, s22
    s_cselect_b32 s20, s21, s20
    s_add_u32 s42, s57, 2
    s_and_b32 s42, s42, 15
    s_mul_i32 s42, s42, 393216
    s_add_u32 s44, s40, s42
    s_addc_u32 s45, s41, 0
    s_load_dword s43, s[44:45], 0
    s_load_dword s43, s[44:45], 2048
    s_load_dword s43, s[44:45], 4096
    s_add_u32 s42, s57, 3
    s_and_b32 s42, s42, 15
    s_mul_i32 s42, s42, 393216
    s_add_u32 s44, s40, s42
    s_addc_u32 s45, s41, 0
    s_load_dword s43, s[44:45], 0
    s_load_dword s43, s[44:45], 2048
    s_load_dword s43, s[44:45], 4096
    s_waitcnt vmcnt(4)
    s_barrier
    s_cmp_lg_u32 s69, 1
    s_cbranch_scc1 nh_3171
    s_add_u32 s64, s27, 5120
    s_and_b32 s64, s64, 0x7fff
    s_mov_b32 m0, 56320
    s_add_u32 s64, s64, s26
    buffer_load_dwordx4 v249, s[80:83], s64 offen sc1 lds
nh_3171:
    s_add_u32 m0, s23, 56320
    s_nop 0
    buffer_load_dwordx4 v249, s[80:83], s20 offen offset:0 sc1 lds
    s_add_u32 m0, s23, 57344
    s_nop 0
    buffer_load_dwordx4 v249, s[80:83], s20 offen offset:1024 sc1 lds
    s_add_u32 s20, s20, 8192
    s_cmp_eq_u32 s20, s22
    s_cselect_b32 s20, s21, s20
    s_cmp_lg_u32 s69, 2
    s_cbranch_scc1 nh_3172
    s_add_u32 s64, s27, 6144
    s_and_b32 s64, s64, 0x7fff
    s_mov_b32 m0, 0
    s_add_u32 s64, s64, s26
    buffer_load_dwordx4 v249, s[80:83], s64 offen sc1 lds
nh_3172:
    s_add_u32 m0, s23, 0
    s_nop 0
    buffer_load_dwordx4 v249, s[80:83], s20 offen offset:0 sc1 lds
    s_add_u32 m0, s23, 1024
    s_nop 0
    buffer_load_dwordx4 v249, s[80:83], s20 offen offset:1024 sc1 lds
    s_add_u32 s20, s20, 8192
    s_cmp_eq_u32 s20, s22
    s_cselect_b32 s20, s21, s20
    s_add_u32 m0, s19, 86400
    s_nop 0
    buffer_load_dwordx4 v10, s[8:11], s16 offen lds
    s_add_u32 m0, s19, 87424
    s_nop 0
    buffer_load_dwordx4 v11, s[8:11], s16 offen lds
    s_add_u32 m0, s19, 88448
    s_nop 0
    buffer_load_dwordx4 v12, s[8:11], s16 offen lds
    s_add_u32 s16, s16, 196608
    s_cmp_eq_u32 s16, s18
    s_cselect_b32 s16, s17, s16
    s_cmp_lg_u32 s69, 3
    s_cbranch_scc1 nh_3173
    s_add_u32 s64, s27, 7168
    s_and_b32 s64, s64, 0x7fff
    s_mov_b32 m0, 1024
    s_add_u32 s64, s64, s26
    buffer_load_dwordx4 v249, s[80:83], s64 offen sc1 lds
nh_3173:
    s_add_u32 m0, s23, 1024
    s_nop 0
    buffer_load_dwordx4 v249, s[80:83], s20 offen offset:0 sc1 lds
    s_add_u32 m0, s23, 2048
    s_nop 0
    buffer_load_dwordx4 v249, s[80:83], s20 offen offset:1024 sc1 lds
    s_add_u32 s20, s20, 8192
    s_cmp_eq_u32 s20, s22
    s_cselect_b32 s20, s21, s20
    s_add_u32 s42, s57, 4
    s_and_b32 s42, s42, 15
    s_mul_i32 s42, s42, 393216
    s_add_u32 s44, s40, s42
    s_addc_u32 s45, s41, 0
    s_load_dword s43, s[44:45], 0
    s_load_dword s43, s[44:45], 2048
    s_load_dword s43, s[44:45], 4096
    s_waitcnt vmcnt(9)
    s_barrier
    s_add_u32 m0, s19, 98816
    s_nop 0
    buffer_load_dwordx4 v10, s[8:11], s16 offen lds
    s_add_u32 m0, s19, 99840
    s_nop 0
    buffer_load_dwordx4 v11, s[8:11], s16 offen lds
    s_add_u32 m0, s19, 100864
    s_nop 0
    buffer_load_dwordx4 v12, s[8:11], s16 offen lds
    s_add_u32 s16, s16, 196608
    s_cmp_eq_u32 s16, s18
    s_cselect_b32 s16, s17, s16
    s_cmp_lg_u32 s69, 0
    s_cbranch_scc1 nh_3174
    s_add_u32 s64, s27, 8192
    s_and_b32 s64, s64, 0x7fff
    s_mov_b32 m0, 18432
    s_add_u32 s64, s64, s26
    buffer_load_dwordx4 v249, s[80:83], s64 offen sc1 lds
nh_3174:
    s_add_u32 m0, s23, 18432
    s_nop 0
    buffer_load_dwordx4 v249, s[80:83], s20 offen offset:0 sc1 lds
    s_add_u32 m0, s23, 19456
    s_nop 0
    buffer_load_dwordx4 v249, s[80:83], s20 offen offset:1024 sc1 lds
    s_add_u32 s20, s20, 8192
    s_cmp_eq_u32 s20, s22
    s_cselect_b32 s20, s21, s20
    s_add_u32 m0, s19, 111232
    s_nop 0
    buffer_load_dwordx4 v10, s[8:11], s16 offen lds
    s_add_u32 m0, s19, 112256
    s_nop 0
    buffer_load_dwordx4 v11, s[8:11], s16 offen lds
    s_add_u32 m0, s19, 113280
    s_nop 0
    buffer_load_dwordx4 v12, s[8:11], s16 offen lds
    s_add_u32 s16, s16, 196608
    s_cmp_eq_u32 s16, s18
    s_cselect_b32 s16, s17, s16
    s_cmp_lg_u32 s69, 1
    s_cbranch_scc1 nh_3175
    s_add_u32 s64, s27, 9216
    s_and_b32 s64, s64, 0x7fff
    s_mov_b32 m0, 19456
    s_add_u32 s64, s64, s26
    buffer_load_dwordx4 v249, s[80:83], s64 offen sc1 lds
nh_3175:
    s_add_u32 m0, s23, 19456
    s_nop 0
    buffer_load_dwordx4 v249, s[80:83], s20 offen offset:0 sc1 lds
    s_add_u32 m0, s23, 20480
    s_nop 0
    buffer_load_dwordx4 v249, s[80:83], s20 offen offset:1024 sc1 lds
    s_add_u32 s20, s20, 8192
    s_cmp_eq_u32 s20, s22
    s_cselect_b32 s20, s21, s20
    s_add_u32 s42, s57, 5
    s_and_b32 s42, s42, 15
    s_mul_i32 s42, s42, 393216
    s_add_u32 s44, s40, s42
    s_addc_u32 s45, s41, 0
    s_load_dword s43, s[44:45], 0
    s_load_dword s43, s[44:45], 2048
    s_load_dword s43, s[44:45], 4096
    s_waitcnt vmcnt(12)
    s_barrier
    s_add_u32 m0, s19, 123648
    s_nop 0
    buffer_load_dwordx4 v10, s[8:11], s16 offen lds
    s_add_u32 m0, s19, 124672
    s_nop 0
    buffer_load_dwordx4 v11, s[8:11], s16 offen lds
    s_add_u32 m0, s19, 125696
    s_nop 0
    buffer_load_dwordx4 v12, s[8:11], s16 offen lds
    s_add_u32 s16, s16, 196608
    s_cmp_eq_u32 s16, s18
    s_cselect_b32 s16, s17, s16
    s_cmp_lg_u32 s69, 2
    s_cbranch_scc1 nh_3176
    s_add_u32 s64, s27, 10240
    s_and_b32 s64, s64, 0x7fff
    s_mov_b32 m0, 36864
    s_add_u32 s64, s64, s26
    buffer_load_dwordx4 v249, s[80:83], s64 offen sc1 lds
nh_3176:
    s_add_u32 m0, s23, 36864
    s_nop 0
    buffer_load_dwordx4 v249, s[80:83], s20 offen offset:0 sc1 lds
    s_add_u32 m0, s23, 37888
    s_nop 0
    buffer_load_dwordx4 v249, s[80:83], s20 offen offset:1024 sc1 lds
    s_add_u32 s20, s20, 8192
    s_cmp_eq_u32 s20, s22
    s_cselect_b32 s20, s21, s20
    s_add_u32 m0, s19, 136064
    s_nop 0
    buffer_load_dwordx4 v10, s[8:11], s16 offen lds
    s_add_u32 m0, s19, 137088
    s_nop 0
    buffer_load_dwordx4 v11, s[8:11], s16 offen lds
    s_add_u32 m0, s19, 138112
    s_nop 0
    buffer_load_dwordx4 v12, s[8:11], s16 offen lds
    s_add_u32 s16, s16, 196608
    s_cmp_eq_u32 s16, s18
    s_cselect_b32 s16, s17, s16
    s_cmp_lg_u32 s69, 3
    s_cbranch_scc1 nh_3177
    s_add_u32 s64, s27, 11264
    s_and_b32 s64, s64, 0x7fff
    s_mov_b32 m0, 37888
    s_add_u32 s64, s64, s26
    buffer_load_dwordx4 v249, s[80:83], s64 offen sc1 lds
nh_3177:
    s_add_u32 m0, s23, 37888
    s_nop 0
    buffer_load_dwordx4 v249, s[80:83], s20 offen offset:0 sc1 lds
    s_add_u32 m0, s23, 38912
    s_nop 0
    buffer_load_dwordx4 v249, s[80:83], s20 offen offset:1024 sc1 lds
    s_add_u32 s20, s20, 8192
    s_cmp_eq_u32 s20, s22
    s_cselect_b32 s20, s21, s20
    s_add_u32 s42, s57, 6
    s_and_b32 s42, s42, 15
    s_mul_i32 s42, s42, 393216
    s_add_u32 s44, s40, s42
    s_addc_u32 s45, s41, 0
    s_load_dword s43, s[44:45], 0
    s_load_dword s43, s[44:45], 2048
    s_load_dword s43, s[44:45], 4096
    s_waitcnt vmcnt(12)
    s_barrier
    s_add_u32 m0, s19, 73984
    s_nop 0
    buffer_load_dwordx4 v10, s[8:11], s16 offen lds
    s_add_u32 m0, s19, 75008
    s_nop 0
    buffer_load_dwordx4 v11, s[8:11], s16 offen lds
    s_add_u32 m0, s19, 76032
    s_nop 0
    buffer_load_dwordx4 v12, s[8:11], s16 offen lds
    s_add_u32 s16, s16, 196608
    s_cmp_eq_u32 s16, s18
    s_cselect_b32 s16, s17, s16
    s_cmp_lg_u32 s69, 0
    s_cbranch_scc1 nh_3178
    s_add_u32 s64, s27, 12288
    s_and_b32 s64, s64, 0x7fff
    s_mov_b32 m0, 55296
    s_add_u32 s64, s64, s26
    buffer_load_dwordx4 v249, s[80:83], s64 offen sc1 lds
nh_3178:
    s_add_u32 m0, s23, 55296
    s_nop 0
    buffer_load_dwordx4 v249, s[80:83], s20 offen offset:0 sc1 lds
    s_add_u32 m0, s23, 56320
    s_nop 0
    buffer_load_dwordx4 v249, s[80:83], s20 offen offset:1024 sc1 lds
    s_add_u32 s20, s20, 8192
    s_cmp_eq_u32 s20, s22
    s_cselect_b32 s20, s21, s20
    s_add_u32 m0, s19, 86400
    s_nop 0
    buffer_load_dwordx4 v10, s[8:11], s16 offen lds
    s_add_u32 m0, s19, 87424
    s_nop 0
    buffer_load_dwordx4 v11, s[8:11], s16 offen lds
    s_add_u32 m0, s19, 88448
    s_nop 0
    buffer_load_dwordx4 v12, s[8:11], s16 offen lds
    s_add_u32 s16, s16, 196608
    s_cmp_eq_u32 s16, s18
    s_cselect_b32 s16, s17, s16
    s_cmp_lg_u32 s69, 1
    s_cbranch_scc1 nh_3179
    s_add_u32 s64, s27, 13312
    s_and_b32 s64, s64, 0x7fff
    s_mov_b32 m0, 56320
    s_add_u32 s64, s64, s26
    buffer_load_dwordx4 v249, s[80:83], s64 offen sc1 lds
nh_3179:
    s_add_u32 m0, s23, 56320
    s_nop 0
    buffer_load_dwordx4 v249, s[80:83], s20 offen offset:0 sc1 lds
    s_add_u32 m0, s23, 57344
    s_nop 0
    buffer_load_dwordx4 v249, s[80:83], s20 offen offset:1024 sc1 lds
    s_add_u32 s20, s20, 8192
    s_cmp_eq_u32 s20, s22
    s_cselect_b32 s20, s21, s20
    s_add_u32 s42, s57, 7
    s_and_b32 s42, s42, 15
    s_mul_i32 s42, s42, 393216
    s_add_u32 s44, s40, s42
    s_addc_u32 s45, s41, 0
    s_load_dword s43, s[44:45], 0
    s_load_dword s43, s[44:45], 2048
    s_load_dword s43, s[44:45], 4096
    s_waitcnt vmcnt(12)
    s_barrier
    s_add_u32 m0, s19, 98816
    s_nop 0
    buffer_load_dwordx4 v10, s[8:11], s16 offen lds
    s_add_u32 m0, s19, 99840
    s_nop 0
    buffer_load_dwordx4 v11, s[8:11], s16 offen lds
    s_add_u32 m0, s19, 100864
    s_nop 0
    buffer_load_dwordx4 v12, s[8:11], s16 offen lds
    s_add_u32 s16, s16, 196608
    s_cmp_eq_u32 s16, s18
    s_cselect_b32 s16, s17, s16
    s_cmp_lg_u32 s69, 2
    s_cbranch_scc1 nh_3180
    s_add_u32 s64, s27, 14336
    s_and_b32 s64, s64, 0x7fff
    s_mov_b32 m0, 0
    s_add_u32 s64, s64, s26
    buffer_load_dwordx4 v249, s[80:83], s64 offen sc1 lds
nh_3180:
    s_add_u32 m0, s23, 0
    s_nop 0
    buffer_load_dwordx4 v249, s[80:83], s20 offen offset:0 sc1 lds
    s_add_u32 m0, s23, 1024
    s_nop 0
    buffer_load_dwordx4 v249, s[80:83], s20 offen offset:1024 sc1 lds
    s_add_u32 s20, s20, 8192
    s_cmp_eq_u32 s20, s22
    s_cselect_b32 s20, s21, s20
    s_add_u32 m0, s19, 111232
    s_nop 0
    buffer_load_dwordx4 v10, s[8:11], s16 offen lds
    s_add_u32 m0, s19, 112256
    s_nop 0
    buffer_load_dwordx4 v11, s[8:11], s16 offen lds
    s_add_u32 m0, s19, 113280
    s_nop 0
    buffer_load_dwordx4 v12, s[8:11], s16 offen lds
    s_add_u32 s16, s16, 196608
    s_cmp_eq_u32 s16, s18
    s_cselect_b32 s16, s17, s16
    s_cmp_lg_u32 s69, 3
    s_cbranch_scc1 nh_3181
    s_add_u32 s64, s27, 15360
    s_and_b32 s64, s64, 0x7fff
    s_mov_b32 m0, 1024
    s_add_u32 s64, s64, s26
    buffer_load_dwordx4 v249, s[80:83], s64 offen sc1 lds
nh_3181:
    s_add_u32 m0, s23, 1024
    s_nop 0
    buffer_load_dwordx4 v249, s[80:83], s20 offen offset:0 sc1 lds
    s_add_u32 m0, s23, 2048
    s_nop 0
    buffer_load_dwordx4 v249, s[80:83], s20 offen offset:1024 sc1 lds
    s_add_u32 s20, s20, 8192
    s_cmp_eq_u32 s20, s22
    s_cselect_b32 s20, s21, s20
    s_add_u32 s42, s57, 8
    s_and_b32 s42, s42, 15
    s_mul_i32 s42, s42, 393216
    s_add_u32 s44, s40, s42
    s_addc_u32 s45, s41, 0
    s_load_dword s43, s[44:45], 0
    s_load_dword s43, s[44:45], 2048
    s_load_dword s43, s[44:45], 4096
    s_lshl_b32 s64, s28, 15
    s_add_u32 s64, s64, 71828352
    v_and_b32 v81, 7, v252
    v_lshlrev_b32 v81, 4, v81
    v_lshrrev_b32 v253, 3, v250
    v_lshl_add_u32 v81, v253, 12, v81
    s_cmp_lg_u32 s69, 3
    s_cbranch_scc1 hs_3182
    buffer_load_dwordx4 v[64:67], v81, s[80:83], s64 offen offset:0 sc1
    buffer_load_dwordx4 v[68:71], v81, s[80:83], s64 offen offset:1024 sc1
    buffer_load_dwordx4 v[72:75], v81, s[80:83], s64 offen offset:2048 sc1
    buffer_load_dwordx4 v[76:79], v81, s[80:83], s64 offen offset:3072 sc1
hs_3182:
    s_lshl_b32 s29, s67, 15
    s_lshl_b32 s65, s69, 8
    s_add_u32 s29, s29, s65
    s_add_u32 s29, s29, 71827456
    v_lshlrev_b32 v80, 4, v252
    v_lshl_add_u32 v80, v251, 13, v80
    s_waitcnt vmcnt(12)
    s_barrier
    s_add_u32 m0, s19, 123648
    s_nop 0
    buffer_load_dwordx4 v10, s[8:11], s16 offen lds
    s_add_u32 m0, s19, 124672
    s_nop 0
    buffer_load_dwordx4 v11, s[8:11], s16 offen lds
    s_add_u32 m0, s19, 125696
    s_nop 0
    buffer_load_dwordx4 v12, s[8:11], s16 offen lds
    s_add_u32 s16, s16, 196608
    s_cmp_eq_u32 s16, s18
    s_cselect_b32 s16, s17, s16
    s_cmp_lg_u32 s69, 0
    s_cbranch_scc1 nh_3183
    s_add_u32 s64, s27, 16384
    s_and_b32 s64, s64, 0x7fff
    s_mov_b32 m0, 18432
    s_add_u32 s64, s64, s26
    buffer_load_dwordx4 v249, s[80:83], s64 offen sc1 lds
nh_3183:
    s_add_u32 m0, s23, 18432
    s_nop 0
    buffer_load_dwordx4 v249, s[80:83], s20 offen offset:0 sc1 lds
    s_add_u32 m0, s23, 19456
    s_nop 0
    buffer_load_dwordx4 v249, s[80:83], s20 offen offset:1024 sc1 lds
    s_add_u32 s20, s20, 8192
    s_cmp_eq_u32 s20, s22
    s_cselect_b32 s20, s21, s20
    s_add_u32 m0, s19, 136064
    s_nop 0
    buffer_load_dwordx4 v10, s[8:11], s16 offen lds
    s_add_u32 m0, s19, 137088
    s_nop 0
    buffer_load_dwordx4 v11, s[8:11], s16 offen lds
    s_add_u32 m0, s19, 138112
    s_nop 0
    buffer_load_dwordx4 v12, s[8:11], s16 offen lds
    s_add_u32 s16, s16, 196608
    s_cmp_eq_u32 s16, s18
    s_cselect_b32 s16, s17, s16
    s_cmp_lg_u32 s69, 1
    s_cbranch_scc1 nh_3184
    s_add_u32 s64, s27, 17408
    s_and_b32 s64, s64, 0x7fff
    s_mov_b32 m0, 19456
    s_add_u32 s64, s64, s26
    buffer_load_dwordx4 v249, s[80:83], s64 offen sc1 lds
nh_3184:
    s_add_u32 m0, s23, 19456
    s_nop 0
    buffer_load_dwordx4 v249, s[80:83], s20 offen offset:0 sc1 lds
    s_add_u32 m0, s23, 20480
    s_nop 0
    buffer_load_dwordx4 v249, s[80:83], s20 offen offset:1024 sc1 lds
    s_add_u32 s20, s20, 8192
    s_cmp_eq_u32 s20, s22
    s_cselect_b32 s20, s21, s20
    s_add_u32 s42, s57, 9
    s_and_b32 s42, s42, 15
    s_mul_i32 s42, s42, 393216
    s_add_u32 s44, s40, s42
    s_addc_u32 s45, s41, 0
    s_load_dword s43, s[44:45], 0
    s_load_dword s43, s[44:45], 2048
    s_load_dword s43, s[44:45], 4096
    buffer_load_dwordx4 v[32:35], v80, s[80:83], s29 offen offset:0 sc1
    buffer_load_dwordx4 v[36:39], v80, s[80:83], s29 offen offset:1024 sc1
    s_add_u32 s29, s29, 2048
    s_waitcnt vmcnt(14)
    s_barrier
    s_add_u32 m0, s19, 73984
    s_nop 0
    buffer_load_dwordx4 v10, s[8:11], s16 offen lds
    s_add_u32 m0, s19, 75008
    s_nop 0
    buffer_load_dwordx4 v11, s[8:11], s16 offen lds
    s_add_u32 m0, s19, 76032
    s_nop 0
    buffer_load_dwordx4 v12, s[8:11], s16 offen lds
    s_add_u32 s16, s16, 196608
    s_cmp_eq_u32 s16, s18
    s_cselect_b32 s16, s17, s16
    s_cmp_lg_u32 s69, 2
    s_cbranch_scc1 nh_3185
    s_add_u32 s64, s27, 18432
    s_and_b32 s64, s64, 0x7fff
    s_mov_b32 m0, 36864
    s_add_u32 s64, s64, s26
    buffer_load_dwordx4 v249, s[80:83], s64 offen sc1 lds
nh_3185:
    s_add_u32 m0, s23, 36864
    s_nop 0
    buffer_load_dwordx4 v249, s[80:83], s20 offen offset:0 sc1 lds
    s_add_u32 m0, s23, 37888
    s_nop 0
    buffer_load_dwordx4 v249, s[80:83], s20 offen offset:1024 sc1 lds
    s_add_u32 s20, s20, 8192
    s_cmp_eq_u32 s20, s22
    s_cselect_b32 s20, s21, s20
    s_add_u32 m0, s19, 86400
    s_nop 0
    buffer_load_dwordx4 v10, s[8:11], s16 offen lds
    s_add_u32 m0, s19, 87424
    s_nop 0
    buffer_load_dwordx4 v11, s[8:11], s16 offen lds
    s_add_u32 m0, s19, 88448
    s_nop 0
    buffer_load_dwordx4 v12, s[8:11], s16 offen lds
    s_add_u32 s16, s16, 196608
    s_cmp_eq_u32 s16, s18
    s_cselect_b32 s16, s17, s16
    s_cmp_lg_u32 s69, 3
    s_cbranch_scc1 nh_3186
    s_add_u32 s64, s27, 19456
    s_and_b32 s64, s64, 0x7fff
    s_mov_b32 m0, 37888
    s_add_u32 s64, s64, s26
    buffer_load_dwordx4 v249, s[80:83], s64 offen sc1 lds
nh_3186:
    s_add_u32 m0, s23, 37888
    s_nop 0
    buffer_load_dwordx4 v249, s[80:83], s20 offen offset:0 sc1 lds
    s_add_u32 m0, s23, 38912
    s_nop 0
    buffer_load_dwordx4 v249, s[80:83], s20 offen offset:1024 sc1 lds
    s_add_u32 s20, s20, 8192
    s_cmp_eq_u32 s20, s22
    s_cselect_b32 s20, s21, s20
    s_add_u32 s42, s57, 10
    s_and_b32 s42, s42, 15
    s_mul_i32 s42, s42, 393216
    s_add_u32 s44, s40, s42
    s_addc_u32 s45, s41, 0
    s_load_dword s43, s[44:45], 0
    s_load_dword s43, s[44:45], 2048
    s_load_dword s43, s[44:45], 4096
    buffer_load_dwordx4 v[40:43], v80, s[80:83], s29 offen offset:0 sc1
    buffer_load_dwordx4 v[44:47], v80, s[80:83], s29 offen offset:1024 sc1
    s_add_u32 s29, s29, 2048
    s_waitcnt vmcnt(16)
    s_barrier
    s_add_u32 m0, s19, 98816
    s_nop 0
    buffer_load_dwordx4 v10, s[8:11], s16 offen lds
    s_add_u32 m0, s19, 99840
    s_nop 0
    buffer_load_dwordx4 v11, s[8:11], s16 offen lds
    s_add_u32 m0, s19, 100864
    s_nop 0
    buffer_load_dwordx4 v12, s[8:11], s16 offen lds
    s_add_u32 s16, s16, 196608
    s_cmp_eq_u32 s16, s18
    s_cselect_b32 s16, s17, s16
    s_cmp_lg_u32 s69, 0
    s_cbranch_scc1 nh_3187
    s_add_u32 s64, s27, 20480
    s_and_b32 s64, s64, 0x7fff
    s_mov_b32 m0, 55296
    s_add_u32 s64, s64, s26
    buffer_load_dwordx4 v249, s[80:83], s64 offen sc1 lds
nh_3187:
    s_add_u32 m0, s23, 55296
    s_nop 0
    buffer_load_dwordx4 v249, s[80:83], s20 offen offset:0 sc1 lds
    s_add_u32 m0, s23, 56320
    s_nop 0
    buffer_load_dwordx4 v249, s[80:83], s20 offen offset:1024 sc1 lds
    s_add_u32 s20, s20, 8192
    s_cmp_eq_u32 s20, s22
    s_cselect_b32 s20, s21, s20
    s_add_u32 m0, s19, 111232
    s_nop 0
    buffer_load_dwordx4 v10, s[8:11], s16 offen lds
    s_add_u32 m0, s19, 112256
    s_nop 0
    buffer_load_dwordx4 v11, s[8:11], s16 offen lds
    s_add_u32 m0, s19, 113280
    s_nop 0
    buffer_load_dwordx4 v12, s[8:11], s16 offen lds
    s_add_u32 s16, s16, 196608
    s_cmp_eq_u32 s16, s18
    s_cselect_b32 s16, s17, s16
    s_cmp_lg_u32 s69, 1
    s_cbranch_scc1 nh_3188
    s_add_u32 s64, s27, 21504
    s_and_b32 s64, s64, 0x7fff
    s_mov_b32 m0, 56320
    s_add_u32 s64, s64, s26
    buffer_load_dwordx4 v249, s[80:83], s64 offen sc1 lds
nh_3188:
    s_add_u32 m0, s23, 56320
    s_nop 0
    buffer_load_dwordx4 v249, s[80:83], s20 offen offset:0 sc1 lds
    s_add_u32 m0, s23, 57344
    s_nop 0
    buffer_load_dwordx4 v249, s[80:83], s20 offen offset:1024 sc1 lds
    s_add_u32 s20, s20, 8192
    s_cmp_eq_u32 s20, s22
    s_cselect_b32 s20, s21, s20
    s_add_u32 s42, s57, 11
    s_and_b32 s42, s42, 15
    s_mul_i32 s42, s42, 393216
    s_add_u32 s44, s40, s42
    s_addc_u32 s45, s41, 0
    s_load_dword s43, s[44:45], 0
    s_load_dword s43, s[44:45], 2048
    s_load_dword s43, s[44:45], 4096
    buffer_load_dwordx4 v[48:51], v80, s[80:83], s29 offen offset:0 sc1
    buffer_load_dwordx4 v[52:55], v80, s[80:83], s29 offen offset:1024 sc1
    s_add_u32 s29, s29, 2048
    s_waitcnt vmcnt(16)
    s_barrier
    s_add_u32 m0, s19, 123648
    s_nop 0
    buffer_load_dwordx4 v10, s[8:11], s16 offen lds
    s_add_u32 m0, s19, 124672
    s_nop 0
    buffer_load_dwordx4 v11, s[8:11], s16 offen lds
    s_add_u32 m0, s19, 125696
    s_nop 0
    buffer_load_dwordx4 v12, s[8:11], s16 offen lds
    s_add_u32 s16, s16, 196608
    s_cmp_eq_u32 s16, s18
    s_cselect_b32 s16, s17, s16
    s_cmp_lg_u32 s69, 2
    s_cbranch_scc1 nh_3189
    s_add_u32 s64, s27, 22528
    s_and_b32 s64, s64, 0x7fff
    s_mov_b32 m0, 0
    s_add_u32 s64, s64, s26
    buffer_load_dwordx4 v249, s[80:83], s64 offen sc1 lds
nh_3189:
    s_add_u32 m0, s23, 0
    s_nop 0
    buffer_load_dwordx4 v249, s[80:83], s20 offen offset:0 sc1 lds
    s_add_u32 m0, s23, 1024
    s_nop 0
    buffer_load_dwordx4 v249, s[80:83], s20 offen offset:1024 sc1 lds
    s_add_u32 s20, s20, 8192
    s_cmp_eq_u32 s20, s22
    s_cselect_b32 s20, s21, s20
    s_add_u32 m0, s19, 136064
    s_nop 0
    buffer_load_dwordx4 v10, s[8:11], s16 offen lds
    s_add_u32 m0, s19, 137088
    s_nop 0
    buffer_load_dwordx4 v11, s[8:11], s16 offen lds
    s_add_u32 m0, s19, 138112
    s_nop 0
    buffer_load_dwordx4 v12, s[8:11], s16 offen lds
    s_add_u32 s16, s16, 196608
    s_cmp_eq_u32 s16, s18
    s_cselect_b32 s16, s17, s16
    s_cmp_lg_u32 s69, 3
    s_cbranch_scc1 nh_3190
    s_add_u32 s64, s27, 23552
    s_and_b32 s64, s64, 0x7fff
    s_mov_b32 m0, 1024
    s_add_u32 s64, s64, s26
    buffer_load_dwordx4 v249, s[80:83], s64 offen sc1 lds
nh_3190:
    s_add_u32 m0, s23, 1024
    s_nop 0
    buffer_load_dwordx4 v249, s[80:83], s20 offen offset:0 sc1 lds
    s_add_u32 m0, s23, 2048
    s_nop 0
    buffer_load_dwordx4 v249, s[80:83], s20 offen offset:1024 sc1 lds
    s_add_u32 s20, s20, 8192
    s_cmp_eq_u32 s20, s22
    s_cselect_b32 s20, s21, s20
    s_add_u32 s42, s57, 12
    s_and_b32 s42, s42, 15
    s_mul_i32 s42, s42, 393216
    s_add_u32 s44, s40, s42
    s_addc_u32 s45, s41, 0
    s_load_dword s43, s[44:45], 0
    s_load_dword s43, s[44:45], 2048
    s_load_dword s43, s[44:45], 4096
    buffer_load_dwordx4 v[56:59], v80, s[80:83], s29 offen offset:0 sc1
    buffer_load_dwordx4 v[60:63], v80, s[80:83], s29 offen offset:1024 sc1
    s_add_u32 s29, s29, 2048
    s_waitcnt vmcnt(16)
    s_barrier
    s_add_u32 m0, s19, 73984
    s_nop 0
    buffer_load_dwordx4 v10, s[8:11], s16 offen lds
    s_add_u32 m0, s19, 75008
    s_nop 0
    buffer_load_dwordx4 v11, s[8:11], s16 offen lds
    s_add_u32 m0, s19, 76032
    s_nop 0
    buffer_load_dwordx4 v12, s[8:11], s16 offen lds
    s_add_u32 s16, s16, 196608
    s_cmp_eq_u32 s16, s18
    s_cselect_b32 s16, s17, s16
    s_cmp_lg_u32 s69, 0
    s_cbranch_scc1 nh_3191
    s_add_u32 s64, s27, 24576
    s_and_b32 s64, s64, 0x7fff
    s_mov_b32 m0, 18432
    s_add_u32 s64, s64, s26
    buffer_load_dwordx4 v249, s[80:83], s64 offen sc1 lds
nh_3191:
    s_add_u32 m0, s23, 18432
    s_nop 0
    buffer_load_dwordx4 v249, s[80:83], s20 offen offset:0 sc1 lds
    s_add_u32 m0, s23, 19456
    s_nop 0
    buffer_load_dwordx4 v249, s[80:83], s20 offen offset:1024 sc1 lds
    s_add_u32 s20, s20, 8192
    s_cmp_eq_u32 s20, s22
    s_cselect_b32 s20, s21, s20
    s_add_u32 m0, s19, 86400
    s_nop 0
    buffer_load_dwordx4 v10, s[8:11], s16 offen lds
    s_add_u32 m0, s19, 87424
    s_nop 0
    buffer_load_dwordx4 v11, s[8:11], s16 offen lds
    s_add_u32 m0, s19, 88448
    s_nop 0
    buffer_load_dwordx4 v12, s[8:11], s16 offen lds
    s_add_u32 s16, s16, 196608
    s_cmp_eq_u32 s16, s18
    s_cselect_b32 s16, s17, s16
    s_cmp_lg_u32 s69, 1
    s_cbranch_scc1 nh_3192
    s_add_u32 s64, s27, 25600
    s_and_b32 s64, s64, 0x7fff
    s_mov_b32 m0, 19456
    s_add_u32 s64, s64, s26
    buffer_load_dwordx4 v249, s[80:83], s64 offen sc1 lds
nh_3192:
    s_add_u32 m0, s23, 19456
    s_nop 0
    buffer_load_dwordx4 v249, s[80:83], s20 offen offset:0 sc1 lds
    s_add_u32 m0, s23, 20480
    s_nop 0
    buffer_load_dwordx4 v249, s[80:83], s20 offen offset:1024 sc1 lds
    s_add_u32 s20, s20, 8192
    s_cmp_eq_u32 s20, s22
    s_cselect_b32 s20, s21, s20
    s_add_u32 s42, s57, 13
    s_and_b32 s42, s42, 15
    s_mul_i32 s42, s42, 393216
    s_add_u32 s44, s40, s42
    s_addc_u32 s45, s41, 0
    s_load_dword s43, s[44:45], 0
    s_load_dword s43, s[44:45], 2048
    s_load_dword s43, s[44:45], 4096
    s_waitcnt vmcnt(14)
    s_barrier
    s_add_u32 m0, s19, 98816
    s_nop 0
    buffer_load_dwordx4 v10, s[8:11], s16 offen lds
    s_add_u32 m0, s19, 99840
    s_nop 0
    buffer_load_dwordx4 v11, s[8:11], s16 offen lds
    s_add_u32 m0, s19, 100864
    s_nop 0
    buffer_load_dwordx4 v12, s[8:11], s16 offen lds
    s_add_u32 s16, s16, 196608
    s_cmp_eq_u32 s16, s18
    s_cselect_b32 s16, s17, s16
    s_waitcnt vmcnt(13)
    s_lshl_b32 s29, s69, 8
    s_add_u32 s29, s29, 159872
    v_add_f32 v32, v32, v48
    v_add_f32 v33, v33, v49
    v_add_f32 v34, v34, v50
    v_add_f32 v35, v35, v51
    v_add_f32 v36, v36, v52
    v_add_f32 v37, v37, v53
    v_add_f32 v38, v38, v54
    v_add_f32 v39, v39, v55
    v_add_f32 v40, v40, v56
    v_add_f32 v41, v41, v57
    v_add_f32 v42, v42, v58
    v_add_f32 v43, v43, v59
    v_add_f32 v44, v44, v60
    v_add_f32 v45, v45, v61
    s_cmp_lg_u32 s69, 2
    s_cbranch_scc1 nh_3193
    s_add_u32 s64, s27, 26624
    s_and_b32 s64, s64, 0x7fff
    s_mov_b32 m0, 36864
    s_add_u32 s64, s64, s26
    buffer_load_dwordx4 v249, s[80:83], s64 offen sc1 lds
nh_3193:
    s_add_u32 m0, s23, 36864
    s_nop 0
    buffer_load_dwordx4 v249, s[80:83], s20 offen offset:0 sc1 lds
    s_add_u32 m0, s23, 37888
    s_nop 0
    buffer_load_dwordx4 v249, s[80:83], s20 offen offset:1024 sc1 lds
    s_add_u32 s20, s20, 8192
    s_cmp_eq_u32 s20, s22
    s_cselect_b32 s20, s21, s20
    s_add_u32 m0, s19, 111232
    s_nop 0
    buffer_load_dwordx4 v10, s[8:11], s16 offen lds
    s_add_u32 m0, s19, 112256
    s_nop 0
    buffer_load_dwordx4 v11, s[8:11], s16 offen lds
    s_add_u32 m0, s19, 113280
    s_nop 0
    buffer_load_dwordx4 v12, s[8:11], s16 offen lds
    s_add_u32 s16, s16, 196608
    s_cmp_eq_u32 s16, s18
    s_cselect_b32 s16, s17, s16
    s_cmp_lg_u32 s69, 3
    s_cbranch_scc1 nh_3194
    s_add_u32 s64, s27, 27648
    s_and_b32 s64, s64, 0x7fff
    s_mov_b32 m0, 37888
    s_add_u32 s64, s64, s26
    buffer_load_dwordx4 v249, s[80:83], s64 offen sc1 lds
nh_3194:
    s_add_u32 m0, s23, 37888
    s_nop 0
    buffer_load_dwordx4 v249, s[80:83], s20 offen offset:0 sc1 lds
    s_add_u32 m0, s23, 38912
    s_nop 0
    buffer_load_dwordx4 v249, s[80:83], s20 offen offset:1024 sc1 lds
    s_add_u32 s20, s20, 8192
    s_cmp_eq_u32 s20, s22
    s_cselect_b32 s20, s21, s20
    s_add_u32 s42, s57, 14
    s_and_b32 s42, s42, 15
    s_mul_i32 s42, s42, 393216
    s_add_u32 s44, s40, s42
    s_addc_u32 s45, s41, 0
    s_load_dword s43, s[44:45], 0
    s_load_dword s43, s[44:45], 2048
    s_load_dword s43, s[44:45], 4096
    s_waitcnt vmcnt(12)
    s_barrier
    s_add_u32 m0, s19, 123648
    s_nop 0
    buffer_load_dwordx4 v10, s[8:11], s16 offen lds
    s_add_u32 m0, s19, 124672
    s_nop 0
    buffer_load_dwordx4 v11, s[8:11], s16 offen lds
    s_add_u32 m0, s19, 125696
    s_nop 0
    buffer_load_dwordx4 v12, s[8:11], s16 offen lds
    s_add_u32 s16, s16, 196608
    s_cmp_eq_u32 s16, s18
    s_cselect_b32 s16, s17, s16
    v_add_f32 v46, v46, v62
    v_add_f32 v47, v47, v63
    v_add_f32 v32, v32, v40
    v_add_f32 v33, v33, v41
    v_add_f32 v34, v34, v42
    v_add_f32 v35, v35, v43
    v_add_f32 v36, v36, v44
    v_add_f32 v37, v37, v45
    v_add_f32 v38, v38, v46
    v_add_f32 v39, v39, v47
    v_add_f32 v32, v32, v36
    v_add_f32 v33, v33, v37
    v_add_f32 v34, v34, v38
    v_add_f32 v35, v35, v39
    v_and_b32 v80, 15, v252
    v_and_b32 v36, 1, v251
    s_cmp_lg_u32 s69, 0
    s_cbranch_scc1 nh_3195
    s_add_u32 s64, s27, 28672
    s_and_b32 s64, s64, 0x7fff
    s_mov_b32 m0, 55296
    s_add_u32 s64, s64, s26
    buffer_load_dwordx4 v249, s[80:83], s64 offen sc1 lds
nh_3195:
    s_add_u32 m0, s23, 55296
    s_nop 0
    buffer_load_dwordx4 v249, s[80:83], s20 offen offset:0 sc1 lds
    s_add_u32 m0, s23, 56320
    s_nop 0
    buffer_load_dwordx4 v249, s[80:83], s20 offen offset:1024 sc1 lds
    s_add_u32 s20, s20, 8192
    s_cmp_eq_u32 s20, s22
    s_cselect_b32 s20, s21, s20
    s_add_u32 m0, s19, 136064
    s_nop 0
    buffer_load_dwordx4 v10, s[8:11], s16 offen lds
    s_add_u32 m0, s19, 137088
    s_nop 0
    buffer_load_dwordx4 v11, s[8:11], s16 offen lds
    s_add_u32 m0, s19, 138112
    s_nop 0
    buffer_load_dwordx4 v12, s[8:11], s16 offen lds
    s_add_u32 s16, s16, 196608
    s_cmp_eq_u32 s16, s18
    s_cselect_b32 s16, s17, s16
    s_cmp_lg_u32 s69, 1
    s_cbranch_scc1 nh_3196
    s_add_u32 s64, s27, 29696
    s_and_b32 s64, s64, 0x7fff
    s_mov_b32 m0, 56320
    s_add_u32 s64, s64, s26
    buffer_load_dwordx4 v249, s[80:83], s64 offen sc1 lds
nh_3196:
    s_add_u32 m0, s23, 56320
    s_nop 0
    buffer_load_dwordx4 v249, s[80:83], s20 offen offset:0 sc1 lds
    s_add_u32 m0, s23, 57344
    s_nop 0
    buffer_load_dwordx4 v249, s[80:83], s20 offen offset:1024 sc1 lds
    s_add_u32 s20, s20, 8192
    s_cmp_eq_u32 s20, s22
    s_cselect_b32 s20, s21, s20
    s_add_u32 s42, s57, 15
    s_and_b32 s42, s42, 15
    s_mul_i32 s42, s42, 393216
    s_add_u32 s44, s40, s42
    s_addc_u32 s45, s41, 0
    s_load_dword s43, s[44:45], 0
    s_load_dword s43, s[44:45], 2048
    s_load_dword s43, s[44:45], 4096
    s_waitcnt vmcnt(12)
    s_barrier
    s_add_u32 m0, s19, 73984
    s_nop 0
    buffer_load_dwordx4 v10, s[8:11], s16 offen lds
    s_add_u32 m0, s19, 75008
    s_nop 0
    buffer_load_dwordx4 v11, s[8:11], s16 offen lds
    s_add_u32 m0, s19, 76032
    s_nop 0
    buffer_load_dwordx4 v12, s[8:11], s16 offen lds
    s_add_u32 s16, s16, 196608
    s_cmp_eq_u32 s16, s18
    s_cselect_b32 s16, s17, s16
    v_permlane16_swap_b32 v32, v34
    v_permlane16_swap_b32 v33, v35
    v_add_f32 v32, v32, v34
    v_add_f32 v33, v33, v35
    v_mov_b32 v34, v32
    v_mov_b32 v35, v33
    v_lshl_add_u32 v80, v80, 1, v36
    v_lshlrev_b32 v80, 3, v80
    v_permlane32_swap_b32 v32, v34
    v_permlane32_swap_b32 v33, v35
    v_add_f32 v32, v32, v34
    v_add_f32 v33, v33, v35
    v_mul_f32 v32, 0x3a800000, v32
    v_mul_f32 v33, 0x3a800000, v33
    s_cmp_lg_u32 s69, 2
    s_cbranch_scc1 nh_3197
    s_add_u32 s64, s27, 30720
    s_and_b32 s64, s64, 0x7fff
    s_mov_b32 m0, 0
    s_add_u32 s64, s64, s26
    buffer_load_dwordx4 v249, s[80:83], s64 offen sc1 lds
nh_3197:
    s_add_u32 m0, s23, 0
    s_nop 0
    buffer_load_dwordx4 v249, s[80:83], s20 offen offset:0 sc1 lds
    s_add_u32 m0, s23, 1024
    s_nop 0
    buffer_load_dwordx4 v249, s[80:83], s20 offen offset:1024 sc1 lds
    s_add_u32 s20, s20, 8192
    s_cmp_eq_u32 s20, s22
    s_cselect_b32 s20, s21, s20
    s_add_u32 m0, s19, 86400
    s_nop 0
    buffer_load_dwordx4 v10, s[8:11], s16 offen lds
    s_add_u32 m0, s19, 87424
    s_nop 0
    buffer_load_dwordx4 v11, s[8:11], s16 offen lds
    s_add_u32 m0, s19, 88448
    s_nop 0
    buffer_load_dwordx4 v12, s[8:11], s16 offen lds
    s_add_u32 s16, s16, 196608
    s_cmp_eq_u32 s16, s18
    s_cselect_b32 s16, s17, s16
    s_cmp_lg_u32 s69, 3
    s_cbranch_scc1 nh_3198
    s_add_u32 s64, s27, 31744
    s_and_b32 s64, s64, 0x7fff
    s_mov_b32 m0, 1024
    s_add_u32 s64, s64, s26
    buffer_load_dwordx4 v249, s[80:83], s64 offen sc1 lds
nh_3198:
    s_add_u32 m0, s23, 1024
    s_nop 0
    buffer_load_dwordx4 v249, s[80:83], s20 offen offset:0 sc1 lds
    s_add_u32 m0, s23, 2048
    s_nop 0
    buffer_load_dwordx4 v249, s[80:83], s20 offen offset:1024 sc1 lds
    s_add_u32 s20, s20, 8192
    s_cmp_eq_u32 s20, s22
    s_cselect_b32 s20, s21, s20
    s_waitcnt vmcnt(12)
    s_barrier
    s_add_u32 m0, s19, 98816
    s_nop 0
    buffer_load_dwordx4 v10, s[8:11], s16 offen lds
    s_add_u32 m0, s19, 99840
    s_nop 0
    buffer_load_dwordx4 v11, s[8:11], s16 offen lds
    s_add_u32 m0, s19, 100864
    s_nop 0
    buffer_load_dwordx4 v12, s[8:11], s16 offen lds
    s_add_u32 s16, s16, 196608
    s_cmp_eq_u32 s16, s18
    s_cselect_b32 s16, s17, s16
    s_lshl_b32 s64, s67, 4
    s_add_u32 s64, s64, s74
    s_lshl_b32 s64, s64, 2
    s_add_u32 s64, s64, s69
    s_lshl_b32 s64, s64, 12
    s_lshl_b32 s65, s75, 22
    s_add_u32 s64, s64, s65
    s_add_u32 s64, s64, 12582912
    s_cmp_eq_u32 s68, 0
    s_cselect_b32 s64, s64, 0x7f000000
    v_lshlrev_b32 v253, 7, v250
    s_mov_b64 exec, 0xffffffff
    buffer_load_dword v9, v253, s[80:83], s64 offen sc1
    s_mov_b64 exec, -1
    s_mov_b32 s12, s88
    s_mov_b32 s13, s89
    s_mov_b32 s14, 2097152
    s_mov_b32 s15, 0x00020000
    v_lshrrev_b32 v253, 3, v250
    v_lshlrev_b32 v253, 13, v253
    v_and_b32 v254, 7, v250
    v_lshl_add_u32 v253, v254, 4, v253
    s_lshl_b32 s64, s69, 11
    v_add_u32 v244, s64, v253
    s_mul_i32 s51, s69, 1056
    s_lshl_b32 s49, s72, 7
    s_add_u32 s48, s58, 0
    s_and_b32 s48, s48, 7
    s_and_b32 s66, s74, 8
    s_or_b32 s48, s48, s66
    s_lshl_b32 s48, s48, 17
    s_add_u32 s48, s48, s49
    s_add_u32 m0, s51, 116224
    s_nop 0
    buffer_load_dwordx4 v244, s[12:15], s48 offen lds
    s_add_u32 s48, s48, 65536
    s_waitcnt vmcnt(7)
    s_barrier
    v_fma_f32 v33, -v32, v32, v33
    v_max_f32 v33, 0, v33
    v_cvt_pk_bf16_f32 v32, v32, v32
    v_lshlrev_b32 v32, 16, v32
    v_cvt_pk_bf16_f32 v33, v33, v33
    v_lshlrev_b32 v33, 16, v33
    v_add_f32 v33, 0x3727c5ac, v33
    v_cvt_pk_bf16_f32 v33, v33, v33
    v_lshlrev_b32 v33, 16, v33
    v_sqrt_f32 v33, v33
    s_nop 0
    v_cvt_pk_bf16_f32 v33, v33, v33
    v_lshlrev_b32 v33, 16, v33
    v_rcp_f32 v33, v33
    s_nop 0
    v_add_u32 v80, s29, v80
    ds_write_b64 v80, v[32:33]
    s_add_u32 m0, s51, 120448
    s_nop 0
    buffer_load_dwordx4 v244, s[12:15], s48 offen lds
    s_add_u32 s48, s48, 65536
    s_add_u32 s48, s58, 1
    s_and_b32 s48, s48, 7
    s_and_b32 s66, s74, 8
    s_or_b32 s48, s48, s66
    s_lshl_b32 s48, s48, 17
    s_add_u32 s48, s48, s49
    s_add_u32 m0, s51, 124672
    s_nop 0
    buffer_load_dwordx4 v244, s[12:15], s48 offen lds
    s_add_u32 s48, s48, 65536
    s_add_u32 m0, s51, 128896
    s_nop 0
    buffer_load_dwordx4 v244, s[12:15], s48 offen lds
    s_add_u32 s48, s48, 65536
    s_add_u32 s48, s58, 2
    s_and_b32 s48, s48, 7
    s_and_b32 s66, s74, 8
    s_or_b32 s48, s48, s66
    s_lshl_b32 s48, s48, 17
    s_add_u32 s48, s48, s49
    s_add_u32 m0, s51, 133120
    s_nop 0
    buffer_load_dwordx4 v244, s[12:15], s48 offen lds
    s_add_u32 s48, s48, 65536
    s_add_u32 m0, s51, 137344
    s_nop 0
    buffer_load_dwordx4 v244, s[12:15], s48 offen lds
    s_add_u32 s48, s48, 65536
    s_add_u32 s48, s58, 3
    s_and_b32 s48, s48, 7
    s_and_b32 s66, s74, 8
    s_or_b32 s48, s48, s66
    s_lshl_b32 s48, s48, 17
    s_add_u32 s48, s48, s49
    s_add_u32 m0, s51, 141568
    s_nop 0
    buffer_load_dwordx4 v244, s[12:15], s48 offen lds
    s_add_u32 s48, s48, 65536
    s_add_u32 m0, s51, 145792
    s_nop 0
    buffer_load_dwordx4 v244, s[12:15], s48 offen lds
    s_add_u32 s48, s48, 65536
    s_add_u32 s48, s58, 4
    s_and_b32 s48, s48, 7
    s_and_b32 s66, s74, 8
    s_or_b32 s48, s48, s66
    s_lshl_b32 s48, s48, 17
    s_add_u32 s48, s48, s49
    s_add_u32 m0, s51, 150016
    s_nop 0
    buffer_load_dwordx4 v244, s[12:15], s48 offen lds
    s_add_u32 s48, s48, 65536
    s_waitcnt vmcnt(10)
    s_barrier
    s_cmp_lg_u32 s69, 3
    s_cbranch_scc1 hf_3199
    v_add_f32 v64, v64, v72
    v_add_f32 v65, v65, v73
    v_add_f32 v66, v66, v74
    v_add_f32 v67, v67, v75
    v_add_f32 v68, v68, v76
    v_add_f32 v69, v69, v77
    v_add_f32 v70, v70, v78
    v_add_f32 v71, v71, v79
    v_add_f32 v64, v64, v68
    v_add_f32 v65, v65, v69
    v_add_f32 v66, v66, v70
    v_add_f32 v67, v67, v71
    v_and_b32 v81, 7, v252
    v_and_b32 v68, 1, v251
    v_add_f32_dpp v64, v64, v64 row_ror:8 row_mask:0xf bank_mask:0xf
    v_add_f32_dpp v65, v65, v65 row_ror:8 row_mask:0xf bank_mask:0xf
    v_add_f32_dpp v66, v66, v66 row_ror:8 row_mask:0xf bank_mask:0xf
    v_add_f32_dpp v67, v67, v67 row_ror:8 row_mask:0xf bank_mask:0xf
    s_nop 0
    v_permlane16_swap_b32 v64, v66
    v_permlane16_swap_b32 v65, v67
    v_add_f32 v64, v64, v66
    v_add_f32 v65, v65, v67
    v_mov_b32 v66, v64
    v_mov_b32 v67, v65
    v_lshl_add_u32 v81, v81, 1, v68
    v_lshlrev_b32 v81, 3, v81
    v_permlane32_swap_b32 v64, v66
    v_permlane32_swap_b32 v65, v67
    v_add_f32 v64, v64, v66
    v_add_f32 v65, v65, v67
    v_mul_f32 v64, 0x3a800000, v64
    v_mul_f32 v65, 0x3a800000, v65
    v_fma_f32 v65, -v64, v64, v65
    v_max_f32 v65, 0, v65
    v_cvt_pk_bf16_f32 v64, v64, v64
    v_lshlrev_b32 v64, 16, v64
    v_cvt_pk_bf16_f32 v65, v65, v65
    v_lshlrev_b32 v65, 16, v65
    v_add_f32 v65, 0x3727c5ac, v65
    v_cvt_pk_bf16_f32 v65, v65, v65
    v_lshlrev_b32 v65, 16, v65
    v_sqrt_f32 v65, v65
    s_nop 0
    v_cvt_pk_bf16_f32 v65, v65, v65
    v_lshlrev_b32 v65, 16, v65
    v_rcp_f32 v65, v65
    s_nop 0
    v_add_u32 v81, 159744, v81
    ds_write_b64 v81, v[64:65]
hf_3199:
    s_add_u32 m0, s51, 154240
    s_nop 0
    buffer_load_dwordx4 v244, s[12:15], s48 offen lds
    s_add_u32 s48, s48, 65536
    s_add_u32 s48, s58, 5
    s_and_b32 s48, s48, 7
    s_and_b32 s66, s74, 8
    s_or_b32 s48, s48, s66
    s_lshl_b32 s48, s48, 17
    s_add_u32 s48, s48, s49
    s_add_u32 m0, s51, 65536
    s_nop 0
    buffer_load_dwordx4 v244, s[12:15], s48 offen lds
    s_add_u32 s48, s48, 65536
    s_add_u32 m0, s51, 69760
    s_nop 0
    buffer_load_dwordx4 v244, s[12:15], s48 offen lds
    s_add_u32 s48, s48, 65536
    s_add_u32 s48, s58, 6
    s_and_b32 s48, s48, 7
    s_and_b32 s66, s74, 8
    s_or_b32 s48, s48, s66
    s_lshl_b32 s48, s48, 17
    s_add_u32 s48, s48, s49
    s_add_u32 m0, s51, 73984
    s_nop 0
    buffer_load_dwordx4 v244, s[12:15], s48 offen lds
    s_add_u32 s48, s48, 65536
    s_add_u32 m0, s51, 78208
    s_nop 0
    buffer_load_dwordx4 v244, s[12:15], s48 offen lds
    s_add_u32 s48, s48, 65536
    s_add_u32 s48, s58, 7
    s_and_b32 s48, s48, 7
    s_and_b32 s66, s74, 8
    s_or_b32 s48, s48, s66
    s_lshl_b32 s48, s48, 17
    s_add_u32 s48, s48, s49
    s_add_u32 m0, s51, 82432
    s_nop 0
    buffer_load_dwordx4 v244, s[12:15], s48 offen lds
    s_add_u32 s48, s48, 65536
    s_add_u32 m0, s51, 86656
    s_nop 0
    buffer_load_dwordx4 v244, s[12:15], s48 offen lds
    s_add_u32 s48, s48, 65536
    s_add_u32 s48, s58, 8
    s_and_b32 s48, s48, 7
    s_and_b32 s66, s74, 8
    s_xor_b32 s66, s66, 8
    s_or_b32 s48, s48, s66
    s_lshl_b32 s48, s48, 17
    s_add_u32 s48, s48, s49
    s_add_u32 m0, s51, 90880
    s_nop 0
    buffer_load_dwordx4 v244, s[12:15], s48 offen lds
    s_add_u32 s48, s48, 65536
    s_waitcnt lgkmcnt(0)
    s_barrier
    s_add_u32 m0, s51, 95104
    s_nop 0
    buffer_load_dwordx4 v244, s[12:15], s48 offen lds
    s_add_u32 s48, s48, 65536
    s_add_u32 s48, s58, 9
    s_and_b32 s48, s48, 7
    s_and_b32 s66, s74, 8
    s_xor_b32 s66, s66, 8
    s_or_b32 s48, s48, s66
    s_lshl_b32 s48, s48, 17
    s_add_u32 s48, s48, s49
    s_add_u32 m0, s51, 99328
    s_nop 0
    buffer_load_dwordx4 v244, s[12:15], s48 offen lds
    s_add_u32 s48, s48, 65536
    s_add_u32 m0, s51, 103552
    s_nop 0
    buffer_load_dwordx4 v244, s[12:15], s48 offen lds
    s_add_u32 s48, s48, 65536
    s_add_u32 s48, s58, 10
    s_and_b32 s48, s48, 7
    s_and_b32 s66, s74, 8
    s_xor_b32 s66, s66, 8
    s_or_b32 s48, s48, s66
    s_lshl_b32 s48, s48, 17
    s_add_u32 s48, s48, s49
    s_add_u32 m0, s51, 107776
    s_nop 0
    buffer_load_dwordx4 v244, s[12:15], s48 offen lds
    s_add_u32 s48, s48, 65536
    s_add_u32 m0, s51, 112000
    s_nop 0
    buffer_load_dwordx4 v244, s[12:15], s48 offen lds
    s_add_u32 s48, s48, 65536
    s_branch L_g2
hs_41:
    buffer_load_dword v72, v71, s[28:31], 0 offen sc1
    s_sub_u32 s79, s79, 1
    s_cbranch_scc1 L_abort
    s_waitcnt vmcnt(0)
    v_and_b32 v73, 0x80808080, v72
    v_cmp_ne_u32 vcc, 0x80808080, v73
    s_cbranch_vccnz hs_41
    s_branch hs_41_b
pl_42_acq:
    buffer_inv sc1
    s_waitcnt vmcnt(0)
    s_branch pl_42_ok
rc_44:
    s_mov_b64 exec, 1
pl_145:
    buffer_load_dword v240, v246, s[80:83], s47 offen sc1
    s_sub_u32 s79, s79, 1
    s_cbranch_scc1 L_abort
    s_waitcnt vmcnt(0)
    v_cmp_ne_u32 vcc, 1, v240
    s_cbranch_vccnz pl_145
    s_mov_b64 exec, -1
    s_cmp_lg_u32 s78, 0
    s_cbranch_scc1 pl_145_acq
pl_145_ok:
    s_branch rc_44_b
pl_145_acq:
    buffer_inv sc1
    s_waitcnt vmcnt(0)
    s_branch pl_145_ok
pl_147_acq:
    buffer_inv sc1
    s_waitcnt vmcnt(0)
    s_branch pl_147_ok
pl_149_acq:
    buffer_inv sc1
    s_waitcnt vmcnt(0)
    s_branch pl_149_ok
cs_150:
    v_add_u32 v225, 28800, v224
    ds_read_b64_tr_b16 v[204:205], v225 offset:0
    ds_read_b64_tr_b16 v[206:207], v225 offset:3584
    ds_read_b64_tr_b16 v[208:209], v225 offset:32
    ds_read_b64_tr_b16 v[210:211], v225 offset:3616
    ds_read_b64_tr_b16 v[212:213], v225 offset:64
    ds_read_b64_tr_b16 v[214:215], v225 offset:3648
    ds_read_b64_tr_b16 v[216:217], v225 offset:96
    ds_read_b64_tr_b16 v[218:219], v225 offset:3680
    s_waitcnt lgkmcnt(0)
    v_mfma_f32_16x16x32_bf16 v[176:179], v[204:207], v[220:223], 0
    v_mfma_f32_16x16x32_bf16 v[180:183], v[208:211], v[220:223], 0
    v_mfma_f32_16x16x32_bf16 v[184:187], v[212:215], v[220:223], 0
    v_mfma_f32_16x16x32_bf16 v[188:191], v[216:219], v[220:223], 0
    s_nop 7
    ds_read_b64_tr_b16 v[204:205], v225 offset:128
    ds_read_b64_tr_b16 v[206:207], v225 offset:3712
    ds_read_b64_tr_b16 v[208:209], v225 offset:160
    ds_read_b64_tr_b16 v[210:211], v225 offset:3744
    ds_read_b64_tr_b16 v[212:213], v225 offset:192
    ds_read_b64_tr_b16 v[214:215], v225 offset:3776
    s_waitcnt lgkmcnt(0)
    v_mfma_f32_16x16x32_bf16 v[192:195], v[204:207], v[220:223], 0
    v_mfma_f32_16x16x32_bf16 v[196:199], v[208:211], v[220:223], 0
    v_mfma_f32_16x16x32_bf16 v[200:203], v[212:215], v[220:223], 0
    s_nop 7
    s_branch cs_150_b
cs_651:
    v_add_u32 v225, 57600, v224
    ds_read_b64_tr_b16 v[204:205], v225 offset:0
    ds_read_b64_tr_b16 v[206:207], v225 offset:3584
    ds_read_b64_tr_b16 v[208:209], v225 offset:32
    ds_read_b64_tr_b16 v[210:211], v225 offset:3616
    ds_read_b64_tr_b16 v[212:213], v225 offset:64
    ds_read_b64_tr_b16 v[214:215], v225 offset:3648
    ds_read_b64_tr_b16 v[216:217], v225 offset:96
    ds_read_b64_tr_b16 v[218:219], v225 offset:3680
    s_waitcnt lgkmcnt(0)
    v_mfma_f32_16x16x32_bf16 v[176:179], v[204:207], v[220:223], v[176:179]
    v_mfma_f32_16x16x32_bf16 v[180:183], v[208:211], v[220:223], v[180:183]
    v_mfma_f32_16x16x32_bf16 v[184:187], v[212:215], v[220:223], v[184:187]
    v_mfma_f32_16x16x32_bf16 v[188:191], v[216:219], v[220:223], v[188:191]
    s_nop 7
    ds_read_b64_tr_b16 v[204:205], v225 offset:128
    ds_read_b64_tr_b16 v[206:207], v225 offset:3712
    ds_read_b64_tr_b16 v[208:209], v225 offset:160
    ds_read_b64_tr_b16 v[210:211], v225 offset:3744
    ds_read_b64_tr_b16 v[212:213], v225 offset:192
    ds_read_b64_tr_b16 v[214:215], v225 offset:3776
    s_waitcnt lgkmcnt(0)
    v_mfma_f32_16x16x32_bf16 v[192:195], v[204:207], v[220:223], v[192:195]
    v_mfma_f32_16x16x32_bf16 v[196:199], v[208:211], v[220:223], v[196:199]
    v_mfma_f32_16x16x32_bf16 v[200:203], v[212:215], v[220:223], v[200:203]
    s_nop 7
    s_lshl_b32 s64, s34, 1
    s_and_b32 s65, s3, 1
    s_add_u32 s64, s64, s65
    s_mul_i32 s64, s64, 14336
    s_mul_i32 s65, s74, 896
    s_add_u32 s64, s64, s65
    s_lshr_b32 s65, s69, 1
    s_mul_i32 s65, s65, 448
    s_add_u32 s64, s64, s65
    s_add_u32 s64, s64, 74448896
    v_lshlrev_b32 v225, 4, v251
    s_mov_b32 exec_lo, 0x00010001
    s_mov_b32 exec_hi, 0x00010001
    buffer_store_dwordx4 v[176:179], v225, s[80:83], s64 offen offset:0 sc0 sc1
    buffer_store_dwordx4 v[180:183], v225, s[80:83], s64 offen offset:64 sc0 sc1
    buffer_store_dwordx4 v[184:187], v225, s[80:83], s64 offen offset:128 sc0 sc1
    buffer_store_dwordx4 v[188:191], v225, s[80:83], s64 offen offset:192 sc0 sc1
    buffer_store_dwordx4 v[192:195], v225, s[80:83], s64 offen offset:256 sc0 sc1
    buffer_store_dwordx4 v[196:199], v225, s[80:83], s64 offen offset:320 sc0 sc1
    buffer_store_dwordx4 v[200:203], v225, s[80:83], s64 offen offset:384 sc0 sc1
    s_mov_b64 exec, -1
    s_nop 3
    s_branch cs_651_b
cs_652:
    v_add_u32 v225, 86400, v224
    ds_read_b64_tr_b16 v[204:205], v225 offset:0
    ds_read_b64_tr_b16 v[206:207], v225 offset:3584
    ds_read_b64_tr_b16 v[208:209], v225 offset:32
    ds_read_b64_tr_b16 v[210:211], v225 offset:3616
    ds_read_b64_tr_b16 v[212:213], v225 offset:64
    ds_read_b64_tr_b16 v[214:215], v225 offset:3648
    ds_read_b64_tr_b16 v[216:217], v225 offset:96
    ds_read_b64_tr_b16 v[218:219], v225 offset:3680
    s_waitcnt lgkmcnt(0)
    v_mfma_f32_16x16x32_bf16 v[176:179], v[204:207], v[220:223], 0
    v_mfma_f32_16x16x32_bf16 v[180:183], v[208:211], v[220:223], 0
    v_mfma_f32_16x16x32_bf16 v[184:187], v[212:215], v[220:223], 0
    v_mfma_f32_16x16x32_bf16 v[188:191], v[216:219], v[220:223], 0
    s_nop 7
    ds_read_b64_tr_b16 v[204:205], v225 offset:128
    ds_read_b64_tr_b16 v[206:207], v225 offset:3712
    ds_read_b64_tr_b16 v[208:209], v225 offset:160
    ds_read_b64_tr_b16 v[210:211], v225 offset:3744
    ds_read_b64_tr_b16 v[212:213], v225 offset:192
    ds_read_b64_tr_b16 v[214:215], v225 offset:3776
    s_waitcnt lgkmcnt(0)
    v_mfma_f32_16x16x32_bf16 v[192:195], v[204:207], v[220:223], 0
    v_mfma_f32_16x16x32_bf16 v[196:199], v[208:211], v[220:223], 0
    v_mfma_f32_16x16x32_bf16 v[200:203], v[212:215], v[220:223], 0
    s_nop 7
    s_branch cs_652_b
cs_653:
    v_add_u32 v225, 0, v224
    ds_read_b64_tr_b16 v[204:205], v225 offset:0
    ds_read_b64_tr_b16 v[206:207], v225 offset:3584
    ds_read_b64_tr_b16 v[208:209], v225 offset:32
    ds_read_b64_tr_b16 v[210:211], v225 offset:3616
    ds_read_b64_tr_b16 v[212:213], v225 offset:64
    ds_read_b64_tr_b16 v[214:215], v225 offset:3648
    ds_read_b64_tr_b16 v[216:217], v225 offset:96
    ds_read_b64_tr_b16 v[218:219], v225 offset:3680
    s_waitcnt lgkmcnt(0)
    v_mfma_f32_16x16x32_bf16 v[176:179], v[204:207], v[220:223], v[176:179]
    v_mfma_f32_16x16x32_bf16 v[180:183], v[208:211], v[220:223], v[180:183]
    v_mfma_f32_16x16x32_bf16 v[184:187], v[212:215], v[220:223], v[184:187]
    v_mfma_f32_16x16x32_bf16 v[188:191], v[216:219], v[220:223], v[188:191]
    s_nop 7
    ds_read_b64_tr_b16 v[204:205], v225 offset:128
    ds_read_b64_tr_b16 v[206:207], v225 offset:3712
    ds_read_b64_tr_b16 v[208:209], v225 offset:160
    ds_read_b64_tr_b16 v[210:211], v225 offset:3744
    ds_read_b64_tr_b16 v[212:213], v225 offset:192
    ds_read_b64_tr_b16 v[214:215], v225 offset:3776
    s_waitcnt lgkmcnt(0)
    v_mfma_f32_16x16x32_bf16 v[192:195], v[204:207], v[220:223], v[192:195]
    v_mfma_f32_16x16x32_bf16 v[196:199], v[208:211], v[220:223], v[196:199]
    v_mfma_f32_16x16x32_bf16 v[200:203], v[212:215], v[220:223], v[200:203]
    s_nop 7
    s_lshl_b32 s64, s34, 1
    s_and_b32 s65, s3, 1
    s_add_u32 s64, s64, s65
    s_mul_i32 s64, s64, 14336
    s_mul_i32 s65, s74, 896
    s_add_u32 s64, s64, s65
    s_lshr_b32 s65, s69, 1
    s_mul_i32 s65, s65, 448
    s_add_u32 s64, s64, s65
    s_add_u32 s64, s64, 74448896
    v_lshlrev_b32 v225, 4, v251
    s_mov_b32 exec_lo, 0x00010001
    s_mov_b32 exec_hi, 0x00010001
    buffer_store_dwordx4 v[176:179], v225, s[80:83], s64 offen offset:0 sc0 sc1
    buffer_store_dwordx4 v[180:183], v225, s[80:83], s64 offen offset:64 sc0 sc1
    buffer_store_dwordx4 v[184:187], v225, s[80:83], s64 offen offset:128 sc0 sc1
    buffer_store_dwordx4 v[188:191], v225, s[80:83], s64 offen offset:192 sc0 sc1
    buffer_store_dwordx4 v[192:195], v225, s[80:83], s64 offen offset:256 sc0 sc1
    buffer_store_dwordx4 v[196:199], v225, s[80:83], s64 offen offset:320 sc0 sc1
    buffer_store_dwordx4 v[200:203], v225, s[80:83], s64 offen offset:384 sc0 sc1
    s_mov_b64 exec, -1
    s_nop 3
    s_branch cs_653_b
cs_654:
    v_add_u32 v225, 28800, v224
    ds_read_b64_tr_b16 v[204:205], v225 offset:0
    ds_read_b64_tr_b16 v[206:207], v225 offset:3584
    ds_read_b64_tr_b16 v[208:209], v225 offset:32
    ds_read_b64_tr_b16 v[210:211], v225 offset:3616
    ds_read_b64_tr_b16 v[212:213], v225 offset:64
    ds_read_b64_tr_b16 v[214:215], v225 offset:3648
    ds_read_b64_tr_b16 v[216:217], v225 offset:96
    ds_read_b64_tr_b16 v[218:219], v225 offset:3680
    s_waitcnt lgkmcnt(0)
    v_mfma_f32_16x16x32_bf16 v[176:179], v[204:207], v[220:223], 0
    v_mfma_f32_16x16x32_bf16 v[180:183], v[208:211], v[220:223], 0
    v_mfma_f32_16x16x32_bf16 v[184:187], v[212:215], v[220:223], 0
    v_mfma_f32_16x16x32_bf16 v[188:191], v[216:219], v[220:223], 0
    s_nop 7
    ds_read_b64_tr_b16 v[204:205], v225 offset:128
    ds_read_b64_tr_b16 v[206:207], v225 offset:3712
    ds_read_b64_tr_b16 v[208:209], v225 offset:160
    ds_read_b64_tr_b16 v[210:211], v225 offset:3744
    ds_read_b64_tr_b16 v[212:213], v225 offset:192
    ds_read_b64_tr_b16 v[214:215], v225 offset:3776
    s_waitcnt lgkmcnt(0)
    v_mfma_f32_16x16x32_bf16 v[192:195], v[204:207], v[220:223], 0
    v_mfma_f32_16x16x32_bf16 v[196:199], v[208:211], v[220:223], 0
    v_mfma_f32_16x16x32_bf16 v[200:203], v[212:215], v[220:223], 0
    s_nop 7
    s_branch cs_654_b
cs_655:
    v_add_u32 v225, 57600, v224
    ds_read_b64_tr_b16 v[204:205], v225 offset:0
    ds_read_b64_tr_b16 v[206:207], v225 offset:3584
    ds_read_b64_tr_b16 v[208:209], v225 offset:32
    ds_read_b64_tr_b16 v[210:211], v225 offset:3616
    ds_read_b64_tr_b16 v[212:213], v225 offset:64
    ds_read_b64_tr_b16 v[214:215], v225 offset:3648
    ds_read_b64_tr_b16 v[216:217], v225 offset:96
    ds_read_b64_tr_b16 v[218:219], v225 offset:3680
    s_waitcnt lgkmcnt(0)
    v_mfma_f32_16x16x32_bf16 v[176:179], v[204:207], v[220:223], v[176:179]
    v_mfma_f32_16x16x32_bf16 v[180:183], v[208:211], v[220:223], v[180:183]
    v_mfma_f32_16x16x32_bf16 v[184:187], v[212:215], v[220:223], v[184:187]
    v_mfma_f32_16x16x32_bf16 v[188:191], v[216:219], v[220:223], v[188:191]
    s_nop 7
    ds_read_b64_tr_b16 v[204:205], v225 offset:128
    ds_read_b64_tr_b16 v[206:207], v225 offset:3712
    ds_read_b64_tr_b16 v[208:209], v225 offset:160
    ds_read_b64_tr_b16 v[210:211], v225 offset:3744
    ds_read_b64_tr_b16 v[212:213], v225 offset:192
    ds_read_b64_tr_b16 v[214:215], v225 offset:3776
    s_waitcnt lgkmcnt(0)
    v_mfma_f32_16x16x32_bf16 v[192:195], v[204:207], v[220:223], v[192:195]
    v_mfma_f32_16x16x32_bf16 v[196:199], v[208:211], v[220:223], v[196:199]
    v_mfma_f32_16x16x32_bf16 v[200:203], v[212:215], v[220:223], v[200:203]
    s_nop 7
    s_lshl_b32 s64, s34, 1
    s_and_b32 s65, s3, 1
    s_add_u32 s64, s64, s65
    s_mul_i32 s64, s64, 14336
    s_mul_i32 s65, s74, 896
    s_add_u32 s64, s64, s65
    s_lshr_b32 s65, s69, 1
    s_mul_i32 s65, s65, 448
    s_add_u32 s64, s64, s65
    s_add_u32 s64, s64, 74448896
    v_lshlrev_b32 v225, 4, v251
    s_mov_b32 exec_lo, 0x00010001
    s_mov_b32 exec_hi, 0x00010001
    buffer_store_dwordx4 v[176:179], v225, s[80:83], s64 offen offset:0 sc0 sc1
    buffer_store_dwordx4 v[180:183], v225, s[80:83], s64 offen offset:64 sc0 sc1
    buffer_store_dwordx4 v[184:187], v225, s[80:83], s64 offen offset:128 sc0 sc1
    buffer_store_dwordx4 v[188:191], v225, s[80:83], s64 offen offset:192 sc0 sc1
    buffer_store_dwordx4 v[192:195], v225, s[80:83], s64 offen offset:256 sc0 sc1
    buffer_store_dwordx4 v[196:199], v225, s[80:83], s64 offen offset:320 sc0 sc1
    buffer_store_dwordx4 v[200:203], v225, s[80:83], s64 offen offset:384 sc0 sc1
    s_mov_b64 exec, -1
    s_nop 3
    s_branch cs_655_b
cs_656:
    v_add_u32 v225, 86400, v224
    ds_read_b64_tr_b16 v[204:205], v225 offset:0
    ds_read_b64_tr_b16 v[206:207], v225 offset:3584
    ds_read_b64_tr_b16 v[208:209], v225 offset:32
    ds_read_b64_tr_b16 v[210:211], v225 offset:3616
    ds_read_b64_tr_b16 v[212:213], v225 offset:64
    ds_read_b64_tr_b16 v[214:215], v225 offset:3648
    ds_read_b64_tr_b16 v[216:217], v225 offset:96
    ds_read_b64_tr_b16 v[218:219], v225 offset:3680
    s_waitcnt lgkmcnt(0)
    v_mfma_f32_16x16x32_bf16 v[176:179], v[204:207], v[220:223], 0
    v_mfma_f32_16x16x32_bf16 v[180:183], v[208:211], v[220:223], 0
    v_mfma_f32_16x16x32_bf16 v[184:187], v[212:215], v[220:223], 0
    v_mfma_f32_16x16x32_bf16 v[188:191], v[216:219], v[220:223], 0
    s_nop 7
    ds_read_b64_tr_b16 v[204:205], v225 offset:128
    ds_read_b64_tr_b16 v[206:207], v225 offset:3712
    ds_read_b64_tr_b16 v[208:209], v225 offset:160
    ds_read_b64_tr_b16 v[210:211], v225 offset:3744
    ds_read_b64_tr_b16 v[212:213], v225 offset:192
    ds_read_b64_tr_b16 v[214:215], v225 offset:3776
    s_waitcnt lgkmcnt(0)
    v_mfma_f32_16x16x32_bf16 v[192:195], v[204:207], v[220:223], 0
    v_mfma_f32_16x16x32_bf16 v[196:199], v[208:211], v[220:223], 0
    v_mfma_f32_16x16x32_bf16 v[200:203], v[212:215], v[220:223], 0
    s_nop 7
    s_branch cs_656_b
cs_657:
    v_add_u32 v225, 0, v224
    ds_read_b64_tr_b16 v[204:205], v225 offset:0
    ds_read_b64_tr_b16 v[206:207], v225 offset:3584
    ds_read_b64_tr_b16 v[208:209], v225 offset:32
    ds_read_b64_tr_b16 v[210:211], v225 offset:3616
    ds_read_b64_tr_b16 v[212:213], v225 offset:64
    ds_read_b64_tr_b16 v[214:215], v225 offset:3648
    ds_read_b64_tr_b16 v[216:217], v225 offset:96
    ds_read_b64_tr_b16 v[218:219], v225 offset:3680
    s_waitcnt lgkmcnt(0)
    v_mfma_f32_16x16x32_bf16 v[176:179], v[204:207], v[220:223], v[176:179]
    v_mfma_f32_16x16x32_bf16 v[180:183], v[208:211], v[220:223], v[180:183]
    v_mfma_f32_16x16x32_bf16 v[184:187], v[212:215], v[220:223], v[184:187]
    v_mfma_f32_16x16x32_bf16 v[188:191], v[216:219], v[220:223], v[188:191]
    s_nop 7
    ds_read_b64_tr_b16 v[204:205], v225 offset:128
    ds_read_b64_tr_b16 v[206:207], v225 offset:3712
    ds_read_b64_tr_b16 v[208:209], v225 offset:160
    ds_read_b64_tr_b16 v[210:211], v225 offset:3744
    ds_read_b64_tr_b16 v[212:213], v225 offset:192
    ds_read_b64_tr_b16 v[214:215], v225 offset:3776
    s_waitcnt lgkmcnt(0)
    v_mfma_f32_16x16x32_bf16 v[192:195], v[204:207], v[220:223], v[192:195]
    v_mfma_f32_16x16x32_bf16 v[196:199], v[208:211], v[220:223], v[196:199]
    v_mfma_f32_16x16x32_bf16 v[200:203], v[212:215], v[220:223], v[200:203]
    s_nop 7
    s_lshl_b32 s64, s34, 1
    s_and_b32 s65, s3, 1
    s_add_u32 s64, s64, s65
    s_mul_i32 s64, s64, 14336
    s_mul_i32 s65, s74, 896
    s_add_u32 s64, s64, s65
    s_lshr_b32 s65, s69, 1
    s_mul_i32 s65, s65, 448
    s_add_u32 s64, s64, s65
    s_add_u32 s64, s64, 74448896
    v_lshlrev_b32 v225, 4, v251
    s_mov_b32 exec_lo, 0x00010001
    s_mov_b32 exec_hi, 0x00010001
    buffer_store_dwordx4 v[176:179], v225, s[80:83], s64 offen offset:0 sc0 sc1
    buffer_store_dwordx4 v[180:183], v225, s[80:83], s64 offen offset:64 sc0 sc1
    buffer_store_dwordx4 v[184:187], v225, s[80:83], s64 offen offset:128 sc0 sc1
    buffer_store_dwordx4 v[188:191], v225, s[80:83], s64 offen offset:192 sc0 sc1
    buffer_store_dwordx4 v[192:195], v225, s[80:83], s64 offen offset:256 sc0 sc1
    buffer_store_dwordx4 v[196:199], v225, s[80:83], s64 offen offset:320 sc0 sc1
    buffer_store_dwordx4 v[200:203], v225, s[80:83], s64 offen offset:384 sc0 sc1
    s_mov_b64 exec, -1
    s_nop 3
    s_branch cs_657_b
cf_1158:
    s_lshl_b32 s64, s74, 4
    s_add_u32 s64, s64, s34
    s_lshl_b32 s64, s64, 3
    s_add_u32 s64, s64, s69
    s_lshl_b32 s64, s64, 2
    s_add_u32 s64, s64, 75587584
    v_mov_b32 v216, 0
    v_mov_b32 v217, 1
    s_mov_b64 exec, 1
    buffer_store_dword v217, v216, s[80:83], s64 offen sc0 sc1
    s_mov_b64 exec, -1
    s_branch cf_1158_b
g3c1_hook:
    s_lshl_b32 s64, s74, 9
    s_add_u32 s64, s64, 75587584
    v_lshlrev_b32 v225, 5, v252
    s_cmp_eq_u32 s24, 1
    s_cbranch_scc1 g3c1_h1
    buffer_load_dwordx4 v[216:219], v225, s[80:83], s64 offen sc1
    s_branch g3c1_hb
g3c1_h1:
    v_and_b32 v216, v216, v217
    v_and_b32 v218, v218, v219
    v_and_b32 v216, v216, v218
    v_cmp_ne_u32 vcc, 1, v216
    s_cbranch_vccz g3c1_h1b
    s_mov_b64 exec, 0xffff
pl_1659:
    buffer_load_dwordx4 v[216:219], v225, s[80:83], s64 offen sc1
    s_sub_u32 s79, s79, 1
    s_cbranch_scc1 L_abort
    s_waitcnt vmcnt(0)
    v_and_b32 v216, v216, v217
    v_and_b32 v218, v218, v219
    v_and_b32 v216, v216, v218
    v_cmp_ne_u32 vcc, 1, v216
    s_cbranch_vccnz pl_1659
    s_mov_b64 exec, -1
g3c1_h1b:
    s_branch g3c1_hb
sg_3161_slow:
    s_waitcnt vmcnt(0)
    buffer_wbl2 sc1
    s_waitcnt vmcnt(0)
    s_mov_b64 exec, 1
    buffer_store_dword v145, v144, s[80:83], s64 offen sc0 sc1
    s_mov_b64 exec, -1
    s_branch sg_3161_done
pl_3162_acq:
    buffer_inv sc1
    s_waitcnt vmcnt(0)
    s_branch pl_3162_ok
pl_3163_acq:
    buffer_inv sc1
    s_waitcnt vmcnt(0)
    s_branch pl_3163_ok
pl_3165_acq:
    buffer_inv sc1
    s_waitcnt vmcnt(0)
    s_branch pl_3165_ok
L_fin:
L_abort:
L_end:
    s_endpgm
.section .rodata,"a"
.p2align 6
.amdhsa_kernel interleave_layers__sliding_local_dilated__glu_gated_swiglu__prompt_kernel
  .amdhsa_next_free_vgpr 256
  .amdhsa_next_free_sgpr 102
  .amdhsa_accum_offset 256
  .amdhsa_group_segment_fixed_size 0
  .amdhsa_kernarg_size 80
  .amdhsa_user_sgpr_count 2
  .amdhsa_user_sgpr_kernarg_segment_ptr 1
  .amdhsa_system_sgpr_workgroup_id_x 1
.end_amdhsa_kernel
```

```asm
; @launch grid=(256,1,1) block=(512,1,1) lds=163840
.amdgcn_target "amdgcn-amd-amdhsa--gfx950"
.text
.globl interleave_layers__sliding_local_dilated__glu_gated_swiglu__prompt_kernel
.p2align 8
.type interleave_layers__sliding_local_dilated__glu_gated_swiglu__prompt_kernel,@function
interleave_layers__sliding_local_dilated__glu_gated_swiglu__prompt_kernel:
    s_cmp_ge_u32 s2, 256
    s_cbranch_scc1 L_end
    s_load_dwordx4 s[84:87], s[0:1], 0
    s_load_dwordx2 s[4:5], s[0:1], 72
    s_load_dwordx2 s[88:89], s[0:1], 16
    s_load_dwordx4 s[92:95], s[0:1], 32
    s_load_dwordx4 s[96:99], s[0:1], 48
    s_load_dwordx2 s[90:91], s[0:1], 64
    v_lshrrev_b32 v1, 6, v0
    v_and_b32 v250, 63, v0
    v_readfirstlane_b32 s3, v1
    v_lshrrev_b32 v251, 4, v250
    v_and_b32 v252, 15, v250
    v_lshlrev_b32 v249, 4, v250
    s_and_b32 s70, s2, 7
    s_lshr_b32 s72, s2, 4
    s_lshr_b32 s71, s2, 3
    s_and_b32 s71, s71, 1
    s_lshl_b32 s73, s70, 1
    s_add_u32 s73, s73, s71
    s_and_b32 s68, s72, 1
    s_lshl_b32 s67, s68, 1
    s_xor_b32 s67, s67, s73
    s_and_b32 s64, s70, 1
    s_lshl_b32 s64, s64, 3
    s_lshr_b32 s74, s72, 1
    s_add_u32 s74, s74, s64
    s_and_b32 s58, s70, 6
    s_lshl_b32 s57, s58, 1
    s_sub_u32 s61, s74, s58
    s_add_u32 s61, s61, 3
    s_and_b32 s61, s61, 7
    s_mov_b32 s60, 0
    s_mov_b32 s59, 1
    s_and_b32 s69, s3, 3
    s_mov_b32 s75, 0
    s_mov_b32 s78, 1
    s_mov_b32 s79, 4194304
    s_waitcnt lgkmcnt(0)
    s_mov_b32 s80, s4
    s_mov_b32 s81, s5
    s_mov_b32 s82, 79691776
    s_mov_b32 s83, 0x00020000
    s_cmp_ge_u32 s3, 4
    s_cbranch_scc1 L_load
    s_mov_b32 s8, s84
    s_mov_b32 s9, s85
    s_mov_b32 s10, 4194304
    s_mov_b32 s11, 0x00020000
    s_lshl_b32 s16, s72, 2
    s_add_u32 s16, s16, s3
    s_lshl_b32 s16, s16, 1
    s_lshl_b32 s17, s73, 7
    s_add_u32 s18, s17, s16
    s_lshl_b32 s18, s18, 11
    buffer_load_dwordx4 v[16:19], v249, s[8:11], s18 offen offset:0
    buffer_load_dwordx4 v[20:23], v249, s[8:11], s18 offen offset:1024
    buffer_load_dwordx4 v[24:27], v249, s[8:11], s18 offen offset:2048
    buffer_load_dwordx4 v[28:31], v249, s[8:11], s18 offen offset:3072
    v_mov_b32 v56, 0x3f803f80
    s_cmp_lg_u32 s3, 1
    s_cbranch_scc1 L_cons
    s_getpc_b64 s[20:21]
    s_lshl_b32 s22, s2, 8
    s_add_u32 s20, s20, s22
    s_addc_u32 s21, s21, 0
    s_cmp_ge_u32 s22, L_end-L_load-256
    s_cbranch_scc1 L_cons
    s_load_dword s22, s[20:21], 0
    s_load_dword s22, s[20:21], 64
    s_load_dword s22, s[20:21], 128
    s_load_dword s22, s[20:21], 192
    s_branch L_cons
L_load:
    s_setprio 3
    s_mov_b32 s12, s84
    s_mov_b32 s13, s85
    s_mov_b32 s14, 4194304
    s_mov_b32 s15, 0x00020000
    s_mov_b32 s8, s86
    s_mov_b32 s9, s87
    s_mov_b32 s10, 6291456
    s_mov_b32 s11, 0x00020000
    v_lshrrev_b32 v253, 3, v250
    v_and_b32 v254, 3, v253
    v_lshlrev_b32 v254, 3, v254
    v_and_b32 v253, 4, v253
    v_add_u32 v253, v253, v254
    v_add_u32 v253, s69, v253
    v_mul_u32_u24 v253, 6144, v253
    v_and_b32 v254, 7, v250
    v_lshl_add_u32 v10, v254, 4, v253
    v_add_u32 v11, 2048, v10
    v_add_u32 v12, 4096, v10
    s_mul_i32 s19, s69, 3104
    s_lshl_b32 s17, s74, 7
    s_add_u32 s18, s17, 6291456
    s_mov_b32 s64, s57
    s_mul_i32 s64, s64, 393216
    s_add_u32 s16, s17, s64
    s_add_u32 m0, s19, 86400
    s_nop 0
    buffer_load_dwordx4 v10, s[8:11], s16 offen lds
    s_add_u32 m0, s19, 87424
    s_nop 0
    buffer_load_dwordx4 v11, s[8:11], s16 offen lds
    s_add_u32 m0, s19, 88448
    s_nop 0
    buffer_load_dwordx4 v12, s[8:11], s16 offen lds
    s_add_u32 s16, s16, 196608
    s_cmp_eq_u32 s16, s18
    s_cselect_b32 s16, s17, s16
    v_lshrrev_b32 v253, 3, v250
    v_and_b32 v254, 6, v253
    v_and_b32 v13, 7, v250
    v_xor_b32 v254, v254, v13
    v_lshlrev_b32 v254, 4, v254
    v_lshl_add_u32 v13, v253, 11, v254
    v_add_u32 v14, 16384, v13
    v_add_u32 v15, 32768, v13
    v_add_u32 v16, 49152, v13
    s_lshl_b32 s21, s67, 18
    s_lshl_b32 s64, s69, 16
    s_add_u32 s21, s21, s64
    s_add_u32 s22, s21, 2048
    s_mov_b32 s64, s57
    s_lshl_b32 s64, s64, 7
    s_add_u32 s20, s21, s64
    s_mul_i32 s24, s69, 4294918144
    s_sub_u32 s24, s24, 32768
    s_cmp_eq_u32 s67, 0
    s_cselect_b32 s24, 0x7f000000, s24
    s_lshl_b32 s23, s69, 12
    s_add_u32 s23, s23, 2048
    s_lshl_b32 s25, s69, 10
    s_cmp_eq_u32 s69, 0
    s_cselect_b32 s26, 0xffffff00, -1
    s_mov_b32 s27, -1
    s_cmp_ge_u32 s69, 2
    s_cbranch_scc1 nh_1
    s_add_u32 m0, s25, 18432
    s_add_u32 s64, s20, s24
    s_mov_b64 exec, s[26:27]
    buffer_load_dwordx4 v13, s[12:15], s64 offen lds
    s_mov_b64 exec, -1
nh_1:
    s_add_u32 m0, s23, 18432
    s_nop 0
    buffer_load_dwordx4 v13, s[12:15], s20 offen lds
    s_add_u32 m0, s23, 19456
    s_nop 0
    buffer_load_dwordx4 v14, s[12:15], s20 offen lds
    s_add_u32 m0, s23, 20480
    s_nop 0
    buffer_load_dwordx4 v15, s[12:15], s20 offen lds
    s_add_u32 m0, s23, 21504
    s_nop 0
    buffer_load_dwordx4 v16, s[12:15], s20 offen lds
    s_add_u32 s20, s20, 128
    s_cmp_eq_u32 s20, s22
    s_cselect_b32 s20, s21, s20
    s_add_u32 m0, s19, 98816
    s_nop 0
    buffer_load_dwordx4 v10, s[8:11], s16 offen lds
    s_add_u32 m0, s19, 99840
    s_nop 0
    buffer_load_dwordx4 v11, s[8:11], s16 offen lds
    s_add_u32 m0, s19, 100864
    s_nop 0
    buffer_load_dwordx4 v12, s[8:11], s16 offen lds
    s_add_u32 s16, s16, 196608
    s_cmp_eq_u32 s16, s18
    s_cselect_b32 s16, s17, s16
    s_add_u32 m0, s19, 111232
    s_nop 0
    buffer_load_dwordx4 v10, s[8:11], s16 offen lds
    s_add_u32 m0, s19, 112256
    s_nop 0
    buffer_load_dwordx4 v11, s[8:11], s16 offen lds
    s_add_u32 m0, s19, 113280
    s_nop 0
    buffer_load_dwordx4 v12, s[8:11], s16 offen lds
    s_add_u32 s16, s16, 196608
    s_cmp_eq_u32 s16, s18
    s_cselect_b32 s16, s17, s16
    s_cmp_ge_u32 s69, 2
    s_cbranch_scc1 nh_2
    s_add_u32 m0, s25, 36864
    s_add_u32 s64, s20, s24
    s_mov_b64 exec, s[26:27]
    buffer_load_dwordx4 v13, s[12:15], s64 offen lds
    s_mov_b64 exec, -1
nh_2:
    s_add_u32 m0, s23, 36864
    s_nop 0
    buffer_load_dwordx4 v13, s[12:15], s20 offen lds
    s_add_u32 m0, s23, 37888
    s_nop 0
    buffer_load_dwordx4 v14, s[12:15], s20 offen lds
    s_add_u32 m0, s23, 38912
    s_nop 0
    buffer_load_dwordx4 v15, s[12:15], s20 offen lds
    s_add_u32 m0, s23, 39936
    s_nop 0
    buffer_load_dwordx4 v16, s[12:15], s20 offen lds
    s_add_u32 s20, s20, 128
    s_cmp_eq_u32 s20, s22
    s_cselect_b32 s20, s21, s20
    s_add_u32 m0, s19, 123648
    s_nop 0
    buffer_load_dwordx4 v10, s[8:11], s16 offen lds
    s_add_u32 m0, s19, 124672
    s_nop 0
    buffer_load_dwordx4 v11, s[8:11], s16 offen lds
    s_add_u32 m0, s19, 125696
    s_nop 0
    buffer_load_dwordx4 v12, s[8:11], s16 offen lds
    s_add_u32 s16, s16, 196608
    s_cmp_eq_u32 s16, s18
    s_cselect_b32 s16, s17, s16
    s_add_u32 m0, s19, 136064
    s_nop 0
    buffer_load_dwordx4 v10, s[8:11], s16 offen lds
    s_add_u32 m0, s19, 137088
    s_nop 0
    buffer_load_dwordx4 v11, s[8:11], s16 offen lds
    s_add_u32 m0, s19, 138112
    s_nop 0
    buffer_load_dwordx4 v12, s[8:11], s16 offen lds
    s_add_u32 s16, s16, 196608
    s_cmp_eq_u32 s16, s18
    s_cselect_b32 s16, s17, s16
    s_mov_b32 s28, s90
    s_mov_b32 s29, s91
    s_mov_b32 s30, 256
    s_mov_b32 s31, 0x00020000
    s_getreg_b32 s32, hwreg(HW_REG_XCC_ID)
    s_and_b32 s32, s32, 15
    s_or_b32 s32, s32, 0x80
    s_cmp_lt_u32 s2, 128
    s_cselect_b32 s36, s92, s94
    s_cselect_b32 s37, s93, s95
    s_mov_b32 s38, 7340032
    s_mov_b32 s39, 0x00020000
    s_and_b32 s34, s2, 127
    s_mul_i32 s34, s34, 57344
    v_lshlrev_b32 v70, 7, v250
    s_mul_i32 s35, s69, 14336
    s_add_u32 s34, s34, s35
    s_lshr_b32 s35, s2, 3
    s_mul_i32 s33, s35, 10923
    s_lshr_b32 s33, s33, 16
    s_mul_i32 s33, s33, 6
    s_sub_u32 s35, s35, s33
    s_lshr_b32 s40, s2, 3
    s_lshl_b32 s40, s40, 2
    s_add_u32 s40, s40, s69
    s_and_b32 s41, s40, 63
    s_mul_i32 s41, s41, 6144
    s_and_b32 s40, s40, 64
    s_add_u32 s40, s40, s41
    s_add_u32 s40, s40, 384
    s_and_b32 s41, s70, 1
    s_lshl_b32 s41, s41, 10
    s_add_u32 s40, s40, s41
    s_add_u32 s40, s86, s40
    s_addc_u32 s41, s87, 0
    s_waitcnt vmcnt(16)
    s_barrier
    s_cmp_ge_u32 s69, 2
    s_cbranch_scc1 nh_3
    s_add_u32 m0, s25, 55296
    s_add_u32 s64, s20, s24
    s_mov_b64 exec, s[26:27]
    buffer_load_dwordx4 v13, s[12:15], s64 offen lds
    s_mov_b64 exec, -1
nh_3:
    s_add_u32 m0, s23, 55296
    s_nop 0
    buffer_load_dwordx4 v13, s[12:15], s20 offen lds
    s_add_u32 m0, s23, 56320
    s_nop 0
    buffer_load_dwordx4 v14, s[12:15], s20 offen lds
    s_add_u32 m0, s23, 57344
    s_nop 0
    buffer_load_dwordx4 v15, s[12:15], s20 offen lds
    s_add_u32 m0, s23, 58368
    s_nop 0
    buffer_load_dwordx4 v16, s[12:15], s20 offen lds
    s_add_u32 s20, s20, 128
    s_cmp_eq_u32 s20, s22
    s_cselect_b32 s20, s21, s20
    s_add_u32 m0, s19, 73984
    s_nop 0
    buffer_load_dwordx4 v10, s[8:11], s16 offen lds
    s_add_u32 m0, s19, 75008
    s_nop 0
    buffer_load_dwordx4 v11, s[8:11], s16 offen lds
    s_add_u32 m0, s19, 76032
    s_nop 0
    buffer_load_dwordx4 v12, s[8:11], s16 offen lds
    s_add_u32 s16, s16, 196608
    s_cmp_eq_u32 s16, s18
    s_cselect_b32 s16, s17, s16
    s_add_u32 s42, s57, 2
    s_and_b32 s42, s42, 15
    s_mul_i32 s42, s42, 393216
    s_add_u32 s44, s40, s42
    s_addc_u32 s45, s41, 0
    s_load_dword s43, s[44:45], 0
    s_load_dword s43, s[44:45], 2048
    s_load_dword s43, s[44:45], 4096
    s_add_u32 s42, s57, 3
    s_and_b32 s42, s42, 15
    s_mul_i32 s42, s42, 393216
    s_add_u32 s44, s40, s42
    s_addc_u32 s45, s41, 0
    s_load_dword s43, s[44:45], 0
    s_load_dword s43, s[44:45], 2048
    s_load_dword s43, s[44:45], 4096
    s_waitcnt vmcnt(13)
    s_barrier
    s_cmp_ge_u32 s69, 2
    s_cbranch_scc1 nh_4
    s_add_u32 m0, s25, 0
    s_add_u32 s64, s20, s24
    s_mov_b64 exec, s[26:27]
    buffer_load_dwordx4 v13, s[12:15], s64 offen lds
    s_mov_b64 exec, -1
nh_4:
    s_add_u32 m0, s23, 0
    s_nop 0
    buffer_load_dwordx4 v13, s[12:15], s20 offen lds
    s_add_u32 m0, s23, 1024
    s_nop 0
    buffer_load_dwordx4 v14, s[12:15], s20 offen lds
    s_add_u32 m0, s23, 2048
    s_nop 0
    buffer_load_dwordx4 v15, s[12:15], s20 offen lds
    s_add_u32 m0, s23, 3072
    s_nop 0
    buffer_load_dwordx4 v16, s[12:15], s20 offen lds
    s_add_u32 s20, s20, 128
    s_cmp_eq_u32 s20, s22
    s_cselect_b32 s20, s21, s20
    s_add_u32 m0, s19, 86400
    s_nop 0
    buffer_load_dwordx4 v10, s[8:11], s16 offen lds
    s_add_u32 m0, s19, 87424
    s_nop 0
    buffer_load_dwordx4 v11, s[8:11], s16 offen lds
    s_add_u32 m0, s19, 88448
    s_nop 0
    buffer_load_dwordx4 v12, s[8:11], s16 offen lds
    s_add_u32 s16, s16, 196608
    s_cmp_eq_u32 s16, s18
    s_cselect_b32 s16, s17, s16
    s_add_u32 s42, s57, 4
    s_and_b32 s42, s42, 15
    s_mul_i32 s42, s42, 393216
    s_add_u32 s44, s40, s42
    s_addc_u32 s45, s41, 0
    s_load_dword s43, s[44:45], 0
    s_load_dword s43, s[44:45], 2048
    s_load_dword s43, s[44:45], 4096
    s_waitcnt vmcnt(10)
    s_barrier
    s_add_u32 m0, s19, 98816
    s_nop 0
    buffer_load_dwordx4 v10, s[8:11], s16 offen lds
    s_add_u32 m0, s19, 99840
    s_nop 0
    buffer_load_dwordx4 v11, s[8:11], s16 offen lds
    s_add_u32 m0, s19, 100864
    s_nop 0
    buffer_load_dwordx4 v12, s[8:11], s16 offen lds
    s_add_u32 s16, s16, 196608
    s_cmp_eq_u32 s16, s18
    s_cselect_b32 s16, s17, s16
    s_cmp_ge_u32 s69, 2
    s_cbranch_scc1 nh_5
    s_add_u32 m0, s25, 18432
    s_add_u32 s64, s20, s24
    s_mov_b64 exec, s[26:27]
    buffer_load_dwordx4 v13, s[12:15], s64 offen lds
    s_mov_b64 exec, -1
nh_5:
    s_add_u32 m0, s23, 18432
    s_nop 0
    buffer_load_dwordx4 v13, s[12:15], s20 offen lds
    s_add_u32 m0, s23, 19456
    s_nop 0
    buffer_load_dwordx4 v14, s[12:15], s20 offen lds
    s_add_u32 m0, s23, 20480
    s_nop 0
    buffer_load_dwordx4 v15, s[12:15], s20 offen lds
    s_add_u32 m0, s23, 21504
    s_nop 0
    buffer_load_dwordx4 v16, s[12:15], s20 offen lds
    s_add_u32 s20, s20, 128
    s_cmp_eq_u32 s20, s22
    s_cselect_b32 s20, s21, s20
    s_add_u32 m0, s19, 111232
    s_nop 0
    buffer_load_dwordx4 v10, s[8:11], s16 offen lds
    s_add_u32 m0, s19, 112256
    s_nop 0
    buffer_load_dwordx4 v11, s[8:11], s16 offen lds
    s_add_u32 m0, s19, 113280
    s_nop 0
    buffer_load_dwordx4 v12, s[8:11], s16 offen lds
    s_add_u32 s16, s16, 196608
    s_cmp_eq_u32 s16, s18
    s_cselect_b32 s16, s17, s16
    s_add_u32 s42, s57, 5
    s_and_b32 s42, s42, 15
    s_mul_i32 s42, s42, 393216
    s_add_u32 s44, s40, s42
    s_addc_u32 s45, s41, 0
    s_load_dword s43, s[44:45], 0
    s_load_dword s43, s[44:45], 2048
    s_load_dword s43, s[44:45], 4096
    s_cmp_lg_u32 s69, 3
    s_cbranch_scc1 ar_6
    s_and_b32 s33, s2, 3
    s_lshl_b32 s33, s33, 3
    s_lshl_b32 s33, s32, s33
    s_and_b32 s46, s2, 0xfc
    s_add_u32 s46, s90, s46
    s_addc_u32 s47, s91, 0
    s_atomic_or s33, s[46:47], 0
ar_6:
    s_cmp_lg_u32 s35, 0
    s_cbranch_scc1 vw_7
    s_mov_b32 exec_lo, 4294967295
    s_mov_b32 exec_hi, 16777215
    buffer_load_dword v69, v70, s[36:39], s34 offen
    s_mov_b64 exec, -1
    s_add_u32 s34, s34, 7168
vw_7:
    s_waitcnt vmcnt(10)
    s_barrier
    s_add_u32 m0, s19, 123648
    s_nop 0
    buffer_load_dwordx4 v10, s[8:11], s16 offen lds
    s_add_u32 m0, s19, 124672
    s_nop 0
    buffer_load_dwordx4 v11, s[8:11], s16 offen lds
    s_add_u32 m0, s19, 125696
    s_nop 0
    buffer_load_dwordx4 v12, s[8:11], s16 offen lds
    s_add_u32 s16, s16, 196608
    s_cmp_eq_u32 s16, s18
    s_cselect_b32 s16, s17, s16
    s_cmp_ge_u32 s69, 2
    s_cbranch_scc1 nh_8
    s_add_u32 m0, s25, 36864
    s_add_u32 s64, s20, s24
    s_mov_b64 exec, s[26:27]
    buffer_load_dwordx4 v13, s[12:15], s64 offen lds
    s_mov_b64 exec, -1
nh_8:
    s_add_u32 m0, s23, 36864
    s_nop 0
    buffer_load_dwordx4 v13, s[12:15], s20 offen lds
    s_add_u32 m0, s23, 37888
    s_nop 0
    buffer_load_dwordx4 v14, s[12:15], s20 offen lds
    s_add_u32 m0, s23, 38912
    s_nop 0
    buffer_load_dwordx4 v15, s[12:15], s20 offen lds
    s_add_u32 m0, s23, 39936
    s_nop 0
    buffer_load_dwordx4 v16, s[12:15], s20 offen lds
    s_add_u32 s20, s20, 128
    s_cmp_eq_u32 s20, s22
    s_cselect_b32 s20, s21, s20
    s_add_u32 m0, s19, 136064
    s_nop 0
    buffer_load_dwordx4 v10, s[8:11], s16 offen lds
    s_add_u32 m0, s19, 137088
    s_nop 0
    buffer_load_dwordx4 v11, s[8:11], s16 offen lds
    s_add_u32 m0, s19, 138112
    s_nop 0
    buffer_load_dwordx4 v12, s[8:11], s16 offen lds
    s_add_u32 s16, s16, 196608
    s_cmp_eq_u32 s16, s18
    s_cselect_b32 s16, s17, s16
    s_add_u32 s42, s57, 6
    s_and_b32 s42, s42, 15
    s_mul_i32 s42, s42, 393216
    s_add_u32 s44, s40, s42
    s_addc_u32 s45, s41, 0
    s_load_dword s43, s[44:45], 0
    s_load_dword s43, s[44:45], 2048
    s_load_dword s43, s[44:45], 4096
    s_cmp_lg_u32 s35, 1
    s_cbranch_scc1 vw_9
    s_mov_b32 exec_lo, 4294967295
    s_mov_b32 exec_hi, 16777215
    buffer_load_dword v69, v70, s[36:39], s34 offen
    s_mov_b64 exec, -1
    s_add_u32 s34, s34, 7168
vw_9:
    s_waitcnt vmcnt(10)
    s_barrier
    s_add_u32 m0, s19, 73984
    s_nop 0
    buffer_load_dwordx4 v10, s[8:11], s16 offen lds
    s_add_u32 m0, s19, 75008
    s_nop 0
    buffer_load_dwordx4 v11, s[8:11], s16 offen lds
    s_add_u32 m0, s19, 76032
    s_nop 0
    buffer_load_dwordx4 v12, s[8:11], s16 offen lds
    s_add_u32 s16, s16, 196608
    s_cmp_eq_u32 s16, s18
    s_cselect_b32 s16, s17, s16
    s_cmp_ge_u32 s69, 2
    s_cbranch_scc1 nh_10
    s_add_u32 m0, s25, 55296
    s_add_u32 s64, s20, s24
    s_mov_b64 exec, s[26:27]
    buffer_load_dwordx4 v13, s[12:15], s64 offen lds
    s_mov_b64 exec, -1
nh_10:
    s_add_u32 m0, s23, 55296
    s_nop 0
    buffer_load_dwordx4 v13, s[12:15], s20 offen lds
    s_add_u32 m0, s23, 56320
    s_nop 0
    buffer_load_dwordx4 v14, s[12:15], s20 offen lds
    s_add_u32 m0, s23, 57344
    s_nop 0
    buffer_load_dwordx4 v15, s[12:15], s20 offen lds
    s_add_u32 m0, s23, 58368
    s_nop 0
    buffer_load_dwordx4 v16, s[12:15], s20 offen lds
    s_add_u32 s20, s20, 128
    s_cmp_eq_u32 s20, s22
    s_cselect_b32 s20, s21, s20
    s_add_u32 m0, s19, 86400
    s_nop 0
    buffer_load_dwordx4 v10, s[8:11], s16 offen lds
    s_add_u32 m0, s19, 87424
    s_nop 0
    buffer_load_dwordx4 v11, s[8:11], s16 offen lds
    s_add_u32 m0, s19, 88448
    s_nop 0
    buffer_load_dwordx4 v12, s[8:11], s16 offen lds
    s_add_u32 s16, s16, 196608
    s_cmp_eq_u32 s16, s18
    s_cselect_b32 s16, s17, s16
    s_add_u32 s42, s57, 7
    s_and_b32 s42, s42, 15
    s_mul_i32 s42, s42, 393216
    s_add_u32 s44, s40, s42
    s_addc_u32 s45, s41, 0
    s_load_dword s43, s[44:45], 0
    s_load_dword s43, s[44:45], 2048
    s_load_dword s43, s[44:45], 4096
    s_cmp_lg_u32 s35, 2
    s_cbranch_scc1 vw_11
    s_mov_b32 exec_lo, 4294967295
    s_mov_b32 exec_hi, 16777215
    buffer_load_dword v69, v70, s[36:39], s34 offen
    s_mov_b64 exec, -1
    s_add_u32 s34, s34, 7168
vw_11:
    s_waitcnt vmcnt(10)
    s_barrier
    s_add_u32 m0, s19, 98816
    s_nop 0
    buffer_load_dwordx4 v10, s[8:11], s16 offen lds
    s_add_u32 m0, s19, 99840
    s_nop 0
    buffer_load_dwordx4 v11, s[8:11], s16 offen lds
    s_add_u32 m0, s19, 100864
    s_nop 0
    buffer_load_dwordx4 v12, s[8:11], s16 offen lds
    s_add_u32 s16, s16, 196608
    s_cmp_eq_u32 s16, s18
    s_cselect_b32 s16, s17, s16
    s_cmp_ge_u32 s69, 2
    s_cbranch_scc1 nh_12
    s_add_u32 m0, s25, 0
    s_add_u32 s64, s20, s24
    s_mov_b64 exec, s[26:27]
    buffer_load_dwordx4 v13, s[12:15], s64 offen lds
    s_mov_b64 exec, -1
nh_12:
    s_add_u32 m0, s23, 0
    s_nop 0
    buffer_load_dwordx4 v13, s[12:15], s20 offen lds
    s_add_u32 m0, s23, 1024
    s_nop 0
    buffer_load_dwordx4 v14, s[12:15], s20 offen lds
    s_add_u32 m0, s23, 2048
    s_nop 0
    buffer_load_dwordx4 v15, s[12:15], s20 offen lds
    s_add_u32 m0, s23, 3072
    s_nop 0
    buffer_load_dwordx4 v16, s[12:15], s20 offen lds
    s_add_u32 s20, s20, 128
    s_cmp_eq_u32 s20, s22
    s_cselect_b32 s20, s21, s20
    s_add_u32 m0, s19, 111232
    s_nop 0
    buffer_load_dwordx4 v10, s[8:11], s16 offen lds
    s_add_u32 m0, s19, 112256
    s_nop 0
    buffer_load_dwordx4 v11, s[8:11], s16 offen lds
    s_add_u32 m0, s19, 113280
    s_nop 0
    buffer_load_dwordx4 v12, s[8:11], s16 offen lds
    s_add_u32 s16, s16, 196608
    s_cmp_eq_u32 s16, s18
    s_cselect_b32 s16, s17, s16
    s_add_u32 s42, s57, 8
    s_and_b32 s42, s42, 15
    s_mul_i32 s42, s42, 393216
    s_add_u32 s44, s40, s42
    s_addc_u32 s45, s41, 0
    s_load_dword s43, s[44:45], 0
    s_load_dword s43, s[44:45], 2048
    s_load_dword s43, s[44:45], 4096
    s_cmp_lg_u32 s35, 3
    s_cbranch_scc1 vw_13
    s_mov_b32 exec_lo, 4294967295
    s_mov_b32 exec_hi, 16777215
    buffer_load_dword v69, v70, s[36:39], s34 offen
    s_mov_b64 exec, -1
    s_add_u32 s34, s34, 7168
vw_13:
    s_waitcnt vmcnt(10)
    s_barrier
    s_add_u32 m0, s19, 123648
    s_nop 0
    buffer_load_dwordx4 v10, s[8:11], s16 offen lds
    s_add_u32 m0, s19, 124672
    s_nop 0
    buffer_load_dwordx4 v11, s[8:11], s16 offen lds
    s_add_u32 m0, s19, 125696
    s_nop 0
    buffer_load_dwordx4 v12, s[8:11], s16 offen lds
    s_add_u32 s16, s16, 196608
    s_cmp_eq_u32 s16, s18
    s_cselect_b32 s16, s17, s16
    s_cmp_ge_u32 s69, 2
    s_cbranch_scc1 nh_14
    s_add_u32 m0, s25, 18432
    s_add_u32 s64, s20, s24
    s_mov_b64 exec, s[26:27]
    buffer_load_dwordx4 v13, s[12:15], s64 offen lds
    s_mov_b64 exec, -1
nh_14:
    s_add_u32 m0, s23, 18432
    s_nop 0
    buffer_load_dwordx4 v13, s[12:15], s20 offen lds
    s_add_u32 m0, s23, 19456
    s_nop 0
    buffer_load_dwordx4 v14, s[12:15], s20 offen lds
    s_add_u32 m0, s23, 20480
    s_nop 0
    buffer_load_dwordx4 v15, s[12:15], s20 offen lds
    s_add_u32 m0, s23, 21504
    s_nop 0
    buffer_load_dwordx4 v16, s[12:15], s20 offen lds
    s_add_u32 s20, s20, 128
    s_cmp_eq_u32 s20, s22
    s_cselect_b32 s20, s21, s20
    s_add_u32 m0, s19, 136064
    s_nop 0
    buffer_load_dwordx4 v10, s[8:11], s16 offen lds
    s_add_u32 m0, s19, 137088
    s_nop 0
    buffer_load_dwordx4 v11, s[8:11], s16 offen lds
    s_add_u32 m0, s19, 138112
    s_nop 0
    buffer_load_dwordx4 v12, s[8:11], s16 offen lds
    s_add_u32 s16, s16, 196608
    s_cmp_eq_u32 s16, s18
    s_cselect_b32 s16, s17, s16
    s_add_u32 s42, s57, 9
    s_and_b32 s42, s42, 15
    s_mul_i32 s42, s42, 393216
    s_add_u32 s44, s40, s42
    s_addc_u32 s45, s41, 0
    s_load_dword s43, s[44:45], 0
    s_load_dword s43, s[44:45], 2048
    s_load_dword s43, s[44:45], 4096
    s_cmp_lg_u32 s35, 4
    s_cbranch_scc1 vw_15
    s_mov_b32 exec_lo, 4294967295
    s_mov_b32 exec_hi, 16777215
    buffer_load_dword v69, v70, s[36:39], s34 offen
    s_mov_b64 exec, -1
    s_add_u32 s34, s34, 7168
vw_15:
    s_waitcnt vmcnt(10)
    s_barrier
    s_add_u32 m0, s19, 73984
    s_nop 0
    buffer_load_dwordx4 v10, s[8:11], s16 offen lds
    s_add_u32 m0, s19, 75008
    s_nop 0
    buffer_load_dwordx4 v11, s[8:11], s16 offen lds
    s_add_u32 m0, s19, 76032
    s_nop 0
    buffer_load_dwordx4 v12, s[8:11], s16 offen lds
    s_add_u32 s16, s16, 196608
    s_cmp_eq_u32 s16, s18
    s_cselect_b32 s16, s17, s16
    s_cmp_ge_u32 s69, 2
    s_cbranch_scc1 nh_16
    s_add_u32 m0, s25, 36864
    s_add_u32 s64, s20, s24
    s_mov_b64 exec, s[26:27]
    buffer_load_dwordx4 v13, s[12:15], s64 offen lds
    s_mov_b64 exec, -1
nh_16:
    s_add_u32 m0, s23, 36864
    s_nop 0
    buffer_load_dwordx4 v13, s[12:15], s20 offen lds
    s_add_u32 m0, s23, 37888
    s_nop 0
    buffer_load_dwordx4 v14, s[12:15], s20 offen lds
    s_add_u32 m0, s23, 38912
    s_nop 0
    buffer_load_dwordx4 v15, s[12:15], s20 offen lds
    s_add_u32 m0, s23, 39936
    s_nop 0
    buffer_load_dwordx4 v16, s[12:15], s20 offen lds
    s_add_u32 s20, s20, 128
    s_cmp_eq_u32 s20, s22
    s_cselect_b32 s20, s21, s20
    s_add_u32 m0, s19, 86400
    s_nop 0
    buffer_load_dwordx4 v10, s[8:11], s16 offen lds
    s_add_u32 m0, s19, 87424
    s_nop 0
    buffer_load_dwordx4 v11, s[8:11], s16 offen lds
    s_add_u32 m0, s19, 88448
    s_nop 0
    buffer_load_dwordx4 v12, s[8:11], s16 offen lds
    s_add_u32 s16, s16, 196608
    s_cmp_eq_u32 s16, s18
    s_cselect_b32 s16, s17, s16
    s_add_u32 s42, s57, 10
    s_and_b32 s42, s42, 15
    s_mul_i32 s42, s42, 393216
    s_add_u32 s44, s40, s42
    s_addc_u32 s45, s41, 0
    s_load_dword s43, s[44:45], 0
    s_load_dword s43, s[44:45], 2048
    s_load_dword s43, s[44:45], 4096
    s_cmp_lg_u32 s35, 5
    s_cbranch_scc1 vw_17
    s_mov_b32 exec_lo, 4294967295
    s_mov_b32 exec_hi, 16777215
    buffer_load_dword v69, v70, s[36:39], s34 offen
    s_mov_b64 exec, -1
    s_add_u32 s34, s34, 7168
vw_17:
    s_waitcnt vmcnt(10)
    s_barrier
    s_add_u32 m0, s19, 98816
    s_nop 0
    buffer_load_dwordx4 v10, s[8:11], s16 offen lds
    s_add_u32 m0, s19, 99840
    s_nop 0
    buffer_load_dwordx4 v11, s[8:11], s16 offen lds
    s_add_u32 m0, s19, 100864
    s_nop 0
    buffer_load_dwordx4 v12, s[8:11], s16 offen lds
    s_add_u32 s16, s16, 196608
    s_cmp_eq_u32 s16, s18
    s_cselect_b32 s16, s17, s16
    s_cmp_ge_u32 s69, 2
    s_cbranch_scc1 nh_18
    s_add_u32 m0, s25, 55296
    s_add_u32 s64, s20, s24
    s_mov_b64 exec, s[26:27]
    buffer_load_dwordx4 v13, s[12:15], s64 offen lds
    s_mov_b64 exec, -1
nh_18:
    s_add_u32 m0, s23, 55296
    s_nop 0
    buffer_load_dwordx4 v13, s[12:15], s20 offen lds
    s_add_u32 m0, s23, 56320
    s_nop 0
    buffer_load_dwordx4 v14, s[12:15], s20 offen lds
    s_add_u32 m0, s23, 57344
    s_nop 0
    buffer_load_dwordx4 v15, s[12:15], s20 offen lds
    s_add_u32 m0, s23, 58368
    s_nop 0
    buffer_load_dwordx4 v16, s[12:15], s20 offen lds
    s_add_u32 s20, s20, 128
    s_cmp_eq_u32 s20, s22
    s_cselect_b32 s20, s21, s20
    s_add_u32 m0, s19, 111232
    s_nop 0
    buffer_load_dwordx4 v10, s[8:11], s16 offen lds
    s_add_u32 m0, s19, 112256
    s_nop 0
    buffer_load_dwordx4 v11, s[8:11], s16 offen lds
    s_add_u32 m0, s19, 113280
    s_nop 0
    buffer_load_dwordx4 v12, s[8:11], s16 offen lds
    s_add_u32 s16, s16, 196608
    s_cmp_eq_u32 s16, s18
    s_cselect_b32 s16, s17, s16
    s_add_u32 s42, s57, 11
    s_and_b32 s42, s42, 15
    s_mul_i32 s42, s42, 393216
    s_add_u32 s44, s40, s42
    s_addc_u32 s45, s41, 0
    s_load_dword s43, s[44:45], 0
    s_load_dword s43, s[44:45], 2048
    s_load_dword s43, s[44:45], 4096
    s_cmp_lg_u32 s35, 0
    s_cbranch_scc1 vw_19
    s_mov_b32 exec_lo, 4294967295
    s_mov_b32 exec_hi, 16777215
    buffer_load_dword v69, v70, s[36:39], s34 offen
    s_mov_b64 exec, -1
    s_add_u32 s34, s34, 7168
vw_19:
    s_waitcnt vmcnt(10)
    s_barrier
    s_add_u32 m0, s19, 123648
    s_nop 0
    buffer_load_dwordx4 v10, s[8:11], s16 offen lds
    s_add_u32 m0, s19, 124672
    s_nop 0
    buffer_load_dwordx4 v11, s[8:11], s16 offen lds
    s_add_u32 m0, s19, 125696
    s_nop 0
    buffer_load_dwordx4 v12, s[8:11], s16 offen lds
    s_add_u32 s16, s16, 196608
    s_cmp_eq_u32 s16, s18
    s_cselect_b32 s16, s17, s16
    s_cmp_ge_u32 s69, 2
    s_cbranch_scc1 nh_20
    s_add_u32 m0, s25, 0
    s_add_u32 s64, s20, s24
    s_mov_b64 exec, s[26:27]
    buffer_load_dwordx4 v13, s[12:15], s64 offen lds
    s_mov_b64 exec, -1
nh_20:
    s_add_u32 m0, s23, 0
    s_nop 0
    buffer_load_dwordx4 v13, s[12:15], s20 offen lds
    s_add_u32 m0, s23, 1024
    s_nop 0
    buffer_load_dwordx4 v14, s[12:15], s20 offen lds
    s_add_u32 m0, s23, 2048
    s_nop 0
    buffer_load_dwordx4 v15, s[12:15], s20 offen lds
    s_add_u32 m0, s23, 3072
    s_nop 0
    buffer_load_dwordx4 v16, s[12:15], s20 offen lds
    s_add_u32 s20, s20, 128
    s_cmp_eq_u32 s20, s22
    s_cselect_b32 s20, s21, s20
    s_add_u32 m0, s19, 136064
    s_nop 0
    buffer_load_dwordx4 v10, s[8:11], s16 offen lds
    s_add_u32 m0, s19, 137088
    s_nop 0
    buffer_load_dwordx4 v11, s[8:11], s16 offen lds
    s_add_u32 m0, s19, 138112
    s_nop 0
    buffer_load_dwordx4 v12, s[8:11], s16 offen lds
    s_add_u32 s16, s16, 196608
    s_cmp_eq_u32 s16, s18
    s_cselect_b32 s16, s17, s16
    s_add_u32 s42, s57, 12
    s_and_b32 s42, s42, 15
    s_mul_i32 s42, s42, 393216
    s_add_u32 s44, s40, s42
    s_addc_u32 s45, s41, 0
    s_load_dword s43, s[44:45], 0
    s_load_dword s43, s[44:45], 2048
    s_load_dword s43, s[44:45], 4096
    s_cmp_lg_u32 s35, 1
    s_cbranch_scc1 vw_21
    s_mov_b32 exec_lo, 4294967295
    s_mov_b32 exec_hi, 16777215
    buffer_load_dword v69, v70, s[36:39], s34 offen
    s_mov_b64 exec, -1
    s_add_u32 s34, s34, 7168
vw_21:
    s_waitcnt vmcnt(10)
    s_barrier
    s_add_u32 m0, s19, 73984
    s_nop 0
    buffer_load_dwordx4 v10, s[8:11], s16 offen lds
    s_add_u32 m0, s19, 75008
    s_nop 0
    buffer_load_dwordx4 v11, s[8:11], s16 offen lds
    s_add_u32 m0, s19, 76032
    s_nop 0
    buffer_load_dwordx4 v12, s[8:11], s16 offen lds
    s_add_u32 s16, s16, 196608
    s_cmp_eq_u32 s16, s18
    s_cselect_b32 s16, s17, s16
    s_cmp_ge_u32 s69, 2
    s_cbranch_scc1 nh_22
    s_add_u32 m0, s25, 18432
    s_add_u32 s64, s20, s24
    s_mov_b64 exec, s[26:27]
    buffer_load_dwordx4 v13, s[12:15], s64 offen lds
    s_mov_b64 exec, -1
nh_22:
    s_add_u32 m0, s23, 18432
    s_nop 0
    buffer_load_dwordx4 v13, s[12:15], s20 offen lds
    s_add_u32 m0, s23, 19456
    s_nop 0
    buffer_load_dwordx4 v14, s[12:15], s20 offen lds
    s_add_u32 m0, s23, 20480
    s_nop 0
    buffer_load_dwordx4 v15, s[12:15], s20 offen lds
    s_add_u32 m0, s23, 21504
    s_nop 0
    buffer_load_dwordx4 v16, s[12:15], s20 offen lds
    s_add_u32 s20, s20, 128
    s_cmp_eq_u32 s20, s22
    s_cselect_b32 s20, s21, s20
    s_add_u32 m0, s19, 86400
    s_nop 0
    buffer_load_dwordx4 v10, s[8:11], s16 offen lds
    s_add_u32 m0, s19, 87424
    s_nop 0
    buffer_load_dwordx4 v11, s[8:11], s16 offen lds
    s_add_u32 m0, s19, 88448
    s_nop 0
    buffer_load_dwordx4 v12, s[8:11], s16 offen lds
    s_add_u32 s16, s16, 196608
    s_cmp_eq_u32 s16, s18
    s_cselect_b32 s16, s17, s16
    s_add_u32 s42, s57, 13
    s_and_b32 s42, s42, 15
    s_mul_i32 s42, s42, 393216
    s_add_u32 s44, s40, s42
    s_addc_u32 s45, s41, 0
    s_load_dword s43, s[44:45], 0
    s_load_dword s43, s[44:45], 2048
    s_load_dword s43, s[44:45], 4096
    s_cmp_lg_u32 s35, 2
    s_cbranch_scc1 vw_23
    s_mov_b32 exec_lo, 4294967295
    s_mov_b32 exec_hi, 16777215
    buffer_load_dword v69, v70, s[36:39], s34 offen
    s_mov_b64 exec, -1
    s_add_u32 s34, s34, 7168
vw_23:
    s_waitcnt vmcnt(10)
    s_barrier
    s_add_u32 m0, s19, 98816
    s_nop 0
    buffer_load_dwordx4 v10, s[8:11], s16 offen lds
    s_add_u32 m0, s19, 99840
    s_nop 0
    buffer_load_dwordx4 v11, s[8:11], s16 offen lds
    s_add_u32 m0, s19, 100864
    s_nop 0
    buffer_load_dwordx4 v12, s[8:11], s16 offen lds
    s_add_u32 s16, s16, 196608
    s_cmp_eq_u32 s16, s18
    s_cselect_b32 s16, s17, s16
    s_cmp_ge_u32 s69, 2
    s_cbranch_scc1 nh_24
    s_add_u32 m0, s25, 36864
    s_add_u32 s64, s20, s24
    s_mov_b64 exec, s[26:27]
    buffer_load_dwordx4 v13, s[12:15], s64 offen lds
    s_mov_b64 exec, -1
nh_24:
    s_add_u32 m0, s23, 36864
    s_nop 0
    buffer_load_dwordx4 v13, s[12:15], s20 offen lds
    s_add_u32 m0, s23, 37888
    s_nop 0
    buffer_load_dwordx4 v14, s[12:15], s20 offen lds
    s_add_u32 m0, s23, 38912
    s_nop 0
    buffer_load_dwordx4 v15, s[12:15], s20 offen lds
    s_add_u32 m0, s23, 39936
    s_nop 0
    buffer_load_dwordx4 v16, s[12:15], s20 offen lds
    s_add_u32 s20, s20, 128
    s_cmp_eq_u32 s20, s22
    s_cselect_b32 s20, s21, s20
    s_add_u32 m0, s19, 111232
    s_nop 0
    buffer_load_dwordx4 v10, s[8:11], s16 offen lds
    s_add_u32 m0, s19, 112256
    s_nop 0
    buffer_load_dwordx4 v11, s[8:11], s16 offen lds
    s_add_u32 m0, s19, 113280
    s_nop 0
    buffer_load_dwordx4 v12, s[8:11], s16 offen lds
    s_add_u32 s16, s16, 196608
    s_cmp_eq_u32 s16, s18
    s_cselect_b32 s16, s17, s16
    s_add_u32 s42, s57, 14
    s_and_b32 s42, s42, 15
    s_mul_i32 s42, s42, 393216
    s_add_u32 s44, s40, s42
    s_addc_u32 s45, s41, 0
    s_load_dword s43, s[44:45], 0
    s_load_dword s43, s[44:45], 2048
    s_load_dword s43, s[44:45], 4096
    s_cmp_lg_u32 s35, 3
    s_cbranch_scc1 vw_25
    s_mov_b32 exec_lo, 4294967295
    s_mov_b32 exec_hi, 16777215
    buffer_load_dword v69, v70, s[36:39], s34 offen
    s_mov_b64 exec, -1
    s_add_u32 s34, s34, 7168
vw_25:
    s_waitcnt vmcnt(10)
    s_barrier
    s_add_u32 m0, s19, 123648
    s_nop 0
    buffer_load_dwordx4 v10, s[8:11], s16 offen lds
    s_add_u32 m0, s19, 124672
    s_nop 0
    buffer_load_dwordx4 v11, s[8:11], s16 offen lds
    s_add_u32 m0, s19, 125696
    s_nop 0
    buffer_load_dwordx4 v12, s[8:11], s16 offen lds
    s_add_u32 s16, s16, 196608
    s_cmp_eq_u32 s16, s18
    s_cselect_b32 s16, s17, s16
    s_cmp_ge_u32 s69, 2
    s_cbranch_scc1 nh_26
    s_add_u32 m0, s25, 55296
    s_add_u32 s64, s20, s24
    s_mov_b64 exec, s[26:27]
    buffer_load_dwordx4 v13, s[12:15], s64 offen lds
    s_mov_b64 exec, -1
nh_26:
    s_add_u32 m0, s23, 55296
    s_nop 0
    buffer_load_dwordx4 v13, s[12:15], s20 offen lds
    s_add_u32 m0, s23, 56320
    s_nop 0
    buffer_load_dwordx4 v14, s[12:15], s20 offen lds
    s_add_u32 m0, s23, 57344
    s_nop 0
    buffer_load_dwordx4 v15, s[12:15], s20 offen lds
    s_add_u32 m0, s23, 58368
    s_nop 0
    buffer_load_dwordx4 v16, s[12:15], s20 offen lds
    s_add_u32 s20, s20, 128
    s_cmp_eq_u32 s20, s22
    s_cselect_b32 s20, s21, s20
    s_add_u32 m0, s19, 136064
    s_nop 0
    buffer_load_dwordx4 v10, s[8:11], s16 offen lds
    s_add_u32 m0, s19, 137088
    s_nop 0
    buffer_load_dwordx4 v11, s[8:11], s16 offen lds
    s_add_u32 m0, s19, 138112
    s_nop 0
    buffer_load_dwordx4 v12, s[8:11], s16 offen lds
    s_add_u32 s16, s16, 196608
    s_cmp_eq_u32 s16, s18
    s_cselect_b32 s16, s17, s16
    s_add_u32 s42, s57, 15
    s_and_b32 s42, s42, 15
    s_mul_i32 s42, s42, 393216
    s_add_u32 s44, s40, s42
    s_addc_u32 s45, s41, 0
    s_load_dword s43, s[44:45], 0
    s_load_dword s43, s[44:45], 2048
    s_load_dword s43, s[44:45], 4096
    v_lshlrev_b32 v71, 2, v250
    buffer_load_dword v72, v71, s[28:31], 0 offen sc1
    s_cmp_lg_u32 s35, 4
    s_cbranch_scc1 vw_27
    s_mov_b32 exec_lo, 4294967295
    s_mov_b32 exec_hi, 16777215
    buffer_load_dword v69, v70, s[36:39], s34 offen
    s_mov_b64 exec, -1
    s_add_u32 s34, s34, 7168
vw_27:
    s_waitcnt vmcnt(11)
    s_barrier
    s_add_u32 m0, s19, 73984
    s_nop 0
    buffer_load_dwordx4 v10, s[8:11], s16 offen lds
    s_add_u32 m0, s19, 75008
    s_nop 0
    buffer_load_dwordx4 v11, s[8:11], s16 offen lds
    s_add_u32 m0, s19, 76032
    s_nop 0
    buffer_load_dwordx4 v12, s[8:11], s16 offen lds
    s_add_u32 s16, s16, 196608
    s_cmp_eq_u32 s16, s18
    s_cselect_b32 s16, s17, s16
    s_cmp_ge_u32 s69, 2
    s_cbranch_scc1 nh_28
    s_add_u32 m0, s25, 0
    s_add_u32 s64, s20, s24
    s_mov_b64 exec, s[26:27]
    buffer_load_dwordx4 v13, s[12:15], s64 offen lds
    s_mov_b64 exec, -1
nh_28:
    s_add_u32 m0, s23, 0
    s_nop 0
    buffer_load_dwordx4 v13, s[12:15], s20 offen lds
    s_add_u32 m0, s23, 1024
    s_nop 0
    buffer_load_dwordx4 v14, s[12:15], s20 offen lds
    s_add_u32 m0, s23, 2048
    s_nop 0
    buffer_load_dwordx4 v15, s[12:15], s20 offen lds
    s_add_u32 m0, s23, 3072
    s_nop 0
    buffer_load_dwordx4 v16, s[12:15], s20 offen lds
    s_add_u32 s20, s20, 128
    s_cmp_eq_u32 s20, s22
    s_cselect_b32 s20, s21, s20
    s_add_u32 m0, s19, 86400
    s_nop 0
    buffer_load_dwordx4 v10, s[8:11], s16 offen lds
    s_add_u32 m0, s19, 87424
    s_nop 0
    buffer_load_dwordx4 v11, s[8:11], s16 offen lds
    s_add_u32 m0, s19, 88448
    s_nop 0
    buffer_load_dwordx4 v12, s[8:11], s16 offen lds
    s_add_u32 s16, s16, 196608
    s_cmp_eq_u32 s16, s18
    s_cselect_b32 s16, s17, s16
    s_cmp_lg_u32 s35, 5
    s_cbranch_scc1 vw_29
    s_mov_b32 exec_lo, 4294967295
    s_mov_b32 exec_hi, 16777215
    buffer_load_dword v69, v70, s[36:39], s34 offen
    s_mov_b64 exec, -1
    s_add_u32 s34, s34, 7168
vw_29:
    s_waitcnt vmcnt(11)
    s_barrier
    s_add_u32 m0, s19, 98816
    s_nop 0
    buffer_load_dwordx4 v10, s[8:11], s16 offen lds
    s_add_u32 m0, s19, 99840
    s_nop 0
    buffer_load_dwordx4 v11, s[8:11], s16 offen lds
    s_add_u32 m0, s19, 100864
    s_nop 0
    buffer_load_dwordx4 v12, s[8:11], s16 offen lds
    s_add_u32 s16, s16, 196608
    s_cmp_eq_u32 s16, s18
    s_cselect_b32 s16, s17, s16
    s_lshl_b32 s64, s67, 4
    s_add_u32 s64, s64, s74
    s_lshl_b32 s64, s64, 2
    s_add_u32 s64, s64, s69
    s_lshl_b32 s64, s64, 12
    s_lshl_b32 s65, s75, 22
    s_add_u32 s64, s64, s65
    s_add_u32 s64, s64, 12582912
    s_cmp_eq_u32 s68, 0
    s_cselect_b32 s64, s64, 0x7f000000
    v_lshlrev_b32 v253, 7, v250
    s_mov_b64 exec, 0xffffffff
    buffer_load_dword v9, v253, s[80:83], s64 offen sc1
    s_mov_b64 exec, -1
    s_mov_b32 s12, s88
    s_mov_b32 s13, s89
    s_mov_b32 s14, 2097152
    s_mov_b32 s15, 0x00020000
    v_lshrrev_b32 v253, 3, v250
    v_lshlrev_b32 v253, 13, v253
    v_and_b32 v254, 7, v250
    v_lshl_add_u32 v253, v254, 4, v253
    s_lshl_b32 s64, s69, 11
    v_add_u32 v244, s64, v253
    s_mul_i32 s51, s69, 1056
    s_lshl_b32 s49, s72, 7
    s_waitcnt vmcnt(14)
    v_and_b32 v73, 0x80808080, v72
    v_cmp_ne_u32 vcc, 0x80808080, v73
    s_cbranch_vccnz hs_30
hs_30_b:
    s_mul_i32 s65, s69, 36
    v_add_u32 v75, s65, v250
    s_lshl_b32 s64, s67, 7
    s_sub_u32 s64, s64, 16
    v_add_u32 v76, s64, v75
    v_and_b32 v76, 0x7ff, v76
    v_lshrrev_b32 v77, 1, v76
    v_and_b32 v76, 1, v76
    v_lshlrev_b32 v77, 6, v77
    v_lshl_add_u32 v74, v76, 3, v77
    s_mov_b32 s64, 74186752
    s_mov_b32 exec_hi, 15
    buffer_load_dwordx2 v[76:77], v74, s[80:83], s64 offen sc1
    s_mov_b64 exec, -1
    v_lshlrev_b32 v75, 3, v75
    v_add_u32 v75, 159744, v75
    s_and_b32 s64, s70, 3
    s_lshl_b32 s64, s64, 3
    v_bfe_u32 v72, v72, s64, 8
    v_cmp_ne_u32 vcc, s32, v72
    s_lshr_b32 s64, s70, 2
    s_lshl_b32 s65, 0x55555555, s64
    s_or_b32 s64, vcc_lo, vcc_hi
    s_and_b32 s64, s64, s65
    s_cselect_b32 s78, 1, 0
    s_mov_b32 s59, s78
    s_mul_i32 s60, s59, s75
    s_add_u32 s48, s58, 0
    s_and_b32 s48, s48, 7
    s_and_b32 s66, s74, 8
    s_or_b32 s48, s48, s66
    s_lshl_b32 s48, s48, 17
    s_add_u32 s48, s48, s49
    s_add_u32 m0, s51, 116224
    s_nop 0
    buffer_load_dwordx4 v244, s[12:15], s48 offen lds
    s_add_u32 s48, s48, 65536
    s_waitcnt vmcnt(6)
    s_barrier
    s_add_u32 m0, s51, 120448
    s_nop 0
    buffer_load_dwordx4 v244, s[12:15], s48 offen lds
    s_add_u32 s48, s48, 65536
    s_add_u32 s48, s58, 1
    s_and_b32 s48, s48, 7
    s_and_b32 s66, s74, 8
    s_or_b32 s48, s48, s66
    s_lshl_b32 s48, s48, 17
    s_add_u32 s48, s48, s49
    s_add_u32 m0, s51, 124672
    s_nop 0
    buffer_load_dwordx4 v244, s[12:15], s48 offen lds
    s_add_u32 s48, s48, 65536
    s_add_u32 m0, s51, 128896
    s_nop 0
    buffer_load_dwordx4 v244, s[12:15], s48 offen lds
    s_add_u32 s48, s48, 65536
    s_add_u32 s48, s58, 2
    s_and_b32 s48, s48, 7
    s_and_b32 s66, s74, 8
    s_or_b32 s48, s48, s66
    s_lshl_b32 s48, s48, 17
    s_add_u32 s48, s48, s49
    s_add_u32 m0, s51, 133120
    s_nop 0
    buffer_load_dwordx4 v244, s[12:15], s48 offen lds
    s_add_u32 s48, s48, 65536
    s_add_u32 m0, s51, 137344
    s_nop 0
    buffer_load_dwordx4 v244, s[12:15], s48 offen lds
    s_add_u32 s48, s48, 65536
    s_add_u32 s48, s58, 3
    s_and_b32 s48, s48, 7
    s_and_b32 s66, s74, 8
    s_or_b32 s48, s48, s66
    s_lshl_b32 s48, s48, 17
    s_add_u32 s48, s48, s49
    s_add_u32 m0, s51, 141568
    s_nop 0
    buffer_load_dwordx4 v244, s[12:15], s48 offen lds
    s_add_u32 s48, s48, 65536
    s_add_u32 m0, s51, 145792
    s_nop 0
    buffer_load_dwordx4 v244, s[12:15], s48 offen lds
    s_add_u32 s48, s48, 65536
    s_add_u32 s48, s58, 4
    s_and_b32 s48, s48, 7
    s_and_b32 s66, s74, 8
    s_or_b32 s48, s48, s66
    s_lshl_b32 s48, s48, 17
    s_add_u32 s48, s48, s49
    s_add_u32 m0, s51, 150016
    s_nop 0
    buffer_load_dwordx4 v244, s[12:15], s48 offen lds
    s_add_u32 s48, s48, 65536
    s_waitcnt vmcnt(11)
    s_barrier
    s_waitcnt vmcnt(9)
    v_mov_b32 v72, s78
    v_mov_b32 v73, 163456
    s_mov_b32 exec_hi, 15
    ds_write_b64 v75, v[76:77]
    ds_write_b32 v73, v72
    s_mov_b64 exec, -1
    s_add_u32 m0, s51, 154240
    s_nop 0
    buffer_load_dwordx4 v244, s[12:15], s48 offen lds
    s_add_u32 s48, s48, 65536
    s_add_u32 s48, s58, 5
    s_and_b32 s48, s48, 7
    s_and_b32 s66, s74, 8
    s_or_b32 s48, s48, s66
    s_lshl_b32 s48, s48, 17
    s_add_u32 s48, s48, s49
    s_add_u32 m0, s51, 65536
    s_nop 0
    buffer_load_dwordx4 v244, s[12:15], s48 offen lds
    s_add_u32 s48, s48, 65536
    s_add_u32 m0, s51, 69760
    s_nop 0
    buffer_load_dwordx4 v244, s[12:15], s48 offen lds
    s_add_u32 s48, s48, 65536
    s_add_u32 s48, s58, 6
    s_and_b32 s48, s48, 7
    s_and_b32 s66, s74, 8
    s_or_b32 s48, s48, s66
    s_lshl_b32 s48, s48, 17
    s_add_u32 s48, s48, s49
    s_add_u32 m0, s51, 73984
    s_nop 0
    buffer_load_dwordx4 v244, s[12:15], s48 offen lds
    s_add_u32 s48, s48, 65536
    s_add_u32 m0, s51, 78208
    s_nop 0
    buffer_load_dwordx4 v244, s[12:15], s48 offen lds
    s_add_u32 s48, s48, 65536
    s_waitcnt lgkmcnt(0)
    s_barrier
    s_add_u32 s48, s58, 7
    s_and_b32 s48, s48, 7
    s_and_b32 s66, s74, 8
    s_or_b32 s48, s48, s66
    s_lshl_b32 s48, s48, 17
    s_add_u32 s48, s48, s49
    s_add_u32 m0, s51, 82432
    s_nop 0
    buffer_load_dwordx4 v244, s[12:15], s48 offen lds
    s_add_u32 s48, s48, 65536
    s_add_u32 m0, s51, 86656
    s_nop 0
    buffer_load_dwordx4 v244, s[12:15], s48 offen lds
    s_add_u32 s48, s48, 65536
    s_add_u32 s48, s58, 8
    s_and_b32 s48, s48, 7
    s_and_b32 s66, s74, 8
    s_xor_b32 s66, s66, 8
    s_or_b32 s48, s48, s66
    s_lshl_b32 s48, s48, 17
    s_add_u32 s48, s48, s49
    s_add_u32 m0, s51, 90880
    s_nop 0
    buffer_load_dwordx4 v244, s[12:15], s48 offen lds
    s_add_u32 s48, s48, 65536
    s_add_u32 m0, s51, 95104
    s_nop 0
    buffer_load_dwordx4 v244, s[12:15], s48 offen lds
    s_add_u32 s48, s48, 65536
    s_add_u32 s48, s58, 9
    s_and_b32 s48, s48, 7
    s_and_b32 s66, s74, 8
    s_xor_b32 s66, s66, 8
    s_or_b32 s48, s48, s66
    s_lshl_b32 s48, s48, 17
    s_add_u32 s48, s48, s49
    s_add_u32 m0, s51, 99328
    s_nop 0
    buffer_load_dwordx4 v244, s[12:15], s48 offen lds
    s_add_u32 s48, s48, 65536
    s_add_u32 m0, s51, 103552
    s_nop 0
    buffer_load_dwordx4 v244, s[12:15], s48 offen lds
    s_add_u32 s48, s48, 65536
    s_add_u32 s48, s58, 10
    s_and_b32 s48, s48, 7
    s_and_b32 s66, s74, 8
    s_xor_b32 s66, s66, 8
    s_or_b32 s48, s48, s66
    s_lshl_b32 s48, s48, 17
    s_add_u32 s48, s48, s49
    s_add_u32 m0, s51, 107776
    s_nop 0
    buffer_load_dwordx4 v244, s[12:15], s48 offen lds
    s_add_u32 s48, s48, 65536
    s_add_u32 m0, s51, 112000
    s_nop 0
    buffer_load_dwordx4 v244, s[12:15], s48 offen lds
    s_add_u32 s48, s48, 65536
L_g2:
    s_and_b32 s64, s3, 1
    s_cmp_eq_u32 s64, 0
    s_cselect_b32 s8, s92, s94
    s_cselect_b32 s9, s93, s95
    s_mov_b32 s10, 7340032
    s_mov_b32 s11, 0x00020000
    s_mul_i32 s19, s64, 14400
    s_lshr_b32 s64, s69, 1
    s_mul_i32 s65, s64, 7200
    s_add_u32 s19, s19, s65
    s_add_u32 s19, s19, 36736
    s_mul_i32 s17, s64, 28672
    s_mul_i32 s65, s74, 448
    s_add_u32 s17, s17, s65
    s_add_u32 s18, s17, 7340032
    s_lshl_b32 s64, s57, 1
    s_mul_i32 s65, s64, 229376
    s_add_u32 s16, s17, s65
    s_mov_b32 s66, 2341
    v_add_u32 v253, 0, v250
    v_mul_lo_u32 v254, v253, s66
    v_lshrrev_b32 v254, 16, v254
    v_mul_u32_u24 v228, 28, v254
    v_sub_u32 v253, v253, v228
    v_and_b32 v228, 12, v254
    v_add_u32 v254, v254, v228
    v_mul_u32_u24 v254, 7168, v254
    v_lshl_add_u32 v228, v253, 4, v254
    v_add_u32 v253, 64, v250
    v_mul_lo_u32 v254, v253, s66
    v_lshrrev_b32 v254, 16, v254
    v_mul_u32_u24 v229, 28, v254
    v_sub_u32 v253, v253, v229
    v_and_b32 v229, 12, v254
    v_add_u32 v254, v254, v229
    v_mul_u32_u24 v254, 7168, v254
    v_lshl_add_u32 v229, v253, 4, v254
    v_add_u32 v253, 128, v250
    v_mul_lo_u32 v254, v253, s66
    v_lshrrev_b32 v254, 16, v254
    v_mul_u32_u24 v230, 28, v254
    v_sub_u32 v253, v253, v230
    v_and_b32 v230, 12, v254
    v_add_u32 v254, v254, v230
    v_mul_u32_u24 v254, 7168, v254
    v_lshl_add_u32 v230, v253, 4, v254
    v_add_u32 v253, 192, v250
    v_mul_lo_u32 v254, v253, s66
    v_lshrrev_b32 v254, 16, v254
    v_mul_u32_u24 v231, 28, v254
    v_sub_u32 v253, v253, v231
    v_and_b32 v231, 12, v254
    v_add_u32 v254, v254, v231
    v_mul_u32_u24 v254, 7168, v254
    v_lshl_add_u32 v231, v253, 4, v254
    v_add_u32 v253, 256, v250
    v_mul_lo_u32 v254, v253, s66
    v_lshrrev_b32 v254, 16, v254
    v_mul_u32_u24 v232, 28, v254
    v_sub_u32 v253, v253, v232
    v_and_b32 v232, 12, v254
    v_add_u32 v254, v254, v232
    v_mul_u32_u24 v254, 7168, v254
    v_lshl_add_u32 v232, v253, 4, v254
    v_add_u32 v253, 320, v250
    v_mul_lo_u32 v254, v253, s66
    v_lshrrev_b32 v254, 16, v254
    v_mul_u32_u24 v233, 28, v254
    v_sub_u32 v253, v253, v233
    v_and_b32 v233, 12, v254
    v_add_u32 v254, v254, v233
    v_mul_u32_u24 v254, 7168, v254
    v_lshl_add_u32 v233, v253, 4, v254
    v_add_u32 v253, 384, v250
    v_mul_lo_u32 v254, v253, s66
    v_lshrrev_b32 v254, 16, v254
    v_mul_u32_u24 v234, 28, v254
    v_sub_u32 v253, v253, v234
    v_and_b32 v234, 12, v254
    v_add_u32 v254, v254, v234
    v_mul_u32_u24 v254, 7168, v254
    v_lshl_add_u32 v234, v253, 4, v254
    s_lshl_b32 s53, s75, 22
    s_lshl_b32 s64, s73, 18
    s_add_u32 s53, s53, s64
    s_add_u32 s53, s53, 12582912
    s_lshl_b32 s55, s69, 11
    s_add_u32 s53, s53, s55
    s_lshl_b32 s56, s75, 15
    s_lshl_b32 s66, s73, 9
    s_add_u32 s56, s56, s66
    s_add_u32 s56, s56, 75497472
    v_lshlrev_b32 v246, 5, v250
    s_lshl_b32 s62, 1, s72
    s_or_b32 s62, s62, 0x5555
    s_mov_b32 s63, 0
    s_xor_b32 s64, s72, 1
    s_or_b32 s64, s64, s69
    s_cselect_b32 s62, s62, 0xffff
    s_lshl_b32 s46, s75, 12
    s_add_u32 s46, s46, 75575296
    s_xor_b32 s47, s73, 2
    s_lshl_b32 s47, s47, 8
    s_add_u32 s47, s47, s46
    s_add_u32 s47, s47, 128
    s_mov_b64 exec, s[62:63]
pl_31:
    buffer_load_dwordx4 v[240:243], v246, s[80:83], s56 offen sc1
    s_sub_u32 s79, s79, 1
    s_cbranch_scc1 L_abort
    s_waitcnt vmcnt(0)
    v_and_b32 v240, v240, v241
    v_and_b32 v242, v242, v243
    v_and_b32 v240, v240, v242
    v_cmp_ne_u32 vcc, 1, v240
    s_cbranch_vccnz pl_31
    s_mov_b64 exec, -1
    s_cmp_lg_u32 s78, 0
    s_cbranch_scc1 pl_31_acq
pl_31_ok:
    s_lshr_b32 s64, s72, 1
    s_or_b32 s64, s64, s69
    s_cbranch_scc1 rl_32
    s_lshl_b32 s64, s73, 1
    s_add_u32 s64, s64, s68
    s_lshl_b32 s64, s64, 7
    s_add_u32 s64, s64, s46
    v_mov_b32 v242, 0
    v_mov_b32 v243, 1
    s_mov_b64 exec, 1
    buffer_store_dword v243, v242, s[80:83], s64 offen sc0 sc1
    s_mov_b64 exec, -1
rl_32:
    s_add_u32 s52, s58, 0
    s_and_b32 s52, s52, 7
    s_and_b32 s66, s74, 8
    s_or_b32 s52, s52, s66
    s_lshl_b32 s52, s52, 14
    s_add_u32 s52, s52, s53
    s_add_u32 m0, s55, 0
    s_nop 0
    buffer_load_dwordx4 v249, s[80:83], s52 offen offset:0 sc1 lds
    buffer_load_dwordx4 v249, s[80:83], s52 offen offset:1024 sc1 lds
    s_add_u32 s52, s52, 8192
    s_add_u32 m0, s55, 8192
    s_nop 0
    buffer_load_dwordx4 v249, s[80:83], s52 offen offset:0 sc1 lds
    buffer_load_dwordx4 v249, s[80:83], s52 offen offset:1024 sc1 lds
    s_add_u32 s52, s52, 8192
    s_add_u32 s52, s58, 1
    s_and_b32 s52, s52, 7
    s_and_b32 s66, s74, 8
    s_or_b32 s52, s52, s66
    s_lshl_b32 s52, s52, 14
    s_add_u32 s52, s52, s53
    s_add_u32 m0, s55, 16384
    s_nop 0
    buffer_load_dwordx4 v249, s[80:83], s52 offen offset:0 sc1 lds
    buffer_load_dwordx4 v249, s[80:83], s52 offen offset:1024 sc1 lds
    s_add_u32 s52, s52, 8192
    s_add_u32 m0, s55, 24576
    s_nop 0
    buffer_load_dwordx4 v249, s[80:83], s52 offen offset:0 sc1 lds
    buffer_load_dwordx4 v249, s[80:83], s52 offen offset:1024 sc1 lds
    s_add_u32 s52, s52, 8192
    s_waitcnt vmcnt(4) lgkmcnt(0)
    s_barrier
    s_add_u32 s52, s58, 2
    s_and_b32 s52, s52, 7
    s_and_b32 s66, s74, 8
    s_or_b32 s52, s52, s66
    s_lshl_b32 s52, s52, 14
    s_add_u32 s52, s52, s53
    s_add_u32 m0, s55, 32768
    s_nop 0
    buffer_load_dwordx4 v249, s[80:83], s52 offen offset:0 sc1 lds
    buffer_load_dwordx4 v249, s[80:83], s52 offen offset:1024 sc1 lds
    s_add_u32 s52, s52, 8192
    s_add_u32 m0, s55, 40960
    s_nop 0
    buffer_load_dwordx4 v249, s[80:83], s52 offen offset:0 sc1 lds
    buffer_load_dwordx4 v249, s[80:83], s52 offen offset:1024 sc1 lds
    s_add_u32 s52, s52, 8192
    s_add_u32 s52, s58, 3
    s_and_b32 s52, s52, 7
    s_and_b32 s66, s74, 8
    s_or_b32 s52, s52, s66
    s_lshl_b32 s52, s52, 14
    s_add_u32 s52, s52, s53
    s_add_u32 m0, s55, 49152
    s_nop 0
    buffer_load_dwordx4 v249, s[80:83], s52 offen offset:0 sc1 lds
    buffer_load_dwordx4 v249, s[80:83], s52 offen offset:1024 sc1 lds
    s_add_u32 s52, s52, 8192
    s_waitcnt vmcnt(6)
    s_barrier
    s_add_u32 m0, s55, 57344
    s_nop 0
    buffer_load_dwordx4 v249, s[80:83], s52 offen offset:0 sc1 lds
    buffer_load_dwordx4 v249, s[80:83], s52 offen offset:1024 sc1 lds
    s_add_u32 s52, s52, 8192
    s_add_u32 s52, s58, 4
    s_and_b32 s52, s52, 7
    s_and_b32 s66, s74, 8
    s_or_b32 s52, s52, s66
    s_lshl_b32 s52, s52, 14
    s_add_u32 s52, s52, s53
    s_add_u32 m0, s55, 0
    s_nop 0
    buffer_load_dwordx4 v249, s[80:83], s52 offen offset:0 sc1 lds
    buffer_load_dwordx4 v249, s[80:83], s52 offen offset:1024 sc1 lds
    s_add_u32 s52, s52, 8192
    s_add_u32 m0, s55, 8192
    s_nop 0
    buffer_load_dwordx4 v249, s[80:83], s52 offen offset:0 sc1 lds
    buffer_load_dwordx4 v249, s[80:83], s52 offen offset:1024 sc1 lds
    s_add_u32 s52, s52, 8192
    s_waitcnt vmcnt(8)
    s_barrier
    s_add_u32 s52, s58, 5
    s_and_b32 s52, s52, 7
    s_and_b32 s66, s74, 8
    s_or_b32 s52, s52, s66
    s_lshl_b32 s52, s52, 14
    s_add_u32 s52, s52, s53
    s_add_u32 m0, s55, 16384
    s_nop 0
    buffer_load_dwordx4 v249, s[80:83], s52 offen offset:0 sc1 lds
    buffer_load_dwordx4 v249, s[80:83], s52 offen offset:1024 sc1 lds
    s_add_u32 s52, s52, 8192
    s_add_u32 m0, s55, 24576
    s_nop 0
    buffer_load_dwordx4 v249, s[80:83], s52 offen offset:0 sc1 lds
    buffer_load_dwordx4 v249, s[80:83], s52 offen offset:1024 sc1 lds
    s_add_u32 s52, s52, 8192
    s_waitcnt vmcnt(8)
    s_barrier
    s_add_u32 s52, s58, 6
    s_and_b32 s52, s52, 7
    s_and_b32 s66, s74, 8
    s_or_b32 s52, s52, s66
    s_lshl_b32 s52, s52, 14
    s_add_u32 s52, s52, s53
    s_add_u32 m0, s55, 32768
    s_nop 0
    buffer_load_dwordx4 v249, s[80:83], s52 offen offset:0 sc1 lds
    buffer_load_dwordx4 v249, s[80:83], s52 offen offset:1024 sc1 lds
    s_add_u32 s52, s52, 8192
    v_mov_b32 v246, 0
    buffer_load_dword v240, v246, s[80:83], s47 offen sc1
    s_add_u32 m0, s55, 40960
    s_nop 0
    buffer_load_dwordx4 v249, s[80:83], s52 offen offset:0 sc1 lds
    buffer_load_dwordx4 v249, s[80:83], s52 offen offset:1024 sc1 lds
    s_add_u32 s52, s52, 8192
    s_add_u32 s48, s58, 11
    s_and_b32 s48, s48, 7
    s_and_b32 s66, s74, 8
    s_xor_b32 s66, s66, 8
    s_or_b32 s48, s48, s66
    s_lshl_b32 s48, s48, 17
    s_add_u32 s48, s48, s49
    s_add_u32 m0, s51, 116224
    s_nop 0
    buffer_load_dwordx4 v244, s[12:15], s48 offen lds
    s_add_u32 s48, s48, 65536
    s_waitcnt vmcnt(10)
    s_barrier
    s_add_u32 s52, s58, 7
    s_and_b32 s52, s52, 7
    s_and_b32 s66, s74, 8
    s_or_b32 s52, s52, s66
    s_lshl_b32 s52, s52, 14
    s_add_u32 s52, s52, s53
    s_add_u32 m0, s55, 49152
    s_nop 0
    buffer_load_dwordx4 v249, s[80:83], s52 offen offset:0 sc1 lds
    buffer_load_dwordx4 v249, s[80:83], s52 offen offset:1024 sc1 lds
    s_add_u32 s52, s52, 8192
    s_add_u32 m0, s55, 57344
    s_nop 0
    buffer_load_dwordx4 v249, s[80:83], s52 offen offset:0 sc1 lds
    buffer_load_dwordx4 v249, s[80:83], s52 offen offset:1024 sc1 lds
    s_add_u32 s52, s52, 8192
    s_add_u32 m0, s51, 120448
    s_nop 0
    buffer_load_dwordx4 v244, s[12:15], s48 offen lds
    s_add_u32 s48, s48, 65536
    s_waitcnt vmcnt(11)
    s_barrier
    s_waitcnt vmcnt(8)
    v_cmp_ne_u32 vcc, 1, v240
    s_or_b32 s64, vcc_lo, s78
    s_cbranch_scc1 rc_33
rc_33_b:
    s_add_u32 s52, s58, 8
    s_and_b32 s52, s52, 7
    s_and_b32 s66, s74, 8
    s_xor_b32 s66, s66, 8
    s_or_b32 s52, s52, s66
    s_lshl_b32 s52, s52, 14
    s_add_u32 s52, s52, s53
    s_add_u32 m0, s55, 0
    s_nop 0
    buffer_load_dwordx4 v249, s[80:83], s52 offen offset:0 sc1 lds
    buffer_load_dwordx4 v249, s[80:83], s52 offen offset:1024 sc1 lds
    s_add_u32 s52, s52, 8192
    s_add_u32 m0, s55, 8192
    s_nop 0
    buffer_load_dwordx4 v249, s[80:83], s52 offen offset:0 sc1 lds
    buffer_load_dwordx4 v249, s[80:83], s52 offen offset:1024 sc1 lds
    s_add_u32 s52, s52, 8192
    s_add_u32 s48, s58, 12
    s_and_b32 s48, s48, 7
    s_and_b32 s66, s74, 8
    s_xor_b32 s66, s66, 8
    s_or_b32 s48, s48, s66
    s_lshl_b32 s48, s48, 17
    s_add_u32 s48, s48, s49
    s_add_u32 m0, s51, 124672
    s_nop 0
    buffer_load_dwordx4 v244, s[12:15], s48 offen lds
    s_add_u32 s48, s48, 65536
    s_waitcnt vmcnt(11)
    s_barrier
    s_add_u32 s52, s58, 9
    s_and_b32 s52, s52, 7
    s_and_b32 s66, s74, 8
    s_xor_b32 s66, s66, 8
    s_or_b32 s52, s52, s66
    s_lshl_b32 s52, s52, 14
    s_add_u32 s52, s52, s53
    s_add_u32 m0, s55, 16384
    s_nop 0
    buffer_load_dwordx4 v249, s[80:83], s52 offen offset:0 sc1 lds
    buffer_load_dwordx4 v249, s[80:83], s52 offen offset:1024 sc1 lds
    s_add_u32 s52, s52, 8192
    s_add_u32 m0, s55, 24576
    s_nop 0
    buffer_load_dwordx4 v249, s[80:83], s52 offen offset:0 sc1 lds
    buffer_load_dwordx4 v249, s[80:83], s52 offen offset:1024 sc1 lds
    s_add_u32 s52, s52, 8192
    s_add_u32 m0, s51, 128896
    s_nop 0
    buffer_load_dwordx4 v244, s[12:15], s48 offen lds
    s_add_u32 s48, s48, 65536
    s_waitcnt vmcnt(11)
    s_barrier
    s_add_u32 s52, s58, 10
    s_and_b32 s52, s52, 7
    s_and_b32 s66, s74, 8
    s_xor_b32 s66, s66, 8
    s_or_b32 s52, s52, s66
    s_lshl_b32 s52, s52, 14
    s_add_u32 s52, s52, s53
    s_add_u32 m0, s55, 32768
    s_nop 0
    buffer_load_dwordx4 v249, s[80:83], s52 offen offset:0 sc1 lds
    buffer_load_dwordx4 v249, s[80:83], s52 offen offset:1024 sc1 lds
    s_add_u32 s52, s52, 8192
    s_add_u32 m0, s55, 40960
    s_nop 0
    buffer_load_dwordx4 v249, s[80:83], s52 offen offset:0 sc1 lds
    buffer_load_dwordx4 v249, s[80:83], s52 offen offset:1024 sc1 lds
    s_add_u32 s52, s52, 8192
    s_add_u32 s48, s58, 13
    s_and_b32 s48, s48, 7
    s_and_b32 s66, s74, 8
    s_xor_b32 s66, s66, 8
    s_or_b32 s48, s48, s66
    s_lshl_b32 s48, s48, 17
    s_add_u32 s48, s48, s49
    s_add_u32 m0, s51, 133120
    s_nop 0
    buffer_load_dwordx4 v244, s[12:15], s48 offen lds
    s_add_u32 s48, s48, 65536
    s_waitcnt vmcnt(11)
    s_barrier
    s_add_u32 s52, s58, 11
    s_and_b32 s52, s52, 7
    s_and_b32 s66, s74, 8
    s_xor_b32 s66, s66, 8
    s_or_b32 s52, s52, s66
    s_lshl_b32 s52, s52, 14
    s_add_u32 s52, s52, s53
    s_add_u32 m0, s55, 49152
    s_nop 0
    buffer_load_dwordx4 v249, s[80:83], s52 offen offset:0 sc1 lds
    buffer_load_dwordx4 v249, s[80:83], s52 offen offset:1024 sc1 lds
    s_add_u32 s52, s52, 8192
    s_add_u32 m0, s55, 57344
    s_nop 0
    buffer_load_dwordx4 v249, s[80:83], s52 offen offset:0 sc1 lds
    buffer_load_dwordx4 v249, s[80:83], s52 offen offset:1024 sc1 lds
    s_add_u32 s52, s52, 8192
    s_add_u32 m0, s51, 137344
    s_nop 0
    buffer_load_dwordx4 v244, s[12:15], s48 offen lds
    s_add_u32 s48, s48, 65536
    s_waitcnt vmcnt(11)
    s_barrier
    s_add_u32 s52, s58, 12
    s_and_b32 s52, s52, 7
    s_and_b32 s66, s74, 8
    s_xor_b32 s66, s66, 8
    s_or_b32 s52, s52, s66
    s_lshl_b32 s52, s52, 14
    s_add_u32 s52, s52, s53
    s_add_u32 m0, s55, 0
    s_nop 0
    buffer_load_dwordx4 v249, s[80:83], s52 offen offset:0 sc1 lds
    buffer_load_dwordx4 v249, s[80:83], s52 offen offset:1024 sc1 lds
    s_add_u32 s52, s52, 8192
    s_add_u32 m0, s55, 8192
    s_nop 0
    buffer_load_dwordx4 v249, s[80:83], s52 offen offset:0 sc1 lds
    buffer_load_dwordx4 v249, s[80:83], s52 offen offset:1024 sc1 lds
    s_add_u32 s52, s52, 8192
    s_add_u32 s48, s58, 14
    s_and_b32 s48, s48, 7
    s_and_b32 s66, s74, 8
    s_xor_b32 s66, s66, 8
    s_or_b32 s48, s48, s66
    s_lshl_b32 s48, s48, 17
    s_add_u32 s48, s48, s49
    s_add_u32 m0, s51, 141568
    s_nop 0
    buffer_load_dwordx4 v244, s[12:15], s48 offen lds
    s_add_u32 s48, s48, 65536
    s_waitcnt vmcnt(11)
    s_barrier
    s_add_u32 s52, s58, 13
    s_and_b32 s52, s52, 7
    s_and_b32 s66, s74, 8
    s_xor_b32 s66, s66, 8
    s_or_b32 s52, s52, s66
    s_lshl_b32 s52, s52, 14
    s_add_u32 s52, s52, s53
    s_add_u32 m0, s55, 16384
    s_nop 0
    buffer_load_dwordx4 v249, s[80:83], s52 offen offset:0 sc1 lds
    buffer_load_dwordx4 v249, s[80:83], s52 offen offset:1024 sc1 lds
    s_add_u32 s52, s52, 8192
    s_add_u32 m0, s55, 24576
    s_nop 0
    buffer_load_dwordx4 v249, s[80:83], s52 offen offset:0 sc1 lds
    buffer_load_dwordx4 v249, s[80:83], s52 offen offset:1024 sc1 lds
    s_add_u32 s52, s52, 8192
    s_add_u32 m0, s51, 145792
    s_nop 0
    buffer_load_dwordx4 v244, s[12:15], s48 offen lds
    s_add_u32 s48, s48, 65536
    s_waitcnt vmcnt(11)
    s_barrier
    s_add_u32 s52, s58, 14
    s_and_b32 s52, s52, 7
    s_and_b32 s66, s74, 8
    s_xor_b32 s66, s66, 8
    s_or_b32 s52, s52, s66
    s_lshl_b32 s52, s52, 14
    s_add_u32 s52, s52, s53
    s_add_u32 m0, s55, 32768
    s_nop 0
    buffer_load_dwordx4 v249, s[80:83], s52 offen offset:0 sc1 lds
    buffer_load_dwordx4 v249, s[80:83], s52 offen offset:1024 sc1 lds
    s_add_u32 s52, s52, 8192
    s_add_u32 m0, s55, 40960
    s_nop 0
    buffer_load_dwordx4 v249, s[80:83], s52 offen offset:0 sc1 lds
    buffer_load_dwordx4 v249, s[80:83], s52 offen offset:1024 sc1 lds
    s_add_u32 s52, s52, 8192
    s_add_u32 s48, s58, 15
    s_and_b32 s48, s48, 7
    s_and_b32 s66, s74, 8
    s_xor_b32 s66, s66, 8
    s_or_b32 s48, s48, s66
    s_lshl_b32 s48, s48, 17
    s_add_u32 s48, s48, s49
    s_add_u32 m0, s51, 150016
    s_nop 0
    buffer_load_dwordx4 v244, s[12:15], s48 offen lds
    s_add_u32 s48, s48, 65536
    s_waitcnt vmcnt(11)
    s_barrier
    s_add_u32 s52, s58, 15
    s_and_b32 s52, s52, 7
    s_and_b32 s66, s74, 8
    s_xor_b32 s66, s66, 8
    s_or_b32 s52, s52, s66
    s_lshl_b32 s52, s52, 14
    s_add_u32 s52, s52, s53
    s_add_u32 m0, s55, 49152
    s_nop 0
    buffer_load_dwordx4 v249, s[80:83], s52 offen offset:0 sc1 lds
    buffer_load_dwordx4 v249, s[80:83], s52 offen offset:1024 sc1 lds
    s_add_u32 s52, s52, 8192
    s_add_u32 m0, s55, 57344
    s_nop 0
    buffer_load_dwordx4 v249, s[80:83], s52 offen offset:0 sc1 lds
    buffer_load_dwordx4 v249, s[80:83], s52 offen offset:1024 sc1 lds
    s_add_u32 s52, s52, 8192
    s_add_u32 m0, s51, 154240
    s_nop 0
    buffer_load_dwordx4 v244, s[12:15], s48 offen lds
    s_add_u32 s48, s48, 65536
    s_waitcnt vmcnt(11)
    s_barrier
    s_add_u32 m0, s19, 28800
    s_nop 0
    buffer_load_dwordx4 v228, s[8:11], s16 offen lds
    s_add_u32 m0, s19, 29824
    s_nop 0
    buffer_load_dwordx4 v229, s[8:11], s16 offen lds
    s_add_u32 m0, s19, 30848
    s_nop 0
    buffer_load_dwordx4 v230, s[8:11], s16 offen lds
    s_waitcnt vmcnt(3)
    s_barrier
    s_add_u32 m0, s19, 31872
    s_nop 0
    buffer_load_dwordx4 v231, s[8:11], s16 offen lds
    s_add_u32 m0, s19, 32896
    s_nop 0
    buffer_load_dwordx4 v232, s[8:11], s16 offen lds
    s_add_u32 m0, s19, 33920
    s_nop 0
    buffer_load_dwordx4 v233, s[8:11], s16 offen lds
    s_add_u32 m0, s19, 34944
    s_nop 0
    buffer_load_dwordx4 v234, s[8:11], s16 offen lds
    s_add_u32 s16, s16, 229376
    s_cmp_eq_u32 s16, s18
    s_cselect_b32 s16, s17, s16
    s_add_u32 m0, s19, 57600
    s_nop 0
    buffer_load_dwordx4 v228, s[8:11], s16 offen lds
    s_add_u32 m0, s19, 58624
    s_nop 0
    buffer_load_dwordx4 v229, s[8:11], s16 offen lds
    s_add_u32 m0, s19, 59648
    s_nop 0
    buffer_load_dwordx4 v230, s[8:11], s16 offen lds
    s_add_u32 m0, s19, 60672
    s_nop 0
    buffer_load_dwordx4 v231, s[8:11], s16 offen lds
    s_add_u32 m0, s19, 61696
    s_nop 0
    buffer_load_dwordx4 v232, s[8:11], s16 offen lds
    s_add_u32 m0, s19, 62720
    s_nop 0
    buffer_load_dwordx4 v233, s[8:11], s16 offen lds
    s_add_u32 m0, s19, 63744
    s_nop 0
    buffer_load_dwordx4 v234, s[8:11], s16 offen lds
    s_add_u32 s16, s16, 229376
    s_cmp_eq_u32 s16, s18
    s_cselect_b32 s16, s17, s16
    s_barrier
    s_setprio 1
    s_and_b32 s64, s69, 2
    s_xor_b32 s32, s73, s64
    s_lshl_b32 s21, s75, 23
    s_lshl_b32 s64, s32, 18
    s_add_u32 s21, s21, s64
    s_lshl_b32 s64, s68, 1
    s_and_b32 s65, s69, 1
    s_add_u32 s33, s64, s65
    s_lshl_b32 s64, s33, 11
    s_add_u32 s21, s21, s64
    s_lshl_b32 s23, s69, 11
    s_add_u32 s22, s21, 262144
    s_lshl_b32 s64, s57, 14
    s_add_u32 s20, s21, s64
    s_add_u32 s34, s58, s71
    s_lshl_b32 s34, s34, 1
    s_add_u32 s34, s34, s68
    s_and_b32 s64, s3, 1
    s_lshl_b32 s64, s64, 12
    v_add_u32 v235, s64, v249
    v_lshrrev_b32 v253, 1, v251
    v_lshrrev_b32 v254, 2, v252
    v_lshl_add_u32 v253, v253, 2, v254
    v_mul_u32_u24 v253, 448, v253
    v_and_b32 v254, 1, v251
    v_mul_u32_u24 v254, 7200, v254
    v_add_u32 v253, v253, v254
    v_and_b32 v254, 3, v252
    v_lshl_add_u32 v253, v254, 3, v253
    v_add_u32 v253, 36736, v253
    s_lshr_b32 s64, s69, 1
    s_lshl_b32 s28, s64, 2
    s_add_u32 s28, s28, 8
    s_lshl_b32 s65, s28, 5
    v_add_u32 v236, s65, v253
    v_add_u32 v237, 57600, v236
    s_add_u32 s65, s64, 10
    s_lshl_b32 s65, s65, 5
    v_add_u32 v238, s65, v253
    v_add_u32 v239, 57600, v238
    s_mul_i32 s65, s64, 224
    s_and_b32 s64, s3, 1
    s_mul_i32 s64, s64, 14400
    s_add_u32 s65, s65, s64
    v_add_u32 v224, s65, v253
    v_mov_b32 v220, 0x3f803f80
    v_cmp_eq_u32 vcc, 0, v252
    s_nop 1
    v_cndmask_b32 v176, 0, v220, vcc
    v_cndmask_b32 v177, 0, v220, vcc
    v_cndmask_b32 v178, 0, v220, vcc
    v_cndmask_b32 v179, 0, v220, vcc
    v_cmp_eq_u32 vcc, 1, v252
    s_nop 1
    v_cndmask_b32 v180, 0, v220, vcc
    v_cndmask_b32 v181, 0, v220, vcc
    v_cndmask_b32 v182, 0, v220, vcc
    v_cndmask_b32 v183, 0, v220, vcc
    v_cmp_eq_u32 vcc, 2, v252
    s_nop 1
    v_cndmask_b32 v184, 0, v220, vcc
    v_cndmask_b32 v185, 0, v220, vcc
    v_cndmask_b32 v186, 0, v220, vcc
    v_cndmask_b32 v187, 0, v220, vcc
    v_cmp_eq_u32 vcc, 3, v252
    s_nop 1
    v_cndmask_b32 v188, 0, v220, vcc
    v_cndmask_b32 v189, 0, v220, vcc
    v_cndmask_b32 v190, 0, v220, vcc
    v_cndmask_b32 v191, 0, v220, vcc
    v_cmp_eq_u32 vcc, 4, v252
    s_nop 1
    v_cndmask_b32 v192, 0, v220, vcc
    v_cndmask_b32 v193, 0, v220, vcc
    v_cndmask_b32 v194, 0, v220, vcc
    v_cndmask_b32 v195, 0, v220, vcc
    v_cmp_eq_u32 vcc, 5, v252
    s_nop 1
    v_cndmask_b32 v196, 0, v220, vcc
    v_cndmask_b32 v197, 0, v220, vcc
    v_cndmask_b32 v198, 0, v220, vcc
    v_cndmask_b32 v199, 0, v220, vcc
    v_cmp_eq_u32 vcc, 6, v252
    s_nop 1
    v_cndmask_b32 v200, 0, v220, vcc
    v_cndmask_b32 v201, 0, v220, vcc
    v_cndmask_b32 v202, 0, v220, vcc
    v_cndmask_b32 v203, 0, v220, vcc
    s_lshl_b32 s25, s73, 1
    s_add_u32 s25, s25, s68
    s_mul_i32 s25, s25, 458752
    s_lshl_b32 s66, s60, 24
    s_add_u32 s25, s25, s66
    s_add_u32 s25, s25, 20971520
    s_and_b32 s64, s74, 7
    s_mul_i32 s64, s64, 57344
    s_add_u32 s25, s25, s64
    s_cmp_eq_u32 s75, 0
    s_cselect_b32 s27, 0, 8
    s_and_b32 s64, s34, 3
    s_or_b32 s27, s27, s64
    s_lshl_b32 s35, s75, 15
    s_lshl_b32 s66, s73, 9
    s_add_u32 s35, s35, s66
    s_add_u32 s35, s35, 75505664
    s_lshl_b32 s65, s68, 3
    s_add_u32 s35, s35, s65
    v_lshlrev_b32 v246, 5, v250
    s_lshl_b32 s36, s75, 12
    s_add_u32 s36, s36, 75563008
    s_xor_b32 s37, s73, 2
    s_lshl_b32 s37, s37, 1
    s_add_u32 s37, s37, s68
    s_lshl_b32 s37, s37, 7
    s_add_u32 s37, s37, s36
    s_cmp_ge_u32 s69, 2
    s_cbranch_scc1 lr_135
    s_mov_b64 exec, 0xffff
pl_136:
    buffer_load_dwordx2 v[240:241], v246, s[80:83], s35 offen sc1
    s_sub_u32 s79, s79, 1
    s_cbranch_scc1 L_abort
    s_waitcnt vmcnt(0)
    v_and_b32 v240, v240, v241
    v_cmp_ne_u32 vcc, 1, v240
    s_cbranch_vccnz pl_136
    s_mov_b64 exec, -1
    s_cmp_lg_u32 s78, 0
    s_cbranch_scc1 pl_136_acq
pl_136_ok:
    s_lshr_b32 s64, s72, 1
    s_or_b32 s64, s64, s69
    s_cbranch_scc1 rl_137
    s_lshl_b32 s64, s73, 1
    s_add_u32 s64, s64, s68
    s_lshl_b32 s64, s64, 7
    s_add_u32 s64, s64, s36
    v_mov_b32 v242, 0
    v_mov_b32 v243, 1
    s_mov_b64 exec, 1
    buffer_store_dword v243, v242, s[80:83], s64 offen sc0 sc1
    s_mov_b64 exec, -1
rl_137:
    s_branch lr_135_d
lr_135:
    s_mov_b64 exec, 1
pl_138:
    buffer_load_dword v240, v246, s[80:83], s37 offen sc1
    s_sub_u32 s79, s79, 1
    s_cbranch_scc1 L_abort
    s_waitcnt vmcnt(0)
    v_cmp_ne_u32 vcc, 1, v240
    s_cbranch_vccnz pl_138
    s_mov_b64 exec, -1
    s_cmp_lg_u32 s78, 0
    s_cbranch_scc1 pl_138_acq
pl_138_ok:
lr_135_d:
    s_add_u32 m0, s23, 0
    s_nop 0
    buffer_load_dwordx4 v249, s[80:83], s20 offen sc1 lds
    s_add_u32 m0, s23, 0
    s_nop 0
    buffer_load_dwordx4 v249, s[80:83], s20 offen offset:1024 sc1 lds
    s_add_u32 s20, s20, 8192
    s_cmp_eq_u32 s20, s22
    s_cselect_b32 s20, s21, s20
    s_add_u32 m0, s23, 8192
    s_nop 0
    buffer_load_dwordx4 v249, s[80:83], s20 offen sc1 lds
    s_add_u32 m0, s23, 8192
    s_nop 0
    buffer_load_dwordx4 v249, s[80:83], s20 offen offset:1024 sc1 lds
    s_add_u32 s20, s20, 8192
    s_cmp_eq_u32 s20, s22
    s_cselect_b32 s20, s21, s20
    s_add_u32 m0, s19, 86400
    s_nop 0
    buffer_load_dwordx4 v228, s[8:11], s16 offen lds
    s_add_u32 m0, s19, 87424
    s_nop 0
    buffer_load_dwordx4 v229, s[8:11], s16 offen lds
    s_add_u32 m0, s19, 88448
    s_nop 0
    buffer_load_dwordx4 v230, s[8:11], s16 offen lds
    s_add_u32 m0, s19, 89472
    s_nop 0
    buffer_load_dwordx4 v231, s[8:11], s16 offen lds
    s_waitcnt vmcnt(6)
    s_barrier
    ds_read_b128 v[144:147], v235 offset:0
    ds_read_b128 v[148:151], v235 offset:1024
    ds_read_b128 v[152:155], v235 offset:2048
    ds_read_b128 v[156:159], v235 offset:3072
    ds_read_b64_tr_b16 v[96:97], v236 offset:28800
    ds_read_b64_tr_b16 v[98:99], v236 offset:32384
    ds_read_b64_tr_b16 v[108:109], v236 offset:43200
    ds_read_b64_tr_b16 v[110:111], v236 offset:46784
    ds_read_b64_tr_b16 v[100:101], v236 offset:28832
    ds_read_b64_tr_b16 v[102:103], v236 offset:32416
    ds_read_b64_tr_b16 v[112:113], v236 offset:43232
    ds_read_b64_tr_b16 v[114:115], v236 offset:46816
    ds_read_b64_tr_b16 v[104:105], v238 offset:28800
    ds_read_b64_tr_b16 v[106:107], v238 offset:32384
    ds_read_b64_tr_b16 v[116:117], v238 offset:43200
    ds_read_b64_tr_b16 v[118:119], v238 offset:46784
    s_add_u32 m0, s19, 90496
    s_nop 0
    buffer_load_dwordx4 v232, s[8:11], s16 offen lds
    s_add_u32 m0, s19, 91520
    s_nop 0
    buffer_load_dwordx4 v233, s[8:11], s16 offen lds
    s_add_u32 m0, s19, 92544
    s_nop 0
    buffer_load_dwordx4 v234, s[8:11], s16 offen lds
    s_add_u32 s16, s16, 229376
    s_cmp_eq_u32 s16, s18
    s_cselect_b32 s16, s17, s16
    s_add_u32 m0, s23, 16384
    s_nop 0
    buffer_load_dwordx4 v249, s[80:83], s20 offen sc1 lds
    s_add_u32 m0, s23, 16384
    s_nop 0
    buffer_load_dwordx4 v249, s[80:83], s20 offen offset:1024 sc1 lds
    s_add_u32 s20, s20, 8192
    s_cmp_eq_u32 s20, s22
    s_cselect_b32 s20, s21, s20
    s_waitcnt vmcnt(9) lgkmcnt(0)
g3c1_pb0:
    s_barrier
    v_mfma_f32_16x16x32_bf16 v[0:3], v[96:99], v[144:147], 0
    ds_read_b128 v[160:163], v235 offset:8192
    ds_read_b128 v[164:167], v235 offset:9216
    v_mfma_f32_16x16x32_bf16 v[4:7], v[96:99], v[148:151], 0
    ds_read_b128 v[168:171], v235 offset:10240
    v_mfma_f32_16x16x32_bf16 v[8:11], v[96:99], v[152:155], 0
    ds_read_b128 v[172:175], v235 offset:11264
    v_mfma_f32_16x16x32_bf16 v[12:15], v[96:99], v[156:159], 0
    s_add_u32 m0, s19, 0
    s_nop 0
    buffer_load_dwordx4 v228, s[8:11], s16 offen lds
    v_mfma_f32_16x16x32_bf16 v[60:63], v[108:111], v[156:159], 0
    ds_read_b64_tr_b16 v[120:121], v237 offset:0
    v_mfma_f32_16x16x32_bf16 v[56:59], v[108:111], v[152:155], 0
    ds_read_b64_tr_b16 v[122:123], v237 offset:3584
    v_mfma_f32_16x16x32_bf16 v[52:55], v[108:111], v[148:151], 0
    ds_read_b64_tr_b16 v[132:133], v237 offset:14400
    v_mfma_f32_16x16x32_bf16 v[48:51], v[108:111], v[144:147], 0
    s_add_u32 m0, s19, 1024
    s_nop 0
    buffer_load_dwordx4 v229, s[8:11], s16 offen lds
    v_mfma_f32_16x16x32_bf16 v[16:19], v[100:103], v[144:147], 0
    ds_read_b64_tr_b16 v[134:135], v237 offset:17984
    v_mfma_f32_16x16x32_bf16 v[20:23], v[100:103], v[148:151], 0
    ds_read_b64_tr_b16 v[124:125], v237 offset:32
    v_mfma_f32_16x16x32_bf16 v[24:27], v[100:103], v[152:155], 0
    ds_read_b64_tr_b16 v[126:127], v237 offset:3616
    v_mfma_f32_16x16x32_bf16 v[28:31], v[100:103], v[156:159], 0
    s_add_u32 m0, s19, 2048
    s_nop 0
    buffer_load_dwordx4 v230, s[8:11], s16 offen lds
    s_add_u32 s16, s16, 229376
    s_cmp_eq_u32 s16, s18
    s_cselect_b32 s16, s17, s16
    v_mfma_f32_16x16x32_bf16 v[76:79], v[112:115], v[156:159], 0
    ds_read_b64_tr_b16 v[136:137], v237 offset:14432
    v_mfma_f32_16x16x32_bf16 v[72:75], v[112:115], v[152:155], 0
    ds_read_b64_tr_b16 v[138:139], v237 offset:18016
    v_mfma_f32_16x16x32_bf16 v[68:71], v[112:115], v[148:151], 0
    ds_read_b64_tr_b16 v[128:129], v239 offset:0
    v_mfma_f32_16x16x32_bf16 v[64:67], v[112:115], v[144:147], 0
    s_add_u32 m0, s23, 24576
    s_nop 0
    buffer_load_dwordx4 v249, s[80:83], s20 offen sc1 lds
    v_mfma_f32_16x16x32_bf16 v[32:35], v[104:107], v[144:147], 0
    ds_read_b64_tr_b16 v[130:131], v239 offset:3584
    v_mfma_f32_16x16x32_bf16 v[36:39], v[104:107], v[148:151], 0
    ds_read_b64_tr_b16 v[140:141], v239 offset:14400
    v_mfma_f32_16x16x32_bf16 v[40:43], v[104:107], v[152:155], 0
    ds_read_b64_tr_b16 v[142:143], v239 offset:17984
    v_mfma_f32_16x16x32_bf16 v[44:47], v[104:107], v[156:159], 0
    s_add_u32 m0, s23, 24576
    s_nop 0
    buffer_load_dwordx4 v249, s[80:83], s20 offen offset:1024 sc1 lds
    s_add_u32 s20, s20, 8192
    s_cmp_eq_u32 s20, s22
    s_cselect_b32 s20, s21, s20
    v_mfma_f32_16x16x32_bf16 v[92:95], v[116:119], v[156:159], 0
    v_mfma_f32_16x16x32_bf16 v[88:91], v[116:119], v[152:155], 0
    v_mfma_f32_16x16x32_bf16 v[84:87], v[116:119], v[148:151], 0
    v_mfma_f32_16x16x32_bf16 v[80:83], v[116:119], v[144:147], 0
    s_cmp_eq_u32 s27, 0
    s_cbranch_scc1 cs_639
cs_639_b:
    s_waitcnt vmcnt(5) lgkmcnt(0)
g3c1_pb1:
    s_barrier
    v_mfma_f32_16x16x32_bf16 v[0:3], v[120:123], v[160:163], v[0:3]
    ds_read_b128 v[144:147], v235 offset:16384
    ds_read_b128 v[148:151], v235 offset:17408
    v_mfma_f32_16x16x32_bf16 v[4:7], v[120:123], v[164:167], v[4:7]
    ds_read_b128 v[152:155], v235 offset:18432
    v_mfma_f32_16x16x32_bf16 v[8:11], v[120:123], v[168:171], v[8:11]
    ds_read_b128 v[156:159], v235 offset:19456
    v_mfma_f32_16x16x32_bf16 v[12:15], v[120:123], v[172:175], v[12:15]
    s_add_u32 m0, s19, 28800
    s_nop 0
    buffer_load_dwordx4 v228, s[8:11], s16 offen lds
    v_mfma_f32_16x16x32_bf16 v[60:63], v[132:135], v[172:175], v[60:63]
    ds_read_b64_tr_b16 v[96:97], v237 offset:28800
    v_mfma_f32_16x16x32_bf16 v[56:59], v[132:135], v[168:171], v[56:59]
    ds_read_b64_tr_b16 v[98:99], v237 offset:32384
    v_mfma_f32_16x16x32_bf16 v[52:55], v[132:135], v[164:167], v[52:55]
    ds_read_b64_tr_b16 v[108:109], v237 offset:43200
    v_mfma_f32_16x16x32_bf16 v[48:51], v[132:135], v[160:163], v[48:51]
    s_add_u32 m0, s19, 29824
    s_nop 0
    buffer_load_dwordx4 v229, s[8:11], s16 offen lds
    v_mfma_f32_16x16x32_bf16 v[16:19], v[124:127], v[160:163], v[16:19]
    ds_read_b64_tr_b16 v[110:111], v237 offset:46784
    v_mfma_f32_16x16x32_bf16 v[20:23], v[124:127], v[164:167], v[20:23]
    ds_read_b64_tr_b16 v[100:101], v237 offset:28832
    v_mfma_f32_16x16x32_bf16 v[24:27], v[124:127], v[168:171], v[24:27]
    ds_read_b64_tr_b16 v[102:103], v237 offset:32416
    v_mfma_f32_16x16x32_bf16 v[28:31], v[124:127], v[172:175], v[28:31]
    s_add_u32 m0, s19, 30848
    s_nop 0
    buffer_load_dwordx4 v230, s[8:11], s16 offen lds
    s_add_u32 s16, s16, 229376
    s_cmp_eq_u32 s16, s18
    s_cselect_b32 s16, s17, s16
    v_mfma_f32_16x16x32_bf16 v[76:79], v[136:139], v[172:175], v[76:79]
    ds_read_b64_tr_b16 v[112:113], v237 offset:43232
    v_mfma_f32_16x16x32_bf16 v[72:75], v[136:139], v[168:171], v[72:75]
    ds_read_b64_tr_b16 v[114:115], v237 offset:46816
    v_mfma_f32_16x16x32_bf16 v[68:71], v[136:139], v[164:167], v[68:71]
    ds_read_b64_tr_b16 v[104:105], v239 offset:28800
    v_mfma_f32_16x16x32_bf16 v[64:67], v[136:139], v[160:163], v[64:67]
    s_add_u32 m0, s23, 0
    s_nop 0
    buffer_load_dwordx4 v249, s[80:83], s20 offen sc1 lds
    v_mfma_f32_16x16x32_bf16 v[32:35], v[128:131], v[160:163], v[32:35]
    ds_read_b64_tr_b16 v[106:107], v239 offset:32384
    v_mfma_f32_16x16x32_bf16 v[36:39], v[128:131], v[164:167], v[36:39]
    ds_read_b64_tr_b16 v[116:117], v239 offset:43200
    v_mfma_f32_16x16x32_bf16 v[40:43], v[128:131], v[168:171], v[40:43]
    ds_read_b64_tr_b16 v[118:119], v239 offset:46784
    v_mfma_f32_16x16x32_bf16 v[44:47], v[128:131], v[172:175], v[44:47]
    s_add_u32 m0, s23, 0
    s_nop 0
    buffer_load_dwordx4 v249, s[80:83], s20 offen offset:1024 sc1 lds
    s_add_u32 s20, s20, 8192
    s_cmp_eq_u32 s20, s22
    s_cselect_b32 s20, s21, s20
    v_mfma_f32_16x16x32_bf16 v[92:95], v[140:143], v[172:175], v[92:95]
    v_mfma_f32_16x16x32_bf16 v[88:91], v[140:143], v[168:171], v[88:91]
    v_mfma_f32_16x16x32_bf16 v[84:87], v[140:143], v[164:167], v[84:87]
    v_mfma_f32_16x16x32_bf16 v[80:83], v[140:143], v[160:163], v[80:83]
    s_cmp_eq_u32 s27, 0
    s_cbranch_scc1 cs_640
cs_640_b:
    s_waitcnt vmcnt(5) lgkmcnt(0)
g3c1_pb2:
    s_barrier
    v_mfma_f32_16x16x32_bf16 v[0:3], v[96:99], v[144:147], v[0:3]
    ds_read_b128 v[160:163], v235 offset:24576
    ds_read_b128 v[164:167], v235 offset:25600
    v_mfma_f32_16x16x32_bf16 v[4:7], v[96:99], v[148:151], v[4:7]
    ds_read_b128 v[168:171], v235 offset:26624
    v_mfma_f32_16x16x32_bf16 v[8:11], v[96:99], v[152:155], v[8:11]
    ds_read_b128 v[172:175], v235 offset:27648
    v_mfma_f32_16x16x32_bf16 v[12:15], v[96:99], v[156:159], v[12:15]
    s_add_u32 m0, s19, 57600
    s_nop 0
    buffer_load_dwordx4 v228, s[8:11], s16 offen lds
    v_mfma_f32_16x16x32_bf16 v[60:63], v[108:111], v[156:159], v[60:63]
    ds_read_b64_tr_b16 v[120:121], v236 offset:0
    v_mfma_f32_16x16x32_bf16 v[56:59], v[108:111], v[152:155], v[56:59]
    ds_read_b64_tr_b16 v[122:123], v236 offset:3584
    v_mfma_f32_16x16x32_bf16 v[52:55], v[108:111], v[148:151], v[52:55]
    ds_read_b64_tr_b16 v[132:133], v236 offset:14400
    v_mfma_f32_16x16x32_bf16 v[48:51], v[108:111], v[144:147], v[48:51]
    s_add_u32 m0, s19, 58624
    s_nop 0
    buffer_load_dwordx4 v229, s[8:11], s16 offen lds
    v_mfma_f32_16x16x32_bf16 v[16:19], v[100:103], v[144:147], v[16:19]
    ds_read_b64_tr_b16 v[134:135], v236 offset:17984
    v_mfma_f32_16x16x32_bf16 v[20:23], v[100:103], v[148:151], v[20:23]
    ds_read_b64_tr_b16 v[124:125], v236 offset:32
    v_mfma_f32_16x16x32_bf16 v[24:27], v[100:103], v[152:155], v[24:27]
    ds_read_b64_tr_b16 v[126:127], v236 offset:3616
    v_mfma_f32_16x16x32_bf16 v[28:31], v[100:103], v[156:159], v[28:31]
    s_add_u32 m0, s19, 59648
    s_nop 0
    buffer_load_dwordx4 v230, s[8:11], s16 offen lds
    s_add_u32 s16, s16, 229376
    s_cmp_eq_u32 s16, s18
    s_cselect_b32 s16, s17, s16
    v_mfma_f32_16x16x32_bf16 v[76:79], v[112:115], v[156:159], v[76:79]
    ds_read_b64_tr_b16 v[136:137], v236 offset:14432
    v_mfma_f32_16x16x32_bf16 v[72:75], v[112:115], v[152:155], v[72:75]
    ds_read_b64_tr_b16 v[138:139], v236 offset:18016
    v_mfma_f32_16x16x32_bf16 v[68:71], v[112:115], v[148:151], v[68:71]
    ds_read_b64_tr_b16 v[128:129], v238 offset:0
    v_mfma_f32_16x16x32_bf16 v[64:67], v[112:115], v[144:147], v[64:67]
    s_add_u32 m0, s23, 8192
    s_nop 0
    buffer_load_dwordx4 v249, s[80:83], s20 offen sc1 lds
    v_mfma_f32_16x16x32_bf16 v[32:35], v[104:107], v[144:147], v[32:35]
    ds_read_b64_tr_b16 v[130:131], v238 offset:3584
    v_mfma_f32_16x16x32_bf16 v[36:39], v[104:107], v[148:151], v[36:39]
    ds_read_b64_tr_b16 v[140:141], v238 offset:14400
    v_mfma_f32_16x16x32_bf16 v[40:43], v[104:107], v[152:155], v[40:43]
    ds_read_b64_tr_b16 v[142:143], v238 offset:17984
    v_mfma_f32_16x16x32_bf16 v[44:47], v[104:107], v[156:159], v[44:47]
    s_add_u32 m0, s23, 8192
    s_nop 0
    buffer_load_dwordx4 v249, s[80:83], s20 offen offset:1024 sc1 lds
    s_add_u32 s20, s20, 8192
    s_cmp_eq_u32 s20, s22
    s_cselect_b32 s20, s21, s20
    v_mfma_f32_16x16x32_bf16 v[92:95], v[116:119], v[156:159], v[92:95]
    v_mfma_f32_16x16x32_bf16 v[88:91], v[116:119], v[152:155], v[88:91]
    v_mfma_f32_16x16x32_bf16 v[84:87], v[116:119], v[148:151], v[84:87]
    v_mfma_f32_16x16x32_bf16 v[80:83], v[116:119], v[144:147], v[80:83]
    s_cmp_eq_u32 s27, 1
    s_cbranch_scc1 cs_641
cs_641_b:
    s_waitcnt vmcnt(5) lgkmcnt(0)
g3c1_pb3:
    s_barrier
    v_mfma_f32_16x16x32_bf16 v[0:3], v[120:123], v[160:163], v[0:3]
    ds_read_b128 v[144:147], v235 offset:0
    ds_read_b128 v[148:151], v235 offset:1024
    v_mfma_f32_16x16x32_bf16 v[4:7], v[120:123], v[164:167], v[4:7]
    ds_read_b128 v[152:155], v235 offset:2048
    v_mfma_f32_16x16x32_bf16 v[8:11], v[120:123], v[168:171], v[8:11]
    ds_read_b128 v[156:159], v235 offset:3072
    v_mfma_f32_16x16x32_bf16 v[12:15], v[120:123], v[172:175], v[12:15]
    s_add_u32 m0, s19, 86400
    s_nop 0
    buffer_load_dwordx4 v228, s[8:11], s16 offen lds
    v_mfma_f32_16x16x32_bf16 v[60:63], v[132:135], v[172:175], v[60:63]
    ds_read_b64_tr_b16 v[96:97], v236 offset:28800
    v_mfma_f32_16x16x32_bf16 v[56:59], v[132:135], v[168:171], v[56:59]
    ds_read_b64_tr_b16 v[98:99], v236 offset:32384
    v_mfma_f32_16x16x32_bf16 v[52:55], v[132:135], v[164:167], v[52:55]
    ds_read_b64_tr_b16 v[108:109], v236 offset:43200
    v_mfma_f32_16x16x32_bf16 v[48:51], v[132:135], v[160:163], v[48:51]
    s_add_u32 m0, s19, 87424
    s_nop 0
    buffer_load_dwordx4 v229, s[8:11], s16 offen lds
    v_mfma_f32_16x16x32_bf16 v[16:19], v[124:127], v[160:163], v[16:19]
    ds_read_b64_tr_b16 v[110:111], v236 offset:46784
    v_mfma_f32_16x16x32_bf16 v[20:23], v[124:127], v[164:167], v[20:23]
    ds_read_b64_tr_b16 v[100:101], v236 offset:28832
    v_mfma_f32_16x16x32_bf16 v[24:27], v[124:127], v[168:171], v[24:27]
    ds_read_b64_tr_b16 v[102:103], v236 offset:32416
    v_mfma_f32_16x16x32_bf16 v[28:31], v[124:127], v[172:175], v[28:31]
    s_add_u32 m0, s19, 88448
    s_nop 0
    buffer_load_dwordx4 v230, s[8:11], s16 offen lds
    s_add_u32 s16, s16, 229376
    s_cmp_eq_u32 s16, s18
    s_cselect_b32 s16, s17, s16
    v_mfma_f32_16x16x32_bf16 v[76:79], v[136:139], v[172:175], v[76:79]
    ds_read_b64_tr_b16 v[112:113], v236 offset:43232
    v_mfma_f32_16x16x32_bf16 v[72:75], v[136:139], v[168:171], v[72:75]
    ds_read_b64_tr_b16 v[114:115], v236 offset:46816
    v_mfma_f32_16x16x32_bf16 v[68:71], v[136:139], v[164:167], v[68:71]
    ds_read_b64_tr_b16 v[104:105], v238 offset:28800
    v_mfma_f32_16x16x32_bf16 v[64:67], v[136:139], v[160:163], v[64:67]
    s_add_u32 m0, s23, 16384
    s_nop 0
    buffer_load_dwordx4 v249, s[80:83], s20 offen sc1 lds
    v_mfma_f32_16x16x32_bf16 v[32:35], v[128:131], v[160:163], v[32:35]
    ds_read_b64_tr_b16 v[106:107], v238 offset:32384
    v_mfma_f32_16x16x32_bf16 v[36:39], v[128:131], v[164:167], v[36:39]
    ds_read_b64_tr_b16 v[116:117], v238 offset:43200
    v_mfma_f32_16x16x32_bf16 v[40:43], v[128:131], v[168:171], v[40:43]
    ds_read_b64_tr_b16 v[118:119], v238 offset:46784
    v_mfma_f32_16x16x32_bf16 v[44:47], v[128:131], v[172:175], v[44:47]
    s_add_u32 m0, s23, 16384
    s_nop 0
    buffer_load_dwordx4 v249, s[80:83], s20 offen offset:1024 sc1 lds
    s_add_u32 s20, s20, 8192
    s_cmp_eq_u32 s20, s22
    s_cselect_b32 s20, s21, s20
    v_mfma_f32_16x16x32_bf16 v[92:95], v[140:143], v[172:175], v[92:95]
    v_mfma_f32_16x16x32_bf16 v[88:91], v[140:143], v[168:171], v[88:91]
    v_mfma_f32_16x16x32_bf16 v[84:87], v[140:143], v[164:167], v[84:87]
    v_mfma_f32_16x16x32_bf16 v[80:83], v[140:143], v[160:163], v[80:83]
    s_cmp_eq_u32 s27, 1
    s_cbranch_scc1 cs_642
cs_642_b:
    s_waitcnt vmcnt(5) lgkmcnt(0)
g3c1_pb4:
    s_barrier
    v_mfma_f32_16x16x32_bf16 v[0:3], v[96:99], v[144:147], v[0:3]
    ds_read_b128 v[160:163], v235 offset:8192
    ds_read_b128 v[164:167], v235 offset:9216
    v_mfma_f32_16x16x32_bf16 v[4:7], v[96:99], v[148:151], v[4:7]
    ds_read_b128 v[168:171], v235 offset:10240
    v_mfma_f32_16x16x32_bf16 v[8:11], v[96:99], v[152:155], v[8:11]
    ds_read_b128 v[172:175], v235 offset:11264
    v_mfma_f32_16x16x32_bf16 v[12:15], v[96:99], v[156:159], v[12:15]
    s_add_u32 m0, s19, 0
    s_nop 0
    buffer_load_dwordx4 v228, s[8:11], s16 offen lds
    v_mfma_f32_16x16x32_bf16 v[60:63], v[108:111], v[156:159], v[60:63]
    ds_read_b64_tr_b16 v[120:121], v237 offset:0
    v_mfma_f32_16x16x32_bf16 v[56:59], v[108:111], v[152:155], v[56:59]
    ds_read_b64_tr_b16 v[122:123], v237 offset:3584
    v_mfma_f32_16x16x32_bf16 v[52:55], v[108:111], v[148:151], v[52:55]
    ds_read_b64_tr_b16 v[132:133], v237 offset:14400
    v_mfma_f32_16x16x32_bf16 v[48:51], v[108:111], v[144:147], v[48:51]
    s_add_u32 m0, s19, 1024
    s_nop 0
    buffer_load_dwordx4 v229, s[8:11], s16 offen lds
    v_mfma_f32_16x16x32_bf16 v[16:19], v[100:103], v[144:147], v[16:19]
    ds_read_b64_tr_b16 v[134:135], v237 offset:17984
    v_mfma_f32_16x16x32_bf16 v[20:23], v[100:103], v[148:151], v[20:23]
    ds_read_b64_tr_b16 v[124:125], v237 offset:32
    v_mfma_f32_16x16x32_bf16 v[24:27], v[100:103], v[152:155], v[24:27]
    ds_read_b64_tr_b16 v[126:127], v237 offset:3616
    v_mfma_f32_16x16x32_bf16 v[28:31], v[100:103], v[156:159], v[28:31]
    s_add_u32 m0, s19, 2048
    s_nop 0
    buffer_load_dwordx4 v230, s[8:11], s16 offen lds
    s_add_u32 s16, s16, 229376
    s_cmp_eq_u32 s16, s18
    s_cselect_b32 s16, s17, s16
    v_mfma_f32_16x16x32_bf16 v[76:79], v[112:115], v[156:159], v[76:79]
    ds_read_b64_tr_b16 v[136:137], v237 offset:14432
    v_mfma_f32_16x16x32_bf16 v[72:75], v[112:115], v[152:155], v[72:75]
    ds_read_b64_tr_b16 v[138:139], v237 offset:18016
    v_mfma_f32_16x16x32_bf16 v[68:71], v[112:115], v[148:151], v[68:71]
    ds_read_b64_tr_b16 v[128:129], v239 offset:0
    v_mfma_f32_16x16x32_bf16 v[64:67], v[112:115], v[144:147], v[64:67]
    s_add_u32 m0, s23, 24576
    s_nop 0
    buffer_load_dwordx4 v249, s[80:83], s20 offen sc1 lds
    v_mfma_f32_16x16x32_bf16 v[32:35], v[104:107], v[144:147], v[32:35]
    ds_read_b64_tr_b16 v[130:131], v239 offset:3584
    v_mfma_f32_16x16x32_bf16 v[36:39], v[104:107], v[148:151], v[36:39]
    ds_read_b64_tr_b16 v[140:141], v239 offset:14400
    v_mfma_f32_16x16x32_bf16 v[40:43], v[104:107], v[152:155], v[40:43]
    ds_read_b64_tr_b16 v[142:143], v239 offset:17984
    v_mfma_f32_16x16x32_bf16 v[44:47], v[104:107], v[156:159], v[44:47]
    s_add_u32 m0, s23, 24576
    s_nop 0
    buffer_load_dwordx4 v249, s[80:83], s20 offen offset:1024 sc1 lds
    s_add_u32 s20, s20, 8192
    s_cmp_eq_u32 s20, s22
    s_cselect_b32 s20, s21, s20
    v_mfma_f32_16x16x32_bf16 v[92:95], v[116:119], v[156:159], v[92:95]
    v_mfma_f32_16x16x32_bf16 v[88:91], v[116:119], v[152:155], v[88:91]
    v_mfma_f32_16x16x32_bf16 v[84:87], v[116:119], v[148:151], v[84:87]
    v_mfma_f32_16x16x32_bf16 v[80:83], v[116:119], v[144:147], v[80:83]
    s_cmp_eq_u32 s27, 2
    s_cbranch_scc1 cs_643
cs_643_b:
    s_waitcnt vmcnt(5) lgkmcnt(0)
g3c1_pb5:
    s_barrier
    v_mfma_f32_16x16x32_bf16 v[0:3], v[120:123], v[160:163], v[0:3]
    ds_read_b128 v[144:147], v235 offset:16384
    ds_read_b128 v[148:151], v235 offset:17408
    v_mfma_f32_16x16x32_bf16 v[4:7], v[120:123], v[164:167], v[4:7]
    ds_read_b128 v[152:155], v235 offset:18432
    v_mfma_f32_16x16x32_bf16 v[8:11], v[120:123], v[168:171], v[8:11]
    ds_read_b128 v[156:159], v235 offset:19456
    v_mfma_f32_16x16x32_bf16 v[12:15], v[120:123], v[172:175], v[12:15]
    s_add_u32 m0, s19, 28800
    s_nop 0
    buffer_load_dwordx4 v228, s[8:11], s16 offen lds
    v_mfma_f32_16x16x32_bf16 v[60:63], v[132:135], v[172:175], v[60:63]
    ds_read_b64_tr_b16 v[96:97], v237 offset:28800
    v_mfma_f32_16x16x32_bf16 v[56:59], v[132:135], v[168:171], v[56:59]
    ds_read_b64_tr_b16 v[98:99], v237 offset:32384
    v_mfma_f32_16x16x32_bf16 v[52:55], v[132:135], v[164:167], v[52:55]
    ds_read_b64_tr_b16 v[108:109], v237 offset:43200
    v_mfma_f32_16x16x32_bf16 v[48:51], v[132:135], v[160:163], v[48:51]
    s_add_u32 m0, s19, 29824
    s_nop 0
    buffer_load_dwordx4 v229, s[8:11], s16 offen lds
    v_mfma_f32_16x16x32_bf16 v[16:19], v[124:127], v[160:163], v[16:19]
    ds_read_b64_tr_b16 v[110:111], v237 offset:46784
    v_mfma_f32_16x16x32_bf16 v[20:23], v[124:127], v[164:167], v[20:23]
    ds_read_b64_tr_b16 v[100:101], v237 offset:28832
    v_mfma_f32_16x16x32_bf16 v[24:27], v[124:127], v[168:171], v[24:27]
    ds_read_b64_tr_b16 v[102:103], v237 offset:32416
    v_mfma_f32_16x16x32_bf16 v[28:31], v[124:127], v[172:175], v[28:31]
    s_add_u32 m0, s19, 30848
    s_nop 0
    buffer_load_dwordx4 v230, s[8:11], s16 offen lds
    s_add_u32 s16, s16, 229376
    s_cmp_eq_u32 s16, s18
    s_cselect_b32 s16, s17, s16
    v_mfma_f32_16x16x32_bf16 v[76:79], v[136:139], v[172:175], v[76:79]
    ds_read_b64_tr_b16 v[112:113], v237 offset:43232
    v_mfma_f32_16x16x32_bf16 v[72:75], v[136:139], v[168:171], v[72:75]
    ds_read_b64_tr_b16 v[114:115], v237 offset:46816
    v_mfma_f32_16x16x32_bf16 v[68:71], v[136:139], v[164:167], v[68:71]
    ds_read_b64_tr_b16 v[104:105], v239 offset:28800
    v_mfma_f32_16x16x32_bf16 v[64:67], v[136:139], v[160:163], v[64:67]
    s_add_u32 m0, s23, 0
    s_nop 0
    buffer_load_dwordx4 v249, s[80:83], s20 offen sc1 lds
    v_mfma_f32_16x16x32_bf16 v[32:35], v[128:131], v[160:163], v[32:35]
    ds_read_b64_tr_b16 v[106:107], v239 offset:32384
    v_mfma_f32_16x16x32_bf16 v[36:39], v[128:131], v[164:167], v[36:39]
    ds_read_b64_tr_b16 v[116:117], v239 offset:43200
    v_mfma_f32_16x16x32_bf16 v[40:43], v[128:131], v[168:171], v[40:43]
    ds_read_b64_tr_b16 v[118:119], v239 offset:46784
    v_mfma_f32_16x16x32_bf16 v[44:47], v[128:131], v[172:175], v[44:47]
    s_add_u32 m0, s23, 0
    s_nop 0
    buffer_load_dwordx4 v249, s[80:83], s20 offen offset:1024 sc1 lds
    s_add_u32 s20, s20, 8192
    s_cmp_eq_u32 s20, s22
    s_cselect_b32 s20, s21, s20
    v_mfma_f32_16x16x32_bf16 v[92:95], v[140:143], v[172:175], v[92:95]
    v_mfma_f32_16x16x32_bf16 v[88:91], v[140:143], v[168:171], v[88:91]
    v_mfma_f32_16x16x32_bf16 v[84:87], v[140:143], v[164:167], v[84:87]
    v_mfma_f32_16x16x32_bf16 v[80:83], v[140:143], v[160:163], v[80:83]
    s_cmp_eq_u32 s27, 2
    s_cbranch_scc1 cs_644
cs_644_b:
    s_waitcnt vmcnt(5) lgkmcnt(0)
g3c1_pb6:
    s_barrier
    v_mfma_f32_16x16x32_bf16 v[0:3], v[96:99], v[144:147], v[0:3]
    ds_read_b128 v[160:163], v235 offset:24576
    ds_read_b128 v[164:167], v235 offset:25600
    v_mfma_f32_16x16x32_bf16 v[4:7], v[96:99], v[148:151], v[4:7]
    ds_read_b128 v[168:171], v235 offset:26624
    v_mfma_f32_16x16x32_bf16 v[8:11], v[96:99], v[152:155], v[8:11]
    ds_read_b128 v[172:175], v235 offset:27648
    v_mfma_f32_16x16x32_bf16 v[12:15], v[96:99], v[156:159], v[12:15]
    s_add_u32 m0, s19, 57600
    s_nop 0
    buffer_load_dwordx4 v228, s[8:11], s16 offen lds
    v_mfma_f32_16x16x32_bf16 v[60:63], v[108:111], v[156:159], v[60:63]
    ds_read_b64_tr_b16 v[120:121], v236 offset:0
    v_mfma_f32_16x16x32_bf16 v[56:59], v[108:111], v[152:155], v[56:59]
    ds_read_b64_tr_b16 v[122:123], v236 offset:3584
    v_mfma_f32_16x16x32_bf16 v[52:55], v[108:111], v[148:151], v[52:55]
    ds_read_b64_tr_b16 v[132:133], v236 offset:14400
    v_mfma_f32_16x16x32_bf16 v[48:51], v[108:111], v[144:147], v[48:51]
    s_add_u32 m0, s19, 58624
    s_nop 0
    buffer_load_dwordx4 v229, s[8:11], s16 offen lds
    v_mfma_f32_16x16x32_bf16 v[16:19], v[100:103], v[144:147], v[16:19]
    ds_read_b64_tr_b16 v[134:135], v236 offset:17984
    v_mfma_f32_16x16x32_bf16 v[20:23], v[100:103], v[148:151], v[20:23]
    ds_read_b64_tr_b16 v[124:125], v236 offset:32
    v_mfma_f32_16x16x32_bf16 v[24:27], v[100:103], v[152:155], v[24:27]
    ds_read_b64_tr_b16 v[126:127], v236 offset:3616
    v_mfma_f32_16x16x32_bf16 v[28:31], v[100:103], v[156:159], v[28:31]
    s_add_u32 m0, s19, 59648
    s_nop 0
    buffer_load_dwordx4 v230, s[8:11], s16 offen lds
    s_add_u32 s16, s16, 229376
    s_cmp_eq_u32 s16, s18
    s_cselect_b32 s16, s17, s16
    v_mfma_f32_16x16x32_bf16 v[76:79], v[112:115], v[156:159], v[76:79]
    ds_read_b64_tr_b16 v[136:137], v236 offset:14432
    v_mfma_f32_16x16x32_bf16 v[72:75], v[112:115], v[152:155], v[72:75]
    ds_read_b64_tr_b16 v[138:139], v236 offset:18016
    v_mfma_f32_16x16x32_bf16 v[68:71], v[112:115], v[148:151], v[68:71]
    ds_read_b64_tr_b16 v[128:129], v238 offset:0
    v_mfma_f32_16x16x32_bf16 v[64:67], v[112:115], v[144:147], v[64:67]
    s_add_u32 m0, s23, 8192
    s_nop 0
    buffer_load_dwordx4 v249, s[80:83], s20 offen sc1 lds
    v_mfma_f32_16x16x32_bf16 v[32:35], v[104:107], v[144:147], v[32:35]
    ds_read_b64_tr_b16 v[130:131], v238 offset:3584
    v_mfma_f32_16x16x32_bf16 v[36:39], v[104:107], v[148:151], v[36:39]
    ds_read_b64_tr_b16 v[140:141], v238 offset:14400
    v_mfma_f32_16x16x32_bf16 v[40:43], v[104:107], v[152:155], v[40:43]
    ds_read_b64_tr_b16 v[142:143], v238 offset:17984
    v_mfma_f32_16x16x32_bf16 v[44:47], v[104:107], v[156:159], v[44:47]
    s_add_u32 m0, s23, 8192
    s_nop 0
    buffer_load_dwordx4 v249, s[80:83], s20 offen offset:1024 sc1 lds
    s_add_u32 s20, s20, 8192
    s_cmp_eq_u32 s20, s22
    s_cselect_b32 s20, s21, s20
    v_mfma_f32_16x16x32_bf16 v[92:95], v[116:119], v[156:159], v[92:95]
    v_mfma_f32_16x16x32_bf16 v[88:91], v[116:119], v[152:155], v[88:91]
    v_mfma_f32_16x16x32_bf16 v[84:87], v[116:119], v[148:151], v[84:87]
    v_mfma_f32_16x16x32_bf16 v[80:83], v[116:119], v[144:147], v[80:83]
    s_cmp_eq_u32 s27, 3
    s_cbranch_scc1 cs_645
cs_645_b:
    s_waitcnt vmcnt(5) lgkmcnt(0)
g3c1_pb7:
    s_barrier
    v_mfma_f32_16x16x32_bf16 v[0:3], v[120:123], v[160:163], v[0:3]
    ds_read_b128 v[144:147], v235 offset:0
    ds_read_b128 v[148:151], v235 offset:1024
    v_mfma_f32_16x16x32_bf16 v[4:7], v[120:123], v[164:167], v[4:7]
    ds_read_b128 v[152:155], v235 offset:2048
    v_mfma_f32_16x16x32_bf16 v[8:11], v[120:123], v[168:171], v[8:11]
    ds_read_b128 v[156:159], v235 offset:3072
    v_mfma_f32_16x16x32_bf16 v[12:15], v[120:123], v[172:175], v[12:15]
    s_add_u32 m0, s19, 86400
    s_nop 0
    buffer_load_dwordx4 v228, s[8:11], s16 offen lds
    v_mfma_f32_16x16x32_bf16 v[60:63], v[132:135], v[172:175], v[60:63]
    ds_read_b64_tr_b16 v[96:97], v236 offset:28800
    v_mfma_f32_16x16x32_bf16 v[56:59], v[132:135], v[168:171], v[56:59]
    ds_read_b64_tr_b16 v[98:99], v236 offset:32384
    v_mfma_f32_16x16x32_bf16 v[52:55], v[132:135], v[164:167], v[52:55]
    ds_read_b64_tr_b16 v[108:109], v236 offset:43200
    v_mfma_f32_16x16x32_bf16 v[48:51], v[132:135], v[160:163], v[48:51]
    s_add_u32 m0, s19, 87424
    s_nop 0
    buffer_load_dwordx4 v229, s[8:11], s16 offen lds
    v_mfma_f32_16x16x32_bf16 v[16:19], v[124:127], v[160:163], v[16:19]
    ds_read_b64_tr_b16 v[110:111], v236 offset:46784
    v_mfma_f32_16x16x32_bf16 v[20:23], v[124:127], v[164:167], v[20:23]
    ds_read_b64_tr_b16 v[100:101], v236 offset:28832
    v_mfma_f32_16x16x32_bf16 v[24:27], v[124:127], v[168:171], v[24:27]
    ds_read_b64_tr_b16 v[102:103], v236 offset:32416
    v_mfma_f32_16x16x32_bf16 v[28:31], v[124:127], v[172:175], v[28:31]
    s_add_u32 m0, s19, 88448
    s_nop 0
    buffer_load_dwordx4 v230, s[8:11], s16 offen lds
    s_add_u32 s16, s16, 229376
    s_cmp_eq_u32 s16, s18
    s_cselect_b32 s16, s17, s16
    v_mfma_f32_16x16x32_bf16 v[76:79], v[136:139], v[172:175], v[76:79]
    ds_read_b64_tr_b16 v[112:113], v236 offset:43232
    v_mfma_f32_16x16x32_bf16 v[72:75], v[136:139], v[168:171], v[72:75]
    ds_read_b64_tr_b16 v[114:115], v236 offset:46816
    v_mfma_f32_16x16x32_bf16 v[68:71], v[136:139], v[164:167], v[68:71]
    ds_read_b64_tr_b16 v[104:105], v238 offset:28800
    v_mfma_f32_16x16x32_bf16 v[64:67], v[136:139], v[160:163], v[64:67]
    s_add_u32 m0, s23, 16384
    s_nop 0
    buffer_load_dwordx4 v249, s[80:83], s20 offen sc1 lds
    v_mfma_f32_16x16x32_bf16 v[32:35], v[128:131], v[160:163], v[32:35]
    ds_read_b64_tr_b16 v[106:107], v238 offset:32384
    v_mfma_f32_16x16x32_bf16 v[36:39], v[128:131], v[164:167], v[36:39]
    ds_read_b64_tr_b16 v[116:117], v238 offset:43200
    v_mfma_f32_16x16x32_bf16 v[40:43], v[128:131], v[168:171], v[40:43]
    ds_read_b64_tr_b16 v[118:119], v238 offset:46784
    v_mfma_f32_16x16x32_bf16 v[44:47], v[128:131], v[172:175], v[44:47]
    s_add_u32 m0, s23, 16384
    s_nop 0
    buffer_load_dwordx4 v249, s[80:83], s20 offen offset:1024 sc1 lds
    s_add_u32 s20, s20, 8192
    s_cmp_eq_u32 s20, s22
    s_cselect_b32 s20, s21, s20
    v_mfma_f32_16x16x32_bf16 v[92:95], v[140:143], v[172:175], v[92:95]
    v_mfma_f32_16x16x32_bf16 v[88:91], v[140:143], v[168:171], v[88:91]
    v_mfma_f32_16x16x32_bf16 v[84:87], v[140:143], v[164:167], v[84:87]
    v_mfma_f32_16x16x32_bf16 v[80:83], v[140:143], v[160:163], v[80:83]
    s_cmp_eq_u32 s27, 3
    s_cbranch_scc1 cs_646
cs_646_b:
    s_waitcnt vmcnt(5) lgkmcnt(0)
g3c1_pb8:
    s_barrier
    v_mfma_f32_16x16x32_bf16 v[0:3], v[96:99], v[144:147], v[0:3]
    ds_read_b128 v[160:163], v235 offset:8192
    ds_read_b128 v[164:167], v235 offset:9216
    v_mfma_f32_16x16x32_bf16 v[4:7], v[96:99], v[148:151], v[4:7]
    ds_read_b128 v[168:171], v235 offset:10240
    v_mfma_f32_16x16x32_bf16 v[8:11], v[96:99], v[152:155], v[8:11]
    ds_read_b128 v[172:175], v235 offset:11264
    v_mfma_f32_16x16x32_bf16 v[12:15], v[96:99], v[156:159], v[12:15]
    s_add_u32 m0, s19, 0
    s_nop 0
    buffer_load_dwordx4 v228, s[8:11], s16 offen lds
    v_mfma_f32_16x16x32_bf16 v[60:63], v[108:111], v[156:159], v[60:63]
    ds_read_b64_tr_b16 v[120:121], v237 offset:0
    v_mfma_f32_16x16x32_bf16 v[56:59], v[108:111], v[152:155], v[56:59]
    ds_read_b64_tr_b16 v[122:123], v237 offset:3584
    v_mfma_f32_16x16x32_bf16 v[52:55], v[108:111], v[148:151], v[52:55]
    ds_read_b64_tr_b16 v[132:133], v237 offset:14400
    s_lshl_b32 s26, s32, 15
    s_lshl_b32 s65, s75, 20
    s_add_u32 s26, s26, s65
    s_lshl_b32 s65, s33, 8
    s_add_u32 s26, s26, s65
    s_add_u32 s26, s26, 71303168
    v_lshlrev_b32 v225, 4, v252
    v_lshl_add_u32 v225, v251, 13, v225
    v_mfma_f32_16x16x32_bf16 v[48:51], v[108:111], v[144:147], v[48:51]
    s_add_u32 m0, s19, 1024
    s_nop 0
    buffer_load_dwordx4 v229, s[8:11], s16 offen lds
    v_mfma_f32_16x16x32_bf16 v[16:19], v[100:103], v[144:147], v[16:19]
    ds_read_b64_tr_b16 v[134:135], v237 offset:17984
    v_mfma_f32_16x16x32_bf16 v[20:23], v[100:103], v[148:151], v[20:23]
    ds_read_b64_tr_b16 v[124:125], v237 offset:32
    v_mfma_f32_16x16x32_bf16 v[24:27], v[100:103], v[152:155], v[24:27]
    ds_read_b64_tr_b16 v[126:127], v237 offset:3616
    v_mfma_f32_16x16x32_bf16 v[28:31], v[100:103], v[156:159], v[28:31]
    s_add_u32 m0, s19, 2048
    s_nop 0
    buffer_load_dwordx4 v230, s[8:11], s16 offen lds
    s_add_u32 s16, s16, 229376
    s_cmp_eq_u32 s16, s18
    s_cselect_b32 s16, s17, s16
    v_mfma_f32_16x16x32_bf16 v[76:79], v[112:115], v[156:159], v[76:79]
    ds_read_b64_tr_b16 v[136:137], v237 offset:14432
    v_mfma_f32_16x16x32_bf16 v[72:75], v[112:115], v[152:155], v[72:75]
    ds_read_b64_tr_b16 v[138:139], v237 offset:18016
    v_mfma_f32_16x16x32_bf16 v[68:71], v[112:115], v[148:151], v[68:71]
    ds_read_b64_tr_b16 v[128:129], v239 offset:0
    v_mfma_f32_16x16x32_bf16 v[64:67], v[112:115], v[144:147], v[64:67]
    s_add_u32 m0, s23, 24576
    s_nop 0
    buffer_load_dwordx4 v249, s[80:83], s20 offen sc1 lds
    v_mfma_f32_16x16x32_bf16 v[32:35], v[104:107], v[144:147], v[32:35]
    ds_read_b64_tr_b16 v[130:131], v239 offset:3584
    v_mfma_f32_16x16x32_bf16 v[36:39], v[104:107], v[148:151], v[36:39]
    ds_read_b64_tr_b16 v[140:141], v239 offset:14400
    v_mfma_f32_16x16x32_bf16 v[40:43], v[104:107], v[152:155], v[40:43]
    ds_read_b64_tr_b16 v[142:143], v239 offset:17984
    v_mfma_f32_16x16x32_bf16 v[44:47], v[104:107], v[156:159], v[44:47]
    s_add_u32 m0, s23, 24576
    s_nop 0
    buffer_load_dwordx4 v249, s[80:83], s20 offen offset:1024 sc1 lds
    s_add_u32 s20, s20, 8192
    s_cmp_eq_u32 s20, s22
    s_cselect_b32 s20, s21, s20
    v_mfma_f32_16x16x32_bf16 v[92:95], v[116:119], v[156:159], v[92:95]
    v_mfma_f32_16x16x32_bf16 v[88:91], v[116:119], v[152:155], v[88:91]
    v_mfma_f32_16x16x32_bf16 v[84:87], v[116:119], v[148:151], v[84:87]
    v_mfma_f32_16x16x32_bf16 v[80:83], v[116:119], v[144:147], v[80:83]
    buffer_load_dwordx4 v[176:179], v225, s[80:83], s26 offen offset:0 sc1
    buffer_load_dwordx4 v[180:183], v225, s[80:83], s26 offen offset:1024 sc1
    buffer_load_dwordx4 v[184:187], v225, s[80:83], s26 offen offset:2048 sc1
    buffer_load_dwordx4 v[188:191], v225, s[80:83], s26 offen offset:3072 sc1
    s_add_u32 s26, s26, 4096
    s_waitcnt vmcnt(9) lgkmcnt(0)
g3c1_pb9:
    s_barrier
    v_mfma_f32_16x16x32_bf16 v[0:3], v[120:123], v[160:163], v[0:3]
    ds_read_b128 v[144:147], v235 offset:16384
    ds_read_b128 v[148:151], v235 offset:17408
    v_mfma_f32_16x16x32_bf16 v[4:7], v[120:123], v[164:167], v[4:7]
    ds_read_b128 v[152:155], v235 offset:18432
    v_mfma_f32_16x16x32_bf16 v[8:11], v[120:123], v[168:171], v[8:11]
    ds_read_b128 v[156:159], v235 offset:19456
    v_mfma_f32_16x16x32_bf16 v[12:15], v[120:123], v[172:175], v[12:15]
    s_add_u32 m0, s19, 28800
    s_nop 0
    buffer_load_dwordx4 v228, s[8:11], s16 offen lds
    v_mfma_f32_16x16x32_bf16 v[60:63], v[132:135], v[172:175], v[60:63]
    ds_read_b64_tr_b16 v[96:97], v237 offset:28800
    v_mfma_f32_16x16x32_bf16 v[56:59], v[132:135], v[168:171], v[56:59]
    ds_read_b64_tr_b16 v[98:99], v237 offset:32384
    v_mfma_f32_16x16x32_bf16 v[52:55], v[132:135], v[164:167], v[52:55]
    ds_read_b64_tr_b16 v[108:109], v237 offset:43200
    v_mfma_f32_16x16x32_bf16 v[48:51], v[132:135], v[160:163], v[48:51]
    s_add_u32 m0, s19, 29824
    s_nop 0
    buffer_load_dwordx4 v229, s[8:11], s16 offen lds
    v_mfma_f32_16x16x32_bf16 v[16:19], v[124:127], v[160:163], v[16:19]
    ds_read_b64_tr_b16 v[110:111], v237 offset:46784
    v_mfma_f32_16x16x32_bf16 v[20:23], v[124:127], v[164:167], v[20:23]
    ds_read_b64_tr_b16 v[100:101], v237 offset:28832
    v_mfma_f32_16x16x32_bf16 v[24:27], v[124:127], v[168:171], v[24:27]
    ds_read_b64_tr_b16 v[102:103], v237 offset:32416
    v_mfma_f32_16x16x32_bf16 v[28:31], v[124:127], v[172:175], v[28:31]
    s_add_u32 m0, s19, 30848
    s_nop 0
    buffer_load_dwordx4 v230, s[8:11], s16 offen lds
    s_add_u32 s16, s16, 229376
    s_cmp_eq_u32 s16, s18
    s_cselect_b32 s16, s17, s16
    v_mfma_f32_16x16x32_bf16 v[76:79], v[136:139], v[172:175], v[76:79]
    ds_read_b64_tr_b16 v[112:113], v237 offset:43232
    v_mfma_f32_16x16x32_bf16 v[72:75], v[136:139], v[168:171], v[72:75]
    ds_read_b64_tr_b16 v[114:115], v237 offset:46816
    v_mfma_f32_16x16x32_bf16 v[68:71], v[136:139], v[164:167], v[68:71]
    ds_read_b64_tr_b16 v[104:105], v239 offset:28800
    v_mfma_f32_16x16x32_bf16 v[64:67], v[136:139], v[160:163], v[64:67]
    s_add_u32 m0, s23, 0
    s_nop 0
    buffer_load_dwordx4 v249, s[80:83], s20 offen sc1 lds
    v_mfma_f32_16x16x32_bf16 v[32:35], v[128:131], v[160:163], v[32:35]
    ds_read_b64_tr_b16 v[106:107], v239 offset:32384
    v_mfma_f32_16x16x32_bf16 v[36:39], v[128:131], v[164:167], v[36:39]
    ds_read_b64_tr_b16 v[116:117], v239 offset:43200
    v_mfma_f32_16x16x32_bf16 v[40:43], v[128:131], v[168:171], v[40:43]
    ds_read_b64_tr_b16 v[118:119], v239 offset:46784
    v_mfma_f32_16x16x32_bf16 v[44:47], v[128:131], v[172:175], v[44:47]
    s_add_u32 m0, s23, 0
    s_nop 0
    buffer_load_dwordx4 v249, s[80:83], s20 offen offset:1024 sc1 lds
    s_add_u32 s20, s20, 8192
    s_cmp_eq_u32 s20, s22
    s_cselect_b32 s20, s21, s20
    v_mfma_f32_16x16x32_bf16 v[92:95], v[140:143], v[172:175], v[92:95]
    v_mfma_f32_16x16x32_bf16 v[88:91], v[140:143], v[168:171], v[88:91]
    v_mfma_f32_16x16x32_bf16 v[84:87], v[140:143], v[164:167], v[84:87]
    v_mfma_f32_16x16x32_bf16 v[80:83], v[140:143], v[160:163], v[80:83]
    buffer_load_dwordx4 v[192:195], v225, s[80:83], s26 offen offset:0 sc1
    buffer_load_dwordx4 v[196:199], v225, s[80:83], s26 offen offset:1024 sc1
    buffer_load_dwordx4 v[200:203], v225, s[80:83], s26 offen offset:2048 sc1
    buffer_load_dwordx4 v[204:207], v225, s[80:83], s26 offen offset:3072 sc1
    s_waitcnt vmcnt(13) lgkmcnt(0)
g3c1_pb10:
    s_barrier
    v_mfma_f32_16x16x32_bf16 v[0:3], v[96:99], v[144:147], v[0:3]
    ds_read_b128 v[160:163], v235 offset:24576
    ds_read_b128 v[164:167], v235 offset:25600
    v_mfma_f32_16x16x32_bf16 v[4:7], v[96:99], v[148:151], v[4:7]
    ds_read_b128 v[168:171], v235 offset:26624
    v_mfma_f32_16x16x32_bf16 v[8:11], v[96:99], v[152:155], v[8:11]
    ds_read_b128 v[172:175], v235 offset:27648
    v_mfma_f32_16x16x32_bf16 v[12:15], v[96:99], v[156:159], v[12:15]
    s_add_u32 m0, s19, 57600
    s_nop 0
    buffer_load_dwordx4 v228, s[8:11], s16 offen lds
    v_mfma_f32_16x16x32_bf16 v[60:63], v[108:111], v[156:159], v[60:63]
    ds_read_b64_tr_b16 v[120:121], v236 offset:0
    v_mfma_f32_16x16x32_bf16 v[56:59], v[108:111], v[152:155], v[56:59]
    ds_read_b64_tr_b16 v[122:123], v236 offset:3584
    v_mfma_f32_16x16x32_bf16 v[52:55], v[108:111], v[148:151], v[52:55]
    ds_read_b64_tr_b16 v[132:133], v236 offset:14400
    v_mfma_f32_16x16x32_bf16 v[48:51], v[108:111], v[144:147], v[48:51]
    s_add_u32 m0, s19, 58624
    s_nop 0
    buffer_load_dwordx4 v229, s[8:11], s16 offen lds
    v_mfma_f32_16x16x32_bf16 v[16:19], v[100:103], v[144:147], v[16:19]
    ds_read_b64_tr_b16 v[134:135], v236 offset:17984
    v_mfma_f32_16x16x32_bf16 v[20:23], v[100:103], v[148:151], v[20:23]
    ds_read_b64_tr_b16 v[124:125], v236 offset:32
    v_mfma_f32_16x16x32_bf16 v[24:27], v[100:103], v[152:155], v[24:27]
    ds_read_b64_tr_b16 v[126:127], v236 offset:3616
    v_mfma_f32_16x16x32_bf16 v[28:31], v[100:103], v[156:159], v[28:31]
    s_add_u32 m0, s19, 59648
    s_nop 0
    buffer_load_dwordx4 v230, s[8:11], s16 offen lds
    s_add_u32 s16, s16, 229376
    s_cmp_eq_u32 s16, s18
    s_cselect_b32 s16, s17, s16
    v_mfma_f32_16x16x32_bf16 v[76:79], v[112:115], v[156:159], v[76:79]
    ds_read_b64_tr_b16 v[136:137], v236 offset:14432
    v_mfma_f32_16x16x32_bf16 v[72:75], v[112:115], v[152:155], v[72:75]
    ds_read_b64_tr_b16 v[138:139], v236 offset:18016
    v_mfma_f32_16x16x32_bf16 v[68:71], v[112:115], v[148:151], v[68:71]
    ds_read_b64_tr_b16 v[128:129], v238 offset:0
    v_mfma_f32_16x16x32_bf16 v[64:67], v[112:115], v[144:147], v[64:67]
    s_add_u32 m0, s23, 8192
    s_nop 0
    buffer_load_dwordx4 v249, s[80:83], s20 offen sc1 lds
    v_mfma_f32_16x16x32_bf16 v[32:35], v[104:107], v[144:147], v[32:35]
    ds_read_b64_tr_b16 v[130:131], v238 offset:3584
    v_mfma_f32_16x16x32_bf16 v[36:39], v[104:107], v[148:151], v[36:39]
    ds_read_b64_tr_b16 v[140:141], v238 offset:14400
    v_mfma_f32_16x16x32_bf16 v[40:43], v[104:107], v[152:155], v[40:43]
    ds_read_b64_tr_b16 v[142:143], v238 offset:17984
    v_mfma_f32_16x16x32_bf16 v[44:47], v[104:107], v[156:159], v[44:47]
    s_add_u32 m0, s23, 8192
    s_nop 0
    buffer_load_dwordx4 v249, s[80:83], s20 offen offset:1024 sc1 lds
    s_add_u32 s20, s20, 8192
    s_cmp_eq_u32 s20, s22
    s_cselect_b32 s20, s21, s20
    v_mfma_f32_16x16x32_bf16 v[92:95], v[116:119], v[156:159], v[92:95]
    v_mfma_f32_16x16x32_bf16 v[88:91], v[116:119], v[152:155], v[88:91]
    v_mfma_f32_16x16x32_bf16 v[84:87], v[116:119], v[148:151], v[84:87]
    v_mfma_f32_16x16x32_bf16 v[80:83], v[116:119], v[144:147], v[80:83]
    s_cmp_eq_u32 s75, 0
    s_cbranch_scc1 cf_1147
cf_1147_b:
    s_waitcnt vmcnt(5) lgkmcnt(0)
g3c1_pb11:
    s_barrier
    v_mfma_f32_16x16x32_bf16 v[0:3], v[120:123], v[160:163], v[0:3]
    ds_read_b128 v[144:147], v235 offset:0
    ds_read_b128 v[148:151], v235 offset:1024
    s_lshl_b32 s26, s69, 8
    v_mfma_f32_16x16x32_bf16 v[4:7], v[120:123], v[164:167], v[4:7]
    ds_read_b128 v[152:155], v235 offset:2048
    s_add_u32 s26, s26, 159744
    v_mfma_f32_16x16x32_bf16 v[8:11], v[120:123], v[168:171], v[8:11]
    ds_read_b128 v[156:159], v235 offset:3072
    v_add_f32 v176, v176, v192
    v_mfma_f32_16x16x32_bf16 v[12:15], v[120:123], v[172:175], v[12:15]
    s_add_u32 m0, s19, 86400
    s_nop 0
    buffer_load_dwordx4 v228, s[8:11], s16 offen lds
    v_add_f32 v177, v177, v193
    v_mfma_f32_16x16x32_bf16 v[60:63], v[132:135], v[172:175], v[60:63]
    ds_read_b64_tr_b16 v[96:97], v236 offset:28800
    v_add_f32 v178, v178, v194
    v_mfma_f32_16x16x32_bf16 v[56:59], v[132:135], v[168:171], v[56:59]
    ds_read_b64_tr_b16 v[98:99], v236 offset:32384
    v_add_f32 v179, v179, v195
    v_mfma_f32_16x16x32_bf16 v[52:55], v[132:135], v[164:167], v[52:55]
    ds_read_b64_tr_b16 v[108:109], v236 offset:43200
    v_add_f32 v180, v180, v196
    v_mfma_f32_16x16x32_bf16 v[48:51], v[132:135], v[160:163], v[48:51]
    s_add_u32 m0, s19, 87424
    s_nop 0
    buffer_load_dwordx4 v229, s[8:11], s16 offen lds
    v_add_f32 v181, v181, v197
    v_mfma_f32_16x16x32_bf16 v[16:19], v[124:127], v[160:163], v[16:19]
    ds_read_b64_tr_b16 v[110:111], v236 offset:46784
    v_add_f32 v182, v182, v198
    v_mfma_f32_16x16x32_bf16 v[20:23], v[124:127], v[164:167], v[20:23]
    ds_read_b64_tr_b16 v[100:101], v236 offset:28832
    v_add_f32 v183, v183, v199
    v_mfma_f32_16x16x32_bf16 v[24:27], v[124:127], v[168:171], v[24:27]
    ds_read_b64_tr_b16 v[102:103], v236 offset:32416
    v_add_f32 v184, v184, v200
    v_mfma_f32_16x16x32_bf16 v[28:31], v[124:127], v[172:175], v[28:31]
    s_add_u32 m0, s19, 88448
    s_nop 0
    buffer_load_dwordx4 v230, s[8:11], s16 offen lds
    s_add_u32 s16, s16, 229376
    s_cmp_eq_u32 s16, s18
    s_cselect_b32 s16, s17, s16
    v_add_f32 v185, v185, v201
    v_mfma_f32_16x16x32_bf16 v[76:79], v[136:139], v[172:175], v[76:79]
    ds_read_b64_tr_b16 v[112:113], v236 offset:43232
    v_add_f32 v186, v186, v202
    v_mfma_f32_16x16x32_bf16 v[72:75], v[136:139], v[168:171], v[72:75]
    ds_read_b64_tr_b16 v[114:115], v236 offset:46816
    v_add_f32 v187, v187, v203
    v_mfma_f32_16x16x32_bf16 v[68:71], v[136:139], v[164:167], v[68:71]
    ds_read_b64_tr_b16 v[104:105], v238 offset:28800
    v_add_f32 v188, v188, v204
    v_mfma_f32_16x16x32_bf16 v[64:67], v[136:139], v[160:163], v[64:67]
    s_add_u32 m0, s23, 16384
    s_nop 0
    buffer_load_dwordx4 v249, s[80:83], s20 offen sc1 lds
    v_add_f32 v189, v189, v205
    v_mfma_f32_16x16x32_bf16 v[32:35], v[128:131], v[160:163], v[32:35]
    ds_read_b64_tr_b16 v[106:107], v238 offset:32384
    v_add_f32 v190, v190, v206
    v_mfma_f32_16x16x32_bf16 v[36:39], v[128:131], v[164:167], v[36:39]
    ds_read_b64_tr_b16 v[116:117], v238 offset:43200
    v_add_f32 v191, v191, v207
    v_mfma_f32_16x16x32_bf16 v[40:43], v[128:131], v[168:171], v[40:43]
    ds_read_b64_tr_b16 v[118:119], v238 offset:46784
    v_add_f32 v176, v176, v184
    v_mfma_f32_16x16x32_bf16 v[44:47], v[128:131], v[172:175], v[44:47]
    s_add_u32 m0, s23, 16384
    s_nop 0
    buffer_load_dwordx4 v249, s[80:83], s20 offen offset:1024 sc1 lds
    s_add_u32 s20, s20, 8192
    s_cmp_eq_u32 s20, s22
    s_cselect_b32 s20, s21, s20
    v_add_f32 v177, v177, v185
    v_mfma_f32_16x16x32_bf16 v[92:95], v[140:143], v[172:175], v[92:95]
    v_add_f32 v178, v178, v186
    v_mfma_f32_16x16x32_bf16 v[88:91], v[140:143], v[168:171], v[88:91]
    v_add_f32 v179, v179, v187
    v_mfma_f32_16x16x32_bf16 v[84:87], v[140:143], v[164:167], v[84:87]
    v_add_f32 v180, v180, v188
    v_mfma_f32_16x16x32_bf16 v[80:83], v[140:143], v[160:163], v[80:83]
    v_add_f32 v181, v181, v189
    v_add_f32 v182, v182, v190
    v_add_f32 v183, v183, v191
    v_add_f32 v176, v176, v180
    v_add_f32 v177, v177, v181
    v_add_f32 v178, v178, v182
    v_add_f32 v179, v179, v183
    v_and_b32 v225, 15, v252
    v_and_b32 v180, 1, v251
    v_permlane16_swap_b32 v176, v178
    v_permlane16_swap_b32 v177, v179
    v_add_f32 v176, v176, v178
    v_add_f32 v177, v177, v179
    v_mov_b32 v178, v176
    v_mov_b32 v179, v177
    v_lshl_add_u32 v225, v225, 1, v180
    v_lshlrev_b32 v225, 3, v225
    v_permlane32_swap_b32 v176, v178
    v_permlane32_swap_b32 v177, v179
    v_add_f32 v176, v176, v178
    v_add_f32 v177, v177, v179
    v_mul_f32 v176, 0x3a800000, v176
    v_mul_f32 v177, 0x3a800000, v177
    v_fma_f32 v177, -v176, v176, v177
    v_max_f32 v177, 0, v177
    v_cvt_pk_bf16_f32 v176, v176, v176
    v_lshlrev_b32 v176, 16, v176
    v_cvt_pk_bf16_f32 v177, v177, v177
    v_lshlrev_b32 v177, 16, v177
    v_add_f32 v177, 0x3727c5ac, v177
    v_cvt_pk_bf16_f32 v177, v177, v177
    v_lshlrev_b32 v177, 16, v177
    v_sqrt_f32 v177, v177
    s_nop 0
    v_cvt_pk_bf16_f32 v177, v177, v177
    v_lshlrev_b32 v177, 16, v177
    v_rcp_f32 v177, v177
    s_nop 0
    v_add_u32 v225, s26, v225
    ds_write_b64 v225, v[176:177]
    s_mov_b32 s24, 4
    s_cmp_eq_u32 s75, 0
    s_cselect_b32 s27, 6, 0
g3c1_loop:
    s_waitcnt vmcnt(5) lgkmcnt(0)
    s_barrier
    v_mfma_f32_16x16x32_bf16 v[0:3], v[96:99], v[144:147], v[0:3]
    ds_read_b128 v[160:163], v235 offset:8192
    ds_read_b128 v[164:167], v235 offset:9216
    v_mfma_f32_16x16x32_bf16 v[4:7], v[96:99], v[148:151], v[4:7]
    ds_read_b128 v[168:171], v235 offset:10240
    v_mfma_f32_16x16x32_bf16 v[8:11], v[96:99], v[152:155], v[8:11]
    ds_read_b128 v[172:175], v235 offset:11264
    v_mfma_f32_16x16x32_bf16 v[12:15], v[96:99], v[156:159], v[12:15]
    s_add_u32 m0, s19, 0
    s_nop 0
    buffer_load_dwordx4 v228, s[8:11], s16 offen lds
    v_mfma_f32_16x16x32_bf16 v[60:63], v[108:111], v[156:159], v[60:63]
    ds_read_b64_tr_b16 v[120:121], v237 offset:0
    v_mfma_f32_16x16x32_bf16 v[56:59], v[108:111], v[152:155], v[56:59]
    ds_read_b64_tr_b16 v[122:123], v237 offset:3584
    v_mfma_f32_16x16x32_bf16 v[52:55], v[108:111], v[148:151], v[52:55]
    ds_read_b64_tr_b16 v[132:133], v237 offset:14400
    v_mfma_f32_16x16x32_bf16 v[48:51], v[108:111], v[144:147], v[48:51]
    s_add_u32 m0, s19, 1024
    s_nop 0
    buffer_load_dwordx4 v229, s[8:11], s16 offen lds
    v_mfma_f32_16x16x32_bf16 v[16:19], v[100:103], v[144:147], v[16:19]
    ds_read_b64_tr_b16 v[134:135], v237 offset:17984
    v_mfma_f32_16x16x32_bf16 v[20:23], v[100:103], v[148:151], v[20:23]
    ds_read_b64_tr_b16 v[124:125], v237 offset:32
    v_mfma_f32_16x16x32_bf16 v[24:27], v[100:103], v[152:155], v[24:27]
    ds_read_b64_tr_b16 v[126:127], v237 offset:3616
    v_mfma_f32_16x16x32_bf16 v[28:31], v[100:103], v[156:159], v[28:31]
    s_add_u32 m0, s19, 2048
    s_nop 0
    buffer_load_dwordx4 v230, s[8:11], s16 offen lds
    s_add_u32 s16, s16, 229376
    s_cmp_eq_u32 s16, s18
    s_cselect_b32 s16, s17, s16
    v_mfma_f32_16x16x32_bf16 v[76:79], v[112:115], v[156:159], v[76:79]
    ds_read_b64_tr_b16 v[136:137], v237 offset:14432
    v_mfma_f32_16x16x32_bf16 v[72:75], v[112:115], v[152:155], v[72:75]
    ds_read_b64_tr_b16 v[138:139], v237 offset:18016
    v_mfma_f32_16x16x32_bf16 v[68:71], v[112:115], v[148:151], v[68:71]
    ds_read_b64_tr_b16 v[128:129], v239 offset:0
    v_mfma_f32_16x16x32_bf16 v[64:67], v[112:115], v[144:147], v[64:67]
    s_add_u32 m0, s23, 24576
    s_nop 0
    buffer_load_dwordx4 v249, s[80:83], s20 offen sc1 lds
    v_mfma_f32_16x16x32_bf16 v[32:35], v[104:107], v[144:147], v[32:35]
    ds_read_b64_tr_b16 v[130:131], v239 offset:3584
    v_mfma_f32_16x16x32_bf16 v[36:39], v[104:107], v[148:151], v[36:39]
    ds_read_b64_tr_b16 v[140:141], v239 offset:14400
    v_mfma_f32_16x16x32_bf16 v[40:43], v[104:107], v[152:155], v[40:43]
    ds_read_b64_tr_b16 v[142:143], v239 offset:17984
    v_mfma_f32_16x16x32_bf16 v[44:47], v[104:107], v[156:159], v[44:47]
    s_add_u32 m0, s23, 24576
    s_nop 0
    buffer_load_dwordx4 v249, s[80:83], s20 offen offset:1024 sc1 lds
    s_add_u32 s20, s20, 8192
    s_cmp_eq_u32 s20, s22
    s_cselect_b32 s20, s21, s20
    v_mfma_f32_16x16x32_bf16 v[92:95], v[116:119], v[156:159], v[92:95]
    v_mfma_f32_16x16x32_bf16 v[88:91], v[116:119], v[152:155], v[88:91]
    v_mfma_f32_16x16x32_bf16 v[84:87], v[116:119], v[148:151], v[84:87]
    v_mfma_f32_16x16x32_bf16 v[80:83], v[116:119], v[144:147], v[80:83]
    s_bitcmp1_b32 s27, s24
    s_cbranch_scc1 g3c1_hook
g3c1_hb:
    s_waitcnt vmcnt(5) lgkmcnt(0)
    s_barrier
    v_mfma_f32_16x16x32_bf16 v[0:3], v[120:123], v[160:163], v[0:3]
    ds_read_b128 v[144:147], v235 offset:16384
    ds_read_b128 v[148:151], v235 offset:17408
    v_mfma_f32_16x16x32_bf16 v[4:7], v[120:123], v[164:167], v[4:7]
    ds_read_b128 v[152:155], v235 offset:18432
    v_mfma_f32_16x16x32_bf16 v[8:11], v[120:123], v[168:171], v[8:11]
    ds_read_b128 v[156:159], v235 offset:19456
    v_mfma_f32_16x16x32_bf16 v[12:15], v[120:123], v[172:175], v[12:15]
    s_add_u32 m0, s19, 28800
    s_nop 0
    buffer_load_dwordx4 v228, s[8:11], s16 offen lds
    v_mfma_f32_16x16x32_bf16 v[60:63], v[132:135], v[172:175], v[60:63]
    ds_read_b64_tr_b16 v[96:97], v237 offset:28800
    v_mfma_f32_16x16x32_bf16 v[56:59], v[132:135], v[168:171], v[56:59]
    ds_read_b64_tr_b16 v[98:99], v237 offset:32384
    v_mfma_f32_16x16x32_bf16 v[52:55], v[132:135], v[164:167], v[52:55]
    ds_read_b64_tr_b16 v[108:109], v237 offset:43200
    v_mfma_f32_16x16x32_bf16 v[48:51], v[132:135], v[160:163], v[48:51]
    s_add_u32 m0, s19, 29824
    s_nop 0
    buffer_load_dwordx4 v229, s[8:11], s16 offen lds
    v_mfma_f32_16x16x32_bf16 v[16:19], v[124:127], v[160:163], v[16:19]
    ds_read_b64_tr_b16 v[110:111], v237 offset:46784
    v_mfma_f32_16x16x32_bf16 v[20:23], v[124:127], v[164:167], v[20:23]
    ds_read_b64_tr_b16 v[100:101], v237 offset:28832
    v_mfma_f32_16x16x32_bf16 v[24:27], v[124:127], v[168:171], v[24:27]
    ds_read_b64_tr_b16 v[102:103], v237 offset:32416
    v_mfma_f32_16x16x32_bf16 v[28:31], v[124:127], v[172:175], v[28:31]
    s_add_u32 m0, s19, 30848
    s_nop 0
    buffer_load_dwordx4 v230, s[8:11], s16 offen lds
    s_add_u32 s16, s16, 229376
    s_cmp_eq_u32 s16, s18
    s_cselect_b32 s16, s17, s16
    v_mfma_f32_16x16x32_bf16 v[76:79], v[136:139], v[172:175], v[76:79]
    ds_read_b64_tr_b16 v[112:113], v237 offset:43232
    v_mfma_f32_16x16x32_bf16 v[72:75], v[136:139], v[168:171], v[72:75]
    ds_read_b64_tr_b16 v[114:115], v237 offset:46816
    v_mfma_f32_16x16x32_bf16 v[68:71], v[136:139], v[164:167], v[68:71]
    ds_read_b64_tr_b16 v[104:105], v239 offset:28800
    v_mfma_f32_16x16x32_bf16 v[64:67], v[136:139], v[160:163], v[64:67]
    s_add_u32 m0, s23, 0
    s_nop 0
    buffer_load_dwordx4 v249, s[80:83], s20 offen sc1 lds
    v_mfma_f32_16x16x32_bf16 v[32:35], v[128:131], v[160:163], v[32:35]
    ds_read_b64_tr_b16 v[106:107], v239 offset:32384
    v_mfma_f32_16x16x32_bf16 v[36:39], v[128:131], v[164:167], v[36:39]
    ds_read_b64_tr_b16 v[116:117], v239 offset:43200
    v_mfma_f32_16x16x32_bf16 v[40:43], v[128:131], v[168:171], v[40:43]
    ds_read_b64_tr_b16 v[118:119], v239 offset:46784
    v_mfma_f32_16x16x32_bf16 v[44:47], v[128:131], v[172:175], v[44:47]
    s_add_u32 m0, s23, 0
    s_nop 0
    buffer_load_dwordx4 v249, s[80:83], s20 offen offset:1024 sc1 lds
    s_add_u32 s20, s20, 8192
    s_cmp_eq_u32 s20, s22
    s_cselect_b32 s20, s21, s20
    v_mfma_f32_16x16x32_bf16 v[92:95], v[140:143], v[172:175], v[92:95]
    v_mfma_f32_16x16x32_bf16 v[88:91], v[140:143], v[168:171], v[88:91]
    v_mfma_f32_16x16x32_bf16 v[84:87], v[140:143], v[164:167], v[84:87]
    v_mfma_f32_16x16x32_bf16 v[80:83], v[140:143], v[160:163], v[80:83]
    s_waitcnt vmcnt(5) lgkmcnt(0)
    s_barrier
    v_mfma_f32_16x16x32_bf16 v[0:3], v[96:99], v[144:147], v[0:3]
    ds_read_b128 v[160:163], v235 offset:24576
    ds_read_b128 v[164:167], v235 offset:25600
    v_mfma_f32_16x16x32_bf16 v[4:7], v[96:99], v[148:151], v[4:7]
    ds_read_b128 v[168:171], v235 offset:26624
    v_mfma_f32_16x16x32_bf16 v[8:11], v[96:99], v[152:155], v[8:11]
    ds_read_b128 v[172:175], v235 offset:27648
    v_mfma_f32_16x16x32_bf16 v[12:15], v[96:99], v[156:159], v[12:15]
    s_add_u32 m0, s19, 57600
    s_nop 0
    buffer_load_dwordx4 v228, s[8:11], s16 offen lds
    v_mfma_f32_16x16x32_bf16 v[60:63], v[108:111], v[156:159], v[60:63]
    ds_read_b64_tr_b16 v[120:121], v236 offset:0
    v_mfma_f32_16x16x32_bf16 v[56:59], v[108:111], v[152:155], v[56:59]
    ds_read_b64_tr_b16 v[122:123], v236 offset:3584
    v_mfma_f32_16x16x32_bf16 v[52:55], v[108:111], v[148:151], v[52:55]
    ds_read_b64_tr_b16 v[132:133], v236 offset:14400
    v_mfma_f32_16x16x32_bf16 v[48:51], v[108:111], v[144:147], v[48:51]
    s_add_u32 m0, s19, 58624
    s_nop 0
    buffer_load_dwordx4 v229, s[8:11], s16 offen lds
    v_mfma_f32_16x16x32_bf16 v[16:19], v[100:103], v[144:147], v[16:19]
    ds_read_b64_tr_b16 v[134:135], v236 offset:17984
    v_mfma_f32_16x16x32_bf16 v[20:23], v[100:103], v[148:151], v[20:23]
    ds_read_b64_tr_b16 v[124:125], v236 offset:32
    v_mfma_f32_16x16x32_bf16 v[24:27], v[100:103], v[152:155], v[24:27]
    ds_read_b64_tr_b16 v[126:127], v236 offset:3616
    v_mfma_f32_16x16x32_bf16 v[28:31], v[100:103], v[156:159], v[28:31]
    s_add_u32 m0, s19, 59648
    s_nop 0
    buffer_load_dwordx4 v230, s[8:11], s16 offen lds
    s_add_u32 s16, s16, 229376
    s_cmp_eq_u32 s16, s18
    s_cselect_b32 s16, s17, s16
    v_mfma_f32_16x16x32_bf16 v[76:79], v[112:115], v[156:159], v[76:79]
    ds_read_b64_tr_b16 v[136:137], v236 offset:14432
    v_mfma_f32_16x16x32_bf16 v[72:75], v[112:115], v[152:155], v[72:75]
    ds_read_b64_tr_b16 v[138:139], v236 offset:18016
    v_mfma_f32_16x16x32_bf16 v[68:71], v[112:115], v[148:151], v[68:71]
    ds_read_b64_tr_b16 v[128:129], v238 offset:0
    v_mfma_f32_16x16x32_bf16 v[64:67], v[112:115], v[144:147], v[64:67]
    s_add_u32 m0, s23, 8192
    s_nop 0
    buffer_load_dwordx4 v249, s[80:83], s20 offen sc1 lds
    v_mfma_f32_16x16x32_bf16 v[32:35], v[104:107], v[144:147], v[32:35]
    ds_read_b64_tr_b16 v[130:131], v238 offset:3584
    v_mfma_f32_16x16x32_bf16 v[36:39], v[104:107], v[148:151], v[36:39]
    ds_read_b64_tr_b16 v[140:141], v238 offset:14400
    v_mfma_f32_16x16x32_bf16 v[40:43], v[104:107], v[152:155], v[40:43]
    ds_read_b64_tr_b16 v[142:143], v238 offset:17984
    v_mfma_f32_16x16x32_bf16 v[44:47], v[104:107], v[156:159], v[44:47]
    s_add_u32 m0, s23, 8192
    s_nop 0
    buffer_load_dwordx4 v249, s[80:83], s20 offen offset:1024 sc1 lds
    s_add_u32 s20, s20, 8192
    s_cmp_eq_u32 s20, s22
    s_cselect_b32 s20, s21, s20
    v_mfma_f32_16x16x32_bf16 v[92:95], v[116:119], v[156:159], v[92:95]
    v_mfma_f32_16x16x32_bf16 v[88:91], v[116:119], v[152:155], v[88:91]
    v_mfma_f32_16x16x32_bf16 v[84:87], v[116:119], v[148:151], v[84:87]
    v_mfma_f32_16x16x32_bf16 v[80:83], v[116:119], v[144:147], v[80:83]
    s_waitcnt vmcnt(5) lgkmcnt(0)
    s_barrier
    v_mfma_f32_16x16x32_bf16 v[0:3], v[120:123], v[160:163], v[0:3]
    ds_read_b128 v[144:147], v235 offset:0
    ds_read_b128 v[148:151], v235 offset:1024
    v_mfma_f32_16x16x32_bf16 v[4:7], v[120:123], v[164:167], v[4:7]
    ds_read_b128 v[152:155], v235 offset:2048
    v_mfma_f32_16x16x32_bf16 v[8:11], v[120:123], v[168:171], v[8:11]
    ds_read_b128 v[156:159], v235 offset:3072
    v_mfma_f32_16x16x32_bf16 v[12:15], v[120:123], v[172:175], v[12:15]
    s_add_u32 m0, s19, 86400
    s_nop 0
    buffer_load_dwordx4 v228, s[8:11], s16 offen lds
    v_mfma_f32_16x16x32_bf16 v[60:63], v[132:135], v[172:175], v[60:63]
    ds_read_b64_tr_b16 v[96:97], v236 offset:28800
    v_mfma_f32_16x16x32_bf16 v[56:59], v[132:135], v[168:171], v[56:59]
    ds_read_b64_tr_b16 v[98:99], v236 offset:32384
    v_mfma_f32_16x16x32_bf16 v[52:55], v[132:135], v[164:167], v[52:55]
    ds_read_b64_tr_b16 v[108:109], v236 offset:43200
    v_mfma_f32_16x16x32_bf16 v[48:51], v[132:135], v[160:163], v[48:51]
    s_add_u32 m0, s19, 87424
    s_nop 0
    buffer_load_dwordx4 v229, s[8:11], s16 offen lds
    v_mfma_f32_16x16x32_bf16 v[16:19], v[124:127], v[160:163], v[16:19]
    ds_read_b64_tr_b16 v[110:111], v236 offset:46784
    v_mfma_f32_16x16x32_bf16 v[20:23], v[124:127], v[164:167], v[20:23]
    ds_read_b64_tr_b16 v[100:101], v236 offset:28832
    v_mfma_f32_16x16x32_bf16 v[24:27], v[124:127], v[168:171], v[24:27]
    ds_read_b64_tr_b16 v[102:103], v236 offset:32416
    v_mfma_f32_16x16x32_bf16 v[28:31], v[124:127], v[172:175], v[28:31]
    s_add_u32 m0, s19, 88448
    s_nop 0
    buffer_load_dwordx4 v230, s[8:11], s16 offen lds
    s_add_u32 s16, s16, 229376
    s_cmp_eq_u32 s16, s18
    s_cselect_b32 s16, s17, s16
    v_mfma_f32_16x16x32_bf16 v[76:79], v[136:139], v[172:175], v[76:79]
    ds_read_b64_tr_b16 v[112:113], v236 offset:43232
    v_mfma_f32_16x16x32_bf16 v[72:75], v[136:139], v[168:171], v[72:75]
    ds_read_b64_tr_b16 v[114:115], v236 offset:46816
    v_mfma_f32_16x16x32_bf16 v[68:71], v[136:139], v[164:167], v[68:71]
    ds_read_b64_tr_b16 v[104:105], v238 offset:28800
    v_mfma_f32_16x16x32_bf16 v[64:67], v[136:139], v[160:163], v[64:67]
    s_add_u32 m0, s23, 16384
    s_nop 0
    buffer_load_dwordx4 v249, s[80:83], s20 offen sc1 lds
    v_mfma_f32_16x16x32_bf16 v[32:35], v[128:131], v[160:163], v[32:35]
    ds_read_b64_tr_b16 v[106:107], v238 offset:32384
    v_mfma_f32_16x16x32_bf16 v[36:39], v[128:131], v[164:167], v[36:39]
    ds_read_b64_tr_b16 v[116:117], v238 offset:43200
    v_mfma_f32_16x16x32_bf16 v[40:43], v[128:131], v[168:171], v[40:43]
    ds_read_b64_tr_b16 v[118:119], v238 offset:46784
    v_mfma_f32_16x16x32_bf16 v[44:47], v[128:131], v[172:175], v[44:47]
    s_add_u32 m0, s23, 16384
    s_nop 0
    buffer_load_dwordx4 v249, s[80:83], s20 offen offset:1024 sc1 lds
    s_add_u32 s20, s20, 8192
    s_cmp_eq_u32 s20, s22
    s_cselect_b32 s20, s21, s20
    v_mfma_f32_16x16x32_bf16 v[92:95], v[140:143], v[172:175], v[92:95]
    v_mfma_f32_16x16x32_bf16 v[88:91], v[140:143], v[168:171], v[88:91]
    v_mfma_f32_16x16x32_bf16 v[84:87], v[140:143], v[164:167], v[84:87]
    v_mfma_f32_16x16x32_bf16 v[80:83], v[140:143], v[160:163], v[80:83]
    s_sub_u32 s24, s24, 1
    s_cmp_lg_u32 s24, 0
    s_cbranch_scc1 g3c1_loop
    s_sub_u32 s27, s74, s58
    s_and_b32 s27, s27, 7
    s_cmp_lt_u32 s27, 4
    s_cselect_b32 s27, 14, 0
    s_waitcnt vmcnt(5) lgkmcnt(0)
    s_barrier
    v_mfma_f32_16x16x32_bf16 v[0:3], v[96:99], v[144:147], v[0:3]
    ds_read_b128 v[160:163], v235 offset:8192
    ds_read_b128 v[164:167], v235 offset:9216
    v_mfma_f32_16x16x32_bf16 v[4:7], v[96:99], v[148:151], v[4:7]
    s_and_b32 s26, s3, 1
    s_mul_i32 s26, s26, 14336
    s_mul_i32 s65, s74, 896
    s_add_u32 s26, s26, s65
    s_lshr_b32 s65, s69, 1
    s_mul_i32 s65, s65, 448
    s_add_u32 s26, s26, s65
    s_add_u32 s26, s26, 74448896
    v_and_b32 v225, 31, v250
    v_min_u32 v225, 27, v225
    v_lshlrev_b32 v225, 4, v225
    v_lshrrev_b32 v253, 5, v250
    v_mul_u32_u24 v253, 229376, v253
    v_add_u32 v225, v253, v225
    v_mfma_f32_16x16x32_bf16 v[8:11], v[96:99], v[152:155], v[8:11]
    ds_read_b128 v[168:171], v235 offset:10240
    s_cmp_lg_u32 s75, 0
    s_cbranch_scc1 cl_1649_0
    buffer_load_dwordx4 v[176:179], v225, s[80:83], s26 offen sc1
    s_add_u32 s26, s26, 28672
cl_1649_0:
    v_mfma_f32_16x16x32_bf16 v[12:15], v[96:99], v[156:159], v[12:15]
    ds_read_b128 v[172:175], v235 offset:11264
    v_mfma_f32_16x16x32_bf16 v[60:63], v[108:111], v[156:159], v[60:63]
    s_cmp_lg_u32 s75, 0
    s_cbranch_scc1 cl_1649_1
    buffer_load_dwordx4 v[180:183], v225, s[80:83], s26 offen sc1
    s_add_u32 s26, s26, 28672
cl_1649_1:
    ds_read_b64_tr_b16 v[120:121], v237 offset:0
    v_mfma_f32_16x16x32_bf16 v[56:59], v[108:111], v[152:155], v[56:59]
    s_cmp_lg_u32 s75, 0
    s_cbranch_scc1 cl_1649_2
    buffer_load_dwordx4 v[184:187], v225, s[80:83], s26 offen sc1
    s_add_u32 s26, s26, 28672
cl_1649_2:
    v_mfma_f32_16x16x32_bf16 v[52:55], v[108:111], v[148:151], v[52:55]
    ds_read_b64_tr_b16 v[122:123], v237 offset:3584
    s_cmp_lg_u32 s75, 0
    s_cbranch_scc1 cl_1649_3
    buffer_load_dwordx4 v[188:191], v225, s[80:83], s26 offen sc1
    s_add_u32 s26, s26, 28672
cl_1649_3:
    v_mfma_f32_16x16x32_bf16 v[48:51], v[108:111], v[144:147], v[48:51]
    ds_read_b64_tr_b16 v[132:133], v237 offset:14400
    v_mfma_f32_16x16x32_bf16 v[16:19], v[100:103], v[144:147], v[16:19]
    s_cmp_lg_u32 s75, 0
    s_cbranch_scc1 cl_1649_4
    buffer_load_dwordx4 v[192:195], v225, s[80:83], s26 offen sc1
    s_add_u32 s26, s26, 28672
cl_1649_4:
    ds_read_b64_tr_b16 v[134:135], v237 offset:17984
    v_mfma_f32_16x16x32_bf16 v[20:23], v[100:103], v[148:151], v[20:23]
    s_cmp_lg_u32 s75, 0
    s_cbranch_scc1 cl_1649_5
    buffer_load_dwordx4 v[196:199], v225, s[80:83], s26 offen sc1
    s_add_u32 s26, s26, 28672
cl_1649_5:
    v_mfma_f32_16x16x32_bf16 v[24:27], v[100:103], v[152:155], v[24:27]
    ds_read_b64_tr_b16 v[124:125], v237 offset:32
    ds_read_b64_tr_b16 v[126:127], v237 offset:3616
    v_mfma_f32_16x16x32_bf16 v[28:31], v[100:103], v[156:159], v[28:31]
    s_cmp_lg_u32 s75, 0
    s_cbranch_scc1 cl_1649_6
    buffer_load_dwordx4 v[200:203], v225, s[80:83], s26 offen sc1
    s_add_u32 s26, s26, 28672
cl_1649_6:
    v_mfma_f32_16x16x32_bf16 v[76:79], v[112:115], v[156:159], v[76:79]
    ds_read_b64_tr_b16 v[136:137], v237 offset:14432
    s_cmp_lg_u32 s75, 0
    s_cbranch_scc1 cl_1649_7
    buffer_load_dwordx4 v[204:207], v225, s[80:83], s26 offen sc1
    s_add_u32 s26, s26, 28672
cl_1649_7:
    v_mfma_f32_16x16x32_bf16 v[72:75], v[112:115], v[152:155], v[72:75]
    ds_read_b64_tr_b16 v[138:139], v237 offset:18016
    v_mfma_f32_16x16x32_bf16 v[68:71], v[112:115], v[148:151], v[68:71]
    s_add_u32 m0, s19, 0
    s_nop 0
    buffer_load_dwordx4 v228, s[8:11], s16 offen lds
    ds_read_b64_tr_b16 v[128:129], v239 offset:0
    v_mfma_f32_16x16x32_bf16 v[64:67], v[112:115], v[144:147], v[64:67]
    s_add_u32 m0, s19, 1024
    s_nop 0
    buffer_load_dwordx4 v229, s[8:11], s16 offen lds
    v_mfma_f32_16x16x32_bf16 v[32:35], v[104:107], v[144:147], v[32:35]
    ds_read_b64_tr_b16 v[130:131], v239 offset:3584
    s_add_u32 m0, s19, 2048
    s_nop 0
    buffer_load_dwordx4 v230, s[8:11], s16 offen lds
    s_add_u32 s16, s16, 229376
    s_cmp_eq_u32 s16, s18
    s_cselect_b32 s16, s17, s16
    v_mfma_f32_16x16x32_bf16 v[36:39], v[104:107], v[148:151], v[36:39]
    ds_read_b64_tr_b16 v[140:141], v239 offset:14400
    v_mfma_f32_16x16x32_bf16 v[40:43], v[104:107], v[152:155], v[40:43]
    s_add_u32 m0, s23, 24576
    s_nop 0
    buffer_load_dwordx4 v249, s[80:83], s20 offen sc1 lds
    ds_read_b64_tr_b16 v[142:143], v239 offset:17984
    v_mfma_f32_16x16x32_bf16 v[44:47], v[104:107], v[156:159], v[44:47]
    s_add_u32 m0, s23, 24576
    s_nop 0
    buffer_load_dwordx4 v249, s[80:83], s20 offen offset:1024 sc1 lds
    s_add_u32 s20, s20, 8192
    s_cmp_eq_u32 s20, s22
    s_cselect_b32 s20, s21, s20
    v_mfma_f32_16x16x32_bf16 v[92:95], v[116:119], v[156:159], v[92:95]
    v_mfma_f32_16x16x32_bf16 v[88:91], v[116:119], v[152:155], v[88:91]
    v_mfma_f32_16x16x32_bf16 v[84:87], v[116:119], v[148:151], v[84:87]
    v_mfma_f32_16x16x32_bf16 v[80:83], v[116:119], v[144:147], v[80:83]
    s_waitcnt vmcnt(5) lgkmcnt(0)
    s_barrier
    v_mfma_f32_16x16x32_bf16 v[0:3], v[120:123], v[160:163], v[0:3]
    ds_read_b128 v[144:147], v235 offset:16384
    v_add_f32 v176, v176, v192
    v_add_f32 v177, v177, v193
    v_add_f32 v178, v178, v194
    v_mfma_f32_16x16x32_bf16 v[4:7], v[120:123], v[164:167], v[4:7]
    ds_read_b128 v[148:151], v235 offset:17408
    v_add_f32 v179, v179, v195
    v_add_f32 v180, v180, v196
    v_add_f32 v181, v181, v197
    v_mfma_f32_16x16x32_bf16 v[8:11], v[120:123], v[168:171], v[8:11]
    ds_read_b128 v[152:155], v235 offset:18432
    v_add_f32 v182, v182, v198
    v_add_f32 v183, v183, v199
    v_mfma_f32_16x16x32_bf16 v[12:15], v[120:123], v[172:175], v[12:15]
    ds_read_b128 v[156:159], v235 offset:19456
    v_add_f32 v184, v184, v200
    v_add_f32 v185, v185, v201
    v_add_f32 v186, v186, v202
    v_mfma_f32_16x16x32_bf16 v[60:63], v[132:135], v[172:175], v[60:63]
    v_add_f32 v187, v187, v203
    v_add_f32 v188, v188, v204
    v_mfma_f32_16x16x32_bf16 v[56:59], v[132:135], v[168:171], v[56:59]
    ds_read_b64_tr_b16 v[96:97], v237 offset:28800
    v_add_f32 v189, v189, v205
    v_add_f32 v190, v190, v206
    v_add_f32 v191, v191, v207
    v_mfma_f32_16x16x32_bf16 v[52:55], v[132:135], v[164:167], v[52:55]
    ds_read_b64_tr_b16 v[98:99], v237 offset:32384
    v_add_f32 v176, v176, v184
    v_add_f32 v177, v177, v185
    v_lshlrev_b32 v247, 7, v250
    s_add_u32 s29, s3, 0
    s_lshl_b32 s30, s29, 12
    s_add_u32 s30, s30, s25
    s_cmp_lt_u32 s29, s27
    s_cselect_b32 s30, s30, 0x7f000000
    s_mov_b64 exec, 0xffffffff
    buffer_load_dword v248, v247, s[80:83], s30 offen sc1
    s_mov_b64 exec, -1
    v_mfma_f32_16x16x32_bf16 v[48:51], v[132:135], v[160:163], v[48:51]
    ds_read_b64_tr_b16 v[108:109], v237 offset:43200
    v_add_f32 v178, v178, v186
    v_add_f32 v179, v179, v187
    v_add_f32 v180, v180, v188
    v_mfma_f32_16x16x32_bf16 v[16:19], v[124:127], v[160:163], v[16:19]
    ds_read_b64_tr_b16 v[110:111], v237 offset:46784
    v_add_f32 v181, v181, v189
    v_add_f32 v182, v182, v190
    v_mfma_f32_16x16x32_bf16 v[20:23], v[124:127], v[164:167], v[20:23]
    v_add_f32 v183, v183, v191
    v_add_f32 v176, v176, v180
    v_add_f32 v177, v177, v181
    v_mfma_f32_16x16x32_bf16 v[24:27], v[124:127], v[168:171], v[24:27]
    ds_read_b64_tr_b16 v[100:101], v237 offset:28832
    v_add_f32 v178, v178, v182
    v_add_f32 v179, v179, v183
    v_mfma_f32_16x16x32_bf16 v[28:31], v[124:127], v[172:175], v[28:31]
    ds_read_b64_tr_b16 v[102:103], v237 offset:32416
    v_mov_b32 v180, v176
    v_mov_b32 v181, v177
    v_mov_b32 v182, v178
    v_mfma_f32_16x16x32_bf16 v[76:79], v[136:139], v[172:175], v[76:79]
    ds_read_b64_tr_b16 v[112:113], v237 offset:43232
    v_mov_b32 v183, v179
    s_nop 1
    v_permlane32_swap_b32 v176, v180
    v_mfma_f32_16x16x32_bf16 v[72:75], v[136:139], v[168:171], v[72:75]
    ds_read_b64_tr_b16 v[114:115], v237 offset:46816
    v_permlane32_swap_b32 v177, v181
    v_permlane32_swap_b32 v178, v182
    v_mfma_f32_16x16x32_bf16 v[68:71], v[136:139], v[164:167], v[68:71]
    v_permlane32_swap_b32 v179, v183
    v_add_f32 v176, v176, v180
    v_add_f32 v177, v177, v181
    v_mfma_f32_16x16x32_bf16 v[64:67], v[136:139], v[160:163], v[64:67]
    ds_read_b64_tr_b16 v[104:105], v239 offset:28800
    v_add_f32 v178, v178, v182
    v_add_f32 v179, v179, v183
    v_mfma_f32_16x16x32_bf16 v[32:35], v[128:131], v[160:163], v[32:35]
    ds_read_b64_tr_b16 v[106:107], v239 offset:32384
    s_and_b32 s64, s3, 1
    s_mul_i32 s64, s64, 896
    s_lshr_b32 s65, s69, 1
    s_mul_i32 s65, s65, 448
    s_add_u32 s64, s64, s65
    s_add_u32 s64, s64, 160896
    v_add_u32 v225, s64, v249
    s_cmp_lg_u32 s75, 0
    s_cbranch_scc1 g3c1_ncs
    s_mov_b64 exec, 0x0fffffff
    ds_write_b128 v225, v[176:179]
    s_mov_b64 exec, -1
g3c1_ncs:
    s_mov_b32 s12, s96
    s_mov_b32 s13, s97
    v_mfma_f32_16x16x32_bf16 v[36:39], v[128:131], v[164:167], v[36:39]
    ds_read_b64_tr_b16 v[116:117], v239 offset:43200
    s_mov_b32 s14, 7340032
    s_mov_b32 s15, 0x00020000
    v_mfma_f32_16x16x32_bf16 v[40:43], v[128:131], v[168:171], v[40:43]
    ds_read_b64_tr_b16 v[118:119], v239 offset:46784
    v_lshlrev_b32 v253, 14, v251
    v_and_b32 v254, 8, v252
    v_lshl_add_u32 v253, v254, 7, v253
    v_mfma_f32_16x16x32_bf16 v[44:47], v[128:131], v[172:175], v[44:47]
    v_and_b32 v254, 7, v252
    v_lshl_add_u32 v253, v254, 4, v253
    v_mfma_f32_16x16x32_bf16 v[92:95], v[140:143], v[172:175], v[92:95]
    s_lshl_b32 s64, s69, 12
    v_add_u32 v244, s64, v253
    v_add_u32 v245, 2048, v244
    v_lshlrev_b32 v247, 7, v250
    s_add_u32 s29, s3, 8
    s_lshl_b32 s30, s29, 12
    s_add_u32 s30, s30, s25
    s_cmp_lt_u32 s29, s27
    s_cselect_b32 s30, s30, 0x7f000000
    s_mov_b64 exec, 0xffffffff
    buffer_load_dword v248, v247, s[80:83], s30 offen sc1
    s_mov_b64 exec, -1
    v_mfma_f32_16x16x32_bf16 v[88:91], v[140:143], v[168:171], v[88:91]
    s_mul_i32 s51, s69, 2112
    s_lshr_b32 s64, s74, 3
    v_mfma_f32_16x16x32_bf16 v[84:87], v[140:143], v[164:167], v[84:87]
    s_mul_i32 s49, s64, 3670016
    s_lshl_b32 s65, s61, 7
    s_add_u32 s49, s49, s65
    v_mfma_f32_16x16x32_bf16 v[80:83], v[140:143], v[160:163], v[80:83]
    s_sub_u32 s50, s74, s58
    s_and_b32 s50, s50, 7
    s_waitcnt vmcnt(2) lgkmcnt(0)
    s_barrier
    s_setprio 1
    ds_read_b128 v[160:163], v235 offset:24576
    ds_read_b128 v[164:167], v235 offset:25600
    ds_read_b128 v[168:171], v235 offset:26624
    ds_read_b128 v[172:175], v235 offset:27648
    ds_read_b64_tr_b16 v[120:121], v236 offset:0
    ds_read_b64_tr_b16 v[122:123], v236 offset:3584
    ds_read_b64_tr_b16 v[132:133], v236 offset:14400
    ds_read_b64_tr_b16 v[134:135], v236 offset:17984
    ds_read_b64_tr_b16 v[124:125], v236 offset:32
    ds_read_b64_tr_b16 v[126:127], v236 offset:3616
    ds_read_b64_tr_b16 v[136:137], v236 offset:14432
    ds_read_b64_tr_b16 v[138:139], v236 offset:18016
    ds_read_b64_tr_b16 v[128:129], v238 offset:0
    ds_read_b64_tr_b16 v[130:131], v238 offset:3584
    ds_read_b64_tr_b16 v[140:141], v238 offset:14400
    ds_read_b64_tr_b16 v[142:143], v238 offset:17984
    s_waitcnt lgkmcnt(0)
    s_and_b32 s48, s74, 7
    s_mul_i32 s48, s48, 458752
    s_add_u32 s48, s48, s49
    s_add_u32 m0, s51, 107776
    s_nop 0
    buffer_load_dwordx4 v244, s[12:15], s48 offen lds
    s_add_u32 m0, s51, 108832
    s_nop 0
    buffer_load_dwordx4 v245, s[12:15], s48 offen lds
    s_add_u32 s48, s48, 65536
    s_barrier
    s_add_u32 m0, s51, 116224
    s_nop 0
    buffer_load_dwordx4 v244, s[12:15], s48 offen lds
    s_add_u32 m0, s51, 117280
    s_nop 0
    buffer_load_dwordx4 v245, s[12:15], s48 offen lds
    s_add_u32 s48, s48, 65536
    s_add_u32 m0, s51, 124672
    s_nop 0
    buffer_load_dwordx4 v244, s[12:15], s48 offen lds
    s_add_u32 m0, s51, 125728
    s_nop 0
    buffer_load_dwordx4 v245, s[12:15], s48 offen lds
    s_add_u32 s48, s48, 65536
    s_add_u32 m0, s51, 133120
    s_nop 0
    buffer_load_dwordx4 v244, s[12:15], s48 offen lds
    s_add_u32 m0, s51, 134176
    s_nop 0
    buffer_load_dwordx4 v245, s[12:15], s48 offen lds
    s_add_u32 s48, s48, 65536
    v_mfma_f32_16x16x32_bf16 v[0:3], v[96:99], v[144:147], v[0:3]
    s_add_u32 m0, s51, 141568
    s_nop 0
    buffer_load_dwordx4 v244, s[12:15], s48 offen lds
    v_mfma_f32_16x16x32_bf16 v[4:7], v[96:99], v[148:151], v[4:7]
    v_mfma_f32_16x16x32_bf16 v[8:11], v[96:99], v[152:155], v[8:11]
    v_mfma_f32_16x16x32_bf16 v[12:15], v[96:99], v[156:159], v[12:15]
    v_mfma_f32_16x16x32_bf16 v[60:63], v[108:111], v[156:159], v[60:63]
    s_add_u32 m0, s51, 142624
    s_nop 0
    buffer_load_dwordx4 v245, s[12:15], s48 offen lds
    s_add_u32 s48, s48, 65536
    v_mfma_f32_16x16x32_bf16 v[56:59], v[108:111], v[152:155], v[56:59]
    v_mfma_f32_16x16x32_bf16 v[52:55], v[108:111], v[148:151], v[52:55]
    v_mfma_f32_16x16x32_bf16 v[48:51], v[108:111], v[144:147], v[48:51]
    v_mfma_f32_16x16x32_bf16 v[16:19], v[100:103], v[144:147], v[16:19]
    s_add_u32 m0, s51, 65536
    s_nop 0
    buffer_load_dwordx4 v244, s[12:15], s48 offen lds
    v_mfma_f32_16x16x32_bf16 v[20:23], v[100:103], v[148:151], v[20:23]
    v_mfma_f32_16x16x32_bf16 v[24:27], v[100:103], v[152:155], v[24:27]
    v_mfma_f32_16x16x32_bf16 v[28:31], v[100:103], v[156:159], v[28:31]
    v_mfma_f32_16x16x32_bf16 v[76:79], v[112:115], v[156:159], v[76:79]
    s_add_u32 m0, s51, 66592
    s_nop 0
    buffer_load_dwordx4 v245, s[12:15], s48 offen lds
    s_add_u32 s48, s48, 65536
    v_mfma_f32_16x16x32_bf16 v[72:75], v[112:115], v[152:155], v[72:75]
    v_mfma_f32_16x16x32_bf16 v[68:71], v[112:115], v[148:151], v[68:71]
    v_mfma_f32_16x16x32_bf16 v[64:67], v[112:115], v[144:147], v[64:67]
    v_mfma_f32_16x16x32_bf16 v[32:35], v[104:107], v[144:147], v[32:35]
    s_add_u32 m0, s51, 73984
    s_nop 0
    buffer_load_dwordx4 v244, s[12:15], s48 offen lds
    v_mfma_f32_16x16x32_bf16 v[36:39], v[104:107], v[148:151], v[36:39]
    v_mfma_f32_16x16x32_bf16 v[40:43], v[104:107], v[152:155], v[40:43]
    v_mfma_f32_16x16x32_bf16 v[44:47], v[104:107], v[156:159], v[44:47]
    v_mfma_f32_16x16x32_bf16 v[92:95], v[116:119], v[156:159], v[92:95]
    s_add_u32 m0, s51, 75040
    s_nop 0
    buffer_load_dwordx4 v245, s[12:15], s48 offen lds
    s_add_u32 s48, s48, 65536
    v_mfma_f32_16x16x32_bf16 v[88:91], v[116:119], v[152:155], v[88:91]
    v_mfma_f32_16x16x32_bf16 v[84:87], v[116:119], v[148:151], v[84:87]
    v_mfma_f32_16x16x32_bf16 v[80:83], v[116:119], v[144:147], v[80:83]
    s_and_b32 s64, s3, 1
    s_lshl_b32 s64, s64, 9
    s_add_u32 s64, s64, 159744
    v_lshlrev_b32 v253, 3, v252
    v_add_u32 v253, s64, v253
    s_lshl_b32 s64, s28, 6
    s_add_u32 s64, s64, 160896
    v_lshlrev_b32 v254, 4, v251
    v_add_u32 v235, s64, v254
    s_lshr_b32 s64, s69, 1
    s_add_u32 s64, s64, 10
    s_lshl_b32 s64, s64, 6
    s_add_u32 s64, s64, 160896
    v_add_u32 v238, s64, v254
    v_mfma_f32_16x16x32_bf16 v[0:3], v[120:123], v[160:163], v[0:3]
    ds_read_b64 v[144:145], v253 offset:0
    s_cmp_le_u32 s50, 0
    s_addc_u32 s48, s58, 0
    s_and_b32 s48, s48, 7
    s_mul_i32 s48, s48, 458752
    s_add_u32 s48, s48, s49
    s_add_u32 m0, s51, 82432
    s_nop 0
    buffer_load_dwordx4 v244, s[12:15], s48 offen lds
    v_mfma_f32_16x16x32_bf16 v[4:7], v[120:123], v[164:167], v[4:7]
    ds_read_b64 v[146:147], v253 offset:128
    v_mfma_f32_16x16x32_bf16 v[8:11], v[120:123], v[168:171], v[8:11]
    ds_read_b64 v[148:149], v253 offset:256
    v_mfma_f32_16x16x32_bf16 v[12:15], v[120:123], v[172:175], v[12:15]
    ds_read_b64 v[150:151], v253 offset:384
    s_add_u32 m0, s51, 83488
    s_nop 0
    buffer_load_dwordx4 v245, s[12:15], s48 offen lds
    s_add_u32 s48, s48, 65536
    v_mfma_f32_16x16x32_bf16 v[60:63], v[132:135], v[172:175], v[60:63]
    v_mfma_f32_16x16x32_bf16 v[56:59], v[132:135], v[168:171], v[56:59]
    ds_read_b128 v[96:99], v235 offset:0
    v_mfma_f32_16x16x32_bf16 v[52:55], v[132:135], v[164:167], v[52:55]
    ds_read_b128 v[100:103], v235 offset:64
    v_mfma_f32_16x16x32_bf16 v[48:51], v[132:135], v[160:163], v[48:51]
    ds_read_b128 v[104:107], v238 offset:0
    s_add_u32 m0, s51, 90880
    s_nop 0
    buffer_load_dwordx4 v244, s[12:15], s48 offen lds
    v_mfma_f32_16x16x32_bf16 v[16:19], v[124:127], v[160:163], v[16:19]
    v_mfma_f32_16x16x32_bf16 v[20:23], v[124:127], v[164:167], v[20:23]
    ds_read_b128 v[108:111], v235 offset:896
    v_mfma_f32_16x16x32_bf16 v[24:27], v[124:127], v[168:171], v[24:27]
    ds_read_b128 v[112:115], v235 offset:960
    v_mfma_f32_16x16x32_bf16 v[28:31], v[124:127], v[172:175], v[28:31]
    ds_read_b128 v[116:119], v238 offset:896
    s_add_u32 m0, s51, 91936
    s_nop 0
    buffer_load_dwordx4 v245, s[12:15], s48 offen lds
    s_add_u32 s48, s48, 65536
    v_mfma_f32_16x16x32_bf16 v[76:79], v[136:139], v[172:175], v[76:79]
    v_mfma_f32_16x16x32_bf16 v[72:75], v[136:139], v[168:171], v[72:75]
    v_mfma_f32_16x16x32_bf16 v[68:71], v[136:139], v[164:167], v[68:71]
    v_mfma_f32_16x16x32_bf16 v[64:67], v[136:139], v[160:163], v[64:67]
    s_add_u32 m0, s51, 99328
    s_nop 0
    buffer_load_dwordx4 v244, s[12:15], s48 offen lds
    v_mfma_f32_16x16x32_bf16 v[32:35], v[128:131], v[160:163], v[32:35]
    v_mfma_f32_16x16x32_bf16 v[36:39], v[128:131], v[164:167], v[36:39]
    v_mfma_f32_16x16x32_bf16 v[40:43], v[128:131], v[168:171], v[40:43]
    v_mfma_f32_16x16x32_bf16 v[44:47], v[128:131], v[172:175], v[44:47]
    s_add_u32 m0, s51, 100384
    s_nop 0
    buffer_load_dwordx4 v245, s[12:15], s48 offen lds
    s_add_u32 s48, s48, 65536
    v_mfma_f32_16x16x32_bf16 v[92:95], v[140:143], v[172:175], v[92:95]
    v_mfma_f32_16x16x32_bf16 v[88:91], v[140:143], v[168:171], v[88:91]
    v_mfma_f32_16x16x32_bf16 v[84:87], v[140:143], v[164:167], v[84:87]
    v_mfma_f32_16x16x32_bf16 v[80:83], v[140:143], v[160:163], v[80:83]
    s_and_b32 s64, s3, 1
    s_lshl_b32 s64, s64, 12
    s_add_u32 s25, s25, s64
    s_lshr_b32 s64, s69, 1
    s_lshl_b32 s65, s64, 3
    s_add_u32 s26, s25, s65
    s_add_u32 s26, s26, 40960
    s_lshl_b32 s64, s64, 14
    s_add_u32 s25, s25, s64
    s_add_u32 s25, s25, 32768
    s_and_b32 s64, s3, 1
    s_lshl_b32 s64, s64, 12
    s_lshr_b32 s65, s69, 1
    s_lshl_b32 s66, s65, 3
    s_add_u32 s66, s66, s64
    s_add_u32 s66, s66, 32768
    v_add_u32 v237, s66, v249
    s_lshl_b32 s65, s65, 14
    s_add_u32 s64, s64, s65
    s_add_u32 s64, s64, 24576
    v_add_u32 v236, s64, v249
    s_waitcnt lgkmcnt(0)
    s_mov_b32 s64, 0xbfb8aa3b
    v_mul_f32 v136, v145, v145
    v_sub_f32 v120, 0, v144
    v_mul_f32 v128, s64, v145
    v_sub_f32 v121, 0, v144
    v_mul_f32 v129, s64, v145
    v_mul_f32 v138, v147, v147
    v_sub_f32 v122, 0, v146
    v_mul_f32 v130, s64, v147
    v_sub_f32 v123, 0, v146
    v_mul_f32 v131, s64, v147
    v_mul_f32 v140, v149, v149
    v_sub_f32 v124, 0, v148
    v_mul_f32 v132, s64, v149
    v_sub_f32 v125, 0, v148
    v_mul_f32 v133, s64, v149
    v_mul_f32 v142, v151, v151
    v_sub_f32 v126, 0, v150
    v_mul_f32 v134, s64, v151
    v_sub_f32 v127, 0, v150
    v_mul_f32 v135, s64, v151
    v_rcp_f32 v137, v136
    v_rcp_f32 v136, v136
    v_rcp_f32 v139, v138
    v_rcp_f32 v138, v138
    v_rcp_f32 v141, v140
    v_rcp_f32 v140, v140
    v_rcp_f32 v143, v142
    v_rcp_f32 v142, v142
    v_pk_fma_f32 v[0:1], v[120:121], v[96:97], v[0:1]
    v_pk_fma_f32 v[2:3], v[120:121], v[98:99], v[2:3]
    v_pk_fma_f32 v[16:17], v[120:121], v[100:101], v[16:17]
    v_pk_fma_f32 v[18:19], v[120:121], v[102:103], v[18:19]
    v_pk_fma_f32 v[32:33], v[120:121], v[104:105], v[32:33]
    v_pk_fma_f32 v[34:35], v[120:121], v[106:107], v[34:35]
    v_pk_mul_f32 v[152:153], v[128:129], v[0:1]
    v_pk_mul_f32 v[154:155], v[128:129], v[2:3]
    v_pk_mul_f32 v[156:157], v[128:129], v[16:17]
    v_pk_mul_f32 v[158:159], v[128:129], v[18:19]
    v_pk_mul_f32 v[160:161], v[128:129], v[32:33]
    v_pk_mul_f32 v[162:163], v[128:129], v[34:35]
    v_exp_f32 v152, v152
    v_exp_f32 v153, v153
    v_exp_f32 v154, v154
    v_exp_f32 v155, v155
    v_exp_f32 v156, v156
    v_exp_f32 v157, v157
    v_exp_f32 v158, v158
    v_exp_f32 v159, v159
    v_exp_f32 v160, v160
    v_exp_f32 v161, v161
    v_exp_f32 v162, v162
    v_exp_f32 v163, v163
    v_pk_fma_f32 v[48:49], v[120:121], v[108:109], v[48:49]
    v_pk_fma_f32 v[50:51], v[120:121], v[110:111], v[50:51]
    v_pk_fma_f32 v[64:65], v[120:121], v[112:113], v[64:65]
    v_pk_fma_f32 v[66:67], v[120:121], v[114:115], v[66:67]
    v_pk_fma_f32 v[80:81], v[120:121], v[116:117], v[80:81]
    v_pk_fma_f32 v[82:83], v[120:121], v[118:119], v[82:83]
    v_pk_fma_f32 v[152:153], v[152:153], v[136:137], v[136:137]
    v_pk_fma_f32 v[154:155], v[154:155], v[136:137], v[136:137]
    v_pk_fma_f32 v[156:157], v[156:157], v[136:137], v[136:137]
    v_pk_fma_f32 v[158:159], v[158:159], v[136:137], v[136:137]
    v_pk_fma_f32 v[160:161], v[160:161], v[136:137], v[136:137]
    v_pk_fma_f32 v[162:163], v[162:163], v[136:137], v[136:137]
    v_rcp_f32 v152, v152
    v_rcp_f32 v153, v153
    v_rcp_f32 v154, v154
    v_rcp_f32 v155, v155
    v_rcp_f32 v156, v156
    v_rcp_f32 v157, v157
    v_rcp_f32 v158, v158
    v_rcp_f32 v159, v159
    v_rcp_f32 v160, v160
    v_rcp_f32 v161, v161
    v_rcp_f32 v162, v162
    v_rcp_f32 v163, v163
    v_pk_mul_f32 v[0:1], v[0:1], v[48:49]
    v_pk_mul_f32 v[2:3], v[2:3], v[50:51]
    v_pk_mul_f32 v[16:17], v[16:17], v[64:65]
    v_pk_mul_f32 v[18:19], v[18:19], v[66:67]
    v_pk_mul_f32 v[32:33], v[32:33], v[80:81]
    v_pk_mul_f32 v[34:35], v[34:35], v[82:83]
    v_pk_mul_f32 v[0:1], v[0:1], v[152:153]
    v_pk_mul_f32 v[2:3], v[2:3], v[154:155]
    v_pk_mul_f32 v[16:17], v[16:17], v[156:157]
    v_pk_mul_f32 v[18:19], v[18:19], v[158:159]
    v_pk_mul_f32 v[32:33], v[32:33], v[160:161]
    v_pk_mul_f32 v[34:35], v[34:35], v[162:163]
    v_cvt_pk_bf16_f32 v168, v0, v1
    v_cvt_pk_bf16_f32 v169, v2, v3
    v_cvt_pk_bf16_f32 v170, v16, v17
    v_cvt_pk_bf16_f32 v171, v18, v19
    v_cvt_pk_bf16_f32 v172, v32, v33
    v_cvt_pk_bf16_f32 v173, v34, v35
    buffer_store_dwordx4 v[168:171], v249, s[80:83], s25 offen offset:0
    ds_write_b128 v236, v[168:171] offset:0
    buffer_store_dwordx2 v[172:173], v249, s[80:83], s26 offen offset:0
    ds_write_b64 v237, v[172:173] offset:0
    v_pk_fma_f32 v[4:5], v[122:123], v[96:97], v[4:5]
    v_pk_fma_f32 v[6:7], v[122:123], v[98:99], v[6:7]
    v_pk_fma_f32 v[20:21], v[122:123], v[100:101], v[20:21]
    v_pk_fma_f32 v[22:23], v[122:123], v[102:103], v[22:23]
    v_pk_fma_f32 v[36:37], v[122:123], v[104:105], v[36:37]
    v_pk_fma_f32 v[38:39], v[122:123], v[106:107], v[38:39]
    v_pk_mul_f32 v[152:153], v[130:131], v[4:5]
    v_pk_mul_f32 v[154:155], v[130:131], v[6:7]
    v_pk_mul_f32 v[156:157], v[130:131], v[20:21]
    v_pk_mul_f32 v[158:159], v[130:131], v[22:23]
    v_pk_mul_f32 v[160:161], v[130:131], v[36:37]
    v_pk_mul_f32 v[162:163], v[130:131], v[38:39]
    v_exp_f32 v152, v152
    v_exp_f32 v153, v153
    v_exp_f32 v154, v154
    v_exp_f32 v155, v155
    v_exp_f32 v156, v156
    v_exp_f32 v157, v157
    v_exp_f32 v158, v158
    v_exp_f32 v159, v159
    v_exp_f32 v160, v160
    v_exp_f32 v161, v161
    v_exp_f32 v162, v162
    v_exp_f32 v163, v163
    v_pk_fma_f32 v[52:53], v[122:123], v[108:109], v[52:53]
    v_pk_fma_f32 v[54:55], v[122:123], v[110:111], v[54:55]
    v_pk_fma_f32 v[68:69], v[122:123], v[112:113], v[68:69]
    v_pk_fma_f32 v[70:71], v[122:123], v[114:115], v[70:71]
    v_pk_fma_f32 v[84:85], v[122:123], v[116:117], v[84:85]
    v_pk_fma_f32 v[86:87], v[122:123], v[118:119], v[86:87]
    v_pk_fma_f32 v[152:153], v[152:153], v[138:139], v[138:139]
    v_pk_fma_f32 v[154:155], v[154:155], v[138:139], v[138:139]
    v_pk_fma_f32 v[156:157], v[156:157], v[138:139], v[138:139]
    v_pk_fma_f32 v[158:159], v[158:159], v[138:139], v[138:139]
    v_pk_fma_f32 v[160:161], v[160:161], v[138:139], v[138:139]
    v_pk_fma_f32 v[162:163], v[162:163], v[138:139], v[138:139]
    v_rcp_f32 v152, v152
    v_rcp_f32 v153, v153
    v_rcp_f32 v154, v154
    v_rcp_f32 v155, v155
    v_rcp_f32 v156, v156
    v_rcp_f32 v157, v157
    v_rcp_f32 v158, v158
    v_rcp_f32 v159, v159
    v_rcp_f32 v160, v160
    v_rcp_f32 v161, v161
    v_rcp_f32 v162, v162
    v_rcp_f32 v163, v163
    v_pk_mul_f32 v[4:5], v[4:5], v[52:53]
    v_pk_mul_f32 v[6:7], v[6:7], v[54:55]
    v_pk_mul_f32 v[20:21], v[20:21], v[68:69]
    v_pk_mul_f32 v[22:23], v[22:23], v[70:71]
    v_pk_mul_f32 v[36:37], v[36:37], v[84:85]
    v_pk_mul_f32 v[38:39], v[38:39], v[86:87]
    v_pk_mul_f32 v[4:5], v[4:5], v[152:153]
    v_pk_mul_f32 v[6:7], v[6:7], v[154:155]
    v_pk_mul_f32 v[20:21], v[20:21], v[156:157]
    v_pk_mul_f32 v[22:23], v[22:23], v[158:159]
    v_pk_mul_f32 v[36:37], v[36:37], v[160:161]
    v_pk_mul_f32 v[38:39], v[38:39], v[162:163]
    v_cvt_pk_bf16_f32 v168, v4, v5
    v_cvt_pk_bf16_f32 v169, v6, v7
    v_cvt_pk_bf16_f32 v170, v20, v21
    v_cvt_pk_bf16_f32 v171, v22, v23
    v_cvt_pk_bf16_f32 v172, v36, v37
    v_cvt_pk_bf16_f32 v173, v38, v39
    buffer_store_dwordx4 v[168:171], v249, s[80:83], s25 offen offset:1024
    ds_write_b128 v236, v[168:171] offset:1024
    buffer_store_dwordx2 v[172:173], v249, s[80:83], s26 offen offset:1024
    ds_write_b64 v237, v[172:173] offset:1024
    v_pk_fma_f32 v[8:9], v[124:125], v[96:97], v[8:9]
    v_pk_fma_f32 v[10:11], v[124:125], v[98:99], v[10:11]
    v_pk_fma_f32 v[24:25], v[124:125], v[100:101], v[24:25]
    v_pk_fma_f32 v[26:27], v[124:125], v[102:103], v[26:27]
    v_pk_fma_f32 v[40:41], v[124:125], v[104:105], v[40:41]
    v_pk_fma_f32 v[42:43], v[124:125], v[106:107], v[42:43]
    v_pk_mul_f32 v[152:153], v[132:133], v[8:9]
    v_pk_mul_f32 v[154:155], v[132:133], v[10:11]
    v_pk_mul_f32 v[156:157], v[132:133], v[24:25]
    v_pk_mul_f32 v[158:159], v[132:133], v[26:27]
    v_pk_mul_f32 v[160:161], v[132:133], v[40:41]
    v_pk_mul_f32 v[162:163], v[132:133], v[42:43]
    v_exp_f32 v152, v152
    v_exp_f32 v153, v153
    v_exp_f32 v154, v154
    v_exp_f32 v155, v155
    v_exp_f32 v156, v156
    v_exp_f32 v157, v157
    v_exp_f32 v158, v158
    v_exp_f32 v159, v159
    v_exp_f32 v160, v160
    v_exp_f32 v161, v161
    v_exp_f32 v162, v162
    v_exp_f32 v163, v163
    v_pk_fma_f32 v[56:57], v[124:125], v[108:109], v[56:57]
    v_pk_fma_f32 v[58:59], v[124:125], v[110:111], v[58:59]
    v_pk_fma_f32 v[72:73], v[124:125], v[112:113], v[72:73]
    v_pk_fma_f32 v[74:75], v[124:125], v[114:115], v[74:75]
    v_pk_fma_f32 v[88:89], v[124:125], v[116:117], v[88:89]
    v_pk_fma_f32 v[90:91], v[124:125], v[118:119], v[90:91]
    v_pk_fma_f32 v[152:153], v[152:153], v[140:141], v[140:141]
    v_pk_fma_f32 v[154:155], v[154:155], v[140:141], v[140:141]
    v_pk_fma_f32 v[156:157], v[156:157], v[140:141], v[140:141]
    v_pk_fma_f32 v[158:159], v[158:159], v[140:141], v[140:141]
    v_pk_fma_f32 v[160:161], v[160:161], v[140:141], v[140:141]
    v_pk_fma_f32 v[162:163], v[162:163], v[140:141], v[140:141]
    v_rcp_f32 v152, v152
    v_rcp_f32 v153, v153
    v_rcp_f32 v154, v154
    v_rcp_f32 v155, v155
    v_rcp_f32 v156, v156
    v_rcp_f32 v157, v157
    v_rcp_f32 v158, v158
    v_rcp_f32 v159, v159
    v_rcp_f32 v160, v160
    v_rcp_f32 v161, v161
    v_rcp_f32 v162, v162
    v_rcp_f32 v163, v163
    v_pk_mul_f32 v[8:9], v[8:9], v[56:57]
    v_pk_mul_f32 v[10:11], v[10:11], v[58:59]
    v_pk_mul_f32 v[24:25], v[24:25], v[72:73]
    v_pk_mul_f32 v[26:27], v[26:27], v[74:75]
    v_pk_mul_f32 v[40:41], v[40:41], v[88:89]
    v_pk_mul_f32 v[42:43], v[42:43], v[90:91]
    v_pk_mul_f32 v[8:9], v[8:9], v[152:153]
    v_pk_mul_f32 v[10:11], v[10:11], v[154:155]
    v_pk_mul_f32 v[24:25], v[24:25], v[156:157]
    v_pk_mul_f32 v[26:27], v[26:27], v[158:159]
    v_pk_mul_f32 v[40:41], v[40:41], v[160:161]
    v_pk_mul_f32 v[42:43], v[42:43], v[162:163]
    v_cvt_pk_bf16_f32 v168, v8, v9
    v_cvt_pk_bf16_f32 v169, v10, v11
    v_cvt_pk_bf16_f32 v170, v24, v25
    v_cvt_pk_bf16_f32 v171, v26, v27
    v_cvt_pk_bf16_f32 v172, v40, v41
    v_cvt_pk_bf16_f32 v173, v42, v43
    buffer_store_dwordx4 v[168:171], v249, s[80:83], s25 offen offset:2048
    ds_write_b128 v236, v[168:171] offset:2048
    buffer_store_dwordx2 v[172:173], v249, s[80:83], s26 offen offset:2048
    ds_write_b64 v237, v[172:173] offset:2048
    v_pk_fma_f32 v[12:13], v[126:127], v[96:97], v[12:13]
    v_pk_fma_f32 v[14:15], v[126:127], v[98:99], v[14:15]
    v_pk_fma_f32 v[28:29], v[126:127], v[100:101], v[28:29]
    v_pk_fma_f32 v[30:31], v[126:127], v[102:103], v[30:31]
    v_pk_fma_f32 v[44:45], v[126:127], v[104:105], v[44:45]
    v_pk_fma_f32 v[46:47], v[126:127], v[106:107], v[46:47]
    v_pk_mul_f32 v[152:153], v[134:135], v[12:13]
    v_pk_mul_f32 v[154:155], v[134:135], v[14:15]
    v_pk_mul_f32 v[156:157], v[134:135], v[28:29]
    v_pk_mul_f32 v[158:159], v[134:135], v[30:31]
    v_pk_mul_f32 v[160:161], v[134:135], v[44:45]
    v_pk_mul_f32 v[162:163], v[134:135], v[46:47]
    v_exp_f32 v152, v152
    v_exp_f32 v153, v153
    v_exp_f32 v154, v154
    v_exp_f32 v155, v155
    v_exp_f32 v156, v156
    v_exp_f32 v157, v157
    v_exp_f32 v158, v158
    v_exp_f32 v159, v159
    v_exp_f32 v160, v160
    v_exp_f32 v161, v161
    v_exp_f32 v162, v162
    v_exp_f32 v163, v163
    v_pk_fma_f32 v[60:61], v[126:127], v[108:109], v[60:61]
    v_pk_fma_f32 v[62:63], v[126:127], v[110:111], v[62:63]
    v_pk_fma_f32 v[76:77], v[126:127], v[112:113], v[76:77]
    v_pk_fma_f32 v[78:79], v[126:127], v[114:115], v[78:79]
    v_pk_fma_f32 v[92:93], v[126:127], v[116:117], v[92:93]
    v_pk_fma_f32 v[94:95], v[126:127], v[118:119], v[94:95]
    v_pk_fma_f32 v[152:153], v[152:153], v[142:143], v[142:143]
    v_pk_fma_f32 v[154:155], v[154:155], v[142:143], v[142:143]
    v_pk_fma_f32 v[156:157], v[156:157], v[142:143], v[142:143]
    v_pk_fma_f32 v[158:159], v[158:159], v[142:143], v[142:143]
    v_pk_fma_f32 v[160:161], v[160:161], v[142:143], v[142:143]
    v_pk_fma_f32 v[162:163], v[162:163], v[142:143], v[142:143]
    v_rcp_f32 v152, v152
    v_rcp_f32 v153, v153
    v_rcp_f32 v154, v154
    v_rcp_f32 v155, v155
    v_rcp_f32 v156, v156
    v_rcp_f32 v157, v157
    v_rcp_f32 v158, v158
    v_rcp_f32 v159, v159
    v_rcp_f32 v160, v160
    v_rcp_f32 v161, v161
    v_rcp_f32 v162, v162
    v_rcp_f32 v163, v163
    v_pk_mul_f32 v[12:13], v[12:13], v[60:61]
    v_pk_mul_f32 v[14:15], v[14:15], v[62:63]
    v_pk_mul_f32 v[28:29], v[28:29], v[76:77]
    v_pk_mul_f32 v[30:31], v[30:31], v[78:79]
    v_pk_mul_f32 v[44:45], v[44:45], v[92:93]
    v_pk_mul_f32 v[46:47], v[46:47], v[94:95]
    v_pk_mul_f32 v[12:13], v[12:13], v[152:153]
    v_pk_mul_f32 v[14:15], v[14:15], v[154:155]
    v_pk_mul_f32 v[28:29], v[28:29], v[156:157]
    v_pk_mul_f32 v[30:31], v[30:31], v[158:159]
    v_pk_mul_f32 v[44:45], v[44:45], v[160:161]
    v_pk_mul_f32 v[46:47], v[46:47], v[162:163]
    v_cvt_pk_bf16_f32 v168, v12, v13
    v_cvt_pk_bf16_f32 v169, v14, v15
    v_cvt_pk_bf16_f32 v170, v28, v29
    v_cvt_pk_bf16_f32 v171, v30, v31
    v_cvt_pk_bf16_f32 v172, v44, v45
    v_cvt_pk_bf16_f32 v173, v46, v47
    buffer_store_dwordx4 v[168:171], v249, s[80:83], s25 offen offset:3072
    ds_write_b128 v236, v[168:171] offset:3072
    buffer_store_dwordx2 v[172:173], v249, s[80:83], s26 offen offset:3072
    ds_write_b64 v237, v[172:173] offset:3072
    s_lshl_b32 s64, s75, 15
    s_lshl_b32 s66, s73, 9
    s_add_u32 s64, s64, s66
    s_add_u32 s64, s64, 75513856
    s_lshl_b32 s65, s72, 5
    s_add_u32 s64, s64, s65
    s_lshl_b32 s65, s3, 2
    s_add_u32 s64, s64, s65
    v_mov_b32 v144, 0
    v_mov_b32 v145, 1
    s_cmp_lg_u32 s78, 0
    s_cbranch_scc1 sg_3150_slow
    s_waitcnt vmcnt(0)
    s_mov_b64 exec, 1
    buffer_store_dword v145, v144, s[80:83], s64 offen
    s_mov_b64 exec, -1
sg_3150_done:
    s_setprio 3
    s_mov_b32 s8, s86
    s_mov_b32 s9, s87
    s_mov_b32 s10, 6291456
    s_mov_b32 s11, 0x00020000
    v_lshrrev_b32 v253, 3, v250
    v_lshlrev_b32 v253, 2, v253
    v_add_u32 v253, s69, v253
    v_mul_u32_u24 v253, 6144, v253
    v_and_b32 v254, 7, v250
    v_lshl_add_u32 v10, v254, 4, v253
    v_add_u32 v11, 2048, v10
    v_add_u32 v12, 4096, v10
    s_mul_i32 s19, s69, 3104
    s_lshl_b32 s17, s74, 7
    s_add_u32 s18, s17, 6291456
    s_mov_b32 s64, s57
    s_mul_i32 s64, s64, 393216
    s_add_u32 s16, s17, s64
    s_lshl_b32 s53, s73, 1
    s_add_u32 s53, s53, s68
    s_mul_i32 s53, s53, 458752
    s_lshl_b32 s66, s60, 24
    s_add_u32 s53, s53, s66
    s_add_u32 s53, s53, 20971520
    s_lshl_b32 s55, s69, 11
    s_add_u32 s53, s53, s55
    s_lshl_b32 s56, s75, 15
    s_lshl_b32 s66, s73, 9
    s_add_u32 s56, s56, s66
    s_add_u32 s56, s56, 75513856
    v_lshlrev_b32 v246, 4, v250
    s_lshl_b32 s64, s68, 1
    s_lshl_b32 s62, 0x33333333, s64
    s_mov_b32 s63, 0
    s_lshr_b32 s40, s2, 3
    s_lshl_b32 s40, s40, 2
    s_add_u32 s40, s40, s69
    s_and_b32 s41, s40, 31
    s_lshl_b32 s41, s41, 11
    s_lshr_b32 s46, s40, 5
    s_and_b32 s46, s46, 1
    s_lshr_b32 s40, s40, 6
    s_lshl_b32 s40, s40, 10
    s_add_u32 s40, s40, s41
    s_lshr_b32 s41, s74, 3
    s_mul_i32 s41, s41, 3670016
    s_add_u32 s40, s40, s41
    s_add_u32 s40, s96, s40
    s_addc_u32 s41, s97, 0
    s_mul_i32 s47, s58, 7
    s_add_u32 s46, s46, s47
    s_waitcnt lgkmcnt(0)
    s_barrier
    s_add_u32 s42, s46, 10
    s_cmp_ge_u32 s42, 56
    s_cselect_b32 s47, 56, 0
    s_sub_u32 s42, s42, s47
    s_lshl_b32 s42, s42, 16
    s_add_u32 s44, s40, s42
    s_addc_u32 s45, s41, 0
    s_load_dword s43, s[44:45], 384
    s_load_dword s43, s[44:45], 448
    s_barrier
    s_add_u32 s42, s46, 12
    s_cmp_ge_u32 s42, 56
    s_cselect_b32 s47, 56, 0
    s_sub_u32 s42, s42, s47
    s_lshl_b32 s42, s42, 16
    s_add_u32 s44, s40, s42
    s_addc_u32 s45, s41, 0
    s_load_dword s43, s[44:45], 384
    s_load_dword s43, s[44:45], 448
    s_add_u32 s42, s46, 14
    s_cmp_ge_u32 s42, 56
    s_cselect_b32 s47, 56, 0
    s_sub_u32 s42, s42, s47
    s_lshl_b32 s42, s42, 16
    s_add_u32 s44, s40, s42
    s_addc_u32 s45, s41, 0
    s_load_dword s43, s[44:45], 384
    s_load_dword s43, s[44:45], 448
    s_add_u32 m0, s51, 107776
    s_nop 0
    buffer_load_dwordx4 v244, s[12:15], s48 offen lds
    s_add_u32 m0, s51, 108832
    s_nop 0
    buffer_load_dwordx4 v245, s[12:15], s48 offen lds
    s_add_u32 s48, s48, 65536
    s_add_u32 m0, s51, 116224
    s_nop 0
    buffer_load_dwordx4 v244, s[12:15], s48 offen lds
    s_add_u32 m0, s51, 117280
    s_nop 0
    buffer_load_dwordx4 v245, s[12:15], s48 offen lds
    s_add_u32 s48, s48, 65536
    s_add_u32 m0, s51, 124672
    s_nop 0
    buffer_load_dwordx4 v244, s[12:15], s48 offen lds
    s_add_u32 m0, s51, 125728
    s_nop 0
    buffer_load_dwordx4 v245, s[12:15], s48 offen lds
    s_add_u32 s48, s48, 65536
    s_mov_b64 exec, s[62:63]
pl_3151:
    buffer_load_dwordx4 v[240:243], v246, s[80:83], s56 offen sc1
    s_sub_u32 s79, s79, 1
    s_cbranch_scc1 L_abort
    s_waitcnt vmcnt(0)
    v_and_b32 v240, v240, v241
    v_and_b32 v242, v242, v243
    v_and_b32 v240, v240, v242
    v_cmp_ne_u32 vcc, 1, v240
    s_cbranch_vccnz pl_3151
    s_mov_b64 exec, -1
    s_cmp_lg_u32 s78, 0
    s_cbranch_scc1 pl_3151_acq
pl_3151_ok:
    s_cmp_le_u32 s50, 0
    s_addc_u32 s52, s58, 0
    s_and_b32 s52, s52, 7
    s_mul_i32 s52, s52, 57344
    s_add_u32 s52, s52, s53
    s_add_u32 m0, s55, 49152
    s_nop 0
    buffer_load_dwordx4 v249, s[80:83], s52 offen offset:0 sc1 lds
    buffer_load_dwordx4 v249, s[80:83], s52 offen offset:1024 sc1 lds
    s_add_u32 s52, s52, 8192
    s_add_u32 m0, s55, 57344
    s_nop 0
    buffer_load_dwordx4 v249, s[80:83], s52 offen offset:0 sc1 lds
    buffer_load_dwordx4 v249, s[80:83], s52 offen offset:1024 sc1 lds
    s_add_u32 s52, s52, 8192
    s_add_u32 m0, s55, 0
    s_nop 0
    buffer_load_dwordx4 v249, s[80:83], s52 offen offset:0 sc1 lds
    buffer_load_dwordx4 v249, s[80:83], s52 offen offset:1024 sc1 lds
    s_add_u32 s52, s52, 8192
    s_add_u32 m0, s55, 8192
    s_nop 0
    buffer_load_dwordx4 v249, s[80:83], s52 offen offset:0 sc1 lds
    buffer_load_dwordx4 v249, s[80:83], s52 offen offset:1024 sc1 lds
    s_add_u32 s52, s52, 8192
    s_waitcnt vmcnt(4)
    s_barrier
    s_add_u32 m0, s55, 16384
    s_nop 0
    buffer_load_dwordx4 v249, s[80:83], s52 offen offset:0 sc1 lds
    buffer_load_dwordx4 v249, s[80:83], s52 offen offset:1024 sc1 lds
    s_add_u32 s52, s52, 8192
    s_add_u32 s42, s46, 16
    s_cmp_ge_u32 s42, 56
    s_cselect_b32 s47, 56, 0
    s_sub_u32 s42, s42, s47
    s_lshl_b32 s42, s42, 16
    s_add_u32 s44, s40, s42
    s_addc_u32 s45, s41, 0
    s_load_dword s43, s[44:45], 384
    s_load_dword s43, s[44:45], 448
    s_add_u32 s42, s46, 18
    s_cmp_ge_u32 s42, 56
    s_cselect_b32 s47, 56, 0
    s_sub_u32 s42, s42, s47
    s_lshl_b32 s42, s42, 16
    s_add_u32 s44, s40, s42
    s_addc_u32 s45, s41, 0
    s_load_dword s43, s[44:45], 384
    s_load_dword s43, s[44:45], 448
    s_add_u32 m0, s55, 24576
    s_nop 0
    buffer_load_dwordx4 v249, s[80:83], s52 offen offset:0 sc1 lds
    buffer_load_dwordx4 v249, s[80:83], s52 offen offset:1024 sc1 lds
    s_add_u32 s52, s52, 8192
    s_add_u32 m0, s55, 32768
    s_nop 0
    buffer_load_dwordx4 v249, s[80:83], s52 offen offset:0 sc1 lds
    buffer_load_dwordx4 v249, s[80:83], s52 offen offset:1024 sc1 lds
    s_add_u32 s52, s52, 8192
    s_add_u32 m0, s51, 133120
    s_nop 0
    buffer_load_dwordx4 v244, s[12:15], s48 offen lds
    s_add_u32 m0, s51, 134176
    s_nop 0
    buffer_load_dwordx4 v245, s[12:15], s48 offen lds
    s_add_u32 s48, s48, 65536
    s_waitcnt vmcnt(8)
    s_barrier
    s_cmp_le_u32 s50, 1
    s_addc_u32 s52, s58, 1
    s_and_b32 s52, s52, 7
    s_mul_i32 s52, s52, 57344
    s_add_u32 s52, s52, s53
    s_add_u32 m0, s55, 40960
    s_nop 0
    buffer_load_dwordx4 v249, s[80:83], s52 offen offset:0 sc1 lds
    buffer_load_dwordx4 v249, s[80:83], s52 offen offset:1024 sc1 lds
    s_add_u32 s52, s52, 8192
    s_add_u32 s42, s46, 20
    s_cmp_ge_u32 s42, 56
    s_cselect_b32 s47, 56, 0
    s_sub_u32 s42, s42, s47
    s_lshl_b32 s42, s42, 16
    s_add_u32 s44, s40, s42
    s_addc_u32 s45, s41, 0
    s_load_dword s43, s[44:45], 384
    s_load_dword s43, s[44:45], 448
    s_cmp_le_u32 s50, 1
    s_addc_u32 s48, s58, 1
    s_and_b32 s48, s48, 7
    s_mul_i32 s48, s48, 458752
    s_add_u32 s48, s48, s49
    s_add_u32 m0, s51, 141568
    s_nop 0
    buffer_load_dwordx4 v244, s[12:15], s48 offen lds
    s_add_u32 m0, s51, 142624
    s_nop 0
    buffer_load_dwordx4 v245, s[12:15], s48 offen lds
    s_add_u32 s48, s48, 65536
    s_add_u32 m0, s55, 49152
    s_nop 0
    buffer_load_dwordx4 v249, s[80:83], s52 offen offset:0 sc1 lds
    buffer_load_dwordx4 v249, s[80:83], s52 offen offset:1024 sc1 lds
    s_add_u32 s52, s52, 8192
    s_add_u32 m0, s51, 65536
    s_nop 0
    buffer_load_dwordx4 v244, s[12:15], s48 offen lds
    s_add_u32 m0, s51, 66592
    s_nop 0
    buffer_load_dwordx4 v245, s[12:15], s48 offen lds
    s_add_u32 s48, s48, 65536
    s_waitcnt vmcnt(12)
    s_barrier
    s_add_u32 m0, s55, 57344
    s_nop 0
    buffer_load_dwordx4 v249, s[80:83], s52 offen offset:0 sc1 lds
    buffer_load_dwordx4 v249, s[80:83], s52 offen offset:1024 sc1 lds
    s_add_u32 s52, s52, 8192
    s_add_u32 s42, s46, 22
    s_cmp_ge_u32 s42, 56
    s_cselect_b32 s47, 56, 0
    s_sub_u32 s42, s42, s47
    s_lshl_b32 s42, s42, 16
    s_add_u32 s44, s40, s42
    s_addc_u32 s45, s41, 0
    s_load_dword s43, s[44:45], 384
    s_load_dword s43, s[44:45], 448
    s_add_u32 m0, s51, 73984
    s_nop 0
    buffer_load_dwordx4 v244, s[12:15], s48 offen lds
    s_add_u32 m0, s51, 75040
    s_nop 0
    buffer_load_dwordx4 v245, s[12:15], s48 offen lds
    s_add_u32 s48, s48, 65536
    s_add_u32 m0, s55, 0
    s_nop 0
    buffer_load_dwordx4 v249, s[80:83], s52 offen offset:0 sc1 lds
    buffer_load_dwordx4 v249, s[80:83], s52 offen offset:1024 sc1 lds
    s_add_u32 s52, s52, 8192
    s_add_u32 m0, s51, 82432
    s_nop 0
    buffer_load_dwordx4 v244, s[12:15], s48 offen lds
    s_add_u32 m0, s51, 83488
    s_nop 0
    buffer_load_dwordx4 v245, s[12:15], s48 offen lds
    s_add_u32 s48, s48, 65536
    s_waitcnt vmcnt(12)
    s_barrier
    s_add_u32 m0, s55, 8192
    s_nop 0
    buffer_load_dwordx4 v249, s[80:83], s52 offen offset:0 sc1 lds
    buffer_load_dwordx4 v249, s[80:83], s52 offen offset:1024 sc1 lds
    s_add_u32 s52, s52, 8192
    s_add_u32 s42, s46, 24
    s_cmp_ge_u32 s42, 56
    s_cselect_b32 s47, 56, 0
    s_sub_u32 s42, s42, s47
    s_lshl_b32 s42, s42, 16
    s_add_u32 s44, s40, s42
    s_addc_u32 s45, s41, 0
    s_load_dword s43, s[44:45], 384
    s_load_dword s43, s[44:45], 448
    s_add_u32 m0, s51, 90880
    s_nop 0
    buffer_load_dwordx4 v244, s[12:15], s48 offen lds
    s_add_u32 m0, s51, 91936
    s_nop 0
    buffer_load_dwordx4 v245, s[12:15], s48 offen lds
    s_add_u32 s48, s48, 65536
    s_add_u32 m0, s55, 16384
    s_nop 0
    buffer_load_dwordx4 v249, s[80:83], s52 offen offset:0 sc1 lds
    buffer_load_dwordx4 v249, s[80:83], s52 offen offset:1024 sc1 lds
    s_add_u32 s52, s52, 8192
    s_add_u32 m0, s51, 99328
    s_nop 0
    buffer_load_dwordx4 v244, s[12:15], s48 offen lds
    s_add_u32 m0, s51, 100384
    s_nop 0
    buffer_load_dwordx4 v245, s[12:15], s48 offen lds
    s_add_u32 s48, s48, 65536
    s_waitcnt vmcnt(12)
    s_barrier
    s_add_u32 m0, s55, 24576
    s_nop 0
    buffer_load_dwordx4 v249, s[80:83], s52 offen offset:0 sc1 lds
    buffer_load_dwordx4 v249, s[80:83], s52 offen offset:1024 sc1 lds
    s_add_u32 s52, s52, 8192
    s_add_u32 s42, s46, 26
    s_cmp_ge_u32 s42, 56
    s_cselect_b32 s47, 56, 0
    s_sub_u32 s42, s42, s47
    s_lshl_b32 s42, s42, 16
    s_add_u32 s44, s40, s42
    s_addc_u32 s45, s41, 0
    s_load_dword s43, s[44:45], 384
    s_load_dword s43, s[44:45], 448
    s_add_u32 m0, s51, 107776
    s_nop 0
    buffer_load_dwordx4 v244, s[12:15], s48 offen lds
    s_add_u32 m0, s51, 108832
    s_nop 0
    buffer_load_dwordx4 v245, s[12:15], s48 offen lds
    s_add_u32 s48, s48, 65536
    s_cmp_le_u32 s50, 2
    s_addc_u32 s52, s58, 2
    s_and_b32 s52, s52, 7
    s_mul_i32 s52, s52, 57344
    s_add_u32 s52, s52, s53
    s_add_u32 m0, s55, 32768
    s_nop 0
    buffer_load_dwordx4 v249, s[80:83], s52 offen offset:0 sc1 lds
    buffer_load_dwordx4 v249, s[80:83], s52 offen offset:1024 sc1 lds
    s_add_u32 s52, s52, 8192
    s_cmp_le_u32 s50, 2
    s_addc_u32 s48, s58, 2
    s_and_b32 s48, s48, 7
    s_mul_i32 s48, s48, 458752
    s_add_u32 s48, s48, s49
    s_add_u32 m0, s51, 116224
    s_nop 0
    buffer_load_dwordx4 v244, s[12:15], s48 offen lds
    s_add_u32 m0, s51, 117280
    s_nop 0
    buffer_load_dwordx4 v245, s[12:15], s48 offen lds
    s_add_u32 s48, s48, 65536
    s_waitcnt vmcnt(12)
    s_barrier
    s_add_u32 m0, s55, 40960
    s_nop 0
    buffer_load_dwordx4 v249, s[80:83], s52 offen offset:0 sc1 lds
    buffer_load_dwordx4 v249, s[80:83], s52 offen offset:1024 sc1 lds
    s_add_u32 s52, s52, 8192
    s_add_u32 s42, s46, 28
    s_cmp_ge_u32 s42, 56
    s_cselect_b32 s47, 56, 0
    s_sub_u32 s42, s42, s47
    s_lshl_b32 s42, s42, 16
    s_add_u32 s44, s40, s42
    s_addc_u32 s45, s41, 0
    s_load_dword s43, s[44:45], 384
    s_load_dword s43, s[44:45], 448
    s_add_u32 m0, s51, 124672
    s_nop 0
    buffer_load_dwordx4 v244, s[12:15], s48 offen lds
    s_add_u32 m0, s51, 125728
    s_nop 0
    buffer_load_dwordx4 v245, s[12:15], s48 offen lds
    s_add_u32 s48, s48, 65536
    s_add_u32 m0, s55, 49152
    s_nop 0
    buffer_load_dwordx4 v249, s[80:83], s52 offen offset:0 sc1 lds
    buffer_load_dwordx4 v249, s[80:83], s52 offen offset:1024 sc1 lds
    s_add_u32 s52, s52, 8192
    s_add_u32 m0, s51, 133120
    s_nop 0
    buffer_load_dwordx4 v244, s[12:15], s48 offen lds
    s_add_u32 m0, s51, 134176
    s_nop 0
    buffer_load_dwordx4 v245, s[12:15], s48 offen lds
    s_add_u32 s48, s48, 65536
    s_waitcnt vmcnt(12)
    s_barrier
    s_add_u32 m0, s55, 57344
    s_nop 0
    buffer_load_dwordx4 v249, s[80:83], s52 offen offset:0 sc1 lds
    buffer_load_dwordx4 v249, s[80:83], s52 offen offset:1024 sc1 lds
    s_add_u32 s52, s52, 8192
    s_add_u32 s42, s46, 30
    s_cmp_ge_u32 s42, 56
    s_cselect_b32 s47, 56, 0
    s_sub_u32 s42, s42, s47
    s_lshl_b32 s42, s42, 16
    s_add_u32 s44, s40, s42
    s_addc_u32 s45, s41, 0
    s_load_dword s43, s[44:45], 384
    s_load_dword s43, s[44:45], 448
    s_add_u32 m0, s51, 141568
    s_nop 0
    buffer_load_dwordx4 v244, s[12:15], s48 offen lds
    s_add_u32 m0, s51, 142624
    s_nop 0
    buffer_load_dwordx4 v245, s[12:15], s48 offen lds
    s_add_u32 s48, s48, 65536
    s_add_u32 m0, s55, 0
    s_nop 0
    buffer_load_dwordx4 v249, s[80:83], s52 offen offset:0 sc1 lds
    buffer_load_dwordx4 v249, s[80:83], s52 offen offset:1024 sc1 lds
    s_add_u32 s52, s52, 8192
    s_add_u32 m0, s51, 65536
    s_nop 0
    buffer_load_dwordx4 v244, s[12:15], s48 offen lds
    s_add_u32 m0, s51, 66592
    s_nop 0
    buffer_load_dwordx4 v245, s[12:15], s48 offen lds
    s_add_u32 s48, s48, 65536
    s_waitcnt vmcnt(12)
    s_barrier
    s_add_u32 m0, s55, 8192
    s_nop 0
    buffer_load_dwordx4 v249, s[80:83], s52 offen offset:0 sc1 lds
    buffer_load_dwordx4 v249, s[80:83], s52 offen offset:1024 sc1 lds
    s_add_u32 s52, s52, 8192
    s_add_u32 s42, s46, 32
    s_cmp_ge_u32 s42, 56
    s_cselect_b32 s47, 56, 0
    s_sub_u32 s42, s42, s47
    s_lshl_b32 s42, s42, 16
    s_add_u32 s44, s40, s42
    s_addc_u32 s45, s41, 0
    s_load_dword s43, s[44:45], 384
    s_load_dword s43, s[44:45], 448
    s_add_u32 m0, s51, 73984
    s_nop 0
    buffer_load_dwordx4 v244, s[12:15], s48 offen lds
    s_add_u32 m0, s51, 75040
    s_nop 0
    buffer_load_dwordx4 v245, s[12:15], s48 offen lds
    s_add_u32 s48, s48, 65536
    s_add_u32 m0, s55, 16384
    s_nop 0
    buffer_load_dwordx4 v249, s[80:83], s52 offen offset:0 sc1 lds
    buffer_load_dwordx4 v249, s[80:83], s52 offen offset:1024 sc1 lds
    s_add_u32 s52, s52, 8192
    s_add_u32 m0, s51, 82432
    s_nop 0
    buffer_load_dwordx4 v244, s[12:15], s48 offen lds
    s_add_u32 m0, s51, 83488
    s_nop 0
    buffer_load_dwordx4 v245, s[12:15], s48 offen lds
    s_add_u32 s48, s48, 65536
    s_waitcnt vmcnt(12)
    s_barrier
    s_cmp_le_u32 s50, 3
    s_addc_u32 s52, s58, 3
    s_and_b32 s52, s52, 7
    s_mul_i32 s52, s52, 57344
    s_add_u32 s52, s52, s53
    s_add_u32 m0, s55, 24576
    s_nop 0
    buffer_load_dwordx4 v249, s[80:83], s52 offen offset:0 sc1 lds
    buffer_load_dwordx4 v249, s[80:83], s52 offen offset:1024 sc1 lds
    s_add_u32 s52, s52, 8192
    s_add_u32 s42, s46, 34
    s_cmp_ge_u32 s42, 56
    s_cselect_b32 s47, 56, 0
    s_sub_u32 s42, s42, s47
    s_lshl_b32 s42, s42, 16
    s_add_u32 s44, s40, s42
    s_addc_u32 s45, s41, 0
    s_load_dword s43, s[44:45], 384
    s_load_dword s43, s[44:45], 448
    s_cmp_le_u32 s50, 3
    s_addc_u32 s48, s58, 3
    s_and_b32 s48, s48, 7
    s_mul_i32 s48, s48, 458752
    s_add_u32 s48, s48, s49
    s_add_u32 m0, s51, 90880
    s_nop 0
    buffer_load_dwordx4 v244, s[12:15], s48 offen lds
    s_add_u32 m0, s51, 91936
    s_nop 0
    buffer_load_dwordx4 v245, s[12:15], s48 offen lds
    s_add_u32 s48, s48, 65536
    s_add_u32 m0, s55, 32768
    s_nop 0
    buffer_load_dwordx4 v249, s[80:83], s52 offen offset:0 sc1 lds
    buffer_load_dwordx4 v249, s[80:83], s52 offen offset:1024 sc1 lds
    s_add_u32 s52, s52, 8192
    s_add_u32 m0, s51, 99328
    s_nop 0
    buffer_load_dwordx4 v244, s[12:15], s48 offen lds
    s_add_u32 m0, s51, 100384
    s_nop 0
    buffer_load_dwordx4 v245, s[12:15], s48 offen lds
    s_add_u32 s48, s48, 65536
    s_waitcnt vmcnt(12)
    s_barrier
    s_add_u32 m0, s55, 40960
    s_nop 0
    buffer_load_dwordx4 v249, s[80:83], s52 offen offset:0 sc1 lds
    buffer_load_dwordx4 v249, s[80:83], s52 offen offset:1024 sc1 lds
    s_add_u32 s52, s52, 8192
    s_add_u32 s42, s46, 36
    s_cmp_ge_u32 s42, 56
    s_cselect_b32 s47, 56, 0
    s_sub_u32 s42, s42, s47
    s_lshl_b32 s42, s42, 16
    s_add_u32 s44, s40, s42
    s_addc_u32 s45, s41, 0
    s_load_dword s43, s[44:45], 384
    s_load_dword s43, s[44:45], 448
    s_add_u32 m0, s51, 107776
    s_nop 0
    buffer_load_dwordx4 v244, s[12:15], s48 offen lds
    s_add_u32 m0, s51, 108832
    s_nop 0
    buffer_load_dwordx4 v245, s[12:15], s48 offen lds
    s_add_u32 s48, s48, 65536
    s_add_u32 m0, s55, 49152
    s_nop 0
    buffer_load_dwordx4 v249, s[80:83], s52 offen offset:0 sc1 lds
    buffer_load_dwordx4 v249, s[80:83], s52 offen offset:1024 sc1 lds
    s_add_u32 s52, s52, 8192
    s_add_u32 m0, s51, 116224
    s_nop 0
    buffer_load_dwordx4 v244, s[12:15], s48 offen lds
    s_add_u32 m0, s51, 117280
    s_nop 0
    buffer_load_dwordx4 v245, s[12:15], s48 offen lds
    s_add_u32 s48, s48, 65536
    s_waitcnt vmcnt(12)
    s_barrier
    s_add_u32 m0, s55, 57344
    s_nop 0
    buffer_load_dwordx4 v249, s[80:83], s52 offen offset:0 sc1 lds
    buffer_load_dwordx4 v249, s[80:83], s52 offen offset:1024 sc1 lds
    s_add_u32 s52, s52, 8192
    s_add_u32 s42, s46, 38
    s_cmp_ge_u32 s42, 56
    s_cselect_b32 s47, 56, 0
    s_sub_u32 s42, s42, s47
    s_lshl_b32 s42, s42, 16
    s_add_u32 s44, s40, s42
    s_addc_u32 s45, s41, 0
    s_load_dword s43, s[44:45], 384
    s_load_dword s43, s[44:45], 448
    s_add_u32 m0, s51, 124672
    s_nop 0
    buffer_load_dwordx4 v244, s[12:15], s48 offen lds
    s_add_u32 m0, s51, 125728
    s_nop 0
    buffer_load_dwordx4 v245, s[12:15], s48 offen lds
    s_add_u32 s48, s48, 65536
    s_add_u32 m0, s55, 0
    s_nop 0
    buffer_load_dwordx4 v249, s[80:83], s52 offen offset:0 sc1 lds
    buffer_load_dwordx4 v249, s[80:83], s52 offen offset:1024 sc1 lds
    s_add_u32 s52, s52, 8192
    s_add_u32 m0, s51, 133120
    s_nop 0
    buffer_load_dwordx4 v244, s[12:15], s48 offen lds
    s_add_u32 m0, s51, 134176
    s_nop 0
    buffer_load_dwordx4 v245, s[12:15], s48 offen lds
    s_add_u32 s48, s48, 65536
    s_waitcnt vmcnt(12)
    s_barrier
    s_add_u32 m0, s55, 8192
    s_nop 0
    buffer_load_dwordx4 v249, s[80:83], s52 offen offset:0 sc1 lds
    buffer_load_dwordx4 v249, s[80:83], s52 offen offset:1024 sc1 lds
    s_add_u32 s52, s52, 8192
    s_add_u32 s42, s46, 40
    s_cmp_ge_u32 s42, 56
    s_cselect_b32 s47, 56, 0
    s_sub_u32 s42, s42, s47
    s_lshl_b32 s42, s42, 16
    s_add_u32 s44, s40, s42
    s_addc_u32 s45, s41, 0
    s_load_dword s43, s[44:45], 384
    s_load_dword s43, s[44:45], 448
    s_add_u32 m0, s51, 141568
    s_nop 0
    buffer_load_dwordx4 v244, s[12:15], s48 offen lds
    s_add_u32 m0, s51, 142624
    s_nop 0
    buffer_load_dwordx4 v245, s[12:15], s48 offen lds
    s_add_u32 s48, s48, 65536
    s_cmp_le_u32 s50, 4
    s_addc_u32 s52, s58, 4
    s_and_b32 s52, s52, 7
    s_mul_i32 s52, s52, 57344
    s_add_u32 s52, s52, s53
    s_add_u32 m0, s55, 16384
    s_nop 0
    buffer_load_dwordx4 v249, s[80:83], s52 offen offset:0 sc1 lds
    buffer_load_dwordx4 v249, s[80:83], s52 offen offset:1024 sc1 lds
    s_add_u32 s52, s52, 8192
    s_cmp_le_u32 s50, 4
    s_addc_u32 s48, s58, 4
    s_and_b32 s48, s48, 7
    s_mul_i32 s48, s48, 458752
    s_add_u32 s48, s48, s49
    s_add_u32 m0, s51, 65536
    s_nop 0
    buffer_load_dwordx4 v244, s[12:15], s48 offen lds
    s_add_u32 m0, s51, 66592
    s_nop 0
    buffer_load_dwordx4 v245, s[12:15], s48 offen lds
    s_add_u32 s48, s48, 65536
    s_waitcnt vmcnt(12)
    s_barrier
    s_add_u32 m0, s55, 24576
    s_nop 0
    buffer_load_dwordx4 v249, s[80:83], s52 offen offset:0 sc1 lds
    buffer_load_dwordx4 v249, s[80:83], s52 offen offset:1024 sc1 lds
    s_add_u32 s52, s52, 8192
    s_add_u32 s42, s46, 42
    s_cmp_ge_u32 s42, 56
    s_cselect_b32 s47, 56, 0
    s_sub_u32 s42, s42, s47
    s_lshl_b32 s42, s42, 16
    s_add_u32 s44, s40, s42
    s_addc_u32 s45, s41, 0
    s_load_dword s43, s[44:45], 384
    s_load_dword s43, s[44:45], 448
    s_add_u32 m0, s51, 73984
    s_nop 0
    buffer_load_dwordx4 v244, s[12:15], s48 offen lds
    s_add_u32 m0, s51, 75040
    s_nop 0
    buffer_load_dwordx4 v245, s[12:15], s48 offen lds
    s_add_u32 s48, s48, 65536
    s_add_u32 m0, s55, 32768
    s_nop 0
    buffer_load_dwordx4 v249, s[80:83], s52 offen offset:0 sc1 lds
    buffer_load_dwordx4 v249, s[80:83], s52 offen offset:1024 sc1 lds
    s_add_u32 s52, s52, 8192
    s_add_u32 m0, s51, 82432
    s_nop 0
    buffer_load_dwordx4 v244, s[12:15], s48 offen lds
    s_add_u32 m0, s51, 83488
    s_nop 0
    buffer_load_dwordx4 v245, s[12:15], s48 offen lds
    s_add_u32 s48, s48, 65536
    s_waitcnt vmcnt(12)
    s_barrier
    s_add_u32 m0, s55, 40960
    s_nop 0
    buffer_load_dwordx4 v249, s[80:83], s52 offen offset:0 sc1 lds
    buffer_load_dwordx4 v249, s[80:83], s52 offen offset:1024 sc1 lds
    s_add_u32 s52, s52, 8192
    s_add_u32 s42, s46, 44
    s_cmp_ge_u32 s42, 56
    s_cselect_b32 s47, 56, 0
    s_sub_u32 s42, s42, s47
    s_lshl_b32 s42, s42, 16
    s_add_u32 s44, s40, s42
    s_addc_u32 s45, s41, 0
    s_load_dword s43, s[44:45], 384
    s_load_dword s43, s[44:45], 448
    s_add_u32 m0, s51, 90880
    s_nop 0
    buffer_load_dwordx4 v244, s[12:15], s48 offen lds
    s_add_u32 m0, s51, 91936
    s_nop 0
    buffer_load_dwordx4 v245, s[12:15], s48 offen lds
    s_add_u32 s48, s48, 65536
    s_add_u32 m0, s55, 49152
    s_nop 0
    buffer_load_dwordx4 v249, s[80:83], s52 offen offset:0 sc1 lds
    buffer_load_dwordx4 v249, s[80:83], s52 offen offset:1024 sc1 lds
    s_add_u32 s52, s52, 8192
    s_add_u32 m0, s51, 99328
    s_nop 0
    buffer_load_dwordx4 v244, s[12:15], s48 offen lds
    s_add_u32 m0, s51, 100384
    s_nop 0
    buffer_load_dwordx4 v245, s[12:15], s48 offen lds
    s_add_u32 s48, s48, 65536
    s_waitcnt vmcnt(12)
    s_barrier
    s_add_u32 m0, s55, 57344
    s_nop 0
    buffer_load_dwordx4 v249, s[80:83], s52 offen offset:0 sc1 lds
    buffer_load_dwordx4 v249, s[80:83], s52 offen offset:1024 sc1 lds
    s_add_u32 s52, s52, 8192
    s_add_u32 s42, s46, 46
    s_cmp_ge_u32 s42, 56
    s_cselect_b32 s47, 56, 0
    s_sub_u32 s42, s42, s47
    s_lshl_b32 s42, s42, 16
    s_add_u32 s44, s40, s42
    s_addc_u32 s45, s41, 0
    s_load_dword s43, s[44:45], 384
    s_load_dword s43, s[44:45], 448
    s_add_u32 m0, s51, 107776
    s_nop 0
    buffer_load_dwordx4 v244, s[12:15], s48 offen lds
    s_add_u32 m0, s51, 108832
    s_nop 0
    buffer_load_dwordx4 v245, s[12:15], s48 offen lds
    s_add_u32 s48, s48, 65536
    s_add_u32 m0, s55, 0
    s_nop 0
    buffer_load_dwordx4 v249, s[80:83], s52 offen offset:0 sc1 lds
    buffer_load_dwordx4 v249, s[80:83], s52 offen offset:1024 sc1 lds
    s_add_u32 s52, s52, 8192
    s_add_u32 m0, s51, 116224
    s_nop 0
    buffer_load_dwordx4 v244, s[12:15], s48 offen lds
    s_add_u32 m0, s51, 117280
    s_nop 0
    buffer_load_dwordx4 v245, s[12:15], s48 offen lds
    s_add_u32 s48, s48, 65536
    s_waitcnt vmcnt(12)
    s_barrier
    s_cmp_le_u32 s50, 5
    s_addc_u32 s52, s58, 5
    s_and_b32 s52, s52, 7
    s_mul_i32 s52, s52, 57344
    s_add_u32 s52, s52, s53
    s_add_u32 m0, s55, 8192
    s_nop 0
    buffer_load_dwordx4 v249, s[80:83], s52 offen offset:0 sc1 lds
    buffer_load_dwordx4 v249, s[80:83], s52 offen offset:1024 sc1 lds
    s_add_u32 s52, s52, 8192
    s_add_u32 s42, s46, 48
    s_cmp_ge_u32 s42, 56
    s_cselect_b32 s47, 56, 0
    s_sub_u32 s42, s42, s47
    s_lshl_b32 s42, s42, 16
    s_add_u32 s44, s40, s42
    s_addc_u32 s45, s41, 0
    s_load_dword s43, s[44:45], 384
    s_load_dword s43, s[44:45], 448
    s_cmp_le_u32 s50, 5
    s_addc_u32 s48, s58, 5
    s_and_b32 s48, s48, 7
    s_mul_i32 s48, s48, 458752
    s_add_u32 s48, s48, s49
    s_add_u32 m0, s51, 124672
    s_nop 0
    buffer_load_dwordx4 v244, s[12:15], s48 offen lds
    s_add_u32 m0, s51, 125728
    s_nop 0
    buffer_load_dwordx4 v245, s[12:15], s48 offen lds
    s_add_u32 s48, s48, 65536
    s_add_u32 m0, s55, 16384
    s_nop 0
    buffer_load_dwordx4 v249, s[80:83], s52 offen offset:0 sc1 lds
    buffer_load_dwordx4 v249, s[80:83], s52 offen offset:1024 sc1 lds
    s_add_u32 s52, s52, 8192
    s_add_u32 m0, s51, 133120
    s_nop 0
    buffer_load_dwordx4 v244, s[12:15], s48 offen lds
    s_add_u32 m0, s51, 134176
    s_nop 0
    buffer_load_dwordx4 v245, s[12:15], s48 offen lds
    s_add_u32 s48, s48, 65536
    s_waitcnt vmcnt(12)
    s_barrier
    s_add_u32 m0, s55, 24576
    s_nop 0
    buffer_load_dwordx4 v249, s[80:83], s52 offen offset:0 sc1 lds
    buffer_load_dwordx4 v249, s[80:83], s52 offen offset:1024 sc1 lds
    s_add_u32 s52, s52, 8192
    s_add_u32 s42, s46, 50
    s_cmp_ge_u32 s42, 56
    s_cselect_b32 s47, 56, 0
    s_sub_u32 s42, s42, s47
    s_lshl_b32 s42, s42, 16
    s_add_u32 s44, s40, s42
    s_addc_u32 s45, s41, 0
    s_load_dword s43, s[44:45], 384
    s_load_dword s43, s[44:45], 448
    s_add_u32 m0, s51, 141568
    s_nop 0
    buffer_load_dwordx4 v244, s[12:15], s48 offen lds
    s_add_u32 m0, s51, 142624
    s_nop 0
    buffer_load_dwordx4 v245, s[12:15], s48 offen lds
    s_add_u32 s48, s48, 65536
    s_add_u32 m0, s55, 32768
    s_nop 0
    buffer_load_dwordx4 v249, s[80:83], s52 offen offset:0 sc1 lds
    buffer_load_dwordx4 v249, s[80:83], s52 offen offset:1024 sc1 lds
    s_add_u32 s52, s52, 8192
    s_add_u32 m0, s51, 65536
    s_nop 0
    buffer_load_dwordx4 v244, s[12:15], s48 offen lds
    s_add_u32 m0, s51, 66592
    s_nop 0
    buffer_load_dwordx4 v245, s[12:15], s48 offen lds
    s_add_u32 s48, s48, 65536
    s_waitcnt vmcnt(12)
    s_barrier
    s_add_u32 m0, s55, 40960
    s_nop 0
    buffer_load_dwordx4 v249, s[80:83], s52 offen offset:0 sc1 lds
    buffer_load_dwordx4 v249, s[80:83], s52 offen offset:1024 sc1 lds
    s_add_u32 s52, s52, 8192
    s_add_u32 s42, s46, 52
    s_cmp_ge_u32 s42, 56
    s_cselect_b32 s47, 56, 0
    s_sub_u32 s42, s42, s47
    s_lshl_b32 s42, s42, 16
    s_add_u32 s44, s40, s42
    s_addc_u32 s45, s41, 0
    s_load_dword s43, s[44:45], 384
    s_load_dword s43, s[44:45], 448
    s_add_u32 m0, s51, 73984
    s_nop 0
    buffer_load_dwordx4 v244, s[12:15], s48 offen lds
    s_add_u32 m0, s51, 75040
    s_nop 0
    buffer_load_dwordx4 v245, s[12:15], s48 offen lds
    s_add_u32 s48, s48, 65536
    s_add_u32 m0, s55, 49152
    s_nop 0
    buffer_load_dwordx4 v249, s[80:83], s52 offen offset:0 sc1 lds
    buffer_load_dwordx4 v249, s[80:83], s52 offen offset:1024 sc1 lds
    s_add_u32 s52, s52, 8192
    s_add_u32 m0, s51, 82432
    s_nop 0
    buffer_load_dwordx4 v244, s[12:15], s48 offen lds
    s_add_u32 m0, s51, 83488
    s_nop 0
    buffer_load_dwordx4 v245, s[12:15], s48 offen lds
    s_add_u32 s48, s48, 65536
    s_waitcnt vmcnt(12)
    s_barrier
    s_add_u32 m0, s55, 57344
    s_nop 0
    buffer_load_dwordx4 v249, s[80:83], s52 offen offset:0 sc1 lds
    buffer_load_dwordx4 v249, s[80:83], s52 offen offset:1024 sc1 lds
    s_add_u32 s52, s52, 8192
    s_add_u32 s42, s46, 54
    s_cmp_ge_u32 s42, 56
    s_cselect_b32 s47, 56, 0
    s_sub_u32 s42, s42, s47
    s_lshl_b32 s42, s42, 16
    s_add_u32 s44, s40, s42
    s_addc_u32 s45, s41, 0
    s_load_dword s43, s[44:45], 384
    s_load_dword s43, s[44:45], 448
    s_add_u32 m0, s51, 90880
    s_nop 0
    buffer_load_dwordx4 v244, s[12:15], s48 offen lds
    s_add_u32 m0, s51, 91936
    s_nop 0
    buffer_load_dwordx4 v245, s[12:15], s48 offen lds
    s_add_u32 s48, s48, 65536
    s_cmp_le_u32 s50, 6
    s_addc_u32 s52, s58, 6
    s_and_b32 s52, s52, 7
    s_mul_i32 s52, s52, 57344
    s_add_u32 s52, s52, s53
    s_add_u32 m0, s55, 0
    s_nop 0
    buffer_load_dwordx4 v249, s[80:83], s52 offen offset:0 sc1 lds
    buffer_load_dwordx4 v249, s[80:83], s52 offen offset:1024 sc1 lds
    s_add_u32 s52, s52, 8192
    s_cmp_le_u32 s50, 6
    s_addc_u32 s48, s58, 6
    s_and_b32 s48, s48, 7
    s_mul_i32 s48, s48, 458752
    s_add_u32 s48, s48, s49
    s_add_u32 m0, s51, 99328
    s_nop 0
    buffer_load_dwordx4 v244, s[12:15], s48 offen lds
    s_add_u32 m0, s51, 100384
    s_nop 0
    buffer_load_dwordx4 v245, s[12:15], s48 offen lds
    s_add_u32 s48, s48, 65536
    s_waitcnt vmcnt(12)
    s_barrier
    s_add_u32 m0, s55, 8192
    s_nop 0
    buffer_load_dwordx4 v249, s[80:83], s52 offen offset:0 sc1 lds
    buffer_load_dwordx4 v249, s[80:83], s52 offen offset:1024 sc1 lds
    s_add_u32 s52, s52, 8192
    s_add_u32 m0, s51, 107776
    s_nop 0
    buffer_load_dwordx4 v244, s[12:15], s48 offen lds
    s_add_u32 m0, s51, 108832
    s_nop 0
    buffer_load_dwordx4 v245, s[12:15], s48 offen lds
    s_add_u32 s48, s48, 65536
    s_add_u32 m0, s55, 16384
    s_nop 0
    buffer_load_dwordx4 v249, s[80:83], s52 offen offset:0 sc1 lds
    buffer_load_dwordx4 v249, s[80:83], s52 offen offset:1024 sc1 lds
    s_add_u32 s52, s52, 8192
    s_add_u32 m0, s51, 116224
    s_nop 0
    buffer_load_dwordx4 v244, s[12:15], s48 offen lds
    s_add_u32 m0, s51, 117280
    s_nop 0
    buffer_load_dwordx4 v245, s[12:15], s48 offen lds
    s_add_u32 s48, s48, 65536
    s_waitcnt vmcnt(12)
    s_barrier
    s_add_u32 m0, s55, 24576
    s_nop 0
    buffer_load_dwordx4 v249, s[80:83], s52 offen offset:0 sc1 lds
    buffer_load_dwordx4 v249, s[80:83], s52 offen offset:1024 sc1 lds
    s_add_u32 s52, s52, 8192
    s_add_u32 m0, s51, 124672
    s_nop 0
    buffer_load_dwordx4 v244, s[12:15], s48 offen lds
    s_add_u32 m0, s51, 125728
    s_nop 0
    buffer_load_dwordx4 v245, s[12:15], s48 offen lds
    s_add_u32 s48, s48, 65536
    s_add_u32 m0, s55, 32768
    s_nop 0
    buffer_load_dwordx4 v249, s[80:83], s52 offen offset:0 sc1 lds
    buffer_load_dwordx4 v249, s[80:83], s52 offen offset:1024 sc1 lds
    s_add_u32 s52, s52, 8192
    s_add_u32 m0, s51, 133120
    s_nop 0
    buffer_load_dwordx4 v244, s[12:15], s48 offen lds
    s_add_u32 m0, s51, 134176
    s_nop 0
    buffer_load_dwordx4 v245, s[12:15], s48 offen lds
    s_add_u32 s48, s48, 65536
    s_waitcnt vmcnt(12)
    s_barrier
    s_add_u32 m0, s55, 40960
    s_nop 0
    buffer_load_dwordx4 v249, s[80:83], s52 offen offset:0 sc1 lds
    buffer_load_dwordx4 v249, s[80:83], s52 offen offset:1024 sc1 lds
    s_add_u32 s52, s52, 8192
    s_add_u32 m0, s51, 141568
    s_nop 0
    buffer_load_dwordx4 v244, s[12:15], s48 offen lds
    s_add_u32 m0, s51, 142624
    s_nop 0
    buffer_load_dwordx4 v245, s[12:15], s48 offen lds
    s_add_u32 s48, s48, 65536
    s_add_u32 m0, s55, 49152
    s_nop 0
    buffer_load_dwordx4 v249, s[80:83], s52 offen offset:0 sc1 lds
    buffer_load_dwordx4 v249, s[80:83], s52 offen offset:1024 sc1 lds
    s_add_u32 s52, s52, 8192
    s_add_u32 m0, s51, 65536
    s_nop 0
    buffer_load_dwordx4 v244, s[12:15], s48 offen lds
    s_add_u32 m0, s51, 66592
    s_nop 0
    buffer_load_dwordx4 v245, s[12:15], s48 offen lds
    s_add_u32 s48, s48, 65536
    s_waitcnt vmcnt(12)
    s_barrier
    s_add_u32 m0, s19, 86400
    s_nop 0
    buffer_load_dwordx4 v10, s[8:11], s16 offen lds
    s_add_u32 m0, s19, 87424
    s_nop 0
    buffer_load_dwordx4 v11, s[8:11], s16 offen lds
    s_add_u32 m0, s19, 88448
    s_nop 0
    buffer_load_dwordx4 v12, s[8:11], s16 offen lds
    s_add_u32 s16, s16, 196608
    s_cmp_eq_u32 s16, s18
    s_cselect_b32 s16, s17, s16
    s_add_u32 m0, s19, 98816
    s_nop 0
    buffer_load_dwordx4 v10, s[8:11], s16 offen lds
    s_add_u32 m0, s19, 99840
    s_nop 0
    buffer_load_dwordx4 v11, s[8:11], s16 offen lds
    s_add_u32 m0, s19, 100864
    s_nop 0
    buffer_load_dwordx4 v12, s[8:11], s16 offen lds
    s_add_u32 s16, s16, 196608
    s_cmp_eq_u32 s16, s18
    s_cselect_b32 s16, s17, s16
    s_waitcnt vmcnt(6)
    s_barrier
    s_add_u32 m0, s19, 111232
    s_nop 0
    buffer_load_dwordx4 v10, s[8:11], s16 offen lds
    s_add_u32 m0, s19, 112256
    s_nop 0
    buffer_load_dwordx4 v11, s[8:11], s16 offen lds
    s_add_u32 m0, s19, 113280
    s_nop 0
    buffer_load_dwordx4 v12, s[8:11], s16 offen lds
    s_add_u32 s16, s16, 196608
    s_cmp_eq_u32 s16, s18
    s_cselect_b32 s16, s17, s16
    s_barrier
    s_add_u32 m0, s19, 123648
    s_nop 0
    buffer_load_dwordx4 v10, s[8:11], s16 offen lds
    s_add_u32 m0, s19, 124672
    s_nop 0
    buffer_load_dwordx4 v11, s[8:11], s16 offen lds
    s_add_u32 m0, s19, 125696
    s_nop 0
    buffer_load_dwordx4 v12, s[8:11], s16 offen lds
    s_add_u32 s16, s16, 196608
    s_cmp_eq_u32 s16, s18
    s_cselect_b32 s16, s17, s16
    s_add_u32 m0, s19, 136064
    s_nop 0
    buffer_load_dwordx4 v10, s[8:11], s16 offen lds
    s_add_u32 m0, s19, 137088
    s_nop 0
    buffer_load_dwordx4 v11, s[8:11], s16 offen lds
    s_add_u32 m0, s19, 138112
    s_nop 0
    buffer_load_dwordx4 v12, s[8:11], s16 offen lds
    s_add_u32 s16, s16, 196608
    s_cmp_eq_u32 s16, s18
    s_cselect_b32 s16, s17, s16
    s_add_u32 m0, s19, 73984
    s_nop 0
    buffer_load_dwordx4 v10, s[8:11], s16 offen lds
    s_add_u32 m0, s19, 75008
    s_nop 0
    buffer_load_dwordx4 v11, s[8:11], s16 offen lds
    s_add_u32 m0, s19, 76032
    s_nop 0
    buffer_load_dwordx4 v12, s[8:11], s16 offen lds
    s_add_u32 s16, s16, 196608
    s_cmp_eq_u32 s16, s18
    s_cselect_b32 s16, s17, s16
    s_cmp_eq_u32 s75, 1
    s_cbranch_scc1 L_fin
    s_mov_b32 s75, 1
    s_mov_b32 s59, s78
    s_mul_i32 s60, s59, s75
    s_lshl_b32 s21, s67, 18
    s_add_u32 s21, s21, 4194304
    s_lshl_b32 s64, s69, 11
    s_add_u32 s21, s21, s64
    s_lshl_b32 s23, s69, 12
    s_add_u32 s23, s23, 2048
    s_add_u32 s22, s21, 262144
    s_mov_b32 s64, s57
    s_lshl_b32 s65, s64, 14
    s_add_u32 s20, s21, s65
    s_sub_u32 s28, s67, 1
    s_and_b32 s28, s28, 15
    s_lshl_b32 s26, s28, 18
    s_add_u32 s26, s26, 4201472
    s_lshl_b32 s27, s64, 14
    v_lshlrev_b32 v246, 5, v250
    s_lshl_b32 s35, s70, 10
    s_add_u32 s35, s35, 75522048
    s_xor_b32 s36, s70, 1
    s_lshl_b32 s36, s36, 9
    s_sub_u32 s37, s58, 1
    s_and_b32 s37, s37, 7
    s_lshl_b32 s37, s37, 9
    v_mov_b32 v8, s36
    v_writelane_b32 v8, s37, 1
    s_mov_b32 s37, 75571584
    s_mov_b64 exec, 0xffffffff
pl_3152:
    buffer_load_dwordx4 v[240:243], v246, s[80:83], s35 offen sc1
    s_sub_u32 s79, s79, 1
    s_cbranch_scc1 L_abort
    s_waitcnt vmcnt(0)
    v_and_b32 v240, v240, v241
    v_and_b32 v242, v242, v243
    v_and_b32 v240, v240, v242
    v_cmp_ne_u32 vcc, 1, v240
    s_cbranch_vccnz pl_3152
    s_mov_b64 exec, -1
    s_cmp_lg_u32 s78, 0
    s_cbranch_scc1 pl_3152_acq
pl_3152_ok:
    s_lshr_b32 s64, s72, 1
    s_or_b32 s64, s64, s69
    s_cbranch_scc1 rl_3153
    s_lshl_b32 s64, s73, 1
    s_add_u32 s64, s64, s68
    s_lshl_b32 s64, s64, 7
    s_add_u32 s64, s64, 75571200
    v_mov_b32 v242, 0
    v_mov_b32 v243, 1
    s_mov_b64 exec, 1
    buffer_store_dword v243, v242, s[80:83], s64 offen sc0 sc1
    s_mov_b64 exec, -1
rl_3153:
    s_mov_b64 exec, 3
pl_3154:
    buffer_load_dword v240, v8, s[80:83], s37 offen sc1
    s_sub_u32 s79, s79, 1
    s_cbranch_scc1 L_abort
    s_waitcnt vmcnt(0)
    v_cmp_ne_u32 vcc, 1, v240
    s_cbranch_vccnz pl_3154
    s_mov_b64 exec, -1
    s_cmp_lg_u32 s78, 0
    s_cbranch_scc1 pl_3154_acq
pl_3154_ok:
    s_lshr_b32 s40, s2, 3
    s_lshl_b32 s40, s40, 2
    s_add_u32 s40, s40, s69
    s_and_b32 s41, s40, 63
    s_mul_i32 s41, s41, 6144
    s_and_b32 s40, s40, 64
    s_add_u32 s40, s40, s41
    s_add_u32 s40, s40, 384
    s_and_b32 s41, s70, 1
    s_lshl_b32 s41, s41, 10
    s_add_u32 s40, s40, s41
    s_add_u32 s40, s86, s40
    s_addc_u32 s41, s87, 0
    s_cmp_lg_u32 s69, 0
    s_cbranch_scc1 nh_3155
    s_add_u32 s64, s27, 0
    s_and_b32 s64, s64, 0x3ffff
    s_mov_b32 m0, 18432
    s_add_u32 s64, s64, s26
    buffer_load_dwordx4 v249, s[80:83], s64 offen sc1 lds
nh_3155:
    s_add_u32 m0, s23, 18432
    s_nop 0
    buffer_load_dwordx4 v249, s[80:83], s20 offen offset:0 sc1 lds
    s_add_u32 m0, s23, 19456
    s_nop 0
    buffer_load_dwordx4 v249, s[80:83], s20 offen offset:1024 sc1 lds
    s_add_u32 s20, s20, 8192
    s_cmp_eq_u32 s20, s22
    s_cselect_b32 s20, s21, s20
    s_cmp_lg_u32 s69, 1
    s_cbranch_scc1 nh_3156
    s_add_u32 s64, s27, 8192
    s_and_b32 s64, s64, 0x3ffff
    s_mov_b32 m0, 19456
    s_add_u32 s64, s64, s26
    buffer_load_dwordx4 v249, s[80:83], s64 offen sc1 lds
nh_3156:
    s_add_u32 m0, s23, 19456
    s_nop 0
    buffer_load_dwordx4 v249, s[80:83], s20 offen offset:0 sc1 lds
    s_add_u32 m0, s23, 20480
    s_nop 0
    buffer_load_dwordx4 v249, s[80:83], s20 offen offset:1024 sc1 lds
    s_add_u32 s20, s20, 8192
    s_cmp_eq_u32 s20, s22
    s_cselect_b32 s20, s21, s20
    s_cmp_lg_u32 s69, 2
    s_cbranch_scc1 nh_3157
    s_add_u32 s64, s27, 16384
    s_and_b32 s64, s64, 0x3ffff
    s_mov_b32 m0, 36864
    s_add_u32 s64, s64, s26
    buffer_load_dwordx4 v249, s[80:83], s64 offen sc1 lds
nh_3157:
    s_add_u32 m0, s23, 36864
    s_nop 0
    buffer_load_dwordx4 v249, s[80:83], s20 offen offset:0 sc1 lds
    s_add_u32 m0, s23, 37888
    s_nop 0
    buffer_load_dwordx4 v249, s[80:83], s20 offen offset:1024 sc1 lds
    s_add_u32 s20, s20, 8192
    s_cmp_eq_u32 s20, s22
    s_cselect_b32 s20, s21, s20
    s_waitcnt vmcnt(4)
    s_barrier
    s_cmp_lg_u32 s69, 3
    s_cbranch_scc1 nh_3158
    s_add_u32 s64, s27, 24576
    s_and_b32 s64, s64, 0x3ffff
    s_mov_b32 m0, 37888
    s_add_u32 s64, s64, s26
    buffer_load_dwordx4 v249, s[80:83], s64 offen sc1 lds
nh_3158:
    s_add_u32 m0, s23, 37888
    s_nop 0
    buffer_load_dwordx4 v249, s[80:83], s20 offen offset:0 sc1 lds
    s_add_u32 m0, s23, 38912
    s_nop 0
    buffer_load_dwordx4 v249, s[80:83], s20 offen offset:1024 sc1 lds
    s_add_u32 s20, s20, 8192
    s_cmp_eq_u32 s20, s22
    s_cselect_b32 s20, s21, s20
    s_cmp_lg_u32 s69, 0
    s_cbranch_scc1 nh_3159
    s_add_u32 s64, s27, 32768
    s_and_b32 s64, s64, 0x3ffff
    s_mov_b32 m0, 55296
    s_add_u32 s64, s64, s26
    buffer_load_dwordx4 v249, s[80:83], s64 offen sc1 lds
nh_3159:
    s_add_u32 m0, s23, 55296
    s_nop 0
    buffer_load_dwordx4 v249, s[80:83], s20 offen offset:0 sc1 lds
    s_add_u32 m0, s23, 56320
    s_nop 0
    buffer_load_dwordx4 v249, s[80:83], s20 offen offset:1024 sc1 lds
    s_add_u32 s20, s20, 8192
    s_cmp_eq_u32 s20, s22
    s_cselect_b32 s20, s21, s20
    s_add_u32 s42, s57, 2
    s_and_b32 s42, s42, 15
    s_mul_i32 s42, s42, 393216
    s_add_u32 s44, s40, s42
    s_addc_u32 s45, s41, 0
    s_load_dword s43, s[44:45], 0
    s_load_dword s43, s[44:45], 2048
    s_load_dword s43, s[44:45], 4096
    s_add_u32 s42, s57, 3
    s_and_b32 s42, s42, 15
    s_mul_i32 s42, s42, 393216
    s_add_u32 s44, s40, s42
    s_addc_u32 s45, s41, 0
    s_load_dword s43, s[44:45], 0
    s_load_dword s43, s[44:45], 2048
    s_load_dword s43, s[44:45], 4096
    s_waitcnt vmcnt(4)
    s_barrier
    s_cmp_lg_u32 s69, 1
    s_cbranch_scc1 nh_3160
    s_add_u32 s64, s27, 40960
    s_and_b32 s64, s64, 0x3ffff
    s_mov_b32 m0, 56320
    s_add_u32 s64, s64, s26
    buffer_load_dwordx4 v249, s[80:83], s64 offen sc1 lds
nh_3160:
    s_add_u32 m0, s23, 56320
    s_nop 0
    buffer_load_dwordx4 v249, s[80:83], s20 offen offset:0 sc1 lds
    s_add_u32 m0, s23, 57344
    s_nop 0
    buffer_load_dwordx4 v249, s[80:83], s20 offen offset:1024 sc1 lds
    s_add_u32 s20, s20, 8192
    s_cmp_eq_u32 s20, s22
    s_cselect_b32 s20, s21, s20
    s_cmp_lg_u32 s69, 2
    s_cbranch_scc1 nh_3161
    s_add_u32 s64, s27, 49152
    s_and_b32 s64, s64, 0x3ffff
    s_mov_b32 m0, 0
    s_add_u32 s64, s64, s26
    buffer_load_dwordx4 v249, s[80:83], s64 offen sc1 lds
nh_3161:
    s_add_u32 m0, s23, 0
    s_nop 0
    buffer_load_dwordx4 v249, s[80:83], s20 offen offset:0 sc1 lds
    s_add_u32 m0, s23, 1024
    s_nop 0
    buffer_load_dwordx4 v249, s[80:83], s20 offen offset:1024 sc1 lds
    s_add_u32 s20, s20, 8192
    s_cmp_eq_u32 s20, s22
    s_cselect_b32 s20, s21, s20
    s_add_u32 m0, s19, 86400
    s_nop 0
    buffer_load_dwordx4 v10, s[8:11], s16 offen lds
    s_add_u32 m0, s19, 87424
    s_nop 0
    buffer_load_dwordx4 v11, s[8:11], s16 offen lds
    s_add_u32 m0, s19, 88448
    s_nop 0
    buffer_load_dwordx4 v12, s[8:11], s16 offen lds
    s_add_u32 s16, s16, 196608
    s_cmp_eq_u32 s16, s18
    s_cselect_b32 s16, s17, s16
    s_cmp_lg_u32 s69, 3
    s_cbranch_scc1 nh_3162
    s_add_u32 s64, s27, 57344
    s_and_b32 s64, s64, 0x3ffff
    s_mov_b32 m0, 1024
    s_add_u32 s64, s64, s26
    buffer_load_dwordx4 v249, s[80:83], s64 offen sc1 lds
nh_3162:
    s_add_u32 m0, s23, 1024
    s_nop 0
    buffer_load_dwordx4 v249, s[80:83], s20 offen offset:0 sc1 lds
    s_add_u32 m0, s23, 2048
    s_nop 0
    buffer_load_dwordx4 v249, s[80:83], s20 offen offset:1024 sc1 lds
    s_add_u32 s20, s20, 8192
    s_cmp_eq_u32 s20, s22
    s_cselect_b32 s20, s21, s20
    s_add_u32 s42, s57, 4
    s_and_b32 s42, s42, 15
    s_mul_i32 s42, s42, 393216
    s_add_u32 s44, s40, s42
    s_addc_u32 s45, s41, 0
    s_load_dword s43, s[44:45], 0
    s_load_dword s43, s[44:45], 2048
    s_load_dword s43, s[44:45], 4096
    s_waitcnt vmcnt(9)
    s_barrier
    s_add_u32 m0, s19, 98816
    s_nop 0
    buffer_load_dwordx4 v10, s[8:11], s16 offen lds
    s_add_u32 m0, s19, 99840
    s_nop 0
    buffer_load_dwordx4 v11, s[8:11], s16 offen lds
    s_add_u32 m0, s19, 100864
    s_nop 0
    buffer_load_dwordx4 v12, s[8:11], s16 offen lds
    s_add_u32 s16, s16, 196608
    s_cmp_eq_u32 s16, s18
    s_cselect_b32 s16, s17, s16
    s_cmp_lg_u32 s69, 0
    s_cbranch_scc1 nh_3163
    s_add_u32 s64, s27, 65536
    s_and_b32 s64, s64, 0x3ffff
    s_mov_b32 m0, 18432
    s_add_u32 s64, s64, s26
    buffer_load_dwordx4 v249, s[80:83], s64 offen sc1 lds
nh_3163:
    s_add_u32 m0, s23, 18432
    s_nop 0
    buffer_load_dwordx4 v249, s[80:83], s20 offen offset:0 sc1 lds
    s_add_u32 m0, s23, 19456
    s_nop 0
    buffer_load_dwordx4 v249, s[80:83], s20 offen offset:1024 sc1 lds
    s_add_u32 s20, s20, 8192
    s_cmp_eq_u32 s20, s22
    s_cselect_b32 s20, s21, s20
    s_add_u32 m0, s19, 111232
    s_nop 0
    buffer_load_dwordx4 v10, s[8:11], s16 offen lds
    s_add_u32 m0, s19, 112256
    s_nop 0
    buffer_load_dwordx4 v11, s[8:11], s16 offen lds
    s_add_u32 m0, s19, 113280
    s_nop 0
    buffer_load_dwordx4 v12, s[8:11], s16 offen lds
    s_add_u32 s16, s16, 196608
    s_cmp_eq_u32 s16, s18
    s_cselect_b32 s16, s17, s16
    s_cmp_lg_u32 s69, 1
    s_cbranch_scc1 nh_3164
    s_add_u32 s64, s27, 73728
    s_and_b32 s64, s64, 0x3ffff
    s_mov_b32 m0, 19456
    s_add_u32 s64, s64, s26
    buffer_load_dwordx4 v249, s[80:83], s64 offen sc1 lds
nh_3164:
    s_add_u32 m0, s23, 19456
    s_nop 0
    buffer_load_dwordx4 v249, s[80:83], s20 offen offset:0 sc1 lds
    s_add_u32 m0, s23, 20480
    s_nop 0
    buffer_load_dwordx4 v249, s[80:83], s20 offen offset:1024 sc1 lds
    s_add_u32 s20, s20, 8192
    s_cmp_eq_u32 s20, s22
    s_cselect_b32 s20, s21, s20
    s_add_u32 s42, s57, 5
    s_and_b32 s42, s42, 15
    s_mul_i32 s42, s42, 393216
    s_add_u32 s44, s40, s42
    s_addc_u32 s45, s41, 0
    s_load_dword s43, s[44:45], 0
    s_load_dword s43, s[44:45], 2048
    s_load_dword s43, s[44:45], 4096
    s_waitcnt vmcnt(12)
    s_barrier
    s_add_u32 m0, s19, 123648
    s_nop 0
    buffer_load_dwordx4 v10, s[8:11], s16 offen lds
    s_add_u32 m0, s19, 124672
    s_nop 0
    buffer_load_dwordx4 v11, s[8:11], s16 offen lds
    s_add_u32 m0, s19, 125696
    s_nop 0
    buffer_load_dwordx4 v12, s[8:11], s16 offen lds
    s_add_u32 s16, s16, 196608
    s_cmp_eq_u32 s16, s18
    s_cselect_b32 s16, s17, s16
    s_cmp_lg_u32 s69, 2
    s_cbranch_scc1 nh_3165
    s_add_u32 s64, s27, 81920
    s_and_b32 s64, s64, 0x3ffff
    s_mov_b32 m0, 36864
    s_add_u32 s64, s64, s26
    buffer_load_dwordx4 v249, s[80:83], s64 offen sc1 lds
nh_3165:
    s_add_u32 m0, s23, 36864
    s_nop 0
    buffer_load_dwordx4 v249, s[80:83], s20 offen offset:0 sc1 lds
    s_add_u32 m0, s23, 37888
    s_nop 0
    buffer_load_dwordx4 v249, s[80:83], s20 offen offset:1024 sc1 lds
    s_add_u32 s20, s20, 8192
    s_cmp_eq_u32 s20, s22
    s_cselect_b32 s20, s21, s20
    s_add_u32 m0, s19, 136064
    s_nop 0
    buffer_load_dwordx4 v10, s[8:11], s16 offen lds
    s_add_u32 m0, s19, 137088
    s_nop 0
    buffer_load_dwordx4 v11, s[8:11], s16 offen lds
    s_add_u32 m0, s19, 138112
    s_nop 0
    buffer_load_dwordx4 v12, s[8:11], s16 offen lds
    s_add_u32 s16, s16, 196608
    s_cmp_eq_u32 s16, s18
    s_cselect_b32 s16, s17, s16
    s_cmp_lg_u32 s69, 3
    s_cbranch_scc1 nh_3166
    s_add_u32 s64, s27, 90112
    s_and_b32 s64, s64, 0x3ffff
    s_mov_b32 m0, 37888
    s_add_u32 s64, s64, s26
    buffer_load_dwordx4 v249, s[80:83], s64 offen sc1 lds
nh_3166:
    s_add_u32 m0, s23, 37888
    s_nop 0
    buffer_load_dwordx4 v249, s[80:83], s20 offen offset:0 sc1 lds
    s_add_u32 m0, s23, 38912
    s_nop 0
    buffer_load_dwordx4 v249, s[80:83], s20 offen offset:1024 sc1 lds
    s_add_u32 s20, s20, 8192
    s_cmp_eq_u32 s20, s22
    s_cselect_b32 s20, s21, s20
    s_add_u32 s42, s57, 6
    s_and_b32 s42, s42, 15
    s_mul_i32 s42, s42, 393216
    s_add_u32 s44, s40, s42
    s_addc_u32 s45, s41, 0
    s_load_dword s43, s[44:45], 0
    s_load_dword s43, s[44:45], 2048
    s_load_dword s43, s[44:45], 4096
    s_waitcnt vmcnt(12)
    s_barrier
    s_add_u32 m0, s19, 73984
    s_nop 0
    buffer_load_dwordx4 v10, s[8:11], s16 offen lds
    s_add_u32 m0, s19, 75008
    s_nop 0
    buffer_load_dwordx4 v11, s[8:11], s16 offen lds
    s_add_u32 m0, s19, 76032
    s_nop 0
    buffer_load_dwordx4 v12, s[8:11], s16 offen lds
    s_add_u32 s16, s16, 196608
    s_cmp_eq_u32 s16, s18
    s_cselect_b32 s16, s17, s16
    s_cmp_lg_u32 s69, 0
    s_cbranch_scc1 nh_3167
    s_add_u32 s64, s27, 98304
    s_and_b32 s64, s64, 0x3ffff
    s_mov_b32 m0, 55296
    s_add_u32 s64, s64, s26
    buffer_load_dwordx4 v249, s[80:83], s64 offen sc1 lds
nh_3167:
    s_add_u32 m0, s23, 55296
    s_nop 0
    buffer_load_dwordx4 v249, s[80:83], s20 offen offset:0 sc1 lds
    s_add_u32 m0, s23, 56320
    s_nop 0
    buffer_load_dwordx4 v249, s[80:83], s20 offen offset:1024 sc1 lds
    s_add_u32 s20, s20, 8192
    s_cmp_eq_u32 s20, s22
    s_cselect_b32 s20, s21, s20
    s_add_u32 m0, s19, 86400
    s_nop 0
    buffer_load_dwordx4 v10, s[8:11], s16 offen lds
    s_add_u32 m0, s19, 87424
    s_nop 0
    buffer_load_dwordx4 v11, s[8:11], s16 offen lds
    s_add_u32 m0, s19, 88448
    s_nop 0
    buffer_load_dwordx4 v12, s[8:11], s16 offen lds
    s_add_u32 s16, s16, 196608
    s_cmp_eq_u32 s16, s18
    s_cselect_b32 s16, s17, s16
    s_cmp_lg_u32 s69, 1
    s_cbranch_scc1 nh_3168
    s_add_u32 s64, s27, 106496
    s_and_b32 s64, s64, 0x3ffff
    s_mov_b32 m0, 56320
    s_add_u32 s64, s64, s26
    buffer_load_dwordx4 v249, s[80:83], s64 offen sc1 lds
nh_3168:
    s_add_u32 m0, s23, 56320
    s_nop 0
    buffer_load_dwordx4 v249, s[80:83], s20 offen offset:0 sc1 lds
    s_add_u32 m0, s23, 57344
    s_nop 0
    buffer_load_dwordx4 v249, s[80:83], s20 offen offset:1024 sc1 lds
    s_add_u32 s20, s20, 8192
    s_cmp_eq_u32 s20, s22
    s_cselect_b32 s20, s21, s20
    s_add_u32 s42, s57, 7
    s_and_b32 s42, s42, 15
    s_mul_i32 s42, s42, 393216
    s_add_u32 s44, s40, s42
    s_addc_u32 s45, s41, 0
    s_load_dword s43, s[44:45], 0
    s_load_dword s43, s[44:45], 2048
    s_load_dword s43, s[44:45], 4096
    s_waitcnt vmcnt(12)
    s_barrier
    s_add_u32 m0, s19, 98816
    s_nop 0
    buffer_load_dwordx4 v10, s[8:11], s16 offen lds
    s_add_u32 m0, s19, 99840
    s_nop 0
    buffer_load_dwordx4 v11, s[8:11], s16 offen lds
    s_add_u32 m0, s19, 100864
    s_nop 0
    buffer_load_dwordx4 v12, s[8:11], s16 offen lds
    s_add_u32 s16, s16, 196608
    s_cmp_eq_u32 s16, s18
    s_cselect_b32 s16, s17, s16
    s_cmp_lg_u32 s69, 2
    s_cbranch_scc1 nh_3169
    s_add_u32 s64, s27, 114688
    s_and_b32 s64, s64, 0x3ffff
    s_mov_b32 m0, 0
    s_add_u32 s64, s64, s26
    buffer_load_dwordx4 v249, s[80:83], s64 offen sc1 lds
nh_3169:
    s_add_u32 m0, s23, 0
    s_nop 0
    buffer_load_dwordx4 v249, s[80:83], s20 offen offset:0 sc1 lds
    s_add_u32 m0, s23, 1024
    s_nop 0
    buffer_load_dwordx4 v249, s[80:83], s20 offen offset:1024 sc1 lds
    s_add_u32 s20, s20, 8192
    s_cmp_eq_u32 s20, s22
    s_cselect_b32 s20, s21, s20
    s_add_u32 m0, s19, 111232
    s_nop 0
    buffer_load_dwordx4 v10, s[8:11], s16 offen lds
    s_add_u32 m0, s19, 112256
    s_nop 0
    buffer_load_dwordx4 v11, s[8:11], s16 offen lds
    s_add_u32 m0, s19, 113280
    s_nop 0
    buffer_load_dwordx4 v12, s[8:11], s16 offen lds
    s_add_u32 s16, s16, 196608
    s_cmp_eq_u32 s16, s18
    s_cselect_b32 s16, s17, s16
    s_cmp_lg_u32 s69, 3
    s_cbranch_scc1 nh_3170
    s_add_u32 s64, s27, 122880
    s_and_b32 s64, s64, 0x3ffff
    s_mov_b32 m0, 1024
    s_add_u32 s64, s64, s26
    buffer_load_dwordx4 v249, s[80:83], s64 offen sc1 lds
nh_3170:
    s_add_u32 m0, s23, 1024
    s_nop 0
    buffer_load_dwordx4 v249, s[80:83], s20 offen offset:0 sc1 lds
    s_add_u32 m0, s23, 2048
    s_nop 0
    buffer_load_dwordx4 v249, s[80:83], s20 offen offset:1024 sc1 lds
    s_add_u32 s20, s20, 8192
    s_cmp_eq_u32 s20, s22
    s_cselect_b32 s20, s21, s20
    s_add_u32 s42, s57, 8
    s_and_b32 s42, s42, 15
    s_mul_i32 s42, s42, 393216
    s_add_u32 s44, s40, s42
    s_addc_u32 s45, s41, 0
    s_load_dword s43, s[44:45], 0
    s_load_dword s43, s[44:45], 2048
    s_load_dword s43, s[44:45], 4096
    s_lshl_b32 s64, s28, 15
    s_add_u32 s64, s64, 71828352
    v_and_b32 v81, 7, v252
    v_lshlrev_b32 v81, 4, v81
    v_lshrrev_b32 v253, 3, v250
    v_lshl_add_u32 v81, v253, 12, v81
    s_cmp_lg_u32 s69, 3
    s_cbranch_scc1 hs_3171
    buffer_load_dwordx4 v[64:67], v81, s[80:83], s64 offen offset:0 sc1
    buffer_load_dwordx4 v[68:71], v81, s[80:83], s64 offen offset:1024 sc1
    buffer_load_dwordx4 v[72:75], v81, s[80:83], s64 offen offset:2048 sc1
    buffer_load_dwordx4 v[76:79], v81, s[80:83], s64 offen offset:3072 sc1
hs_3171:
    s_lshl_b32 s29, s67, 15
    s_lshl_b32 s65, s69, 8
    s_add_u32 s29, s29, s65
    s_add_u32 s29, s29, 71827456
    v_lshlrev_b32 v80, 4, v252
    v_lshl_add_u32 v80, v251, 13, v80
    s_waitcnt vmcnt(12)
    s_barrier
    s_add_u32 m0, s19, 123648
    s_nop 0
    buffer_load_dwordx4 v10, s[8:11], s16 offen lds
    s_add_u32 m0, s19, 124672
    s_nop 0
    buffer_load_dwordx4 v11, s[8:11], s16 offen lds
    s_add_u32 m0, s19, 125696
    s_nop 0
    buffer_load_dwordx4 v12, s[8:11], s16 offen lds
    s_add_u32 s16, s16, 196608
    s_cmp_eq_u32 s16, s18
    s_cselect_b32 s16, s17, s16
    s_cmp_lg_u32 s69, 0
    s_cbranch_scc1 nh_3172
    s_add_u32 s64, s27, 131072
    s_and_b32 s64, s64, 0x3ffff
    s_mov_b32 m0, 18432
    s_add_u32 s64, s64, s26
    buffer_load_dwordx4 v249, s[80:83], s64 offen sc1 lds
nh_3172:
    s_add_u32 m0, s23, 18432
    s_nop 0
    buffer_load_dwordx4 v249, s[80:83], s20 offen offset:0 sc1 lds
    s_add_u32 m0, s23, 19456
    s_nop 0
    buffer_load_dwordx4 v249, s[80:83], s20 offen offset:1024 sc1 lds
    s_add_u32 s20, s20, 8192
    s_cmp_eq_u32 s20, s22
    s_cselect_b32 s20, s21, s20
    s_add_u32 m0, s19, 136064
    s_nop 0
    buffer_load_dwordx4 v10, s[8:11], s16 offen lds
    s_add_u32 m0, s19, 137088
    s_nop 0
    buffer_load_dwordx4 v11, s[8:11], s16 offen lds
    s_add_u32 m0, s19, 138112
    s_nop 0
    buffer_load_dwordx4 v12, s[8:11], s16 offen lds
    s_add_u32 s16, s16, 196608
    s_cmp_eq_u32 s16, s18
    s_cselect_b32 s16, s17, s16
    s_cmp_lg_u32 s69, 1
    s_cbranch_scc1 nh_3173
    s_add_u32 s64, s27, 139264
    s_and_b32 s64, s64, 0x3ffff
    s_mov_b32 m0, 19456
    s_add_u32 s64, s64, s26
    buffer_load_dwordx4 v249, s[80:83], s64 offen sc1 lds
nh_3173:
    s_add_u32 m0, s23, 19456
    s_nop 0
    buffer_load_dwordx4 v249, s[80:83], s20 offen offset:0 sc1 lds
    s_add_u32 m0, s23, 20480
    s_nop 0
    buffer_load_dwordx4 v249, s[80:83], s20 offen offset:1024 sc1 lds
    s_add_u32 s20, s20, 8192
    s_cmp_eq_u32 s20, s22
    s_cselect_b32 s20, s21, s20
    s_add_u32 s42, s57, 9
    s_and_b32 s42, s42, 15
    s_mul_i32 s42, s42, 393216
    s_add_u32 s44, s40, s42
    s_addc_u32 s45, s41, 0
    s_load_dword s43, s[44:45], 0
    s_load_dword s43, s[44:45], 2048
    s_load_dword s43, s[44:45], 4096
    buffer_load_dwordx4 v[32:35], v80, s[80:83], s29 offen offset:0 sc1
    buffer_load_dwordx4 v[36:39], v80, s[80:83], s29 offen offset:1024 sc1
    s_add_u32 s29, s29, 2048
    s_waitcnt vmcnt(14)
    s_barrier
    s_add_u32 m0, s19, 73984
    s_nop 0
    buffer_load_dwordx4 v10, s[8:11], s16 offen lds
    s_add_u32 m0, s19, 75008
    s_nop 0
    buffer_load_dwordx4 v11, s[8:11], s16 offen lds
    s_add_u32 m0, s19, 76032
    s_nop 0
    buffer_load_dwordx4 v12, s[8:11], s16 offen lds
    s_add_u32 s16, s16, 196608
    s_cmp_eq_u32 s16, s18
    s_cselect_b32 s16, s17, s16
    s_cmp_lg_u32 s69, 2
    s_cbranch_scc1 nh_3174
    s_add_u32 s64, s27, 147456
    s_and_b32 s64, s64, 0x3ffff
    s_mov_b32 m0, 36864
    s_add_u32 s64, s64, s26
    buffer_load_dwordx4 v249, s[80:83], s64 offen sc1 lds
nh_3174:
    s_add_u32 m0, s23, 36864
    s_nop 0
    buffer_load_dwordx4 v249, s[80:83], s20 offen offset:0 sc1 lds
    s_add_u32 m0, s23, 37888
    s_nop 0
    buffer_load_dwordx4 v249, s[80:83], s20 offen offset:1024 sc1 lds
    s_add_u32 s20, s20, 8192
    s_cmp_eq_u32 s20, s22
    s_cselect_b32 s20, s21, s20
    s_add_u32 m0, s19, 86400
    s_nop 0
    buffer_load_dwordx4 v10, s[8:11], s16 offen lds
    s_add_u32 m0, s19, 87424
    s_nop 0
    buffer_load_dwordx4 v11, s[8:11], s16 offen lds
    s_add_u32 m0, s19, 88448
    s_nop 0
    buffer_load_dwordx4 v12, s[8:11], s16 offen lds
    s_add_u32 s16, s16, 196608
    s_cmp_eq_u32 s16, s18
    s_cselect_b32 s16, s17, s16
    s_cmp_lg_u32 s69, 3
    s_cbranch_scc1 nh_3175
    s_add_u32 s64, s27, 155648
    s_and_b32 s64, s64, 0x3ffff
    s_mov_b32 m0, 37888
    s_add_u32 s64, s64, s26
    buffer_load_dwordx4 v249, s[80:83], s64 offen sc1 lds
nh_3175:
    s_add_u32 m0, s23, 37888
    s_nop 0
    buffer_load_dwordx4 v249, s[80:83], s20 offen offset:0 sc1 lds
    s_add_u32 m0, s23, 38912
    s_nop 0
    buffer_load_dwordx4 v249, s[80:83], s20 offen offset:1024 sc1 lds
    s_add_u32 s20, s20, 8192
    s_cmp_eq_u32 s20, s22
    s_cselect_b32 s20, s21, s20
    s_add_u32 s42, s57, 10
    s_and_b32 s42, s42, 15
    s_mul_i32 s42, s42, 393216
    s_add_u32 s44, s40, s42
    s_addc_u32 s45, s41, 0
    s_load_dword s43, s[44:45], 0
    s_load_dword s43, s[44:45], 2048
    s_load_dword s43, s[44:45], 4096
    buffer_load_dwordx4 v[40:43], v80, s[80:83], s29 offen offset:0 sc1
    buffer_load_dwordx4 v[44:47], v80, s[80:83], s29 offen offset:1024 sc1
    s_add_u32 s29, s29, 2048
    s_waitcnt vmcnt(16)
    s_barrier
    s_add_u32 m0, s19, 98816
    s_nop 0
    buffer_load_dwordx4 v10, s[8:11], s16 offen lds
    s_add_u32 m0, s19, 99840
    s_nop 0
    buffer_load_dwordx4 v11, s[8:11], s16 offen lds
    s_add_u32 m0, s19, 100864
    s_nop 0
    buffer_load_dwordx4 v12, s[8:11], s16 offen lds
    s_add_u32 s16, s16, 196608
    s_cmp_eq_u32 s16, s18
    s_cselect_b32 s16, s17, s16
    s_cmp_lg_u32 s69, 0
    s_cbranch_scc1 nh_3176
    s_add_u32 s64, s27, 163840
    s_and_b32 s64, s64, 0x3ffff
    s_mov_b32 m0, 55296
    s_add_u32 s64, s64, s26
    buffer_load_dwordx4 v249, s[80:83], s64 offen sc1 lds
nh_3176:
    s_add_u32 m0, s23, 55296
    s_nop 0
    buffer_load_dwordx4 v249, s[80:83], s20 offen offset:0 sc1 lds
    s_add_u32 m0, s23, 56320
    s_nop 0
    buffer_load_dwordx4 v249, s[80:83], s20 offen offset:1024 sc1 lds
    s_add_u32 s20, s20, 8192
    s_cmp_eq_u32 s20, s22
    s_cselect_b32 s20, s21, s20
    s_add_u32 m0, s19, 111232
    s_nop 0
    buffer_load_dwordx4 v10, s[8:11], s16 offen lds
    s_add_u32 m0, s19, 112256
    s_nop 0
    buffer_load_dwordx4 v11, s[8:11], s16 offen lds
    s_add_u32 m0, s19, 113280
    s_nop 0
    buffer_load_dwordx4 v12, s[8:11], s16 offen lds
    s_add_u32 s16, s16, 196608
    s_cmp_eq_u32 s16, s18
    s_cselect_b32 s16, s17, s16
    s_cmp_lg_u32 s69, 1
    s_cbranch_scc1 nh_3177
    s_add_u32 s64, s27, 172032
    s_and_b32 s64, s64, 0x3ffff
    s_mov_b32 m0, 56320
    s_add_u32 s64, s64, s26
    buffer_load_dwordx4 v249, s[80:83], s64 offen sc1 lds
nh_3177:
    s_add_u32 m0, s23, 56320
    s_nop 0
    buffer_load_dwordx4 v249, s[80:83], s20 offen offset:0 sc1 lds
    s_add_u32 m0, s23, 57344
    s_nop 0
    buffer_load_dwordx4 v249, s[80:83], s20 offen offset:1024 sc1 lds
    s_add_u32 s20, s20, 8192
    s_cmp_eq_u32 s20, s22
    s_cselect_b32 s20, s21, s20
    s_add_u32 s42, s57, 11
    s_and_b32 s42, s42, 15
    s_mul_i32 s42, s42, 393216
    s_add_u32 s44, s40, s42
    s_addc_u32 s45, s41, 0
    s_load_dword s43, s[44:45], 0
    s_load_dword s43, s[44:45], 2048
    s_load_dword s43, s[44:45], 4096
    buffer_load_dwordx4 v[48:51], v80, s[80:83], s29 offen offset:0 sc1
    buffer_load_dwordx4 v[52:55], v80, s[80:83], s29 offen offset:1024 sc1
    s_add_u32 s29, s29, 2048
    s_waitcnt vmcnt(16)
    s_barrier
    s_add_u32 m0, s19, 123648
    s_nop 0
    buffer_load_dwordx4 v10, s[8:11], s16 offen lds
    s_add_u32 m0, s19, 124672
    s_nop 0
    buffer_load_dwordx4 v11, s[8:11], s16 offen lds
    s_add_u32 m0, s19, 125696
    s_nop 0
    buffer_load_dwordx4 v12, s[8:11], s16 offen lds
    s_add_u32 s16, s16, 196608
    s_cmp_eq_u32 s16, s18
    s_cselect_b32 s16, s17, s16
    s_cmp_lg_u32 s69, 2
    s_cbranch_scc1 nh_3178
    s_add_u32 s64, s27, 180224
    s_and_b32 s64, s64, 0x3ffff
    s_mov_b32 m0, 0
    s_add_u32 s64, s64, s26
    buffer_load_dwordx4 v249, s[80:83], s64 offen sc1 lds
nh_3178:
    s_add_u32 m0, s23, 0
    s_nop 0
    buffer_load_dwordx4 v249, s[80:83], s20 offen offset:0 sc1 lds
    s_add_u32 m0, s23, 1024
    s_nop 0
    buffer_load_dwordx4 v249, s[80:83], s20 offen offset:1024 sc1 lds
    s_add_u32 s20, s20, 8192
    s_cmp_eq_u32 s20, s22
    s_cselect_b32 s20, s21, s20
    s_add_u32 m0, s19, 136064
    s_nop 0
    buffer_load_dwordx4 v10, s[8:11], s16 offen lds
    s_add_u32 m0, s19, 137088
    s_nop 0
    buffer_load_dwordx4 v11, s[8:11], s16 offen lds
    s_add_u32 m0, s19, 138112
    s_nop 0
    buffer_load_dwordx4 v12, s[8:11], s16 offen lds
    s_add_u32 s16, s16, 196608
    s_cmp_eq_u32 s16, s18
    s_cselect_b32 s16, s17, s16
    s_cmp_lg_u32 s69, 3
    s_cbranch_scc1 nh_3179
    s_add_u32 s64, s27, 188416
    s_and_b32 s64, s64, 0x3ffff
    s_mov_b32 m0, 1024
    s_add_u32 s64, s64, s26
    buffer_load_dwordx4 v249, s[80:83], s64 offen sc1 lds
nh_3179:
    s_add_u32 m0, s23, 1024
    s_nop 0
    buffer_load_dwordx4 v249, s[80:83], s20 offen offset:0 sc1 lds
    s_add_u32 m0, s23, 2048
    s_nop 0
    buffer_load_dwordx4 v249, s[80:83], s20 offen offset:1024 sc1 lds
    s_add_u32 s20, s20, 8192
    s_cmp_eq_u32 s20, s22
    s_cselect_b32 s20, s21, s20
    s_add_u32 s42, s57, 12
    s_and_b32 s42, s42, 15
    s_mul_i32 s42, s42, 393216
    s_add_u32 s44, s40, s42
    s_addc_u32 s45, s41, 0
    s_load_dword s43, s[44:45], 0
    s_load_dword s43, s[44:45], 2048
    s_load_dword s43, s[44:45], 4096
    buffer_load_dwordx4 v[56:59], v80, s[80:83], s29 offen offset:0 sc1
    buffer_load_dwordx4 v[60:63], v80, s[80:83], s29 offen offset:1024 sc1
    s_add_u32 s29, s29, 2048
    s_waitcnt vmcnt(16)
    s_barrier
    s_add_u32 m0, s19, 73984
    s_nop 0
    buffer_load_dwordx4 v10, s[8:11], s16 offen lds
    s_add_u32 m0, s19, 75008
    s_nop 0
    buffer_load_dwordx4 v11, s[8:11], s16 offen lds
    s_add_u32 m0, s19, 76032
    s_nop 0
    buffer_load_dwordx4 v12, s[8:11], s16 offen lds
    s_add_u32 s16, s16, 196608
    s_cmp_eq_u32 s16, s18
    s_cselect_b32 s16, s17, s16
    s_cmp_lg_u32 s69, 0
    s_cbranch_scc1 nh_3180
    s_add_u32 s64, s27, 196608
    s_and_b32 s64, s64, 0x3ffff
    s_mov_b32 m0, 18432
    s_add_u32 s64, s64, s26
    buffer_load_dwordx4 v249, s[80:83], s64 offen sc1 lds
nh_3180:
    s_add_u32 m0, s23, 18432
    s_nop 0
    buffer_load_dwordx4 v249, s[80:83], s20 offen offset:0 sc1 lds
    s_add_u32 m0, s23, 19456
    s_nop 0
    buffer_load_dwordx4 v249, s[80:83], s20 offen offset:1024 sc1 lds
    s_add_u32 s20, s20, 8192
    s_cmp_eq_u32 s20, s22
    s_cselect_b32 s20, s21, s20
    s_add_u32 m0, s19, 86400
    s_nop 0
    buffer_load_dwordx4 v10, s[8:11], s16 offen lds
    s_add_u32 m0, s19, 87424
    s_nop 0
    buffer_load_dwordx4 v11, s[8:11], s16 offen lds
    s_add_u32 m0, s19, 88448
    s_nop 0
    buffer_load_dwordx4 v12, s[8:11], s16 offen lds
    s_add_u32 s16, s16, 196608
    s_cmp_eq_u32 s16, s18
    s_cselect_b32 s16, s17, s16
    s_cmp_lg_u32 s69, 1
    s_cbranch_scc1 nh_3181
    s_add_u32 s64, s27, 204800
    s_and_b32 s64, s64, 0x3ffff
    s_mov_b32 m0, 19456
    s_add_u32 s64, s64, s26
    buffer_load_dwordx4 v249, s[80:83], s64 offen sc1 lds
nh_3181:
    s_add_u32 m0, s23, 19456
    s_nop 0
    buffer_load_dwordx4 v249, s[80:83], s20 offen offset:0 sc1 lds
    s_add_u32 m0, s23, 20480
    s_nop 0
    buffer_load_dwordx4 v249, s[80:83], s20 offen offset:1024 sc1 lds
    s_add_u32 s20, s20, 8192
    s_cmp_eq_u32 s20, s22
    s_cselect_b32 s20, s21, s20
    s_add_u32 s42, s57, 13
    s_and_b32 s42, s42, 15
    s_mul_i32 s42, s42, 393216
    s_add_u32 s44, s40, s42
    s_addc_u32 s45, s41, 0
    s_load_dword s43, s[44:45], 0
    s_load_dword s43, s[44:45], 2048
    s_load_dword s43, s[44:45], 4096
    s_waitcnt vmcnt(14)
    s_barrier
    s_add_u32 m0, s19, 98816
    s_nop 0
    buffer_load_dwordx4 v10, s[8:11], s16 offen lds
    s_add_u32 m0, s19, 99840
    s_nop 0
    buffer_load_dwordx4 v11, s[8:11], s16 offen lds
    s_add_u32 m0, s19, 100864
    s_nop 0
    buffer_load_dwordx4 v12, s[8:11], s16 offen lds
    s_add_u32 s16, s16, 196608
    s_cmp_eq_u32 s16, s18
    s_cselect_b32 s16, s17, s16
    s_waitcnt vmcnt(13)
    s_lshl_b32 s29, s69, 8
    s_add_u32 s29, s29, 159872
    v_add_f32 v32, v32, v48
    v_add_f32 v33, v33, v49
    v_add_f32 v34, v34, v50
    v_add_f32 v35, v35, v51
    v_add_f32 v36, v36, v52
    v_add_f32 v37, v37, v53
    v_add_f32 v38, v38, v54
    v_add_f32 v39, v39, v55
    v_add_f32 v40, v40, v56
    v_add_f32 v41, v41, v57
    v_add_f32 v42, v42, v58
    v_add_f32 v43, v43, v59
    v_add_f32 v44, v44, v60
    v_add_f32 v45, v45, v61
    s_cmp_lg_u32 s69, 2
    s_cbranch_scc1 nh_3182
    s_add_u32 s64, s27, 212992
    s_and_b32 s64, s64, 0x3ffff
    s_mov_b32 m0, 36864
    s_add_u32 s64, s64, s26
    buffer_load_dwordx4 v249, s[80:83], s64 offen sc1 lds
nh_3182:
    s_add_u32 m0, s23, 36864
    s_nop 0
    buffer_load_dwordx4 v249, s[80:83], s20 offen offset:0 sc1 lds
    s_add_u32 m0, s23, 37888
    s_nop 0
    buffer_load_dwordx4 v249, s[80:83], s20 offen offset:1024 sc1 lds
    s_add_u32 s20, s20, 8192
    s_cmp_eq_u32 s20, s22
    s_cselect_b32 s20, s21, s20
    s_add_u32 m0, s19, 111232
    s_nop 0
    buffer_load_dwordx4 v10, s[8:11], s16 offen lds
    s_add_u32 m0, s19, 112256
    s_nop 0
    buffer_load_dwordx4 v11, s[8:11], s16 offen lds
    s_add_u32 m0, s19, 113280
    s_nop 0
    buffer_load_dwordx4 v12, s[8:11], s16 offen lds
    s_add_u32 s16, s16, 196608
    s_cmp_eq_u32 s16, s18
    s_cselect_b32 s16, s17, s16
    s_cmp_lg_u32 s69, 3
    s_cbranch_scc1 nh_3183
    s_add_u32 s64, s27, 221184
    s_and_b32 s64, s64, 0x3ffff
    s_mov_b32 m0, 37888
    s_add_u32 s64, s64, s26
    buffer_load_dwordx4 v249, s[80:83], s64 offen sc1 lds
nh_3183:
    s_add_u32 m0, s23, 37888
    s_nop 0
    buffer_load_dwordx4 v249, s[80:83], s20 offen offset:0 sc1 lds
    s_add_u32 m0, s23, 38912
    s_nop 0
    buffer_load_dwordx4 v249, s[80:83], s20 offen offset:1024 sc1 lds
    s_add_u32 s20, s20, 8192
    s_cmp_eq_u32 s20, s22
    s_cselect_b32 s20, s21, s20
    s_add_u32 s42, s57, 14
    s_and_b32 s42, s42, 15
    s_mul_i32 s42, s42, 393216
    s_add_u32 s44, s40, s42
    s_addc_u32 s45, s41, 0
    s_load_dword s43, s[44:45], 0
    s_load_dword s43, s[44:45], 2048
    s_load_dword s43, s[44:45], 4096
    s_waitcnt vmcnt(12)
    s_barrier
    s_add_u32 m0, s19, 123648
    s_nop 0
    buffer_load_dwordx4 v10, s[8:11], s16 offen lds
    s_add_u32 m0, s19, 124672
    s_nop 0
    buffer_load_dwordx4 v11, s[8:11], s16 offen lds
    s_add_u32 m0, s19, 125696
    s_nop 0
    buffer_load_dwordx4 v12, s[8:11], s16 offen lds
    s_add_u32 s16, s16, 196608
    s_cmp_eq_u32 s16, s18
    s_cselect_b32 s16, s17, s16
    v_add_f32 v46, v46, v62
    v_add_f32 v47, v47, v63
    v_add_f32 v32, v32, v40
    v_add_f32 v33, v33, v41
    v_add_f32 v34, v34, v42
    v_add_f32 v35, v35, v43
    v_add_f32 v36, v36, v44
    v_add_f32 v37, v37, v45
    v_add_f32 v38, v38, v46
    v_add_f32 v39, v39, v47
    v_add_f32 v32, v32, v36
    v_add_f32 v33, v33, v37
    v_add_f32 v34, v34, v38
    v_add_f32 v35, v35, v39
    v_and_b32 v80, 15, v252
    v_and_b32 v36, 1, v251
    s_cmp_lg_u32 s69, 0
    s_cbranch_scc1 nh_3184
    s_add_u32 s64, s27, 229376
    s_and_b32 s64, s64, 0x3ffff
    s_mov_b32 m0, 55296
    s_add_u32 s64, s64, s26
    buffer_load_dwordx4 v249, s[80:83], s64 offen sc1 lds
nh_3184:
    s_add_u32 m0, s23, 55296
    s_nop 0
    buffer_load_dwordx4 v249, s[80:83], s20 offen offset:0 sc1 lds
    s_add_u32 m0, s23, 56320
    s_nop 0
    buffer_load_dwordx4 v249, s[80:83], s20 offen offset:1024 sc1 lds
    s_add_u32 s20, s20, 8192
    s_cmp_eq_u32 s20, s22
    s_cselect_b32 s20, s21, s20
    s_add_u32 m0, s19, 136064
    s_nop 0
    buffer_load_dwordx4 v10, s[8:11], s16 offen lds
    s_add_u32 m0, s19, 137088
    s_nop 0
    buffer_load_dwordx4 v11, s[8:11], s16 offen lds
    s_add_u32 m0, s19, 138112
    s_nop 0
    buffer_load_dwordx4 v12, s[8:11], s16 offen lds
    s_add_u32 s16, s16, 196608
    s_cmp_eq_u32 s16, s18
    s_cselect_b32 s16, s17, s16
    s_cmp_lg_u32 s69, 1
    s_cbranch_scc1 nh_3185
    s_add_u32 s64, s27, 237568
    s_and_b32 s64, s64, 0x3ffff
    s_mov_b32 m0, 56320
    s_add_u32 s64, s64, s26
    buffer_load_dwordx4 v249, s[80:83], s64 offen sc1 lds
nh_3185:
    s_add_u32 m0, s23, 56320
    s_nop 0
    buffer_load_dwordx4 v249, s[80:83], s20 offen offset:0 sc1 lds
    s_add_u32 m0, s23, 57344
    s_nop 0
    buffer_load_dwordx4 v249, s[80:83], s20 offen offset:1024 sc1 lds
    s_add_u32 s20, s20, 8192
    s_cmp_eq_u32 s20, s22
    s_cselect_b32 s20, s21, s20
    s_add_u32 s42, s57, 15
    s_and_b32 s42, s42, 15
    s_mul_i32 s42, s42, 393216
    s_add_u32 s44, s40, s42
    s_addc_u32 s45, s41, 0
    s_load_dword s43, s[44:45], 0
    s_load_dword s43, s[44:45], 2048
    s_load_dword s43, s[44:45], 4096
    s_waitcnt vmcnt(12)
    s_barrier
    s_add_u32 m0, s19, 73984
    s_nop 0
    buffer_load_dwordx4 v10, s[8:11], s16 offen lds
    s_add_u32 m0, s19, 75008
    s_nop 0
    buffer_load_dwordx4 v11, s[8:11], s16 offen lds
    s_add_u32 m0, s19, 76032
    s_nop 0
    buffer_load_dwordx4 v12, s[8:11], s16 offen lds
    s_add_u32 s16, s16, 196608
    s_cmp_eq_u32 s16, s18
    s_cselect_b32 s16, s17, s16
    v_permlane16_swap_b32 v32, v34
    v_permlane16_swap_b32 v33, v35
    v_add_f32 v32, v32, v34
    v_add_f32 v33, v33, v35
    v_mov_b32 v34, v32
    v_mov_b32 v35, v33
    v_lshl_add_u32 v80, v80, 1, v36
    v_lshlrev_b32 v80, 3, v80
    v_permlane32_swap_b32 v32, v34
    v_permlane32_swap_b32 v33, v35
    v_add_f32 v32, v32, v34
    v_add_f32 v33, v33, v35
    v_mul_f32 v32, 0x3a800000, v32
    v_mul_f32 v33, 0x3a800000, v33
    s_cmp_lg_u32 s69, 2
    s_cbranch_scc1 nh_3186
    s_add_u32 s64, s27, 245760
    s_and_b32 s64, s64, 0x3ffff
    s_mov_b32 m0, 0
    s_add_u32 s64, s64, s26
    buffer_load_dwordx4 v249, s[80:83], s64 offen sc1 lds
nh_3186:
    s_add_u32 m0, s23, 0
    s_nop 0
    buffer_load_dwordx4 v249, s[80:83], s20 offen offset:0 sc1 lds
    s_add_u32 m0, s23, 1024
    s_nop 0
    buffer_load_dwordx4 v249, s[80:83], s20 offen offset:1024 sc1 lds
    s_add_u32 s20, s20, 8192
    s_cmp_eq_u32 s20, s22
    s_cselect_b32 s20, s21, s20
    s_add_u32 m0, s19, 86400
    s_nop 0
    buffer_load_dwordx4 v10, s[8:11], s16 offen lds
    s_add_u32 m0, s19, 87424
    s_nop 0
    buffer_load_dwordx4 v11, s[8:11], s16 offen lds
    s_add_u32 m0, s19, 88448
    s_nop 0
    buffer_load_dwordx4 v12, s[8:11], s16 offen lds
    s_add_u32 s16, s16, 196608
    s_cmp_eq_u32 s16, s18
    s_cselect_b32 s16, s17, s16
    s_cmp_lg_u32 s69, 3
    s_cbranch_scc1 nh_3187
    s_add_u32 s64, s27, 253952
    s_and_b32 s64, s64, 0x3ffff
    s_mov_b32 m0, 1024
    s_add_u32 s64, s64, s26
    buffer_load_dwordx4 v249, s[80:83], s64 offen sc1 lds
nh_3187:
    s_add_u32 m0, s23, 1024
    s_nop 0
    buffer_load_dwordx4 v249, s[80:83], s20 offen offset:0 sc1 lds
    s_add_u32 m0, s23, 2048
    s_nop 0
    buffer_load_dwordx4 v249, s[80:83], s20 offen offset:1024 sc1 lds
    s_add_u32 s20, s20, 8192
    s_cmp_eq_u32 s20, s22
    s_cselect_b32 s20, s21, s20
    s_waitcnt vmcnt(12)
    s_barrier
    s_add_u32 m0, s19, 98816
    s_nop 0
    buffer_load_dwordx4 v10, s[8:11], s16 offen lds
    s_add_u32 m0, s19, 99840
    s_nop 0
    buffer_load_dwordx4 v11, s[8:11], s16 offen lds
    s_add_u32 m0, s19, 100864
    s_nop 0
    buffer_load_dwordx4 v12, s[8:11], s16 offen lds
    s_add_u32 s16, s16, 196608
    s_cmp_eq_u32 s16, s18
    s_cselect_b32 s16, s17, s16
    s_lshl_b32 s64, s67, 4
    s_add_u32 s64, s64, s74
    s_lshl_b32 s64, s64, 2
    s_add_u32 s64, s64, s69
    s_lshl_b32 s64, s64, 12
    s_lshl_b32 s65, s75, 22
    s_add_u32 s64, s64, s65
    s_add_u32 s64, s64, 12582912
    s_cmp_eq_u32 s68, 0
    s_cselect_b32 s64, s64, 0x7f000000
    v_lshlrev_b32 v253, 7, v250
    s_mov_b64 exec, 0xffffffff
    buffer_load_dword v9, v253, s[80:83], s64 offen sc1
    s_mov_b64 exec, -1
    s_mov_b32 s12, s88
    s_mov_b32 s13, s89
    s_mov_b32 s14, 2097152
    s_mov_b32 s15, 0x00020000
    v_lshrrev_b32 v253, 3, v250
    v_lshlrev_b32 v253, 13, v253
    v_and_b32 v254, 7, v250
    v_lshl_add_u32 v253, v254, 4, v253
    s_lshl_b32 s64, s69, 11
    v_add_u32 v244, s64, v253
    s_mul_i32 s51, s69, 1056
    s_lshl_b32 s49, s72, 7
    s_add_u32 s48, s58, 0
    s_and_b32 s48, s48, 7
    s_and_b32 s66, s74, 8
    s_or_b32 s48, s48, s66
    s_lshl_b32 s48, s48, 17
    s_add_u32 s48, s48, s49
    s_add_u32 m0, s51, 116224
    s_nop 0
    buffer_load_dwordx4 v244, s[12:15], s48 offen lds
    s_add_u32 s48, s48, 65536
    s_waitcnt vmcnt(7)
    s_barrier
    v_fma_f32 v33, -v32, v32, v33
    v_max_f32 v33, 0, v33
    v_cvt_pk_bf16_f32 v32, v32, v32
    v_lshlrev_b32 v32, 16, v32
    v_cvt_pk_bf16_f32 v33, v33, v33
    v_lshlrev_b32 v33, 16, v33
    v_add_f32 v33, 0x3727c5ac, v33
    v_cvt_pk_bf16_f32 v33, v33, v33
    v_lshlrev_b32 v33, 16, v33
    v_sqrt_f32 v33, v33
    s_nop 0
    v_cvt_pk_bf16_f32 v33, v33, v33
    v_lshlrev_b32 v33, 16, v33
    v_rcp_f32 v33, v33
    s_nop 0
    v_add_u32 v80, s29, v80
    ds_write_b64 v80, v[32:33]
    s_add_u32 m0, s51, 120448
    s_nop 0
    buffer_load_dwordx4 v244, s[12:15], s48 offen lds
    s_add_u32 s48, s48, 65536
    s_add_u32 s48, s58, 1
    s_and_b32 s48, s48, 7
    s_and_b32 s66, s74, 8
    s_or_b32 s48, s48, s66
    s_lshl_b32 s48, s48, 17
    s_add_u32 s48, s48, s49
    s_add_u32 m0, s51, 124672
    s_nop 0
    buffer_load_dwordx4 v244, s[12:15], s48 offen lds
    s_add_u32 s48, s48, 65536
    s_add_u32 m0, s51, 128896
    s_nop 0
    buffer_load_dwordx4 v244, s[12:15], s48 offen lds
    s_add_u32 s48, s48, 65536
    s_add_u32 s48, s58, 2
    s_and_b32 s48, s48, 7
    s_and_b32 s66, s74, 8
    s_or_b32 s48, s48, s66
    s_lshl_b32 s48, s48, 17
    s_add_u32 s48, s48, s49
    s_add_u32 m0, s51, 133120
    s_nop 0
    buffer_load_dwordx4 v244, s[12:15], s48 offen lds
    s_add_u32 s48, s48, 65536
    s_add_u32 m0, s51, 137344
    s_nop 0
    buffer_load_dwordx4 v244, s[12:15], s48 offen lds
    s_add_u32 s48, s48, 65536
    s_add_u32 s48, s58, 3
    s_and_b32 s48, s48, 7
    s_and_b32 s66, s74, 8
    s_or_b32 s48, s48, s66
    s_lshl_b32 s48, s48, 17
    s_add_u32 s48, s48, s49
    s_add_u32 m0, s51, 141568
    s_nop 0
    buffer_load_dwordx4 v244, s[12:15], s48 offen lds
    s_add_u32 s48, s48, 65536
    s_add_u32 m0, s51, 145792
    s_nop 0
    buffer_load_dwordx4 v244, s[12:15], s48 offen lds
    s_add_u32 s48, s48, 65536
    s_add_u32 s48, s58, 4
    s_and_b32 s48, s48, 7
    s_and_b32 s66, s74, 8
    s_or_b32 s48, s48, s66
    s_lshl_b32 s48, s48, 17
    s_add_u32 s48, s48, s49
    s_add_u32 m0, s51, 150016
    s_nop 0
    buffer_load_dwordx4 v244, s[12:15], s48 offen lds
    s_add_u32 s48, s48, 65536
    s_waitcnt vmcnt(10)
    s_barrier
    s_cmp_lg_u32 s69, 3
    s_cbranch_scc1 hf_3188
    v_add_f32 v64, v64, v72
    v_add_f32 v65, v65, v73
    v_add_f32 v66, v66, v74
    v_add_f32 v67, v67, v75
    v_add_f32 v68, v68, v76
    v_add_f32 v69, v69, v77
    v_add_f32 v70, v70, v78
    v_add_f32 v71, v71, v79
    v_add_f32 v64, v64, v68
    v_add_f32 v65, v65, v69
    v_add_f32 v66, v66, v70
    v_add_f32 v67, v67, v71
    v_and_b32 v81, 7, v252
    v_and_b32 v68, 1, v251
    v_add_f32_dpp v64, v64, v64 row_ror:8 row_mask:0xf bank_mask:0xf
    v_add_f32_dpp v65, v65, v65 row_ror:8 row_mask:0xf bank_mask:0xf
    v_add_f32_dpp v66, v66, v66 row_ror:8 row_mask:0xf bank_mask:0xf
    v_add_f32_dpp v67, v67, v67 row_ror:8 row_mask:0xf bank_mask:0xf
    s_nop 0
    v_permlane16_swap_b32 v64, v66
    v_permlane16_swap_b32 v65, v67
    v_add_f32 v64, v64, v66
    v_add_f32 v65, v65, v67
    v_mov_b32 v66, v64
    v_mov_b32 v67, v65
    v_lshl_add_u32 v81, v81, 1, v68
    v_lshlrev_b32 v81, 3, v81
    v_permlane32_swap_b32 v64, v66
    v_permlane32_swap_b32 v65, v67
    v_add_f32 v64, v64, v66
    v_add_f32 v65, v65, v67
    v_mul_f32 v64, 0x3a800000, v64
    v_mul_f32 v65, 0x3a800000, v65
    v_fma_f32 v65, -v64, v64, v65
    v_max_f32 v65, 0, v65
    v_cvt_pk_bf16_f32 v64, v64, v64
    v_lshlrev_b32 v64, 16, v64
    v_cvt_pk_bf16_f32 v65, v65, v65
    v_lshlrev_b32 v65, 16, v65
    v_add_f32 v65, 0x3727c5ac, v65
    v_cvt_pk_bf16_f32 v65, v65, v65
    v_lshlrev_b32 v65, 16, v65
    v_sqrt_f32 v65, v65
    s_nop 0
    v_cvt_pk_bf16_f32 v65, v65, v65
    v_lshlrev_b32 v65, 16, v65
    v_rcp_f32 v65, v65
    s_nop 0
    v_add_u32 v81, 159744, v81
    ds_write_b64 v81, v[64:65]
hf_3188:
    s_add_u32 m0, s51, 154240
    s_nop 0
    buffer_load_dwordx4 v244, s[12:15], s48 offen lds
    s_add_u32 s48, s48, 65536
    s_add_u32 s48, s58, 5
    s_and_b32 s48, s48, 7
    s_and_b32 s66, s74, 8
    s_or_b32 s48, s48, s66
    s_lshl_b32 s48, s48, 17
    s_add_u32 s48, s48, s49
    s_add_u32 m0, s51, 65536
    s_nop 0
    buffer_load_dwordx4 v244, s[12:15], s48 offen lds
    s_add_u32 s48, s48, 65536
    s_add_u32 m0, s51, 69760
    s_nop 0
    buffer_load_dwordx4 v244, s[12:15], s48 offen lds
    s_add_u32 s48, s48, 65536
    s_add_u32 s48, s58, 6
    s_and_b32 s48, s48, 7
    s_and_b32 s66, s74, 8
    s_or_b32 s48, s48, s66
    s_lshl_b32 s48, s48, 17
    s_add_u32 s48, s48, s49
    s_add_u32 m0, s51, 73984
    s_nop 0
    buffer_load_dwordx4 v244, s[12:15], s48 offen lds
    s_add_u32 s48, s48, 65536
    s_add_u32 m0, s51, 78208
    s_nop 0
    buffer_load_dwordx4 v244, s[12:15], s48 offen lds
    s_add_u32 s48, s48, 65536
    s_waitcnt lgkmcnt(0)
    s_barrier
    s_add_u32 s48, s58, 7
    s_and_b32 s48, s48, 7
    s_and_b32 s66, s74, 8
    s_or_b32 s48, s48, s66
    s_lshl_b32 s48, s48, 17
    s_add_u32 s48, s48, s49
    s_add_u32 m0, s51, 82432
    s_nop 0
    buffer_load_dwordx4 v244, s[12:15], s48 offen lds
    s_add_u32 s48, s48, 65536
    s_add_u32 m0, s51, 86656
    s_nop 0
    buffer_load_dwordx4 v244, s[12:15], s48 offen lds
    s_add_u32 s48, s48, 65536
    s_add_u32 s48, s58, 8
    s_and_b32 s48, s48, 7
    s_and_b32 s66, s74, 8
    s_xor_b32 s66, s66, 8
    s_or_b32 s48, s48, s66
    s_lshl_b32 s48, s48, 17
    s_add_u32 s48, s48, s49
    s_add_u32 m0, s51, 90880
    s_nop 0
    buffer_load_dwordx4 v244, s[12:15], s48 offen lds
    s_add_u32 s48, s48, 65536
    s_add_u32 m0, s51, 95104
    s_nop 0
    buffer_load_dwordx4 v244, s[12:15], s48 offen lds
    s_add_u32 s48, s48, 65536
    s_add_u32 s48, s58, 9
    s_and_b32 s48, s48, 7
    s_and_b32 s66, s74, 8
    s_xor_b32 s66, s66, 8
    s_or_b32 s48, s48, s66
    s_lshl_b32 s48, s48, 17
    s_add_u32 s48, s48, s49
    s_add_u32 m0, s51, 99328
    s_nop 0
    buffer_load_dwordx4 v244, s[12:15], s48 offen lds
    s_add_u32 s48, s48, 65536
    s_add_u32 m0, s51, 103552
    s_nop 0
    buffer_load_dwordx4 v244, s[12:15], s48 offen lds
    s_add_u32 s48, s48, 65536
    s_add_u32 s48, s58, 10
    s_and_b32 s48, s48, 7
    s_and_b32 s66, s74, 8
    s_xor_b32 s66, s66, 8
    s_or_b32 s48, s48, s66
    s_lshl_b32 s48, s48, 17
    s_add_u32 s48, s48, s49
    s_add_u32 m0, s51, 107776
    s_nop 0
    buffer_load_dwordx4 v244, s[12:15], s48 offen lds
    s_add_u32 s48, s48, 65536
    s_add_u32 m0, s51, 112000
    s_nop 0
    buffer_load_dwordx4 v244, s[12:15], s48 offen lds
    s_add_u32 s48, s48, 65536
    s_branch L_g2
hs_30:
    buffer_load_dword v72, v71, s[28:31], 0 offen sc1
    s_sub_u32 s79, s79, 1
    s_cbranch_scc1 L_abort
    s_waitcnt vmcnt(0)
    v_and_b32 v73, 0x80808080, v72
    v_cmp_ne_u32 vcc, 0x80808080, v73
    s_cbranch_vccnz hs_30
    s_branch hs_30_b
pl_31_acq:
    buffer_inv sc1
    s_waitcnt vmcnt(0)
    s_branch pl_31_ok
rc_33:
    s_mov_b64 exec, 1
pl_134:
    buffer_load_dword v240, v246, s[80:83], s47 offen sc1
    s_sub_u32 s79, s79, 1
    s_cbranch_scc1 L_abort
    s_waitcnt vmcnt(0)
    v_cmp_ne_u32 vcc, 1, v240
    s_cbranch_vccnz pl_134
    s_mov_b64 exec, -1
    s_cmp_lg_u32 s78, 0
    s_cbranch_scc1 pl_134_acq
pl_134_ok:
    s_branch rc_33_b
pl_134_acq:
    buffer_inv sc1
    s_waitcnt vmcnt(0)
    s_branch pl_134_ok
pl_136_acq:
    buffer_inv sc1
    s_waitcnt vmcnt(0)
    s_branch pl_136_ok
pl_138_acq:
    buffer_inv sc1
    s_waitcnt vmcnt(0)
    s_branch pl_138_ok
cs_639:
    v_add_u32 v225, 28800, v224
    ds_read_b64_tr_b16 v[204:205], v225 offset:0
    ds_read_b64_tr_b16 v[206:207], v225 offset:3584
    ds_read_b64_tr_b16 v[208:209], v225 offset:32
    ds_read_b64_tr_b16 v[210:211], v225 offset:3616
    ds_read_b64_tr_b16 v[212:213], v225 offset:64
    ds_read_b64_tr_b16 v[214:215], v225 offset:3648
    ds_read_b64_tr_b16 v[216:217], v225 offset:96
    ds_read_b64_tr_b16 v[218:219], v225 offset:3680
    s_waitcnt lgkmcnt(0)
    v_mfma_f32_16x16x32_bf16 v[220:223], v[204:207], v[176:179], 0
    v_mfma_f32_16x16x32_bf16 v[220:223], v[208:211], v[180:183], v[220:223]
    v_mfma_f32_16x16x32_bf16 v[220:223], v[212:215], v[184:187], v[220:223]
    v_mfma_f32_16x16x32_bf16 v[220:223], v[216:219], v[188:191], v[220:223]
    s_nop 3
    ds_read_b64_tr_b16 v[204:205], v225 offset:128
    ds_read_b64_tr_b16 v[206:207], v225 offset:3712
    ds_read_b64_tr_b16 v[208:209], v225 offset:160
    ds_read_b64_tr_b16 v[210:211], v225 offset:3744
    ds_read_b64_tr_b16 v[212:213], v225 offset:192
    ds_read_b64_tr_b16 v[214:215], v225 offset:3776
    s_waitcnt lgkmcnt(0)
    v_mfma_f32_16x16x32_bf16 v[220:223], v[204:207], v[192:195], v[220:223]
    v_mfma_f32_16x16x32_bf16 v[220:223], v[208:211], v[196:199], v[220:223]
    v_mfma_f32_16x16x32_bf16 v[220:223], v[212:215], v[200:203], v[220:223]
    s_branch cs_639_b
cs_640:
    v_add_u32 v225, 57600, v224
    ds_read_b64_tr_b16 v[204:205], v225 offset:0
    ds_read_b64_tr_b16 v[206:207], v225 offset:3584
    ds_read_b64_tr_b16 v[208:209], v225 offset:32
    ds_read_b64_tr_b16 v[210:211], v225 offset:3616
    ds_read_b64_tr_b16 v[212:213], v225 offset:64
    ds_read_b64_tr_b16 v[214:215], v225 offset:3648
    ds_read_b64_tr_b16 v[216:217], v225 offset:96
    ds_read_b64_tr_b16 v[218:219], v225 offset:3680
    s_waitcnt lgkmcnt(0)
    v_mfma_f32_16x16x32_bf16 v[220:223], v[204:207], v[176:179], v[220:223]
    v_mfma_f32_16x16x32_bf16 v[220:223], v[208:211], v[180:183], v[220:223]
    v_mfma_f32_16x16x32_bf16 v[220:223], v[212:215], v[184:187], v[220:223]
    v_mfma_f32_16x16x32_bf16 v[220:223], v[216:219], v[188:191], v[220:223]
    s_nop 3
    ds_read_b64_tr_b16 v[204:205], v225 offset:128
    ds_read_b64_tr_b16 v[206:207], v225 offset:3712
    ds_read_b64_tr_b16 v[208:209], v225 offset:160
    ds_read_b64_tr_b16 v[210:211], v225 offset:3744
    ds_read_b64_tr_b16 v[212:213], v225 offset:192
    ds_read_b64_tr_b16 v[214:215], v225 offset:3776
    s_waitcnt lgkmcnt(0)
    v_mfma_f32_16x16x32_bf16 v[220:223], v[204:207], v[192:195], v[220:223]
    v_mfma_f32_16x16x32_bf16 v[220:223], v[208:211], v[196:199], v[220:223]
    v_mfma_f32_16x16x32_bf16 v[220:223], v[212:215], v[200:203], v[220:223]
    s_lshl_b32 s64, s34, 1
    s_and_b32 s65, s3, 1
    s_add_u32 s64, s64, s65
    s_mul_i32 s64, s64, 14336
    s_mul_i32 s65, s74, 896
    s_add_u32 s64, s64, s65
    s_lshr_b32 s65, s69, 1
    s_mul_i32 s65, s65, 448
    s_add_u32 s64, s64, s65
    s_add_u32 s64, s64, 74448896
    v_lshlrev_b32 v225, 4, v251
    v_lshl_add_u32 v225, v252, 6, v225
    s_mov_b32 exec_lo, 0x007f007f
    s_mov_b32 exec_hi, 0x007f007f
    buffer_store_dwordx4 v[220:223], v225, s[80:83], s64 offen sc0 sc1
    s_mov_b64 exec, -1
    s_waitcnt vmcnt(6) lgkmcnt(0)
    s_branch g3c1_pb2
cs_641:
    v_add_u32 v225, 86400, v224
    ds_read_b64_tr_b16 v[204:205], v225 offset:0
    ds_read_b64_tr_b16 v[206:207], v225 offset:3584
    ds_read_b64_tr_b16 v[208:209], v225 offset:32
    ds_read_b64_tr_b16 v[210:211], v225 offset:3616
    ds_read_b64_tr_b16 v[212:213], v225 offset:64
    ds_read_b64_tr_b16 v[214:215], v225 offset:3648
    ds_read_b64_tr_b16 v[216:217], v225 offset:96
    ds_read_b64_tr_b16 v[218:219], v225 offset:3680
    s_waitcnt lgkmcnt(0)
    v_mfma_f32_16x16x32_bf16 v[220:223], v[204:207], v[176:179], 0
    v_mfma_f32_16x16x32_bf16 v[220:223], v[208:211], v[180:183], v[220:223]
    v_mfma_f32_16x16x32_bf16 v[220:223], v[212:215], v[184:187], v[220:223]
    v_mfma_f32_16x16x32_bf16 v[220:223], v[216:219], v[188:191], v[220:223]
    s_nop 3
    ds_read_b64_tr_b16 v[204:205], v225 offset:128
    ds_read_b64_tr_b16 v[206:207], v225 offset:3712
    ds_read_b64_tr_b16 v[208:209], v225 offset:160
    ds_read_b64_tr_b16 v[210:211], v225 offset:3744
    ds_read_b64_tr_b16 v[212:213], v225 offset:192
    ds_read_b64_tr_b16 v[214:215], v225 offset:3776
    s_waitcnt lgkmcnt(0)
    v_mfma_f32_16x16x32_bf16 v[220:223], v[204:207], v[192:195], v[220:223]
    v_mfma_f32_16x16x32_bf16 v[220:223], v[208:211], v[196:199], v[220:223]
    v_mfma_f32_16x16x32_bf16 v[220:223], v[212:215], v[200:203], v[220:223]
    s_branch cs_641_b
cs_642:
    v_add_u32 v225, 0, v224
    ds_read_b64_tr_b16 v[204:205], v225 offset:0
    ds_read_b64_tr_b16 v[206:207], v225 offset:3584
    ds_read_b64_tr_b16 v[208:209], v225 offset:32
    ds_read_b64_tr_b16 v[210:211], v225 offset:3616
    ds_read_b64_tr_b16 v[212:213], v225 offset:64
    ds_read_b64_tr_b16 v[214:215], v225 offset:3648
    ds_read_b64_tr_b16 v[216:217], v225 offset:96
    ds_read_b64_tr_b16 v[218:219], v225 offset:3680
    s_waitcnt lgkmcnt(0)
    v_mfma_f32_16x16x32_bf16 v[220:223], v[204:207], v[176:179], v[220:223]
    v_mfma_f32_16x16x32_bf16 v[220:223], v[208:211], v[180:183], v[220:223]
    v_mfma_f32_16x16x32_bf16 v[220:223], v[212:215], v[184:187], v[220:223]
    v_mfma_f32_16x16x32_bf16 v[220:223], v[216:219], v[188:191], v[220:223]
    s_nop 3
    ds_read_b64_tr_b16 v[204:205], v225 offset:128
    ds_read_b64_tr_b16 v[206:207], v225 offset:3712
    ds_read_b64_tr_b16 v[208:209], v225 offset:160
    ds_read_b64_tr_b16 v[210:211], v225 offset:3744
    ds_read_b64_tr_b16 v[212:213], v225 offset:192
    ds_read_b64_tr_b16 v[214:215], v225 offset:3776
    s_waitcnt lgkmcnt(0)
    v_mfma_f32_16x16x32_bf16 v[220:223], v[204:207], v[192:195], v[220:223]
    v_mfma_f32_16x16x32_bf16 v[220:223], v[208:211], v[196:199], v[220:223]
    v_mfma_f32_16x16x32_bf16 v[220:223], v[212:215], v[200:203], v[220:223]
    s_lshl_b32 s64, s34, 1
    s_and_b32 s65, s3, 1
    s_add_u32 s64, s64, s65
    s_mul_i32 s64, s64, 14336
    s_mul_i32 s65, s74, 896
    s_add_u32 s64, s64, s65
    s_lshr_b32 s65, s69, 1
    s_mul_i32 s65, s65, 448
    s_add_u32 s64, s64, s65
    s_add_u32 s64, s64, 74448896
    v_lshlrev_b32 v225, 4, v251
    v_lshl_add_u32 v225, v252, 6, v225
    s_mov_b32 exec_lo, 0x007f007f
    s_mov_b32 exec_hi, 0x007f007f
    buffer_store_dwordx4 v[220:223], v225, s[80:83], s64 offen sc0 sc1
    s_mov_b64 exec, -1
    s_waitcnt vmcnt(6) lgkmcnt(0)
    s_branch g3c1_pb4
cs_643:
    v_add_u32 v225, 28800, v224
    ds_read_b64_tr_b16 v[204:205], v225 offset:0
    ds_read_b64_tr_b16 v[206:207], v225 offset:3584
    ds_read_b64_tr_b16 v[208:209], v225 offset:32
    ds_read_b64_tr_b16 v[210:211], v225 offset:3616
    ds_read_b64_tr_b16 v[212:213], v225 offset:64
    ds_read_b64_tr_b16 v[214:215], v225 offset:3648
    ds_read_b64_tr_b16 v[216:217], v225 offset:96
    ds_read_b64_tr_b16 v[218:219], v225 offset:3680
    s_waitcnt lgkmcnt(0)
    v_mfma_f32_16x16x32_bf16 v[220:223], v[204:207], v[176:179], 0
    v_mfma_f32_16x16x32_bf16 v[220:223], v[208:211], v[180:183], v[220:223]
    v_mfma_f32_16x16x32_bf16 v[220:223], v[212:215], v[184:187], v[220:223]
    v_mfma_f32_16x16x32_bf16 v[220:223], v[216:219], v[188:191], v[220:223]
    s_nop 3
    ds_read_b64_tr_b16 v[204:205], v225 offset:128
    ds_read_b64_tr_b16 v[206:207], v225 offset:3712
    ds_read_b64_tr_b16 v[208:209], v225 offset:160
    ds_read_b64_tr_b16 v[210:211], v225 offset:3744
    ds_read_b64_tr_b16 v[212:213], v225 offset:192
    ds_read_b64_tr_b16 v[214:215], v225 offset:3776
    s_waitcnt lgkmcnt(0)
    v_mfma_f32_16x16x32_bf16 v[220:223], v[204:207], v[192:195], v[220:223]
    v_mfma_f32_16x16x32_bf16 v[220:223], v[208:211], v[196:199], v[220:223]
    v_mfma_f32_16x16x32_bf16 v[220:223], v[212:215], v[200:203], v[220:223]
    s_branch cs_643_b
cs_644:
    v_add_u32 v225, 57600, v224
    ds_read_b64_tr_b16 v[204:205], v225 offset:0
    ds_read_b64_tr_b16 v[206:207], v225 offset:3584
    ds_read_b64_tr_b16 v[208:209], v225 offset:32
    ds_read_b64_tr_b16 v[210:211], v225 offset:3616
    ds_read_b64_tr_b16 v[212:213], v225 offset:64
    ds_read_b64_tr_b16 v[214:215], v225 offset:3648
    ds_read_b64_tr_b16 v[216:217], v225 offset:96
    ds_read_b64_tr_b16 v[218:219], v225 offset:3680
    s_waitcnt lgkmcnt(0)
    v_mfma_f32_16x16x32_bf16 v[220:223], v[204:207], v[176:179], v[220:223]
    v_mfma_f32_16x16x32_bf16 v[220:223], v[208:211], v[180:183], v[220:223]
    v_mfma_f32_16x16x32_bf16 v[220:223], v[212:215], v[184:187], v[220:223]
    v_mfma_f32_16x16x32_bf16 v[220:223], v[216:219], v[188:191], v[220:223]
    s_nop 3
    ds_read_b64_tr_b16 v[204:205], v225 offset:128
    ds_read_b64_tr_b16 v[206:207], v225 offset:3712
    ds_read_b64_tr_b16 v[208:209], v225 offset:160
    ds_read_b64_tr_b16 v[210:211], v225 offset:3744
    ds_read_b64_tr_b16 v[212:213], v225 offset:192
    ds_read_b64_tr_b16 v[214:215], v225 offset:3776
    s_waitcnt lgkmcnt(0)
    v_mfma_f32_16x16x32_bf16 v[220:223], v[204:207], v[192:195], v[220:223]
    v_mfma_f32_16x16x32_bf16 v[220:223], v[208:211], v[196:199], v[220:223]
    v_mfma_f32_16x16x32_bf16 v[220:223], v[212:215], v[200:203], v[220:223]
    s_lshl_b32 s64, s34, 1
    s_and_b32 s65, s3, 1
    s_add_u32 s64, s64, s65
    s_mul_i32 s64, s64, 14336
    s_mul_i32 s65, s74, 896
    s_add_u32 s64, s64, s65
    s_lshr_b32 s65, s69, 1
    s_mul_i32 s65, s65, 448
    s_add_u32 s64, s64, s65
    s_add_u32 s64, s64, 74448896
    v_lshlrev_b32 v225, 4, v251
    v_lshl_add_u32 v225, v252, 6, v225
    s_mov_b32 exec_lo, 0x007f007f
    s_mov_b32 exec_hi, 0x007f007f
    buffer_store_dwordx4 v[220:223], v225, s[80:83], s64 offen sc0 sc1
    s_mov_b64 exec, -1
    s_waitcnt vmcnt(6) lgkmcnt(0)
    s_branch g3c1_pb6
cs_645:
    v_add_u32 v225, 86400, v224
    ds_read_b64_tr_b16 v[204:205], v225 offset:0
    ds_read_b64_tr_b16 v[206:207], v225 offset:3584
    ds_read_b64_tr_b16 v[208:209], v225 offset:32
    ds_read_b64_tr_b16 v[210:211], v225 offset:3616
    ds_read_b64_tr_b16 v[212:213], v225 offset:64
    ds_read_b64_tr_b16 v[214:215], v225 offset:3648
    ds_read_b64_tr_b16 v[216:217], v225 offset:96
    ds_read_b64_tr_b16 v[218:219], v225 offset:3680
    s_waitcnt lgkmcnt(0)
    v_mfma_f32_16x16x32_bf16 v[220:223], v[204:207], v[176:179], 0
    v_mfma_f32_16x16x32_bf16 v[220:223], v[208:211], v[180:183], v[220:223]
    v_mfma_f32_16x16x32_bf16 v[220:223], v[212:215], v[184:187], v[220:223]
    v_mfma_f32_16x16x32_bf16 v[220:223], v[216:219], v[188:191], v[220:223]
    s_nop 3
    ds_read_b64_tr_b16 v[204:205], v225 offset:128
    ds_read_b64_tr_b16 v[206:207], v225 offset:3712
    ds_read_b64_tr_b16 v[208:209], v225 offset:160
    ds_read_b64_tr_b16 v[210:211], v225 offset:3744
    ds_read_b64_tr_b16 v[212:213], v225 offset:192
    ds_read_b64_tr_b16 v[214:215], v225 offset:3776
    s_waitcnt lgkmcnt(0)
    v_mfma_f32_16x16x32_bf16 v[220:223], v[204:207], v[192:195], v[220:223]
    v_mfma_f32_16x16x32_bf16 v[220:223], v[208:211], v[196:199], v[220:223]
    v_mfma_f32_16x16x32_bf16 v[220:223], v[212:215], v[200:203], v[220:223]
    s_branch cs_645_b
cs_646:
    v_add_u32 v225, 0, v224
    ds_read_b64_tr_b16 v[204:205], v225 offset:0
    ds_read_b64_tr_b16 v[206:207], v225 offset:3584
    ds_read_b64_tr_b16 v[208:209], v225 offset:32
    ds_read_b64_tr_b16 v[210:211], v225 offset:3616
    ds_read_b64_tr_b16 v[212:213], v225 offset:64
    ds_read_b64_tr_b16 v[214:215], v225 offset:3648
    ds_read_b64_tr_b16 v[216:217], v225 offset:96
    ds_read_b64_tr_b16 v[218:219], v225 offset:3680
    s_waitcnt lgkmcnt(0)
    v_mfma_f32_16x16x32_bf16 v[220:223], v[204:207], v[176:179], v[220:223]
    v_mfma_f32_16x16x32_bf16 v[220:223], v[208:211], v[180:183], v[220:223]
    v_mfma_f32_16x16x32_bf16 v[220:223], v[212:215], v[184:187], v[220:223]
    v_mfma_f32_16x16x32_bf16 v[220:223], v[216:219], v[188:191], v[220:223]
    s_nop 3
    ds_read_b64_tr_b16 v[204:205], v225 offset:128
    ds_read_b64_tr_b16 v[206:207], v225 offset:3712
    ds_read_b64_tr_b16 v[208:209], v225 offset:160
    ds_read_b64_tr_b16 v[210:211], v225 offset:3744
    ds_read_b64_tr_b16 v[212:213], v225 offset:192
    ds_read_b64_tr_b16 v[214:215], v225 offset:3776
    s_waitcnt lgkmcnt(0)
    v_mfma_f32_16x16x32_bf16 v[220:223], v[204:207], v[192:195], v[220:223]
    v_mfma_f32_16x16x32_bf16 v[220:223], v[208:211], v[196:199], v[220:223]
    v_mfma_f32_16x16x32_bf16 v[220:223], v[212:215], v[200:203], v[220:223]
    s_lshl_b32 s64, s34, 1
    s_and_b32 s65, s3, 1
    s_add_u32 s64, s64, s65
    s_mul_i32 s64, s64, 14336
    s_mul_i32 s65, s74, 896
    s_add_u32 s64, s64, s65
    s_lshr_b32 s65, s69, 1
    s_mul_i32 s65, s65, 448
    s_add_u32 s64, s64, s65
    s_add_u32 s64, s64, 74448896
    v_lshlrev_b32 v225, 4, v251
    v_lshl_add_u32 v225, v252, 6, v225
    s_mov_b32 exec_lo, 0x007f007f
    s_mov_b32 exec_hi, 0x007f007f
    buffer_store_dwordx4 v[220:223], v225, s[80:83], s64 offen sc0 sc1
    s_mov_b64 exec, -1
    s_waitcnt vmcnt(6) lgkmcnt(0)
    s_branch g3c1_pb8
cf_1147:
    s_lshl_b32 s64, s74, 4
    s_add_u32 s64, s64, s34
    s_lshl_b32 s64, s64, 3
    s_add_u32 s64, s64, s69
    s_lshl_b32 s64, s64, 2
    s_add_u32 s64, s64, 75587584
    v_mov_b32 v216, 0
    v_mov_b32 v217, 1
    s_mov_b64 exec, 1
    buffer_store_dword v217, v216, s[80:83], s64 offen sc0 sc1
    s_mov_b64 exec, -1
    s_branch cf_1147_b
g3c1_hook:
    s_lshl_b32 s64, s74, 9
    s_add_u32 s64, s64, 75587584
    v_lshlrev_b32 v225, 5, v252
    s_cmp_eq_u32 s24, 1
    s_cbranch_scc1 g3c1_h1
    buffer_load_dwordx4 v[216:219], v225, s[80:83], s64 offen sc1
    s_branch g3c1_hb
g3c1_h1:
    v_and_b32 v216, v216, v217
    v_and_b32 v218, v218, v219
    v_and_b32 v216, v216, v218
    v_cmp_ne_u32 vcc, 1, v216
    s_cbranch_vccz g3c1_h1b
    s_mov_b64 exec, 0xffff
pl_1648:
    buffer_load_dwordx4 v[216:219], v225, s[80:83], s64 offen sc1
    s_sub_u32 s79, s79, 1
    s_cbranch_scc1 L_abort
    s_waitcnt vmcnt(0)
    v_and_b32 v216, v216, v217
    v_and_b32 v218, v218, v219
    v_and_b32 v216, v216, v218
    v_cmp_ne_u32 vcc, 1, v216
    s_cbranch_vccnz pl_1648
    s_mov_b64 exec, -1
g3c1_h1b:
    s_branch g3c1_hb
sg_3150_slow:
    s_waitcnt vmcnt(0)
    buffer_wbl2 sc1
    s_waitcnt vmcnt(0)
    s_mov_b64 exec, 1
    buffer_store_dword v145, v144, s[80:83], s64 offen sc0 sc1
    s_mov_b64 exec, -1
    s_branch sg_3150_done
pl_3151_acq:
    buffer_inv sc1
    s_waitcnt vmcnt(0)
    s_branch pl_3151_ok
pl_3152_acq:
    buffer_inv sc1
    s_waitcnt vmcnt(0)
    s_branch pl_3152_ok
pl_3154_acq:
    buffer_inv sc1
    s_waitcnt vmcnt(0)
    s_branch pl_3154_ok
L_cons:
    s_mul_i32 s64, s3, 18432
    v_add_u32 v8, s64, v249
    v_mov_b32 v4, 0x3f803f80
    v_mov_b32 v5, 0x3f803f80
    v_mov_b32 v6, 0x3f803f80
    v_mov_b32 v7, 0x3f803f80
    s_mov_b64 exec, 0xff
    ds_write_b128 v8, v[4:7]
    s_mov_b64 exec, -1
    v_mov_b32 v0, 0
    s_waitcnt vmcnt(0)
    v_dot2_f32_bf16 v48, v16, v56, 0
    v_dot2_f32_bf16 v49, v16, v16, 0
    v_dot2_f32_bf16 v50, v24, v56, 0
    v_dot2_f32_bf16 v51, v24, v24, 0
    v_dot2_f32_bf16 v48, v17, v56, v48
    v_dot2_f32_bf16 v49, v17, v17, v49
    v_dot2_f32_bf16 v50, v25, v56, v50
    v_dot2_f32_bf16 v51, v25, v25, v51
    v_dot2_f32_bf16 v48, v18, v56, v48
    v_dot2_f32_bf16 v49, v18, v18, v49
    v_dot2_f32_bf16 v50, v26, v56, v50
    v_dot2_f32_bf16 v51, v26, v26, v51
    v_dot2_f32_bf16 v48, v19, v56, v48
    v_dot2_f32_bf16 v49, v19, v19, v49
    v_dot2_f32_bf16 v50, v27, v56, v50
    v_dot2_f32_bf16 v51, v27, v27, v51
    v_dot2_f32_bf16 v48, v20, v56, v48
    v_dot2_f32_bf16 v49, v20, v20, v49
    v_dot2_f32_bf16 v50, v28, v56, v50
    v_dot2_f32_bf16 v51, v28, v28, v51
    v_dot2_f32_bf16 v48, v21, v56, v48
    v_dot2_f32_bf16 v49, v21, v21, v49
    v_dot2_f32_bf16 v50, v29, v56, v50
    v_dot2_f32_bf16 v51, v29, v29, v51
    v_dot2_f32_bf16 v48, v22, v56, v48
    v_dot2_f32_bf16 v49, v22, v22, v49
    v_dot2_f32_bf16 v50, v30, v56, v50
    v_dot2_f32_bf16 v51, v30, v30, v51
    v_dot2_f32_bf16 v48, v23, v56, v48
    v_dot2_f32_bf16 v49, v23, v23, v49
    v_dot2_f32_bf16 v50, v31, v56, v50
    v_dot2_f32_bf16 v51, v31, v31, v51
    s_nop 2
    v_add_f32_dpp v48, v48, v48 quad_perm:[1,0,3,2] row_mask:0xf bank_mask:0xf
    v_add_f32_dpp v49, v49, v49 quad_perm:[1,0,3,2] row_mask:0xf bank_mask:0xf
    v_add_f32_dpp v50, v50, v50 quad_perm:[1,0,3,2] row_mask:0xf bank_mask:0xf
    v_add_f32_dpp v51, v51, v51 quad_perm:[1,0,3,2] row_mask:0xf bank_mask:0xf
    v_add_f32_dpp v48, v48, v48 quad_perm:[2,3,0,1] row_mask:0xf bank_mask:0xf
    v_add_f32_dpp v49, v49, v49 quad_perm:[2,3,0,1] row_mask:0xf bank_mask:0xf
    v_add_f32_dpp v50, v50, v50 quad_perm:[2,3,0,1] row_mask:0xf bank_mask:0xf
    v_add_f32_dpp v51, v51, v51 quad_perm:[2,3,0,1] row_mask:0xf bank_mask:0xf
    v_add_f32_dpp v48, v48, v48 row_half_mirror row_mask:0xf bank_mask:0xf
    v_add_f32_dpp v49, v49, v49 row_half_mirror row_mask:0xf bank_mask:0xf
    v_add_f32_dpp v50, v50, v50 row_half_mirror row_mask:0xf bank_mask:0xf
    v_add_f32_dpp v51, v51, v51 row_half_mirror row_mask:0xf bank_mask:0xf
    v_add_f32_dpp v48, v48, v48 row_mirror row_mask:0xf bank_mask:0xf
    v_add_f32_dpp v49, v49, v49 row_mirror row_mask:0xf bank_mask:0xf
    v_add_f32_dpp v50, v50, v50 row_mirror row_mask:0xf bank_mask:0xf
    v_add_f32_dpp v51, v51, v51 row_mirror row_mask:0xf bank_mask:0xf
    v_cmp_eq_u32 vcc, 1, v250
    v_mov_b32 v16, v48
    v_mov_b32 v17, v49
    v_mov_b32 v18, v50
    v_mov_b32 v19, v51
    s_nop 1
    v_permlane16_swap_b32 v48, v16
    v_permlane16_swap_b32 v49, v17
    v_permlane16_swap_b32 v50, v18
    v_permlane16_swap_b32 v51, v19
    v_add_f32 v48, v48, v16
    v_add_f32 v49, v49, v17
    v_add_f32 v50, v50, v18
    v_add_f32 v51, v51, v19
    v_mov_b32 v16, v48
    v_mov_b32 v17, v49
    v_mov_b32 v18, v50
    v_mov_b32 v19, v51
    s_nop 1
    v_permlane32_swap_b32 v48, v16
    v_permlane32_swap_b32 v49, v17
    v_permlane32_swap_b32 v50, v18
    v_permlane32_swap_b32 v51, v19
    v_add_f32 v48, v48, v16
    v_add_f32 v49, v49, v17
    v_add_f32 v50, v50, v18
    v_add_f32 v51, v51, v19
    v_cndmask_b32 v48, v48, v50, vcc
    v_cndmask_b32 v49, v49, v51, vcc
    v_mul_f32 v48, 0x3a800000, v48
    v_mul_f32 v49, 0x3a800000, v49
    v_fma_f32 v49, -v48, v48, v49
    v_max_f32 v49, 0, v49
    v_cvt_pk_bf16_f32 v48, v48, v48
    v_lshlrev_b32 v48, 16, v48
    v_cvt_pk_bf16_f32 v49, v49, v49
    v_lshlrev_b32 v49, 16, v49
    v_add_f32 v49, 0x3727c5ac, v49
    v_cvt_pk_bf16_f32 v49, v49, v49
    v_lshlrev_b32 v49, 16, v49
    v_sqrt_f32 v49, v49
    s_nop 0
    v_cvt_pk_bf16_f32 v49, v49, v49
    v_lshlrev_b32 v49, 16, v49
    v_rcp_f32 v49, v49
    s_nop 0
    v_lshlrev_b32 v16, 3, v250
    s_lshl_b32 s17, s73, 12
    s_lshl_b32 s16, s16, 5
    s_add_u32 s17, s17, s16
    s_add_u32 s17, s17, 74186752
    s_mov_b64 exec, 0xff
    buffer_store_dwordx2 v[48:49], v16, s[80:83], s17 offen sc0 sc1
    s_mov_b64 exec, -1
    s_cmp_lg_u32 s3, 3
    s_cbranch_scc1 L_noinit
    v_mov_b32 v0, 0
    v_mov_b32 v1, 0
    v_mov_b32 v2, 0
    v_mov_b32 v3, 0
    s_lshl_b32 s64, s2, 10
    s_add_u32 s64, s64, 75628544
    buffer_store_dwordx4 v[0:3], v249, s[80:83], s64 offen sc0 sc1
    s_mul_i32 s64, s2, 384
    s_add_u32 s64, s64, 75497472
    s_mov_b64 exec, 0xffffff
    buffer_store_dwordx4 v[0:3], v249, s[80:83], s64 offen sc0 sc1
    s_mov_b64 exec, -1
L_noinit:
    s_waitcnt lgkmcnt(0)
C_layer:
    s_and_b32 s19, s3, 1
    s_lshr_b32 s20, s3, 1
    s_cmp_lg_u32 s75, 0
    s_cbranch_scc1 ad_3189_f
    v_lshlrev_b32 v253, 7, v252
    v_and_b32 v254, 6, v250
    v_xor_b32 v254, v254, v251
    v_lshl_add_u32 v204, v254, 4, v253
    v_xor_b32 v205, 64, v204
    s_branch ad_3189_d
ad_3189_f:
    v_mov_b32 v204, v249
    v_add_u32 v205, 1024, v249
ad_3189_d:
    v_lshrrev_b32 v253, 2, v252
    v_mul_u32_u24 v253, 3104, v253
    v_lshl_add_u32 v253, v251, 7, v253
    v_and_b32 v254, 3, v252
    v_lshl_add_u32 v253, v254, 3, v253
    s_lshl_b32 s64, s19, 6
    s_add_u32 s64, s64, 73984
    v_add_u32 v208, s64, v253
    v_mov_b32 v209, v208
    s_mov_b32 s16, 0
    s_mov_b32 s17, 18432
    v_add_u32 v206, s17, v204
    v_add_u32 v207, s17, v205
    s_lshl_b32 s21, s67, 4
    s_add_u32 s21, s21, s74
    s_lshl_b32 s21, s21, 1
    s_add_u32 s21, s21, s19
    s_lshl_b32 s21, s21, 1
    s_add_u32 s21, s21, s20
    s_lshl_b32 s21, s21, 12
    s_lshl_b32 s64, s75, 22
    s_add_u32 s21, s21, s64
    s_add_u32 s21, s21, 12582912
    v_and_b32 v254, 1, v252
    v_cmp_eq_u32 s[28:29], 1, v254
    v_lshlrev_b32 v253, 2, v251
    v_sub_u32 v253, v252, v253
    v_sub_u32 v253, v253, v254
    v_lshlrev_b32 v254, 4, v254
    v_mov_b32 v210, 0xffff
    v_lshlrev_b32 v210, v254, v210
    v_cmp_le_i32 s[30:31], 0, v253
    v_cmp_le_i32 s[32:33], 2, v253
    s_or_b32 s22, s67, s20
    s_cmp_eq_u32 s22, 0
    s_cselect_b64 s[34:35], s[30:31], -1
    s_cselect_b64 s[36:37], s[32:33], -1
    v_cndmask_b32 v232, v210, 0, s[30:31]
    v_cndmask_b32 v234, 0, v210, s[30:31]
    v_cndmask_b32 v233, v210, 0, s[32:33]
    v_cndmask_b32 v235, 0, v210, s[32:33]
    s_mov_b32 s23, 0x3e8293ee
    s_mul_i32 s64, s19, 6144
    s_add_u32 s64, s64, 18432
    v_add_u32 v236, s64, v249
    s_mul_i32 s64, s19, 384
    s_add_u32 s64, s64, 162688
    v_lshlrev_b32 v237, 4, v251
    v_add_u32 v237, s64, v237
    v_lshlrev_b32 v238, 2, v252
    v_add_u32 v238, s64, v238
    s_lshl_b32 s64, s20, 9
    s_add_u32 s64, s64, 159744
    v_lshlrev_b32 v239, 3, v252
    v_add_u32 v239, s64, v239
    v_lshlrev_b32 v240, 5, v251
    v_add_u32 v240, s64, v240
    v_and_b32 v254, 1, v252
    v_lshl_add_u32 v254, v254, 3, v240
    v_mov_b32 v253, 128
    v_cndmask_b32 v244, 0, v253, s[30:31]
    v_add3_u32 v244, v244, v254, 4
    v_cndmask_b32 v245, 0, v253, s[32:33]
    v_add3_u32 v245, v245, v254, 20
    v_mov_b32 v241, 163456
    v_mov_b32 v212, 0
    v_mov_b32 v213, 0
    v_mov_b32 v214, 0
    v_mov_b32 v215, 0
    s_mov_b32 s18, 16
    s_nop 0
    v_mfma_f32_32x32x16_bf16 v[0:15], v[212:215], v[212:215], 0
    v_mfma_f32_32x32x16_bf16 v[16:31], v[212:215], v[212:215], 0
    v_mfma_f32_32x32x16_bf16 v[32:47], v[212:215], v[212:215], 0
    v_mfma_f32_32x32x16_bf16 v[48:63], v[212:215], v[212:215], 0
    v_mfma_f32_32x32x16_bf16 v[64:79], v[212:215], v[212:215], 0
    v_mfma_f32_32x32x16_bf16 v[80:95], v[212:215], v[212:215], 0
    v_mfma_f32_32x32x16_bf16 v[96:111], v[212:215], v[212:215], 0
    v_mfma_f32_32x32x16_bf16 v[112:127], v[212:215], v[212:215], 0
    s_nop 7
    s_nop 3
    s_lshl_b32 s64, s75, 1
    s_add_u32 s64, s64, s20
    s_cmp_eq_u32 s64, 1
    s_cbranch_scc1 g1c_v1
    s_cmp_eq_u32 s64, 2
    s_cbranch_scc1 g1c_v2
    s_cmp_eq_u32 s64, 3
    s_cbranch_scc1 g1c_v3
    s_barrier
    ds_read_b128 v[116:119], v206 offset:0
    ds_read_b64_tr_b16 v[172:173], v209 offset:14464
    ds_read_b64_tr_b16 v[174:175], v209 offset:14976
    ds_read_b128 v[132:135], v206 offset:8192
    ds_read_b64_tr_b16 v[176:177], v209 offset:14496
    ds_read_b64_tr_b16 v[178:179], v209 offset:15008
    ds_read_b128 v[128:131], v206 offset:6144
    ds_read_b64_tr_b16 v[168:169], v209 offset:13472
    ds_read_b64_tr_b16 v[170:171], v209 offset:13984
    ds_read_b128 v[124:127], v206 offset:4096
    ds_read_b64_tr_b16 v[164:165], v209 offset:13440
    ds_read_b64_tr_b16 v[166:167], v209 offset:13952
    ds_read_b128 v[120:123], v206 offset:2048
    ds_read_b64_tr_b16 v[156:157], v209 offset:12416
    ds_read_b64_tr_b16 v[158:159], v209 offset:12928
    ds_read_b64_tr_b16 v[160:161], v209 offset:12448
    ds_read_b64_tr_b16 v[162:163], v209 offset:12960
    s_add_u32 s16, s16, 24832
    s_cmp_eq_u32 s16, 74496
    s_cselect_b32 s16, 0, s16
    v_add_u32 v209, s16, v208
    s_waitcnt lgkmcnt(0)
    s_branch g1c_ent0
g1c_loop0:
    v_mfma_f32_16x16x32_bf16 v[104:107], v[152:155], v[196:199], v[104:107]
    ds_read_b128 v[116:119], v206 offset:0
    v_mfma_f32_16x16x32_bf16 v[96:99], v[148:151], v[196:199], v[96:99]
    ds_read_b64_tr_b16 v[172:173], v209 offset:14464
    v_mfma_f32_16x16x32_bf16 v[88:91], v[144:147], v[196:199], v[88:91]
    ds_read_b64_tr_b16 v[174:175], v209 offset:14976
    v_mfma_f32_16x16x32_bf16 v[80:83], v[140:143], v[196:199], v[80:83]
    ds_read_b128 v[132:135], v206 offset:8192
    v_mfma_f32_16x16x32_bf16 v[84:87], v[140:143], v[200:203], v[84:87]
    ds_read_b64_tr_b16 v[176:177], v209 offset:14496
    v_mfma_f32_16x16x32_bf16 v[92:95], v[144:147], v[200:203], v[92:95]
    ds_read_b64_tr_b16 v[178:179], v209 offset:15008
    v_mfma_f32_16x16x32_bf16 v[100:103], v[148:151], v[200:203], v[100:103]
    ds_read_b128 v[128:131], v206 offset:6144
    v_mfma_f32_16x16x32_bf16 v[108:111], v[152:155], v[200:203], v[108:111]
    ds_read_b64_tr_b16 v[168:169], v209 offset:13472
    v_mfma_f32_16x16x32_bf16 v[112:115], v[180:183], v[136:139], v[112:115]
    ds_read_b64_tr_b16 v[170:171], v209 offset:13984
    v_mfma_f32_16x16x32_bf16 v[36:39], v[192:195], v[136:139], v[36:39]
    ds_read_b128 v[124:127], v206 offset:4096
    v_mfma_f32_16x16x32_bf16 v[32:35], v[188:191], v[136:139], v[32:35]
    ds_read_b64_tr_b16 v[164:165], v209 offset:13440
    v_mfma_f32_16x16x32_bf16 v[64:67], v[188:191], v[152:155], v[64:67]
    ds_read_b64_tr_b16 v[166:167], v209 offset:13952
    v_mfma_f32_16x16x32_bf16 v[56:59], v[188:191], v[148:151], v[56:59]
    ds_read_b128 v[120:123], v206 offset:2048
    v_mfma_f32_16x16x32_bf16 v[48:51], v[188:191], v[144:147], v[48:51]
    ds_read_b64_tr_b16 v[156:157], v209 offset:12416
    v_mfma_f32_16x16x32_bf16 v[40:43], v[188:191], v[140:143], v[40:43]
    ds_read_b64_tr_b16 v[158:159], v209 offset:12928
    v_mfma_f32_16x16x32_bf16 v[44:47], v[192:195], v[140:143], v[44:47]
    ds_read_b64_tr_b16 v[160:161], v209 offset:12448
    v_mfma_f32_16x16x32_bf16 v[52:55], v[192:195], v[144:147], v[52:55]
    ds_read_b64_tr_b16 v[162:163], v209 offset:12960
    v_mfma_f32_16x16x32_bf16 v[60:63], v[192:195], v[148:151], v[60:63]
    v_mfma_f32_16x16x32_bf16 v[68:71], v[192:195], v[152:155], v[68:71]
    s_add_u32 s16, s16, 24832
    s_cmp_eq_u32 s16, 74496
    v_mfma_f32_16x16x32_bf16 v[24:27], v[180:183], v[152:155], v[24:27]
    v_mfma_f32_16x16x32_bf16 v[16:19], v[180:183], v[148:151], v[16:19]
    s_cselect_b32 s16, 0, s16
    v_mfma_f32_16x16x32_bf16 v[8:11], v[180:183], v[144:147], v[8:11]
    v_mfma_f32_16x16x32_bf16 v[0:3], v[180:183], v[140:143], v[0:3]
    v_mfma_f32_16x16x32_bf16 v[4:7], v[184:187], v[140:143], v[4:7]
    v_add_u32 v209, s16, v208
    v_mfma_f32_16x16x32_bf16 v[12:15], v[184:187], v[144:147], v[12:15]
    v_mfma_f32_16x16x32_bf16 v[20:23], v[184:187], v[148:151], v[20:23]
    v_mfma_f32_16x16x32_bf16 v[28:31], v[184:187], v[152:155], v[28:31]
    s_waitcnt vmcnt(0) lgkmcnt(0)
g1c_ent0:
    s_barrier
    v_mfma_f32_16x16x32_bf16 v[104:107], v[132:135], v[172:175], v[104:107]
    ds_read_b128 v[136:139], v207 offset:0
    v_mfma_f32_16x16x32_bf16 v[96:99], v[128:131], v[172:175], v[96:99]
    ds_read_b64_tr_b16 v[196:197], v209 offset:2048
    v_mfma_f32_16x16x32_bf16 v[88:91], v[124:127], v[172:175], v[88:91]
    ds_read_b64_tr_b16 v[198:199], v209 offset:2560
    v_mfma_f32_16x16x32_bf16 v[80:83], v[120:123], v[172:175], v[80:83]
    ds_read_b128 v[152:155], v207 offset:8192
    v_mfma_f32_16x16x32_bf16 v[84:87], v[120:123], v[176:179], v[84:87]
    ds_read_b64_tr_b16 v[200:201], v209 offset:2080
    v_mfma_f32_16x16x32_bf16 v[92:95], v[124:127], v[176:179], v[92:95]
    ds_read_b64_tr_b16 v[202:203], v209 offset:2592
    v_mfma_f32_16x16x32_bf16 v[100:103], v[128:131], v[176:179], v[100:103]
    ds_read_b128 v[148:151], v207 offset:6144
    v_mfma_f32_16x16x32_bf16 v[108:111], v[132:135], v[176:179], v[108:111]
    ds_read_b64_tr_b16 v[192:193], v209 offset:1056
    v_mfma_f32_16x16x32_bf16 v[112:115], v[156:159], v[116:119], v[112:115]
    ds_read_b64_tr_b16 v[194:195], v209 offset:1568
    v_mfma_f32_16x16x32_bf16 v[36:39], v[168:171], v[116:119], v[36:39]
    ds_read_b128 v[144:147], v207 offset:4096
    v_mfma_f32_16x16x32_bf16 v[32:35], v[164:167], v[116:119], v[32:35]
    ds_read_b64_tr_b16 v[188:189], v209 offset:1024
    v_mfma_f32_16x16x32_bf16 v[64:67], v[164:167], v[132:135], v[64:67]
    ds_read_b64_tr_b16 v[190:191], v209 offset:1536
    v_mfma_f32_16x16x32_bf16 v[56:59], v[164:167], v[128:131], v[56:59]
    ds_read_b128 v[140:143], v207 offset:2048
    v_mfma_f32_16x16x32_bf16 v[48:51], v[164:167], v[124:127], v[48:51]
    ds_read_b64_tr_b16 v[180:181], v209 offset:0
    v_mfma_f32_16x16x32_bf16 v[40:43], v[164:167], v[120:123], v[40:43]
    ds_read_b64_tr_b16 v[182:183], v209 offset:512
    v_mfma_f32_16x16x32_bf16 v[44:47], v[168:171], v[120:123], v[44:47]
    ds_read_b64_tr_b16 v[184:185], v209 offset:32
    v_mfma_f32_16x16x32_bf16 v[52:55], v[168:171], v[124:127], v[52:55]
    ds_read_b64_tr_b16 v[186:187], v209 offset:544
    v_mfma_f32_16x16x32_bf16 v[60:63], v[168:171], v[128:131], v[60:63]
    v_mfma_f32_16x16x32_bf16 v[68:71], v[168:171], v[132:135], v[68:71]
    s_add_u32 s17, s17, 18432
    s_cmp_eq_u32 s17, 73728
    v_mfma_f32_16x16x32_bf16 v[24:27], v[156:159], v[132:135], v[24:27]
    s_cselect_b32 s17, 0, s17
    v_mfma_f32_16x16x32_bf16 v[16:19], v[156:159], v[128:131], v[16:19]
    v_mfma_f32_16x16x32_bf16 v[8:11], v[156:159], v[124:127], v[8:11]
    v_add_u32 v206, s17, v204
    v_mfma_f32_16x16x32_bf16 v[0:3], v[156:159], v[120:123], v[0:3]
    v_add_u32 v207, s17, v205
    v_mfma_f32_16x16x32_bf16 v[4:7], v[160:163], v[120:123], v[4:7]
    v_mfma_f32_16x16x32_bf16 v[12:15], v[160:163], v[124:127], v[12:15]
    s_sub_u32 s18, s18, 1
    s_cmp_lg_u32 s18, 0
    v_mfma_f32_16x16x32_bf16 v[20:23], v[160:163], v[128:131], v[20:23]
    v_mfma_f32_16x16x32_bf16 v[28:31], v[160:163], v[132:135], v[28:31]
    s_waitcnt lgkmcnt(0)
    s_cbranch_scc1 g1c_loop0
    v_mfma_f32_16x16x32_bf16 v[112:115], v[180:183], v[136:139], v[112:115]
    v_mfma_f32_16x16x32_bf16 v[36:39], v[192:195], v[136:139], v[36:39]
    v_mfma_f32_16x16x32_bf16 v[32:35], v[188:191], v[136:139], v[32:35]
    v_mfma_f32_16x16x32_bf16 v[64:67], v[188:191], v[152:155], v[64:67]
    v_mfma_f32_16x16x32_bf16 v[68:71], v[192:195], v[152:155], v[68:71]
    v_mfma_f32_16x16x32_bf16 v[108:111], v[152:155], v[200:203], v[108:111]
    v_mfma_f32_16x16x32_bf16 v[104:107], v[152:155], v[196:199], v[104:107]
    v_mfma_f32_16x16x32_bf16 v[24:27], v[180:183], v[152:155], v[24:27]
    v_mfma_f32_16x16x32_bf16 v[16:19], v[180:183], v[148:151], v[16:19]
    v_mfma_f32_16x16x32_bf16 v[8:11], v[180:183], v[144:147], v[8:11]
    v_mfma_f32_16x16x32_bf16 v[0:3], v[180:183], v[140:143], v[0:3]
    v_mfma_f32_16x16x32_bf16 v[4:7], v[184:187], v[140:143], v[4:7]
    s_mov_b32 exec_lo, 0x00010001
    s_mov_b32 exec_hi, 0x00010001
    ds_write_b128 v237, v[112:115]
    ds_write_b128 v237, v[32:35] offset:128
    ds_write_b128 v237, v[36:39] offset:192
    s_mov_b64 exec, -1
    v_mfma_f32_16x16x32_bf16 v[12:15], v[184:187], v[144:147], v[12:15]
    ds_write_b128 v236, v[64:67] offset:0
    v_mfma_f32_16x16x32_bf16 v[20:23], v[184:187], v[148:151], v[20:23]
    ds_write_b128 v236, v[68:71] offset:1024
    v_mfma_f32_16x16x32_bf16 v[28:31], v[184:187], v[152:155], v[28:31]
    ds_write_b128 v236, v[108:111] offset:3072
    v_mfma_f32_16x16x32_bf16 v[56:59], v[188:191], v[148:151], v[56:59]
    ds_write_b128 v236, v[104:107] offset:2048
    v_mfma_f32_16x16x32_bf16 v[48:51], v[188:191], v[144:147], v[48:51]
    v_mfma_f32_16x16x32_bf16 v[40:43], v[188:191], v[140:143], v[40:43]
    v_mfma_f32_16x16x32_bf16 v[44:47], v[192:195], v[140:143], v[44:47]
    s_waitcnt lgkmcnt(0)
    s_barrier
    ds_read_b128 v[116:119], v237 offset:0
    ds_read_b128 v[120:123], v237 offset:64
    v_mfma_f32_16x16x32_bf16 v[52:55], v[192:195], v[144:147], v[52:55]
    ds_read2_b32 v[158:159], v239 offset0:32 offset1:32
    v_mfma_f32_16x16x32_bf16 v[60:63], v[192:195], v[148:151], v[60:63]
    ds_read2_b32 v[160:161], v239 offset0:64 offset1:64
    ds_read2_b32 v[162:163], v239 offset0:96 offset1:96
    v_mfma_f32_16x16x32_bf16 v[96:99], v[148:151], v[196:199], v[96:99]
    ds_read2_b32 v[164:165], v239 offset0:128 offset1:128
    v_mfma_f32_16x16x32_bf16 v[88:91], v[144:147], v[196:199], v[88:91]
    ds_read_b128 v[124:127], v237 offset:128
    v_mfma_f32_16x16x32_bf16 v[80:83], v[140:143], v[196:199], v[80:83]
    ds_read_b128 v[128:131], v237 offset:192
    ds_read2_b32 v[156:157], v239 offset0:0 offset1:0
    v_mfma_f32_16x16x32_bf16 v[84:87], v[140:143], v[200:203], v[84:87]
    ds_read_b128 v[72:75], v236 offset:4096
    v_mfma_f32_16x16x32_bf16 v[92:95], v[144:147], v[200:203], v[92:95]
    ds_read_b128 v[76:79], v236 offset:5120
    v_mfma_f32_16x16x32_bf16 v[100:103], v[148:151], v[200:203], v[100:103]
    s_waitcnt lgkmcnt(3)
    s_branch g1c_epi
g1c_v1:
    s_barrier
    ds_read_b128 v[116:119], v206 offset:0
    ds_read_b64_tr_b16 v[172:173], v209 offset:14464
    ds_read_b64_tr_b16 v[174:175], v209 offset:14976
    ds_read_b128 v[132:135], v206 offset:16384
    ds_read_b64_tr_b16 v[176:177], v209 offset:14496
    ds_read_b64_tr_b16 v[178:179], v209 offset:15008
    ds_read_b128 v[128:131], v206 offset:14336
    ds_read_b64_tr_b16 v[168:169], v209 offset:13472
    ds_read_b64_tr_b16 v[170:171], v209 offset:13984
    ds_read_b128 v[124:127], v206 offset:12288
    ds_read_b64_tr_b16 v[164:165], v209 offset:13440
    ds_read_b64_tr_b16 v[166:167], v209 offset:13952
    ds_read_b128 v[120:123], v206 offset:10240
    ds_read_b64_tr_b16 v[156:157], v209 offset:12416
    ds_read_b64_tr_b16 v[158:159], v209 offset:12928
    ds_read_b64_tr_b16 v[160:161], v209 offset:12448
    ds_read_b64_tr_b16 v[162:163], v209 offset:12960
    s_add_u32 s16, s16, 24832
    s_cmp_eq_u32 s16, 74496
    s_cselect_b32 s16, 0, s16
    v_add_u32 v209, s16, v208
    s_waitcnt lgkmcnt(0)
    s_branch g1c_ent1
g1c_loop1:
    v_mfma_f32_16x16x32_bf16 v[112:115], v[184:187], v[136:139], v[112:115]
    ds_read_b128 v[116:119], v206 offset:0
    v_mfma_f32_16x16x32_bf16 v[76:79], v[136:139], v[200:203], v[76:79]
    ds_read_b64_tr_b16 v[172:173], v209 offset:14464
    v_mfma_f32_16x16x32_bf16 v[72:75], v[136:139], v[196:199], v[72:75]
    ds_read_b64_tr_b16 v[174:175], v209 offset:14976
    v_mfma_f32_16x16x32_bf16 v[104:107], v[152:155], v[196:199], v[104:107]
    ds_read_b128 v[132:135], v206 offset:16384
    v_mfma_f32_16x16x32_bf16 v[96:99], v[148:151], v[196:199], v[96:99]
    ds_read_b64_tr_b16 v[176:177], v209 offset:14496
    v_mfma_f32_16x16x32_bf16 v[88:91], v[144:147], v[196:199], v[88:91]
    ds_read_b64_tr_b16 v[178:179], v209 offset:15008
    v_mfma_f32_16x16x32_bf16 v[80:83], v[140:143], v[196:199], v[80:83]
    ds_read_b128 v[128:131], v206 offset:14336
    v_mfma_f32_16x16x32_bf16 v[84:87], v[140:143], v[200:203], v[84:87]
    ds_read_b64_tr_b16 v[168:169], v209 offset:13472
    v_mfma_f32_16x16x32_bf16 v[92:95], v[144:147], v[200:203], v[92:95]
    ds_read_b64_tr_b16 v[170:171], v209 offset:13984
    v_mfma_f32_16x16x32_bf16 v[100:103], v[148:151], v[200:203], v[100:103]
    ds_read_b128 v[124:127], v206 offset:12288
    v_mfma_f32_16x16x32_bf16 v[108:111], v[152:155], v[200:203], v[108:111]
    ds_read_b64_tr_b16 v[164:165], v209 offset:13440
    v_mfma_f32_16x16x32_bf16 v[64:67], v[188:191], v[152:155], v[64:67]
    ds_read_b64_tr_b16 v[166:167], v209 offset:13952
    v_mfma_f32_16x16x32_bf16 v[56:59], v[188:191], v[148:151], v[56:59]
    ds_read_b128 v[120:123], v206 offset:10240
    v_mfma_f32_16x16x32_bf16 v[48:51], v[188:191], v[144:147], v[48:51]
    ds_read_b64_tr_b16 v[156:157], v209 offset:12416
    v_mfma_f32_16x16x32_bf16 v[40:43], v[188:191], v[140:143], v[40:43]
    ds_read_b64_tr_b16 v[158:159], v209 offset:12928
    v_mfma_f32_16x16x32_bf16 v[44:47], v[192:195], v[140:143], v[44:47]
    ds_read_b64_tr_b16 v[160:161], v209 offset:12448
    v_mfma_f32_16x16x32_bf16 v[52:55], v[192:195], v[144:147], v[52:55]
    ds_read_b64_tr_b16 v[162:163], v209 offset:12960
    v_mfma_f32_16x16x32_bf16 v[60:63], v[192:195], v[148:151], v[60:63]
    v_mfma_f32_16x16x32_bf16 v[68:71], v[192:195], v[152:155], v[68:71]
    s_add_u32 s16, s16, 24832
    s_cmp_eq_u32 s16, 74496
    v_mfma_f32_16x16x32_bf16 v[24:27], v[180:183], v[152:155], v[24:27]
    v_mfma_f32_16x16x32_bf16 v[16:19], v[180:183], v[148:151], v[16:19]
    s_cselect_b32 s16, 0, s16
    v_mfma_f32_16x16x32_bf16 v[8:11], v[180:183], v[144:147], v[8:11]
    v_mfma_f32_16x16x32_bf16 v[0:3], v[180:183], v[140:143], v[0:3]
    v_mfma_f32_16x16x32_bf16 v[4:7], v[184:187], v[140:143], v[4:7]
    v_add_u32 v209, s16, v208
    v_mfma_f32_16x16x32_bf16 v[12:15], v[184:187], v[144:147], v[12:15]
    v_mfma_f32_16x16x32_bf16 v[20:23], v[184:187], v[148:151], v[20:23]
    v_mfma_f32_16x16x32_bf16 v[28:31], v[184:187], v[152:155], v[28:31]
    s_waitcnt vmcnt(0) lgkmcnt(0)
g1c_ent1:
    s_barrier
    v_mfma_f32_16x16x32_bf16 v[112:115], v[160:163], v[116:119], v[112:115]
    ds_read_b128 v[136:139], v207 offset:0
    v_mfma_f32_16x16x32_bf16 v[76:79], v[116:119], v[176:179], v[76:79]
    ds_read_b64_tr_b16 v[196:197], v209 offset:2048
    v_mfma_f32_16x16x32_bf16 v[72:75], v[116:119], v[172:175], v[72:75]
    ds_read_b64_tr_b16 v[198:199], v209 offset:2560
    v_mfma_f32_16x16x32_bf16 v[104:107], v[132:135], v[172:175], v[104:107]
    ds_read_b128 v[152:155], v207 offset:16384
    v_mfma_f32_16x16x32_bf16 v[96:99], v[128:131], v[172:175], v[96:99]
    ds_read_b64_tr_b16 v[200:201], v209 offset:2080
    v_mfma_f32_16x16x32_bf16 v[88:91], v[124:127], v[172:175], v[88:91]
    ds_read_b64_tr_b16 v[202:203], v209 offset:2592
    v_mfma_f32_16x16x32_bf16 v[80:83], v[120:123], v[172:175], v[80:83]
    ds_read_b128 v[148:151], v207 offset:14336
    v_mfma_f32_16x16x32_bf16 v[84:87], v[120:123], v[176:179], v[84:87]
    ds_read_b64_tr_b16 v[192:193], v209 offset:1056
    v_mfma_f32_16x16x32_bf16 v[92:95], v[124:127], v[176:179], v[92:95]
    ds_read_b64_tr_b16 v[194:195], v209 offset:1568
    v_mfma_f32_16x16x32_bf16 v[100:103], v[128:131], v[176:179], v[100:103]
    ds_read_b128 v[144:147], v207 offset:12288
    v_mfma_f32_16x16x32_bf16 v[108:111], v[132:135], v[176:179], v[108:111]
    ds_read_b64_tr_b16 v[188:189], v209 offset:1024
    v_mfma_f32_16x16x32_bf16 v[64:67], v[164:167], v[132:135], v[64:67]
    ds_read_b64_tr_b16 v[190:191], v209 offset:1536
    v_mfma_f32_16x16x32_bf16 v[56:59], v[164:167], v[128:131], v[56:59]
    ds_read_b128 v[140:143], v207 offset:10240
    v_mfma_f32_16x16x32_bf16 v[48:51], v[164:167], v[124:127], v[48:51]
    ds_read_b64_tr_b16 v[180:181], v209 offset:0
    v_mfma_f32_16x16x32_bf16 v[40:43], v[164:167], v[120:123], v[40:43]
    ds_read_b64_tr_b16 v[182:183], v209 offset:512
    v_mfma_f32_16x16x32_bf16 v[44:47], v[168:171], v[120:123], v[44:47]
    ds_read_b64_tr_b16 v[184:185], v209 offset:32
    v_mfma_f32_16x16x32_bf16 v[52:55], v[168:171], v[124:127], v[52:55]
    ds_read_b64_tr_b16 v[186:187], v209 offset:544
    v_mfma_f32_16x16x32_bf16 v[60:63], v[168:171], v[128:131], v[60:63]
    v_mfma_f32_16x16x32_bf16 v[68:71], v[168:171], v[132:135], v[68:71]
    s_add_u32 s17, s17, 18432
    s_cmp_eq_u32 s17, 73728
    v_mfma_f32_16x16x32_bf16 v[24:27], v[156:159], v[132:135], v[24:27]
    s_cselect_b32 s17, 0, s17
    v_mfma_f32_16x16x32_bf16 v[16:19], v[156:159], v[128:131], v[16:19]
    v_mfma_f32_16x16x32_bf16 v[8:11], v[156:159], v[124:127], v[8:11]
    v_add_u32 v206, s17, v204
    v_mfma_f32_16x16x32_bf16 v[0:3], v[156:159], v[120:123], v[0:3]
    v_add_u32 v207, s17, v205
    v_mfma_f32_16x16x32_bf16 v[4:7], v[160:163], v[120:123], v[4:7]
    v_mfma_f32_16x16x32_bf16 v[12:15], v[160:163], v[124:127], v[12:15]
    s_sub_u32 s18, s18, 1
    s_cmp_lg_u32 s18, 0
    v_mfma_f32_16x16x32_bf16 v[20:23], v[160:163], v[128:131], v[20:23]
    v_mfma_f32_16x16x32_bf16 v[28:31], v[160:163], v[132:135], v[28:31]
    s_waitcnt lgkmcnt(0)
    s_cbranch_scc1 g1c_loop1
    v_mfma_f32_16x16x32_bf16 v[112:115], v[184:187], v[136:139], v[112:115]
    v_mfma_f32_16x16x32_bf16 v[76:79], v[136:139], v[200:203], v[76:79]
    v_mfma_f32_16x16x32_bf16 v[72:75], v[136:139], v[196:199], v[72:75]
    v_mfma_f32_16x16x32_bf16 v[24:27], v[180:183], v[152:155], v[24:27]
    v_mfma_f32_16x16x32_bf16 v[16:19], v[180:183], v[148:151], v[16:19]
    v_mfma_f32_16x16x32_bf16 v[8:11], v[180:183], v[144:147], v[8:11]
    v_mfma_f32_16x16x32_bf16 v[0:3], v[180:183], v[140:143], v[0:3]
    v_mfma_f32_16x16x32_bf16 v[4:7], v[184:187], v[140:143], v[4:7]
    v_mfma_f32_16x16x32_bf16 v[12:15], v[184:187], v[144:147], v[12:15]
    v_mfma_f32_16x16x32_bf16 v[20:23], v[184:187], v[148:151], v[20:23]
    v_mfma_f32_16x16x32_bf16 v[28:31], v[184:187], v[152:155], v[28:31]
    v_mfma_f32_16x16x32_bf16 v[64:67], v[188:191], v[152:155], v[64:67]
    s_mov_b32 exec_lo, 0x00010001
    s_mov_b32 exec_hi, 0x00010001
    ds_write_b128 v237, v[112:115] offset:64
    s_mov_b64 exec, 0xffff
    ds_write_b32 v238, v72 offset:256
    ds_write_b32 v238, v76 offset:320
    s_mov_b64 exec, -1
    v_mfma_f32_16x16x32_bf16 v[56:59], v[188:191], v[148:151], v[56:59]
    ds_write_b128 v236, v[72:75] offset:4096
    v_mfma_f32_16x16x32_bf16 v[48:51], v[188:191], v[144:147], v[48:51]
    ds_write_b128 v236, v[76:79] offset:5120
    v_mfma_f32_16x16x32_bf16 v[40:43], v[188:191], v[140:143], v[40:43]
    v_mfma_f32_16x16x32_bf16 v[44:47], v[192:195], v[140:143], v[44:47]
    v_mfma_f32_16x16x32_bf16 v[52:55], v[192:195], v[144:147], v[52:55]
    v_mfma_f32_16x16x32_bf16 v[60:63], v[192:195], v[148:151], v[60:63]
    v_mfma_f32_16x16x32_bf16 v[68:71], v[192:195], v[152:155], v[68:71]
    s_waitcnt lgkmcnt(0)
    s_barrier
    ds_read_b128 v[116:119], v237 offset:0
    ds_read_b128 v[120:123], v237 offset:64
    v_mfma_f32_16x16x32_bf16 v[104:107], v[152:155], v[196:199], v[104:107]
    ds_read2_b32 v[158:159], v239 offset0:32 offset1:32
    ds_read2_b32 v[160:161], v239 offset0:64 offset1:64
    v_mfma_f32_16x16x32_bf16 v[96:99], v[148:151], v[196:199], v[96:99]
    ds_read2_b32 v[162:163], v239 offset0:96 offset1:96
    v_mfma_f32_16x16x32_bf16 v[88:91], v[144:147], v[196:199], v[88:91]
    ds_read2_b32 v[164:165], v239 offset0:128 offset1:128
    ds_read_b128 v[124:127], v237 offset:128
    v_mfma_f32_16x16x32_bf16 v[80:83], v[140:143], v[196:199], v[80:83]
    ds_read_b128 v[128:131], v237 offset:192
    ds_read2_b32 v[156:157], v239 offset0:0 offset1:0
    v_mfma_f32_16x16x32_bf16 v[84:87], v[140:143], v[200:203], v[84:87]
    ds_read_b128 v[32:35], v236 offset:0
    v_mfma_f32_16x16x32_bf16 v[92:95], v[144:147], v[200:203], v[92:95]
    ds_read_b128 v[36:39], v236 offset:1024
    ds_read_b128 v[72:75], v236 offset:2048
    v_mfma_f32_16x16x32_bf16 v[100:103], v[148:151], v[200:203], v[100:103]
    ds_read_b128 v[76:79], v236 offset:3072
    v_mfma_f32_16x16x32_bf16 v[108:111], v[152:155], v[200:203], v[108:111]
    s_waitcnt lgkmcnt(5)
    s_branch g1c_epi
g1c_v2:
    s_barrier
    ds_read_b128 v[116:119], v206 offset:0
    ds_read_b64_tr_b16 v[172:173], v209 offset:14464
    ds_read_b64_tr_b16 v[174:175], v209 offset:14976
    ds_read_b128 v[132:135], v206 offset:8192
    ds_read_b64_tr_b16 v[176:177], v209 offset:14496
    ds_read_b64_tr_b16 v[178:179], v209 offset:15008
    ds_read_b128 v[128:131], v206 offset:6144
    ds_read_b64_tr_b16 v[168:169], v209 offset:13472
    ds_read_b64_tr_b16 v[170:171], v209 offset:13984
    ds_read_b128 v[124:127], v206 offset:4096
    ds_read_b64_tr_b16 v[164:165], v209 offset:13440
    ds_read_b64_tr_b16 v[166:167], v209 offset:13952
    ds_read_b128 v[120:123], v206 offset:2048
    ds_read_b64_tr_b16 v[156:157], v209 offset:12416
    ds_read_b64_tr_b16 v[158:159], v209 offset:12928
    ds_read_b64_tr_b16 v[160:161], v209 offset:12448
    ds_read_b64_tr_b16 v[162:163], v209 offset:12960
    s_add_u32 s16, s16, 24832
    s_cmp_eq_u32 s16, 74496
    s_cselect_b32 s16, 0, s16
    v_add_u32 v209, s16, v208
    s_waitcnt lgkmcnt(0)
    s_branch g1c_ent2
g1c_loop2:
    v_mfma_f32_16x16x32_bf16 v[104:107], v[152:155], v[196:199], v[104:107]
    ds_read_b128 v[116:119], v206 offset:0
    v_mfma_f32_16x16x32_bf16 v[96:99], v[148:151], v[196:199], v[96:99]
    ds_read_b64_tr_b16 v[172:173], v209 offset:14464
    v_mfma_f32_16x16x32_bf16 v[88:91], v[144:147], v[196:199], v[88:91]
    ds_read_b64_tr_b16 v[174:175], v209 offset:14976
    v_mfma_f32_16x16x32_bf16 v[80:83], v[140:143], v[196:199], v[80:83]
    ds_read_b128 v[132:135], v206 offset:8192
    v_mfma_f32_16x16x32_bf16 v[84:87], v[140:143], v[200:203], v[84:87]
    ds_read_b64_tr_b16 v[176:177], v209 offset:14496
    v_mfma_f32_16x16x32_bf16 v[92:95], v[144:147], v[200:203], v[92:95]
    ds_read_b64_tr_b16 v[178:179], v209 offset:15008
    v_mfma_f32_16x16x32_bf16 v[100:103], v[148:151], v[200:203], v[100:103]
    ds_read_b128 v[128:131], v206 offset:6144
    v_mfma_f32_16x16x32_bf16 v[108:111], v[152:155], v[200:203], v[108:111]
    ds_read_b64_tr_b16 v[168:169], v209 offset:13472
    v_mfma_f32_16x16x32_bf16 v[36:39], v[192:195], v[136:139], v[36:39]
    ds_read_b64_tr_b16 v[170:171], v209 offset:13984
    v_mfma_f32_16x16x32_bf16 v[32:35], v[188:191], v[136:139], v[32:35]
    ds_read_b128 v[124:127], v206 offset:4096
    v_mfma_f32_16x16x32_bf16 v[64:67], v[188:191], v[152:155], v[64:67]
    ds_read_b64_tr_b16 v[164:165], v209 offset:13440
    v_mfma_f32_16x16x32_bf16 v[56:59], v[188:191], v[148:151], v[56:59]
    ds_read_b64_tr_b16 v[166:167], v209 offset:13952
    v_mfma_f32_16x16x32_bf16 v[48:51], v[188:191], v[144:147], v[48:51]
    ds_read_b128 v[120:123], v206 offset:2048
    v_mfma_f32_16x16x32_bf16 v[40:43], v[188:191], v[140:143], v[40:43]
    ds_read_b64_tr_b16 v[156:157], v209 offset:12416
    v_mfma_f32_16x16x32_bf16 v[44:47], v[192:195], v[140:143], v[44:47]
    ds_read_b64_tr_b16 v[158:159], v209 offset:12928
    v_mfma_f32_16x16x32_bf16 v[52:55], v[192:195], v[144:147], v[52:55]
    ds_read_b64_tr_b16 v[160:161], v209 offset:12448
    v_mfma_f32_16x16x32_bf16 v[60:63], v[192:195], v[148:151], v[60:63]
    ds_read_b64_tr_b16 v[162:163], v209 offset:12960
    v_mfma_f32_16x16x32_bf16 v[68:71], v[192:195], v[152:155], v[68:71]
    v_mfma_f32_16x16x32_bf16 v[24:27], v[180:183], v[152:155], v[24:27]
    s_add_u32 s16, s16, 24832
    s_cmp_eq_u32 s16, 74496
    v_mfma_f32_16x16x32_bf16 v[16:19], v[180:183], v[148:151], v[16:19]
    v_mfma_f32_16x16x32_bf16 v[8:11], v[180:183], v[144:147], v[8:11]
    s_cselect_b32 s16, 0, s16
    v_mfma_f32_16x16x32_bf16 v[0:3], v[180:183], v[140:143], v[0:3]
    v_mfma_f32_16x16x32_bf16 v[4:7], v[184:187], v[140:143], v[4:7]
    v_add_u32 v209, s16, v208
    v_mfma_f32_16x16x32_bf16 v[12:15], v[184:187], v[144:147], v[12:15]
    v_mfma_f32_16x16x32_bf16 v[20:23], v[184:187], v[148:151], v[20:23]
    v_mfma_f32_16x16x32_bf16 v[28:31], v[184:187], v[152:155], v[28:31]
    s_waitcnt lgkmcnt(0)
g1c_ent2:
    s_barrier
    v_mfma_f32_16x16x32_bf16 v[104:107], v[132:135], v[172:175], v[104:107]
    ds_read_b128 v[136:139], v207 offset:0
    v_mfma_f32_16x16x32_bf16 v[96:99], v[128:131], v[172:175], v[96:99]
    ds_read_b64_tr_b16 v[196:197], v209 offset:2048
    v_mfma_f32_16x16x32_bf16 v[88:91], v[124:127], v[172:175], v[88:91]
    ds_read_b64_tr_b16 v[198:199], v209 offset:2560
    v_mfma_f32_16x16x32_bf16 v[80:83], v[120:123], v[172:175], v[80:83]
    ds_read_b128 v[152:155], v207 offset:8192
    v_mfma_f32_16x16x32_bf16 v[84:87], v[120:123], v[176:179], v[84:87]
    ds_read_b64_tr_b16 v[200:201], v209 offset:2080
    v_mfma_f32_16x16x32_bf16 v[92:95], v[124:127], v[176:179], v[92:95]
    ds_read_b64_tr_b16 v[202:203], v209 offset:2592
    v_mfma_f32_16x16x32_bf16 v[100:103], v[128:131], v[176:179], v[100:103]
    ds_read_b128 v[148:151], v207 offset:6144
    v_mfma_f32_16x16x32_bf16 v[108:111], v[132:135], v[176:179], v[108:111]
    ds_read_b64_tr_b16 v[192:193], v209 offset:1056
    v_mfma_f32_16x16x32_bf16 v[36:39], v[168:171], v[116:119], v[36:39]
    ds_read_b64_tr_b16 v[194:195], v209 offset:1568
    v_mfma_f32_16x16x32_bf16 v[32:35], v[164:167], v[116:119], v[32:35]
    ds_read_b128 v[144:147], v207 offset:4096
    v_mfma_f32_16x16x32_bf16 v[64:67], v[164:167], v[132:135], v[64:67]
    ds_read_b64_tr_b16 v[188:189], v209 offset:1024
    v_mfma_f32_16x16x32_bf16 v[56:59], v[164:167], v[128:131], v[56:59]
    ds_read_b64_tr_b16 v[190:191], v209 offset:1536
    v_mfma_f32_16x16x32_bf16 v[48:51], v[164:167], v[124:127], v[48:51]
    ds_read_b128 v[140:143], v207 offset:2048
    v_mfma_f32_16x16x32_bf16 v[40:43], v[164:167], v[120:123], v[40:43]
    ds_read_b64_tr_b16 v[180:181], v209 offset:0
    v_mfma_f32_16x16x32_bf16 v[44:47], v[168:171], v[120:123], v[44:47]
    ds_read_b64_tr_b16 v[182:183], v209 offset:512
    v_mfma_f32_16x16x32_bf16 v[52:55], v[168:171], v[124:127], v[52:55]
    ds_read_b64_tr_b16 v[184:185], v209 offset:32
    v_mfma_f32_16x16x32_bf16 v[60:63], v[168:171], v[128:131], v[60:63]
    ds_read_b64_tr_b16 v[186:187], v209 offset:544
    v_mfma_f32_16x16x32_bf16 v[68:71], v[168:171], v[132:135], v[68:71]
    v_mfma_f32_16x16x32_bf16 v[24:27], v[156:159], v[132:135], v[24:27]
    s_add_u32 s17, s17, 18432
    s_cmp_eq_u32 s17, 73728
    v_mfma_f32_16x16x32_bf16 v[16:19], v[156:159], v[128:131], v[16:19]
    s_cselect_b32 s17, 0, s17
    v_mfma_f32_16x16x32_bf16 v[8:11], v[156:159], v[124:127], v[8:11]
    v_add_u32 v206, s17, v204
    v_mfma_f32_16x16x32_bf16 v[0:3], v[156:159], v[120:123], v[0:3]
    v_mfma_f32_16x16x32_bf16 v[4:7], v[160:163], v[120:123], v[4:7]
    v_add_u32 v207, s17, v205
    v_mfma_f32_16x16x32_bf16 v[12:15], v[160:163], v[124:127], v[12:15]
    s_sub_u32 s18, s18, 1
    s_cmp_lg_u32 s18, 0
    v_mfma_f32_16x16x32_bf16 v[20:23], v[160:163], v[128:131], v[20:23]
    v_mfma_f32_16x16x32_bf16 v[28:31], v[160:163], v[132:135], v[28:31]
    s_waitcnt lgkmcnt(0)
    s_cbranch_scc1 g1c_loop2
    v_mfma_f32_16x16x32_bf16 v[36:39], v[192:195], v[136:139], v[36:39]
    v_mfma_f32_16x16x32_bf16 v[32:35], v[188:191], v[136:139], v[32:35]
    v_mfma_f32_16x16x32_bf16 v[64:67], v[188:191], v[152:155], v[64:67]
    v_mfma_f32_16x16x32_bf16 v[68:71], v[192:195], v[152:155], v[68:71]
    v_mfma_f32_16x16x32_bf16 v[108:111], v[152:155], v[200:203], v[108:111]
    v_mfma_f32_16x16x32_bf16 v[104:107], v[152:155], v[196:199], v[104:107]
    v_mfma_f32_16x16x32_bf16 v[24:27], v[180:183], v[152:155], v[24:27]
    v_mfma_f32_16x16x32_bf16 v[16:19], v[180:183], v[148:151], v[16:19]
    v_mfma_f32_16x16x32_bf16 v[8:11], v[180:183], v[144:147], v[8:11]
    v_mfma_f32_16x16x32_bf16 v[0:3], v[180:183], v[140:143], v[0:3]
    v_mfma_f32_16x16x32_bf16 v[4:7], v[184:187], v[140:143], v[4:7]
    v_mfma_f32_16x16x32_bf16 v[12:15], v[184:187], v[144:147], v[12:15]
    ds_write_b128 v236, v[64:67] offset:0
    v_mfma_f32_16x16x32_bf16 v[20:23], v[184:187], v[148:151], v[20:23]
    ds_write_b128 v236, v[68:71] offset:1024
    v_mfma_f32_16x16x32_bf16 v[28:31], v[184:187], v[152:155], v[28:31]
    ds_write_b128 v236, v[108:111] offset:3072
    v_mfma_f32_16x16x32_bf16 v[56:59], v[188:191], v[148:151], v[56:59]
    ds_write_b128 v236, v[104:107] offset:2048
    v_mfma_f32_16x16x32_bf16 v[48:51], v[188:191], v[144:147], v[48:51]
    v_mfma_f32_16x16x32_bf16 v[40:43], v[188:191], v[140:143], v[40:43]
    v_mfma_f32_16x16x32_bf16 v[44:47], v[192:195], v[140:143], v[44:47]
    v_mfma_f32_16x16x32_bf16 v[52:55], v[192:195], v[144:147], v[52:55]
    s_waitcnt lgkmcnt(0)
    s_barrier
    ds_read_b128 v[116:119], v237 offset:0
    ds_read_b128 v[120:123], v237 offset:64
    v_mfma_f32_16x16x32_bf16 v[60:63], v[192:195], v[148:151], v[60:63]
    ds_read2_b32 v[158:159], v239 offset0:32 offset1:32
    ds_read2_b32 v[160:161], v239 offset0:64 offset1:64
    v_mfma_f32_16x16x32_bf16 v[96:99], v[148:151], v[196:199], v[96:99]
    ds_read2_b32 v[162:163], v239 offset0:96 offset1:96
    v_mfma_f32_16x16x32_bf16 v[88:91], v[144:147], v[196:199], v[88:91]
    ds_read2_b32 v[164:165], v239 offset0:128 offset1:128
    ds_read_b128 v[124:127], v237 offset:128
    v_mfma_f32_16x16x32_bf16 v[80:83], v[140:143], v[196:199], v[80:83]
    ds_read_b128 v[128:131], v237 offset:192
    v_mfma_f32_16x16x32_bf16 v[84:87], v[140:143], v[200:203], v[84:87]
    ds_read2_b32 v[156:157], v239 offset0:0 offset1:0
    ds_read_b128 v[72:75], v236 offset:4096
    v_mfma_f32_16x16x32_bf16 v[92:95], v[144:147], v[200:203], v[92:95]
    ds_read_b128 v[76:79], v236 offset:5120
    v_mfma_f32_16x16x32_bf16 v[100:103], v[148:151], v[200:203], v[100:103]
    s_waitcnt lgkmcnt(3)
    s_branch g1c_epi
g1c_v3:
    s_barrier
    ds_read_b128 v[116:119], v206 offset:0
    ds_read_b64_tr_b16 v[172:173], v209 offset:14464
    ds_read_b64_tr_b16 v[174:175], v209 offset:14976
    ds_read_b128 v[132:135], v206 offset:16384
    ds_read_b64_tr_b16 v[176:177], v209 offset:14496
    ds_read_b64_tr_b16 v[178:179], v209 offset:15008
    ds_read_b128 v[128:131], v206 offset:14336
    ds_read_b64_tr_b16 v[168:169], v209 offset:13472
    ds_read_b64_tr_b16 v[170:171], v209 offset:13984
    ds_read_b128 v[124:127], v206 offset:12288
    ds_read_b64_tr_b16 v[164:165], v209 offset:13440
    ds_read_b64_tr_b16 v[166:167], v209 offset:13952
    ds_read_b128 v[120:123], v206 offset:10240
    ds_read_b64_tr_b16 v[156:157], v209 offset:12416
    ds_read_b64_tr_b16 v[158:159], v209 offset:12928
    ds_read_b64_tr_b16 v[160:161], v209 offset:12448
    ds_read_b64_tr_b16 v[162:163], v209 offset:12960
    s_add_u32 s16, s16, 24832
    s_cmp_eq_u32 s16, 74496
    s_cselect_b32 s16, 0, s16
    v_add_u32 v209, s16, v208
    s_waitcnt lgkmcnt(0)
    s_branch g1c_ent3
g1c_loop3:
    v_mfma_f32_16x16x32_bf16 v[76:79], v[136:139], v[200:203], v[76:79]
    ds_read_b128 v[116:119], v206 offset:0
    v_mfma_f32_16x16x32_bf16 v[72:75], v[136:139], v[196:199], v[72:75]
    ds_read_b64_tr_b16 v[172:173], v209 offset:14464
    v_mfma_f32_16x16x32_bf16 v[104:107], v[152:155], v[196:199], v[104:107]
    ds_read_b64_tr_b16 v[174:175], v209 offset:14976
    v_mfma_f32_16x16x32_bf16 v[96:99], v[148:151], v[196:199], v[96:99]
    ds_read_b128 v[132:135], v206 offset:16384
    v_mfma_f32_16x16x32_bf16 v[88:91], v[144:147], v[196:199], v[88:91]
    ds_read_b64_tr_b16 v[176:177], v209 offset:14496
    v_mfma_f32_16x16x32_bf16 v[80:83], v[140:143], v[196:199], v[80:83]
    ds_read_b64_tr_b16 v[178:179], v209 offset:15008
    v_mfma_f32_16x16x32_bf16 v[84:87], v[140:143], v[200:203], v[84:87]
    ds_read_b128 v[128:131], v206 offset:14336
    v_mfma_f32_16x16x32_bf16 v[92:95], v[144:147], v[200:203], v[92:95]
    ds_read_b64_tr_b16 v[168:169], v209 offset:13472
    v_mfma_f32_16x16x32_bf16 v[100:103], v[148:151], v[200:203], v[100:103]
    ds_read_b64_tr_b16 v[170:171], v209 offset:13984
    v_mfma_f32_16x16x32_bf16 v[108:111], v[152:155], v[200:203], v[108:111]
    ds_read_b128 v[124:127], v206 offset:12288
    v_mfma_f32_16x16x32_bf16 v[64:67], v[188:191], v[152:155], v[64:67]
    ds_read_b64_tr_b16 v[164:165], v209 offset:13440
    v_mfma_f32_16x16x32_bf16 v[56:59], v[188:191], v[148:151], v[56:59]
    ds_read_b64_tr_b16 v[166:167], v209 offset:13952
    v_mfma_f32_16x16x32_bf16 v[48:51], v[188:191], v[144:147], v[48:51]
    ds_read_b128 v[120:123], v206 offset:10240
    v_mfma_f32_16x16x32_bf16 v[40:43], v[188:191], v[140:143], v[40:43]
    ds_read_b64_tr_b16 v[156:157], v209 offset:12416
    v_mfma_f32_16x16x32_bf16 v[44:47], v[192:195], v[140:143], v[44:47]
    ds_read_b64_tr_b16 v[158:159], v209 offset:12928
    v_mfma_f32_16x16x32_bf16 v[52:55], v[192:195], v[144:147], v[52:55]
    ds_read_b64_tr_b16 v[160:161], v209 offset:12448
    v_mfma_f32_16x16x32_bf16 v[60:63], v[192:195], v[148:151], v[60:63]
    ds_read_b64_tr_b16 v[162:163], v209 offset:12960
    v_mfma_f32_16x16x32_bf16 v[68:71], v[192:195], v[152:155], v[68:71]
    v_mfma_f32_16x16x32_bf16 v[24:27], v[180:183], v[152:155], v[24:27]
    s_add_u32 s16, s16, 24832
    s_cmp_eq_u32 s16, 74496
    v_mfma_f32_16x16x32_bf16 v[16:19], v[180:183], v[148:151], v[16:19]
    v_mfma_f32_16x16x32_bf16 v[8:11], v[180:183], v[144:147], v[8:11]
    s_cselect_b32 s16, 0, s16
    v_mfma_f32_16x16x32_bf16 v[0:3], v[180:183], v[140:143], v[0:3]
    v_mfma_f32_16x16x32_bf16 v[4:7], v[184:187], v[140:143], v[4:7]
    v_add_u32 v209, s16, v208
    v_mfma_f32_16x16x32_bf16 v[12:15], v[184:187], v[144:147], v[12:15]
    v_mfma_f32_16x16x32_bf16 v[20:23], v[184:187], v[148:151], v[20:23]
    v_mfma_f32_16x16x32_bf16 v[28:31], v[184:187], v[152:155], v[28:31]
    s_waitcnt lgkmcnt(0)
g1c_ent3:
    s_barrier
    v_mfma_f32_16x16x32_bf16 v[76:79], v[116:119], v[176:179], v[76:79]
    ds_read_b128 v[136:139], v207 offset:0
    v_mfma_f32_16x16x32_bf16 v[72:75], v[116:119], v[172:175], v[72:75]
    ds_read_b64_tr_b16 v[196:197], v209 offset:2048
    v_mfma_f32_16x16x32_bf16 v[104:107], v[132:135], v[172:175], v[104:107]
    ds_read_b64_tr_b16 v[198:199], v209 offset:2560
    v_mfma_f32_16x16x32_bf16 v[96:99], v[128:131], v[172:175], v[96:99]
    ds_read_b128 v[152:155], v207 offset:16384
    v_mfma_f32_16x16x32_bf16 v[88:91], v[124:127], v[172:175], v[88:91]
    ds_read_b64_tr_b16 v[200:201], v209 offset:2080
    v_mfma_f32_16x16x32_bf16 v[80:83], v[120:123], v[172:175], v[80:83]
    ds_read_b64_tr_b16 v[202:203], v209 offset:2592
    v_mfma_f32_16x16x32_bf16 v[84:87], v[120:123], v[176:179], v[84:87]
    ds_read_b128 v[148:151], v207 offset:14336
    v_mfma_f32_16x16x32_bf16 v[92:95], v[124:127], v[176:179], v[92:95]
    ds_read_b64_tr_b16 v[192:193], v209 offset:1056
    v_mfma_f32_16x16x32_bf16 v[100:103], v[128:131], v[176:179], v[100:103]
    ds_read_b64_tr_b16 v[194:195], v209 offset:1568
    v_mfma_f32_16x16x32_bf16 v[108:111], v[132:135], v[176:179], v[108:111]
    ds_read_b128 v[144:147], v207 offset:12288
    v_mfma_f32_16x16x32_bf16 v[64:67], v[164:167], v[132:135], v[64:67]
    ds_read_b64_tr_b16 v[188:189], v209 offset:1024
    v_mfma_f32_16x16x32_bf16 v[56:59], v[164:167], v[128:131], v[56:59]
    ds_read_b64_tr_b16 v[190:191], v209 offset:1536
    v_mfma_f32_16x16x32_bf16 v[48:51], v[164:167], v[124:127], v[48:51]
    ds_read_b128 v[140:143], v207 offset:10240
    v_mfma_f32_16x16x32_bf16 v[40:43], v[164:167], v[120:123], v[40:43]
    ds_read_b64_tr_b16 v[180:181], v209 offset:0
    v_mfma_f32_16x16x32_bf16 v[44:47], v[168:171], v[120:123], v[44:47]
    ds_read_b64_tr_b16 v[182:183], v209 offset:512
    v_mfma_f32_16x16x32_bf16 v[52:55], v[168:171], v[124:127], v[52:55]
    ds_read_b64_tr_b16 v[184:185], v209 offset:32
    v_mfma_f32_16x16x32_bf16 v[60:63], v[168:171], v[128:131], v[60:63]
    ds_read_b64_tr_b16 v[186:187], v209 offset:544
    v_mfma_f32_16x16x32_bf16 v[68:71], v[168:171], v[132:135], v[68:71]
    v_mfma_f32_16x16x32_bf16 v[24:27], v[156:159], v[132:135], v[24:27]
    s_add_u32 s17, s17, 18432
    s_cmp_eq_u32 s17, 73728
    v_mfma_f32_16x16x32_bf16 v[16:19], v[156:159], v[128:131], v[16:19]
    s_cselect_b32 s17, 0, s17
    v_mfma_f32_16x16x32_bf16 v[8:11], v[156:159], v[124:127], v[8:11]
    v_add_u32 v206, s17, v204
    v_mfma_f32_16x16x32_bf16 v[0:3], v[156:159], v[120:123], v[0:3]
    v_mfma_f32_16x16x32_bf16 v[4:7], v[160:163], v[120:123], v[4:7]
    v_add_u32 v207, s17, v205
    v_mfma_f32_16x16x32_bf16 v[12:15], v[160:163], v[124:127], v[12:15]
    s_sub_u32 s18, s18, 1
    s_cmp_lg_u32 s18, 0
    v_mfma_f32_16x16x32_bf16 v[20:23], v[160:163], v[128:131], v[20:23]
    v_mfma_f32_16x16x32_bf16 v[28:31], v[160:163], v[132:135], v[28:31]
    s_waitcnt lgkmcnt(0)
    s_cbranch_scc1 g1c_loop3
    v_mfma_f32_16x16x32_bf16 v[76:79], v[136:139], v[200:203], v[76:79]
    v_mfma_f32_16x16x32_bf16 v[72:75], v[136:139], v[196:199], v[72:75]
    v_mfma_f32_16x16x32_bf16 v[24:27], v[180:183], v[152:155], v[24:27]
    v_mfma_f32_16x16x32_bf16 v[16:19], v[180:183], v[148:151], v[16:19]
    v_mfma_f32_16x16x32_bf16 v[8:11], v[180:183], v[144:147], v[8:11]
    v_mfma_f32_16x16x32_bf16 v[0:3], v[180:183], v[140:143], v[0:3]
    v_mfma_f32_16x16x32_bf16 v[4:7], v[184:187], v[140:143], v[4:7]
    v_mfma_f32_16x16x32_bf16 v[12:15], v[184:187], v[144:147], v[12:15]
    v_mfma_f32_16x16x32_bf16 v[20:23], v[184:187], v[148:151], v[20:23]
    v_mfma_f32_16x16x32_bf16 v[28:31], v[184:187], v[152:155], v[28:31]
    v_mfma_f32_16x16x32_bf16 v[64:67], v[188:191], v[152:155], v[64:67]
    v_mfma_f32_16x16x32_bf16 v[56:59], v[188:191], v[148:151], v[56:59]
    ds_write_b128 v236, v[72:75] offset:4096
    v_mfma_f32_16x16x32_bf16 v[48:51], v[188:191], v[144:147], v[48:51]
    ds_write_b128 v236, v[76:79] offset:5120
    v_mfma_f32_16x16x32_bf16 v[40:43], v[188:191], v[140:143], v[40:43]
    v_mfma_f32_16x16x32_bf16 v[44:47], v[192:195], v[140:143], v[44:47]
    v_mfma_f32_16x16x32_bf16 v[52:55], v[192:195], v[144:147], v[52:55]
    v_mfma_f32_16x16x32_bf16 v[60:63], v[192:195], v[148:151], v[60:63]
    v_mfma_f32_16x16x32_bf16 v[68:71], v[192:195], v[152:155], v[68:71]
    v_mfma_f32_16x16x32_bf16 v[104:107], v[152:155], v[196:199], v[104:107]
    s_waitcnt lgkmcnt(0)
    s_barrier
    ds_read_b128 v[116:119], v237 offset:0
    ds_read_b128 v[120:123], v237 offset:64
    v_mfma_f32_16x16x32_bf16 v[96:99], v[148:151], v[196:199], v[96:99]
    ds_read2_b32 v[158:159], v239 offset0:32 offset1:32
    ds_read2_b32 v[160:161], v239 offset0:64 offset1:64
    v_mfma_f32_16x16x32_bf16 v[88:91], v[144:147], v[196:199], v[88:91]
    ds_read2_b32 v[162:163], v239 offset0:96 offset1:96
    ds_read2_b32 v[164:165], v239 offset0:128 offset1:128
    v_mfma_f32_16x16x32_bf16 v[80:83], v[140:143], v[196:199], v[80:83]
    ds_read_b128 v[124:127], v237 offset:128
    ds_read_b128 v[128:131], v237 offset:192
    v_mfma_f32_16x16x32_bf16 v[84:87], v[140:143], v[200:203], v[84:87]
    ds_read2_b32 v[156:157], v239 offset0:0 offset1:0
    ds_read_b128 v[32:35], v236 offset:0
    v_mfma_f32_16x16x32_bf16 v[92:95], v[144:147], v[200:203], v[92:95]
    ds_read_b128 v[36:39], v236 offset:1024
    ds_read_b128 v[72:75], v236 offset:2048
    v_mfma_f32_16x16x32_bf16 v[100:103], v[148:151], v[200:203], v[100:103]
    ds_read_b128 v[76:79], v236 offset:3072
    v_mfma_f32_16x16x32_bf16 v[108:111], v[152:155], v[200:203], v[108:111]
    s_waitcnt lgkmcnt(5)
g1c_epi:
    ds_read_b32 v241, v241
    ds_read2_b32 v[132:133], v238 offset0:64 offset1:64
    ds_read2_b32 v[134:135], v238 offset0:80 offset1:80
    ds_read2_b32 v[174:175], v239 offset0:33 offset1:65
    ds_read2_b32 v[176:177], v239 offset0:97 offset1:129
    v_pk_fma_f32 v[0:1], v[158:159], v[116:117], v[0:1] neg_lo:[1,0,0] neg_hi:[1,0,0]
    v_pk_fma_f32 v[2:3], v[158:159], v[118:119], v[2:3] neg_lo:[1,0,0] neg_hi:[1,0,0]
    v_pk_fma_f32 v[4:5], v[158:159], v[120:121], v[4:5] neg_lo:[1,0,0] neg_hi:[1,0,0]
    v_pk_fma_f32 v[6:7], v[158:159], v[122:123], v[6:7] neg_lo:[1,0,0] neg_hi:[1,0,0]
    v_pk_fma_f32 v[40:41], v[158:159], v[124:125], v[40:41] neg_lo:[1,0,0] neg_hi:[1,0,0]
    v_pk_fma_f32 v[42:43], v[158:159], v[126:127], v[42:43] neg_lo:[1,0,0] neg_hi:[1,0,0]
    v_pk_fma_f32 v[44:45], v[158:159], v[128:129], v[44:45] neg_lo:[1,0,0] neg_hi:[1,0,0]
    v_pk_fma_f32 v[46:47], v[158:159], v[130:131], v[46:47] neg_lo:[1,0,0] neg_hi:[1,0,0]
    ds_read2_b32 v[140:141], v240 offset0:32 offset1:34
    ds_read2_b32 v[142:143], v240 offset0:36 offset1:38
    v_cvt_pk_bf16_f32 v0, v0, v1
    v_cvt_pk_bf16_f32 v1, v2, v3
    v_cvt_pk_bf16_f32 v2, v4, v5
    v_cvt_pk_bf16_f32 v3, v6, v7
    v_cvt_pk_bf16_f32 v40, v40, v41
    v_cvt_pk_bf16_f32 v41, v42, v43
    v_cvt_pk_bf16_f32 v42, v44, v45
    v_cvt_pk_bf16_f32 v43, v46, v47
    v_pk_fma_f32 v[8:9], v[160:161], v[116:117], v[8:9] neg_lo:[1,0,0] neg_hi:[1,0,0]
    v_pk_fma_f32 v[10:11], v[160:161], v[118:119], v[10:11] neg_lo:[1,0,0] neg_hi:[1,0,0]
    v_pk_fma_f32 v[12:13], v[160:161], v[120:121], v[12:13] neg_lo:[1,0,0] neg_hi:[1,0,0]
    v_pk_fma_f32 v[14:15], v[160:161], v[122:123], v[14:15] neg_lo:[1,0,0] neg_hi:[1,0,0]
    v_pk_fma_f32 v[48:49], v[160:161], v[124:125], v[48:49] neg_lo:[1,0,0] neg_hi:[1,0,0]
    v_pk_fma_f32 v[50:51], v[160:161], v[126:127], v[50:51] neg_lo:[1,0,0] neg_hi:[1,0,0]
    v_pk_fma_f32 v[52:53], v[160:161], v[128:129], v[52:53] neg_lo:[1,0,0] neg_hi:[1,0,0]
    v_pk_fma_f32 v[54:55], v[160:161], v[130:131], v[54:55] neg_lo:[1,0,0] neg_hi:[1,0,0]
    ds_read2_b32 v[144:145], v240 offset0:64 offset1:66
    ds_read2_b32 v[146:147], v240 offset0:68 offset1:70
    v_cvt_pk_bf16_f32 v8, v8, v9
    v_cvt_pk_bf16_f32 v9, v10, v11
    v_cvt_pk_bf16_f32 v10, v12, v13
    v_cvt_pk_bf16_f32 v11, v14, v15
    v_cvt_pk_bf16_f32 v48, v48, v49
    v_cvt_pk_bf16_f32 v49, v50, v51
    v_cvt_pk_bf16_f32 v50, v52, v53
    v_cvt_pk_bf16_f32 v51, v54, v55
    s_waitcnt lgkmcnt(2)
    v_pk_fma_f32 v[16:17], v[162:163], v[116:117], v[16:17] neg_lo:[1,0,0] neg_hi:[1,0,0]
    v_pk_fma_f32 v[18:19], v[162:163], v[118:119], v[18:19] neg_lo:[1,0,0] neg_hi:[1,0,0]
    v_pk_fma_f32 v[20:21], v[162:163], v[120:121], v[20:21] neg_lo:[1,0,0] neg_hi:[1,0,0]
    v_pk_fma_f32 v[22:23], v[162:163], v[122:123], v[22:23] neg_lo:[1,0,0] neg_hi:[1,0,0]
    v_pk_fma_f32 v[56:57], v[162:163], v[124:125], v[56:57] neg_lo:[1,0,0] neg_hi:[1,0,0]
    v_pk_fma_f32 v[58:59], v[162:163], v[126:127], v[58:59] neg_lo:[1,0,0] neg_hi:[1,0,0]
    v_pk_fma_f32 v[60:61], v[162:163], v[128:129], v[60:61] neg_lo:[1,0,0] neg_hi:[1,0,0]
    v_pk_fma_f32 v[62:63], v[162:163], v[130:131], v[62:63] neg_lo:[1,0,0] neg_hi:[1,0,0]
    ds_read2_b32 v[148:149], v240 offset0:96 offset1:98
    ds_read2_b32 v[150:151], v240 offset0:100 offset1:102
    v_cvt_pk_bf16_f32 v16, v16, v17
    v_cvt_pk_bf16_f32 v17, v18, v19
    v_cvt_pk_bf16_f32 v18, v20, v21
    v_cvt_pk_bf16_f32 v19, v22, v23
    v_cvt_pk_bf16_f32 v56, v56, v57
    v_cvt_pk_bf16_f32 v57, v58, v59
    v_cvt_pk_bf16_f32 v58, v60, v61
    v_cvt_pk_bf16_f32 v59, v62, v63
    v_pk_fma_f32 v[24:25], v[164:165], v[116:117], v[24:25] neg_lo:[1,0,0] neg_hi:[1,0,0]
    v_pk_fma_f32 v[26:27], v[164:165], v[118:119], v[26:27] neg_lo:[1,0,0] neg_hi:[1,0,0]
    v_pk_fma_f32 v[28:29], v[164:165], v[120:121], v[28:29] neg_lo:[1,0,0] neg_hi:[1,0,0]
    v_pk_fma_f32 v[30:31], v[164:165], v[122:123], v[30:31] neg_lo:[1,0,0] neg_hi:[1,0,0]
    v_pk_fma_f32 v[64:65], v[164:165], v[124:125], v[64:65] neg_lo:[1,0,0] neg_hi:[1,0,0]
    v_pk_fma_f32 v[66:67], v[164:165], v[126:127], v[66:67] neg_lo:[1,0,0] neg_hi:[1,0,0]
    v_pk_fma_f32 v[68:69], v[164:165], v[128:129], v[68:69] neg_lo:[1,0,0] neg_hi:[1,0,0]
    v_pk_fma_f32 v[70:71], v[164:165], v[130:131], v[70:71] neg_lo:[1,0,0] neg_hi:[1,0,0]
    ds_read2_b32 v[152:153], v240 offset0:128 offset1:130
    ds_read2_b32 v[154:155], v240 offset0:132 offset1:134
    v_cvt_pk_bf16_f32 v24, v24, v25
    v_cvt_pk_bf16_f32 v25, v26, v27
    v_cvt_pk_bf16_f32 v26, v28, v29
    v_cvt_pk_bf16_f32 v27, v30, v31
    v_cvt_pk_bf16_f32 v64, v64, v65
    v_cvt_pk_bf16_f32 v65, v66, v67
    v_cvt_pk_bf16_f32 v66, v68, v69
    v_cvt_pk_bf16_f32 v67, v70, v71
    ds_read2_b32 v[136:137], v240 offset0:0 offset1:2
    ds_read2_b32 v[138:139], v240 offset0:4 offset1:6
    ds_read2_b32 v[166:167], v244 offset0:0 offset1:32
    ds_read2_b32 v[168:169], v244 offset0:64 offset1:96
    ds_read2_b32 v[170:171], v245 offset0:0 offset1:32
    ds_read2_b32 v[172:173], v245 offset0:64 offset1:96
    v_pk_fma_f32 v[32:33], v[156:157], v[124:125], v[32:33] neg_lo:[1,0,0] neg_hi:[1,0,0]
    v_pk_fma_f32 v[34:35], v[156:157], v[126:127], v[34:35] neg_lo:[1,0,0] neg_hi:[1,0,0]
    v_pk_fma_f32 v[36:37], v[156:157], v[128:129], v[36:37] neg_lo:[1,0,0] neg_hi:[1,0,0]
    v_pk_fma_f32 v[38:39], v[156:157], v[130:131], v[38:39] neg_lo:[1,0,0] neg_hi:[1,0,0]
    v_mul_f32 v200, s23, v174
    v_mul_f32 v201, s23, v175
    v_mul_f32 v202, s23, v176
    v_mul_f32 v203, s23, v177
    v_cvt_pk_bf16_f32 v32, v32, v33
    v_cvt_pk_bf16_f32 v33, v34, v35
    v_cvt_pk_bf16_f32 v34, v36, v37
    v_cvt_pk_bf16_f32 v35, v38, v39
    v_readfirstlane_b32 s78, v241
    s_mov_b32 s59, s78
    s_mul_i32 s60, s59, s75
    v_mfma_f32_16x16x32_bf16 v[116:119], v[40:43], v[0:3], 0
    v_mfma_f32_16x16x32_bf16 v[120:123], v[32:35], v[0:3], 0
    v_mfma_f32_16x16x32_bf16 v[124:127], v[48:51], v[8:11], 0
    v_mfma_f32_16x16x32_bf16 v[128:131], v[40:43], v[8:11], 0
    v_mfma_f32_16x16x32_bf16 v[178:181], v[56:59], v[16:19], 0
    v_mfma_f32_16x16x32_bf16 v[182:185], v[48:51], v[16:19], 0
    v_mfma_f32_16x16x32_bf16 v[186:189], v[64:67], v[24:27], 0
    v_mfma_f32_16x16x32_bf16 v[190:193], v[56:59], v[24:27], 0
    s_waitcnt lgkmcnt(0)
    v_pk_fma_f32 v[80:81], v[140:141], v[132:133], v[80:81] neg_lo:[1,0,0] neg_hi:[1,0,0]
    v_pk_fma_f32 v[82:83], v[142:143], v[132:133], v[82:83] neg_lo:[1,0,0] neg_hi:[1,0,0]
    v_pk_fma_f32 v[84:85], v[140:141], v[134:135], v[84:85] neg_lo:[1,0,0] neg_hi:[1,0,0]
    v_pk_fma_f32 v[86:87], v[142:143], v[134:135], v[86:87] neg_lo:[1,0,0] neg_hi:[1,0,0]
    v_cvt_pk_bf16_f32 v214, v80, v81
    v_cvt_pk_bf16_f32 v215, v82, v83
    v_cvt_pk_bf16_f32 v224, v84, v85
    v_cvt_pk_bf16_f32 v225, v86, v87
    v_pk_fma_f32 v[88:89], v[144:145], v[132:133], v[88:89] neg_lo:[1,0,0] neg_hi:[1,0,0]
    v_pk_fma_f32 v[90:91], v[146:147], v[132:133], v[90:91] neg_lo:[1,0,0] neg_hi:[1,0,0]
    v_pk_fma_f32 v[92:93], v[144:145], v[134:135], v[92:93] neg_lo:[1,0,0] neg_hi:[1,0,0]
    v_pk_fma_f32 v[94:95], v[146:147], v[134:135], v[94:95] neg_lo:[1,0,0] neg_hi:[1,0,0]
    v_cvt_pk_bf16_f32 v216, v88, v89
    v_cvt_pk_bf16_f32 v217, v90, v91
    v_cvt_pk_bf16_f32 v226, v92, v93
    v_cvt_pk_bf16_f32 v227, v94, v95
    v_pk_fma_f32 v[96:97], v[148:149], v[132:133], v[96:97] neg_lo:[1,0,0] neg_hi:[1,0,0]
    v_pk_fma_f32 v[98:99], v[150:151], v[132:133], v[98:99] neg_lo:[1,0,0] neg_hi:[1,0,0]
    v_pk_fma_f32 v[100:101], v[148:149], v[134:135], v[100:101] neg_lo:[1,0,0] neg_hi:[1,0,0]
    v_pk_fma_f32 v[102:103], v[150:151], v[134:135], v[102:103] neg_lo:[1,0,0] neg_hi:[1,0,0]
    v_cvt_pk_bf16_f32 v218, v96, v97
    v_cvt_pk_bf16_f32 v219, v98, v99
    v_cvt_pk_bf16_f32 v228, v100, v101
    v_cvt_pk_bf16_f32 v229, v102, v103
    v_pk_fma_f32 v[104:105], v[152:153], v[132:133], v[104:105] neg_lo:[1,0,0] neg_hi:[1,0,0]
    v_pk_fma_f32 v[106:107], v[154:155], v[132:133], v[106:107] neg_lo:[1,0,0] neg_hi:[1,0,0]
    v_pk_fma_f32 v[108:109], v[152:153], v[134:135], v[108:109] neg_lo:[1,0,0] neg_hi:[1,0,0]
    v_pk_fma_f32 v[110:111], v[154:155], v[134:135], v[110:111] neg_lo:[1,0,0] neg_hi:[1,0,0]
    v_cvt_pk_bf16_f32 v220, v104, v105
    v_cvt_pk_bf16_f32 v221, v106, v107
    v_cvt_pk_bf16_f32 v230, v108, v109
    v_cvt_pk_bf16_f32 v231, v110, v111
    v_pk_fma_f32 v[72:73], v[136:137], v[132:133], v[72:73] neg_lo:[1,0,0] neg_hi:[1,0,0]
    v_pk_fma_f32 v[74:75], v[138:139], v[132:133], v[74:75] neg_lo:[1,0,0] neg_hi:[1,0,0]
    v_pk_fma_f32 v[76:77], v[136:137], v[134:135], v[76:77] neg_lo:[1,0,0] neg_hi:[1,0,0]
    v_pk_fma_f32 v[78:79], v[138:139], v[134:135], v[78:79] neg_lo:[1,0,0] neg_hi:[1,0,0]
    v_cvt_pk_bf16_f32 v212, v72, v73
    v_cvt_pk_bf16_f32 v213, v74, v75
    v_cvt_pk_bf16_f32 v222, v76, v77
    v_cvt_pk_bf16_f32 v223, v78, v79
    s_mov_b64 vcc, s[28:29]
    v_mov_b32 v4, 0xf149f2ca
    v_cndmask_b32 v116, v116, v117, vcc
    v_cndmask_b32 v120, v120, v121, vcc
    v_cndmask_b32 v118, v118, v119, vcc
    v_cndmask_b32 v122, v122, v123, vcc
    v_cndmask_b32 v156, v120, v116, s[30:31]
    v_cndmask_b32 v157, v122, v118, s[32:33]
    v_cndmask_b32 v124, v124, v125, vcc
    v_cndmask_b32 v128, v128, v129, vcc
    v_cndmask_b32 v126, v126, v127, vcc
    v_cndmask_b32 v130, v130, v131, vcc
    v_cndmask_b32 v158, v128, v124, s[30:31]
    v_cndmask_b32 v159, v130, v126, s[32:33]
    v_cndmask_b32 v178, v178, v179, vcc
    v_cndmask_b32 v182, v182, v183, vcc
    v_cndmask_b32 v180, v180, v181, vcc
    v_cndmask_b32 v184, v184, v185, vcc
    v_cndmask_b32 v160, v182, v178, s[30:31]
    v_cndmask_b32 v161, v184, v180, s[32:33]
    v_cndmask_b32 v186, v186, v187, vcc
    v_cndmask_b32 v190, v190, v191, vcc
    v_cndmask_b32 v188, v188, v189, vcc
    v_cndmask_b32 v192, v192, v193, vcc
    v_cndmask_b32 v162, v190, v186, s[30:31]
    v_cndmask_b32 v163, v192, v188, s[32:33]
    s_cmp_lg_u32 s75, 0
    s_cbranch_scc1 xo_3190_f
    s_mov_b32 s8, s84
    s_mov_b32 s9, s85
    s_mov_b32 s10, 4194304
    s_mov_b32 s11, 0x00020000
    s_lshl_b32 s64, s73, 1
    s_lshr_b32 s65, s3, 1
    s_add_u32 s64, s64, s65
    s_lshl_b32 s64, s64, 17
    s_and_b32 s65, s3, 1
    s_lshl_b32 s65, s65, 6
    s_add_u32 s64, s64, s65
    s_lshl_b32 s65, s72, 7
    s_add_u32 s64, s64, s65
    v_lshlrev_b32 v243, 11, v252
    v_lshl_add_u32 v243, v251, 3, v243
    buffer_load_dwordx2 v[176:177], v243, s[8:11], s64 offen
    buffer_load_dwordx2 v[178:179], v243, s[8:11], s64 offen offset:32
    s_add_u32 s64, s64, 32768
    buffer_load_dwordx2 v[180:181], v243, s[8:11], s64 offen
    buffer_load_dwordx2 v[182:183], v243, s[8:11], s64 offen offset:32
    s_add_u32 s64, s64, 32768
    buffer_load_dwordx2 v[184:185], v243, s[8:11], s64 offen
    buffer_load_dwordx2 v[186:187], v243, s[8:11], s64 offen offset:32
    s_add_u32 s64, s64, 32768
    buffer_load_dwordx2 v[188:189], v243, s[8:11], s64 offen
    buffer_load_dwordx2 v[190:191], v243, s[8:11], s64 offen offset:32
    s_add_u32 s64, s64, 32768
    s_branch xo_3190_d
xo_3190_f:
    s_lshl_b32 s12, s73, 4
    s_add_u32 s12, s12, s72
    s_lshl_b32 s12, s12, 14
    s_and_b32 s64, s3, 1
    s_lshl_b32 s64, s64, 13
    s_add_u32 s12, s12, s64
    s_lshr_b32 s64, s3, 1
    s_lshl_b32 s64, s64, 12
    s_add_u32 s12, s12, s64
    s_add_u32 s12, s12, 4194304
    buffer_load_dwordx4 v[176:179], v249, s[80:83], s12 offen offset:0 sc1
    buffer_load_dwordx4 v[180:183], v249, s[80:83], s12 offen offset:1024 sc1
    buffer_load_dwordx4 v[184:187], v249, s[80:83], s12 offen offset:2048 sc1
    buffer_load_dwordx4 v[188:191], v249, s[80:83], s12 offen offset:3072 sc1
xo_3190_d:
    v_mul_f32 v156, v166, v156
    v_mul_f32 v157, v170, v157
    v_mul_f32 v158, v167, v158
    v_mul_f32 v159, v171, v159
    v_mul_f32 v160, v168, v160
    v_mul_f32 v161, v172, v161
    v_mul_f32 v162, v169, v162
    v_mul_f32 v163, v173, v163
    v_cndmask_b32 v156, v4, v156, s[34:35]
    v_cndmask_b32 v157, v4, v157, s[36:37]
    v_max_f32 v0, v156, v157
    v_max_f32 v1, v158, v159
    v_max_f32 v2, v160, v161
    v_max_f32 v3, v162, v163
    s_nop 0
    v_permlane16_swap_b32 v0, v1
    v_permlane16_swap_b32 v2, v3
    v_max_f32 v0, v0, v1
    v_max_f32 v2, v2, v3
    s_nop 1
    v_permlane32_swap_b32 v0, v2
    v_max_f32 v0, v0, v2
    v_mov_b32 v2, v0
    s_nop 1
    v_permlane32_swap_b32 v0, v2
    v_mov_b32 v1, v0
    v_mov_b32 v3, v2
    s_nop 0
    v_permlane16_swap_b32 v0, v1
    v_permlane16_swap_b32 v2, v3
    v_sub_f32 v156, v156, v0
    v_sub_f32 v157, v157, v0
    v_sub_f32 v158, v158, v1
    v_sub_f32 v159, v159, v1
    v_sub_f32 v160, v160, v2
    v_sub_f32 v161, v161, v2
    v_sub_f32 v162, v162, v3
    v_sub_f32 v163, v163, v3
    v_mul_f32 v156, v200, v156
    v_mul_f32 v157, v200, v157
    v_mul_f32 v158, v201, v158
    v_mul_f32 v159, v201, v159
    v_mul_f32 v160, v202, v160
    v_mul_f32 v161, v202, v161
    v_mul_f32 v162, v203, v162
    v_mul_f32 v163, v203, v163
    v_exp_f32 v156, v156
    v_exp_f32 v157, v157
    v_exp_f32 v158, v158
    v_exp_f32 v159, v159
    v_exp_f32 v160, v160
    v_exp_f32 v161, v161
    v_exp_f32 v162, v162
    v_exp_f32 v163, v163
    v_add_f32 v0, v156, v157
    v_add_f32 v1, v158, v159
    v_add_f32 v2, v160, v161
    v_add_f32 v3, v162, v163
    v_mul_f32 v156, v166, v156
    v_mul_f32 v157, v170, v157
    v_mul_f32 v158, v167, v158
    v_mul_f32 v159, v171, v159
    v_mul_f32 v160, v168, v160
    v_mul_f32 v161, v172, v161
    v_mul_f32 v162, v169, v162
    v_mul_f32 v163, v173, v163
    s_nop 0
    v_permlane16_swap_b32 v0, v1
    v_permlane16_swap_b32 v2, v3
    v_add_f32 v0, v0, v1
    v_add_f32 v2, v2, v3
    s_nop 1
    v_permlane32_swap_b32 v0, v2
    v_add_f32 v0, v0, v2
    v_rcp_f32 v0, v0
    s_nop 0
    v_mov_b32 v2, v0
    s_nop 1
    v_permlane32_swap_b32 v0, v2
    v_mov_b32 v1, v0
    v_mov_b32 v3, v2
    s_nop 0
    v_permlane16_swap_b32 v0, v1
    v_permlane16_swap_b32 v2, v3
    v_mul_f32 v156, v156, v0
    v_mul_f32 v157, v157, v0
    v_cvt_pk_bf16_f32 v156, v156, v156
    v_cvt_pk_bf16_f32 v157, v157, v157
    v_and_b32 v8, v156, v232
    v_and_b32 v9, v157, v233
    v_and_b32 v10, v156, v234
    v_and_b32 v11, v157, v235
    v_mul_f32 v158, v158, v1
    v_mul_f32 v159, v159, v1
    v_cvt_pk_bf16_f32 v158, v158, v158
    v_cvt_pk_bf16_f32 v159, v159, v159
    v_and_b32 v12, v158, v232
    v_and_b32 v13, v159, v233
    v_and_b32 v14, v158, v234
    v_and_b32 v15, v159, v235
    v_mfma_f32_16x16x32_bf16 v[24:27], v[212:215], v[8:11], 0
    v_mfma_f32_16x16x32_bf16 v[28:31], v[222:225], v[8:11], 0
    v_mul_f32 v160, v160, v2
    v_mul_f32 v161, v161, v2
    v_cvt_pk_bf16_f32 v160, v160, v160
    v_cvt_pk_bf16_f32 v161, v161, v161
    v_and_b32 v16, v160, v232
    v_and_b32 v17, v161, v233
    v_and_b32 v18, v160, v234
    v_and_b32 v19, v161, v235
    v_mfma_f32_16x16x32_bf16 v[32:35], v[214:217], v[12:15], 0
    v_mfma_f32_16x16x32_bf16 v[36:39], v[224:227], v[12:15], 0
    v_mul_f32 v162, v162, v3
    v_mul_f32 v163, v163, v3
    v_cvt_pk_bf16_f32 v162, v162, v162
    v_cvt_pk_bf16_f32 v163, v163, v163
    v_and_b32 v20, v162, v232
    v_and_b32 v21, v163, v233
    v_and_b32 v22, v162, v234
    v_and_b32 v23, v163, v235
    v_mfma_f32_16x16x32_bf16 v[40:43], v[216:219], v[16:19], 0
    v_mfma_f32_16x16x32_bf16 v[44:47], v[226:229], v[16:19], 0
    v_mfma_f32_16x16x32_bf16 v[48:51], v[218:221], v[20:23], 0
    v_mfma_f32_16x16x32_bf16 v[52:55], v[228:231], v[20:23], 0
    s_cmp_lg_u32 s68, 0
    s_cbranch_scc1 g1c_rem
    v_cvt_pk_bf16_f32 v56, v24, v25
    v_cvt_pk_bf16_f32 v57, v26, v27
    v_cvt_pk_bf16_f32 v58, v28, v29
    v_cvt_pk_bf16_f32 v59, v30, v31
    buffer_store_dwordx4 v[56:59], v249, s[80:83], s21 offen offset:0
    v_cvt_pk_bf16_f32 v60, v32, v33
    v_cvt_pk_bf16_f32 v61, v34, v35
    v_cvt_pk_bf16_f32 v62, v36, v37
    v_cvt_pk_bf16_f32 v63, v38, v39
    buffer_store_dwordx4 v[60:63], v249, s[80:83], s21 offen offset:1024
    v_cvt_pk_bf16_f32 v64, v40, v41
    v_cvt_pk_bf16_f32 v65, v42, v43
    v_cvt_pk_bf16_f32 v66, v44, v45
    v_cvt_pk_bf16_f32 v67, v46, v47
    buffer_store_dwordx4 v[64:67], v249, s[80:83], s21 offen offset:2048
    v_cvt_pk_bf16_f32 v68, v48, v49
    v_cvt_pk_bf16_f32 v69, v50, v51
    v_cvt_pk_bf16_f32 v70, v52, v53
    v_cvt_pk_bf16_f32 v71, v54, v55
    buffer_store_dwordx4 v[68:71], v249, s[80:83], s21 offen offset:3072
g1c_remb:
    s_lshl_b32 s64, s75, 15
    s_lshl_b32 s66, s73, 9
    s_add_u32 s64, s64, s66
    s_add_u32 s64, s64, 75497472
    s_lshl_b32 s65, s72, 5
    s_add_u32 s64, s64, s65
    s_lshl_b32 s65, s3, 2
    s_add_u32 s64, s64, s65
    v_mov_b32 v108, 0
    v_mov_b32 v109, 1
    s_cmp_lg_u32 s78, 0
    s_cbranch_scc1 sg_3191_slow
    s_waitcnt vmcnt(0)
    s_mov_b64 exec, 1
    buffer_store_dword v109, v108, s[80:83], s64 offen
    s_mov_b64 exec, -1
sg_3191_done:
    s_lshr_b32 s64, s3, 1
    s_lshl_b32 s64, s64, 12
    v_add_u32 v240, s64, v249
    v_lshrrev_b32 v253, 2, v252
    v_mul_u32_u24 v253, 1056, v253
    v_lshl_add_u32 v253, v251, 7, v253
    v_and_b32 v254, 3, v252
    v_lshl_add_u32 v253, v254, 3, v253
    s_and_b32 s64, s3, 1
    s_lshl_b32 s64, s64, 6
    s_add_u32 s64, s64, 65536
    v_add_u32 v241, s64, v253
    s_mov_b32 s16, 50688
    v_add_u32 v242, s16, v241
    s_mov_b32 s25, s72
    s_lshl_b32 s18, s73, 4
    s_add_u32 s18, s18, s72
    s_lshl_b32 s18, s18, 14
    s_and_b32 s64, s3, 1
    s_lshl_b32 s64, s64, 13
    s_add_u32 s18, s18, s64
    s_lshr_b32 s64, s3, 1
    s_lshl_b32 s64, s64, 12
    s_add_u32 s18, s18, s64
    s_mov_b32 s20, s18
    s_lshl_b32 s66, s75, 23
    s_add_u32 s20, s20, s66
    s_lshl_b32 s24, s73, 4
    s_add_u32 s24, s24, s25
    s_lshl_b32 s24, s24, 11
    s_lshl_b32 s65, s75, 20
    s_add_u32 s24, s24, s65
    s_add_u32 s24, s24, 71303168
    s_lshr_b32 s65, s3, 1
    s_lshl_b32 s65, s65, 9
    s_add_u32 s24, s24, s65
    s_and_b32 s65, s3, 1
    s_lshl_b32 s65, s65, 10
    s_add_u32 s24, s24, s65
    v_lshlrev_b32 v239, 3, v250
    v_mov_b32 v208, 0
    v_mov_b32 v209, 0
    v_mov_b32 v210, 0
    v_mov_b32 v211, 0
    s_nop 1
    v_mfma_f32_32x32x16_bf16 v[0:15], v[208:211], v[208:211], 0
    v_mfma_f32_32x32x16_bf16 v[16:31], v[208:211], v[208:211], 0
    s_mov_b32 s17, 8
    s_waitcnt vmcnt(1)
    v_lshlrev_b32 v144, 16, v176
    v_and_b32 v145, 0xffff0000, v176
    v_lshlrev_b32 v146, 16, v177
    v_and_b32 v147, 0xffff0000, v177
    v_lshlrev_b32 v148, 16, v178
    v_and_b32 v149, 0xffff0000, v178
    v_lshlrev_b32 v150, 16, v179
    v_and_b32 v151, 0xffff0000, v179
    v_lshlrev_b32 v152, 16, v180
    v_and_b32 v153, 0xffff0000, v180
    v_lshlrev_b32 v154, 16, v181
    v_and_b32 v155, 0xffff0000, v181
    v_lshlrev_b32 v156, 16, v182
    v_and_b32 v157, 0xffff0000, v182
    v_lshlrev_b32 v158, 16, v183
    v_and_b32 v159, 0xffff0000, v183
    v_lshlrev_b32 v160, 16, v184
    v_and_b32 v161, 0xffff0000, v184
    v_lshlrev_b32 v162, 16, v185
    v_and_b32 v163, 0xffff0000, v185
    v_lshlrev_b32 v164, 16, v186
    v_and_b32 v165, 0xffff0000, v186
    v_lshlrev_b32 v166, 16, v187
    v_and_b32 v167, 0xffff0000, v187
    v_lshlrev_b32 v168, 16, v188
    v_and_b32 v169, 0xffff0000, v188
    v_lshlrev_b32 v170, 16, v189
    v_and_b32 v171, 0xffff0000, v189
    v_lshlrev_b32 v172, 16, v190
    v_and_b32 v173, 0xffff0000, v190
    v_lshlrev_b32 v174, 16, v191
    v_and_b32 v175, 0xffff0000, v191
    s_waitcnt lgkmcnt(0)
    s_barrier
    ds_read_b128 v[32:35], v240 offset:0
    ds_read_b64_tr_b16 v[48:49], v242 offset:0
    ds_read_b64_tr_b16 v[50:51], v242 offset:512
    ds_read_b128 v[36:39], v240 offset:1024
    ds_read_b64_tr_b16 v[52:53], v242 offset:32
    ds_read_b64_tr_b16 v[54:55], v242 offset:544
    ds_read_b128 v[40:43], v240 offset:2048
    ds_read_b128 v[44:47], v240 offset:3072
    ds_read_b128 v[56:59], v240 offset:8192
    ds_read_b64_tr_b16 v[72:73], v242 offset:4224
    ds_read_b64_tr_b16 v[74:75], v242 offset:4736
    ds_read_b128 v[60:63], v240 offset:9216
    ds_read_b64_tr_b16 v[76:77], v242 offset:4256
    ds_read_b64_tr_b16 v[78:79], v242 offset:4768
    ds_read_b128 v[64:67], v240 offset:10240
    ds_read_b128 v[68:71], v240 offset:11264
    v_add_u16 v240, 0x4000, v240
    s_add_u32 s16, s16, 8448
    s_cmp_eq_u32 s16, 92928
    s_cselect_b32 s16, 0, s16
    v_add_u32 v242, s16, v241
    s_waitcnt lgkmcnt(0)
r1_loop:
    s_bitcmp1_b32 2, s17
    s_cbranch_scc1 r1_nb0
    s_barrier
r1_nb0:
    v_mfma_f32_16x16x32_bf16 v[0:3], v[48:51], v[32:35], v[0:3]
    ds_read_b128 v[80:83], v240 offset:0
    ds_read_b64_tr_b16 v[96:97], v242 offset:0
    v_mfma_f32_16x16x32_bf16 v[8:11], v[48:51], v[36:39], v[8:11]
    ds_read_b64_tr_b16 v[98:99], v242 offset:512
    v_mfma_f32_16x16x32_bf16 v[16:19], v[48:51], v[40:43], v[16:19]
    ds_read_b128 v[84:87], v240 offset:1024
    ds_read_b64_tr_b16 v[100:101], v242 offset:32
    v_mfma_f32_16x16x32_bf16 v[24:27], v[48:51], v[44:47], v[24:27]
    ds_read_b64_tr_b16 v[102:103], v242 offset:544
    v_mfma_f32_16x16x32_bf16 v[28:31], v[52:55], v[44:47], v[28:31]
    ds_read_b128 v[88:91], v240 offset:2048
    ds_read_b128 v[92:95], v240 offset:3072
    v_mfma_f32_16x16x32_bf16 v[20:23], v[52:55], v[40:43], v[20:23]
    ds_read_b128 v[104:107], v240 offset:8192
    v_mfma_f32_16x16x32_bf16 v[12:15], v[52:55], v[36:39], v[12:15]
    ds_read_b64_tr_b16 v[120:121], v242 offset:4224
    ds_read_b64_tr_b16 v[122:123], v242 offset:4736
    v_mfma_f32_16x16x32_bf16 v[4:7], v[52:55], v[32:35], v[4:7]
    ds_read_b128 v[108:111], v240 offset:9216
    v_mfma_f32_16x16x32_bf16 v[0:3], v[72:75], v[56:59], v[0:3]
    ds_read_b64_tr_b16 v[124:125], v242 offset:4256
    ds_read_b64_tr_b16 v[126:127], v242 offset:4768
    v_mfma_f32_16x16x32_bf16 v[8:11], v[72:75], v[60:63], v[8:11]
    ds_read_b128 v[112:115], v240 offset:10240
    v_mfma_f32_16x16x32_bf16 v[16:19], v[72:75], v[64:67], v[16:19]
    ds_read_b128 v[116:119], v240 offset:11264
    v_mfma_f32_16x16x32_bf16 v[24:27], v[72:75], v[68:71], v[24:27]
    v_add_u16 v240, 0x4000, v240
    v_mfma_f32_16x16x32_bf16 v[28:31], v[76:79], v[68:71], v[28:31]
    s_add_u32 s16, s16, 8448
    s_cmp_eq_u32 s16, 92928
    v_mfma_f32_16x16x32_bf16 v[20:23], v[76:79], v[64:67], v[20:23]
    s_cselect_b32 s16, 0, s16
    v_mfma_f32_16x16x32_bf16 v[12:15], v[76:79], v[60:63], v[12:15]
    v_add_u32 v242, s16, v241
    v_mfma_f32_16x16x32_bf16 v[4:7], v[76:79], v[56:59], v[4:7]
    s_waitcnt lgkmcnt(0)
    s_bitcmp1_b32 2, s17
    s_cbranch_scc1 r1_nb1
    s_barrier
r1_nb1:
    v_mfma_f32_16x16x32_bf16 v[0:3], v[96:99], v[80:83], v[0:3]
    ds_read_b128 v[32:35], v240 offset:0
    ds_read_b64_tr_b16 v[48:49], v242 offset:0
    v_mfma_f32_16x16x32_bf16 v[8:11], v[96:99], v[84:87], v[8:11]
    ds_read_b64_tr_b16 v[50:51], v242 offset:512
    v_mfma_f32_16x16x32_bf16 v[16:19], v[96:99], v[88:91], v[16:19]
    ds_read_b128 v[36:39], v240 offset:1024
    ds_read_b64_tr_b16 v[52:53], v242 offset:32
    v_mfma_f32_16x16x32_bf16 v[24:27], v[96:99], v[92:95], v[24:27]
    ds_read_b64_tr_b16 v[54:55], v242 offset:544
    v_mfma_f32_16x16x32_bf16 v[28:31], v[100:103], v[92:95], v[28:31]
    ds_read_b128 v[40:43], v240 offset:2048
    ds_read_b128 v[44:47], v240 offset:3072
    v_mfma_f32_16x16x32_bf16 v[20:23], v[100:103], v[88:91], v[20:23]
    ds_read_b128 v[56:59], v240 offset:8192
    v_mfma_f32_16x16x32_bf16 v[12:15], v[100:103], v[84:87], v[12:15]
    ds_read_b64_tr_b16 v[72:73], v242 offset:4224
    ds_read_b64_tr_b16 v[74:75], v242 offset:4736
    v_mfma_f32_16x16x32_bf16 v[4:7], v[100:103], v[80:83], v[4:7]
    ds_read_b128 v[60:63], v240 offset:9216
    v_mfma_f32_16x16x32_bf16 v[0:3], v[120:123], v[104:107], v[0:3]
    ds_read_b64_tr_b16 v[76:77], v242 offset:4256
    ds_read_b64_tr_b16 v[78:79], v242 offset:4768
    v_mfma_f32_16x16x32_bf16 v[8:11], v[120:123], v[108:111], v[8:11]
    ds_read_b128 v[64:67], v240 offset:10240
    v_mfma_f32_16x16x32_bf16 v[16:19], v[120:123], v[112:115], v[16:19]
    ds_read_b128 v[68:71], v240 offset:11264
    v_mfma_f32_16x16x32_bf16 v[24:27], v[120:123], v[116:119], v[24:27]
    v_add_u16 v240, 0x4000, v240
    s_add_u32 s16, s16, 8448
    s_cmp_eq_u32 s16, 92928
    v_mfma_f32_16x16x32_bf16 v[28:31], v[124:127], v[116:119], v[28:31]
    s_cselect_b32 s16, 0, s16
    v_mfma_f32_16x16x32_bf16 v[20:23], v[124:127], v[112:115], v[20:23]
    v_add_u32 v242, s16, v241
    v_mfma_f32_16x16x32_bf16 v[12:15], v[124:127], v[108:111], v[12:15]
    s_sub_u32 s17, s17, 1
    s_cmp_lg_u32 s17, 0
    v_mfma_f32_16x16x32_bf16 v[4:7], v[124:127], v[104:107], v[4:7]
    s_waitcnt lgkmcnt(0)
    s_cbranch_scc1 r1_loop
    s_barrier
    s_nop 5
    v_mov_b32 v88, 0x3f803f80
    v_cvt_pk_bf16_f32 v208, v0, v1
    v_cvt_pk_bf16_f32 v209, v2, v3
    v_cvt_pk_bf16_f32 v210, v4, v5
    v_cvt_pk_bf16_f32 v211, v6, v7
    v_cvt_pk_bf16_f32 v212, v8, v9
    v_cvt_pk_bf16_f32 v213, v10, v11
    v_cvt_pk_bf16_f32 v214, v12, v13
    v_cvt_pk_bf16_f32 v215, v14, v15
    v_lshlrev_b32 v96, 16, v208
    v_lshlrev_b32 v98, 16, v209
    v_lshlrev_b32 v100, 16, v210
    v_lshlrev_b32 v102, 16, v211
    v_lshlrev_b32 v104, 16, v212
    v_lshlrev_b32 v106, 16, v213
    v_lshlrev_b32 v108, 16, v214
    v_lshlrev_b32 v110, 16, v215
    v_and_b32 v97, 0xffff0000, v208
    v_and_b32 v99, 0xffff0000, v209
    v_and_b32 v101, 0xffff0000, v210
    v_and_b32 v103, 0xffff0000, v211
    v_and_b32 v105, 0xffff0000, v212
    v_and_b32 v107, 0xffff0000, v213
    v_and_b32 v109, 0xffff0000, v214
    v_and_b32 v111, 0xffff0000, v215
    v_pk_add_f32 v[96:97], v[96:97], v[144:145]
    v_pk_add_f32 v[98:99], v[98:99], v[146:147]
    v_pk_add_f32 v[100:101], v[100:101], v[148:149]
    v_pk_add_f32 v[102:103], v[102:103], v[150:151]
    v_pk_add_f32 v[104:105], v[104:105], v[152:153]
    v_pk_add_f32 v[106:107], v[106:107], v[154:155]
    v_pk_add_f32 v[108:109], v[108:109], v[156:157]
    v_pk_add_f32 v[110:111], v[110:111], v[158:159]
    v_cvt_pk_bf16_f32 v64, v96, v97
    v_cvt_pk_bf16_f32 v65, v98, v99
    v_cvt_pk_bf16_f32 v66, v100, v101
    v_cvt_pk_bf16_f32 v67, v102, v103
    v_cvt_pk_bf16_f32 v68, v104, v105
    v_cvt_pk_bf16_f32 v69, v106, v107
    v_cvt_pk_bf16_f32 v70, v108, v109
    v_cvt_pk_bf16_f32 v71, v110, v111
    buffer_store_dwordx4 v[64:67], v249, s[80:83], s20 offen offset:0 sc0 sc1
    buffer_store_dwordx4 v[68:71], v249, s[80:83], s20 offen offset:1024 sc0 sc1
    v_cvt_pk_bf16_f32 v208, v16, v17
    v_cvt_pk_bf16_f32 v209, v18, v19
    v_cvt_pk_bf16_f32 v210, v20, v21
    v_cvt_pk_bf16_f32 v211, v22, v23
    v_cvt_pk_bf16_f32 v212, v24, v25
    v_cvt_pk_bf16_f32 v213, v26, v27
    v_cvt_pk_bf16_f32 v214, v28, v29
    v_cvt_pk_bf16_f32 v215, v30, v31
    v_lshlrev_b32 v96, 16, v208
    v_lshlrev_b32 v98, 16, v209
    v_lshlrev_b32 v100, 16, v210
    v_lshlrev_b32 v102, 16, v211
    v_lshlrev_b32 v104, 16, v212
    v_lshlrev_b32 v106, 16, v213
    v_lshlrev_b32 v108, 16, v214
    v_lshlrev_b32 v110, 16, v215
    v_and_b32 v97, 0xffff0000, v208
    v_and_b32 v99, 0xffff0000, v209
    v_and_b32 v101, 0xffff0000, v210
    v_and_b32 v103, 0xffff0000, v211
    v_and_b32 v105, 0xffff0000, v212
    v_and_b32 v107, 0xffff0000, v213
    v_and_b32 v109, 0xffff0000, v214
    v_and_b32 v111, 0xffff0000, v215
    v_pk_add_f32 v[96:97], v[96:97], v[160:161]
    v_pk_add_f32 v[98:99], v[98:99], v[162:163]
    v_pk_add_f32 v[100:101], v[100:101], v[164:165]
    v_pk_add_f32 v[102:103], v[102:103], v[166:167]
    v_pk_add_f32 v[104:105], v[104:105], v[168:169]
    v_pk_add_f32 v[106:107], v[106:107], v[170:171]
    v_pk_add_f32 v[108:109], v[108:109], v[172:173]
    v_pk_add_f32 v[110:111], v[110:111], v[174:175]
    v_cvt_pk_bf16_f32 v72, v96, v97
    v_cvt_pk_bf16_f32 v73, v98, v99
    v_cvt_pk_bf16_f32 v74, v100, v101
    v_cvt_pk_bf16_f32 v75, v102, v103
    v_cvt_pk_bf16_f32 v76, v104, v105
    v_cvt_pk_bf16_f32 v77, v106, v107
    v_cvt_pk_bf16_f32 v78, v108, v109
    v_cvt_pk_bf16_f32 v79, v110, v111
    buffer_store_dwordx4 v[72:75], v249, s[80:83], s20 offen offset:2048 sc0 sc1
    buffer_store_dwordx4 v[76:79], v249, s[80:83], s20 offen offset:3072 sc0 sc1
    v_dot2_f32_bf16 v80, v64, v88, 0
    v_dot2_f32_bf16 v84, v64, v64, 0
    v_dot2_f32_bf16 v81, v68, v88, 0
    v_dot2_f32_bf16 v85, v68, v68, 0
    v_dot2_f32_bf16 v82, v72, v88, 0
    v_dot2_f32_bf16 v86, v72, v72, 0
    v_dot2_f32_bf16 v83, v76, v88, 0
    v_dot2_f32_bf16 v87, v76, v76, 0
    v_dot2_f32_bf16 v80, v65, v88, v80
    v_dot2_f32_bf16 v84, v65, v65, v84
    v_dot2_f32_bf16 v81, v69, v88, v81
    v_dot2_f32_bf16 v85, v69, v69, v85
    v_dot2_f32_bf16 v82, v73, v88, v82
    v_dot2_f32_bf16 v86, v73, v73, v86
    v_dot2_f32_bf16 v83, v77, v88, v83
    v_dot2_f32_bf16 v87, v77, v77, v87
    v_dot2_f32_bf16 v80, v66, v88, v80
    v_dot2_f32_bf16 v84, v66, v66, v84
    v_dot2_f32_bf16 v81, v70, v88, v81
    v_dot2_f32_bf16 v85, v70, v70, v85
    v_dot2_f32_bf16 v82, v74, v88, v82
    v_dot2_f32_bf16 v86, v74, v74, v86
    v_dot2_f32_bf16 v83, v78, v88, v83
    v_dot2_f32_bf16 v87, v78, v78, v87
    v_dot2_f32_bf16 v80, v67, v88, v80
    v_dot2_f32_bf16 v84, v67, v67, v84
    v_dot2_f32_bf16 v81, v71, v88, v81
    v_dot2_f32_bf16 v85, v71, v71, v85
    v_dot2_f32_bf16 v82, v75, v88, v82
    v_dot2_f32_bf16 v86, v75, v75, v86
    v_dot2_f32_bf16 v83, v79, v88, v83
    v_dot2_f32_bf16 v87, v79, v79, v87
    s_nop 2
    v_permlane16_swap_b32 v80, v81
    v_permlane16_swap_b32 v82, v83
    v_permlane16_swap_b32 v84, v85
    v_permlane16_swap_b32 v86, v87
    v_add_f32 v80, v80, v81
    v_add_f32 v82, v82, v83
    v_add_f32 v84, v84, v85
    v_add_f32 v86, v86, v87
    s_nop 1
    v_permlane32_swap_b32 v80, v82
    v_permlane32_swap_b32 v84, v86
    v_add_f32 v80, v80, v82
    v_add_f32 v81, v84, v86
    buffer_store_dwordx2 v[80:81], v239, s[80:83], s24 offen sc0 sc1
    s_lshl_b32 s64, s75, 15
    s_lshl_b32 s66, s73, 9
    s_add_u32 s64, s64, s66
    s_add_u32 s64, s64, 75505664
    s_lshl_b32 s65, s72, 5
    s_add_u32 s64, s64, s65
    s_lshl_b32 s65, s3, 2
    s_add_u32 s64, s64, s65
    v_mov_b32 v208, 0
    v_mov_b32 v209, 1
    s_cmp_lg_u32 s78, 0
    s_cbranch_scc1 sg_3193_slow
    s_waitcnt vmcnt(0)
    s_mov_b64 exec, 1
    buffer_store_dword v209, v208, s[80:83], s64 offen
    s_mov_b64 exec, -1
sg_3193_done:
    s_and_b32 s64, s3, 1
    s_cmp_eq_u32 s64, 0
    s_cselect_b32 s8, s92, s94
    s_cselect_b32 s9, s93, s95
    s_mov_b32 s10, 7340032
    s_mov_b32 s11, 0x00020000
    s_mul_i32 s19, s64, 14400
    s_lshr_b32 s64, s69, 1
    s_mul_i32 s65, s64, 7200
    s_add_u32 s19, s19, s65
    s_add_u32 s19, s19, 36736
    s_mul_i32 s17, s64, 28672
    s_mul_i32 s65, s74, 448
    s_add_u32 s17, s17, s65
    s_add_u32 s18, s17, 7340032
    s_lshl_b32 s64, s57, 1
    s_add_u32 s64, s64, 3
    s_and_b32 s64, s64, 31
    s_mul_i32 s65, s64, 229376
    s_add_u32 s16, s17, s65
    s_mov_b32 s66, 2341
    v_add_u32 v253, 192, v250
    v_mul_lo_u32 v254, v253, s66
    v_lshrrev_b32 v254, 16, v254
    v_mul_u32_u24 v224, 28, v254
    v_sub_u32 v253, v253, v224
    v_and_b32 v224, 12, v254
    v_add_u32 v254, v254, v224
    v_mul_u32_u24 v254, 7168, v254
    v_lshl_add_u32 v224, v253, 4, v254
    v_add_u32 v253, 256, v250
    v_mul_lo_u32 v254, v253, s66
    v_lshrrev_b32 v254, 16, v254
    v_mul_u32_u24 v225, 28, v254
    v_sub_u32 v253, v253, v225
    v_and_b32 v225, 12, v254
    v_add_u32 v254, v254, v225
    v_mul_u32_u24 v254, 7168, v254
    v_lshl_add_u32 v225, v253, 4, v254
    v_add_u32 v253, 320, v250
    v_mul_lo_u32 v254, v253, s66
    v_lshrrev_b32 v254, 16, v254
    v_mul_u32_u24 v226, 28, v254
    v_sub_u32 v253, v253, v226
    v_and_b32 v226, 12, v254
    v_add_u32 v254, v254, v226
    v_mul_u32_u24 v254, 7168, v254
    v_lshl_add_u32 v226, v253, 4, v254
    v_add_u32 v253, 384, v250
    v_mul_lo_u32 v254, v253, s66
    v_lshrrev_b32 v254, 16, v254
    v_mul_u32_u24 v227, 28, v254
    v_sub_u32 v253, v253, v227
    v_and_b32 v227, 12, v254
    v_add_u32 v254, v254, v227
    v_mul_u32_u24 v254, 7168, v254
    v_lshl_add_u32 v227, v253, 4, v254
    s_and_b32 s64, s3, 1
    s_lshl_b32 s64, s64, 12
    v_add_u32 v231, s64, v249
    v_lshrrev_b32 v253, 1, v251
    v_lshrrev_b32 v254, 2, v252
    v_lshl_add_u32 v253, v253, 2, v254
    v_mul_u32_u24 v253, 448, v253
    v_and_b32 v254, 1, v251
    v_mul_u32_u24 v254, 7200, v254
    v_add_u32 v253, v253, v254
    v_and_b32 v254, 3, v252
    v_lshl_add_u32 v253, v254, 3, v253
    v_add_u32 v253, 36736, v253
    s_lshr_b32 s64, s69, 1
    s_lshl_b32 s28, s64, 2
    s_lshl_b32 s65, s28, 5
    v_add_u32 v232, s65, v253
    v_add_u32 v233, 57600, v232
    s_lshl_b32 s25, s73, 1
    s_add_u32 s25, s25, s68
    s_mul_i32 s25, s25, 458752
    s_lshl_b32 s66, s60, 24
    s_add_u32 s25, s25, s66
    s_add_u32 s25, s25, 20971520
    s_and_b32 s64, s74, 7
    s_mul_i32 s64, s64, 57344
    s_add_u32 s25, s25, s64
    v_mov_b32 v192, 0
    v_mov_b32 v193, 0
    v_mov_b32 v194, 0
    v_mov_b32 v195, 0
    s_nop 1
    v_mfma_f32_32x32x16_bf16 v[0:15], v[192:195], v[192:195], 0
    v_mfma_f32_32x32x16_bf16 v[16:31], v[192:195], v[192:195], 0
    v_mfma_f32_32x32x16_bf16 v[32:47], v[192:195], v[192:195], 0
    v_mfma_f32_32x32x16_bf16 v[48:63], v[192:195], v[192:195], 0
    v_mfma_f32_32x32x16_bf16 v[64:79], v[192:195], v[192:195], 0
    v_mfma_f32_32x32x16_bf16 v[80:95], v[192:195], v[192:195], 0
    v_mfma_f32_32x32x16_bf16 v[96:111], v[192:195], v[192:195], 0
    v_mfma_f32_32x32x16_bf16 v[112:127], v[192:195], v[192:195], 0
    s_mov_b32 s12, s96
    s_mov_b32 s13, s97
    s_mov_b32 s14, 7340032
    s_mov_b32 s15, 0x00020000
    s_lshl_b32 s34, s2, 2
    s_add_u32 s34, s34, s3
    s_mul_i32 s34, s34, 7168
    s_cmp_eq_u32 s75, 0
    s_cselect_b32 s34, s34, 0x40000000
    v_lshlrev_b32 v247, 7, v250
    v_and_b32 v248, 56, v250
    v_lshl_add_u32 v247, v248, 24, v247
    s_barrier
    ds_read_b128 v[192:195], v231 offset:0
    ds_read_b128 v[196:199], v231 offset:1024
    ds_read_b128 v[200:203], v231 offset:2048
    ds_read_b128 v[204:207], v231 offset:3072
    ds_read_b64_tr_b16 v[128:129], v232 offset:28800
    ds_read_b64_tr_b16 v[130:131], v232 offset:32384
    ds_read_b64_tr_b16 v[144:145], v232 offset:43200
    ds_read_b64_tr_b16 v[146:147], v232 offset:46784
    ds_read_b64_tr_b16 v[132:133], v232 offset:28832
    ds_read_b64_tr_b16 v[134:135], v232 offset:32416
    ds_read_b64_tr_b16 v[148:149], v232 offset:43232
    ds_read_b64_tr_b16 v[150:151], v232 offset:46816
    ds_read_b64_tr_b16 v[136:137], v232 offset:28864
    ds_read_b64_tr_b16 v[138:139], v232 offset:32448
    ds_read_b64_tr_b16 v[152:153], v232 offset:43264
    ds_read_b64_tr_b16 v[154:155], v232 offset:46848
    ds_read_b64_tr_b16 v[140:141], v232 offset:28896
    ds_read_b64_tr_b16 v[142:143], v232 offset:32480
    ds_read_b64_tr_b16 v[156:157], v232 offset:43296
    ds_read_b64_tr_b16 v[158:159], v232 offset:46880
    s_mov_b32 s24, 7
g3c0_loop:
    s_waitcnt vmcnt(5) lgkmcnt(0)
    s_barrier
    v_mfma_f32_16x16x32_bf16 v[0:3], v[128:131], v[192:195], v[0:3]
    ds_read_b128 v[208:211], v231 offset:8192
    v_mfma_f32_16x16x32_bf16 v[4:7], v[128:131], v[196:199], v[4:7]
    ds_read_b128 v[212:215], v231 offset:9216
    v_mfma_f32_16x16x32_bf16 v[8:11], v[128:131], v[200:203], v[8:11]
    ds_read_b128 v[216:219], v231 offset:10240
    v_mfma_f32_16x16x32_bf16 v[12:15], v[128:131], v[204:207], v[12:15]
    ds_read_b128 v[220:223], v231 offset:11264
    v_mfma_f32_16x16x32_bf16 v[76:79], v[144:147], v[204:207], v[76:79]
    ds_read_b64_tr_b16 v[160:161], v233 offset:0
    v_mfma_f32_16x16x32_bf16 v[72:75], v[144:147], v[200:203], v[72:75]
    s_add_u32 m0, s19, 3072
    s_nop 0
    buffer_load_dwordx4 v224, s[8:11], s16 offen lds
    v_mfma_f32_16x16x32_bf16 v[68:71], v[144:147], v[196:199], v[68:71]
    ds_read_b64_tr_b16 v[162:163], v233 offset:3584
    v_mfma_f32_16x16x32_bf16 v[64:67], v[144:147], v[192:195], v[64:67]
    ds_read_b64_tr_b16 v[176:177], v233 offset:14400
    v_mfma_f32_16x16x32_bf16 v[16:19], v[132:135], v[192:195], v[16:19]
    ds_read_b64_tr_b16 v[178:179], v233 offset:17984
    v_mfma_f32_16x16x32_bf16 v[20:23], v[132:135], v[196:199], v[20:23]
    ds_read_b64_tr_b16 v[164:165], v233 offset:32
    v_mfma_f32_16x16x32_bf16 v[24:27], v[132:135], v[200:203], v[24:27]
    ds_read_b64_tr_b16 v[166:167], v233 offset:3616
    v_mfma_f32_16x16x32_bf16 v[28:31], v[132:135], v[204:207], v[28:31]
    s_add_u32 m0, s19, 4096
    s_nop 0
    buffer_load_dwordx4 v225, s[8:11], s16 offen lds
    v_mfma_f32_16x16x32_bf16 v[92:95], v[148:151], v[204:207], v[92:95]
    v_mfma_f32_16x16x32_bf16 v[88:91], v[148:151], v[200:203], v[88:91]
    ds_read_b64_tr_b16 v[180:181], v233 offset:14432
    v_mfma_f32_16x16x32_bf16 v[84:87], v[148:151], v[196:199], v[84:87]
    ds_read_b64_tr_b16 v[182:183], v233 offset:18016
    v_mfma_f32_16x16x32_bf16 v[80:83], v[148:151], v[192:195], v[80:83]
    ds_read_b64_tr_b16 v[168:169], v233 offset:64
    v_mfma_f32_16x16x32_bf16 v[32:35], v[136:139], v[192:195], v[32:35]
    ds_read_b64_tr_b16 v[170:171], v233 offset:3648
    v_mfma_f32_16x16x32_bf16 v[36:39], v[136:139], v[196:199], v[36:39]
    ds_read_b64_tr_b16 v[184:185], v233 offset:14464
    v_mfma_f32_16x16x32_bf16 v[40:43], v[136:139], v[200:203], v[40:43]
    s_add_u32 m0, s19, 5120
    s_nop 0
    buffer_load_dwordx4 v226, s[8:11], s16 offen lds
    v_mfma_f32_16x16x32_bf16 v[44:47], v[136:139], v[204:207], v[44:47]
    ds_read_b64_tr_b16 v[186:187], v233 offset:18048
    v_mfma_f32_16x16x32_bf16 v[108:111], v[152:155], v[204:207], v[108:111]
    ds_read_b64_tr_b16 v[172:173], v233 offset:96
    v_mfma_f32_16x16x32_bf16 v[104:107], v[152:155], v[200:203], v[104:107]
    ds_read_b64_tr_b16 v[174:175], v233 offset:3680
    v_mfma_f32_16x16x32_bf16 v[100:103], v[152:155], v[196:199], v[100:103]
    ds_read_b64_tr_b16 v[188:189], v233 offset:14496
    v_mfma_f32_16x16x32_bf16 v[96:99], v[152:155], v[192:195], v[96:99]
    ds_read_b64_tr_b16 v[190:191], v233 offset:18080
    v_mfma_f32_16x16x32_bf16 v[48:51], v[140:143], v[192:195], v[48:51]
    s_add_u32 m0, s19, 6144
    s_nop 0
    buffer_load_dwordx4 v227, s[8:11], s16 offen lds
    s_add_u32 s16, s16, 229376
    s_cmp_eq_u32 s16, s18
    s_cselect_b32 s16, s17, s16
    v_mfma_f32_16x16x32_bf16 v[52:55], v[140:143], v[196:199], v[52:55]
    v_mfma_f32_16x16x32_bf16 v[56:59], v[140:143], v[200:203], v[56:59]
    v_mfma_f32_16x16x32_bf16 v[60:63], v[140:143], v[204:207], v[60:63]
    v_mfma_f32_16x16x32_bf16 v[124:127], v[156:159], v[204:207], v[124:127]
    v_mfma_f32_16x16x32_bf16 v[120:123], v[156:159], v[200:203], v[120:123]
    v_mfma_f32_16x16x32_bf16 v[116:119], v[156:159], v[196:199], v[116:119]
    v_mfma_f32_16x16x32_bf16 v[112:115], v[156:159], v[192:195], v[112:115]
    s_waitcnt vmcnt(4) lgkmcnt(0)
    s_barrier
    v_mfma_f32_16x16x32_bf16 v[0:3], v[160:163], v[208:211], v[0:3]
    ds_read_b128 v[192:195], v231 offset:16384
    v_mfma_f32_16x16x32_bf16 v[4:7], v[160:163], v[212:215], v[4:7]
    ds_read_b128 v[196:199], v231 offset:17408
    v_mfma_f32_16x16x32_bf16 v[8:11], v[160:163], v[216:219], v[8:11]
    ds_read_b128 v[200:203], v231 offset:18432
    v_mfma_f32_16x16x32_bf16 v[12:15], v[160:163], v[220:223], v[12:15]
    ds_read_b128 v[204:207], v231 offset:19456
    v_mfma_f32_16x16x32_bf16 v[76:79], v[176:179], v[220:223], v[76:79]
    ds_read_b64_tr_b16 v[128:129], v233 offset:28800
    v_mfma_f32_16x16x32_bf16 v[72:75], v[176:179], v[216:219], v[72:75]
    s_add_u32 m0, s19, 31872
    s_nop 0
    buffer_load_dwordx4 v224, s[8:11], s16 offen lds
    v_mfma_f32_16x16x32_bf16 v[68:71], v[176:179], v[212:215], v[68:71]
    ds_read_b64_tr_b16 v[130:131], v233 offset:32384
    v_mfma_f32_16x16x32_bf16 v[64:67], v[176:179], v[208:211], v[64:67]
    ds_read_b64_tr_b16 v[144:145], v233 offset:43200
    v_mfma_f32_16x16x32_bf16 v[16:19], v[164:167], v[208:211], v[16:19]
    ds_read_b64_tr_b16 v[146:147], v233 offset:46784
    v_mfma_f32_16x16x32_bf16 v[20:23], v[164:167], v[212:215], v[20:23]
    ds_read_b64_tr_b16 v[132:133], v233 offset:28832
    v_mfma_f32_16x16x32_bf16 v[24:27], v[164:167], v[216:219], v[24:27]
    ds_read_b64_tr_b16 v[134:135], v233 offset:32416
    v_mfma_f32_16x16x32_bf16 v[28:31], v[164:167], v[220:223], v[28:31]
    s_add_u32 m0, s19, 32896
    s_nop 0
    buffer_load_dwordx4 v225, s[8:11], s16 offen lds
    v_mfma_f32_16x16x32_bf16 v[92:95], v[180:183], v[220:223], v[92:95]
    v_mfma_f32_16x16x32_bf16 v[88:91], v[180:183], v[216:219], v[88:91]
    ds_read_b64_tr_b16 v[148:149], v233 offset:43232
    v_mfma_f32_16x16x32_bf16 v[84:87], v[180:183], v[212:215], v[84:87]
    ds_read_b64_tr_b16 v[150:151], v233 offset:46816
    v_mfma_f32_16x16x32_bf16 v[80:83], v[180:183], v[208:211], v[80:83]
    ds_read_b64_tr_b16 v[136:137], v233 offset:28864
    v_mfma_f32_16x16x32_bf16 v[32:35], v[168:171], v[208:211], v[32:35]
    ds_read_b64_tr_b16 v[138:139], v233 offset:32448
    v_mfma_f32_16x16x32_bf16 v[36:39], v[168:171], v[212:215], v[36:39]
    ds_read_b64_tr_b16 v[152:153], v233 offset:43264
    v_mfma_f32_16x16x32_bf16 v[40:43], v[168:171], v[216:219], v[40:43]
    s_add_u32 m0, s19, 33920
    s_nop 0
    buffer_load_dwordx4 v226, s[8:11], s16 offen lds
    v_mfma_f32_16x16x32_bf16 v[44:47], v[168:171], v[220:223], v[44:47]
    ds_read_b64_tr_b16 v[154:155], v233 offset:46848
    v_mfma_f32_16x16x32_bf16 v[108:111], v[184:187], v[220:223], v[108:111]
    ds_read_b64_tr_b16 v[140:141], v233 offset:28896
    v_mfma_f32_16x16x32_bf16 v[104:107], v[184:187], v[216:219], v[104:107]
    ds_read_b64_tr_b16 v[142:143], v233 offset:32480
    v_mfma_f32_16x16x32_bf16 v[100:103], v[184:187], v[212:215], v[100:103]
    ds_read_b64_tr_b16 v[156:157], v233 offset:43296
    v_mfma_f32_16x16x32_bf16 v[96:99], v[184:187], v[208:211], v[96:99]
    ds_read_b64_tr_b16 v[158:159], v233 offset:46880
    v_mfma_f32_16x16x32_bf16 v[48:51], v[172:175], v[208:211], v[48:51]
    s_add_u32 m0, s19, 34944
    s_nop 0
    buffer_load_dwordx4 v227, s[8:11], s16 offen lds
    s_add_u32 s16, s16, 229376
    s_cmp_eq_u32 s16, s18
    s_cselect_b32 s16, s17, s16
    v_mfma_f32_16x16x32_bf16 v[52:55], v[172:175], v[212:215], v[52:55]
    v_mfma_f32_16x16x32_bf16 v[56:59], v[172:175], v[216:219], v[56:59]
    v_mfma_f32_16x16x32_bf16 v[60:63], v[172:175], v[220:223], v[60:63]
    v_mfma_f32_16x16x32_bf16 v[124:127], v[188:191], v[220:223], v[124:127]
    v_mfma_f32_16x16x32_bf16 v[120:123], v[188:191], v[216:219], v[120:123]
    v_mfma_f32_16x16x32_bf16 v[116:119], v[188:191], v[212:215], v[116:119]
    v_mfma_f32_16x16x32_bf16 v[112:115], v[188:191], v[208:211], v[112:115]
    s_waitcnt vmcnt(4) lgkmcnt(0)
    s_barrier
    v_mfma_f32_16x16x32_bf16 v[0:3], v[128:131], v[192:195], v[0:3]
    ds_read_b128 v[208:211], v231 offset:24576
    v_mfma_f32_16x16x32_bf16 v[4:7], v[128:131], v[196:199], v[4:7]
    ds_read_b128 v[212:215], v231 offset:25600
    v_mfma_f32_16x16x32_bf16 v[8:11], v[128:131], v[200:203], v[8:11]
    ds_read_b128 v[216:219], v231 offset:26624
    v_mfma_f32_16x16x32_bf16 v[12:15], v[128:131], v[204:207], v[12:15]
    ds_read_b128 v[220:223], v231 offset:27648
    v_mfma_f32_16x16x32_bf16 v[76:79], v[144:147], v[204:207], v[76:79]
    ds_read_b64_tr_b16 v[160:161], v232 offset:0
    v_mfma_f32_16x16x32_bf16 v[72:75], v[144:147], v[200:203], v[72:75]
    s_add_u32 m0, s19, 60672
    s_nop 0
    buffer_load_dwordx4 v224, s[8:11], s16 offen lds
    v_mfma_f32_16x16x32_bf16 v[68:71], v[144:147], v[196:199], v[68:71]
    ds_read_b64_tr_b16 v[162:163], v232 offset:3584
    v_mfma_f32_16x16x32_bf16 v[64:67], v[144:147], v[192:195], v[64:67]
    ds_read_b64_tr_b16 v[176:177], v232 offset:14400
    v_mfma_f32_16x16x32_bf16 v[16:19], v[132:135], v[192:195], v[16:19]
    ds_read_b64_tr_b16 v[178:179], v232 offset:17984
    v_mfma_f32_16x16x32_bf16 v[20:23], v[132:135], v[196:199], v[20:23]
    ds_read_b64_tr_b16 v[164:165], v232 offset:32
    v_mfma_f32_16x16x32_bf16 v[24:27], v[132:135], v[200:203], v[24:27]
    ds_read_b64_tr_b16 v[166:167], v232 offset:3616
    v_mfma_f32_16x16x32_bf16 v[28:31], v[132:135], v[204:207], v[28:31]
    s_add_u32 m0, s19, 61696
    s_nop 0
    buffer_load_dwordx4 v225, s[8:11], s16 offen lds
    v_mfma_f32_16x16x32_bf16 v[92:95], v[148:151], v[204:207], v[92:95]
    v_mfma_f32_16x16x32_bf16 v[88:91], v[148:151], v[200:203], v[88:91]
    ds_read_b64_tr_b16 v[180:181], v232 offset:14432
    v_mfma_f32_16x16x32_bf16 v[84:87], v[148:151], v[196:199], v[84:87]
    ds_read_b64_tr_b16 v[182:183], v232 offset:18016
    v_mfma_f32_16x16x32_bf16 v[80:83], v[148:151], v[192:195], v[80:83]
    ds_read_b64_tr_b16 v[168:169], v232 offset:64
    v_mfma_f32_16x16x32_bf16 v[32:35], v[136:139], v[192:195], v[32:35]
    ds_read_b64_tr_b16 v[170:171], v232 offset:3648
    v_mfma_f32_16x16x32_bf16 v[36:39], v[136:139], v[196:199], v[36:39]
    ds_read_b64_tr_b16 v[184:185], v232 offset:14464
    v_mfma_f32_16x16x32_bf16 v[40:43], v[136:139], v[200:203], v[40:43]
    s_add_u32 m0, s19, 62720
    s_nop 0
    buffer_load_dwordx4 v226, s[8:11], s16 offen lds
    v_mfma_f32_16x16x32_bf16 v[44:47], v[136:139], v[204:207], v[44:47]
    ds_read_b64_tr_b16 v[186:187], v232 offset:18048
    v_mfma_f32_16x16x32_bf16 v[108:111], v[152:155], v[204:207], v[108:111]
    ds_read_b64_tr_b16 v[172:173], v232 offset:96
    v_mfma_f32_16x16x32_bf16 v[104:107], v[152:155], v[200:203], v[104:107]
    ds_read_b64_tr_b16 v[174:175], v232 offset:3680
    v_mfma_f32_16x16x32_bf16 v[100:103], v[152:155], v[196:199], v[100:103]
    ds_read_b64_tr_b16 v[188:189], v232 offset:14496
    v_mfma_f32_16x16x32_bf16 v[96:99], v[152:155], v[192:195], v[96:99]
    ds_read_b64_tr_b16 v[190:191], v232 offset:18080
    v_mfma_f32_16x16x32_bf16 v[48:51], v[140:143], v[192:195], v[48:51]
    s_add_u32 m0, s19, 63744
    s_nop 0
    buffer_load_dwordx4 v227, s[8:11], s16 offen lds
    s_add_u32 s16, s16, 229376
    s_cmp_eq_u32 s16, s18
    s_cselect_b32 s16, s17, s16
    v_mfma_f32_16x16x32_bf16 v[52:55], v[140:143], v[196:199], v[52:55]
    v_mfma_f32_16x16x32_bf16 v[56:59], v[140:143], v[200:203], v[56:59]
    v_mfma_f32_16x16x32_bf16 v[60:63], v[140:143], v[204:207], v[60:63]
    buffer_load_dword v248, v247, s[12:15], s34 offen
    s_add_u32 s34, s34, 1024
    v_mfma_f32_16x16x32_bf16 v[124:127], v[156:159], v[204:207], v[124:127]
    v_mfma_f32_16x16x32_bf16 v[120:123], v[156:159], v[200:203], v[120:123]
    v_mfma_f32_16x16x32_bf16 v[116:119], v[156:159], v[196:199], v[116:119]
    v_mfma_f32_16x16x32_bf16 v[112:115], v[156:159], v[192:195], v[112:115]
    s_waitcnt vmcnt(5) lgkmcnt(0)
    s_barrier
    v_mfma_f32_16x16x32_bf16 v[0:3], v[160:163], v[208:211], v[0:3]
    ds_read_b128 v[192:195], v231 offset:0
    v_mfma_f32_16x16x32_bf16 v[4:7], v[160:163], v[212:215], v[4:7]
    ds_read_b128 v[196:199], v231 offset:1024
    v_mfma_f32_16x16x32_bf16 v[8:11], v[160:163], v[216:219], v[8:11]
    ds_read_b128 v[200:203], v231 offset:2048
    v_mfma_f32_16x16x32_bf16 v[12:15], v[160:163], v[220:223], v[12:15]
    ds_read_b128 v[204:207], v231 offset:3072
    v_mfma_f32_16x16x32_bf16 v[76:79], v[176:179], v[220:223], v[76:79]
    ds_read_b64_tr_b16 v[128:129], v232 offset:28800
    v_mfma_f32_16x16x32_bf16 v[72:75], v[176:179], v[216:219], v[72:75]
    s_add_u32 m0, s19, 89472
    s_nop 0
    buffer_load_dwordx4 v224, s[8:11], s16 offen lds
    v_mfma_f32_16x16x32_bf16 v[68:71], v[176:179], v[212:215], v[68:71]
    ds_read_b64_tr_b16 v[130:131], v232 offset:32384
    v_mfma_f32_16x16x32_bf16 v[64:67], v[176:179], v[208:211], v[64:67]
    ds_read_b64_tr_b16 v[144:145], v232 offset:43200
    v_mfma_f32_16x16x32_bf16 v[16:19], v[164:167], v[208:211], v[16:19]
    ds_read_b64_tr_b16 v[146:147], v232 offset:46784
    v_mfma_f32_16x16x32_bf16 v[20:23], v[164:167], v[212:215], v[20:23]
    ds_read_b64_tr_b16 v[132:133], v232 offset:28832
    v_mfma_f32_16x16x32_bf16 v[24:27], v[164:167], v[216:219], v[24:27]
    ds_read_b64_tr_b16 v[134:135], v232 offset:32416
    v_mfma_f32_16x16x32_bf16 v[28:31], v[164:167], v[220:223], v[28:31]
    s_add_u32 m0, s19, 90496
    s_nop 0
    buffer_load_dwordx4 v225, s[8:11], s16 offen lds
    v_mfma_f32_16x16x32_bf16 v[92:95], v[180:183], v[220:223], v[92:95]
    v_mfma_f32_16x16x32_bf16 v[88:91], v[180:183], v[216:219], v[88:91]
    ds_read_b64_tr_b16 v[148:149], v232 offset:43232
    v_mfma_f32_16x16x32_bf16 v[84:87], v[180:183], v[212:215], v[84:87]
    ds_read_b64_tr_b16 v[150:151], v232 offset:46816
    v_mfma_f32_16x16x32_bf16 v[80:83], v[180:183], v[208:211], v[80:83]
    ds_read_b64_tr_b16 v[136:137], v232 offset:28864
    v_mfma_f32_16x16x32_bf16 v[32:35], v[168:171], v[208:211], v[32:35]
    ds_read_b64_tr_b16 v[138:139], v232 offset:32448
    v_mfma_f32_16x16x32_bf16 v[36:39], v[168:171], v[212:215], v[36:39]
    ds_read_b64_tr_b16 v[152:153], v232 offset:43264
    v_mfma_f32_16x16x32_bf16 v[40:43], v[168:171], v[216:219], v[40:43]
    s_add_u32 m0, s19, 91520
    s_nop 0
    buffer_load_dwordx4 v226, s[8:11], s16 offen lds
    v_mfma_f32_16x16x32_bf16 v[44:47], v[168:171], v[220:223], v[44:47]
    ds_read_b64_tr_b16 v[154:155], v232 offset:46848
    v_mfma_f32_16x16x32_bf16 v[108:111], v[184:187], v[220:223], v[108:111]
    ds_read_b64_tr_b16 v[140:141], v232 offset:28896
    v_mfma_f32_16x16x32_bf16 v[104:107], v[184:187], v[216:219], v[104:107]
    ds_read_b64_tr_b16 v[142:143], v232 offset:32480
    v_mfma_f32_16x16x32_bf16 v[100:103], v[184:187], v[212:215], v[100:103]
    ds_read_b64_tr_b16 v[156:157], v232 offset:43296
    v_mfma_f32_16x16x32_bf16 v[96:99], v[184:187], v[208:211], v[96:99]
    ds_read_b64_tr_b16 v[158:159], v232 offset:46880
    v_mfma_f32_16x16x32_bf16 v[48:51], v[172:175], v[208:211], v[48:51]
    s_add_u32 m0, s19, 92544
    s_nop 0
    buffer_load_dwordx4 v227, s[8:11], s16 offen lds
    s_add_u32 s16, s16, 229376
    s_cmp_eq_u32 s16, s18
    s_cselect_b32 s16, s17, s16
    v_mfma_f32_16x16x32_bf16 v[52:55], v[172:175], v[212:215], v[52:55]
    v_mfma_f32_16x16x32_bf16 v[56:59], v[172:175], v[216:219], v[56:59]
    v_mfma_f32_16x16x32_bf16 v[60:63], v[172:175], v[220:223], v[60:63]
    v_mfma_f32_16x16x32_bf16 v[124:127], v[188:191], v[220:223], v[124:127]
    v_mfma_f32_16x16x32_bf16 v[120:123], v[188:191], v[216:219], v[120:123]
    v_mfma_f32_16x16x32_bf16 v[116:119], v[188:191], v[212:215], v[116:119]
    v_mfma_f32_16x16x32_bf16 v[112:115], v[188:191], v[208:211], v[112:115]
    s_sub_u32 s24, s24, 1
    s_cmp_lg_u32 s24, 0
    s_cbranch_scc1 g3c0_loop
    s_sub_u32 s27, s74, s58
    s_and_b32 s27, s27, 7
    s_cmp_lt_u32 s27, 4
    s_cselect_b32 s27, 14, 0
    s_waitcnt vmcnt(4) lgkmcnt(0)
    s_barrier
    v_mfma_f32_16x16x32_bf16 v[0:3], v[128:131], v[192:195], v[0:3]
    ds_read_b128 v[208:211], v231 offset:8192
    v_mfma_f32_16x16x32_bf16 v[4:7], v[128:131], v[196:199], v[4:7]
    ds_read_b128 v[212:215], v231 offset:9216
    v_mfma_f32_16x16x32_bf16 v[8:11], v[128:131], v[200:203], v[8:11]
    ds_read_b128 v[216:219], v231 offset:10240
    v_mfma_f32_16x16x32_bf16 v[12:15], v[128:131], v[204:207], v[12:15]
    ds_read_b128 v[220:223], v231 offset:11264
    v_mfma_f32_16x16x32_bf16 v[76:79], v[144:147], v[204:207], v[76:79]
    ds_read_b64_tr_b16 v[160:161], v233 offset:0
    v_mfma_f32_16x16x32_bf16 v[72:75], v[144:147], v[200:203], v[72:75]
    s_add_u32 m0, s19, 3072
    s_nop 0
    buffer_load_dwordx4 v224, s[8:11], s16 offen lds
    v_mfma_f32_16x16x32_bf16 v[68:71], v[144:147], v[196:199], v[68:71]
    ds_read_b64_tr_b16 v[162:163], v233 offset:3584
    v_mfma_f32_16x16x32_bf16 v[64:67], v[144:147], v[192:195], v[64:67]
    ds_read_b64_tr_b16 v[176:177], v233 offset:14400
    v_mfma_f32_16x16x32_bf16 v[16:19], v[132:135], v[192:195], v[16:19]
    ds_read_b64_tr_b16 v[178:179], v233 offset:17984
    v_mfma_f32_16x16x32_bf16 v[20:23], v[132:135], v[196:199], v[20:23]
    ds_read_b64_tr_b16 v[164:165], v233 offset:32
    v_mfma_f32_16x16x32_bf16 v[24:27], v[132:135], v[200:203], v[24:27]
    ds_read_b64_tr_b16 v[166:167], v233 offset:3616
    v_mfma_f32_16x16x32_bf16 v[28:31], v[132:135], v[204:207], v[28:31]
    s_add_u32 m0, s19, 4096
    s_nop 0
    buffer_load_dwordx4 v225, s[8:11], s16 offen lds
    v_mfma_f32_16x16x32_bf16 v[92:95], v[148:151], v[204:207], v[92:95]
    v_mfma_f32_16x16x32_bf16 v[88:91], v[148:151], v[200:203], v[88:91]
    ds_read_b64_tr_b16 v[180:181], v233 offset:14432
    v_mfma_f32_16x16x32_bf16 v[84:87], v[148:151], v[196:199], v[84:87]
    ds_read_b64_tr_b16 v[182:183], v233 offset:18016
    v_mfma_f32_16x16x32_bf16 v[80:83], v[148:151], v[192:195], v[80:83]
    ds_read_b64_tr_b16 v[168:169], v233 offset:64
    v_mfma_f32_16x16x32_bf16 v[32:35], v[136:139], v[192:195], v[32:35]
    ds_read_b64_tr_b16 v[170:171], v233 offset:3648
    v_mfma_f32_16x16x32_bf16 v[36:39], v[136:139], v[196:199], v[36:39]
    ds_read_b64_tr_b16 v[184:185], v233 offset:14464
    v_mfma_f32_16x16x32_bf16 v[40:43], v[136:139], v[200:203], v[40:43]
    s_add_u32 m0, s19, 5120
    s_nop 0
    buffer_load_dwordx4 v226, s[8:11], s16 offen lds
    v_mfma_f32_16x16x32_bf16 v[44:47], v[136:139], v[204:207], v[44:47]
    ds_read_b64_tr_b16 v[186:187], v233 offset:18048
    v_mfma_f32_16x16x32_bf16 v[108:111], v[152:155], v[204:207], v[108:111]
    ds_read_b64_tr_b16 v[172:173], v233 offset:96
    v_mfma_f32_16x16x32_bf16 v[104:107], v[152:155], v[200:203], v[104:107]
    ds_read_b64_tr_b16 v[174:175], v233 offset:3680
    v_mfma_f32_16x16x32_bf16 v[100:103], v[152:155], v[196:199], v[100:103]
    ds_read_b64_tr_b16 v[188:189], v233 offset:14496
    v_mfma_f32_16x16x32_bf16 v[96:99], v[152:155], v[192:195], v[96:99]
    ds_read_b64_tr_b16 v[190:191], v233 offset:18080
    v_mfma_f32_16x16x32_bf16 v[48:51], v[140:143], v[192:195], v[48:51]
    s_add_u32 m0, s19, 6144
    s_nop 0
    buffer_load_dwordx4 v227, s[8:11], s16 offen lds
    s_add_u32 s16, s16, 229376
    s_cmp_eq_u32 s16, s18
    s_cselect_b32 s16, s17, s16
    v_mfma_f32_16x16x32_bf16 v[52:55], v[140:143], v[196:199], v[52:55]
    v_mfma_f32_16x16x32_bf16 v[56:59], v[140:143], v[200:203], v[56:59]
    v_mfma_f32_16x16x32_bf16 v[60:63], v[140:143], v[204:207], v[60:63]
    v_mfma_f32_16x16x32_bf16 v[124:127], v[156:159], v[204:207], v[124:127]
    v_mfma_f32_16x16x32_bf16 v[120:123], v[156:159], v[200:203], v[120:123]
    v_mfma_f32_16x16x32_bf16 v[116:119], v[156:159], v[196:199], v[116:119]
    v_mfma_f32_16x16x32_bf16 v[112:115], v[156:159], v[192:195], v[112:115]
    s_waitcnt vmcnt(4) lgkmcnt(0)
    s_barrier
    v_mfma_f32_16x16x32_bf16 v[0:3], v[160:163], v[208:211], v[0:3]
    ds_read_b128 v[192:195], v231 offset:16384
    v_mfma_f32_16x16x32_bf16 v[4:7], v[160:163], v[212:215], v[4:7]
    ds_read_b128 v[196:199], v231 offset:17408
    v_lshlrev_b32 v247, 7, v250
    s_add_u32 s29, s3, 0
    s_lshl_b32 s30, s29, 12
    s_add_u32 s30, s30, s25
    s_cmp_lt_u32 s29, s27
    s_cselect_b32 s30, s30, 0x7f000000
    s_mov_b64 exec, 0xffffffff
    buffer_load_dword v248, v247, s[80:83], s30 offen sc1
    s_mov_b64 exec, -1
    v_mfma_f32_16x16x32_bf16 v[8:11], v[160:163], v[216:219], v[8:11]
    ds_read_b128 v[200:203], v231 offset:18432
    v_mfma_f32_16x16x32_bf16 v[12:15], v[160:163], v[220:223], v[12:15]
    ds_read_b128 v[204:207], v231 offset:19456
    v_mfma_f32_16x16x32_bf16 v[76:79], v[176:179], v[220:223], v[76:79]
    v_mfma_f32_16x16x32_bf16 v[72:75], v[176:179], v[216:219], v[72:75]
    ds_read_b64_tr_b16 v[128:129], v233 offset:28800
    v_mfma_f32_16x16x32_bf16 v[68:71], v[176:179], v[212:215], v[68:71]
    ds_read_b64_tr_b16 v[130:131], v233 offset:32384
    v_mfma_f32_16x16x32_bf16 v[64:67], v[176:179], v[208:211], v[64:67]
    ds_read_b64_tr_b16 v[144:145], v233 offset:43200
    v_mfma_f32_16x16x32_bf16 v[16:19], v[164:167], v[208:211], v[16:19]
    v_mfma_f32_16x16x32_bf16 v[20:23], v[164:167], v[212:215], v[20:23]
    ds_read_b64_tr_b16 v[146:147], v233 offset:46784
    v_mfma_f32_16x16x32_bf16 v[24:27], v[164:167], v[216:219], v[24:27]
    ds_read_b64_tr_b16 v[132:133], v233 offset:28832
    v_mfma_f32_16x16x32_bf16 v[28:31], v[164:167], v[220:223], v[28:31]
    ds_read_b64_tr_b16 v[134:135], v233 offset:32416
    v_mfma_f32_16x16x32_bf16 v[92:95], v[180:183], v[220:223], v[92:95]
    v_mfma_f32_16x16x32_bf16 v[88:91], v[180:183], v[216:219], v[88:91]
    ds_read_b64_tr_b16 v[148:149], v233 offset:43232
    v_mfma_f32_16x16x32_bf16 v[84:87], v[180:183], v[212:215], v[84:87]
    ds_read_b64_tr_b16 v[150:151], v233 offset:46816
    v_mfma_f32_16x16x32_bf16 v[80:83], v[180:183], v[208:211], v[80:83]
    ds_read_b64_tr_b16 v[136:137], v233 offset:28864
    v_mfma_f32_16x16x32_bf16 v[32:35], v[168:171], v[208:211], v[32:35]
    ds_read_b64_tr_b16 v[138:139], v233 offset:32448
    v_mfma_f32_16x16x32_bf16 v[36:39], v[168:171], v[212:215], v[36:39]
    v_lshlrev_b32 v247, 7, v250
    s_add_u32 s29, s3, 8
    s_lshl_b32 s30, s29, 12
    s_add_u32 s30, s30, s25
    s_cmp_lt_u32 s29, s27
    s_cselect_b32 s30, s30, 0x7f000000
    s_mov_b64 exec, 0xffffffff
    buffer_load_dword v248, v247, s[80:83], s30 offen sc1
    s_mov_b64 exec, -1
    v_mfma_f32_16x16x32_bf16 v[40:43], v[168:171], v[216:219], v[40:43]
    ds_read_b64_tr_b16 v[152:153], v233 offset:43264
    v_mfma_f32_16x16x32_bf16 v[44:47], v[168:171], v[220:223], v[44:47]
    ds_read_b64_tr_b16 v[154:155], v233 offset:46848
    v_mfma_f32_16x16x32_bf16 v[108:111], v[184:187], v[220:223], v[108:111]
    ds_read_b64_tr_b16 v[140:141], v233 offset:28896
    v_mfma_f32_16x16x32_bf16 v[104:107], v[184:187], v[216:219], v[104:107]
    v_mfma_f32_16x16x32_bf16 v[100:103], v[184:187], v[212:215], v[100:103]
    ds_read_b64_tr_b16 v[142:143], v233 offset:32480
    v_mfma_f32_16x16x32_bf16 v[96:99], v[184:187], v[208:211], v[96:99]
    ds_read_b64_tr_b16 v[156:157], v233 offset:43296
    v_mfma_f32_16x16x32_bf16 v[48:51], v[172:175], v[208:211], v[48:51]
    ds_read_b64_tr_b16 v[158:159], v233 offset:46880
    v_mfma_f32_16x16x32_bf16 v[52:55], v[172:175], v[212:215], v[52:55]
    v_mfma_f32_16x16x32_bf16 v[56:59], v[172:175], v[216:219], v[56:59]
    v_mfma_f32_16x16x32_bf16 v[60:63], v[172:175], v[220:223], v[60:63]
    v_mfma_f32_16x16x32_bf16 v[124:127], v[188:191], v[220:223], v[124:127]
    v_mfma_f32_16x16x32_bf16 v[120:123], v[188:191], v[216:219], v[120:123]
    v_mfma_f32_16x16x32_bf16 v[116:119], v[188:191], v[212:215], v[116:119]
    v_mfma_f32_16x16x32_bf16 v[112:115], v[188:191], v[208:211], v[112:115]
    s_waitcnt vmcnt(2) lgkmcnt(0)
    s_barrier
    s_setprio 2
    v_mfma_f32_16x16x32_bf16 v[0:3], v[128:131], v[192:195], v[0:3]
    ds_read_b128 v[208:211], v231 offset:24576
    ds_read_b128 v[212:215], v231 offset:25600
    v_mfma_f32_16x16x32_bf16 v[4:7], v[128:131], v[196:199], v[4:7]
    ds_read_b128 v[216:219], v231 offset:26624
    v_mfma_f32_16x16x32_bf16 v[8:11], v[128:131], v[200:203], v[8:11]
    ds_read_b128 v[220:223], v231 offset:27648
    ds_read_b64_tr_b16 v[160:161], v232 offset:0
    v_mfma_f32_16x16x32_bf16 v[12:15], v[128:131], v[204:207], v[12:15]
    ds_read_b64_tr_b16 v[162:163], v232 offset:3584
    v_mfma_f32_16x16x32_bf16 v[76:79], v[144:147], v[204:207], v[76:79]
    ds_read_b64_tr_b16 v[176:177], v232 offset:14400
    ds_read_b64_tr_b16 v[178:179], v232 offset:17984
    v_mfma_f32_16x16x32_bf16 v[72:75], v[144:147], v[200:203], v[72:75]
    ds_read_b64_tr_b16 v[164:165], v232 offset:32
    v_mfma_f32_16x16x32_bf16 v[68:71], v[144:147], v[196:199], v[68:71]
    ds_read_b64_tr_b16 v[166:167], v232 offset:3616
    v_mfma_f32_16x16x32_bf16 v[64:67], v[144:147], v[192:195], v[64:67]
    ds_read_b64_tr_b16 v[180:181], v232 offset:14432
    ds_read_b64_tr_b16 v[182:183], v232 offset:18016
    v_mfma_f32_16x16x32_bf16 v[16:19], v[132:135], v[192:195], v[16:19]
    ds_read_b64_tr_b16 v[168:169], v232 offset:64
    v_mfma_f32_16x16x32_bf16 v[20:23], v[132:135], v[196:199], v[20:23]
    ds_read_b64_tr_b16 v[170:171], v232 offset:3648
    ds_read_b64_tr_b16 v[184:185], v232 offset:14464
    v_mfma_f32_16x16x32_bf16 v[24:27], v[132:135], v[200:203], v[24:27]
    ds_read_b64_tr_b16 v[186:187], v232 offset:18048
    v_mfma_f32_16x16x32_bf16 v[28:31], v[132:135], v[204:207], v[28:31]
    ds_read_b64_tr_b16 v[172:173], v232 offset:96
    ds_read_b64_tr_b16 v[174:175], v232 offset:3680
    v_mfma_f32_16x16x32_bf16 v[92:95], v[148:151], v[204:207], v[92:95]
    ds_read_b64_tr_b16 v[188:189], v232 offset:14496
    v_mfma_f32_16x16x32_bf16 v[88:91], v[148:151], v[200:203], v[88:91]
    ds_read_b64_tr_b16 v[190:191], v232 offset:18080
    v_mfma_f32_16x16x32_bf16 v[84:87], v[148:151], v[196:199], v[84:87]
    v_mfma_f32_16x16x32_bf16 v[80:83], v[148:151], v[192:195], v[80:83]
    v_mfma_f32_16x16x32_bf16 v[32:35], v[136:139], v[192:195], v[32:35]
    v_mfma_f32_16x16x32_bf16 v[36:39], v[136:139], v[196:199], v[36:39]
    v_mfma_f32_16x16x32_bf16 v[40:43], v[136:139], v[200:203], v[40:43]
    v_mfma_f32_16x16x32_bf16 v[44:47], v[136:139], v[204:207], v[44:47]
    v_mfma_f32_16x16x32_bf16 v[108:111], v[152:155], v[204:207], v[108:111]
    s_waitcnt lgkmcnt(0)
    s_barrier
    v_mfma_f32_16x16x32_bf16 v[104:107], v[152:155], v[200:203], v[104:107]
    v_mfma_f32_16x16x32_bf16 v[100:103], v[152:155], v[196:199], v[100:103]
    v_mfma_f32_16x16x32_bf16 v[96:99], v[152:155], v[192:195], v[96:99]
    v_mfma_f32_16x16x32_bf16 v[48:51], v[140:143], v[192:195], v[48:51]
    v_mfma_f32_16x16x32_bf16 v[52:55], v[140:143], v[196:199], v[52:55]
    v_mfma_f32_16x16x32_bf16 v[56:59], v[140:143], v[200:203], v[56:59]
    v_mfma_f32_16x16x32_bf16 v[60:63], v[140:143], v[204:207], v[60:63]
    v_mfma_f32_16x16x32_bf16 v[124:127], v[156:159], v[204:207], v[124:127]
    v_mfma_f32_16x16x32_bf16 v[120:123], v[156:159], v[200:203], v[120:123]
    v_mfma_f32_16x16x32_bf16 v[116:119], v[156:159], v[196:199], v[116:119]
    v_mfma_f32_16x16x32_bf16 v[112:115], v[156:159], v[192:195], v[112:115]
    s_and_b32 s64, s3, 1
    s_lshl_b32 s64, s64, 9
    s_add_u32 s64, s64, 159744
    v_lshlrev_b32 v253, 3, v252
    v_add_u32 v253, s64, v253
    s_lshl_b32 s64, s28, 6
    s_add_u32 s64, s64, 160896
    v_lshlrev_b32 v254, 4, v251
    v_add_u32 v231, s64, v254
    v_mfma_f32_16x16x32_bf16 v[0:3], v[160:163], v[208:211], v[0:3]
    ds_read_b64 v[192:193], v253 offset:0
    v_mfma_f32_16x16x32_bf16 v[4:7], v[160:163], v[212:215], v[4:7]
    ds_read_b64 v[194:195], v253 offset:128
    v_mfma_f32_16x16x32_bf16 v[8:11], v[160:163], v[216:219], v[8:11]
    ds_read_b64 v[196:197], v253 offset:256
    v_mfma_f32_16x16x32_bf16 v[12:15], v[160:163], v[220:223], v[12:15]
    v_mfma_f32_16x16x32_bf16 v[76:79], v[176:179], v[220:223], v[76:79]
    ds_read_b64 v[198:199], v253 offset:384
    v_mfma_f32_16x16x32_bf16 v[72:75], v[176:179], v[216:219], v[72:75]
    ds_read_b128 v[128:131], v231 offset:0
    v_mfma_f32_16x16x32_bf16 v[68:71], v[176:179], v[212:215], v[68:71]
    v_mfma_f32_16x16x32_bf16 v[64:67], v[176:179], v[208:211], v[64:67]
    ds_read_b128 v[132:135], v231 offset:64
    v_mfma_f32_16x16x32_bf16 v[16:19], v[164:167], v[208:211], v[16:19]
    ds_read_b128 v[136:139], v231 offset:128
    v_mfma_f32_16x16x32_bf16 v[20:23], v[164:167], v[212:215], v[20:23]
    ds_read_b128 v[140:143], v231 offset:192
    v_mfma_f32_16x16x32_bf16 v[24:27], v[164:167], v[216:219], v[24:27]
    v_mfma_f32_16x16x32_bf16 v[28:31], v[164:167], v[220:223], v[28:31]
    ds_read_b128 v[144:147], v231 offset:896
    v_mfma_f32_16x16x32_bf16 v[92:95], v[180:183], v[220:223], v[92:95]
    ds_read_b128 v[148:151], v231 offset:960
    v_mfma_f32_16x16x32_bf16 v[88:91], v[180:183], v[216:219], v[88:91]
    v_mfma_f32_16x16x32_bf16 v[84:87], v[180:183], v[212:215], v[84:87]
    ds_read_b128 v[152:155], v231 offset:1024
    v_mfma_f32_16x16x32_bf16 v[80:83], v[180:183], v[208:211], v[80:83]
    ds_read_b128 v[156:159], v231 offset:1088
    v_mfma_f32_16x16x32_bf16 v[32:35], v[168:171], v[208:211], v[32:35]
    v_mfma_f32_16x16x32_bf16 v[36:39], v[168:171], v[212:215], v[36:39]
    v_mfma_f32_16x16x32_bf16 v[40:43], v[168:171], v[216:219], v[40:43]
    v_mfma_f32_16x16x32_bf16 v[44:47], v[168:171], v[220:223], v[44:47]
    v_mfma_f32_16x16x32_bf16 v[108:111], v[184:187], v[220:223], v[108:111]
    v_mfma_f32_16x16x32_bf16 v[104:107], v[184:187], v[216:219], v[104:107]
    v_mfma_f32_16x16x32_bf16 v[100:103], v[184:187], v[212:215], v[100:103]
    v_mfma_f32_16x16x32_bf16 v[96:99], v[184:187], v[208:211], v[96:99]
    v_mfma_f32_16x16x32_bf16 v[48:51], v[172:175], v[208:211], v[48:51]
    v_mfma_f32_16x16x32_bf16 v[52:55], v[172:175], v[212:215], v[52:55]
    v_mfma_f32_16x16x32_bf16 v[56:59], v[172:175], v[216:219], v[56:59]
    v_mfma_f32_16x16x32_bf16 v[60:63], v[172:175], v[220:223], v[60:63]
    v_mfma_f32_16x16x32_bf16 v[124:127], v[188:191], v[220:223], v[124:127]
    v_mfma_f32_16x16x32_bf16 v[120:123], v[188:191], v[216:219], v[120:123]
    v_mfma_f32_16x16x32_bf16 v[116:119], v[188:191], v[212:215], v[116:119]
    v_mfma_f32_16x16x32_bf16 v[112:115], v[188:191], v[208:211], v[112:115]
    s_setprio 0
    s_and_b32 s64, s3, 1
    s_lshl_b32 s64, s64, 12
    s_add_u32 s25, s25, s64
    s_lshr_b32 s64, s69, 1
    s_lshl_b32 s64, s64, 14
    s_add_u32 s25, s25, s64
    s_add_u32 s26, s25, 8192
    s_and_b32 s64, s3, 1
    s_lshl_b32 s64, s64, 12
    s_lshr_b32 s65, s69, 1
    s_lshl_b32 s65, s65, 14
    s_add_u32 s64, s64, s65
    v_add_u32 v233, s64, v249
    v_add_u16 v232, 0xe000, v233
    s_waitcnt lgkmcnt(0)
    s_mov_b32 s64, 0xbfb8aa3b
    v_mul_f32 v176, v193, v193
    v_sub_f32 v160, 0, v192
    v_mul_f32 v168, s64, v193
    v_sub_f32 v161, 0, v192
    v_mul_f32 v169, s64, v193
    v_mul_f32 v178, v195, v195
    v_sub_f32 v162, 0, v194
    v_mul_f32 v170, s64, v195
    v_sub_f32 v163, 0, v194
    v_mul_f32 v171, s64, v195
    v_mul_f32 v180, v197, v197
    v_sub_f32 v164, 0, v196
    v_mul_f32 v172, s64, v197
    v_sub_f32 v165, 0, v196
    v_mul_f32 v173, s64, v197
    v_mul_f32 v182, v199, v199
    v_sub_f32 v166, 0, v198
    v_mul_f32 v174, s64, v199
    v_sub_f32 v167, 0, v198
    v_mul_f32 v175, s64, v199
    v_rcp_f32 v177, v176
    v_rcp_f32 v176, v176
    v_rcp_f32 v179, v178
    v_rcp_f32 v178, v178
    v_rcp_f32 v181, v180
    v_rcp_f32 v180, v180
    v_rcp_f32 v183, v182
    v_rcp_f32 v182, v182
    v_pk_fma_f32 v[0:1], v[160:161], v[128:129], v[0:1]
    v_pk_fma_f32 v[2:3], v[160:161], v[130:131], v[2:3]
    v_pk_fma_f32 v[16:17], v[160:161], v[132:133], v[16:17]
    v_pk_fma_f32 v[18:19], v[160:161], v[134:135], v[18:19]
    v_pk_fma_f32 v[32:33], v[160:161], v[136:137], v[32:33]
    v_pk_fma_f32 v[34:35], v[160:161], v[138:139], v[34:35]
    v_pk_fma_f32 v[48:49], v[160:161], v[140:141], v[48:49]
    v_pk_fma_f32 v[50:51], v[160:161], v[142:143], v[50:51]
    v_pk_mul_f32 v[200:201], v[168:169], v[0:1]
    v_pk_mul_f32 v[202:203], v[168:169], v[2:3]
    v_pk_mul_f32 v[204:205], v[168:169], v[16:17]
    v_pk_mul_f32 v[206:207], v[168:169], v[18:19]
    v_pk_mul_f32 v[208:209], v[168:169], v[32:33]
    v_pk_mul_f32 v[210:211], v[168:169], v[34:35]
    v_pk_mul_f32 v[212:213], v[168:169], v[48:49]
    v_pk_mul_f32 v[214:215], v[168:169], v[50:51]
    v_exp_f32 v200, v200
    v_exp_f32 v201, v201
    v_exp_f32 v202, v202
    v_exp_f32 v203, v203
    v_exp_f32 v204, v204
    v_exp_f32 v205, v205
    v_exp_f32 v206, v206
    v_exp_f32 v207, v207
    v_exp_f32 v208, v208
    v_exp_f32 v209, v209
    v_exp_f32 v210, v210
    v_exp_f32 v211, v211
    v_exp_f32 v212, v212
    v_exp_f32 v213, v213
    v_exp_f32 v214, v214
    v_exp_f32 v215, v215
    v_pk_fma_f32 v[64:65], v[160:161], v[144:145], v[64:65]
    v_pk_fma_f32 v[66:67], v[160:161], v[146:147], v[66:67]
    v_pk_fma_f32 v[80:81], v[160:161], v[148:149], v[80:81]
    v_pk_fma_f32 v[82:83], v[160:161], v[150:151], v[82:83]
    v_pk_fma_f32 v[96:97], v[160:161], v[152:153], v[96:97]
    v_pk_fma_f32 v[98:99], v[160:161], v[154:155], v[98:99]
    v_pk_fma_f32 v[112:113], v[160:161], v[156:157], v[112:113]
    v_pk_fma_f32 v[114:115], v[160:161], v[158:159], v[114:115]
    v_pk_fma_f32 v[200:201], v[200:201], v[176:177], v[176:177]
    v_pk_fma_f32 v[202:203], v[202:203], v[176:177], v[176:177]
    v_pk_fma_f32 v[204:205], v[204:205], v[176:177], v[176:177]
    v_pk_fma_f32 v[206:207], v[206:207], v[176:177], v[176:177]
    v_pk_fma_f32 v[208:209], v[208:209], v[176:177], v[176:177]
    v_pk_fma_f32 v[210:211], v[210:211], v[176:177], v[176:177]
    v_pk_fma_f32 v[212:213], v[212:213], v[176:177], v[176:177]
    v_pk_fma_f32 v[214:215], v[214:215], v[176:177], v[176:177]
    v_rcp_f32 v200, v200
    v_rcp_f32 v201, v201
    v_rcp_f32 v202, v202
    v_rcp_f32 v203, v203
    v_rcp_f32 v204, v204
    v_rcp_f32 v205, v205
    v_rcp_f32 v206, v206
    v_rcp_f32 v207, v207
    v_rcp_f32 v208, v208
    v_rcp_f32 v209, v209
    v_rcp_f32 v210, v210
    v_rcp_f32 v211, v211
    v_rcp_f32 v212, v212
    v_rcp_f32 v213, v213
    v_rcp_f32 v214, v214
    v_rcp_f32 v215, v215
    v_pk_mul_f32 v[0:1], v[0:1], v[64:65]
    v_pk_mul_f32 v[2:3], v[2:3], v[66:67]
    v_pk_mul_f32 v[16:17], v[16:17], v[80:81]
    v_pk_mul_f32 v[18:19], v[18:19], v[82:83]
    v_pk_mul_f32 v[32:33], v[32:33], v[96:97]
    v_pk_mul_f32 v[34:35], v[34:35], v[98:99]
    v_pk_mul_f32 v[48:49], v[48:49], v[112:113]
    v_pk_mul_f32 v[50:51], v[50:51], v[114:115]
    v_pk_mul_f32 v[0:1], v[0:1], v[200:201]
    v_pk_mul_f32 v[2:3], v[2:3], v[202:203]
    v_pk_mul_f32 v[16:17], v[16:17], v[204:205]
    v_pk_mul_f32 v[18:19], v[18:19], v[206:207]
    v_pk_mul_f32 v[32:33], v[32:33], v[208:209]
    v_pk_mul_f32 v[34:35], v[34:35], v[210:211]
    v_pk_mul_f32 v[48:49], v[48:49], v[212:213]
    v_pk_mul_f32 v[50:51], v[50:51], v[214:215]
    v_cvt_pk_bf16_f32 v216, v0, v1
    v_cvt_pk_bf16_f32 v217, v2, v3
    v_cvt_pk_bf16_f32 v218, v16, v17
    v_cvt_pk_bf16_f32 v219, v18, v19
    v_cvt_pk_bf16_f32 v220, v32, v33
    v_cvt_pk_bf16_f32 v221, v34, v35
    v_cvt_pk_bf16_f32 v222, v48, v49
    v_cvt_pk_bf16_f32 v223, v50, v51
    buffer_store_dwordx4 v[216:219], v249, s[80:83], s25 offen offset:0
    ds_write_b128 v232, v[216:219] offset:0
    buffer_store_dwordx4 v[220:223], v249, s[80:83], s26 offen offset:0
    ds_write_b128 v233, v[220:223] offset:0
    v_pk_fma_f32 v[4:5], v[162:163], v[128:129], v[4:5]
    v_pk_fma_f32 v[6:7], v[162:163], v[130:131], v[6:7]
    v_pk_fma_f32 v[20:21], v[162:163], v[132:133], v[20:21]
    v_pk_fma_f32 v[22:23], v[162:163], v[134:135], v[22:23]
    v_pk_fma_f32 v[36:37], v[162:163], v[136:137], v[36:37]
    v_pk_fma_f32 v[38:39], v[162:163], v[138:139], v[38:39]
    v_pk_fma_f32 v[52:53], v[162:163], v[140:141], v[52:53]
    v_pk_fma_f32 v[54:55], v[162:163], v[142:143], v[54:55]
    v_pk_mul_f32 v[200:201], v[170:171], v[4:5]
    v_pk_mul_f32 v[202:203], v[170:171], v[6:7]
    v_pk_mul_f32 v[204:205], v[170:171], v[20:21]
    v_pk_mul_f32 v[206:207], v[170:171], v[22:23]
    v_pk_mul_f32 v[208:209], v[170:171], v[36:37]
    v_pk_mul_f32 v[210:211], v[170:171], v[38:39]
    v_pk_mul_f32 v[212:213], v[170:171], v[52:53]
    v_pk_mul_f32 v[214:215], v[170:171], v[54:55]
    v_exp_f32 v200, v200
    v_exp_f32 v201, v201
    v_exp_f32 v202, v202
    v_exp_f32 v203, v203
    v_exp_f32 v204, v204
    v_exp_f32 v205, v205
    v_exp_f32 v206, v206
    v_exp_f32 v207, v207
    v_exp_f32 v208, v208
    v_exp_f32 v209, v209
    v_exp_f32 v210, v210
    v_exp_f32 v211, v211
    v_exp_f32 v212, v212
    v_exp_f32 v213, v213
    v_exp_f32 v214, v214
    v_exp_f32 v215, v215
    v_pk_fma_f32 v[68:69], v[162:163], v[144:145], v[68:69]
    v_pk_fma_f32 v[70:71], v[162:163], v[146:147], v[70:71]
    v_pk_fma_f32 v[84:85], v[162:163], v[148:149], v[84:85]
    v_pk_fma_f32 v[86:87], v[162:163], v[150:151], v[86:87]
    v_pk_fma_f32 v[100:101], v[162:163], v[152:153], v[100:101]
    v_pk_fma_f32 v[102:103], v[162:163], v[154:155], v[102:103]
    v_pk_fma_f32 v[116:117], v[162:163], v[156:157], v[116:117]
    v_pk_fma_f32 v[118:119], v[162:163], v[158:159], v[118:119]
    v_pk_fma_f32 v[200:201], v[200:201], v[178:179], v[178:179]
    v_pk_fma_f32 v[202:203], v[202:203], v[178:179], v[178:179]
    v_pk_fma_f32 v[204:205], v[204:205], v[178:179], v[178:179]
    v_pk_fma_f32 v[206:207], v[206:207], v[178:179], v[178:179]
    v_pk_fma_f32 v[208:209], v[208:209], v[178:179], v[178:179]
    v_pk_fma_f32 v[210:211], v[210:211], v[178:179], v[178:179]
    v_pk_fma_f32 v[212:213], v[212:213], v[178:179], v[178:179]
    v_pk_fma_f32 v[214:215], v[214:215], v[178:179], v[178:179]
    v_rcp_f32 v200, v200
    v_rcp_f32 v201, v201
    v_rcp_f32 v202, v202
    v_rcp_f32 v203, v203
    v_rcp_f32 v204, v204
    v_rcp_f32 v205, v205
    v_rcp_f32 v206, v206
    v_rcp_f32 v207, v207
    v_rcp_f32 v208, v208
    v_rcp_f32 v209, v209
    v_rcp_f32 v210, v210
    v_rcp_f32 v211, v211
    v_rcp_f32 v212, v212
    v_rcp_f32 v213, v213
    v_rcp_f32 v214, v214
    v_rcp_f32 v215, v215
    v_pk_mul_f32 v[4:5], v[4:5], v[68:69]
    v_pk_mul_f32 v[6:7], v[6:7], v[70:71]
    v_pk_mul_f32 v[20:21], v[20:21], v[84:85]
    v_pk_mul_f32 v[22:23], v[22:23], v[86:87]
    v_pk_mul_f32 v[36:37], v[36:37], v[100:101]
    v_pk_mul_f32 v[38:39], v[38:39], v[102:103]
    v_pk_mul_f32 v[52:53], v[52:53], v[116:117]
    v_pk_mul_f32 v[54:55], v[54:55], v[118:119]
    v_pk_mul_f32 v[4:5], v[4:5], v[200:201]
    v_pk_mul_f32 v[6:7], v[6:7], v[202:203]
    v_pk_mul_f32 v[20:21], v[20:21], v[204:205]
    v_pk_mul_f32 v[22:23], v[22:23], v[206:207]
    v_pk_mul_f32 v[36:37], v[36:37], v[208:209]
    v_pk_mul_f32 v[38:39], v[38:39], v[210:211]
    v_pk_mul_f32 v[52:53], v[52:53], v[212:213]
    v_pk_mul_f32 v[54:55], v[54:55], v[214:215]
    v_cvt_pk_bf16_f32 v216, v4, v5
    v_cvt_pk_bf16_f32 v217, v6, v7
    v_cvt_pk_bf16_f32 v218, v20, v21
    v_cvt_pk_bf16_f32 v219, v22, v23
    v_cvt_pk_bf16_f32 v220, v36, v37
    v_cvt_pk_bf16_f32 v221, v38, v39
    v_cvt_pk_bf16_f32 v222, v52, v53
    v_cvt_pk_bf16_f32 v223, v54, v55
    buffer_store_dwordx4 v[216:219], v249, s[80:83], s25 offen offset:1024
    ds_write_b128 v232, v[216:219] offset:1024
    buffer_store_dwordx4 v[220:223], v249, s[80:83], s26 offen offset:1024
    ds_write_b128 v233, v[220:223] offset:1024
    v_pk_fma_f32 v[8:9], v[164:165], v[128:129], v[8:9]
    v_pk_fma_f32 v[10:11], v[164:165], v[130:131], v[10:11]
    v_pk_fma_f32 v[24:25], v[164:165], v[132:133], v[24:25]
    v_pk_fma_f32 v[26:27], v[164:165], v[134:135], v[26:27]
    v_pk_fma_f32 v[40:41], v[164:165], v[136:137], v[40:41]
    v_pk_fma_f32 v[42:43], v[164:165], v[138:139], v[42:43]
    v_pk_fma_f32 v[56:57], v[164:165], v[140:141], v[56:57]
    v_pk_fma_f32 v[58:59], v[164:165], v[142:143], v[58:59]
    v_pk_mul_f32 v[200:201], v[172:173], v[8:9]
    v_pk_mul_f32 v[202:203], v[172:173], v[10:11]
    v_pk_mul_f32 v[204:205], v[172:173], v[24:25]
    v_pk_mul_f32 v[206:207], v[172:173], v[26:27]
    v_pk_mul_f32 v[208:209], v[172:173], v[40:41]
    v_pk_mul_f32 v[210:211], v[172:173], v[42:43]
    v_pk_mul_f32 v[212:213], v[172:173], v[56:57]
    v_pk_mul_f32 v[214:215], v[172:173], v[58:59]
    v_exp_f32 v200, v200
    v_exp_f32 v201, v201
    v_exp_f32 v202, v202
    v_exp_f32 v203, v203
    v_exp_f32 v204, v204
    v_exp_f32 v205, v205
    v_exp_f32 v206, v206
    v_exp_f32 v207, v207
    v_exp_f32 v208, v208
    v_exp_f32 v209, v209
    v_exp_f32 v210, v210
    v_exp_f32 v211, v211
    v_exp_f32 v212, v212
    v_exp_f32 v213, v213
    v_exp_f32 v214, v214
    v_exp_f32 v215, v215
    v_pk_fma_f32 v[72:73], v[164:165], v[144:145], v[72:73]
    v_pk_fma_f32 v[74:75], v[164:165], v[146:147], v[74:75]
    v_pk_fma_f32 v[88:89], v[164:165], v[148:149], v[88:89]
    v_pk_fma_f32 v[90:91], v[164:165], v[150:151], v[90:91]
    v_pk_fma_f32 v[104:105], v[164:165], v[152:153], v[104:105]
    v_pk_fma_f32 v[106:107], v[164:165], v[154:155], v[106:107]
    v_pk_fma_f32 v[120:121], v[164:165], v[156:157], v[120:121]
    v_pk_fma_f32 v[122:123], v[164:165], v[158:159], v[122:123]
    v_pk_fma_f32 v[200:201], v[200:201], v[180:181], v[180:181]
    v_pk_fma_f32 v[202:203], v[202:203], v[180:181], v[180:181]
    v_pk_fma_f32 v[204:205], v[204:205], v[180:181], v[180:181]
    v_pk_fma_f32 v[206:207], v[206:207], v[180:181], v[180:181]
    v_pk_fma_f32 v[208:209], v[208:209], v[180:181], v[180:181]
    v_pk_fma_f32 v[210:211], v[210:211], v[180:181], v[180:181]
    v_pk_fma_f32 v[212:213], v[212:213], v[180:181], v[180:181]
    v_pk_fma_f32 v[214:215], v[214:215], v[180:181], v[180:181]
    v_rcp_f32 v200, v200
    v_rcp_f32 v201, v201
    v_rcp_f32 v202, v202
    v_rcp_f32 v203, v203
    v_rcp_f32 v204, v204
    v_rcp_f32 v205, v205
    v_rcp_f32 v206, v206
    v_rcp_f32 v207, v207
    v_rcp_f32 v208, v208
    v_rcp_f32 v209, v209
    v_rcp_f32 v210, v210
    v_rcp_f32 v211, v211
    v_rcp_f32 v212, v212
    v_rcp_f32 v213, v213
    v_rcp_f32 v214, v214
    v_rcp_f32 v215, v215
    v_pk_mul_f32 v[8:9], v[8:9], v[72:73]
    v_pk_mul_f32 v[10:11], v[10:11], v[74:75]
    v_pk_mul_f32 v[24:25], v[24:25], v[88:89]
    v_pk_mul_f32 v[26:27], v[26:27], v[90:91]
    v_pk_mul_f32 v[40:41], v[40:41], v[104:105]
    v_pk_mul_f32 v[42:43], v[42:43], v[106:107]
    v_pk_mul_f32 v[56:57], v[56:57], v[120:121]
    v_pk_mul_f32 v[58:59], v[58:59], v[122:123]
    v_pk_mul_f32 v[8:9], v[8:9], v[200:201]
    v_pk_mul_f32 v[10:11], v[10:11], v[202:203]
    v_pk_mul_f32 v[24:25], v[24:25], v[204:205]
    v_pk_mul_f32 v[26:27], v[26:27], v[206:207]
    v_pk_mul_f32 v[40:41], v[40:41], v[208:209]
    v_pk_mul_f32 v[42:43], v[42:43], v[210:211]
    v_pk_mul_f32 v[56:57], v[56:57], v[212:213]
    v_pk_mul_f32 v[58:59], v[58:59], v[214:215]
    v_cvt_pk_bf16_f32 v216, v8, v9
    v_cvt_pk_bf16_f32 v217, v10, v11
    v_cvt_pk_bf16_f32 v218, v24, v25
    v_cvt_pk_bf16_f32 v219, v26, v27
    v_cvt_pk_bf16_f32 v220, v40, v41
    v_cvt_pk_bf16_f32 v221, v42, v43
    v_cvt_pk_bf16_f32 v222, v56, v57
    v_cvt_pk_bf16_f32 v223, v58, v59
    buffer_store_dwordx4 v[216:219], v249, s[80:83], s25 offen offset:2048
    ds_write_b128 v232, v[216:219] offset:2048
    buffer_store_dwordx4 v[220:223], v249, s[80:83], s26 offen offset:2048
    ds_write_b128 v233, v[220:223] offset:2048
    v_pk_fma_f32 v[12:13], v[166:167], v[128:129], v[12:13]
    v_pk_fma_f32 v[14:15], v[166:167], v[130:131], v[14:15]
    v_pk_fma_f32 v[28:29], v[166:167], v[132:133], v[28:29]
    v_pk_fma_f32 v[30:31], v[166:167], v[134:135], v[30:31]
    v_pk_fma_f32 v[44:45], v[166:167], v[136:137], v[44:45]
    v_pk_fma_f32 v[46:47], v[166:167], v[138:139], v[46:47]
    v_pk_fma_f32 v[60:61], v[166:167], v[140:141], v[60:61]
    v_pk_fma_f32 v[62:63], v[166:167], v[142:143], v[62:63]
    v_pk_mul_f32 v[200:201], v[174:175], v[12:13]
    v_pk_mul_f32 v[202:203], v[174:175], v[14:15]
    v_pk_mul_f32 v[204:205], v[174:175], v[28:29]
    v_pk_mul_f32 v[206:207], v[174:175], v[30:31]
    v_pk_mul_f32 v[208:209], v[174:175], v[44:45]
    v_pk_mul_f32 v[210:211], v[174:175], v[46:47]
    v_pk_mul_f32 v[212:213], v[174:175], v[60:61]
    v_pk_mul_f32 v[214:215], v[174:175], v[62:63]
    v_exp_f32 v200, v200
    v_exp_f32 v201, v201
    v_exp_f32 v202, v202
    v_exp_f32 v203, v203
    v_exp_f32 v204, v204
    v_exp_f32 v205, v205
    v_exp_f32 v206, v206
    v_exp_f32 v207, v207
    v_exp_f32 v208, v208
    v_exp_f32 v209, v209
    v_exp_f32 v210, v210
    v_exp_f32 v211, v211
    v_exp_f32 v212, v212
    v_exp_f32 v213, v213
    v_exp_f32 v214, v214
    v_exp_f32 v215, v215
    v_pk_fma_f32 v[76:77], v[166:167], v[144:145], v[76:77]
    v_pk_fma_f32 v[78:79], v[166:167], v[146:147], v[78:79]
    v_pk_fma_f32 v[92:93], v[166:167], v[148:149], v[92:93]
    v_pk_fma_f32 v[94:95], v[166:167], v[150:151], v[94:95]
    v_pk_fma_f32 v[108:109], v[166:167], v[152:153], v[108:109]
    v_pk_fma_f32 v[110:111], v[166:167], v[154:155], v[110:111]
    v_pk_fma_f32 v[124:125], v[166:167], v[156:157], v[124:125]
    v_pk_fma_f32 v[126:127], v[166:167], v[158:159], v[126:127]
    v_pk_fma_f32 v[200:201], v[200:201], v[182:183], v[182:183]
    v_pk_fma_f32 v[202:203], v[202:203], v[182:183], v[182:183]
    v_pk_fma_f32 v[204:205], v[204:205], v[182:183], v[182:183]
    v_pk_fma_f32 v[206:207], v[206:207], v[182:183], v[182:183]
    v_pk_fma_f32 v[208:209], v[208:209], v[182:183], v[182:183]
    v_pk_fma_f32 v[210:211], v[210:211], v[182:183], v[182:183]
    v_pk_fma_f32 v[212:213], v[212:213], v[182:183], v[182:183]
    v_pk_fma_f32 v[214:215], v[214:215], v[182:183], v[182:183]
    v_rcp_f32 v200, v200
    v_rcp_f32 v201, v201
    v_rcp_f32 v202, v202
    v_rcp_f32 v203, v203
    v_rcp_f32 v204, v204
    v_rcp_f32 v205, v205
    v_rcp_f32 v206, v206
    v_rcp_f32 v207, v207
    v_rcp_f32 v208, v208
    v_rcp_f32 v209, v209
    v_rcp_f32 v210, v210
    v_rcp_f32 v211, v211
    v_rcp_f32 v212, v212
    v_rcp_f32 v213, v213
    v_rcp_f32 v214, v214
    v_rcp_f32 v215, v215
    v_pk_mul_f32 v[12:13], v[12:13], v[76:77]
    v_pk_mul_f32 v[14:15], v[14:15], v[78:79]
    v_pk_mul_f32 v[28:29], v[28:29], v[92:93]
    v_pk_mul_f32 v[30:31], v[30:31], v[94:95]
    v_pk_mul_f32 v[44:45], v[44:45], v[108:109]
    v_pk_mul_f32 v[46:47], v[46:47], v[110:111]
    v_pk_mul_f32 v[60:61], v[60:61], v[124:125]
    v_pk_mul_f32 v[62:63], v[62:63], v[126:127]
    v_pk_mul_f32 v[12:13], v[12:13], v[200:201]
    v_pk_mul_f32 v[14:15], v[14:15], v[202:203]
    v_pk_mul_f32 v[28:29], v[28:29], v[204:205]
    v_pk_mul_f32 v[30:31], v[30:31], v[206:207]
    v_pk_mul_f32 v[44:45], v[44:45], v[208:209]
    v_pk_mul_f32 v[46:47], v[46:47], v[210:211]
    v_pk_mul_f32 v[60:61], v[60:61], v[212:213]
    v_pk_mul_f32 v[62:63], v[62:63], v[214:215]
    v_cvt_pk_bf16_f32 v216, v12, v13
    v_cvt_pk_bf16_f32 v217, v14, v15
    v_cvt_pk_bf16_f32 v218, v28, v29
    v_cvt_pk_bf16_f32 v219, v30, v31
    v_cvt_pk_bf16_f32 v220, v44, v45
    v_cvt_pk_bf16_f32 v221, v46, v47
    v_cvt_pk_bf16_f32 v222, v60, v61
    v_cvt_pk_bf16_f32 v223, v62, v63
    buffer_store_dwordx4 v[216:219], v249, s[80:83], s25 offen offset:3072
    ds_write_b128 v232, v[216:219] offset:3072
    buffer_store_dwordx4 v[220:223], v249, s[80:83], s26 offen offset:3072
    ds_write_b128 v233, v[220:223] offset:3072
    s_lshr_b32 s64, s3, 1
    s_lshl_b32 s64, s64, 11
    s_add_u32 s64, s64, 49152
    v_add_u32 v240, s64, v249
    v_lshrrev_b32 v253, 2, v252
    v_and_b32 v254, 1, v251
    v_lshl_add_u32 v253, v254, 2, v253
    v_mul_u32_u24 v253, 1056, v253
    v_lshrrev_b32 v254, 1, v251
    v_lshl_add_u32 v253, v254, 8, v253
    v_and_b32 v254, 3, v252
    v_lshl_add_u32 v253, v254, 3, v253
    s_and_b32 s64, s3, 1
    s_lshl_b32 s64, s64, 7
    s_add_u32 s64, s64, 65536
    v_add_u32 v241, s64, v253
    s_mov_b32 s16, 33792
    v_add_u32 v242, s16, v241
    s_and_b32 s25, s3, 1
    s_lshl_b32 s25, s25, 3
    s_add_u32 s25, s25, s61
    s_lshl_b32 s18, s73, 4
    s_add_u32 s18, s18, s25
    s_lshl_b32 s18, s18, 2
    s_add_u32 s18, s18, s68
    s_lshl_b32 s18, s18, 12
    s_lshr_b32 s64, s3, 1
    s_lshl_b32 s64, s64, 11
    s_add_u32 s18, s18, s64
    s_mov_b32 s20, s18
    s_add_u32 s20, s20, 4194304
    s_lshl_b32 s66, s75, 23
    s_add_u32 s18, s18, s66
    s_add_u32 s19, s18, 8192
    s_add_u32 s21, s20, 8192
    buffer_load_dwordx4 v[128:131], v249, s[80:83], s18 offen offset:0 sc1
    buffer_load_dwordx4 v[132:135], v249, s[80:83], s19 offen offset:0 sc1
    buffer_load_dwordx4 v[136:139], v249, s[80:83], s18 offen offset:1024 sc1
    buffer_load_dwordx4 v[140:143], v249, s[80:83], s19 offen offset:1024 sc1
    s_lshl_b32 s24, s73, 4
    s_add_u32 s24, s24, s25
    s_lshl_b32 s24, s24, 11
    s_add_u32 s24, s24, 71827456
    s_lshl_b32 s65, s68, 9
    s_add_u32 s24, s24, s65
    s_lshr_b32 s65, s3, 1
    s_lshl_b32 s65, s65, 8
    s_add_u32 s24, s24, s65
    v_lshrrev_b32 v253, 1, v251
    v_lshl_add_u32 v253, v253, 4, v252
    v_lshlrev_b32 v253, 3, v253
    v_and_b32 v254, 1, v251
    v_lshl_add_u32 v239, v254, 10, v253
    s_lshl_b32 s23, s75, 8
    s_add_u32 s23, s23, s2
    s_lshl_b32 s23, s23, 2
    s_add_u32 s23, s23, s3
    s_lshl_b32 s22, s23, 13
    s_add_u32 s22, s22, 54525952
    s_lshl_b32 s23, s23, 7
    s_add_u32 s23, s23, 75628544
    v_mov_b32 v208, 0
    v_mov_b32 v209, 0
    v_mov_b32 v210, 0
    v_mov_b32 v211, 0
    s_nop 1
    v_mfma_f32_32x32x16_bf16 v[0:15], v[208:211], v[208:211], 0
    v_mfma_f32_32x32x16_bf16 v[16:31], v[208:211], v[208:211], 0
    v_mfma_f32_32x32x16_bf16 v[32:47], v[208:211], v[208:211], 0
    v_mfma_f32_32x32x16_bf16 v[48:63], v[208:211], v[208:211], 0
    s_mov_b32 s17, 14
    s_lshl_b32 s64, s75, 15
    s_lshl_b32 s66, s73, 9
    s_add_u32 s64, s64, s66
    s_add_u32 s64, s64, 75513856
    s_lshl_b32 s65, s72, 5
    s_add_u32 s64, s64, s65
    s_lshl_b32 s65, s3, 2
    s_add_u32 s64, s64, s65
    v_mov_b32 v236, 0
    v_mov_b32 v237, 1
    s_cmp_lg_u32 s78, 0
    s_cbranch_scc1 sg_3194_slow
    s_waitcnt vmcnt(4)
    s_mov_b64 exec, 1
    buffer_store_dword v237, v236, s[80:83], s64 offen
    s_mov_b64 exec, -1
sg_3194_done:
    s_waitcnt lgkmcnt(0)
    s_barrier
    ds_read_b128 v[72:75], v240 offset:12288
    ds_read_b64_tr_b16 v[80:81], v242 offset:8448
    ds_read_b64_tr_b16 v[82:83], v242 offset:8960
    ds_read_b128 v[76:79], v240 offset:13312
    ds_read_b64_tr_b16 v[84:85], v242 offset:8480
    ds_read_b64_tr_b16 v[86:87], v242 offset:8992
    ds_read_b128 v[64:67], v240 offset:8192
    ds_read_b64_tr_b16 v[88:89], v242 offset:8512
    ds_read_b64_tr_b16 v[90:91], v242 offset:9024
    ds_read_b128 v[68:71], v240 offset:9216
    ds_read_b64_tr_b16 v[92:93], v242 offset:8544
    ds_read_b64_tr_b16 v[94:95], v242 offset:9056
    v_add_u16 v240, 0x4000, v240
    s_add_u32 s16, s16, 16896
    s_cmp_eq_u32 s16, 84480
    s_cselect_b32 s16, 0, s16
    v_add_u32 v242, s16, v241
    s_waitcnt lgkmcnt(0)
r3_loop:
    s_bitcmp1_b32 24576, s17
    s_cbranch_scc1 r3_nb0
    s_barrier
r3_nb0:
    v_mfma_f32_16x16x32_bf16 v[32:35], v[80:83], v[72:75], v[32:35]
    ds_read_b128 v[104:107], v240 offset:4096
    ds_read_b64_tr_b16 v[112:113], v242 offset:0
    v_mfma_f32_16x16x32_bf16 v[36:39], v[84:87], v[72:75], v[36:39]
    ds_read_b64_tr_b16 v[114:115], v242 offset:512
    v_mfma_f32_16x16x32_bf16 v[40:43], v[88:91], v[72:75], v[40:43]
    ds_read_b128 v[108:111], v240 offset:5120
    v_mfma_f32_16x16x32_bf16 v[44:47], v[92:95], v[72:75], v[44:47]
    ds_read_b64_tr_b16 v[116:117], v242 offset:32
    v_mfma_f32_16x16x32_bf16 v[60:63], v[92:95], v[76:79], v[60:63]
    ds_read_b64_tr_b16 v[118:119], v242 offset:544
    v_mfma_f32_16x16x32_bf16 v[56:59], v[88:91], v[76:79], v[56:59]
    ds_read_b128 v[96:99], v240 offset:0
    ds_read_b64_tr_b16 v[120:121], v242 offset:64
    v_mfma_f32_16x16x32_bf16 v[52:55], v[84:87], v[76:79], v[52:55]
    ds_read_b64_tr_b16 v[122:123], v242 offset:576
    v_mfma_f32_16x16x32_bf16 v[48:51], v[80:83], v[76:79], v[48:51]
    ds_read_b128 v[100:103], v240 offset:1024
    v_mfma_f32_16x16x32_bf16 v[0:3], v[80:83], v[64:67], v[0:3]
    ds_read_b64_tr_b16 v[124:125], v242 offset:96
    v_mfma_f32_16x16x32_bf16 v[4:7], v[84:87], v[64:67], v[4:7]
    ds_read_b64_tr_b16 v[126:127], v242 offset:608
    v_mfma_f32_16x16x32_bf16 v[8:11], v[88:91], v[64:67], v[8:11]
    v_mfma_f32_16x16x32_bf16 v[12:15], v[92:95], v[64:67], v[12:15]
    v_mfma_f32_16x16x32_bf16 v[28:31], v[92:95], v[68:71], v[28:31]
    v_mfma_f32_16x16x32_bf16 v[24:27], v[88:91], v[68:71], v[24:27]
    v_mfma_f32_16x16x32_bf16 v[20:23], v[84:87], v[68:71], v[20:23]
    v_mfma_f32_16x16x32_bf16 v[16:19], v[80:83], v[68:71], v[16:19]
    s_waitcnt lgkmcnt(0)
    v_mfma_f32_16x16x32_bf16 v[32:35], v[112:115], v[104:107], v[32:35]
    ds_read_b128 v[72:75], v240 offset:12288
    ds_read_b64_tr_b16 v[80:81], v242 offset:8448
    v_mfma_f32_16x16x32_bf16 v[36:39], v[116:119], v[104:107], v[36:39]
    ds_read_b64_tr_b16 v[82:83], v242 offset:8960
    v_mfma_f32_16x16x32_bf16 v[40:43], v[120:123], v[104:107], v[40:43]
    ds_read_b128 v[76:79], v240 offset:13312
    v_mfma_f32_16x16x32_bf16 v[44:47], v[124:127], v[104:107], v[44:47]
    ds_read_b64_tr_b16 v[84:85], v242 offset:8480
    v_mfma_f32_16x16x32_bf16 v[60:63], v[124:127], v[108:111], v[60:63]
    ds_read_b64_tr_b16 v[86:87], v242 offset:8992
    v_mfma_f32_16x16x32_bf16 v[56:59], v[120:123], v[108:111], v[56:59]
    ds_read_b128 v[64:67], v240 offset:8192
    ds_read_b64_tr_b16 v[88:89], v242 offset:8512
    v_mfma_f32_16x16x32_bf16 v[52:55], v[116:119], v[108:111], v[52:55]
    ds_read_b64_tr_b16 v[90:91], v242 offset:9024
    v_mfma_f32_16x16x32_bf16 v[48:51], v[112:115], v[108:111], v[48:51]
    ds_read_b128 v[68:71], v240 offset:9216
    v_mfma_f32_16x16x32_bf16 v[0:3], v[112:115], v[96:99], v[0:3]
    ds_read_b64_tr_b16 v[92:93], v242 offset:8544
    v_mfma_f32_16x16x32_bf16 v[4:7], v[116:119], v[96:99], v[4:7]
    ds_read_b64_tr_b16 v[94:95], v242 offset:9056
    v_mfma_f32_16x16x32_bf16 v[8:11], v[120:123], v[96:99], v[8:11]
    v_add_u16 v240, 0x4000, v240
    v_mfma_f32_16x16x32_bf16 v[12:15], v[124:127], v[96:99], v[12:15]
    s_add_u32 s16, s16, 16896
    s_cmp_eq_u32 s16, 84480
    v_mfma_f32_16x16x32_bf16 v[28:31], v[124:127], v[100:103], v[28:31]
    s_cselect_b32 s16, 0, s16
    v_mfma_f32_16x16x32_bf16 v[24:27], v[120:123], v[100:103], v[24:27]
    v_add_u32 v242, s16, v241
    v_mfma_f32_16x16x32_bf16 v[20:23], v[116:119], v[100:103], v[20:23]
    v_mfma_f32_16x16x32_bf16 v[16:19], v[112:115], v[100:103], v[16:19]
    s_waitcnt lgkmcnt(0)
    s_bitcmp1_b32 2, s17
    s_cbranch_scc1 r3_nb1
    s_barrier
r3_nb1:
    v_mfma_f32_16x16x32_bf16 v[32:35], v[80:83], v[72:75], v[32:35]
    ds_read_b128 v[104:107], v240 offset:4096
    ds_read_b64_tr_b16 v[112:113], v242 offset:0
    v_mfma_f32_16x16x32_bf16 v[36:39], v[84:87], v[72:75], v[36:39]
    ds_read_b64_tr_b16 v[114:115], v242 offset:512
    v_mfma_f32_16x16x32_bf16 v[40:43], v[88:91], v[72:75], v[40:43]
    ds_read_b128 v[108:111], v240 offset:5120
    v_mfma_f32_16x16x32_bf16 v[44:47], v[92:95], v[72:75], v[44:47]
    ds_read_b64_tr_b16 v[116:117], v242 offset:32
    v_mfma_f32_16x16x32_bf16 v[60:63], v[92:95], v[76:79], v[60:63]
    ds_read_b64_tr_b16 v[118:119], v242 offset:544
    v_mfma_f32_16x16x32_bf16 v[56:59], v[88:91], v[76:79], v[56:59]
    ds_read_b128 v[96:99], v240 offset:0
    ds_read_b64_tr_b16 v[120:121], v242 offset:64
    v_mfma_f32_16x16x32_bf16 v[52:55], v[84:87], v[76:79], v[52:55]
    ds_read_b64_tr_b16 v[122:123], v242 offset:576
    v_mfma_f32_16x16x32_bf16 v[48:51], v[80:83], v[76:79], v[48:51]
    ds_read_b128 v[100:103], v240 offset:1024
    v_mfma_f32_16x16x32_bf16 v[0:3], v[80:83], v[64:67], v[0:3]
    ds_read_b64_tr_b16 v[124:125], v242 offset:96
    v_mfma_f32_16x16x32_bf16 v[4:7], v[84:87], v[64:67], v[4:7]
    ds_read_b64_tr_b16 v[126:127], v242 offset:608
    v_mfma_f32_16x16x32_bf16 v[8:11], v[88:91], v[64:67], v[8:11]
    v_mfma_f32_16x16x32_bf16 v[12:15], v[92:95], v[64:67], v[12:15]
    v_mfma_f32_16x16x32_bf16 v[28:31], v[92:95], v[68:71], v[28:31]
    v_mfma_f32_16x16x32_bf16 v[24:27], v[88:91], v[68:71], v[24:27]
    v_mfma_f32_16x16x32_bf16 v[20:23], v[84:87], v[68:71], v[20:23]
    v_mfma_f32_16x16x32_bf16 v[16:19], v[80:83], v[68:71], v[16:19]
    s_waitcnt lgkmcnt(0)
    v_mfma_f32_16x16x32_bf16 v[32:35], v[112:115], v[104:107], v[32:35]
    ds_read_b128 v[72:75], v240 offset:12288
    ds_read_b64_tr_b16 v[80:81], v242 offset:8448
    v_mfma_f32_16x16x32_bf16 v[36:39], v[116:119], v[104:107], v[36:39]
    ds_read_b64_tr_b16 v[82:83], v242 offset:8960
    v_mfma_f32_16x16x32_bf16 v[40:43], v[120:123], v[104:107], v[40:43]
    ds_read_b128 v[76:79], v240 offset:13312
    v_mfma_f32_16x16x32_bf16 v[44:47], v[124:127], v[104:107], v[44:47]
    ds_read_b64_tr_b16 v[84:85], v242 offset:8480
    v_mfma_f32_16x16x32_bf16 v[60:63], v[124:127], v[108:111], v[60:63]
    ds_read_b64_tr_b16 v[86:87], v242 offset:8992
    v_mfma_f32_16x16x32_bf16 v[56:59], v[120:123], v[108:111], v[56:59]
    ds_read_b128 v[64:67], v240 offset:8192
    ds_read_b64_tr_b16 v[88:89], v242 offset:8512
    v_mfma_f32_16x16x32_bf16 v[52:55], v[116:119], v[108:111], v[52:55]
    ds_read_b64_tr_b16 v[90:91], v242 offset:9024
    v_mfma_f32_16x16x32_bf16 v[48:51], v[112:115], v[108:111], v[48:51]
    ds_read_b128 v[68:71], v240 offset:9216
    v_mfma_f32_16x16x32_bf16 v[0:3], v[112:115], v[96:99], v[0:3]
    ds_read_b64_tr_b16 v[92:93], v242 offset:8544
    v_mfma_f32_16x16x32_bf16 v[4:7], v[116:119], v[96:99], v[4:7]
    ds_read_b64_tr_b16 v[94:95], v242 offset:9056
    v_mfma_f32_16x16x32_bf16 v[8:11], v[120:123], v[96:99], v[8:11]
    v_add_u16 v240, 0x4000, v240
    v_mfma_f32_16x16x32_bf16 v[12:15], v[124:127], v[96:99], v[12:15]
    s_add_u32 s16, s16, 16896
    s_cmp_eq_u32 s16, 84480
    v_mfma_f32_16x16x32_bf16 v[28:31], v[124:127], v[100:103], v[28:31]
    s_cselect_b32 s16, 0, s16
    v_mfma_f32_16x16x32_bf16 v[24:27], v[120:123], v[100:103], v[24:27]
    v_add_u32 v242, s16, v241
    v_mfma_f32_16x16x32_bf16 v[20:23], v[116:119], v[100:103], v[20:23]
    s_sub_u32 s17, s17, 1
    s_cmp_lg_u32 s17, 0
    v_mfma_f32_16x16x32_bf16 v[16:19], v[112:115], v[100:103], v[16:19]
    s_waitcnt lgkmcnt(0)
    s_cbranch_scc1 r3_loop
    s_add_u32 s65, s22, 4096
    v_cvt_pk_bf16_f32 v32, v32, v33
    v_cvt_pk_bf16_f32 v33, v34, v35
    v_cvt_pk_bf16_f32 v34, v36, v37
    v_cvt_pk_bf16_f32 v35, v38, v39
    buffer_store_dwordx4 v[32:35], v249, s[80:83], s22 offen offset:0 sc0 sc1
    v_cvt_pk_bf16_f32 v40, v40, v41
    v_cvt_pk_bf16_f32 v41, v42, v43
    v_cvt_pk_bf16_f32 v42, v44, v45
    v_cvt_pk_bf16_f32 v43, v46, v47
    buffer_store_dwordx4 v[40:43], v249, s[80:83], s22 offen offset:1024 sc0 sc1
    v_cvt_pk_bf16_f32 v48, v48, v49
    v_cvt_pk_bf16_f32 v49, v50, v51
    v_cvt_pk_bf16_f32 v50, v52, v53
    v_cvt_pk_bf16_f32 v51, v54, v55
    buffer_store_dwordx4 v[48:51], v249, s[80:83], s22 offen offset:2048 sc0 sc1
    v_cvt_pk_bf16_f32 v56, v56, v57
    v_cvt_pk_bf16_f32 v57, v58, v59
    v_cvt_pk_bf16_f32 v58, v60, v61
    v_cvt_pk_bf16_f32 v59, v62, v63
    buffer_store_dwordx4 v[56:59], v249, s[80:83], s22 offen offset:3072 sc0 sc1
    s_waitcnt vmcnt(4)
    v_lshlrev_b32 v144, 16, v128
    v_and_b32 v145, 0xffff0000, v128
    v_lshlrev_b32 v146, 16, v129
    v_and_b32 v147, 0xffff0000, v129
    v_lshlrev_b32 v148, 16, v130
    v_and_b32 v149, 0xffff0000, v130
    v_lshlrev_b32 v150, 16, v131
    v_and_b32 v151, 0xffff0000, v131
    v_lshlrev_b32 v152, 16, v132
    v_and_b32 v153, 0xffff0000, v132
    v_lshlrev_b32 v154, 16, v133
    v_and_b32 v155, 0xffff0000, v133
    v_lshlrev_b32 v156, 16, v134
    v_and_b32 v157, 0xffff0000, v134
    v_lshlrev_b32 v158, 16, v135
    v_and_b32 v159, 0xffff0000, v135
    v_lshlrev_b32 v160, 16, v136
    v_and_b32 v161, 0xffff0000, v136
    v_lshlrev_b32 v162, 16, v137
    v_and_b32 v163, 0xffff0000, v137
    v_lshlrev_b32 v164, 16, v138
    v_and_b32 v165, 0xffff0000, v138
    v_lshlrev_b32 v166, 16, v139
    v_and_b32 v167, 0xffff0000, v139
    v_lshlrev_b32 v168, 16, v140
    v_and_b32 v169, 0xffff0000, v140
    v_lshlrev_b32 v170, 16, v141
    v_and_b32 v171, 0xffff0000, v141
    v_lshlrev_b32 v172, 16, v142
    v_and_b32 v173, 0xffff0000, v142
    v_lshlrev_b32 v174, 16, v143
    v_and_b32 v175, 0xffff0000, v143
    v_mov_b32 v208, 0
    v_mov_b32 v209, 1
    s_waitcnt vmcnt(0)
    s_mov_b64 exec, 1
    buffer_store_dword v209, v208, s[80:83], s23 offen sc0 sc1
    s_mov_b64 exec, -1
    s_barrier
    s_xor_b32 s23, s23, 512
    s_xor_b32 s22, s22, 32768
    s_mov_b64 exec, 1
pl_3195:
    buffer_load_dword v210, v208, s[80:83], s23 offen sc1
    s_sub_u32 s79, s79, 1
    s_cbranch_scc1 L_abort
    s_waitcnt vmcnt(0)
    v_cmp_ne_u32 vcc, 1, v210
    s_cbranch_vccnz pl_3195
    s_mov_b64 exec, -1
    s_add_u32 s65, s22, 4096
    buffer_load_dwordx4 v[32:35], v249, s[80:83], s22 offen offset:0 sc1
    buffer_load_dwordx4 v[36:39], v249, s[80:83], s22 offen offset:1024 sc1
    buffer_load_dwordx4 v[40:43], v249, s[80:83], s22 offen offset:2048 sc1
    buffer_load_dwordx4 v[44:47], v249, s[80:83], s22 offen offset:3072 sc1
    v_mov_b32 v88, 0x3f803f80
    s_cmp_lg_u32 s75, 0
    s_cbranch_scc1 fo_3196_out
    s_waitcnt vmcnt(2)
    v_lshlrev_b32 v176, 16, v32
    v_lshlrev_b32 v178, 16, v33
    v_lshlrev_b32 v180, 16, v34
    v_lshlrev_b32 v182, 16, v35
    v_lshlrev_b32 v184, 16, v36
    v_lshlrev_b32 v186, 16, v37
    v_lshlrev_b32 v188, 16, v38
    v_lshlrev_b32 v190, 16, v39
    v_and_b32 v177, 0xffff0000, v32
    v_and_b32 v179, 0xffff0000, v33
    v_and_b32 v181, 0xffff0000, v34
    v_and_b32 v183, 0xffff0000, v35
    v_and_b32 v185, 0xffff0000, v36
    v_and_b32 v187, 0xffff0000, v37
    v_and_b32 v189, 0xffff0000, v38
    v_and_b32 v191, 0xffff0000, v39
    v_pk_add_f32 v[0:1], v[0:1], v[176:177]
    v_pk_add_f32 v[2:3], v[2:3], v[178:179]
    v_pk_add_f32 v[4:5], v[4:5], v[180:181]
    v_pk_add_f32 v[6:7], v[6:7], v[182:183]
    v_pk_add_f32 v[8:9], v[8:9], v[184:185]
    v_pk_add_f32 v[10:11], v[10:11], v[186:187]
    v_pk_add_f32 v[12:13], v[12:13], v[188:189]
    v_pk_add_f32 v[14:15], v[14:15], v[190:191]
    v_cvt_pk_bf16_f32 v208, v0, v1
    v_cvt_pk_bf16_f32 v209, v2, v3
    v_cvt_pk_bf16_f32 v210, v4, v5
    v_cvt_pk_bf16_f32 v211, v6, v7
    v_cvt_pk_bf16_f32 v212, v8, v9
    v_cvt_pk_bf16_f32 v213, v10, v11
    v_cvt_pk_bf16_f32 v214, v12, v13
    v_cvt_pk_bf16_f32 v215, v14, v15
    v_lshlrev_b32 v96, 16, v208
    v_lshlrev_b32 v98, 16, v209
    v_lshlrev_b32 v100, 16, v210
    v_lshlrev_b32 v102, 16, v211
    v_lshlrev_b32 v104, 16, v212
    v_lshlrev_b32 v106, 16, v213
    v_lshlrev_b32 v108, 16, v214
    v_lshlrev_b32 v110, 16, v215
    v_and_b32 v97, 0xffff0000, v208
    v_and_b32 v99, 0xffff0000, v209
    v_and_b32 v101, 0xffff0000, v210
    v_and_b32 v103, 0xffff0000, v211
    v_and_b32 v105, 0xffff0000, v212
    v_and_b32 v107, 0xffff0000, v213
    v_and_b32 v109, 0xffff0000, v214
    v_and_b32 v111, 0xffff0000, v215
    v_pk_add_f32 v[96:97], v[96:97], v[144:145]
    v_pk_add_f32 v[98:99], v[98:99], v[146:147]
    v_pk_add_f32 v[100:101], v[100:101], v[148:149]
    v_pk_add_f32 v[102:103], v[102:103], v[150:151]
    v_pk_add_f32 v[104:105], v[104:105], v[152:153]
    v_pk_add_f32 v[106:107], v[106:107], v[154:155]
    v_pk_add_f32 v[108:109], v[108:109], v[156:157]
    v_pk_add_f32 v[110:111], v[110:111], v[158:159]
    v_cvt_pk_bf16_f32 v64, v96, v97
    v_cvt_pk_bf16_f32 v65, v98, v99
    v_cvt_pk_bf16_f32 v66, v100, v101
    v_cvt_pk_bf16_f32 v67, v102, v103
    v_cvt_pk_bf16_f32 v68, v104, v105
    v_cvt_pk_bf16_f32 v69, v106, v107
    v_cvt_pk_bf16_f32 v70, v108, v109
    v_cvt_pk_bf16_f32 v71, v110, v111
    buffer_store_dwordx4 v[64:67], v249, s[80:83], s20 offen offset:0 sc0 sc1
    buffer_store_dwordx4 v[68:71], v249, s[80:83], s21 offen offset:0 sc0 sc1
    s_waitcnt vmcnt(2)
    v_lshlrev_b32 v192, 16, v40
    v_lshlrev_b32 v194, 16, v41
    v_lshlrev_b32 v196, 16, v42
    v_lshlrev_b32 v198, 16, v43
    v_lshlrev_b32 v200, 16, v44
    v_lshlrev_b32 v202, 16, v45
    v_lshlrev_b32 v204, 16, v46
    v_lshlrev_b32 v206, 16, v47
    v_and_b32 v193, 0xffff0000, v40
    v_and_b32 v195, 0xffff0000, v41
    v_and_b32 v197, 0xffff0000, v42
    v_and_b32 v199, 0xffff0000, v43
    v_and_b32 v201, 0xffff0000, v44
    v_and_b32 v203, 0xffff0000, v45
    v_and_b32 v205, 0xffff0000, v46
    v_and_b32 v207, 0xffff0000, v47
    v_pk_add_f32 v[16:17], v[16:17], v[192:193]
    v_pk_add_f32 v[18:19], v[18:19], v[194:195]
    v_pk_add_f32 v[20:21], v[20:21], v[196:197]
    v_pk_add_f32 v[22:23], v[22:23], v[198:199]
    v_pk_add_f32 v[24:25], v[24:25], v[200:201]
    v_pk_add_f32 v[26:27], v[26:27], v[202:203]
    v_pk_add_f32 v[28:29], v[28:29], v[204:205]
    v_pk_add_f32 v[30:31], v[30:31], v[206:207]
    v_cvt_pk_bf16_f32 v208, v16, v17
    v_cvt_pk_bf16_f32 v209, v18, v19
    v_cvt_pk_bf16_f32 v210, v20, v21
    v_cvt_pk_bf16_f32 v211, v22, v23
    v_cvt_pk_bf16_f32 v212, v24, v25
    v_cvt_pk_bf16_f32 v213, v26, v27
    v_cvt_pk_bf16_f32 v214, v28, v29
    v_cvt_pk_bf16_f32 v215, v30, v31
    v_lshlrev_b32 v96, 16, v208
    v_lshlrev_b32 v98, 16, v209
    v_lshlrev_b32 v100, 16, v210
    v_lshlrev_b32 v102, 16, v211
    v_lshlrev_b32 v104, 16, v212
    v_lshlrev_b32 v106, 16, v213
    v_lshlrev_b32 v108, 16, v214
    v_lshlrev_b32 v110, 16, v215
    v_and_b32 v97, 0xffff0000, v208
    v_and_b32 v99, 0xffff0000, v209
    v_and_b32 v101, 0xffff0000, v210
    v_and_b32 v103, 0xffff0000, v211
    v_and_b32 v105, 0xffff0000, v212
    v_and_b32 v107, 0xffff0000, v213
    v_and_b32 v109, 0xffff0000, v214
    v_and_b32 v111, 0xffff0000, v215
    v_pk_add_f32 v[96:97], v[96:97], v[160:161]
    v_pk_add_f32 v[98:99], v[98:99], v[162:163]
    v_pk_add_f32 v[100:101], v[100:101], v[164:165]
    v_pk_add_f32 v[102:103], v[102:103], v[166:167]
    v_pk_add_f32 v[104:105], v[104:105], v[168:169]
    v_pk_add_f32 v[106:107], v[106:107], v[170:171]
    v_pk_add_f32 v[108:109], v[108:109], v[172:173]
    v_pk_add_f32 v[110:111], v[110:111], v[174:175]
    v_cvt_pk_bf16_f32 v72, v96, v97
    v_cvt_pk_bf16_f32 v73, v98, v99
    v_cvt_pk_bf16_f32 v74, v100, v101
    v_cvt_pk_bf16_f32 v75, v102, v103
    v_cvt_pk_bf16_f32 v76, v104, v105
    v_cvt_pk_bf16_f32 v77, v106, v107
    v_cvt_pk_bf16_f32 v78, v108, v109
    v_cvt_pk_bf16_f32 v79, v110, v111
    buffer_store_dwordx4 v[72:75], v249, s[80:83], s20 offen offset:1024 sc0 sc1
    buffer_store_dwordx4 v[76:79], v249, s[80:83], s21 offen offset:1024 sc0 sc1
    v_dot2_f32_bf16 v80, v64, v88, 0
    v_dot2_f32_bf16 v84, v64, v64, 0
    v_dot2_f32_bf16 v81, v68, v88, 0
    v_dot2_f32_bf16 v85, v68, v68, 0
    v_dot2_f32_bf16 v82, v72, v88, 0
    v_dot2_f32_bf16 v86, v72, v72, 0
    v_dot2_f32_bf16 v83, v76, v88, 0
    v_dot2_f32_bf16 v87, v76, v76, 0
    v_dot2_f32_bf16 v80, v65, v88, v80
    v_dot2_f32_bf16 v84, v65, v65, v84
    v_dot2_f32_bf16 v81, v69, v88, v81
    v_dot2_f32_bf16 v85, v69, v69, v85
    v_dot2_f32_bf16 v82, v73, v88, v82
    v_dot2_f32_bf16 v86, v73, v73, v86
    v_dot2_f32_bf16 v83, v77, v88, v83
    v_dot2_f32_bf16 v87, v77, v77, v87
    v_dot2_f32_bf16 v80, v66, v88, v80
    v_dot2_f32_bf16 v84, v66, v66, v84
    v_dot2_f32_bf16 v81, v70, v88, v81
    v_dot2_f32_bf16 v85, v70, v70, v85
    v_dot2_f32_bf16 v82, v74, v88, v82
    v_dot2_f32_bf16 v86, v74, v74, v86
    v_dot2_f32_bf16 v83, v78, v88, v83
    v_dot2_f32_bf16 v87, v78, v78, v87
    v_dot2_f32_bf16 v80, v67, v88, v80
    v_dot2_f32_bf16 v84, v67, v67, v84
    v_dot2_f32_bf16 v81, v71, v88, v81
    v_dot2_f32_bf16 v85, v71, v71, v85
    v_dot2_f32_bf16 v82, v75, v88, v82
    v_dot2_f32_bf16 v86, v75, v75, v86
    v_dot2_f32_bf16 v83, v79, v88, v83
    v_dot2_f32_bf16 v87, v79, v79, v87
    s_nop 2
    v_permlane16_swap_b32 v80, v81
    v_permlane16_swap_b32 v82, v83
    v_permlane16_swap_b32 v84, v85
    v_permlane16_swap_b32 v86, v87
    v_add_f32 v80, v80, v81
    v_add_f32 v82, v82, v83
    v_add_f32 v84, v84, v85
    v_add_f32 v86, v86, v87
    s_nop 1
    v_permlane32_swap_b32 v80, v82
    v_permlane32_swap_b32 v84, v86
    v_add_f32 v80, v80, v82
    v_add_f32 v81, v84, v86
    buffer_store_dwordx2 v[80:81], v239, s[80:83], s24 offen sc0 sc1
    s_lshl_b32 s64, s75, 15
    s_lshl_b32 s66, s73, 9
    s_add_u32 s64, s64, s66
    s_add_u32 s64, s64, 75522048
    s_lshl_b32 s65, s72, 5
    s_add_u32 s64, s64, s65
    s_lshl_b32 s65, s3, 2
    s_add_u32 s64, s64, s65
    v_mov_b32 v208, 0
    v_mov_b32 v209, 1
    s_cmp_lg_u32 s78, 0
    s_cbranch_scc1 sg_3197_slow
    s_waitcnt vmcnt(0)
    s_mov_b64 exec, 1
    buffer_store_dword v209, v208, s[80:83], s64 offen
    s_mov_b64 exec, -1
sg_3197_done:
    s_branch fo_3196_end
fo_3196_out:
    s_mov_b32 s8, s98
    s_mov_b32 s9, s99
    s_mov_b32 s10, 4194304
    s_mov_b32 s11, 0x00020000
    s_lshl_b32 s64, s73, 1
    s_add_u32 s64, s64, s68
    s_lshl_b32 s64, s64, 1
    s_lshr_b32 s65, s3, 1
    s_add_u32 s64, s64, s65
    s_lshl_b32 s64, s64, 16
    s_lshl_b32 s65, s25, 7
    s_add_u32 s64, s64, s65
    v_lshlrev_b32 v243, 11, v252
    v_add_u32 v243, s64, v243
    v_and_b32 v253, 1, v251
    v_lshl_add_u32 v243, v253, 5, v243
    v_lshrrev_b32 v253, 1, v251
    v_lshl_add_u32 v243, v253, 4, v243
    s_waitcnt vmcnt(2)
    v_lshlrev_b32 v176, 16, v32
    v_lshlrev_b32 v178, 16, v33
    v_lshlrev_b32 v180, 16, v34
    v_lshlrev_b32 v182, 16, v35
    v_lshlrev_b32 v184, 16, v36
    v_lshlrev_b32 v186, 16, v37
    v_lshlrev_b32 v188, 16, v38
    v_lshlrev_b32 v190, 16, v39
    v_and_b32 v177, 0xffff0000, v32
    v_and_b32 v179, 0xffff0000, v33
    v_and_b32 v181, 0xffff0000, v34
    v_and_b32 v183, 0xffff0000, v35
    v_and_b32 v185, 0xffff0000, v36
    v_and_b32 v187, 0xffff0000, v37
    v_and_b32 v189, 0xffff0000, v38
    v_and_b32 v191, 0xffff0000, v39
    v_pk_add_f32 v[0:1], v[0:1], v[176:177]
    v_pk_add_f32 v[2:3], v[2:3], v[178:179]
    v_pk_add_f32 v[4:5], v[4:5], v[180:181]
    v_pk_add_f32 v[6:7], v[6:7], v[182:183]
    v_pk_add_f32 v[8:9], v[8:9], v[184:185]
    v_pk_add_f32 v[10:11], v[10:11], v[186:187]
    v_pk_add_f32 v[12:13], v[12:13], v[188:189]
    v_pk_add_f32 v[14:15], v[14:15], v[190:191]
    v_cvt_pk_bf16_f32 v208, v0, v1
    v_cvt_pk_bf16_f32 v209, v2, v3
    v_cvt_pk_bf16_f32 v210, v4, v5
    v_cvt_pk_bf16_f32 v211, v6, v7
    v_cvt_pk_bf16_f32 v212, v8, v9
    v_cvt_pk_bf16_f32 v213, v10, v11
    v_cvt_pk_bf16_f32 v214, v12, v13
    v_cvt_pk_bf16_f32 v215, v14, v15
    v_lshlrev_b32 v96, 16, v208
    v_lshlrev_b32 v98, 16, v209
    v_lshlrev_b32 v100, 16, v210
    v_lshlrev_b32 v102, 16, v211
    v_lshlrev_b32 v104, 16, v212
    v_lshlrev_b32 v106, 16, v213
    v_lshlrev_b32 v108, 16, v214
    v_lshlrev_b32 v110, 16, v215
    v_and_b32 v97, 0xffff0000, v208
    v_and_b32 v99, 0xffff0000, v209
    v_and_b32 v101, 0xffff0000, v210
    v_and_b32 v103, 0xffff0000, v211
    v_and_b32 v105, 0xffff0000, v212
    v_and_b32 v107, 0xffff0000, v213
    v_and_b32 v109, 0xffff0000, v214
    v_and_b32 v111, 0xffff0000, v215
    v_pk_add_f32 v[96:97], v[96:97], v[144:145]
    v_pk_add_f32 v[98:99], v[98:99], v[146:147]
    v_pk_add_f32 v[100:101], v[100:101], v[148:149]
    v_pk_add_f32 v[102:103], v[102:103], v[150:151]
    v_pk_add_f32 v[104:105], v[104:105], v[152:153]
    v_pk_add_f32 v[106:107], v[106:107], v[154:155]
    v_pk_add_f32 v[108:109], v[108:109], v[156:157]
    v_pk_add_f32 v[110:111], v[110:111], v[158:159]
    v_cvt_pk_bf16_f32 v64, v96, v97
    v_cvt_pk_bf16_f32 v65, v98, v99
    v_cvt_pk_bf16_f32 v66, v100, v101
    v_cvt_pk_bf16_f32 v67, v102, v103
    v_cvt_pk_bf16_f32 v68, v104, v105
    v_cvt_pk_bf16_f32 v69, v106, v107
    v_cvt_pk_bf16_f32 v70, v108, v109
    v_cvt_pk_bf16_f32 v71, v110, v111
    s_mov_b32 s64, 0
    s_nop 0
    v_permlane16_swap_b32 v64, v66
    v_permlane16_swap_b32 v65, v67
    buffer_store_dwordx4 v[64:67], v243, s[8:11], s64 offen offset:0
    s_mov_b32 s64, 0
    s_nop 0
    v_permlane16_swap_b32 v68, v70
    v_permlane16_swap_b32 v69, v71
    buffer_store_dwordx4 v[68:71], v243, s[8:11], s64 offen offset:64
    s_waitcnt vmcnt(2)
    v_lshlrev_b32 v192, 16, v40
    v_lshlrev_b32 v194, 16, v41
    v_lshlrev_b32 v196, 16, v42
    v_lshlrev_b32 v198, 16, v43
    v_lshlrev_b32 v200, 16, v44
    v_lshlrev_b32 v202, 16, v45
    v_lshlrev_b32 v204, 16, v46
    v_lshlrev_b32 v206, 16, v47
    v_and_b32 v193, 0xffff0000, v40
    v_and_b32 v195, 0xffff0000, v41
    v_and_b32 v197, 0xffff0000, v42
    v_and_b32 v199, 0xffff0000, v43
    v_and_b32 v201, 0xffff0000, v44
    v_and_b32 v203, 0xffff0000, v45
    v_and_b32 v205, 0xffff0000, v46
    v_and_b32 v207, 0xffff0000, v47
    v_pk_add_f32 v[16:17], v[16:17], v[192:193]
    v_pk_add_f32 v[18:19], v[18:19], v[194:195]
    v_pk_add_f32 v[20:21], v[20:21], v[196:197]
    v_pk_add_f32 v[22:23], v[22:23], v[198:199]
    v_pk_add_f32 v[24:25], v[24:25], v[200:201]
    v_pk_add_f32 v[26:27], v[26:27], v[202:203]
    v_pk_add_f32 v[28:29], v[28:29], v[204:205]
    v_pk_add_f32 v[30:31], v[30:31], v[206:207]
    v_cvt_pk_bf16_f32 v208, v16, v17
    v_cvt_pk_bf16_f32 v209, v18, v19
    v_cvt_pk_bf16_f32 v210, v20, v21
    v_cvt_pk_bf16_f32 v211, v22, v23
    v_cvt_pk_bf16_f32 v212, v24, v25
    v_cvt_pk_bf16_f32 v213, v26, v27
    v_cvt_pk_bf16_f32 v214, v28, v29
    v_cvt_pk_bf16_f32 v215, v30, v31
    v_lshlrev_b32 v96, 16, v208
    v_lshlrev_b32 v98, 16, v209
    v_lshlrev_b32 v100, 16, v210
    v_lshlrev_b32 v102, 16, v211
    v_lshlrev_b32 v104, 16, v212
    v_lshlrev_b32 v106, 16, v213
    v_lshlrev_b32 v108, 16, v214
    v_lshlrev_b32 v110, 16, v215
    v_and_b32 v97, 0xffff0000, v208
    v_and_b32 v99, 0xffff0000, v209
    v_and_b32 v101, 0xffff0000, v210
    v_and_b32 v103, 0xffff0000, v211
    v_and_b32 v105, 0xffff0000, v212
    v_and_b32 v107, 0xffff0000, v213
    v_and_b32 v109, 0xffff0000, v214
    v_and_b32 v111, 0xffff0000, v215
    v_pk_add_f32 v[96:97], v[96:97], v[160:161]
    v_pk_add_f32 v[98:99], v[98:99], v[162:163]
    v_pk_add_f32 v[100:101], v[100:101], v[164:165]
    v_pk_add_f32 v[102:103], v[102:103], v[166:167]
    v_pk_add_f32 v[104:105], v[104:105], v[168:169]
    v_pk_add_f32 v[106:107], v[106:107], v[170:171]
    v_pk_add_f32 v[108:109], v[108:109], v[172:173]
    v_pk_add_f32 v[110:111], v[110:111], v[174:175]
    v_cvt_pk_bf16_f32 v72, v96, v97
    v_cvt_pk_bf16_f32 v73, v98, v99
    v_cvt_pk_bf16_f32 v74, v100, v101
    v_cvt_pk_bf16_f32 v75, v102, v103
    v_cvt_pk_bf16_f32 v76, v104, v105
    v_cvt_pk_bf16_f32 v77, v106, v107
    v_cvt_pk_bf16_f32 v78, v108, v109
    v_cvt_pk_bf16_f32 v79, v110, v111
    s_mov_b32 s64, 32768
    s_nop 0
    v_permlane16_swap_b32 v72, v74
    v_permlane16_swap_b32 v73, v75
    buffer_store_dwordx4 v[72:75], v243, s[8:11], s64 offen offset:0
    s_mov_b32 s64, 32768
    s_nop 0
    v_permlane16_swap_b32 v76, v78
    v_permlane16_swap_b32 v77, v79
    buffer_store_dwordx4 v[76:79], v243, s[8:11], s64 offen offset:64
fo_3196_end:
    s_add_u32 s75, s75, 1
    s_mov_b32 s59, s78
    s_mul_i32 s60, s59, s75
    s_cmp_lt_u32 s75, 2
    s_cbranch_scc1 C_layer
    s_branch L_fin
g1c_rem:
    v_cvt_pk_bf16_f32 v56, v24, v25
    v_cvt_pk_bf16_f32 v57, v26, v27
    v_cvt_pk_bf16_f32 v58, v28, v29
    v_cvt_pk_bf16_f32 v59, v30, v31
    buffer_store_dwordx4 v[56:59], v249, s[80:83], s21 offen offset:0 sc0 sc1
    v_cvt_pk_bf16_f32 v60, v32, v33
    v_cvt_pk_bf16_f32 v61, v34, v35
    v_cvt_pk_bf16_f32 v62, v36, v37
    v_cvt_pk_bf16_f32 v63, v38, v39
    buffer_store_dwordx4 v[60:63], v249, s[80:83], s21 offen offset:1024 sc0 sc1
    v_cvt_pk_bf16_f32 v64, v40, v41
    v_cvt_pk_bf16_f32 v65, v42, v43
    v_cvt_pk_bf16_f32 v66, v44, v45
    v_cvt_pk_bf16_f32 v67, v46, v47
    buffer_store_dwordx4 v[64:67], v249, s[80:83], s21 offen offset:2048 sc0 sc1
    v_cvt_pk_bf16_f32 v68, v48, v49
    v_cvt_pk_bf16_f32 v69, v50, v51
    v_cvt_pk_bf16_f32 v70, v52, v53
    v_cvt_pk_bf16_f32 v71, v54, v55
    buffer_store_dwordx4 v[68:71], v249, s[80:83], s21 offen offset:3072 sc0 sc1
    s_branch g1c_remb
sg_3191_slow:
    s_waitcnt vmcnt(0)
    buffer_wbl2 sc1
    s_waitcnt vmcnt(0)
    s_mov_b64 exec, 1
    buffer_store_dword v109, v108, s[80:83], s64 offen sc0 sc1
    s_mov_b64 exec, -1
    s_branch sg_3191_done
sg_3193_slow:
    s_waitcnt vmcnt(0)
    buffer_wbl2 sc1
    s_waitcnt vmcnt(0)
    s_mov_b64 exec, 1
    buffer_store_dword v209, v208, s[80:83], s64 offen sc0 sc1
    s_mov_b64 exec, -1
    s_branch sg_3193_done
sg_3194_slow:
    s_waitcnt vmcnt(0)
    buffer_wbl2 sc1
    s_waitcnt vmcnt(0)
    s_mov_b64 exec, 1
    buffer_store_dword v237, v236, s[80:83], s64 offen sc0 sc1
    s_mov_b64 exec, -1
    s_branch sg_3194_done
sg_3197_slow:
    s_waitcnt vmcnt(0)
    buffer_wbl2 sc1
    s_waitcnt vmcnt(0)
    s_mov_b64 exec, 1
    buffer_store_dword v209, v208, s[80:83], s64 offen sc0 sc1
    s_mov_b64 exec, -1
    s_branch sg_3197_done
L_fin:
L_abort:
L_end:
    s_endpgm
.section .rodata,"a"
.p2align 6
.amdhsa_kernel interleave_layers__sliding_local_dilated__glu_gated_swiglu__prompt_kernel
  .amdhsa_next_free_vgpr 256
  .amdhsa_next_free_sgpr 102
  .amdhsa_accum_offset 256
  .amdhsa_group_segment_fixed_size 0
  .amdhsa_kernarg_size 80
  .amdhsa_user_sgpr_count 2
  .amdhsa_user_sgpr_kernarg_segment_ptr 1
  .amdhsa_system_sgpr_workgroup_id_x 1
.end_amdhsa_kernel
```
